```python
import torch

def _softmax(x, axis=-1):
    return torch.softmax(x, dim=axis)
def _gelu(x):
    return torch.nn.functional.gelu(x, approximate="tanh")
def _silu(x):
    return torch.nn.functional.silu(x)
def _sigmoid(x):
    return torch.sigmoid(x)
def _layernorm(x, axis=-1, eps=1e-5):
    m = x.mean(dim=axis, keepdim=True)
    v = x.var(dim=axis, keepdim=True, unbiased=False)
    return (x - m) / torch.sqrt(v + eps)
def _scatter_add(tgt, idx, src, axis=0):
    return tgt.clone().index_add_(axis, idx, src)
def _segment_sum(src, seg, n):
    out = torch.zeros((n,) + src.shape[1:], dtype=src.dtype)
    return out.index_add_(0, seg, src)
def _pad(x, pw):
    flat = tuple(v for pair in reversed(pw) for v in pair)
    return torch.nn.functional.pad(x, flat)

kernel_name = 'concat_heads__ssm_conv_h3__ssm_conv_s5__prompt'

def setup_inputs():

    _w = (lambda a: (lambda t: t.to(torch.bfloat16) if t.is_floating_point() else t)(torch.as_tensor(a)))
    def _A_setup():
        B, S, D = 1, 2048, 1024
        ks = 4
        return {
            "q": _w((lambda *s: torch.randn(*s, dtype=torch.bfloat16) * 0.05)(B, S, D)),
            "k": _w((lambda *s: torch.randn(*s, dtype=torch.bfloat16) * 0.2)(B, S, D)),
            "v": _w((lambda *s: torch.randn(*s, dtype=torch.bfloat16) * 0.2)(B, S, D)),
            "shift_k": _w((lambda *s: torch.randn(*s, dtype=torch.bfloat16) * 0.2)(D, ks) * 0.5),
            "ssm_k": _w((lambda *s: torch.randn(*s, dtype=torch.bfloat16) * 0.8)(D, S) * (1.0 / S ** 0.5)),
            "ssm_D": _w((lambda *s: torch.randn(*s, dtype=torch.bfloat16) * 0.2)(D)),
        }
    _A_in = _A_setup()

    def _B_setup():
        B, S, D = 1, 2048, 1024
        P = D
        Lambda_re = -0.5 * (lambda _x: torch.exp(torch.as_tensor(_x)))((lambda *s: torch.randn(*s, dtype=torch.bfloat16) * 0.2)(P))
        Lambda_im = (lambda *s: torch.randn(*s, dtype=torch.bfloat16) * 0.4)(P) * 1.0
        B_re = (lambda *s: torch.randn(*s, dtype=torch.bfloat16) * 0.2)(P, D) * (D ** -0.5)
        B_im = (lambda *s: torch.randn(*s, dtype=torch.bfloat16) * 0.2)(P, D) * (D ** -0.5)
        C_re = (lambda *s: torch.randn(*s, dtype=torch.bfloat16) * 0.2)(D, P) * (P ** -0.5)
        C_im = (lambda *s: torch.randn(*s, dtype=torch.bfloat16) * 0.2)(D, P) * (P ** -0.5)
        log_dt = (lambda *s: torch.randn(*s, dtype=torch.bfloat16) * 0.2)(P) * 0.3 - 2.0
        Dskip = (lambda *s: torch.randn(*s, dtype=torch.bfloat16) * 0.05)(D)
        return {
            "x": _w((lambda *s: torch.randn(*s, dtype=torch.bfloat16) * 0.05)(B, S, D)),
            "Lambda_re": _w(Lambda_re),
            "Lambda_im": _w(Lambda_im),
            "B_re": _w(B_re),
            "B_im": _w(B_im),
            "C_re": _w(C_re),
            "C_im": _w(C_im),
            "log_dt": _w(log_dt),
            "Dskip": _w(Dskip),
        }
    _B_in = _B_setup()

    return {
        "A_q": _A_in["q"],
        "A_k": _A_in["k"],
        "A_v": _A_in["v"],
        "A_shift_k": _A_in["shift_k"],
        "A_ssm_k": _A_in["ssm_k"],
        "A_ssm_D": _A_in["ssm_D"],
        "B_x": _B_in["x"],
        "B_Lambda_re": _B_in["Lambda_re"],
        "B_Lambda_im": _B_in["Lambda_im"],
        "B_B_re": _B_in["B_re"],
        "B_B_im": _B_in["B_im"],
        "B_C_re": _B_in["C_re"],
        "B_C_im": _B_in["C_im"],
        "B_log_dt": _B_in["log_dt"],
        "B_Dskip": _B_in["Dskip"],
    }

def reference(A_q, A_k, A_v, A_shift_k, A_ssm_k, A_ssm_D, B_x, B_Lambda_re, B_Lambda_im, B_B_re, B_B_im, B_C_re, B_C_im, B_log_dt, B_Dskip):
    def _A_ref(q, k, v, shift_k, ssm_k, ssm_D):
        B, S, D = q.shape
        ks = shift_k.shape[-1]
        k_pad = _pad(k, ((0, 0), (ks - 1, 0), (0, 0)))
        k_shift = torch.zeros_like(k)
        for t in range(ks):
            k_shift = k_shift + k_pad[:, t:t + S, :] * shift_k[:, ks - 1 - t][None, None, :]
        kv = k_shift * v
        L = 2 * S
        kv_pad = _pad(kv, ((0, 0), (0, S), (0, 0)))
        kf_pad = _pad(ssm_k, ((0, 0), (0, S)))
        kv_f = (lambda x, axes=(-2,-1): torch.fft.rfft2(x.float(), dim=axes))(kv_pad[:, None, :, :], axes=(1, 2))
        kf_f = (lambda x, axes=(-2,-1): torch.fft.rfft2(x.float(), dim=axes))(kf_pad[:, None, :], axes=(1, 2))
        kf_f = (lambda x, *d: x.permute(*d))(kf_f, 1, 2, 0)
        y_f = kv_f * kf_f[None, :, :, :]
        y = (lambda x, s, axes=(-2,-1): torch.fft.irfft2(x, s=s, dim=axes).to(torch.bfloat16))(y_f, (1, L), axes=(1, 2))[:, 0, :S, :]
        y = y + kv * ssm_D[None, None, :]
        return q * y

    def _B_ref(x, Lambda_re, Lambda_im, B_re, B_im, C_re, C_im, log_dt, Dskip):
        Bsz, L, H = x.shape
        Lam = Lambda_re + 1j * Lambda_im
        Bmat = B_re + 1j * B_im
        Cmat = C_re + 1j * C_im
        dt = torch.exp(log_dt)
        Lam_bar = torch.exp(dt * Lam)
        B_bar = ((Lam_bar - 1.0) / Lam)[:, None] * Bmat
        Bu = torch.einsum("bld,pd->blp", x + 0j, B_bar)
        h = torch.zeros_like(Bu[:, 0, :])
        hs = []
        for t in range(L):
            h = Lam_bar[None, :] * h + Bu[:, t, :]
            hs.append(h)
        hseq = torch.stack(hs, 1)
        y = 2.0 * torch.einsum("blp,dp->bld", hseq, Cmat).real + x * Dskip[None, None, :]
        return y

    a = _A_ref(A_q, A_k, A_v, A_shift_k, A_ssm_k, A_ssm_D)
    b = _B_ref(B_x, B_Lambda_re, B_Lambda_im, B_B_re, B_B_im, B_C_re, B_C_im, B_log_dt, B_Dskip)
    return torch.concatenate([a, b], axis=-1)
```

```asm
; @launch grid=(256,1,1) block=(512,1,1) lds=163840
.amdgcn_target "amdgcn-amd-amdhsa--gfx950"
.text
.globl concat_heads__ssm_conv_h3__ssm_conv_s5__prompt_kernel
.p2align 8
.type concat_heads__ssm_conv_h3__ssm_conv_s5__prompt_kernel,@function
concat_heads__ssm_conv_h3__ssm_conv_s5__prompt_kernel:
    s_cmp_ge_u32 s2, 256
    s_cbranch_scc1 Y_done
    s_load_dwordx16 s[16:31], s[0:1], 0
    s_load_dwordx16 s[32:47], s[0:1], 64
    s_load_dwordx4 s[48:51], s[0:1], 128
    v_lshrrev_b32 v1, 6, v0
    v_and_b32 v2, 63, v0
    s_and_b32 s4, s2, 7
    v_readfirstlane_b32 s3, v1
    s_lshr_b32 s5, s2, 3
    s_and_b32 s6, s4, 3
    s_lshl_b32 s6, s6, 2
    s_and_b32 s7, s5, 3
    s_add_u32 s6, s6, s7
    s_and_b32 s7, s4, 4
    s_lshl_b32 s7, s7, 1
    s_lshr_b32 s8, s5, 2
    s_add_u32 s7, s7, s8
    s_and_b32 s9, s5, 3
    s_add_u32 s101, s8, s9
    s_lshl_b32 s101, s101, 2
    s_and_b32 s9, s4, 3
    s_add_u32 s101, s101, s9
    s_lshr_b32 s9, s4, 2
    s_lshl_b32 s9, s9, 1
    s_add_u32 s101, s101, s9
    s_lshl_b32 s101, s101, 1
    s_and_b32 s101, s101, 15
    s_and_b32 s100, s4, 3
    s_lshl_b32 s100, s100, 2
    s_and_b32 s9, s4, 4
    s_lshl_b32 s9, s9, 1
    s_add_u32 s100, s100, s9
    s_and_b32 s100, s100, 15
    s_cmp_lt_u32 s3, 4
    s_cbranch_scc1 Y_G
    s_setprio 2
    s_sub_u32 s8, s3, 4
    s_lshl_b32 s10, s6, 7
    s_lshr_b32 s11, s8, 1
    s_and_b32 s9, s8, 1
    s_lshl_b32 s12, s11, 6
    s_add_u32 s10, s10, s12
    s_lshl_b32 s12, s9, 3
    s_add_u32 s10, s10, s12
    v_and_b32 v24, 32, v2
    v_bfe_u32 v25, v2, 3, 1
    v_lshl_add_u32 v24, v25, 4, v24
    v_bfe_u32 v25, v2, 4, 1
    v_add_u32 v24, v24, v25
    v_add_u32 v24, s10, v24
    v_lshlrev_b32 v24, 11, v24
    v_lshrrev_b32 v25, 4, v2
    v_xor_b32 v25, v25, v2
    v_and_b32 v25, 7, v25
    v_lshl_add_u32 v4, v25, 4, v24
    v_xor_b32 v5, 64, v4
    v_add_u32 v5, 3072, v5
    v_add_u32 v6, 6144, v4
    v_add_u32 v7, 6144, v5
    s_lshl_b32 s10, s7, 6
    v_lshrrev_b32 v24, 3, v2
    s_lshl_b32 s12, s11, 5
    s_add_u32 s10, s10, s12
    v_add_u32 v24, s10, v24
    v_lshlrev_b32 v24, 11, v24
    v_lshrrev_b32 v25, 4, v2
    v_xor_b32 v25, v25, v2
    v_and_b32 v25, 7, v25
    v_lshl_add_u32 v8, v25, 4, v24
    v_xor_b32 v9, 64, v8
    v_add_u32 v9, 15360, v9
    v_add_u32 v10, 30720, v8
    v_add_u32 v11, 30720, v9
    s_lshl_b32 s13, s101, 7
    s_lshl_b32 s101, s100, 7
    s_lshl_b32 s14, s8, 12
    v_mov_b32 v19, 0
    s_lshl_b32 s10, s3, 2
    s_add_u32 s10, s10, 163776
    v_mov_b32 v22, s10
    v_mov_b32 v21, 163776
    s_cmp_ge_u32 s8, 4
    s_cselect_b32 s10, 1000, 0
    v_mov_b32 v25, s10
    ds_write_b32 v22, v25
    ds_write_b32 v22, v19 offset:24
    s_waitcnt lgkmcnt(0)
    s_barrier
    s_mov_b32 s52, s28
    s_mov_b32 s53, s29
    s_mov_b32 s54, 4194304
    s_mov_b32 s55, 0x00020000
    s_cmp_eq_u32 s9, 1
    s_cselect_b32 s56, s36, s34
    s_cselect_b32 s57, s37, s35
    s_mov_b32 s58, 2097152
    s_mov_b32 s59, 0x00020000
    s_add_u32 m0, s14, 0
    s_nop 0
    buffer_load_dwordx4 v4, s[52:55], s13 offen offset:0 lds
    buffer_load_dwordx4 v5, s[52:55], s13 offen offset:1024 lds
    buffer_load_dwordx4 v6, s[52:55], s13 offen offset:2048 lds
    buffer_load_dwordx4 v7, s[52:55], s13 offen offset:3072 lds
    s_add_u32 m0, s14, 16384
    s_nop 0
    buffer_load_dwordx4 v8, s[56:59], s13 offen offset:0 lds
    buffer_load_dwordx4 v9, s[56:59], s13 offen offset:1024 lds
    buffer_load_dwordx4 v10, s[56:59], s13 offen offset:2048 lds
    buffer_load_dwordx4 v11, s[56:59], s13 offen offset:3072 lds
    s_add_u32 s13, s13, 128
    s_and_b32 s13, s13, 2047
    s_add_u32 s14, s14, 32768
    s_and_b32 s14, s14, 131071
L_ns0:
    s_add_u32 s72, s50, 17825792
    s_addc_u32 s73, s51, 0
    s_mov_b32 s74, 24576
    s_mov_b32 s75, 0x00020000
    s_mov_b32 s76, s48
    s_mov_b32 s77, s49
    s_mov_b32 s78, 256
    s_mov_b32 s79, 0x00020000
    s_lshl_b32 s100, s4, 7
    s_lshl_b32 s10, s5, 2
    s_add_u32 s100, s100, s10
    s_add_u32 s100, s100, s8
    s_lshl_b32 s10, s100, 12
    s_load_dword s30, s[24:25], s10
    s_lshr_b32 s10, s100, 1
    s_lshl_b32 s10, s10, 2
    s_load_dword s31, s[26:27], s10
    s_mov_b32 s37, s101
    s_mul_i32 s101, s8, 12928
    s_add_u32 s101, s101, 98304
    s_mov_b32 s68, s24
    s_mov_b32 s69, s25
    s_mov_b32 s70, 4194304
    s_mov_b32 s71, 0x00020000
    s_mov_b32 s64, s46
    s_mov_b32 s65, s47
    s_mov_b32 s66, 16777216
    s_mov_b32 s67, 0x00020000
    s_movk_i32 s32, 4096
    s_movk_i32 s33, 8192
    s_movk_i32 s34, 12288
    s_lshl_b32 s10, s5, 6
    v_and_b32 v23, 56, v2
    v_add_u32 v23, s10, v23
    s_lshl_b32 s10, s4, 7
    s_lshl_b32 s12, s8, 5
    s_add_u32 s35, s10, s12
    v_and_b32 v25, 7, v2
    v_lshl_add_u32 v24, v25, 2, s35
    v_lshlrev_b32 v25, 1, v24
    v_lshl_add_u32 v16, v23, 11, v25
    v_lshlrev_b32 v26, 4, v2
    s_lshl_b32 s36, s100, 12
    v_add_u32 v27, s36, v26
    v_add_u32 v17, 2, v27
    s_add_u32 s10, s101, 32
    v_add_u32 v35, s10, v26
    v_add_u32 v60, 12416, v26
    v_and_b32 v61, 16, v26
    v_and_b32 v62, 32, v26
    v_mul_u32_u24 v62, 130, v62
    v_add_u32 v61, v61, v62
    v_cmp_gt_u32 vcc, 32, v2
    s_nop 1
    v_cndmask_b32 v60, v61, v60, vcc
    v_add_u32 v18, s101, v60
    v_mov_b32 v56, 0
    v_mov_b32 v57, 0
    v_mov_b32 v58, 0
    s_waitcnt lgkmcnt(0)
    s_lshl_b32 s30, s30, 16
    v_mov_b32 v61, s30
    v_and_b32 v62, 35, v2
    v_cmp_eq_u32 vcc, 35, v62
    s_nop 1
    v_cndmask_b32 v59, 0, v61, vcc
    s_lshl_b32 s10, s4, 2
    s_lshr_b32 s12, s5, 3
    s_add_u32 s10, s10, s12
    s_lshl_b32 s10, s10, 8
    v_and_b32 v60, 31, v2
    v_lshl_add_u32 v20, v60, 3, s10
    s_lshl_b32 s10, s4, 10
    s_add_u32 s10, s10, 8192
    v_add_u32 v3, s10, v26
    v_and_b32 v64, 15, v2
    v_lshrrev_b32 v65, 4, v2
    v_lshlrev_b32 v60, 1, v64
    v_lshlrev_b32 v61, 4, v65
    v_sub_u32 v60, v60, v61
    v_and_b32 v62, 1, v64
    v_mov_b32 v63, 4208
    v_cmp_eq_u32 vcc, 1, v62
    s_nop 1
    v_cndmask_b32 v63, v63, 50, vcc
    v_add3_u32 v28, v60, v63, s101
    v_add_u32 v29, 1024, v28
    v_add_u32 v30, 2048, v28
    v_add_u32 v31, 3072, v28
    v_lshl_add_u32 v60, v64, 5, v61
    s_add_u32 s10, s101, 8848
    v_sub_u32 v32, s10, v60
    s_add_u32 s10, s101, 8320
    v_add_u32 v33, s10, v26
    s_bitcmp1_b32 s100, 0
    s_cselect_b32 s10, 16, 0
    s_lshr_b32 s31, s31, s10
    s_and_b32 s31, s31, 0xffff
    v_lshlrev_b32 v60, 3, v65
    v_sub_u32 v60, v60, v64
    v_add_u32 v60, -9, v60
    v_and_b32 v61, 1, v60
    v_lshlrev_b32 v61, 4, v61
    v_lshlrev_b32 v61, v61, s31
    v_ashrrev_i32 v60, 1, v60
    v_cmp_eq_u32 vcc, 0, v60
    s_nop 1
    v_cndmask_b32 v36, 0, v61, vcc
    v_cmp_eq_u32 vcc, 1, v60
    s_nop 1
    v_cndmask_b32 v37, 0, v61, vcc
    v_cmp_eq_u32 vcc, 2, v60
    s_nop 1
    v_cndmask_b32 v38, 0, v61, vcc
    v_cmp_eq_u32 vcc, 3, v60
    s_nop 1
    v_cndmask_b32 v39, 0, v61, vcc
    v_and_b32 v60, 1, v65
    v_lshlrev_b32 v60, 9, v60
    v_lshl_add_u32 v60, v64, 5, v60
    v_lshrrev_b32 v61, 1, v65
    v_lshl_add_u32 v34, v61, 4, v60
    s_mov_b32 s29, 1
    v_mov_b32 v60, 0
L_loop:
    s_sub_i32 s28, s29, 3
    s_max_i32 s28, s28, 0
    s_waitcnt lgkmcnt(0)
    v_min3_u32 v60, v60, v61, v62
    v_min_u32 v60, v60, v63
    v_mov_b32 v25, s29
    v_cmp_gt_u32 vcc, s28, v60
    s_cbranch_vccz L_free
    s_mov_b32 s15, 0
L_slot_w:
    ds_read_b128 v[60:63], v21 offset:0
    s_waitcnt lgkmcnt(0)
    v_min3_u32 v60, v60, v61, v62
    v_min_u32 v60, v60, v63
    v_cmp_gt_u32 vcc, s28, v60
    s_cbranch_vccz L_slot_ok
    s_sleep 1
    s_add_u32 s15, s15, 1
    s_cmp_lt_u32 s15, 160000
    s_cbranch_scc1 L_slot_w
L_slot_ok:
L_free:
    s_lshl_b32 s10, s8, 4
    s_add_u32 s10, s10, s29
    s_cmp_eq_u32 s10, 2
    s_cbranch_scc0 L_nn1
    buffer_load_dwordx2 v[0:1], v19, s[76:79], 0 offen sc1
L_nn1:
    s_cmp_eq_u32 s10, 3
    s_cbranch_scc0 L_nn2
    s_waitcnt vmcnt(8)
    s_mov_b32 s12, 0
L_np:
    v_cmp_eq_u32 vcc, 0, v0
    s_cbranch_vccz L_nok
    buffer_load_dwordx2 v[0:1], v19, s[76:79], 0 offen sc1
    s_add_u32 s12, s12, 1
    s_waitcnt vmcnt(0)
    s_cmp_lt_u32 s12, 20000
    s_cbranch_scc1 L_np
L_nok:
    ds_write_b64 v21, v[0:1] offset:32
L_nn2:
    s_cmp_eq_u32 s10, 14
    s_cbranch_scc0 L_nf
    buffer_load_dwordx2 v[66:67], v20, s[72:75], 0 offen sc1
L_nf:
    s_cmp_ge_u32 s29, 8
    s_cbranch_scc1 L_sh
    s_add_u32 m0, s14, 0
    s_waitcnt vmcnt(7)
    buffer_load_dwordx4 v4, s[52:55], s13 offen offset:0 lds
    s_waitcnt vmcnt(7)
    buffer_load_dwordx4 v5, s[52:55], s13 offen offset:1024 lds
    s_waitcnt vmcnt(7)
    buffer_load_dwordx4 v6, s[52:55], s13 offen offset:2048 lds
    s_waitcnt vmcnt(7)
    buffer_load_dwordx4 v7, s[52:55], s13 offen offset:3072 lds
    s_add_u32 m0, s14, 16384
    s_waitcnt vmcnt(7)
    buffer_load_dwordx4 v8, s[56:59], s13 offen offset:0 lds
    s_waitcnt vmcnt(7)
    buffer_load_dwordx4 v9, s[56:59], s13 offen offset:1024 lds
    ds_read_b128 v[60:63], v21
    s_waitcnt vmcnt(7)
    buffer_load_dwordx4 v10, s[56:59], s13 offen offset:2048 lds
    s_waitcnt vmcnt(7)
    ds_write_b32 v22, v25
    buffer_load_dwordx4 v11, s[56:59], s13 offen offset:3072 lds
    s_add_u32 s13, s13, 128
    s_and_b32 s13, s13, 2047
    s_add_u32 s14, s14, 32768
    s_and_b32 s14, s14, 131071
    s_add_u32 s29, s29, 1
    s_branch L_loop
L_sh:
    s_add_u32 m0, s14, 0
    s_waitcnt vmcnt(3)
    buffer_load_dwordx4 v4, s[52:55], s13 offen offset:0 lds
    s_waitcnt vmcnt(3)
    buffer_load_dwordx4 v5, s[52:55], s13 offen offset:1024 lds
    s_waitcnt vmcnt(3)
    buffer_load_dwordx4 v6, s[52:55], s13 offen offset:2048 lds
    s_waitcnt vmcnt(3)
    ds_write_b32 v22, v25
    buffer_load_dwordx4 v7, s[52:55], s13 offen offset:3072 lds
    s_add_u32 m0, s14, 16384
    s_waitcnt vmcnt(3)
    buffer_load_dwordx4 v8, s[56:59], s13 offen offset:0 lds
    s_waitcnt vmcnt(3)
    buffer_load_dwordx4 v9, s[56:59], s13 offen offset:1024 lds
    ds_read_b128 v[60:63], v21
    s_waitcnt vmcnt(3)
    buffer_load_dwordx4 v10, s[56:59], s13 offen offset:2048 lds
    s_waitcnt vmcnt(3)
    buffer_load_dwordx4 v11, s[56:59], s13 offen offset:3072 lds
    s_add_u32 s13, s13, 128
    s_and_b32 s13, s13, 2047
    s_add_u32 s14, s14, 32768
    s_and_b32 s14, s14, 131071
    s_add_u32 s29, s29, 1
    s_cmp_lt_u32 s29, 16
    s_cbranch_scc1 L_loop
    ds_read_b64 v[0:1], v21 offset:32
    v_mov_b32 v25, 16
    s_cmp_eq_u32 s8, 0
    s_cbranch_scc0 L_nf2
    s_waitcnt vmcnt(8)
    v_cmp_ne_u64 vcc, v[66:67], v[0:1]
    s_mov_b32 s12, 0
    s_cbranch_vccnz L_nf3
    ds_write_b32 v21, v25 offset:44
L_nf2:
    s_mov_b32 s12, 1
L_nf3:
    buffer_load_dwordx4 v[64:67], v27, s[68:71], 0 offen offset:0 nt
    buffer_load_dwordx4 v[68:71], v27, s[68:71], 0 offen offset:1024 nt
    buffer_load_dwordx4 v[72:75], v27, s[68:71], 0 offen offset:2048 nt
    buffer_load_dwordx4 v[76:79], v27, s[68:71], 0 offen offset:3072 nt
    buffer_load_dwordx4 v[80:83], v17, s[68:71], 0 offen offset:0 nt
    buffer_load_dwordx4 v[84:87], v17, s[68:71], 0 offen offset:1024 nt
    buffer_load_dwordx4 v[88:91], v17, s[68:71], 0 offen offset:2048 nt
    buffer_load_dwordx4 v[92:95], v17, s[68:71], 0 offen offset:3072 nt
    s_waitcnt vmcnt(8)
    ds_write_b32 v22, v25
    s_mov_b32 s15, 0
    s_cmp_eq_u32 s12, 1
    s_cbranch_scc1 L_nf4
    s_mov_b32 s15, 0
LK_poll:
    buffer_load_dwordx2 v[60:61], v20, s[72:75], 0 offen sc1
    s_waitcnt vmcnt(0)
    v_cmp_ne_u64 vcc, v[60:61], v[0:1]
    s_cbranch_vccz LK_ok
    s_add_u32 s15, s15, 1
    s_cmp_lt_u32 s15, 20000
    s_cbranch_scc1 LK_poll
LK_ok:
    ds_write_b32 v21, v25 offset:44
    s_add_u32 s15, s15, 1
L_nf4:
L_t2:
    s_mov_b32 s52, s50
    s_mov_b32 s53, s51
    s_mov_b32 s54, 4194304
    s_mov_b32 s55, 0x00020000
    s_add_u32 s56, s50, 4194304
    s_addc_u32 s57, s51, 0
    s_mov_b32 s58, 4194304
    s_mov_b32 s59, 0x00020000
    s_mov_b32 s60, s16
    s_mov_b32 s61, s17
    s_mov_b32 s62, 4194304
    s_mov_b32 s63, 0x00020000
    s_mov_b32 s15, 0
L_fk_w:
    ds_read_b32 v60, v21 offset:44
    s_waitcnt lgkmcnt(0)
    v_cmp_gt_u32 vcc, 1, v60
    s_cbranch_vccz L_fk_ok
    s_sleep 1
    s_add_u32 s15, s15, 1
    s_cmp_lt_u32 s15, 160000
    s_cbranch_scc1 L_fk_w
L_fk_ok:
    buffer_load_dwordx4 v[40:43], v26, s[52:55], s36 offen offset:0 sc1
    buffer_load_dwordx4 v[44:47], v26, s[52:55], s36 offen offset:1024 sc1
    buffer_load_dwordx4 v[48:51], v26, s[52:55], s36 offen offset:2048 sc1
    buffer_load_dwordx4 v[52:55], v26, s[52:55], s36 offen offset:3072 sc1
    s_mov_b32 s15, 0
L_c2_w:
    ds_read_b128 v[60:63], v21 offset:0
    s_waitcnt lgkmcnt(0)
    v_min3_u32 v60, v60, v61, v62
    v_min_u32 v60, v60, v63
    v_cmp_gt_u32 vcc, 16, v60
    s_cbranch_vccz L_c2_ok
    s_sleep 1
    s_add_u32 s15, s15, 1
    s_cmp_lt_u32 s15, 160000
    s_cbranch_scc1 L_c2_w
L_c2_ok:
    s_setprio 0
    ds_write_b128 v18, v[56:59]
    s_waitcnt vmcnt(11)
    ds_write_b128 v35, v[64:67] offset:0
    s_waitcnt vmcnt(10)
    ds_write_b128 v35, v[68:71] offset:1024
    s_waitcnt vmcnt(9)
    ds_write_b128 v35, v[72:75] offset:2048
    s_waitcnt vmcnt(8)
    ds_write_b128 v35, v[76:79] offset:3072
    s_waitcnt vmcnt(7)
    ds_write_b128 v35, v[80:83] offset:4160
    s_waitcnt vmcnt(6)
    ds_write_b128 v35, v[84:87] offset:5184
    s_waitcnt vmcnt(5)
    ds_write_b128 v35, v[88:91] offset:6208
    s_waitcnt vmcnt(4)
    ds_write_b128 v35, v[92:95] offset:7232
    ds_read2_b32 v[128:129], v28 offset0:0 offset1:1
    ds_read2_b32 v[130:131], v28 offset0:2 offset1:3
    ds_read2_b32 v[132:133], v28 offset0:128 offset1:129
    ds_read2_b32 v[134:135], v28 offset0:130 offset1:131
    ds_read2_b32 v[136:137], v29 offset0:0 offset1:1
    ds_read2_b32 v[138:139], v29 offset0:2 offset1:3
    ds_read2_b32 v[140:141], v29 offset0:128 offset1:129
    ds_read2_b32 v[142:143], v29 offset0:130 offset1:131
    ds_read2_b32 v[144:145], v30 offset0:0 offset1:1
    ds_read2_b32 v[146:147], v30 offset0:2 offset1:3
    ds_read2_b32 v[148:149], v30 offset0:128 offset1:129
    ds_read2_b32 v[150:151], v30 offset0:130 offset1:131
    ds_read2_b32 v[152:153], v31 offset0:0 offset1:1
    ds_read2_b32 v[154:155], v31 offset0:2 offset1:3
    ds_read2_b32 v[156:157], v31 offset0:128 offset1:129
    ds_read2_b32 v[158:159], v31 offset0:130 offset1:131
    s_waitcnt vmcnt(3)
    ds_write_b128 v33, v[40:43] offset:0
    s_waitcnt vmcnt(2)
    ds_write_b128 v33, v[44:47] offset:1024
    s_waitcnt vmcnt(1)
    ds_write_b128 v33, v[48:51] offset:2048
    s_waitcnt vmcnt(0)
    ds_write_b128 v33, v[52:55] offset:3072
    ds_read_b128 v[160:163], v32 offset:3584
    ds_read_b128 v[164:167], v32 offset:3072
    ds_read_b128 v[168:171], v32 offset:2560
    ds_read_b128 v[172:175], v32 offset:2048
    ds_read_b128 v[176:179], v32 offset:1536
    ds_read_b128 v[180:183], v32 offset:1024
    ds_read_b128 v[184:187], v32 offset:512
    ds_read_b128 v[188:191], v32 offset:0
    s_setprio 0
    s_mov_b32 s15, 0
    s_waitcnt lgkmcnt(0)
    buffer_load_dwordx2 v[80:81], v16, s[60:63], 0 offen offset:0 nt
    buffer_load_dwordx2 v[82:83], v16, s[60:63], 0 offen offset:2048 nt
    buffer_load_dwordx2 v[84:85], v16, s[60:63], s32 offen offset:0 nt
    buffer_load_dwordx2 v[86:87], v16, s[60:63], s32 offen offset:2048 nt
    buffer_load_dwordx2 v[88:89], v16, s[60:63], s33 offen offset:0 nt
    buffer_load_dwordx2 v[90:91], v16, s[60:63], s33 offen offset:2048 nt
    buffer_load_dwordx2 v[92:93], v16, s[60:63], s34 offen offset:0 nt
    buffer_load_dwordx2 v[94:95], v16, s[60:63], s34 offen offset:2048 nt
    v_mfma_f32_16x16x32_bf16 v[96:99], v[36:39], v[160:163], 0
    v_mfma_f32_16x16x32_bf16 v[100:103], v[36:39], v[164:167], 0
    v_mfma_f32_16x16x32_bf16 v[104:107], v[36:39], v[168:171], 0
    v_mfma_f32_16x16x32_bf16 v[108:111], v[36:39], v[172:175], 0
    v_mfma_f32_16x16x32_bf16 v[112:115], v[36:39], v[176:179], 0
    v_mfma_f32_16x16x32_bf16 v[116:119], v[36:39], v[180:183], 0
    v_mfma_f32_16x16x32_bf16 v[120:123], v[36:39], v[184:187], 0
    v_mfma_f32_16x16x32_bf16 v[124:127], v[36:39], v[188:191], 0
L_conv:
    v_mfma_f32_16x16x32_bf16 v[96:99], v[128:131], v[160:163], v[96:99]
    ds_read2_b32 v[192:193], v28 offset0:16 offset1:17
    v_mfma_f32_16x16x32_bf16 v[100:103], v[128:131], v[164:167], v[100:103]
    ds_read2_b32 v[194:195], v28 offset0:18 offset1:19
    v_mfma_f32_16x16x32_bf16 v[104:107], v[128:131], v[168:171], v[104:107]
    ds_read_b128 v[224:227], v32 offset:3648
    v_mfma_f32_16x16x32_bf16 v[108:111], v[128:131], v[172:175], v[108:111]
    ds_read2_b32 v[196:197], v28 offset0:144 offset1:145
    v_mfma_f32_16x16x32_bf16 v[112:115], v[128:131], v[176:179], v[112:115]
    ds_read2_b32 v[198:199], v28 offset0:146 offset1:147
    v_mfma_f32_16x16x32_bf16 v[116:119], v[128:131], v[180:183], v[116:119]
    ds_read_b128 v[228:231], v32 offset:3136
    v_mfma_f32_16x16x32_bf16 v[120:123], v[128:131], v[184:187], v[120:123]
    ds_read2_b32 v[200:201], v29 offset0:16 offset1:17
    v_mfma_f32_16x16x32_bf16 v[124:127], v[128:131], v[188:191], v[124:127]
    ds_read2_b32 v[202:203], v29 offset0:18 offset1:19
    v_mfma_f32_16x16x32_bf16 v[100:103], v[132:135], v[160:163], v[100:103]
    ds_read_b128 v[232:235], v32 offset:2624
    v_mfma_f32_16x16x32_bf16 v[104:107], v[132:135], v[164:167], v[104:107]
    ds_read2_b32 v[204:205], v29 offset0:144 offset1:145
    v_mfma_f32_16x16x32_bf16 v[108:111], v[132:135], v[168:171], v[108:111]
    ds_read2_b32 v[206:207], v29 offset0:146 offset1:147
    v_mfma_f32_16x16x32_bf16 v[112:115], v[132:135], v[172:175], v[112:115]
    ds_read_b128 v[236:239], v32 offset:2112
    v_mfma_f32_16x16x32_bf16 v[116:119], v[132:135], v[176:179], v[116:119]
    ds_read2_b32 v[208:209], v30 offset0:16 offset1:17
    v_mfma_f32_16x16x32_bf16 v[120:123], v[132:135], v[180:183], v[120:123]
    ds_read2_b32 v[210:211], v30 offset0:18 offset1:19
    v_mfma_f32_16x16x32_bf16 v[124:127], v[132:135], v[184:187], v[124:127]
    ds_read_b128 v[240:243], v32 offset:1600
    v_mfma_f32_16x16x32_bf16 v[104:107], v[136:139], v[160:163], v[104:107]
    ds_read2_b32 v[212:213], v30 offset0:144 offset1:145
    v_mfma_f32_16x16x32_bf16 v[108:111], v[136:139], v[164:167], v[108:111]
    ds_read2_b32 v[214:215], v30 offset0:146 offset1:147
    v_mfma_f32_16x16x32_bf16 v[112:115], v[136:139], v[168:171], v[112:115]
    ds_read_b128 v[244:247], v32 offset:1088
    v_mfma_f32_16x16x32_bf16 v[116:119], v[136:139], v[172:175], v[116:119]
    ds_read2_b32 v[216:217], v31 offset0:16 offset1:17
    v_mfma_f32_16x16x32_bf16 v[120:123], v[136:139], v[176:179], v[120:123]
    ds_read2_b32 v[218:219], v31 offset0:18 offset1:19
    v_mfma_f32_16x16x32_bf16 v[124:127], v[136:139], v[180:183], v[124:127]
    ds_read_b128 v[248:251], v32 offset:576
    v_mfma_f32_16x16x32_bf16 v[108:111], v[140:143], v[160:163], v[108:111]
    ds_read2_b32 v[220:221], v31 offset0:144 offset1:145
    v_mfma_f32_16x16x32_bf16 v[112:115], v[140:143], v[164:167], v[112:115]
    ds_read2_b32 v[222:223], v31 offset0:146 offset1:147
    v_mfma_f32_16x16x32_bf16 v[116:119], v[140:143], v[168:171], v[116:119]
    ds_read_b128 v[252:255], v32 offset:64
    v_mfma_f32_16x16x32_bf16 v[120:123], v[140:143], v[172:175], v[120:123]
    v_mfma_f32_16x16x32_bf16 v[124:127], v[140:143], v[176:179], v[124:127]
    v_mfma_f32_16x16x32_bf16 v[112:115], v[144:147], v[160:163], v[112:115]
    v_mfma_f32_16x16x32_bf16 v[116:119], v[144:147], v[164:167], v[116:119]
    v_mfma_f32_16x16x32_bf16 v[120:123], v[144:147], v[168:171], v[120:123]
    v_mfma_f32_16x16x32_bf16 v[124:127], v[144:147], v[172:175], v[124:127]
    v_mfma_f32_16x16x32_bf16 v[116:119], v[148:151], v[160:163], v[116:119]
    v_mfma_f32_16x16x32_bf16 v[120:123], v[148:151], v[164:167], v[120:123]
    v_mfma_f32_16x16x32_bf16 v[124:127], v[148:151], v[168:171], v[124:127]
    v_mfma_f32_16x16x32_bf16 v[120:123], v[152:155], v[160:163], v[120:123]
    v_mfma_f32_16x16x32_bf16 v[124:127], v[152:155], v[164:167], v[124:127]
    v_mfma_f32_16x16x32_bf16 v[124:127], v[156:159], v[160:163], v[124:127]
    s_waitcnt lgkmcnt(0)
    v_mfma_f32_16x16x32_bf16 v[96:99], v[192:195], v[224:227], v[96:99]
    ds_read2_b32 v[128:129], v28 offset0:32 offset1:33
    v_mfma_f32_16x16x32_bf16 v[100:103], v[192:195], v[228:231], v[100:103]
    ds_read2_b32 v[130:131], v28 offset0:34 offset1:35
    v_mfma_f32_16x16x32_bf16 v[104:107], v[192:195], v[232:235], v[104:107]
    ds_read_b128 v[160:163], v32 offset:3712
    v_mfma_f32_16x16x32_bf16 v[108:111], v[192:195], v[236:239], v[108:111]
    ds_read2_b32 v[132:133], v28 offset0:160 offset1:161
    v_mfma_f32_16x16x32_bf16 v[112:115], v[192:195], v[240:243], v[112:115]
    ds_read2_b32 v[134:135], v28 offset0:162 offset1:163
    v_mfma_f32_16x16x32_bf16 v[116:119], v[192:195], v[244:247], v[116:119]
    ds_read_b128 v[164:167], v32 offset:3200
    v_mfma_f32_16x16x32_bf16 v[120:123], v[192:195], v[248:251], v[120:123]
    ds_read2_b32 v[136:137], v29 offset0:32 offset1:33
    v_mfma_f32_16x16x32_bf16 v[124:127], v[192:195], v[252:255], v[124:127]
    ds_read2_b32 v[138:139], v29 offset0:34 offset1:35
    v_mfma_f32_16x16x32_bf16 v[100:103], v[196:199], v[224:227], v[100:103]
    ds_read_b128 v[168:171], v32 offset:2688
    v_mfma_f32_16x16x32_bf16 v[104:107], v[196:199], v[228:231], v[104:107]
    ds_read2_b32 v[140:141], v29 offset0:160 offset1:161
    v_mfma_f32_16x16x32_bf16 v[108:111], v[196:199], v[232:235], v[108:111]
    ds_read2_b32 v[142:143], v29 offset0:162 offset1:163
    v_mfma_f32_16x16x32_bf16 v[112:115], v[196:199], v[236:239], v[112:115]
    ds_read_b128 v[172:175], v32 offset:2176
    v_mfma_f32_16x16x32_bf16 v[116:119], v[196:199], v[240:243], v[116:119]
    ds_read2_b32 v[144:145], v30 offset0:32 offset1:33
    v_mfma_f32_16x16x32_bf16 v[120:123], v[196:199], v[244:247], v[120:123]
    ds_read2_b32 v[146:147], v30 offset0:34 offset1:35
    v_mfma_f32_16x16x32_bf16 v[124:127], v[196:199], v[248:251], v[124:127]
    ds_read_b128 v[176:179], v32 offset:1664
    v_mfma_f32_16x16x32_bf16 v[104:107], v[200:203], v[224:227], v[104:107]
    ds_read2_b32 v[148:149], v30 offset0:160 offset1:161
    v_mfma_f32_16x16x32_bf16 v[108:111], v[200:203], v[228:231], v[108:111]
    ds_read2_b32 v[150:151], v30 offset0:162 offset1:163
    v_mfma_f32_16x16x32_bf16 v[112:115], v[200:203], v[232:235], v[112:115]
    ds_read_b128 v[180:183], v32 offset:1152
    v_mfma_f32_16x16x32_bf16 v[116:119], v[200:203], v[236:239], v[116:119]
    ds_read2_b32 v[152:153], v31 offset0:32 offset1:33
    v_mfma_f32_16x16x32_bf16 v[120:123], v[200:203], v[240:243], v[120:123]
    ds_read2_b32 v[154:155], v31 offset0:34 offset1:35
    v_mfma_f32_16x16x32_bf16 v[124:127], v[200:203], v[244:247], v[124:127]
    ds_read_b128 v[184:187], v32 offset:640
    v_mfma_f32_16x16x32_bf16 v[108:111], v[204:207], v[224:227], v[108:111]
    ds_read2_b32 v[156:157], v31 offset0:160 offset1:161
    v_mfma_f32_16x16x32_bf16 v[112:115], v[204:207], v[228:231], v[112:115]
    ds_read2_b32 v[158:159], v31 offset0:162 offset1:163
    v_mfma_f32_16x16x32_bf16 v[116:119], v[204:207], v[232:235], v[116:119]
    ds_read_b128 v[188:191], v32 offset:128
    v_mfma_f32_16x16x32_bf16 v[120:123], v[204:207], v[236:239], v[120:123]
    v_mfma_f32_16x16x32_bf16 v[124:127], v[204:207], v[240:243], v[124:127]
    v_mfma_f32_16x16x32_bf16 v[112:115], v[208:211], v[224:227], v[112:115]
    v_add_u32 v28, 128, v28
    v_mfma_f32_16x16x32_bf16 v[116:119], v[208:211], v[228:231], v[116:119]
    v_add_u32 v29, 128, v29
    v_mfma_f32_16x16x32_bf16 v[120:123], v[208:211], v[232:235], v[120:123]
    v_add_u32 v30, 128, v30
    v_mfma_f32_16x16x32_bf16 v[124:127], v[208:211], v[236:239], v[124:127]
    v_add_u32 v31, 128, v31
    v_mfma_f32_16x16x32_bf16 v[116:119], v[212:215], v[224:227], v[116:119]
    v_add_u32 v32, 128, v32
    v_mfma_f32_16x16x32_bf16 v[120:123], v[212:215], v[228:231], v[120:123]
    v_mfma_f32_16x16x32_bf16 v[124:127], v[212:215], v[232:235], v[124:127]
    v_mfma_f32_16x16x32_bf16 v[120:123], v[216:219], v[224:227], v[120:123]
    v_mfma_f32_16x16x32_bf16 v[124:127], v[216:219], v[228:231], v[124:127]
    v_mfma_f32_16x16x32_bf16 v[124:127], v[220:223], v[224:227], v[124:127]
    s_waitcnt lgkmcnt(0)
    s_add_u32 s15, s15, 1
    s_cmp_lt_u32 s15, 4
    s_cbranch_scc1 L_conv
    s_setprio 3
    v_cvt_pk_bf16_f32 v64, v96, v97
    v_cvt_pk_bf16_f32 v65, v98, v99
    v_cvt_pk_bf16_f32 v66, v100, v101
    v_cvt_pk_bf16_f32 v67, v102, v103
    v_cvt_pk_bf16_f32 v68, v104, v105
    v_cvt_pk_bf16_f32 v69, v106, v107
    v_cvt_pk_bf16_f32 v70, v108, v109
    v_cvt_pk_bf16_f32 v71, v110, v111
    v_cvt_pk_bf16_f32 v72, v112, v113
    v_cvt_pk_bf16_f32 v73, v114, v115
    v_cvt_pk_bf16_f32 v74, v116, v117
    v_cvt_pk_bf16_f32 v75, v118, v119
    v_cvt_pk_bf16_f32 v76, v120, v121
    v_cvt_pk_bf16_f32 v77, v122, v123
    v_cvt_pk_bf16_f32 v78, v124, v125
    v_cvt_pk_bf16_f32 v79, v126, v127
    v_permlane16_swap_b32 v64, v66
    v_permlane16_swap_b32 v65, v67
    buffer_store_dwordx4 v[64:67], v34, s[56:59], s36 offen offset:0 sc1
    v_permlane16_swap_b32 v68, v70
    v_permlane16_swap_b32 v69, v71
    buffer_store_dwordx4 v[68:71], v34, s[56:59], s36 offen offset:1024 sc1
    v_permlane16_swap_b32 v72, v74
    v_permlane16_swap_b32 v73, v75
    buffer_store_dwordx4 v[72:75], v34, s[56:59], s36 offen offset:2048 sc1
    v_permlane16_swap_b32 v76, v78
    v_permlane16_swap_b32 v77, v79
    buffer_store_dwordx4 v[76:79], v34, s[56:59], s36 offen offset:3072 sc1
    s_lshl_b32 s12, s100, 3
    s_add_u32 s12, s12, 8192
    v_lshlrev_b32 v28, 1, v23
    v_lshl_add_u32 v28, v24, 12, v28
    v_lshlrev_b32 v29, 2, v24
    v_lshl_add_u32 v29, v23, 13, v29
    s_waitcnt vmcnt(0)
    s_mov_b64 exec, 1
    buffer_store_dwordx2 v[0:1], v19, s[72:75], s12 offen sc1
    s_mov_b64 exec, -1
    s_mov_b32 s15, 0
L_zw_w:
    ds_read_b128 v[60:63], v21 offset:0
    s_waitcnt lgkmcnt(0)
    v_min3_u32 v60, v60, v61, v62
    v_min_u32 v60, v60, v63
    v_cmp_gt_u32 vcc, 30, v60
    s_cbranch_vccz L_zw_ok
    s_sleep 4
    s_add_u32 s15, s15, 1
    s_cmp_lt_u32 s15, 160000
    s_cbranch_scc1 L_zw_w
L_zw_ok:
    s_cmp_eq_u32 s8, 0
    s_cbranch_scc0 L_z1
    s_mov_b32 s15, 0
LZ_poll:
    buffer_load_dwordx4 v[60:63], v3, s[72:75], 0 offen sc1
    s_waitcnt vmcnt(0)
    v_cmp_ne_u64 vcc, v[60:61], v[0:1]
    v_cmp_ne_u64 s[10:11], v[62:63], v[0:1]
    s_or_b64 vcc, vcc, s[10:11]
    s_cbranch_scc0 LZ_ok
    s_sleep 4
    s_add_u32 s15, s15, 1
    s_cmp_lt_u32 s15, 20000
    s_cbranch_scc1 LZ_poll
LZ_ok:
    ds_write_b32 v21, v25 offset:48
L_z1:
    s_waitcnt vmcnt(0)
    v_lshlrev_b32 v128, 16, v80
    v_and_b32 v129, 0xffff0000, v80
    v_lshlrev_b32 v130, 16, v81
    v_and_b32 v131, 0xffff0000, v81
    v_lshlrev_b32 v132, 16, v82
    v_and_b32 v133, 0xffff0000, v82
    v_lshlrev_b32 v134, 16, v83
    v_and_b32 v135, 0xffff0000, v83
    v_lshlrev_b32 v136, 16, v84
    v_and_b32 v137, 0xffff0000, v84
    v_lshlrev_b32 v138, 16, v85
    v_and_b32 v139, 0xffff0000, v85
    v_lshlrev_b32 v140, 16, v86
    v_and_b32 v141, 0xffff0000, v86
    v_lshlrev_b32 v142, 16, v87
    v_and_b32 v143, 0xffff0000, v87
    v_lshlrev_b32 v144, 16, v88
    v_and_b32 v145, 0xffff0000, v88
    v_lshlrev_b32 v146, 16, v89
    v_and_b32 v147, 0xffff0000, v89
    v_lshlrev_b32 v148, 16, v90
    v_and_b32 v149, 0xffff0000, v90
    v_lshlrev_b32 v150, 16, v91
    v_and_b32 v151, 0xffff0000, v91
    v_lshlrev_b32 v152, 16, v92
    v_and_b32 v153, 0xffff0000, v92
    v_lshlrev_b32 v154, 16, v93
    v_and_b32 v155, 0xffff0000, v93
    v_lshlrev_b32 v156, 16, v94
    v_and_b32 v157, 0xffff0000, v94
    v_lshlrev_b32 v158, 16, v95
    v_and_b32 v159, 0xffff0000, v95
    s_mov_b32 s15, 0
L_fz_w:
    ds_read_b32 v60, v21 offset:48
    s_waitcnt lgkmcnt(0)
    v_cmp_gt_u32 vcc, 1, v60
    s_cbranch_vccz L_fz_ok
    s_sleep 1
    s_add_u32 s15, s15, 1
    s_cmp_lt_u32 s15, 160000
    s_cbranch_scc1 L_fz_w
L_fz_ok:
    buffer_load_dwordx4 v[64:67], v28, s[56:59], 0 offen sc1
    buffer_load_dwordx4 v[68:71], v28, s[56:59], s32 offen sc1
    buffer_load_dwordx4 v[72:75], v28, s[56:59], s33 offen sc1
    buffer_load_dwordx4 v[76:79], v28, s[56:59], s34 offen sc1
    s_waitcnt vmcnt(0)
    v_lshlrev_b32 v160, 16, v64
    v_lshlrev_b32 v161, 16, v68
    v_lshlrev_b32 v162, 16, v72
    v_lshlrev_b32 v163, 16, v76
    v_mul_f32 v160, v160, v128
    v_mul_f32 v161, v161, v129
    v_mul_f32 v162, v162, v130
    v_mul_f32 v163, v163, v131
    s_mov_b32 s10, 0
    buffer_store_dwordx4 v[160:163], v29, s[64:67], s10 offen
    v_and_b32 v164, 0xffff0000, v64
    v_and_b32 v165, 0xffff0000, v68
    v_and_b32 v166, 0xffff0000, v72
    v_and_b32 v167, 0xffff0000, v76
    v_mul_f32 v164, v164, v132
    v_mul_f32 v165, v165, v133
    v_mul_f32 v166, v166, v134
    v_mul_f32 v167, v167, v135
    s_mov_b32 s10, 8192
    buffer_store_dwordx4 v[164:167], v29, s[64:67], s10 offen
    v_lshlrev_b32 v168, 16, v65
    v_lshlrev_b32 v169, 16, v69
    v_lshlrev_b32 v170, 16, v73
    v_lshlrev_b32 v171, 16, v77
    v_mul_f32 v168, v168, v136
    v_mul_f32 v169, v169, v137
    v_mul_f32 v170, v170, v138
    v_mul_f32 v171, v171, v139
    s_mov_b32 s10, 16384
    buffer_store_dwordx4 v[168:171], v29, s[64:67], s10 offen
    v_and_b32 v172, 0xffff0000, v65
    v_and_b32 v173, 0xffff0000, v69
    v_and_b32 v174, 0xffff0000, v73
    v_and_b32 v175, 0xffff0000, v77
    v_mul_f32 v172, v172, v140
    v_mul_f32 v173, v173, v141
    v_mul_f32 v174, v174, v142
    v_mul_f32 v175, v175, v143
    s_mov_b32 s10, 24576
    buffer_store_dwordx4 v[172:175], v29, s[64:67], s10 offen
    v_lshlrev_b32 v176, 16, v66
    v_lshlrev_b32 v177, 16, v70
    v_lshlrev_b32 v178, 16, v74
    v_lshlrev_b32 v179, 16, v78
    v_mul_f32 v176, v176, v144
    v_mul_f32 v177, v177, v145
    v_mul_f32 v178, v178, v146
    v_mul_f32 v179, v179, v147
    s_mov_b32 s10, 32768
    buffer_store_dwordx4 v[176:179], v29, s[64:67], s10 offen
    v_and_b32 v180, 0xffff0000, v66
    v_and_b32 v181, 0xffff0000, v70
    v_and_b32 v182, 0xffff0000, v74
    v_and_b32 v183, 0xffff0000, v78
    v_mul_f32 v180, v180, v148
    v_mul_f32 v181, v181, v149
    v_mul_f32 v182, v182, v150
    v_mul_f32 v183, v183, v151
    s_mov_b32 s10, 40960
    buffer_store_dwordx4 v[180:183], v29, s[64:67], s10 offen
    v_lshlrev_b32 v184, 16, v67
    v_lshlrev_b32 v185, 16, v71
    v_lshlrev_b32 v186, 16, v75
    v_lshlrev_b32 v187, 16, v79
    v_mul_f32 v184, v184, v152
    v_mul_f32 v185, v185, v153
    v_mul_f32 v186, v186, v154
    v_mul_f32 v187, v187, v155
    s_mov_b32 s10, 49152
    buffer_store_dwordx4 v[184:187], v29, s[64:67], s10 offen
    v_and_b32 v188, 0xffff0000, v67
    v_and_b32 v189, 0xffff0000, v71
    v_and_b32 v190, 0xffff0000, v75
    v_and_b32 v191, 0xffff0000, v79
    v_mul_f32 v188, v188, v156
    v_mul_f32 v189, v189, v157
    v_mul_f32 v190, v190, v158
    v_mul_f32 v191, v191, v159
    s_mov_b32 s10, 57344
    buffer_store_dwordx4 v[188:191], v29, s[64:67], s10 offen
    s_waitcnt vmcnt(0)
    s_endpgm
Y_G:
    s_setprio 3
    s_lshl_b32 s10, s5, 6
    v_and_b32 v56, 56, v2
    v_add_u32 v56, s10, v56
    s_lshl_b32 s10, s4, 7
    s_lshl_b32 s12, s3, 5
    s_add_u32 s10, s10, s12
    v_and_b32 v62, 7, v2
    v_lshl_add_u32 v57, v62, 2, s10
    v_lshlrev_b32 v62, 1, v57
    v_lshl_add_u32 v58, v56, 11, v62
    v_subrev_u32 v59, 6144, v58
    v_bfrev_b32 v62, 1
    v_cmp_eq_u32 vcc, 0, v56
    s_nop 1
    v_cndmask_b32 v59, v59, v62, vcc
    v_lshlrev_b32 v60, 3, v57
    s_movk_i32 s12, 4096
    s_movk_i32 s13, 8192
    s_movk_i32 s14, 12288
    v_and_b32 v3, 31, v2
    v_lshrrev_b32 v4, 5, v2
    s_lshr_b32 s8, s3, 1
    s_and_b32 s9, s3, 1
    s_lshl_b32 s10, s7, 6
    s_lshl_b32 s11, s9, 5
    s_add_u32 s10, s10, s11
    v_add_u32 v5, s10, v3
    v_lshlrev_b32 v48, 1, v5
    v_mov_b32 v23, 0
    s_lshl_b32 s10, s7, 7
    v_lshl_add_u32 v49, v3, 2, s10
    s_lshl_b32 s10, s3, 2
    s_add_u32 s10, s10, 163776
    v_mov_b32 v10, s10
    v_mov_b32 v11, 163776
    ds_write_b32 v10, v23
    s_waitcnt lgkmcnt(0)
    s_barrier
    s_mov_b32 s76, s48
    s_mov_b32 s77, s49
    s_mov_b32 s78, 256
    s_mov_b32 s79, 0x00020000
    s_or_b32 s10, s2, s3
    s_cmp_eq_u32 s10, 0
    s_cbranch_scc0 G_nononce
    s_memrealtime s[10:11]
    s_waitcnt lgkmcnt(0)
    s_or_b32 s10, s10, 1
    v_mov_b32 v54, s10
    v_mov_b32 v55, s11
    s_mov_b64 exec, 1
    buffer_store_dwordx2 v[54:55], v23, s[76:79], 0 offen sc1
    s_mov_b64 exec, -1
G_nononce:
    s_mov_b32 s72, s22
    s_mov_b32 s73, s23
    s_mov_b32 s74, 8192
    s_mov_b32 s75, 0x00020000
    s_mov_b32 s64, s18
    s_mov_b32 s65, s19
    s_mov_b32 s66, 4194304
    s_mov_b32 s67, 0x00020000
    s_mov_b32 s68, s20
    s_mov_b32 s69, s21
    s_mov_b32 s70, 4194304
    s_mov_b32 s71, 0x00020000
    buffer_load_dwordx4 v[144:147], v60, s[72:75], 0 offen
    buffer_load_dwordx4 v[148:151], v60, s[72:75], 0 offen offset:16
    buffer_load_dwordx2 v[158:159], v58, s[64:67], 0 offen offset:0 nt
    buffer_load_dwordx2 v[160:161], v58, s[64:67], 0 offen offset:2048 nt
    buffer_load_dwordx2 v[162:163], v58, s[64:67], s12 offen offset:0 nt
    buffer_load_dwordx2 v[164:165], v58, s[64:67], s12 offen offset:2048 nt
    buffer_load_dwordx2 v[166:167], v58, s[64:67], s13 offen offset:0 nt
    buffer_load_dwordx2 v[168:169], v58, s[64:67], s13 offen offset:2048 nt
    buffer_load_dwordx2 v[170:171], v58, s[64:67], s14 offen offset:0 nt
    buffer_load_dwordx2 v[172:173], v58, s[64:67], s14 offen offset:2048 nt
    buffer_load_dwordx2 v[152:153], v59, s[64:67], 0 offen offset:0 nt
    buffer_load_dwordx2 v[154:155], v59, s[64:67], 0 offen offset:2048 nt
    buffer_load_dwordx2 v[156:157], v59, s[64:67], s12 offen offset:0 nt
    buffer_load_dwordx2 v[128:129], v58, s[68:71], 0 offen offset:0 nt
    buffer_load_dwordx2 v[130:131], v58, s[68:71], 0 offen offset:2048 nt
    buffer_load_dwordx2 v[132:133], v58, s[68:71], s12 offen offset:0 nt
    buffer_load_dwordx2 v[134:135], v58, s[68:71], s12 offen offset:2048 nt
    buffer_load_dwordx2 v[136:137], v58, s[68:71], s13 offen offset:0 nt
    buffer_load_dwordx2 v[138:139], v58, s[68:71], s13 offen offset:2048 nt
    buffer_load_dwordx2 v[140:141], v58, s[68:71], s14 offen offset:0 nt
    buffer_load_dwordx2 v[142:143], v58, s[68:71], s14 offen offset:2048 nt
    s_mov_b32 s52, s42
    s_mov_b32 s53, s43
    s_mov_b32 s54, 2048
    s_mov_b32 s55, 0x00020000
    buffer_load_ushort v12, v48, s[52:55], 0 offen
    s_mov_b32 s52, s30
    s_mov_b32 s53, s31
    buffer_load_ushort v13, v48, s[52:55], 0 offen
    s_mov_b32 s52, s32
    s_mov_b32 s53, s33
    buffer_load_ushort v14, v48, s[52:55], 0 offen
    s_mov_b32 s52, s44
    s_mov_b32 s53, s45
    buffer_load_dword v24, v49, s[52:55], 0 offen
    s_mov_b32 s56, s50
    s_mov_b32 s57, s51
    s_mov_b32 s58, 4194304
    s_mov_b32 s59, 0x00020000
    s_lshl_b32 s16, s4, 2
    s_add_u32 s16, s16, s3
    s_lshl_b32 s16, s16, 5
    s_add_u32 s16, s16, s5
    s_lshl_b32 s16, s16, 3
    v_sub_u32 v61, 2040, v56
    v_lshlrev_b32 v61, 1, v61
    v_lshl_add_u32 v61, v57, 12, v61
    s_mov_b32 s52, s28
    s_mov_b32 s53, s29
    s_mov_b32 s54, 4194304
    s_mov_b32 s55, 0x00020000
    s_mov_b32 s60, s46
    s_mov_b32 s61, s47
    s_mov_b32 s62, 16777216
    s_mov_b32 s63, 0x00020000
    s_add_u32 s64, s50, 16777216
    s_addc_u32 s65, s51, 0
    s_mov_b32 s66, 540672
    s_mov_b32 s67, 0x00020000
    s_add_u32 s68, s50, 8388608
    s_addc_u32 s69, s51, 0
    s_mov_b32 s70, 8388608
    s_mov_b32 s71, 0x00020000
    s_add_u32 s72, s50, 17825792
    s_addc_u32 s73, s51, 0
    s_mov_b32 s74, 24576
    s_mov_b32 s75, 0x00020000
    s_cmp_eq_u32 s9, 1
    s_cselect_b32 s80, s40, s38
    s_cselect_b32 s81, s41, s39
    s_mov_b32 s82, 2097152
    s_mov_b32 s83, 0x00020000
    s_lshl_b32 s10, s6, 7
    s_lshl_b32 s11, s3, 5
    s_add_u32 s10, s10, s11
    v_lshl_add_u32 v50, v4, 2, s10
    v_lshl_add_u32 v22, v50, 11, v49
    v_xor_b32 v50, 1, v4
    v_lshlrev_b32 v50, 14, v50
    v_lshl_add_u32 v25, v5, 4, v50
    v_lshlrev_b32 v26, 4, v2
    v_add_u32 v27, 4096, v26
    v_lshrrev_b32 v50, 1, v3
    v_and_b32 v50, 7, v50
    v_xor_b32 v50, v50, v4
    v_lshlrev_b32 v50, 4, v50
    v_lshl_add_u32 v50, v3, 7, v50
    s_lshl_b32 s10, s8, 13
    s_lshl_b32 s11, s9, 13
    s_add_u32 s11, s11, 16384
    v_add_u32 v32, s10, v50
    v_add_u32 v36, s11, v50
    v_xor_b32 v33, 32, v32
    v_xor_b32 v37, 32, v36
    v_xor_b32 v34, 64, v32
    v_xor_b32 v38, 64, v36
    v_xor_b32 v35, 96, v32
    v_xor_b32 v39, 96, v36
    v_add_u32 v40, 65536, v32
    v_add_u32 v41, 65536, v33
    v_add_u32 v42, 65536, v34
    v_add_u32 v43, 65536, v35
    v_add_u32 v44, 65536, v36
    v_add_u32 v45, 65536, v37
    v_add_u32 v46, 65536, v38
    v_add_u32 v47, 65536, v39
    v_mov_b32 v64, 0
    v_mov_b32 v65, 0
    v_mov_b32 v66, 0
    v_mov_b32 v67, 0
    v_mov_b32 v68, 0
    v_mov_b32 v69, 0
    v_mov_b32 v70, 0
    v_mov_b32 v71, 0
    v_mov_b32 v72, 0
    v_mov_b32 v73, 0
    v_mov_b32 v74, 0
    v_mov_b32 v75, 0
    v_mov_b32 v76, 0
    v_mov_b32 v77, 0
    v_mov_b32 v78, 0
    v_mov_b32 v79, 0
    v_mov_b32 v80, 0
    v_mov_b32 v81, 0
    v_mov_b32 v82, 0
    v_mov_b32 v83, 0
    v_mov_b32 v84, 0
    v_mov_b32 v85, 0
    v_mov_b32 v86, 0
    v_mov_b32 v87, 0
    v_mov_b32 v88, 0
    v_mov_b32 v89, 0
    v_mov_b32 v90, 0
    v_mov_b32 v91, 0
    v_mov_b32 v92, 0
    v_mov_b32 v93, 0
    v_mov_b32 v94, 0
    v_mov_b32 v95, 0
    v_mov_b32 v96, 0
    v_mov_b32 v97, 0
    v_mov_b32 v98, 0
    v_mov_b32 v99, 0
    v_mov_b32 v100, 0
    v_mov_b32 v101, 0
    v_mov_b32 v102, 0
    v_mov_b32 v103, 0
    v_mov_b32 v104, 0
    v_mov_b32 v105, 0
    v_mov_b32 v106, 0
    v_mov_b32 v107, 0
    v_mov_b32 v108, 0
    v_mov_b32 v109, 0
    v_mov_b32 v110, 0
    v_mov_b32 v111, 0
    v_mov_b32 v112, 0
    v_mov_b32 v113, 0
    v_mov_b32 v114, 0
    v_mov_b32 v115, 0
    v_mov_b32 v116, 0
    v_mov_b32 v117, 0
    v_mov_b32 v118, 0
    v_mov_b32 v119, 0
    v_mov_b32 v120, 0
    v_mov_b32 v121, 0
    v_mov_b32 v122, 0
    v_mov_b32 v123, 0
    v_mov_b32 v124, 0
    v_mov_b32 v125, 0
    v_mov_b32 v126, 0
    v_mov_b32 v127, 0
    s_waitcnt vmcnt(23)
    v_lshlrev_b32 v176, 16, v144
    v_and_b32 v180, 0xffff0000, v144
    v_lshlrev_b32 v184, 16, v145
    v_and_b32 v188, 0xffff0000, v145
    v_lshlrev_b32 v177, 16, v146
    v_and_b32 v181, 0xffff0000, v146
    v_lshlrev_b32 v185, 16, v147
    v_and_b32 v189, 0xffff0000, v147
    v_lshlrev_b32 v178, 16, v148
    v_and_b32 v182, 0xffff0000, v148
    v_lshlrev_b32 v186, 16, v149
    v_and_b32 v190, 0xffff0000, v149
    v_lshlrev_b32 v179, 16, v150
    v_and_b32 v183, 0xffff0000, v150
    v_lshlrev_b32 v187, 16, v151
    v_and_b32 v191, 0xffff0000, v151
    s_waitcnt vmcnt(12)
    v_lshlrev_b32 v192, 16, v152
    v_and_b32 v193, 0xffff0000, v152
    v_lshlrev_b32 v194, 16, v153
    v_and_b32 v195, 0xffff0000, v153
    v_lshlrev_b32 v196, 16, v154
    v_and_b32 v197, 0xffff0000, v154
    v_lshlrev_b32 v198, 16, v155
    v_and_b32 v199, 0xffff0000, v155
    v_lshlrev_b32 v200, 16, v156
    v_and_b32 v201, 0xffff0000, v156
    v_lshlrev_b32 v202, 16, v157
    v_and_b32 v203, 0xffff0000, v157
    v_lshlrev_b32 v204, 16, v158
    v_and_b32 v205, 0xffff0000, v158
    v_lshlrev_b32 v206, 16, v159
    v_and_b32 v207, 0xffff0000, v159
    v_lshlrev_b32 v208, 16, v160
    v_and_b32 v209, 0xffff0000, v160
    v_lshlrev_b32 v210, 16, v161
    v_and_b32 v211, 0xffff0000, v161
    v_lshlrev_b32 v212, 16, v162
    v_and_b32 v213, 0xffff0000, v162
    v_lshlrev_b32 v214, 16, v163
    v_and_b32 v215, 0xffff0000, v163
    v_lshlrev_b32 v216, 16, v164
    v_and_b32 v217, 0xffff0000, v164
    v_lshlrev_b32 v218, 16, v165
    v_and_b32 v219, 0xffff0000, v165
    v_lshlrev_b32 v220, 16, v166
    v_and_b32 v221, 0xffff0000, v166
    v_lshlrev_b32 v222, 16, v167
    v_and_b32 v223, 0xffff0000, v167
    v_lshlrev_b32 v224, 16, v168
    v_and_b32 v225, 0xffff0000, v168
    v_lshlrev_b32 v226, 16, v169
    v_and_b32 v227, 0xffff0000, v169
    v_lshlrev_b32 v228, 16, v170
    v_and_b32 v229, 0xffff0000, v170
    v_lshlrev_b32 v230, 16, v171
    v_and_b32 v231, 0xffff0000, v171
    v_lshlrev_b32 v232, 16, v172
    v_and_b32 v233, 0xffff0000, v172
    v_lshlrev_b32 v234, 16, v173
    v_and_b32 v235, 0xffff0000, v173
    v_pk_mul_f32 v[144:145], v[204:205], v[176:177]
    v_pk_mul_f32 v[146:147], v[206:207], v[178:179]
    v_pk_mul_f32 v[148:149], v[208:209], v[176:177]
    v_pk_mul_f32 v[150:151], v[210:211], v[178:179]
    v_pk_mul_f32 v[152:153], v[212:213], v[176:177]
    v_pk_mul_f32 v[154:155], v[214:215], v[178:179]
    v_pk_mul_f32 v[156:157], v[216:217], v[176:177]
    v_pk_mul_f32 v[158:159], v[218:219], v[178:179]
    v_pk_mul_f32 v[160:161], v[220:221], v[176:177]
    v_pk_mul_f32 v[162:163], v[222:223], v[178:179]
    v_pk_mul_f32 v[164:165], v[224:225], v[176:177]
    v_pk_mul_f32 v[166:167], v[226:227], v[178:179]
    v_pk_mul_f32 v[168:169], v[228:229], v[176:177]
    v_pk_mul_f32 v[170:171], v[230:231], v[178:179]
    v_pk_mul_f32 v[172:173], v[232:233], v[176:177]
    v_pk_mul_f32 v[174:175], v[234:235], v[178:179]
    v_pk_fma_f32 v[144:145], v[200:201], v[180:181], v[144:145]
    v_pk_fma_f32 v[146:147], v[202:203], v[182:183], v[146:147]
    v_pk_fma_f32 v[148:149], v[204:205], v[180:181], v[148:149]
    v_pk_fma_f32 v[150:151], v[206:207], v[182:183], v[150:151]
    v_pk_fma_f32 v[152:153], v[208:209], v[180:181], v[152:153]
    v_pk_fma_f32 v[154:155], v[210:211], v[182:183], v[154:155]
    v_pk_fma_f32 v[156:157], v[212:213], v[180:181], v[156:157]
    v_pk_fma_f32 v[158:159], v[214:215], v[182:183], v[158:159]
    v_pk_fma_f32 v[160:161], v[216:217], v[180:181], v[160:161]
    v_pk_fma_f32 v[162:163], v[218:219], v[182:183], v[162:163]
    v_pk_fma_f32 v[164:165], v[220:221], v[180:181], v[164:165]
    v_pk_fma_f32 v[166:167], v[222:223], v[182:183], v[166:167]
    v_pk_fma_f32 v[168:169], v[224:225], v[180:181], v[168:169]
    v_pk_fma_f32 v[170:171], v[226:227], v[182:183], v[170:171]
    v_pk_fma_f32 v[172:173], v[228:229], v[180:181], v[172:173]
    v_pk_fma_f32 v[174:175], v[230:231], v[182:183], v[174:175]
    v_pk_fma_f32 v[144:145], v[196:197], v[184:185], v[144:145]
    v_pk_fma_f32 v[146:147], v[198:199], v[186:187], v[146:147]
    v_pk_fma_f32 v[148:149], v[200:201], v[184:185], v[148:149]
    v_pk_fma_f32 v[150:151], v[202:203], v[186:187], v[150:151]
    v_pk_fma_f32 v[152:153], v[204:205], v[184:185], v[152:153]
    v_pk_fma_f32 v[154:155], v[206:207], v[186:187], v[154:155]
    v_pk_fma_f32 v[156:157], v[208:209], v[184:185], v[156:157]
    v_pk_fma_f32 v[158:159], v[210:211], v[186:187], v[158:159]
    v_pk_fma_f32 v[160:161], v[212:213], v[184:185], v[160:161]
    v_pk_fma_f32 v[162:163], v[214:215], v[186:187], v[162:163]
    v_pk_fma_f32 v[164:165], v[216:217], v[184:185], v[164:165]
    v_pk_fma_f32 v[166:167], v[218:219], v[186:187], v[166:167]
    v_pk_fma_f32 v[168:169], v[220:221], v[184:185], v[168:169]
    v_pk_fma_f32 v[170:171], v[222:223], v[186:187], v[170:171]
    v_pk_fma_f32 v[172:173], v[224:225], v[184:185], v[172:173]
    v_pk_fma_f32 v[174:175], v[226:227], v[186:187], v[174:175]
    v_pk_fma_f32 v[144:145], v[192:193], v[188:189], v[144:145]
    v_pk_fma_f32 v[146:147], v[194:195], v[190:191], v[146:147]
    v_pk_fma_f32 v[148:149], v[196:197], v[188:189], v[148:149]
    v_pk_fma_f32 v[150:151], v[198:199], v[190:191], v[150:151]
    v_pk_fma_f32 v[152:153], v[200:201], v[188:189], v[152:153]
    v_pk_fma_f32 v[154:155], v[202:203], v[190:191], v[154:155]
    v_pk_fma_f32 v[156:157], v[204:205], v[188:189], v[156:157]
    v_pk_fma_f32 v[158:159], v[206:207], v[190:191], v[158:159]
    v_pk_fma_f32 v[160:161], v[208:209], v[188:189], v[160:161]
    v_pk_fma_f32 v[162:163], v[210:211], v[190:191], v[162:163]
    v_pk_fma_f32 v[164:165], v[212:213], v[188:189], v[164:165]
    v_pk_fma_f32 v[166:167], v[214:215], v[190:191], v[166:167]
    v_pk_fma_f32 v[168:169], v[216:217], v[188:189], v[168:169]
    v_pk_fma_f32 v[170:171], v[218:219], v[190:191], v[170:171]
    v_pk_fma_f32 v[172:173], v[220:221], v[188:189], v[172:173]
    v_pk_fma_f32 v[174:175], v[222:223], v[190:191], v[174:175]
    s_waitcnt vmcnt(4)
    v_lshlrev_b32 v192, 16, v128
    v_and_b32 v193, 0xffff0000, v128
    v_lshlrev_b32 v194, 16, v129
    v_and_b32 v195, 0xffff0000, v129
    v_lshlrev_b32 v196, 16, v130
    v_and_b32 v197, 0xffff0000, v130
    v_lshlrev_b32 v198, 16, v131
    v_and_b32 v199, 0xffff0000, v131
    v_lshlrev_b32 v200, 16, v132
    v_and_b32 v201, 0xffff0000, v132
    v_lshlrev_b32 v202, 16, v133
    v_and_b32 v203, 0xffff0000, v133
    v_lshlrev_b32 v204, 16, v134
    v_and_b32 v205, 0xffff0000, v134
    v_lshlrev_b32 v206, 16, v135
    v_and_b32 v207, 0xffff0000, v135
    v_lshlrev_b32 v208, 16, v136
    v_and_b32 v209, 0xffff0000, v136
    v_lshlrev_b32 v210, 16, v137
    v_and_b32 v211, 0xffff0000, v137
    v_lshlrev_b32 v212, 16, v138
    v_and_b32 v213, 0xffff0000, v138
    v_lshlrev_b32 v214, 16, v139
    v_and_b32 v215, 0xffff0000, v139
    v_lshlrev_b32 v216, 16, v140
    v_and_b32 v217, 0xffff0000, v140
    v_lshlrev_b32 v218, 16, v141
    v_and_b32 v219, 0xffff0000, v141
    v_lshlrev_b32 v220, 16, v142
    v_and_b32 v221, 0xffff0000, v142
    v_lshlrev_b32 v222, 16, v143
    v_and_b32 v223, 0xffff0000, v143
    v_pk_mul_f32 v[144:145], v[144:145], v[192:193]
    v_pk_mul_f32 v[146:147], v[146:147], v[194:195]
    v_pk_mul_f32 v[148:149], v[148:149], v[196:197]
    v_pk_mul_f32 v[150:151], v[150:151], v[198:199]
    v_pk_mul_f32 v[152:153], v[152:153], v[200:201]
    v_pk_mul_f32 v[154:155], v[154:155], v[202:203]
    v_pk_mul_f32 v[156:157], v[156:157], v[204:205]
    v_pk_mul_f32 v[158:159], v[158:159], v[206:207]
    v_pk_mul_f32 v[160:161], v[160:161], v[208:209]
    v_pk_mul_f32 v[162:163], v[162:163], v[210:211]
    v_pk_mul_f32 v[164:165], v[164:165], v[212:213]
    v_pk_mul_f32 v[166:167], v[166:167], v[214:215]
    v_pk_mul_f32 v[168:169], v[168:169], v[216:217]
    v_pk_mul_f32 v[170:171], v[170:171], v[218:219]
    v_pk_mul_f32 v[172:173], v[172:173], v[220:221]
    v_pk_mul_f32 v[174:175], v[174:175], v[222:223]
    v_cvt_pk_bf16_f32 v236, v172, v168
    v_cvt_pk_bf16_f32 v237, v164, v160
    v_cvt_pk_bf16_f32 v238, v156, v152
    v_cvt_pk_bf16_f32 v239, v148, v144
    buffer_store_dwordx4 v[236:239], v61, s[56:59], 0 offen sc1
    v_cvt_pk_bf16_f32 v240, v173, v169
    v_cvt_pk_bf16_f32 v241, v165, v161
    v_cvt_pk_bf16_f32 v242, v157, v153
    v_cvt_pk_bf16_f32 v243, v149, v145
    buffer_store_dwordx4 v[240:243], v61, s[56:59], s12 offen sc1
    v_cvt_pk_bf16_f32 v244, v174, v170
    v_cvt_pk_bf16_f32 v245, v166, v162
    v_cvt_pk_bf16_f32 v246, v158, v154
    v_cvt_pk_bf16_f32 v247, v150, v146
    buffer_store_dwordx4 v[244:247], v61, s[56:59], s13 offen sc1
    v_cvt_pk_bf16_f32 v248, v175, v171
    v_cvt_pk_bf16_f32 v249, v167, v163
    v_cvt_pk_bf16_f32 v250, v159, v155
    v_cvt_pk_bf16_f32 v251, v151, v147
    buffer_store_dwordx4 v[248:251], v61, s[56:59], s14 offen sc1
    s_setprio 0
    s_mov_b32 s15, 0
G_s0_w:
    ds_read_b128 v[48:51], v11 offset:16
    s_waitcnt lgkmcnt(0)
    v_min3_u32 v48, v48, v49, v50
    v_min_u32 v48, v48, v51
    v_cmp_gt_u32 vcc, 1, v48
    s_cbranch_vccz G_s0_ok
    s_add_u32 s15, s15, 1
    s_cmp_lt_u32 s15, 160000
    s_cbranch_scc1 G_s0_w
G_s0_ok:
    ds_read_b128 v[128:131], v32 offset:0
    ds_read_b128 v[136:139], v36 offset:0
    ds_read_b128 v[140:143], v36 offset:4096
    ds_read_b128 v[132:135], v32 offset:4096
    ds_read_b128 v[144:147], v33 offset:0
    ds_read_b128 v[152:155], v37 offset:0
    ds_read_b128 v[156:159], v37 offset:4096
    ds_read_b128 v[148:151], v33 offset:4096
    ds_read_b128 v[160:163], v34 offset:0
    ds_read_b128 v[168:171], v38 offset:0
    ds_read_b128 v[172:175], v38 offset:4096
    ds_read_b128 v[164:167], v34 offset:4096
    ds_read_b128 v[176:179], v35 offset:0
    ds_read_b128 v[184:187], v39 offset:0
    ds_read_b128 v[188:191], v39 offset:4096
    ds_read_b128 v[180:183], v35 offset:4096
    ds_read_b128 v[48:51], v11 offset:16
    v_mov_b32 v52, 1
    s_mov_b32 s12, 2
    s_waitcnt lgkmcnt(0)
    ds_write_b32 v10, v52
G1_loop:
    v_mfma_f32_32x32x16_bf16 v[64:79], v[128:131], v[136:139], v[64:79]
    s_waitcnt lgkmcnt(0)
    v_min3_u32 v48, v48, v49, v50
    v_min_u32 v48, v48, v51
    v_cmp_gt_u32 vcc, s12, v48
    s_cbranch_vccnz G1_slow0
G1_back0:
    ds_read_b128 v[192:195], v32 offset:32768
    ds_read_b128 v[200:203], v36 offset:32768
    v_mfma_f32_32x32x16_bf16 v[80:95], v[128:131], v[140:143], v[80:95]
    ds_read_b128 v[204:207], v36 offset:36864
    ds_read_b128 v[196:199], v32 offset:36864
    v_mfma_f32_32x32x16_bf16 v[96:111], v[132:135], v[136:139], v[96:111]
    ds_read_b128 v[208:211], v33 offset:32768
    ds_read_b128 v[216:219], v37 offset:32768
    v_mfma_f32_32x32x16_bf16 v[112:127], v[132:135], v[140:143], v[112:127]
    ds_read_b128 v[220:223], v37 offset:36864
    ds_read_b128 v[212:215], v33 offset:36864
    v_mfma_f32_32x32x16_bf16 v[64:79], v[144:147], v[152:155], v[64:79]
    ds_read_b128 v[224:227], v34 offset:32768
    ds_read_b128 v[232:235], v38 offset:32768
    v_mfma_f32_32x32x16_bf16 v[80:95], v[144:147], v[156:159], v[80:95]
    ds_read_b128 v[236:239], v38 offset:36864
    ds_read_b128 v[228:231], v34 offset:36864
    v_mfma_f32_32x32x16_bf16 v[96:111], v[148:151], v[152:155], v[96:111]
    ds_read_b128 v[240:243], v35 offset:32768
    ds_read_b128 v[248:251], v39 offset:32768
    v_mfma_f32_32x32x16_bf16 v[112:127], v[148:151], v[156:159], v[112:127]
    ds_read_b128 v[252:255], v39 offset:36864
    ds_read_b128 v[244:247], v35 offset:36864
    v_mfma_f32_32x32x16_bf16 v[64:79], v[160:163], v[168:171], v[64:79]
    v_mfma_f32_32x32x16_bf16 v[80:95], v[160:163], v[172:175], v[80:95]
    s_cmp_eq_u32 s12, 6
    s_cbranch_scc1 G1_fk
G1_fkb:
    v_mfma_f32_32x32x16_bf16 v[96:111], v[164:167], v[168:171], v[96:111]
    v_mfma_f32_32x32x16_bf16 v[112:127], v[164:167], v[172:175], v[112:127]
    v_mfma_f32_32x32x16_bf16 v[64:79], v[176:179], v[184:187], v[64:79]
    v_mov_b32 v52, s12
    s_waitcnt lgkmcnt(0)
    ds_write_b32 v10, v52
    s_add_u32 s12, s12, 1
    v_mfma_f32_32x32x16_bf16 v[80:95], v[176:179], v[188:191], v[80:95]
    ds_read_b128 v[48:51], v11 offset:16
    v_mfma_f32_32x32x16_bf16 v[96:111], v[180:183], v[184:187], v[96:111]
    v_mfma_f32_32x32x16_bf16 v[112:127], v[180:183], v[188:191], v[112:127]
    v_mfma_f32_32x32x16_bf16 v[64:79], v[192:195], v[200:203], v[64:79]
    s_waitcnt lgkmcnt(0)
    v_min3_u32 v48, v48, v49, v50
    v_min_u32 v48, v48, v51
    v_cmp_gt_u32 vcc, s12, v48
    s_cbranch_vccnz G1_slow1
G1_back1:
    ds_read_b128 v[128:131], v40 offset:0
    ds_read_b128 v[136:139], v44 offset:0
    v_mfma_f32_32x32x16_bf16 v[80:95], v[192:195], v[204:207], v[80:95]
    ds_read_b128 v[140:143], v44 offset:4096
    ds_read_b128 v[132:135], v40 offset:4096
    v_mfma_f32_32x32x16_bf16 v[96:111], v[196:199], v[200:203], v[96:111]
    ds_read_b128 v[144:147], v41 offset:0
    ds_read_b128 v[152:155], v45 offset:0
    v_mfma_f32_32x32x16_bf16 v[112:127], v[196:199], v[204:207], v[112:127]
    ds_read_b128 v[156:159], v45 offset:4096
    ds_read_b128 v[148:151], v41 offset:4096
    v_mfma_f32_32x32x16_bf16 v[64:79], v[208:211], v[216:219], v[64:79]
    ds_read_b128 v[160:163], v42 offset:0
    ds_read_b128 v[168:171], v46 offset:0
    v_mfma_f32_32x32x16_bf16 v[80:95], v[208:211], v[220:223], v[80:95]
    ds_read_b128 v[172:175], v46 offset:4096
    ds_read_b128 v[164:167], v42 offset:4096
    v_mfma_f32_32x32x16_bf16 v[96:111], v[212:215], v[216:219], v[96:111]
    ds_read_b128 v[176:179], v43 offset:0
    ds_read_b128 v[184:187], v47 offset:0
    v_mfma_f32_32x32x16_bf16 v[112:127], v[212:215], v[220:223], v[112:127]
    ds_read_b128 v[188:191], v47 offset:4096
    ds_read_b128 v[180:183], v43 offset:4096
    v_mfma_f32_32x32x16_bf16 v[64:79], v[224:227], v[232:235], v[64:79]
    v_mfma_f32_32x32x16_bf16 v[80:95], v[224:227], v[236:239], v[80:95]
    v_mfma_f32_32x32x16_bf16 v[96:111], v[228:231], v[232:235], v[96:111]
    v_mfma_f32_32x32x16_bf16 v[112:127], v[228:231], v[236:239], v[112:127]
    v_mfma_f32_32x32x16_bf16 v[64:79], v[240:243], v[248:251], v[64:79]
    v_mov_b32 v52, s12
    s_waitcnt lgkmcnt(0)
    ds_write_b32 v10, v52
    s_add_u32 s12, s12, 1
    v_mfma_f32_32x32x16_bf16 v[80:95], v[240:243], v[252:255], v[80:95]
    ds_read_b128 v[48:51], v11 offset:16
    v_mfma_f32_32x32x16_bf16 v[96:111], v[244:247], v[248:251], v[96:111]
    v_mfma_f32_32x32x16_bf16 v[112:127], v[244:247], v[252:255], v[112:127]
    v_mfma_f32_32x32x16_bf16 v[64:79], v[128:131], v[136:139], v[64:79]
    s_waitcnt lgkmcnt(0)
    v_min3_u32 v48, v48, v49, v50
    v_min_u32 v48, v48, v51
    v_cmp_gt_u32 vcc, s12, v48
    s_cbranch_vccnz G1_slow2
G1_back2:
    ds_read_b128 v[192:195], v40 offset:32768
    ds_read_b128 v[200:203], v44 offset:32768
    v_mfma_f32_32x32x16_bf16 v[80:95], v[128:131], v[140:143], v[80:95]
    ds_read_b128 v[204:207], v44 offset:36864
    ds_read_b128 v[196:199], v40 offset:36864
    v_mfma_f32_32x32x16_bf16 v[96:111], v[132:135], v[136:139], v[96:111]
    ds_read_b128 v[208:211], v41 offset:32768
    ds_read_b128 v[216:219], v45 offset:32768
    v_mfma_f32_32x32x16_bf16 v[112:127], v[132:135], v[140:143], v[112:127]
    ds_read_b128 v[220:223], v45 offset:36864
    ds_read_b128 v[212:215], v41 offset:36864
    v_mfma_f32_32x32x16_bf16 v[64:79], v[144:147], v[152:155], v[64:79]
    ds_read_b128 v[224:227], v42 offset:32768
    ds_read_b128 v[232:235], v46 offset:32768
    v_mfma_f32_32x32x16_bf16 v[80:95], v[144:147], v[156:159], v[80:95]
    ds_read_b128 v[236:239], v46 offset:36864
    ds_read_b128 v[228:231], v42 offset:36864
    v_mfma_f32_32x32x16_bf16 v[96:111], v[148:151], v[152:155], v[96:111]
    ds_read_b128 v[240:243], v43 offset:32768
    ds_read_b128 v[248:251], v47 offset:32768
    v_mfma_f32_32x32x16_bf16 v[112:127], v[148:151], v[156:159], v[112:127]
    ds_read_b128 v[252:255], v47 offset:36864
    ds_read_b128 v[244:247], v43 offset:36864
    v_mfma_f32_32x32x16_bf16 v[64:79], v[160:163], v[168:171], v[64:79]
    v_mfma_f32_32x32x16_bf16 v[80:95], v[160:163], v[172:175], v[80:95]
    v_mfma_f32_32x32x16_bf16 v[96:111], v[164:167], v[168:171], v[96:111]
    v_mfma_f32_32x32x16_bf16 v[112:127], v[164:167], v[172:175], v[112:127]
    v_mfma_f32_32x32x16_bf16 v[64:79], v[176:179], v[184:187], v[64:79]
    v_mov_b32 v52, s12
    s_waitcnt lgkmcnt(0)
    ds_write_b32 v10, v52
    s_add_u32 s12, s12, 1
    v_mfma_f32_32x32x16_bf16 v[80:95], v[176:179], v[188:191], v[80:95]
    ds_read_b128 v[48:51], v11 offset:16
    v_mfma_f32_32x32x16_bf16 v[96:111], v[180:183], v[184:187], v[96:111]
    v_mfma_f32_32x32x16_bf16 v[112:127], v[180:183], v[188:191], v[112:127]
    s_cmp_eq_u32 s12, 17
    s_cbranch_scc1 G1_last
    v_mfma_f32_32x32x16_bf16 v[64:79], v[192:195], v[200:203], v[64:79]
    s_waitcnt lgkmcnt(0)
    v_min3_u32 v48, v48, v49, v50
    v_min_u32 v48, v48, v51
    v_cmp_gt_u32 vcc, s12, v48
    s_cbranch_vccnz G1_slow3
G1_back3:
    ds_read_b128 v[128:131], v32 offset:0
    ds_read_b128 v[136:139], v36 offset:0
    v_mfma_f32_32x32x16_bf16 v[80:95], v[192:195], v[204:207], v[80:95]
    ds_read_b128 v[140:143], v36 offset:4096
    ds_read_b128 v[132:135], v32 offset:4096
    v_mfma_f32_32x32x16_bf16 v[96:111], v[196:199], v[200:203], v[96:111]
    ds_read_b128 v[144:147], v33 offset:0
    ds_read_b128 v[152:155], v37 offset:0
    v_mfma_f32_32x32x16_bf16 v[112:127], v[196:199], v[204:207], v[112:127]
    ds_read_b128 v[156:159], v37 offset:4096
    ds_read_b128 v[148:151], v33 offset:4096
    v_mfma_f32_32x32x16_bf16 v[64:79], v[208:211], v[216:219], v[64:79]
    ds_read_b128 v[160:163], v34 offset:0
    ds_read_b128 v[168:171], v38 offset:0
    v_mfma_f32_32x32x16_bf16 v[80:95], v[208:211], v[220:223], v[80:95]
    ds_read_b128 v[172:175], v38 offset:4096
    ds_read_b128 v[164:167], v34 offset:4096
    v_mfma_f32_32x32x16_bf16 v[96:111], v[212:215], v[216:219], v[96:111]
    ds_read_b128 v[176:179], v35 offset:0
    ds_read_b128 v[184:187], v39 offset:0
    v_mfma_f32_32x32x16_bf16 v[112:127], v[212:215], v[220:223], v[112:127]
    ds_read_b128 v[188:191], v39 offset:4096
    ds_read_b128 v[180:183], v35 offset:4096
    v_mfma_f32_32x32x16_bf16 v[64:79], v[224:227], v[232:235], v[64:79]
    v_mfma_f32_32x32x16_bf16 v[80:95], v[224:227], v[236:239], v[80:95]
    v_mfma_f32_32x32x16_bf16 v[96:111], v[228:231], v[232:235], v[96:111]
    v_mfma_f32_32x32x16_bf16 v[112:127], v[228:231], v[236:239], v[112:127]
    v_mfma_f32_32x32x16_bf16 v[64:79], v[240:243], v[248:251], v[64:79]
    v_mov_b32 v52, s12
    s_waitcnt lgkmcnt(0)
    ds_write_b32 v10, v52
    s_add_u32 s12, s12, 1
    v_mfma_f32_32x32x16_bf16 v[80:95], v[240:243], v[252:255], v[80:95]
    ds_read_b128 v[48:51], v11 offset:16
    v_mfma_f32_32x32x16_bf16 v[96:111], v[244:247], v[248:251], v[96:111]
    v_mfma_f32_32x32x16_bf16 v[112:127], v[244:247], v[252:255], v[112:127]
    s_branch G1_loop
G1_slow0:
    s_mov_b32 s15, 0
G1_sl0_w:
    ds_read_b128 v[48:51], v11 offset:16
    s_waitcnt lgkmcnt(0)
    v_min3_u32 v48, v48, v49, v50
    v_min_u32 v48, v48, v51
    v_cmp_gt_u32 vcc, s12, v48
    s_cbranch_vccz G1_sl0_ok
    s_add_u32 s15, s15, 1
    s_cmp_lt_u32 s15, 160000
    s_cbranch_scc1 G1_sl0_w
G1_sl0_ok:
    s_branch G1_back0
G1_slow1:
    s_mov_b32 s15, 0
G1_sl1_w:
    ds_read_b128 v[48:51], v11 offset:16
    s_waitcnt lgkmcnt(0)
    v_min3_u32 v48, v48, v49, v50
    v_min_u32 v48, v48, v51
    v_cmp_gt_u32 vcc, s12, v48
    s_cbranch_vccz G1_sl1_ok
    s_add_u32 s15, s15, 1
    s_cmp_lt_u32 s15, 160000
    s_cbranch_scc1 G1_sl1_w
G1_sl1_ok:
    s_branch G1_back1
G1_slow2:
    s_mov_b32 s15, 0
G1_sl2_w:
    ds_read_b128 v[48:51], v11 offset:16
    s_waitcnt lgkmcnt(0)
    v_min3_u32 v48, v48, v49, v50
    v_min_u32 v48, v48, v51
    v_cmp_gt_u32 vcc, s12, v48
    s_cbranch_vccz G1_sl2_ok
    s_add_u32 s15, s15, 1
    s_cmp_lt_u32 s15, 160000
    s_cbranch_scc1 G1_sl2_w
G1_sl2_ok:
    s_branch G1_back2
G1_slow3:
    s_mov_b32 s15, 0
G1_sl3_w:
    ds_read_b128 v[48:51], v11 offset:16
    s_waitcnt lgkmcnt(0)
    v_min3_u32 v48, v48, v49, v50
    v_min_u32 v48, v48, v51
    v_cmp_gt_u32 vcc, s12, v48
    s_cbranch_vccz G1_sl3_ok
    s_add_u32 s15, s15, 1
    s_cmp_lt_u32 s15, 160000
    s_cbranch_scc1 G1_sl3_w
G1_sl3_ok:
    s_branch G1_back3
G1_fk:
    ds_read_b64 v[30:31], v11 offset:32
    s_waitcnt vmcnt(0) lgkmcnt(0)
    s_mov_b64 exec, 1
    buffer_store_dwordx2 v[30:31], v23, s[72:75], s16 offen sc1
    s_mov_b64 exec, -1
    s_branch G1_fkb
G1_last:
    v_mfma_f32_32x32x16_bf16 v[64:79], v[192:195], v[200:203], v[64:79]
    s_setprio 3
    v_lshlrev_b32 v133, 16, v12
    v_lshlrev_b32 v134, 16, v13
    v_lshlrev_b32 v135, 16, v14
    v_mul_f32 v133, 0x3fb8aa3b, v133
    v_mfma_f32_32x32x16_bf16 v[80:95], v[192:195], v[204:207], v[80:95]
    v_exp_f32 v133, v133
    v_mul_f32 v140, v134, v134
    v_cvt_pk_bf16_f32 v133, v133, v133
    v_fmac_f32 v140, v135, v135
    v_mfma_f32_32x32x16_bf16 v[96:111], v[196:199], v[200:203], v[96:111]
    v_lshlrev_b32 v133, 16, v133
    v_rcp_f32 v140, v140
    v_mul_f32 v136, v133, v134
    v_mul_f32 v137, v133, v135
    v_mfma_f32_32x32x16_bf16 v[112:127], v[196:199], v[204:207], v[112:127]
    v_mul_f32 v136, 0x3fb8aa3b, v136
    v_exp_f32 v136, v136
    v_mul_f32 v137, 0.15915494, v137
    v_cos_f32 v138, v137
    v_mfma_f32_32x32x16_bf16 v[64:79], v[208:211], v[216:219], v[64:79]
    v_sin_f32 v139, v137
    v_add_f32 v140, v140, v140
    v_mul_f32 v6, v136, v138
    v_mul_f32 v7, v136, v139
    v_mfma_f32_32x32x16_bf16 v[80:95], v[208:211], v[220:223], v[80:95]
    v_mul_f32 v128, v6, v6
    v_mul_f32 v129, v6, v7
    v_fma_f32 v128, -v7, v7, v128
    v_fmac_f32 v129, v7, v6
    v_mfma_f32_32x32x16_bf16 v[96:111], v[212:215], v[216:219], v[96:111]
    v_mul_f32 v130, v128, v128
    v_mul_f32 v131, v128, v129
    v_fma_f32 v130, -v129, v129, v130
    v_fmac_f32 v131, v129, v128
    v_mfma_f32_32x32x16_bf16 v[112:127], v[212:215], v[220:223], v[112:127]
    v_mul_f32 v12, v130, v130
    v_mul_f32 v13, v130, v131
    v_fma_f32 v12, -v131, v131, v12
    v_fmac_f32 v13, v131, v130
    v_mfma_f32_32x32x16_bf16 v[64:79], v[224:227], v[232:235], v[64:79]
    v_mul_f32 v14, v12, v12
    v_mul_f32 v15, v12, v13
    v_fma_f32 v14, -v13, v13, v14
    v_fmac_f32 v15, v13, v12
    v_mfma_f32_32x32x16_bf16 v[80:95], v[224:227], v[236:239], v[80:95]
    v_mul_f32 v16, v14, v14
    v_mul_f32 v17, v14, v15
    v_fma_f32 v16, -v15, v15, v16
    v_fmac_f32 v17, v15, v14
    v_mfma_f32_32x32x16_bf16 v[96:111], v[228:231], v[232:235], v[96:111]
    v_add_f32 v136, -1.0, v6
    v_mul_f32 v138, v136, v134
    v_fmac_f32 v138, v7, v135
    v_mul_f32 v139, v7, v134
    v_mfma_f32_32x32x16_bf16 v[112:127], v[228:231], v[236:239], v[112:127]
    v_fma_f32 v139, -v136, v135, v139
    v_mul_f32 v8, v138, v140
    v_mul_f32 v9, v139, v140
    v_mul_f32 v18, v16, v16
    v_mfma_f32_32x32x16_bf16 v[64:79], v[240:243], v[248:251], v[64:79]
    v_mul_f32 v19, v16, v17
    v_fma_f32 v18, -v17, v17, v18
    v_fmac_f32 v19, v17, v16
    v_mul_f32 v20, v18, v18
    v_mfma_f32_32x32x16_bf16 v[80:95], v[240:243], v[252:255], v[80:95]
    v_mul_f32 v21, v18, v19
    v_fma_f32 v20, -v19, v19, v20
    v_fmac_f32 v21, v19, v18
    v_mfma_f32_32x32x16_bf16 v[96:111], v[244:247], v[248:251], v[96:111]
    v_mfma_f32_32x32x16_bf16 v[112:127], v[244:247], v[252:255], v[112:127]
    s_nop 1
    v_pk_fma_f32 v[40:41], v[6:7], v[64:65], v[66:67] op_sel:[0,0,0] op_sel_hi:[0,1,1]
    s_nop 3
    v_pk_fma_f32 v[42:43], v[6:7], v[80:81], v[82:83] op_sel:[0,0,0] op_sel_hi:[0,1,1]
    s_nop 2
    v_pk_fma_f32 v[44:45], v[6:7], v[96:97], v[98:99] op_sel:[0,0,0] op_sel_hi:[0,1,1]
    v_pk_fma_f32 v[46:47], v[6:7], v[112:113], v[114:115] op_sel:[0,0,0] op_sel_hi:[0,1,1]
    v_pk_fma_f32 v[40:41], v[6:7], v[80:81], v[40:41] op_sel:[1,0,0] op_sel_hi:[1,1,1] neg_lo:[1,0,0] neg_hi:[1,0,0]
    v_pk_fma_f32 v[42:43], v[6:7], v[64:65], v[42:43] op_sel:[1,0,0] op_sel_hi:[1,1,1]
    v_pk_fma_f32 v[44:45], v[6:7], v[112:113], v[44:45] op_sel:[1,0,0] op_sel_hi:[1,1,1] neg_lo:[1,0,0] neg_hi:[1,0,0]
    v_pk_fma_f32 v[46:47], v[6:7], v[96:97], v[46:47] op_sel:[1,0,0] op_sel_hi:[1,1,1]
    v_pk_fma_f32 v[32:33], v[6:7], v[40:41], v[68:69] op_sel:[0,0,0] op_sel_hi:[0,1,1]
    v_pk_fma_f32 v[34:35], v[6:7], v[42:43], v[84:85] op_sel:[0,0,0] op_sel_hi:[0,1,1]
    v_pk_fma_f32 v[36:37], v[6:7], v[44:45], v[100:101] op_sel:[0,0,0] op_sel_hi:[0,1,1]
    v_pk_fma_f32 v[38:39], v[6:7], v[46:47], v[116:117] op_sel:[0,0,0] op_sel_hi:[0,1,1]
    v_pk_fma_f32 v[32:33], v[6:7], v[42:43], v[32:33] op_sel:[1,0,0] op_sel_hi:[1,1,1] neg_lo:[1,0,0] neg_hi:[1,0,0]
    v_pk_fma_f32 v[34:35], v[6:7], v[40:41], v[34:35] op_sel:[1,0,0] op_sel_hi:[1,1,1]
    v_pk_fma_f32 v[36:37], v[6:7], v[46:47], v[36:37] op_sel:[1,0,0] op_sel_hi:[1,1,1] neg_lo:[1,0,0] neg_hi:[1,0,0]
    v_pk_fma_f32 v[38:39], v[6:7], v[44:45], v[38:39] op_sel:[1,0,0] op_sel_hi:[1,1,1]
    v_pk_fma_f32 v[40:41], v[6:7], v[32:33], v[70:71] op_sel:[0,0,0] op_sel_hi:[0,1,1]
    v_pk_fma_f32 v[42:43], v[6:7], v[34:35], v[86:87] op_sel:[0,0,0] op_sel_hi:[0,1,1]
    v_pk_fma_f32 v[44:45], v[6:7], v[36:37], v[102:103] op_sel:[0,0,0] op_sel_hi:[0,1,1]
    v_pk_fma_f32 v[46:47], v[6:7], v[38:39], v[118:119] op_sel:[0,0,0] op_sel_hi:[0,1,1]
    v_pk_fma_f32 v[40:41], v[6:7], v[34:35], v[40:41] op_sel:[1,0,0] op_sel_hi:[1,1,1] neg_lo:[1,0,0] neg_hi:[1,0,0]
    v_pk_fma_f32 v[42:43], v[6:7], v[32:33], v[42:43] op_sel:[1,0,0] op_sel_hi:[1,1,1]
    v_pk_fma_f32 v[44:45], v[6:7], v[38:39], v[44:45] op_sel:[1,0,0] op_sel_hi:[1,1,1] neg_lo:[1,0,0] neg_hi:[1,0,0]
    v_pk_fma_f32 v[46:47], v[6:7], v[36:37], v[46:47] op_sel:[1,0,0] op_sel_hi:[1,1,1]
    v_pk_fma_f32 v[32:33], v[6:7], v[40:41], v[72:73] op_sel:[0,0,0] op_sel_hi:[0,1,1]
    v_pk_fma_f32 v[34:35], v[6:7], v[42:43], v[88:89] op_sel:[0,0,0] op_sel_hi:[0,1,1]
    v_pk_fma_f32 v[36:37], v[6:7], v[44:45], v[104:105] op_sel:[0,0,0] op_sel_hi:[0,1,1]
    v_pk_fma_f32 v[38:39], v[6:7], v[46:47], v[120:121] op_sel:[0,0,0] op_sel_hi:[0,1,1]
    v_pk_fma_f32 v[32:33], v[6:7], v[42:43], v[32:33] op_sel:[1,0,0] op_sel_hi:[1,1,1] neg_lo:[1,0,0] neg_hi:[1,0,0]
    v_pk_fma_f32 v[34:35], v[6:7], v[40:41], v[34:35] op_sel:[1,0,0] op_sel_hi:[1,1,1]
    v_pk_fma_f32 v[36:37], v[6:7], v[46:47], v[36:37] op_sel:[1,0,0] op_sel_hi:[1,1,1] neg_lo:[1,0,0] neg_hi:[1,0,0]
    v_pk_fma_f32 v[38:39], v[6:7], v[44:45], v[38:39] op_sel:[1,0,0] op_sel_hi:[1,1,1]
    v_pk_fma_f32 v[40:41], v[6:7], v[32:33], v[74:75] op_sel:[0,0,0] op_sel_hi:[0,1,1]
    v_pk_fma_f32 v[42:43], v[6:7], v[34:35], v[90:91] op_sel:[0,0,0] op_sel_hi:[0,1,1]
    v_pk_fma_f32 v[44:45], v[6:7], v[36:37], v[106:107] op_sel:[0,0,0] op_sel_hi:[0,1,1]
    v_pk_fma_f32 v[46:47], v[6:7], v[38:39], v[122:123] op_sel:[0,0,0] op_sel_hi:[0,1,1]
    v_pk_fma_f32 v[40:41], v[6:7], v[34:35], v[40:41] op_sel:[1,0,0] op_sel_hi:[1,1,1] neg_lo:[1,0,0] neg_hi:[1,0,0]
    v_pk_fma_f32 v[42:43], v[6:7], v[32:33], v[42:43] op_sel:[1,0,0] op_sel_hi:[1,1,1]
    v_pk_fma_f32 v[44:45], v[6:7], v[38:39], v[44:45] op_sel:[1,0,0] op_sel_hi:[1,1,1] neg_lo:[1,0,0] neg_hi:[1,0,0]
    v_pk_fma_f32 v[46:47], v[6:7], v[36:37], v[46:47] op_sel:[1,0,0] op_sel_hi:[1,1,1]
    v_pk_fma_f32 v[32:33], v[6:7], v[40:41], v[76:77] op_sel:[0,0,0] op_sel_hi:[0,1,1]
    v_pk_fma_f32 v[34:35], v[6:7], v[42:43], v[92:93] op_sel:[0,0,0] op_sel_hi:[0,1,1]
    v_pk_fma_f32 v[36:37], v[6:7], v[44:45], v[108:109] op_sel:[0,0,0] op_sel_hi:[0,1,1]
    v_pk_fma_f32 v[38:39], v[6:7], v[46:47], v[124:125] op_sel:[0,0,0] op_sel_hi:[0,1,1]
    v_pk_fma_f32 v[32:33], v[6:7], v[42:43], v[32:33] op_sel:[1,0,0] op_sel_hi:[1,1,1] neg_lo:[1,0,0] neg_hi:[1,0,0]
    v_pk_fma_f32 v[34:35], v[6:7], v[40:41], v[34:35] op_sel:[1,0,0] op_sel_hi:[1,1,1]
    v_pk_fma_f32 v[36:37], v[6:7], v[46:47], v[36:37] op_sel:[1,0,0] op_sel_hi:[1,1,1] neg_lo:[1,0,0] neg_hi:[1,0,0]
    v_pk_fma_f32 v[38:39], v[6:7], v[44:45], v[38:39] op_sel:[1,0,0] op_sel_hi:[1,1,1]
    v_pk_fma_f32 v[40:41], v[6:7], v[32:33], v[78:79] op_sel:[0,0,0] op_sel_hi:[0,1,1]
    v_pk_fma_f32 v[42:43], v[6:7], v[34:35], v[94:95] op_sel:[0,0,0] op_sel_hi:[0,1,1]
    v_pk_fma_f32 v[44:45], v[6:7], v[36:37], v[110:111] op_sel:[0,0,0] op_sel_hi:[0,1,1]
    v_pk_fma_f32 v[46:47], v[6:7], v[38:39], v[126:127] op_sel:[0,0,0] op_sel_hi:[0,1,1]
    v_pk_fma_f32 v[40:41], v[6:7], v[34:35], v[40:41] op_sel:[1,0,0] op_sel_hi:[1,1,1] neg_lo:[1,0,0] neg_hi:[1,0,0]
    v_pk_fma_f32 v[42:43], v[6:7], v[32:33], v[42:43] op_sel:[1,0,0] op_sel_hi:[1,1,1]
    v_pk_fma_f32 v[44:45], v[6:7], v[38:39], v[44:45] op_sel:[1,0,0] op_sel_hi:[1,1,1] neg_lo:[1,0,0] neg_hi:[1,0,0]
    v_pk_fma_f32 v[46:47], v[6:7], v[36:37], v[46:47] op_sel:[1,0,0] op_sel_hi:[1,1,1]
    v_pk_fma_f32 v[44:45], v[12:13], v[40:41], v[44:45] op_sel:[0,0,0] op_sel_hi:[0,1,1]
    v_pk_fma_f32 v[46:47], v[12:13], v[42:43], v[46:47] op_sel:[0,0,0] op_sel_hi:[0,1,1]
    v_pk_fma_f32 v[44:45], v[12:13], v[42:43], v[44:45] op_sel:[1,0,0] op_sel_hi:[1,1,1] neg_lo:[1,0,0] neg_hi:[1,0,0]
    v_pk_fma_f32 v[46:47], v[12:13], v[40:41], v[46:47] op_sel:[1,0,0] op_sel_hi:[1,1,1]
    v_fma_f32 v32, v14, v44, v45
    v_fma_f32 v34, v14, v46, v47
    v_fma_f32 v32, -v15, v46, v32
    v_fmac_f32 v34, v15, v44
    v_mov_b32 v33, v32
    v_mov_b32 v35, v34
    s_lshl_b32 s12, s6, 1
    s_add_u32 s12, s12, s8
    v_permlane32_swap_b32 v32, v33
    v_permlane32_swap_b32 v34, v35
    s_lshl_b32 s13, s12, 14
    v_fma_f32 v28, v16, v32, v33
    v_fma_f32 v29, v16, v34, v35
    v_fma_f32 v28, -v17, v34, v28
    v_fmac_f32 v29, v17, v32
    s_waitcnt lgkmcnt(0)
    s_mov_b32 exec_hi, 0
    buffer_store_dwordx4 v[28:31], v25, s[64:67], s13 offen sc1
    s_cmp_eq_u32 s12, 0
    s_cbranch_scc0 G_pub1
    s_not_b64 exec, exec
    v_mov_b32 v28, 0
    v_mov_b32 v29, 0
    buffer_store_dwordx4 v[28:31], v25, s[64:67], 0 offen sc1
G_pub1:
    s_mov_b64 exec, -1
    v_mul_f32 v128, v8, v64
    v_mul_f32 v129, v8, v65
    v_mul_f32 v144, -v8, v80
    v_mul_f32 v145, -v8, v81
    v_mul_f32 v160, v8, v96
    v_mul_f32 v161, v8, v97
    v_mul_f32 v176, -v8, v112
    v_mul_f32 v177, -v8, v113
    v_fma_f32 v128, -v9, v80, v128
    v_fma_f32 v129, -v9, v81, v129
    v_fma_f32 v144, -v9, v64, v144
    v_fma_f32 v145, -v9, v65, v145
    v_fma_f32 v160, -v9, v112, v160
    v_fma_f32 v161, -v9, v113, v161
    v_fma_f32 v176, -v9, v96, v176
    v_fma_f32 v177, -v9, v97, v177
    v_mul_f32 v130, v8, v66
    v_mul_f32 v131, v8, v67
    v_mul_f32 v146, -v8, v82
    v_mul_f32 v147, -v8, v83
    v_mul_f32 v162, v8, v98
    v_mul_f32 v163, v8, v99
    v_mul_f32 v178, -v8, v114
    v_mul_f32 v179, -v8, v115
    v_fma_f32 v130, -v9, v82, v130
    v_fma_f32 v131, -v9, v83, v131
    v_fma_f32 v146, -v9, v66, v146
    v_fma_f32 v147, -v9, v67, v147
    v_fma_f32 v162, -v9, v114, v162
    v_fma_f32 v163, -v9, v115, v163
    v_fma_f32 v178, -v9, v98, v178
    v_fma_f32 v179, -v9, v99, v179
    v_mul_f32 v132, v8, v68
    v_mul_f32 v133, v8, v69
    v_mul_f32 v148, -v8, v84
    v_mul_f32 v149, -v8, v85
    v_mul_f32 v164, v8, v100
    v_mul_f32 v165, v8, v101
    v_mul_f32 v180, -v8, v116
    v_mul_f32 v181, -v8, v117
    v_fma_f32 v132, -v9, v84, v132
    v_fma_f32 v133, -v9, v85, v133
    v_fma_f32 v148, -v9, v68, v148
    v_fma_f32 v149, -v9, v69, v149
    v_fma_f32 v164, -v9, v116, v164
    v_fma_f32 v165, -v9, v117, v165
    v_fma_f32 v180, -v9, v100, v180
    v_fma_f32 v181, -v9, v101, v181
    v_mul_f32 v134, v8, v70
    v_mul_f32 v135, v8, v71
    v_mul_f32 v150, -v8, v86
    v_mul_f32 v151, -v8, v87
    v_mul_f32 v166, v8, v102
    v_mul_f32 v167, v8, v103
    v_mul_f32 v182, -v8, v118
    v_mul_f32 v183, -v8, v119
    v_fma_f32 v134, -v9, v86, v134
    v_fma_f32 v135, -v9, v87, v135
    v_fma_f32 v150, -v9, v70, v150
    v_fma_f32 v151, -v9, v71, v151
    v_fma_f32 v166, -v9, v118, v166
    v_fma_f32 v167, -v9, v119, v167
    v_fma_f32 v182, -v9, v102, v182
    v_fma_f32 v183, -v9, v103, v183
    v_mul_f32 v136, v8, v72
    v_mul_f32 v137, v8, v73
    v_mul_f32 v152, -v8, v88
    v_mul_f32 v153, -v8, v89
    v_mul_f32 v168, v8, v104
    v_mul_f32 v169, v8, v105
    v_mul_f32 v184, -v8, v120
    v_mul_f32 v185, -v8, v121
    v_fma_f32 v136, -v9, v88, v136
    v_fma_f32 v137, -v9, v89, v137
    v_fma_f32 v152, -v9, v72, v152
    v_fma_f32 v153, -v9, v73, v153
    v_fma_f32 v168, -v9, v120, v168
    v_fma_f32 v169, -v9, v121, v169
    v_fma_f32 v184, -v9, v104, v184
    v_fma_f32 v185, -v9, v105, v185
    v_mul_f32 v138, v8, v74
    v_mul_f32 v139, v8, v75
    v_mul_f32 v154, -v8, v90
    v_mul_f32 v155, -v8, v91
    v_mul_f32 v170, v8, v106
    v_mul_f32 v171, v8, v107
    v_mul_f32 v186, -v8, v122
    v_mul_f32 v187, -v8, v123
    v_fma_f32 v138, -v9, v90, v138
    v_fma_f32 v139, -v9, v91, v139
    v_fma_f32 v154, -v9, v74, v154
    v_fma_f32 v155, -v9, v75, v155
    v_fma_f32 v170, -v9, v122, v170
    v_fma_f32 v171, -v9, v123, v171
    v_fma_f32 v186, -v9, v106, v186
    v_fma_f32 v187, -v9, v107, v187
    v_mul_f32 v140, v8, v76
    v_mul_f32 v141, v8, v77
    v_mul_f32 v156, -v8, v92
    v_mul_f32 v157, -v8, v93
    v_mul_f32 v172, v8, v108
    v_mul_f32 v173, v8, v109
    v_mul_f32 v188, -v8, v124
    v_mul_f32 v189, -v8, v125
    v_fma_f32 v140, -v9, v92, v140
    v_fma_f32 v141, -v9, v93, v141
    v_fma_f32 v156, -v9, v76, v156
    v_fma_f32 v157, -v9, v77, v157
    v_fma_f32 v172, -v9, v124, v172
    v_fma_f32 v173, -v9, v125, v173
    v_fma_f32 v188, -v9, v108, v188
    v_fma_f32 v189, -v9, v109, v189
    v_mul_f32 v142, v8, v78
    v_mul_f32 v143, v8, v79
    v_mul_f32 v158, -v8, v94
    v_mul_f32 v159, -v8, v95
    v_mul_f32 v174, v8, v110
    v_mul_f32 v175, v8, v111
    v_mul_f32 v190, -v8, v126
    v_mul_f32 v191, -v8, v127
    v_fma_f32 v142, -v9, v94, v142
    v_fma_f32 v143, -v9, v95, v143
    v_fma_f32 v158, -v9, v78, v158
    v_fma_f32 v159, -v9, v79, v159
    v_fma_f32 v174, -v9, v126, v174
    v_fma_f32 v175, -v9, v127, v175
    v_fma_f32 v190, -v9, v110, v190
    v_fma_f32 v191, -v9, v111, v191
    v_cmp_eq_u32 vcc, 1, v4
    v_mov_b32 v36, 1.0
    s_nop 0
    v_cndmask_b32 v64, v36, v18, vcc
    v_cndmask_b32 v65, 0, v19, vcc
    v_cndmask_b32 v96, 0, v32, vcc
    v_cndmask_b32 v98, 0, v34, vcc
    v_cndmask_b32 v36, v36, v16, vcc
    v_cndmask_b32 v37, 0, v17, vcc
    v_mul_f32 v66, v20, v64
    v_mul_f32 v67, v20, v65
    v_fma_f32 v97, v14, v96, v44
    v_fma_f32 v66, -v21, v65, v66
    v_fmac_f32 v67, v21, v64
    v_fma_f32 v99, v14, v98, v46
    v_mul_f32 v68, v20, v66
    v_mul_f32 v69, v20, v67
    v_fma_f32 v97, -v15, v98, v97
    v_fma_f32 v68, -v21, v67, v68
    v_fmac_f32 v69, v21, v66
    v_fmac_f32 v99, v15, v96
    v_mul_f32 v70, v20, v68
    v_mul_f32 v71, v20, v69
    v_fma_f32 v100, v12, v96, v40
    v_fma_f32 v70, -v21, v69, v70
    v_fmac_f32 v71, v21, v68
    v_fma_f32 v101, v12, v97, v41
    v_mul_f32 v72, v20, v70
    v_mul_f32 v73, v20, v71
    v_fma_f32 v102, v12, v98, v42
    v_fma_f32 v72, -v21, v71, v72
    v_fmac_f32 v73, v21, v70
    v_fma_f32 v103, v12, v99, v43
    v_mul_f32 v74, v20, v72
    v_mul_f32 v75, v20, v73
    v_fma_f32 v100, -v13, v98, v100
    v_fma_f32 v74, -v21, v73, v74
    v_fmac_f32 v75, v21, v72
    v_fma_f32 v101, -v13, v99, v101
    v_mul_f32 v76, v20, v74
    v_mul_f32 v77, v20, v75
    v_fmac_f32 v102, v13, v96
    v_fma_f32 v76, -v21, v75, v76
    v_fmac_f32 v77, v21, v74
    v_fmac_f32 v103, v13, v97
    v_mul_f32 v78, v20, v76
    v_mul_f32 v79, v20, v77
    v_mul_f32 v104, v8, v36
    v_fma_f32 v78, -v21, v77, v78
    v_fmac_f32 v79, v21, v76
    v_mul_f32 v106, v8, v37
    v_mul_f32 v80, v20, v78
    v_mul_f32 v81, v20, v79
    v_fma_f32 v104, -v9, v37, v104
    v_fma_f32 v80, -v21, v79, v80
    v_fmac_f32 v81, v21, v78
    v_fmac_f32 v106, v9, v36
    v_mul_f32 v82, v20, v80
    v_mul_f32 v83, v20, v81
    v_mul_f32 v105, v14, v104
    v_fma_f32 v82, -v21, v81, v82
    v_fmac_f32 v83, v21, v80
    v_mul_f32 v107, v14, v106
    v_mul_f32 v84, v20, v82
    v_mul_f32 v85, v20, v83
    v_fma_f32 v105, -v15, v106, v105
    v_fma_f32 v84, -v21, v83, v84
    v_fmac_f32 v85, v21, v82
    v_fmac_f32 v107, v15, v104
    v_mul_f32 v86, v20, v84
    v_mul_f32 v87, v20, v85
    v_mul_f32 v108, v12, v104
    v_fma_f32 v86, -v21, v85, v86
    v_fmac_f32 v87, v21, v84
    v_mul_f32 v109, v12, v105
    v_mul_f32 v88, v20, v86
    v_mul_f32 v89, v20, v87
    v_mul_f32 v110, v12, v106
    v_fma_f32 v88, -v21, v87, v88
    v_fmac_f32 v89, v21, v86
    v_mul_f32 v111, v12, v107
    v_mul_f32 v90, v20, v88
    v_mul_f32 v91, v20, v89
    v_fma_f32 v108, -v13, v106, v108
    v_fma_f32 v90, -v21, v89, v90
    v_fmac_f32 v91, v21, v88
    v_fma_f32 v109, -v13, v107, v109
    v_mul_f32 v92, v20, v90
    v_mul_f32 v93, v20, v91
    v_fmac_f32 v110, v13, v104
    v_fma_f32 v92, -v21, v91, v92
    v_fmac_f32 v93, v21, v90
    v_fmac_f32 v111, v13, v105
    v_mul_f32 v94, v20, v92
    v_mul_f32 v95, v20, v93
    v_mul_f32 v112, v8, v96
    v_fma_f32 v94, -v21, v93, v94
    v_fmac_f32 v95, v21, v92
    v_mul_f32 v113, v8, v97
    v_mul_f32 v114, -v8, v98
    v_mul_f32 v115, -v8, v99
    v_fma_f32 v112, -v9, v98, v112
    v_fma_f32 v113, -v9, v99, v113
    v_fma_f32 v114, -v9, v96, v114
    v_fma_f32 v115, -v9, v97, v115
    v_mul_f32 v116, v8, v100
    v_mul_f32 v117, v8, v101
    v_mul_f32 v118, -v8, v102
    v_mul_f32 v119, -v8, v103
    v_fma_f32 v116, -v9, v102, v116
    v_fma_f32 v117, -v9, v103, v117
    v_fma_f32 v118, -v9, v100, v118
    v_fma_f32 v119, -v9, v101, v119
    s_lshl_b32 s13, s3, 13
    s_add_u32 s13, s13, 65536
    v_and_b32 v32, 1, v2
    v_and_b32 v33, 2, v2
    v_lshl_or_b32 v32, v33, 1, v32
    v_bfe_u32 v33, v2, 2, 1
    v_lshl_or_b32 v32, v33, 1, v32
    v_lshlrev_b32 v33, 2, v4
    v_xor_b32 v32, v32, v33
    v_lshlrev_b32 v32, 4, v32
    v_lshl_add_u32 v32, v3, 7, v32
    v_add_u32 v120, s13, v32
    v_xor_b32 v121, 16, v120
    v_xor_b32 v122, 32, v120
    v_xor_b32 v123, 48, v120
    v_bfe_u32 v32, v2, 2, 2
    v_lshl_add_u32 v33, v4, 3, v32
    v_lshlrev_b32 v33, 7, v33
    v_and_b32 v34, 1, v32
    v_and_b32 v32, 2, v32
    v_lshl_or_b32 v32, v32, 1, v34
    v_bfe_u32 v34, v2, 4, 1
    v_bfe_u32 v35, v2, 1, 1
    v_lshl_or_b32 v34, v34, 1, v35
    v_xor_b32 v32, v32, v34
    v_lshl_add_u32 v33, v32, 4, v33
    v_and_b32 v32, 1, v2
    v_lshl_add_u32 v33, v32, 3, v33
    v_add_u32 v124, s13, v33
    v_xor_b32 v125, 64, v124
    v_xor_b32 v126, 32, v124
    v_add_u32 v126, 512, v126
    v_xor_b32 v127, 64, v126
    v_lshrrev_b32 v40, 3, v2
    v_lshlrev_b32 v40, 1, v40
    s_lshl_b32 s10, s7, 6
    s_add_u32 s10, s10, s8
    v_add_u32 v40, s10, v40
    v_lshlrev_b32 v40, 11, v40
    v_lshrrev_b32 v41, 4, v2
    v_xor_b32 v41, v41, v2
    v_and_b32 v41, 7, v41
    v_lshl_add_u32 v44, v41, 4, v40
    v_xor_b32 v45, 64, v44
    v_add_u32 v45, 31744, v45
    v_add_u32 v46, 63488, v44
    v_add_u32 v47, 63488, v45
    s_lshl_b32 s16, s6, 2
    s_add_u32 s16, s16, s3
    s_lshl_b32 s16, s16, 17
    s_mov_b32 s17, s100
    s_lshl_b32 s22, s9, 13
    s_lshl_b32 s10, s8, 12
    s_add_u32 s22, s22, s10
    s_mov_b32 s15, 0
G_all16_w:
    ds_read_b128 v[48:51], v11 offset:0
    s_waitcnt lgkmcnt(0)
    v_min3_u32 v48, v48, v49, v50
    v_min_u32 v48, v48, v51
    v_cmp_gt_u32 vcc, 16, v48
    s_cbranch_vccz G_all16_ok
    s_add_u32 s15, s15, 1
    s_cmp_lt_u32 s15, 160000
    s_cbranch_scc1 G_all16_w
G_all16_ok:
    v_mov_b32 v36, 0
    v_mov_b32 v37, 0
    s_cmp_eq_u32 s12, 0
    s_cbranch_scc1 G_lbdone
    s_mov_b32 s14, -1
    s_mov_b32 s15, 0
G_lb:
    s_lshl_b32 s13, s12, 14
    s_sub_u32 s13, s13, 16384
    s_bitcmp1_b32 s14, 0
    s_cbranch_scc0 G_lbs0
    buffer_load_dwordx4 v[192:195], v25, s[64:67], s13 offen sc1
G_lbs0:
    s_sub_u32 s13, s13, 32768
    s_cbranch_scc1 G_lb1
    s_bitcmp1_b32 s14, 1
    s_cbranch_scc0 G_lbs1
    buffer_load_dwordx4 v[196:199], v25, s[64:67], s13 offen sc1
G_lbs1:
    s_sub_u32 s13, s13, 32768
    s_cbranch_scc1 G_lb1
    s_bitcmp1_b32 s14, 2
    s_cbranch_scc0 G_lbs2
    buffer_load_dwordx4 v[200:203], v25, s[64:67], s13 offen sc1
G_lbs2:
    s_sub_u32 s13, s13, 32768
    s_cbranch_scc1 G_lb1
    s_bitcmp1_b32 s14, 3
    s_cbranch_scc0 G_lbs3
    buffer_load_dwordx4 v[204:207], v25, s[64:67], s13 offen sc1
G_lbs3:
    s_sub_u32 s13, s13, 32768
    s_cbranch_scc1 G_lb1
    s_bitcmp1_b32 s14, 4
    s_cbranch_scc0 G_lbs4
    buffer_load_dwordx4 v[208:211], v25, s[64:67], s13 offen sc1
G_lbs4:
    s_sub_u32 s13, s13, 32768
    s_cbranch_scc1 G_lb1
    s_bitcmp1_b32 s14, 5
    s_cbranch_scc0 G_lbs5
    buffer_load_dwordx4 v[212:215], v25, s[64:67], s13 offen sc1
G_lbs5:
    s_sub_u32 s13, s13, 32768
    s_cbranch_scc1 G_lb1
    s_bitcmp1_b32 s14, 6
    s_cbranch_scc0 G_lbs6
    buffer_load_dwordx4 v[216:219], v25, s[64:67], s13 offen sc1
G_lbs6:
    s_sub_u32 s13, s13, 32768
    s_cbranch_scc1 G_lb1
    s_bitcmp1_b32 s14, 7
    s_cbranch_scc0 G_lbs7
    buffer_load_dwordx4 v[220:223], v25, s[64:67], s13 offen sc1
G_lbs7:
    s_sub_u32 s13, s13, 32768
    s_cbranch_scc1 G_lb1
    s_bitcmp1_b32 s14, 8
    s_cbranch_scc0 G_lbs8
    buffer_load_dwordx4 v[224:227], v25, s[64:67], s13 offen sc1
G_lbs8:
    s_sub_u32 s13, s13, 32768
    s_cbranch_scc1 G_lb1
    s_bitcmp1_b32 s14, 9
    s_cbranch_scc0 G_lbs9
    buffer_load_dwordx4 v[228:231], v25, s[64:67], s13 offen sc1
G_lbs9:
    s_sub_u32 s13, s13, 32768
    s_cbranch_scc1 G_lb1
    s_bitcmp1_b32 s14, 10
    s_cbranch_scc0 G_lbs10
    buffer_load_dwordx4 v[232:235], v25, s[64:67], s13 offen sc1
G_lbs10:
    s_sub_u32 s13, s13, 32768
    s_cbranch_scc1 G_lb1
    s_bitcmp1_b32 s14, 11
    s_cbranch_scc0 G_lbs11
    buffer_load_dwordx4 v[236:239], v25, s[64:67], s13 offen sc1
G_lbs11:
    s_sub_u32 s13, s13, 32768
    s_cbranch_scc1 G_lb1
    s_bitcmp1_b32 s14, 12
    s_cbranch_scc0 G_lbs12
    buffer_load_dwordx4 v[240:243], v25, s[64:67], s13 offen sc1
G_lbs12:
    s_sub_u32 s13, s13, 32768
    s_cbranch_scc1 G_lb1
    s_bitcmp1_b32 s14, 13
    s_cbranch_scc0 G_lbs13
    buffer_load_dwordx4 v[244:247], v25, s[64:67], s13 offen sc1
G_lbs13:
    s_sub_u32 s13, s13, 32768
    s_cbranch_scc1 G_lb1
    s_bitcmp1_b32 s14, 14
    s_cbranch_scc0 G_lbs14
    buffer_load_dwordx4 v[248:251], v25, s[64:67], s13 offen sc1
G_lbs14:
    s_sub_u32 s13, s13, 32768
    s_cbranch_scc1 G_lb1
    s_bitcmp1_b32 s14, 15
    s_cbranch_scc0 G_lbs15
    buffer_load_dwordx4 v[252:255], v25, s[64:67], s13 offen sc1
G_lbs15:
G_lb1:
    v_mov_b32 v36, 0
    v_mov_b32 v37, 0
    v_mov_b32 v38, 0
    v_mov_b32 v39, 0
    s_mov_b32 s14, 0
    s_sub_u32 s13, s12, 1
    s_waitcnt vmcnt(0)
    v_cmp_ne_u64 vcc, v[194:195], v[30:31]
    v_fmac_f32 v36, v64, v192
    v_fmac_f32 v37, v64, v193
    v_fma_f32 v38, -v65, v193, v38
    v_fmac_f32 v39, v65, v192
    s_cmp_lg_u64 vcc, 0
    s_cselect_b32 s10, 1, 0
    s_or_b32 s14, s14, s10
    s_sub_u32 s13, s13, 2
    s_cbranch_scc1 G_lb2
    v_cmp_ne_u64 vcc, v[198:199], v[30:31]
    v_fmac_f32 v36, v66, v196
    v_fmac_f32 v37, v66, v197
    v_fma_f32 v38, -v67, v197, v38
    v_fmac_f32 v39, v67, v196
    s_cmp_lg_u64 vcc, 0
    s_cselect_b32 s10, 2, 0
    s_or_b32 s14, s14, s10
    s_sub_u32 s13, s13, 2
    s_cbranch_scc1 G_lb2
    v_cmp_ne_u64 vcc, v[202:203], v[30:31]
    v_fmac_f32 v36, v68, v200
    v_fmac_f32 v37, v68, v201
    v_fma_f32 v38, -v69, v201, v38
    v_fmac_f32 v39, v69, v200
    s_cmp_lg_u64 vcc, 0
    s_cselect_b32 s10, 4, 0
    s_or_b32 s14, s14, s10
    s_sub_u32 s13, s13, 2
    s_cbranch_scc1 G_lb2
    v_cmp_ne_u64 vcc, v[206:207], v[30:31]
    v_fmac_f32 v36, v70, v204
    v_fmac_f32 v37, v70, v205
    v_fma_f32 v38, -v71, v205, v38
    v_fmac_f32 v39, v71, v204
    s_cmp_lg_u64 vcc, 0
    s_cselect_b32 s10, 8, 0
    s_or_b32 s14, s14, s10
    s_sub_u32 s13, s13, 2
    s_cbranch_scc1 G_lb2
    v_cmp_ne_u64 vcc, v[210:211], v[30:31]
    v_fmac_f32 v36, v72, v208
    v_fmac_f32 v37, v72, v209
    v_fma_f32 v38, -v73, v209, v38
    v_fmac_f32 v39, v73, v208
    s_cmp_lg_u64 vcc, 0
    s_cselect_b32 s10, 16, 0
    s_or_b32 s14, s14, s10
    s_sub_u32 s13, s13, 2
    s_cbranch_scc1 G_lb2
    v_cmp_ne_u64 vcc, v[214:215], v[30:31]
    v_fmac_f32 v36, v74, v212
    v_fmac_f32 v37, v74, v213
    v_fma_f32 v38, -v75, v213, v38
    v_fmac_f32 v39, v75, v212
    s_cmp_lg_u64 vcc, 0
    s_cselect_b32 s10, 32, 0
    s_or_b32 s14, s14, s10
    s_sub_u32 s13, s13, 2
    s_cbranch_scc1 G_lb2
    v_cmp_ne_u64 vcc, v[218:219], v[30:31]
    v_fmac_f32 v36, v76, v216
    v_fmac_f32 v37, v76, v217
    v_fma_f32 v38, -v77, v217, v38
    v_fmac_f32 v39, v77, v216
    s_cmp_lg_u64 vcc, 0
    s_cselect_b32 s10, 64, 0
    s_or_b32 s14, s14, s10
    s_sub_u32 s13, s13, 2
    s_cbranch_scc1 G_lb2
    v_cmp_ne_u64 vcc, v[222:223], v[30:31]
    v_fmac_f32 v36, v78, v220
    v_fmac_f32 v37, v78, v221
    v_fma_f32 v38, -v79, v221, v38
    v_fmac_f32 v39, v79, v220
    s_cmp_lg_u64 vcc, 0
    s_cselect_b32 s10, 128, 0
    s_or_b32 s14, s14, s10
    s_sub_u32 s13, s13, 2
    s_cbranch_scc1 G_lb2
    v_cmp_ne_u64 vcc, v[226:227], v[30:31]
    v_fmac_f32 v36, v80, v224
    v_fmac_f32 v37, v80, v225
    v_fma_f32 v38, -v81, v225, v38
    v_fmac_f32 v39, v81, v224
    s_cmp_lg_u64 vcc, 0
    s_cselect_b32 s10, 256, 0
    s_or_b32 s14, s14, s10
    s_sub_u32 s13, s13, 2
    s_cbranch_scc1 G_lb2
    v_cmp_ne_u64 vcc, v[230:231], v[30:31]
    v_fmac_f32 v36, v82, v228
    v_fmac_f32 v37, v82, v229
    v_fma_f32 v38, -v83, v229, v38
    v_fmac_f32 v39, v83, v228
    s_cmp_lg_u64 vcc, 0
    s_cselect_b32 s10, 512, 0
    s_or_b32 s14, s14, s10
    s_sub_u32 s13, s13, 2
    s_cbranch_scc1 G_lb2
    v_cmp_ne_u64 vcc, v[234:235], v[30:31]
    v_fmac_f32 v36, v84, v232
    v_fmac_f32 v37, v84, v233
    v_fma_f32 v38, -v85, v233, v38
    v_fmac_f32 v39, v85, v232
    s_cmp_lg_u64 vcc, 0
    s_cselect_b32 s10, 1024, 0
    s_or_b32 s14, s14, s10
    s_sub_u32 s13, s13, 2
    s_cbranch_scc1 G_lb2
    v_cmp_ne_u64 vcc, v[238:239], v[30:31]
    v_fmac_f32 v36, v86, v236
    v_fmac_f32 v37, v86, v237
    v_fma_f32 v38, -v87, v237, v38
    v_fmac_f32 v39, v87, v236
    s_cmp_lg_u64 vcc, 0
    s_cselect_b32 s10, 2048, 0
    s_or_b32 s14, s14, s10
    s_sub_u32 s13, s13, 2
    s_cbranch_scc1 G_lb2
    v_cmp_ne_u64 vcc, v[242:243], v[30:31]
    v_fmac_f32 v36, v88, v240
    v_fmac_f32 v37, v88, v241
    v_fma_f32 v38, -v89, v241, v38
    v_fmac_f32 v39, v89, v240
    s_cmp_lg_u64 vcc, 0
    s_cselect_b32 s10, 4096, 0
    s_or_b32 s14, s14, s10
    s_sub_u32 s13, s13, 2
    s_cbranch_scc1 G_lb2
    v_cmp_ne_u64 vcc, v[246:247], v[30:31]
    v_fmac_f32 v36, v90, v244
    v_fmac_f32 v37, v90, v245
    v_fma_f32 v38, -v91, v245, v38
    v_fmac_f32 v39, v91, v244
    s_cmp_lg_u64 vcc, 0
    s_cselect_b32 s10, 8192, 0
    s_or_b32 s14, s14, s10
    s_sub_u32 s13, s13, 2
    s_cbranch_scc1 G_lb2
    v_cmp_ne_u64 vcc, v[250:251], v[30:31]
    v_fmac_f32 v36, v92, v248
    v_fmac_f32 v37, v92, v249
    v_fma_f32 v38, -v93, v249, v38
    v_fmac_f32 v39, v93, v248
    s_cmp_lg_u64 vcc, 0
    s_cselect_b32 s10, 16384, 0
    s_or_b32 s14, s14, s10
    s_sub_u32 s13, s13, 2
    s_cbranch_scc1 G_lb2
    v_cmp_ne_u64 vcc, v[254:255], v[30:31]
    v_fmac_f32 v36, v94, v252
    v_fmac_f32 v37, v94, v253
    v_fma_f32 v38, -v95, v253, v38
    v_fmac_f32 v39, v95, v252
    s_cmp_lg_u64 vcc, 0
    s_cselect_b32 s10, 32768, 0
    s_or_b32 s14, s14, s10
G_lb2:
    s_cmp_eq_u32 s14, 0
    s_cbranch_scc1 G_lb3
    s_add_u32 s15, s15, 1
    s_cmp_lt_u32 s15, 20000
    s_cbranch_scc1 G_lb
G_lb3:
    v_add_f32 v36, v36, v38
    v_add_f32 v37, v37, v39
    v_mov_b32 v38, v36
    v_mov_b32 v39, v37
    s_nop 0
    v_permlane32_swap_b32 v36, v38
    v_permlane32_swap_b32 v37, v39
    v_add_f32 v36, v36, v38
    v_add_f32 v37, v37, v39
G_lbdone:
    v_fmac_f32 v112, v36, v104
    v_fmac_f32 v113, v36, v105
    v_fma_f32 v114, -v37, v104, v114
    v_fma_f32 v115, -v37, v105, v115
    v_fmac_f32 v116, v36, v108
    v_fmac_f32 v117, v36, v109
    v_fma_f32 v118, -v37, v108, v118
    v_fma_f32 v119, -v37, v109, v119
    v_fma_f32 v112, -v37, v106, v112
    v_fma_f32 v113, -v37, v107, v113
    v_fma_f32 v114, -v36, v106, v114
    v_fma_f32 v115, -v36, v107, v115
    v_fma_f32 v116, -v37, v110, v116
    v_fma_f32 v117, -v37, v111, v117
    v_fma_f32 v118, -v36, v110, v118
    v_fma_f32 v119, -v36, v111, v119
    v_fmac_f32 v128, v6, v112
    v_fmac_f32 v129, v6, v113
    v_fmac_f32 v144, v6, v114
    v_fmac_f32 v145, v6, v115
    v_fmac_f32 v160, v6, v116
    v_fmac_f32 v161, v6, v117
    v_fmac_f32 v176, v6, v118
    v_fmac_f32 v177, v6, v119
    v_fmac_f32 v128, v7, v114
    v_fmac_f32 v129, v7, v115
    v_fma_f32 v144, -v7, v112, v144
    v_fma_f32 v145, -v7, v113, v145
    v_fmac_f32 v160, v7, v118
    v_fmac_f32 v161, v7, v119
    v_fma_f32 v176, -v7, v116, v176
    v_fma_f32 v177, -v7, v117, v177
    v_fmac_f32 v130, v6, v128
    v_fmac_f32 v131, v6, v129
    v_fmac_f32 v146, v6, v144
    v_fmac_f32 v147, v6, v145
    v_fmac_f32 v162, v6, v160
    v_fmac_f32 v163, v6, v161
    v_fmac_f32 v178, v6, v176
    v_fmac_f32 v179, v6, v177
    v_fmac_f32 v130, v7, v144
    v_fmac_f32 v131, v7, v145
    v_fma_f32 v146, -v7, v128, v146
    v_fma_f32 v147, -v7, v129, v147
    v_fmac_f32 v162, v7, v176
    v_fmac_f32 v163, v7, v177
    v_fma_f32 v178, -v7, v160, v178
    v_fma_f32 v179, -v7, v161, v179
    v_fmac_f32 v132, v6, v130
    v_fmac_f32 v133, v6, v131
    v_fmac_f32 v148, v6, v146
    v_fmac_f32 v149, v6, v147
    v_fmac_f32 v164, v6, v162
    v_fmac_f32 v165, v6, v163
    v_fmac_f32 v180, v6, v178
    v_fmac_f32 v181, v6, v179
    v_fmac_f32 v132, v7, v146
    v_fmac_f32 v133, v7, v147
    v_fma_f32 v148, -v7, v130, v148
    v_fma_f32 v149, -v7, v131, v149
    v_fmac_f32 v164, v7, v178
    v_fmac_f32 v165, v7, v179
    v_fma_f32 v180, -v7, v162, v180
    v_fma_f32 v181, -v7, v163, v181
    v_fmac_f32 v134, v6, v132
    v_fmac_f32 v135, v6, v133
    v_fmac_f32 v150, v6, v148
    v_fmac_f32 v151, v6, v149
    v_fmac_f32 v166, v6, v164
    v_fmac_f32 v167, v6, v165
    v_fmac_f32 v182, v6, v180
    v_fmac_f32 v183, v6, v181
    v_fmac_f32 v134, v7, v148
    v_fmac_f32 v135, v7, v149
    v_fma_f32 v150, -v7, v132, v150
    v_fma_f32 v151, -v7, v133, v151
    v_fmac_f32 v166, v7, v180
    v_fmac_f32 v167, v7, v181
    v_fma_f32 v182, -v7, v164, v182
    v_fma_f32 v183, -v7, v165, v183
    v_fmac_f32 v136, v6, v134
    v_fmac_f32 v137, v6, v135
    v_fmac_f32 v152, v6, v150
    v_fmac_f32 v153, v6, v151
    v_fmac_f32 v168, v6, v166
    v_fmac_f32 v169, v6, v167
    v_fmac_f32 v184, v6, v182
    v_fmac_f32 v185, v6, v183
    v_fmac_f32 v136, v7, v150
    v_fmac_f32 v137, v7, v151
    v_fma_f32 v152, -v7, v134, v152
    v_fma_f32 v153, -v7, v135, v153
    v_fmac_f32 v168, v7, v182
    v_fmac_f32 v169, v7, v183
    v_fma_f32 v184, -v7, v166, v184
    v_fma_f32 v185, -v7, v167, v185
    v_fmac_f32 v138, v6, v136
    v_fmac_f32 v139, v6, v137
    v_fmac_f32 v154, v6, v152
    v_fmac_f32 v155, v6, v153
    v_fmac_f32 v170, v6, v168
    v_fmac_f32 v171, v6, v169
    v_fmac_f32 v186, v6, v184
    v_fmac_f32 v187, v6, v185
    v_fmac_f32 v138, v7, v152
    v_fmac_f32 v139, v7, v153
    v_fma_f32 v154, -v7, v136, v154
    v_fma_f32 v155, -v7, v137, v155
    v_fmac_f32 v170, v7, v184
    v_fmac_f32 v171, v7, v185
    v_fma_f32 v186, -v7, v168, v186
    v_fma_f32 v187, -v7, v169, v187
    v_fmac_f32 v140, v6, v138
    v_fmac_f32 v141, v6, v139
    v_fmac_f32 v156, v6, v154
    v_fmac_f32 v157, v6, v155
    v_fmac_f32 v172, v6, v170
    v_fmac_f32 v173, v6, v171
    v_fmac_f32 v188, v6, v186
    v_fmac_f32 v189, v6, v187
    v_fmac_f32 v140, v7, v154
    v_fmac_f32 v141, v7, v155
    v_fma_f32 v156, -v7, v138, v156
    v_fma_f32 v157, -v7, v139, v157
    v_fmac_f32 v172, v7, v186
    v_fmac_f32 v173, v7, v187
    v_fma_f32 v188, -v7, v170, v188
    v_fma_f32 v189, -v7, v171, v189
    v_fmac_f32 v142, v6, v140
    v_fmac_f32 v143, v6, v141
    v_fmac_f32 v158, v6, v156
    v_fmac_f32 v159, v6, v157
    v_fmac_f32 v174, v6, v172
    v_fmac_f32 v175, v6, v173
    v_fmac_f32 v190, v6, v188
    v_fmac_f32 v191, v6, v189
    v_fmac_f32 v142, v7, v156
    v_fmac_f32 v143, v7, v157
    v_fma_f32 v158, -v7, v140, v158
    v_fma_f32 v159, -v7, v141, v159
    v_fmac_f32 v174, v7, v188
    v_fmac_f32 v175, v7, v189
    v_fma_f32 v190, -v7, v172, v190
    v_fma_f32 v191, -v7, v173, v191
    v_cvt_pk_bf16_f32 v192, v128, v130
    v_cvt_pk_bf16_f32 v193, v132, v134
    v_cvt_pk_bf16_f32 v194, v136, v138
    v_cvt_pk_bf16_f32 v195, v140, v142
    ds_write_b128 v120, v[192:195] offset:0
    v_cvt_pk_bf16_f32 v196, v160, v162
    v_cvt_pk_bf16_f32 v197, v164, v166
    v_cvt_pk_bf16_f32 v198, v168, v170
    v_cvt_pk_bf16_f32 v199, v172, v174
    ds_write_b128 v121, v[196:199] offset:0
    v_cvt_pk_bf16_f32 v200, v129, v131
    v_cvt_pk_bf16_f32 v201, v133, v135
    v_cvt_pk_bf16_f32 v202, v137, v139
    v_cvt_pk_bf16_f32 v203, v141, v143
    ds_write_b128 v122, v[200:203] offset:0
    v_cvt_pk_bf16_f32 v204, v161, v163
    v_cvt_pk_bf16_f32 v205, v165, v167
    v_cvt_pk_bf16_f32 v206, v169, v171
    v_cvt_pk_bf16_f32 v207, v173, v175
    ds_write_b128 v123, v[204:207] offset:0
    v_cvt_pk_bf16_f32 v208, v144, v146
    v_cvt_pk_bf16_f32 v209, v148, v150
    v_cvt_pk_bf16_f32 v210, v152, v154
    v_cvt_pk_bf16_f32 v211, v156, v158
    ds_write_b128 v120, v[208:211] offset:4096
    v_cvt_pk_bf16_f32 v212, v176, v178
    v_cvt_pk_bf16_f32 v213, v180, v182
    v_cvt_pk_bf16_f32 v214, v184, v186
    v_cvt_pk_bf16_f32 v215, v188, v190
    ds_write_b128 v121, v[212:215] offset:4096
    v_cvt_pk_bf16_f32 v216, v145, v147
    v_cvt_pk_bf16_f32 v217, v149, v151
    v_cvt_pk_bf16_f32 v218, v153, v155
    v_cvt_pk_bf16_f32 v219, v157, v159
    ds_write_b128 v122, v[216:219] offset:4096
    v_cvt_pk_bf16_f32 v220, v177, v179
    v_cvt_pk_bf16_f32 v221, v181, v183
    v_cvt_pk_bf16_f32 v222, v185, v187
    v_cvt_pk_bf16_f32 v223, v189, v191
    ds_write_b128 v123, v[220:223] offset:4096
    s_lshl_b32 s10, s12, 18
    s_lshl_b32 s11, s7, 13
    s_add_u32 s10, s10, s11
    s_lshl_b32 s11, s9, 11
    s_add_u32 s10, s10, s11
    s_add_u32 s11, s10, 131072
    s_waitcnt lgkmcnt(0)
    ds_read_b64_tr_b16 v[224:225], v124 offset:0
    ds_read_b64_tr_b16 v[226:227], v126 offset:0
    ds_read_b64_tr_b16 v[228:229], v124 offset:2048
    ds_read_b64_tr_b16 v[230:231], v126 offset:2048
    ds_read_b64_tr_b16 v[232:233], v125 offset:0
    ds_read_b64_tr_b16 v[234:235], v127 offset:0
    ds_read_b64_tr_b16 v[236:237], v125 offset:2048
    ds_read_b64_tr_b16 v[238:239], v127 offset:2048
    ds_read_b64_tr_b16 v[240:241], v124 offset:4096
    ds_read_b64_tr_b16 v[242:243], v126 offset:4096
    ds_read_b64_tr_b16 v[244:245], v124 offset:6144
    ds_read_b64_tr_b16 v[246:247], v126 offset:6144
    ds_read_b64_tr_b16 v[248:249], v125 offset:4096
    ds_read_b64_tr_b16 v[250:251], v127 offset:4096
    ds_read_b64_tr_b16 v[252:253], v125 offset:6144
    ds_read_b64_tr_b16 v[254:255], v127 offset:6144
    s_waitcnt lgkmcnt(14)
    buffer_store_dwordx4 v[224:227], v26, s[68:71], s10 offen offset:0 sc1
    s_waitcnt lgkmcnt(12)
    buffer_store_dwordx4 v[228:231], v26, s[68:71], s10 offen offset:1024 sc1
    s_waitcnt lgkmcnt(10)
    buffer_store_dwordx4 v[232:235], v26, s[68:71], s11 offen offset:0 sc1
    s_waitcnt lgkmcnt(8)
    buffer_store_dwordx4 v[236:239], v26, s[68:71], s11 offen offset:1024 sc1
    s_waitcnt lgkmcnt(6)
    buffer_store_dwordx4 v[240:243], v27, s[68:71], s10 offen offset:0 sc1
    s_waitcnt lgkmcnt(4)
    buffer_store_dwordx4 v[244:247], v27, s[68:71], s10 offen offset:1024 sc1
    s_waitcnt lgkmcnt(2)
    buffer_store_dwordx4 v[248:251], v27, s[68:71], s11 offen offset:0 sc1
    s_waitcnt lgkmcnt(0)
    buffer_store_dwordx4 v[252:255], v27, s[68:71], s11 offen offset:1024 sc1
    v_lshrrev_b32 v34, 1, v3
    v_and_b32 v34, 7, v34
    v_xor_b32 v34, v34, v4
    v_lshlrev_b32 v34, 4, v34
    v_lshl_add_u32 v32, v3, 7, v34
    v_xor_b32 v33, 32, v32
    v_xor_b32 v34, 64, v32
    v_xor_b32 v35, 96, v32
    v_mov_b32 v36, v32
    v_mov_b32 v37, v33
    v_mov_b32 v38, v34
    v_mov_b32 v39, v35
    v_mov_b32 v52, 17
    s_lshl_b32 s10, s12, 8
    s_add_u32 s10, s10, 16384
    s_lshl_b32 s11, s7, 4
    s_lshl_b32 s13, s9, 3
    s_add_u32 s11, s11, s13
    s_add_u32 s11, s11, s10
    v_lshl_add_u32 v19, v3, 3, s10
    s_waitcnt vmcnt(0)
    s_mov_b64 exec, 1
    buffer_store_dwordx2 v[30:31], v23, s[72:75], s11 offen sc1
    s_mov_b64 exec, -1
    s_add_u32 s18, s17, 0
    s_and_b32 s18, s18, 15
    s_lshl_b32 s18, s18, 7
    s_add_u32 m0, s22, 0
    s_nop 0
    buffer_load_dwordx4 v44, s[80:83], s18 offen offset:0 lds
    buffer_load_dwordx4 v45, s[80:83], s18 offen offset:1024 lds
    buffer_load_dwordx4 v46, s[80:83], s18 offen offset:2048 lds
    buffer_load_dwordx4 v47, s[80:83], s18 offen offset:3072 lds
    s_add_u32 s18, s17, 1
    s_and_b32 s18, s18, 15
    s_lshl_b32 s18, s18, 7
    s_add_u32 m0, s22, 16384
    s_nop 0
    buffer_load_dwordx4 v44, s[80:83], s18 offen offset:0 lds
    buffer_load_dwordx4 v45, s[80:83], s18 offen offset:1024 lds
    buffer_load_dwordx4 v46, s[80:83], s18 offen offset:2048 lds
    buffer_load_dwordx4 v47, s[80:83], s18 offen offset:3072 lds
    s_add_u32 s18, s17, 2
    s_and_b32 s18, s18, 15
    s_lshl_b32 s18, s18, 7
    s_add_u32 m0, s22, 32768
    s_nop 0
    buffer_load_dwordx4 v44, s[80:83], s18 offen offset:0 lds
    buffer_load_dwordx4 v45, s[80:83], s18 offen offset:1024 lds
    buffer_load_dwordx4 v46, s[80:83], s18 offen offset:2048 lds
    buffer_load_dwordx4 v47, s[80:83], s18 offen offset:3072 lds
    s_add_u32 s18, s17, 3
    s_and_b32 s18, s18, 15
    s_lshl_b32 s18, s18, 7
    s_add_u32 m0, s22, 49152
    s_nop 0
    buffer_load_dwordx4 v44, s[80:83], s18 offen offset:0 lds
    buffer_load_dwordx4 v45, s[80:83], s18 offen offset:1024 lds
    buffer_load_dwordx4 v46, s[80:83], s18 offen offset:2048 lds
    buffer_load_dwordx4 v47, s[80:83], s18 offen offset:3072 lds
    s_mov_b32 s13, 0
    buffer_load_dword v224, v22, s[52:55], s13 offen offset:0
    buffer_load_dword v225, v22, s[52:55], s13 offen offset:2048
    s_mov_b32 s13, 4096
    buffer_load_dword v226, v22, s[52:55], s13 offen offset:0
    buffer_load_dword v227, v22, s[52:55], s13 offen offset:2048
    s_mov_b32 s13, 16384
    buffer_load_dword v228, v22, s[52:55], s13 offen offset:0
    buffer_load_dword v229, v22, s[52:55], s13 offen offset:2048
    s_mov_b32 s13, 20480
    buffer_load_dword v230, v22, s[52:55], s13 offen offset:0
    buffer_load_dword v231, v22, s[52:55], s13 offen offset:2048
    s_mov_b32 s13, 32768
    buffer_load_dword v232, v22, s[52:55], s13 offen offset:0
    buffer_load_dword v233, v22, s[52:55], s13 offen offset:2048
    s_mov_b32 s13, 36864
    buffer_load_dword v234, v22, s[52:55], s13 offen offset:0
    buffer_load_dword v235, v22, s[52:55], s13 offen offset:2048
    s_mov_b32 s13, 49152
    buffer_load_dword v236, v22, s[52:55], s13 offen offset:0
    buffer_load_dword v237, v22, s[52:55], s13 offen offset:2048
    s_mov_b32 s13, 53248
    buffer_load_dword v238, v22, s[52:55], s13 offen offset:0
    buffer_load_dword v239, v22, s[52:55], s13 offen offset:2048
    v_mov_b32 v64, 0
    v_mov_b32 v65, 0
    v_mov_b32 v66, 0
    v_mov_b32 v67, 0
    v_mov_b32 v68, 0
    v_mov_b32 v69, 0
    v_mov_b32 v70, 0
    v_mov_b32 v71, 0
    v_mov_b32 v72, 0
    v_mov_b32 v73, 0
    v_mov_b32 v74, 0
    v_mov_b32 v75, 0
    v_mov_b32 v76, 0
    v_mov_b32 v77, 0
    v_mov_b32 v78, 0
    v_mov_b32 v79, 0
    v_mov_b32 v80, 0
    v_mov_b32 v81, 0
    v_mov_b32 v82, 0
    v_mov_b32 v83, 0
    v_mov_b32 v84, 0
    v_mov_b32 v85, 0
    v_mov_b32 v86, 0
    v_mov_b32 v87, 0
    v_mov_b32 v88, 0
    v_mov_b32 v89, 0
    v_mov_b32 v90, 0
    v_mov_b32 v91, 0
    v_mov_b32 v92, 0
    v_mov_b32 v93, 0
    v_mov_b32 v94, 0
    v_mov_b32 v95, 0
    s_mov_b32 s15, 0
GH_poll:
    buffer_load_dwordx2 v[40:41], v19, s[72:75], 0 offen sc1
    s_waitcnt vmcnt(0)
    v_cmp_ne_u64 vcc, v[40:41], v[30:31]
    s_cbranch_vccz GH_ok
    s_add_u32 s15, s15, 1
    s_cmp_lt_u32 s15, 20000
    s_cbranch_scc1 GH_poll
GH_ok:
    ds_write_b32 v10, v52
    s_add_u32 s10, s17, 0
    s_and_b32 s10, s10, 15
    s_lshl_b32 s10, s10, 13
    s_add_u32 s19, s16, s10
    buffer_load_dword v19, v23, s[76:79], 0 offen offset:512
    buffer_load_dwordx4 v[128:131], v26, s[68:71], s19 offen offset:0 sc1
    buffer_load_dword v19, v23, s[76:79], 0 offen offset:512
    buffer_load_dwordx4 v[132:135], v26, s[68:71], s19 offen offset:1024 sc1
    buffer_load_dword v19, v23, s[76:79], 0 offen offset:512
    buffer_load_dwordx4 v[136:139], v26, s[68:71], s19 offen offset:2048 sc1
    buffer_load_dword v19, v23, s[76:79], 0 offen offset:512
    buffer_load_dwordx4 v[140:143], v26, s[68:71], s19 offen offset:3072 sc1
    buffer_load_dwordx4 v[144:147], v27, s[68:71], s19 offen offset:0 sc1
    buffer_load_dwordx4 v[148:151], v27, s[68:71], s19 offen offset:1024 sc1
    buffer_load_dwordx4 v[152:155], v27, s[68:71], s19 offen offset:2048 sc1
    buffer_load_dwordx4 v[156:159], v27, s[68:71], s19 offen offset:3072 sc1
    s_add_u32 s10, s17, 1
    s_and_b32 s10, s10, 15
    s_lshl_b32 s10, s10, 13
    s_add_u32 s19, s16, s10
    buffer_load_dword v19, v23, s[76:79], 0 offen offset:512
    buffer_load_dwordx4 v[160:163], v26, s[68:71], s19 offen offset:0 sc1
    buffer_load_dword v19, v23, s[76:79], 0 offen offset:512
    buffer_load_dwordx4 v[164:167], v26, s[68:71], s19 offen offset:1024 sc1
    buffer_load_dword v19, v23, s[76:79], 0 offen offset:512
    buffer_load_dwordx4 v[168:171], v26, s[68:71], s19 offen offset:2048 sc1
    buffer_load_dword v19, v23, s[76:79], 0 offen offset:512
    buffer_load_dwordx4 v[172:175], v26, s[68:71], s19 offen offset:3072 sc1
    buffer_load_dwordx4 v[176:179], v27, s[68:71], s19 offen offset:0 sc1
    buffer_load_dwordx4 v[180:183], v27, s[68:71], s19 offen offset:1024 sc1
    buffer_load_dwordx4 v[184:187], v27, s[68:71], s19 offen offset:2048 sc1
    buffer_load_dwordx4 v[188:191], v27, s[68:71], s19 offen offset:3072 sc1
    v_lshlrev_b32 v20, 16, v24
    v_and_b32 v21, 0xffff0000, v24
    v_lshlrev_b32 v96, 16, v224
    v_and_b32 v97, 0xffff0000, v224
    v_lshlrev_b32 v98, 16, v225
    v_and_b32 v99, 0xffff0000, v225
    v_lshlrev_b32 v100, 16, v226
    v_and_b32 v101, 0xffff0000, v226
    v_lshlrev_b32 v102, 16, v227
    v_and_b32 v103, 0xffff0000, v227
    v_lshlrev_b32 v104, 16, v228
    v_and_b32 v105, 0xffff0000, v228
    v_lshlrev_b32 v106, 16, v229
    v_and_b32 v107, 0xffff0000, v229
    v_lshlrev_b32 v108, 16, v230
    v_and_b32 v109, 0xffff0000, v230
    v_lshlrev_b32 v110, 16, v231
    v_and_b32 v111, 0xffff0000, v231
    v_lshlrev_b32 v112, 16, v232
    v_and_b32 v113, 0xffff0000, v232
    v_lshlrev_b32 v114, 16, v233
    v_and_b32 v115, 0xffff0000, v233
    v_lshlrev_b32 v116, 16, v234
    v_and_b32 v117, 0xffff0000, v234
    v_lshlrev_b32 v118, 16, v235
    v_and_b32 v119, 0xffff0000, v235
    v_lshlrev_b32 v120, 16, v236
    v_and_b32 v121, 0xffff0000, v236
    v_lshlrev_b32 v122, 16, v237
    v_and_b32 v123, 0xffff0000, v237
    v_lshlrev_b32 v124, 16, v238
    v_and_b32 v125, 0xffff0000, v238
    v_lshlrev_b32 v126, 16, v239
    v_and_b32 v127, 0xffff0000, v239
    v_mul_f32 v96, v96, v20
    v_mul_f32 v97, v97, v21
    v_mul_f32 v98, v98, v20
    v_mul_f32 v99, v99, v21
    v_mul_f32 v100, v100, v20
    v_mul_f32 v101, v101, v21
    v_mul_f32 v102, v102, v20
    v_mul_f32 v103, v103, v21
    v_mul_f32 v104, v104, v20
    v_mul_f32 v105, v105, v21
    v_mul_f32 v106, v106, v20
    v_mul_f32 v107, v107, v21
    v_mul_f32 v108, v108, v20
    v_mul_f32 v109, v109, v21
    v_mul_f32 v110, v110, v20
    v_mul_f32 v111, v111, v21
    v_mul_f32 v112, v112, v20
    v_mul_f32 v113, v113, v21
    v_mul_f32 v114, v114, v20
    v_mul_f32 v115, v115, v21
    v_mul_f32 v116, v116, v20
    v_mul_f32 v117, v117, v21
    v_mul_f32 v118, v118, v20
    v_mul_f32 v119, v119, v21
    v_mul_f32 v120, v120, v20
    v_mul_f32 v121, v121, v21
    v_mul_f32 v122, v122, v20
    v_mul_f32 v123, v123, v21
    v_mul_f32 v124, v124, v20
    v_mul_f32 v125, v125, v21
    v_mul_f32 v126, v126, v20
    v_mul_f32 v127, v127, v21
    s_mov_b32 s15, 0
G_f1_w:
    ds_read_b128 v[48:51], v11 offset:0
    s_waitcnt lgkmcnt(0)
    v_min3_u32 v48, v48, v49, v50
    v_min_u32 v48, v48, v51
    v_cmp_gt_u32 vcc, 17, v48
    s_cbranch_vccz G_f1_ok
    s_sleep 1
    s_add_u32 s15, s15, 1
    s_cmp_lt_u32 s15, 160000
    s_cbranch_scc1 G_f1_w
G_f1_ok:
    v_mov_b32 v49, v48
    v_mov_b32 v50, v48
    v_mov_b32 v51, v48
    ds_read_b128 v[192:195], v36 offset:0
    ds_read_b128 v[196:199], v36 offset:4096
    ds_read_b128 v[200:203], v37 offset:0
    ds_read_b128 v[204:207], v37 offset:4096
    s_setprio 1
    s_mov_b32 s23, 17
    s_mov_b32 s20, 65536
    s_mov_b32 s21, 16384
    s_add_u32 s17, s17, 2
G2_loop:
    s_waitcnt vmcnt(17) lgkmcnt(2)
    v_mfma_f32_32x32x16_bf16 v[64:79], v[128:131], v[192:195], v[64:79]
    v_min3_u32 v52, v48, v49, v50
    v_min_u32 v52, v52, v51
    v_cmp_gt_u32 vcc, s23, v52
    s_add_u32 s23, s23, 1
    s_cbranch_vccnz G2_slow0
G2_back0:
    s_and_b32 s10, s17, 15
    s_lshl_b32 s10, s10, 13
    s_add_u32 s19, s16, s10
    s_add_u32 s10, s17, 2
    s_and_b32 s10, s10, 15
    s_lshl_b32 s18, s10, 7
    s_add_u32 m0, s22, s20
    s_add_u32 s17, s17, 1
    v_mov_b32 v52, s23
    ds_write_b32 v10, v52
    ds_read_b128 v[208:211], v38 offset:0
    ds_read_b128 v[212:215], v38 offset:4096
    buffer_load_dwordx4 v44, s[80:83], s18 offen offset:0 lds
    v_mfma_f32_32x32x16_bf16 v[80:95], v[128:131], v[196:199], v[80:95]
    buffer_load_dwordx4 v[128:131], v26, s[68:71], s19 offen offset:0 sc1
    s_waitcnt vmcnt(22) lgkmcnt(3)
    v_mfma_f32_32x32x16_bf16 v[64:79], v[132:135], v[200:203], v[64:79]
    ds_read_b128 v[216:219], v39 offset:0
    ds_read_b128 v[220:223], v39 offset:4096
    buffer_load_dwordx4 v45, s[80:83], s18 offen offset:1024 lds
    v_mfma_f32_32x32x16_bf16 v[80:95], v[132:135], v[204:207], v[80:95]
    buffer_load_dwordx4 v[132:135], v26, s[68:71], s19 offen offset:1024 sc1
    s_waitcnt vmcnt(22) lgkmcnt(2)
    v_mfma_f32_32x32x16_bf16 v[64:79], v[136:139], v[208:211], v[64:79]
    ds_read_b128 v[192:195], v36 offset:8192
    ds_read_b128 v[196:199], v36 offset:12288
    buffer_load_dwordx4 v46, s[80:83], s18 offen offset:2048 lds
    v_mfma_f32_32x32x16_bf16 v[80:95], v[136:139], v[212:215], v[80:95]
    buffer_load_dwordx4 v[136:139], v26, s[68:71], s19 offen offset:2048 sc1
    s_waitcnt vmcnt(22) lgkmcnt(2)
    v_mfma_f32_32x32x16_bf16 v[64:79], v[140:143], v[216:219], v[64:79]
    ds_read_b128 v[200:203], v37 offset:8192
    ds_read_b128 v[204:207], v37 offset:12288
    buffer_load_dwordx4 v47, s[80:83], s18 offen offset:3072 lds
    v_mfma_f32_32x32x16_bf16 v[80:95], v[140:143], v[220:223], v[80:95]
    buffer_load_dwordx4 v[140:143], v26, s[68:71], s19 offen offset:3072 sc1
    s_waitcnt vmcnt(23) lgkmcnt(2)
    v_mfma_f32_32x32x16_bf16 v[64:79], v[144:147], v[192:195], v[64:79]
    v_add_u32 v40, s21, v32
    v_add_u32 v41, s21, v33
    v_add_u32 v42, s21, v34
    v_add_u32 v43, s21, v35
    s_add_u32 s21, s21, 16384
    s_cmp_eq_u32 s21, 98304
    s_cselect_b32 s21, 0, s21
    s_add_u32 s20, s20, 16384
    s_cmp_eq_u32 s20, 98304
    s_cselect_b32 s20, 0, s20
    ds_read_b128 v[208:211], v38 offset:8192
    ds_read_b128 v[212:215], v38 offset:12288
    v_mfma_f32_32x32x16_bf16 v[80:95], v[144:147], v[196:199], v[80:95]
    buffer_load_dwordx4 v[144:147], v27, s[68:71], s19 offen offset:0 sc1
    s_waitcnt vmcnt(23) lgkmcnt(2)
    v_mfma_f32_32x32x16_bf16 v[64:79], v[148:151], v[200:203], v[64:79]
    ds_read_b128 v[216:219], v39 offset:8192
    ds_read_b128 v[220:223], v39 offset:12288
    ds_read_b128 v[48:51], v11
    v_mfma_f32_32x32x16_bf16 v[80:95], v[148:151], v[204:207], v[80:95]
    buffer_load_dwordx4 v[148:151], v27, s[68:71], s19 offen offset:1024 sc1
    s_waitcnt vmcnt(23) lgkmcnt(3)
    v_mfma_f32_32x32x16_bf16 v[64:79], v[152:155], v[208:211], v[64:79]
    ds_read_b128 v[192:195], v40 offset:0
    ds_read_b128 v[196:199], v40 offset:4096
    v_mfma_f32_32x32x16_bf16 v[80:95], v[152:155], v[212:215], v[80:95]
    buffer_load_dwordx4 v[152:155], v27, s[68:71], s19 offen offset:2048 sc1
    s_waitcnt vmcnt(23) lgkmcnt(3)
    v_mfma_f32_32x32x16_bf16 v[64:79], v[156:159], v[216:219], v[64:79]
    ds_read_b128 v[200:203], v41 offset:0
    ds_read_b128 v[204:207], v41 offset:4096
    v_mfma_f32_32x32x16_bf16 v[80:95], v[156:159], v[220:223], v[80:95]
    buffer_load_dwordx4 v[156:159], v27, s[68:71], s19 offen offset:3072 sc1
    s_waitcnt vmcnt(17) lgkmcnt(2)
    v_mfma_f32_32x32x16_bf16 v[64:79], v[160:163], v[192:195], v[64:79]
    v_min3_u32 v52, v48, v49, v50
    v_min_u32 v52, v52, v51
    v_cmp_gt_u32 vcc, s23, v52
    s_add_u32 s23, s23, 1
    s_cbranch_vccnz G2_slow1
G2_back1:
    s_and_b32 s10, s17, 15
    s_lshl_b32 s10, s10, 13
    s_add_u32 s19, s16, s10
    s_add_u32 s10, s17, 2
    s_and_b32 s10, s10, 15
    s_lshl_b32 s18, s10, 7
    s_add_u32 m0, s22, s20
    s_add_u32 s17, s17, 1
    v_mov_b32 v52, s23
    ds_write_b32 v10, v52
    ds_read_b128 v[208:211], v42 offset:0
    ds_read_b128 v[212:215], v42 offset:4096
    buffer_load_dwordx4 v44, s[80:83], s18 offen offset:0 lds
    v_mfma_f32_32x32x16_bf16 v[80:95], v[160:163], v[196:199], v[80:95]
    buffer_load_dwordx4 v[160:163], v26, s[68:71], s19 offen offset:0 sc1
    s_waitcnt vmcnt(22) lgkmcnt(3)
    v_mfma_f32_32x32x16_bf16 v[64:79], v[164:167], v[200:203], v[64:79]
    ds_read_b128 v[216:219], v43 offset:0
    ds_read_b128 v[220:223], v43 offset:4096
    buffer_load_dwordx4 v45, s[80:83], s18 offen offset:1024 lds
    v_mfma_f32_32x32x16_bf16 v[80:95], v[164:167], v[204:207], v[80:95]
    buffer_load_dwordx4 v[164:167], v26, s[68:71], s19 offen offset:1024 sc1
    s_waitcnt vmcnt(22) lgkmcnt(2)
    v_mfma_f32_32x32x16_bf16 v[64:79], v[168:171], v[208:211], v[64:79]
    ds_read_b128 v[192:195], v40 offset:8192
    ds_read_b128 v[196:199], v40 offset:12288
    buffer_load_dwordx4 v46, s[80:83], s18 offen offset:2048 lds
    v_mfma_f32_32x32x16_bf16 v[80:95], v[168:171], v[212:215], v[80:95]
    buffer_load_dwordx4 v[168:171], v26, s[68:71], s19 offen offset:2048 sc1
    s_waitcnt vmcnt(22) lgkmcnt(2)
    v_mfma_f32_32x32x16_bf16 v[64:79], v[172:175], v[216:219], v[64:79]
    ds_read_b128 v[200:203], v41 offset:8192
    ds_read_b128 v[204:207], v41 offset:12288
    buffer_load_dwordx4 v47, s[80:83], s18 offen offset:3072 lds
    v_mfma_f32_32x32x16_bf16 v[80:95], v[172:175], v[220:223], v[80:95]
    buffer_load_dwordx4 v[172:175], v26, s[68:71], s19 offen offset:3072 sc1
    s_waitcnt vmcnt(23) lgkmcnt(2)
    v_mfma_f32_32x32x16_bf16 v[64:79], v[176:179], v[192:195], v[64:79]
    v_add_u32 v36, s21, v32
    v_add_u32 v37, s21, v33
    v_add_u32 v38, s21, v34
    v_add_u32 v39, s21, v35
    s_add_u32 s21, s21, 16384
    s_cmp_eq_u32 s21, 98304
    s_cselect_b32 s21, 0, s21
    s_add_u32 s20, s20, 16384
    s_cmp_eq_u32 s20, 98304
    s_cselect_b32 s20, 0, s20
    ds_read_b128 v[208:211], v42 offset:8192
    ds_read_b128 v[212:215], v42 offset:12288
    v_mfma_f32_32x32x16_bf16 v[80:95], v[176:179], v[196:199], v[80:95]
    buffer_load_dwordx4 v[176:179], v27, s[68:71], s19 offen offset:0 sc1
    s_waitcnt vmcnt(23) lgkmcnt(2)
    v_mfma_f32_32x32x16_bf16 v[64:79], v[180:183], v[200:203], v[64:79]
    ds_read_b128 v[216:219], v43 offset:8192
    ds_read_b128 v[220:223], v43 offset:12288
    ds_read_b128 v[48:51], v11
    v_mfma_f32_32x32x16_bf16 v[80:95], v[180:183], v[204:207], v[80:95]
    buffer_load_dwordx4 v[180:183], v27, s[68:71], s19 offen offset:1024 sc1
    s_waitcnt vmcnt(23) lgkmcnt(3)
    v_mfma_f32_32x32x16_bf16 v[64:79], v[184:187], v[208:211], v[64:79]
    ds_read_b128 v[192:195], v36 offset:0
    ds_read_b128 v[196:199], v36 offset:4096
    v_mfma_f32_32x32x16_bf16 v[80:95], v[184:187], v[212:215], v[80:95]
    buffer_load_dwordx4 v[184:187], v27, s[68:71], s19 offen offset:2048 sc1
    s_waitcnt vmcnt(23) lgkmcnt(3)
    v_mfma_f32_32x32x16_bf16 v[64:79], v[188:191], v[216:219], v[64:79]
    ds_read_b128 v[200:203], v37 offset:0
    ds_read_b128 v[204:207], v37 offset:4096
    v_mfma_f32_32x32x16_bf16 v[80:95], v[188:191], v[220:223], v[80:95]
    buffer_load_dwordx4 v[188:191], v27, s[68:71], s19 offen offset:3072 sc1
    s_cmp_ge_u32 s23, 29
    s_cselect_b32 s82, 0, s82
    s_cmp_ge_u32 s23, 31
    s_cselect_b32 s70, 0, s70
    s_cmp_lt_u32 s23, 33
    s_cbranch_scc1 G2_loop
    s_lshl_b32 s10, s6, 7
    s_lshl_b32 s11, s3, 5
    s_add_u32 s10, s10, s11
    v_lshl_add_u32 v32, v4, 2, s10
    v_lshlrev_b32 v32, 13, v32
    s_lshl_b32 s10, s7, 8
    s_add_u32 s10, s10, 4096
    v_lshl_add_u32 v33, v3, 3, s10
    v_add_u32 v32, v32, v33
    v_add_f32 v96, v96, v64
    v_add_f32 v97, v97, v80
    s_mov_b32 s10, 0
    buffer_store_dwordx2 v[96:97], v32, s[60:63], s10 offen
    v_add_f32 v98, v98, v65
    v_add_f32 v99, v99, v81
    s_mov_b32 s10, 8192
    buffer_store_dwordx2 v[98:99], v32, s[60:63], s10 offen
    v_add_f32 v100, v100, v66
    v_add_f32 v101, v101, v82
    s_mov_b32 s10, 16384
    buffer_store_dwordx2 v[100:101], v32, s[60:63], s10 offen
    v_add_f32 v102, v102, v67
    v_add_f32 v103, v103, v83
    s_mov_b32 s10, 24576
    buffer_store_dwordx2 v[102:103], v32, s[60:63], s10 offen
    v_add_f32 v104, v104, v68
    v_add_f32 v105, v105, v84
    s_mov_b32 s10, 65536
    buffer_store_dwordx2 v[104:105], v32, s[60:63], s10 offen
    v_add_f32 v106, v106, v69
    v_add_f32 v107, v107, v85
    s_mov_b32 s10, 73728
    buffer_store_dwordx2 v[106:107], v32, s[60:63], s10 offen
    v_add_f32 v108, v108, v70
    v_add_f32 v109, v109, v86
    s_mov_b32 s10, 81920
    buffer_store_dwordx2 v[108:109], v32, s[60:63], s10 offen
    v_add_f32 v110, v110, v71
    v_add_f32 v111, v111, v87
    s_mov_b32 s10, 90112
    buffer_store_dwordx2 v[110:111], v32, s[60:63], s10 offen
    v_add_f32 v112, v112, v72
    v_add_f32 v113, v113, v88
    s_mov_b32 s10, 131072
    buffer_store_dwordx2 v[112:113], v32, s[60:63], s10 offen
    v_add_f32 v114, v114, v73
    v_add_f32 v115, v115, v89
    s_mov_b32 s10, 139264
    buffer_store_dwordx2 v[114:115], v32, s[60:63], s10 offen
    v_add_f32 v116, v116, v74
    v_add_f32 v117, v117, v90
    s_mov_b32 s10, 147456
    buffer_store_dwordx2 v[116:117], v32, s[60:63], s10 offen
    v_add_f32 v118, v118, v75
    v_add_f32 v119, v119, v91
    s_mov_b32 s10, 155648
    buffer_store_dwordx2 v[118:119], v32, s[60:63], s10 offen
    v_add_f32 v120, v120, v76
    v_add_f32 v121, v121, v92
    s_mov_b32 s10, 196608
    buffer_store_dwordx2 v[120:121], v32, s[60:63], s10 offen
    v_add_f32 v122, v122, v77
    v_add_f32 v123, v123, v93
    s_mov_b32 s10, 204800
    buffer_store_dwordx2 v[122:123], v32, s[60:63], s10 offen
    v_add_f32 v124, v124, v78
    v_add_f32 v125, v125, v94
    s_mov_b32 s10, 212992
    buffer_store_dwordx2 v[124:125], v32, s[60:63], s10 offen
    v_add_f32 v126, v126, v79
    v_add_f32 v127, v127, v95
    s_mov_b32 s10, 221184
    buffer_store_dwordx2 v[126:127], v32, s[60:63], s10 offen
    s_waitcnt vmcnt(0) lgkmcnt(0)
    s_endpgm
G2_slow0:
    s_sub_u32 s10, s23, 1
    s_mov_b32 s15, 0
G2_sl0_w:
    ds_read_b128 v[48:51], v11 offset:0
    s_waitcnt lgkmcnt(0)
    v_min3_u32 v48, v48, v49, v50
    v_min_u32 v48, v48, v51
    v_cmp_gt_u32 vcc, s10, v48
    s_cbranch_vccz G2_sl0_ok
    s_add_u32 s15, s15, 1
    s_cmp_lt_u32 s15, 160000
    s_cbranch_scc1 G2_sl0_w
G2_sl0_ok:
    s_branch G2_back0
G2_slow1:
    s_sub_u32 s10, s23, 1
    s_mov_b32 s15, 0
G2_sl1_w:
    ds_read_b128 v[48:51], v11 offset:0
    s_waitcnt lgkmcnt(0)
    v_min3_u32 v48, v48, v49, v50
    v_min_u32 v48, v48, v51
    v_cmp_gt_u32 vcc, s10, v48
    s_cbranch_vccz G2_sl1_ok
    s_add_u32 s15, s15, 1
    s_cmp_lt_u32 s15, 160000
    s_cbranch_scc1 G2_sl1_w
G2_sl1_ok:
    s_branch G2_back1
Y_done:
    s_endpgm
.section .rodata,"a"
.p2align 6
.amdhsa_kernel concat_heads__ssm_conv_h3__ssm_conv_s5__prompt_kernel
  .amdhsa_next_free_vgpr 256
  .amdhsa_next_free_sgpr 102
  .amdhsa_accum_offset 256
  .amdhsa_group_segment_fixed_size 0
  .amdhsa_kernarg_size 144
  .amdhsa_user_sgpr_count 2
  .amdhsa_user_sgpr_kernarg_segment_ptr 1
  .amdhsa_system_sgpr_workgroup_id_x 1
.end_amdhsa_kernel
```

```asm
; @launch grid=(256,1,1) block=(512,1,1) lds=163840
.amdgcn_target "amdgcn-amd-amdhsa--gfx950"
.text
.globl concat_heads__ssm_conv_h3__ssm_conv_s5__prompt_kernel
.p2align 8
.type concat_heads__ssm_conv_h3__ssm_conv_s5__prompt_kernel,@function
concat_heads__ssm_conv_h3__ssm_conv_s5__prompt_kernel:
    s_cmp_ge_u32 s2, 256
    s_cbranch_scc1 Y_done
    s_load_dwordx16 s[16:31], s[0:1], 0
    s_load_dwordx16 s[32:47], s[0:1], 64
    s_load_dwordx4 s[48:51], s[0:1], 128
    s_getpc_b64 s[52:53]
Y_pc:
    v_lshrrev_b32 v1, 6, v0
    v_and_b32 v2, 63, v0
    s_and_b32 s4, s2, 7
    v_readfirstlane_b32 s3, v1
    s_lshr_b32 s5, s2, 3
    s_and_b32 s6, s4, 3
    s_lshl_b32 s6, s6, 2
    s_and_b32 s7, s5, 3
    s_add_u32 s6, s6, s7
    s_and_b32 s7, s4, 4
    s_lshl_b32 s7, s7, 1
    s_lshr_b32 s8, s5, 2
    s_add_u32 s7, s7, s8
    s_lshl_b32 s54, s5, 3
    s_add_u32 s54, s54, s3
    s_lshl_b32 s54, s54, 6
    s_load_dword s56, s[52:53], s54
    s_add_u32 s54, s54, 16384
    s_min_u32 s54, s54, Y_end-Y_pc-4
    s_load_dword s57, s[52:53], s54
    s_and_b32 s9, s5, 3
    s_add_u32 s13, s8, s9
    s_lshl_b32 s13, s13, 2
    s_and_b32 s9, s4, 3
    s_add_u32 s13, s13, s9
    s_lshr_b32 s9, s4, 2
    s_lshl_b32 s9, s9, 1
    s_add_u32 s13, s13, s9
    s_lshl_b32 s13, s13, 1
    s_and_b32 s13, s13, 15
    s_add_u32 s12, s5, s4
    s_lshr_b32 s9, s4, 2
    s_lshl_b32 s9, s9, 1
    s_add_u32 s12, s12, s9
    s_lshl_b32 s12, s12, 2
    s_and_b32 s12, s12, 15
    s_lshl_b32 s13, s13, 7
    s_mov_b32 s100, 0x76543210
    s_mov_b32 s101, 0xfedcba98
    s_lshl_b32 s9, s12, 2
    s_lshr_b64 s[10:11], s[100:101], s9
    s_sub_u32 s9, 64, s9
    s_lshl_b64 s[100:101], s[100:101], s9
    s_or_b64 s[100:101], s[100:101], s[10:11]
    s_sub_u32 s9, s7, s12
    s_and_b32 s9, s9, 15
    s_lshl_b32 s9, s9, 2
    s_bfm_b64 s[10:11], s9, 0
    s_and_b64 s[14:15], s[100:101], s[10:11]
    s_lshl_b64 s[14:15], s[14:15], 4
    s_lshl_b64 s[10:11], s[10:11], 4
    s_or_b32 s10, s10, 15
    s_andn2_b64 s[100:101], s[100:101], s[10:11]
    s_or_b64 s[100:101], s[100:101], s[14:15]
    s_or_b32 s100, s100, s7
    s_cmp_lt_u32 s3, 4
    s_cbranch_scc0 Y_L
    v_and_b32 v3, 31, v2
    v_mov_b32 v23, 0
    v_mov_b32 v11, 163712
    v_lshl_add_u32 v48, v3, 2, v11
    ds_write_b32 v48, v23
    s_waitcnt lgkmcnt(0)
    s_barrier
    s_branch Y_G
Y_L:
    s_setprio 2
    s_sub_u32 s8, s3, 4
    s_lshr_b32 s11, s8, 1
    s_and_b32 s9, s8, 1
    s_cmp_eq_u32 s11, 1
    s_cbranch_scc1 L_ns0
    s_lshl_b32 s10, s6, 7
    s_lshl_b32 s12, s9, 6
    s_add_u32 s10, s10, s12
    v_and_b32 v24, 32, v2
    v_bfe_u32 v25, v2, 3, 1
    v_lshl_add_u32 v24, v25, 4, v24
    v_bfe_u32 v25, v2, 4, 1
    v_add_u32 v24, v24, v25
    v_add_u32 v24, s10, v24
    v_lshlrev_b32 v24, 11, v24
    v_lshrrev_b32 v25, 4, v2
    v_xor_b32 v25, v25, v2
    v_and_b32 v25, 7, v25
    v_lshl_add_u32 v4, v25, 4, v24
    v_xor_b32 v5, 64, v4
    v_add_u32 v5, 3072, v5
    v_add_u32 v6, 6144, v4
    v_add_u32 v7, 6144, v5
    s_lshl_b32 s10, s7, 6
    v_lshrrev_b32 v24, 3, v2
    s_lshl_b32 s12, s9, 5
    s_add_u32 s10, s10, s12
    v_add_u32 v24, s10, v24
    v_lshlrev_b32 v24, 11, v24
    v_lshrrev_b32 v25, 4, v2
    v_xor_b32 v25, v25, v2
    v_and_b32 v25, 7, v25
    v_lshl_add_u32 v8, v25, 4, v24
    v_xor_b32 v9, 64, v8
    v_add_u32 v9, 15360, v9
    v_add_u32 v10, 30720, v8
    v_add_u32 v11, 30720, v9
    s_lshl_b32 s14, s8, 13
    s_waitcnt lgkmcnt(0)
    s_mov_b32 s52, s28
    s_mov_b32 s53, s29
    s_mov_b32 s54, 4194304
    s_mov_b32 s55, 0x00020000
    s_mov_b32 s56, s34
    s_mov_b32 s57, s35
    s_mov_b32 s58, 2097152
    s_mov_b32 s59, 0x00020000
    s_mov_b32 s60, s36
    s_mov_b32 s61, s37
    s_mov_b32 s62, 2097152
    s_mov_b32 s63, 0x00020000
    s_add_u32 m0, s14, 0
    s_nop 0
    buffer_load_dwordx4 v4, s[52:55], s13 offen offset:0 lds
    buffer_load_dwordx4 v5, s[52:55], s13 offen offset:1024 lds
    buffer_load_dwordx4 v6, s[52:55], s13 offen offset:2048 lds
    buffer_load_dwordx4 v7, s[52:55], s13 offen offset:3072 lds
    s_add_u32 m0, s14, 16384
    s_nop 0
    buffer_load_dwordx4 v8, s[56:59], s13 offen offset:0 lds
    buffer_load_dwordx4 v9, s[56:59], s13 offen offset:1024 lds
    buffer_load_dwordx4 v10, s[56:59], s13 offen offset:2048 lds
    buffer_load_dwordx4 v11, s[56:59], s13 offen offset:3072 lds
    s_add_u32 m0, s14, 4096
    s_add_u32 s12, s13, 16384
    buffer_load_dwordx4 v4, s[52:55], s12 offen offset:0 lds
    buffer_load_dwordx4 v5, s[52:55], s12 offen offset:1024 lds
    buffer_load_dwordx4 v6, s[52:55], s12 offen offset:2048 lds
    buffer_load_dwordx4 v7, s[52:55], s12 offen offset:3072 lds
    s_add_u32 m0, s14, 20480
    s_nop 0
    buffer_load_dwordx4 v8, s[60:63], s13 offen offset:0 lds
    buffer_load_dwordx4 v9, s[60:63], s13 offen offset:1024 lds
    buffer_load_dwordx4 v10, s[60:63], s13 offen offset:2048 lds
    buffer_load_dwordx4 v11, s[60:63], s13 offen offset:3072 lds
    s_add_u32 s13, s13, 128
    s_and_b32 s13, s13, 2047
    s_add_u32 s14, s14, 32768
    s_and_b32 s14, s14, 131071
L_ns0:
    s_waitcnt lgkmcnt(0)
    s_barrier
    v_mov_b32 v19, 0
    s_lshl_b32 s10, s3, 2
    s_add_u32 s10, s10, 163712
    v_mov_b32 v22, s10
    v_mov_b32 v21, 163712
    s_add_u32 s72, s50, 17825792
    s_addc_u32 s73, s51, 0
    s_mov_b32 s74, 24576
    s_mov_b32 s75, 0x00020000
    s_mov_b32 s76, s48
    s_mov_b32 s77, s49
    s_mov_b32 s78, 256
    s_mov_b32 s79, 0x00020000
    s_mov_b32 s37, s100
    s_mov_b32 s30, s101
    s_lshl_b32 s100, s4, 7
    s_lshl_b32 s10, s5, 2
    s_add_u32 s100, s100, s10
    s_add_u32 s100, s100, s8
    s_lshr_b32 s10, s100, 1
    s_lshl_b32 s10, s10, 2
    s_load_dword s31, s[26:27], s10
    s_mul_i32 s101, s8, 12928
    s_add_u32 s101, s101, 98304
    s_lshl_b32 s10, s7, 5
    s_add_u32 s10, s10, s11
    s_lshl_b32 s10, s10, 12
    v_lshrrev_b32 v24, 3, v2
    v_lshl_add_u32 v24, v24, 13, s10
    v_lshrrev_b32 v25, 4, v2
    v_xor_b32 v25, v25, v2
    v_and_b32 v25, 7, v25
    v_lshl_add_u32 v12, v25, 4, v24
    v_xor_b32 v13, 64, v12
    v_add_u32 v13, 64512, v13
    s_cmp_eq_u32 s9, 1
    s_cselect_b32 s80, s40, s38
    s_cselect_b32 s81, s41, s39
    s_mov_b32 s82, 2097152
    s_mov_b32 s83, 0x00020000
    s_mov_b32 s68, s24
    s_mov_b32 s69, s25
    s_mov_b32 s70, 4194304
    s_mov_b32 s71, 0x00020000
    s_movk_i32 s32, 4096
    s_movk_i32 s33, 8192
    s_movk_i32 s34, 12288
    s_lshl_b32 s10, s5, 6
    v_and_b32 v23, 56, v2
    v_add_u32 v23, s10, v23
    v_lshlrev_b32 v26, 4, v2
    s_lshl_b32 s36, s100, 12
    s_lshl_b32 s10, s4, 1
    s_lshr_b32 s12, s5, 4
    s_add_u32 s10, s10, s12
    s_lshl_b32 s10, s10, 8
    v_and_b32 v60, 31, v2
    v_lshl_add_u32 v20, v60, 3, s10
    s_lshl_b32 s10, s4, 7
    s_lshl_b32 s12, s8, 5
    s_add_u32 s35, s10, s12
    v_and_b32 v25, 7, v2
    v_lshl_add_u32 v24, v25, 2, s35
    v_lshlrev_b32 v25, 1, v24
    v_lshl_add_u32 v16, v23, 11, v25
    v_add_u32 v60, 12416, v26
    v_and_b32 v61, 16, v26
    v_and_b32 v62, 32, v26
    v_mul_u32_u24 v62, 130, v62
    v_add_u32 v61, v61, v62
    v_cmp_gt_u32 vcc, 32, v2
    s_nop 1
    v_cndmask_b32 v60, v61, v60, vcc
    v_add_u32 v18, s101, v60
    s_lshl_b32 s10, s4, 10
    s_add_u32 s10, s10, 8192
    v_add_u32 v3, s10, v26
    v_and_b32 v17, 15, v2
    v_lshrrev_b32 v27, 4, v2
    v_lshlrev_b32 v60, 1, v17
    v_lshlrev_b32 v61, 4, v27
    v_sub_u32 v60, v60, v61
    v_and_b32 v62, 1, v17
    v_mov_b32 v63, 4212
    v_cmp_eq_u32 vcc, 1, v62
    s_nop 1
    v_cndmask_b32 v63, v63, 50, vcc
    v_add3_u32 v28, v60, v63, s101
    v_add_u32 v29, 1024, v28
    v_add_u32 v30, 2048, v28
    v_add_u32 v31, 3072, v28
    v_lshl_add_u32 v60, v17, 5, v61
    s_add_u32 s10, s101, 8848
    v_sub_u32 v32, s10, v60
    s_add_u32 s10, s101, 8320
    v_add_u32 v33, s10, v26
    s_cmp_eq_u32 s11, 1
    s_cbranch_scc1 L_idle
    s_mov_b32 s29, 1
    v_mov_b32 v25, 1
    s_branch L_free
L_loop:
    s_sub_i32 s28, s29, 3
    s_max_i32 s28, s28, 0
    s_waitcnt lgkmcnt(0)
    v_min3_u32 v60, v60, v61, v62
    v_min_u32 v60, v60, v63
    v_mov_b32 v25, s29
    v_cmp_gt_u32 vcc, s28, v60
    s_cbranch_vccz L_free
    s_mov_b32 s15, 0
L_slot_w:
    ds_read_b128 v[60:63], v21 offset:0
    s_waitcnt lgkmcnt(0)
    v_min3_u32 v60, v60, v61, v62
    v_min_u32 v60, v60, v63
    v_cmp_gt_u32 vcc, s28, v60
    s_cbranch_vccz L_slot_ok
    s_sleep 1
    s_add_u32 s15, s15, 1
    s_cmp_lt_u32 s15, 160000
    s_cbranch_scc1 L_slot_w
L_slot_ok:
L_free:
    s_cmp_ge_u32 s29, 8
    s_cbranch_scc1 L_sh
    s_add_u32 m0, s14, 0
    s_waitcnt vmcnt(15)
    buffer_load_dwordx4 v4, s[52:55], s13 offen offset:0 lds
    s_waitcnt vmcnt(15)
    buffer_load_dwordx4 v5, s[52:55], s13 offen offset:1024 lds
    s_waitcnt vmcnt(15)
    buffer_load_dwordx4 v6, s[52:55], s13 offen offset:2048 lds
    s_waitcnt vmcnt(15)
    buffer_load_dwordx4 v7, s[52:55], s13 offen offset:3072 lds
    s_add_u32 m0, s14, 16384
    s_waitcnt vmcnt(15)
    buffer_load_dwordx4 v8, s[56:59], s13 offen offset:0 lds
    s_waitcnt vmcnt(15)
    buffer_load_dwordx4 v9, s[56:59], s13 offen offset:1024 lds
    s_waitcnt vmcnt(15)
    buffer_load_dwordx4 v10, s[56:59], s13 offen offset:2048 lds
    s_waitcnt vmcnt(15)
    buffer_load_dwordx4 v11, s[56:59], s13 offen offset:3072 lds
    s_add_u32 m0, s14, 4096
    s_add_u32 s12, s13, 16384
    s_waitcnt vmcnt(15)
    buffer_load_dwordx4 v4, s[52:55], s12 offen offset:0 lds
    s_waitcnt vmcnt(15)
    buffer_load_dwordx4 v5, s[52:55], s12 offen offset:1024 lds
    s_waitcnt vmcnt(15)
    buffer_load_dwordx4 v6, s[52:55], s12 offen offset:2048 lds
    s_waitcnt vmcnt(15)
    buffer_load_dwordx4 v7, s[52:55], s12 offen offset:3072 lds
    ds_read_b128 v[60:63], v21
    s_add_u32 m0, s14, 20480
    s_waitcnt vmcnt(15)
    buffer_load_dwordx4 v8, s[60:63], s13 offen offset:0 lds
    s_waitcnt vmcnt(15)
    buffer_load_dwordx4 v9, s[60:63], s13 offen offset:1024 lds
    s_waitcnt vmcnt(15)
    buffer_load_dwordx4 v10, s[60:63], s13 offen offset:2048 lds
    s_waitcnt vmcnt(15)
    ds_write_b32 v22, v25
    buffer_load_dwordx4 v11, s[60:63], s13 offen offset:3072 lds
    s_add_u32 s13, s13, 128
    s_and_b32 s13, s13, 2047
    s_add_u32 s14, s14, 32768
    s_and_b32 s14, s14, 131071
    s_add_u32 s29, s29, 1
    s_branch L_loop
L_sh:
    s_add_u32 m0, s14, 0
    s_waitcnt vmcnt(7)
    buffer_load_dwordx4 v4, s[52:55], s13 offen offset:0 lds
    s_waitcnt vmcnt(7)
    buffer_load_dwordx4 v5, s[52:55], s13 offen offset:1024 lds
    s_waitcnt vmcnt(7)
    buffer_load_dwordx4 v6, s[52:55], s13 offen offset:2048 lds
    s_waitcnt vmcnt(7)
    buffer_load_dwordx4 v7, s[52:55], s13 offen offset:3072 lds
    s_add_u32 m0, s14, 16384
    s_waitcnt vmcnt(7)
    buffer_load_dwordx4 v8, s[56:59], s13 offen offset:0 lds
    s_waitcnt vmcnt(7)
    buffer_load_dwordx4 v9, s[56:59], s13 offen offset:1024 lds
    s_waitcnt vmcnt(7)
    buffer_load_dwordx4 v10, s[56:59], s13 offen offset:2048 lds
    s_waitcnt vmcnt(7)
    ds_write_b32 v22, v25
    buffer_load_dwordx4 v11, s[56:59], s13 offen offset:3072 lds
    s_add_u32 m0, s14, 4096
    s_add_u32 s12, s13, 16384
    s_waitcnt vmcnt(7)
    buffer_load_dwordx4 v4, s[52:55], s12 offen offset:0 lds
    s_waitcnt vmcnt(7)
    buffer_load_dwordx4 v5, s[52:55], s12 offen offset:1024 lds
    s_waitcnt vmcnt(7)
    buffer_load_dwordx4 v6, s[52:55], s12 offen offset:2048 lds
    s_waitcnt vmcnt(7)
    buffer_load_dwordx4 v7, s[52:55], s12 offen offset:3072 lds
    ds_read_b128 v[60:63], v21
    s_add_u32 m0, s14, 20480
    s_waitcnt vmcnt(7)
    buffer_load_dwordx4 v8, s[60:63], s13 offen offset:0 lds
    s_waitcnt vmcnt(7)
    buffer_load_dwordx4 v9, s[60:63], s13 offen offset:1024 lds
    s_waitcnt vmcnt(7)
    buffer_load_dwordx4 v10, s[60:63], s13 offen offset:2048 lds
    s_waitcnt vmcnt(7)
    buffer_load_dwordx4 v11, s[60:63], s13 offen offset:3072 lds
    s_add_u32 s13, s13, 128
    s_and_b32 s13, s13, 2047
    s_add_u32 s14, s14, 32768
    s_and_b32 s14, s14, 131071
    s_add_u32 s29, s29, 1
    s_cmp_lt_u32 s29, 16
    s_cbranch_scc1 L_loop
    v_mov_b32 v25, 16
    v_mov_b32 v60, 1
    s_mov_b64 exec, 1
    ds_add_u32 v21, v60 offset:40
    s_mov_b64 exec, -1
    s_waitcnt vmcnt(0)
    ds_write_b32 v22, v25
    s_mov_b32 s15, 0
L_is0_w:
    ds_read_b32 v60, v21 offset:40
    s_waitcnt lgkmcnt(0)
    v_cmp_gt_u32 vcc, 2, v60
    s_cbranch_vccz L_is0_ok
    s_add_u32 s15, s15, 1
    s_cmp_lt_u32 s15, 160000
    s_cbranch_scc1 L_is0_w
L_is0_ok:
    buffer_load_dwordx4 v[192:195], v26, s[68:71], s36 offen offset:0 nt
    buffer_load_dwordx4 v[196:199], v26, s[68:71], s36 offen offset:1024 nt
    buffer_load_dwordx4 v[200:203], v26, s[68:71], s36 offen offset:2048 nt
    buffer_load_dwordx4 v[204:207], v26, s[68:71], s36 offen offset:3072 nt
    s_branch L_t2
L_idle:
    s_setprio 0
    s_mov_b32 s52, s18
    s_mov_b32 s53, s19
    s_mov_b32 s54, 4194304
    s_mov_b32 s55, 0x00020000
    s_mov_b32 s56, s20
    s_mov_b32 s57, s21
    s_mov_b32 s58, 4194304
    s_mov_b32 s59, 0x00020000
    s_mov_b32 s60, s22
    s_mov_b32 s61, s23
    s_mov_b32 s62, 8192
    s_mov_b32 s63, 0x00020000
    s_mov_b32 s64, s50
    s_mov_b32 s65, s51
    s_mov_b32 s66, 4194304
    s_mov_b32 s67, 0x00020000
    s_lshl_b32 s10, s4, 7
    s_lshl_b32 s12, s9, 6
    s_add_u32 s10, s10, s12
    v_and_b32 v60, 7, v2
    v_lshl_add_u32 v4, v60, 3, s10
    v_lshlrev_b32 v60, 1, v4
    v_lshl_add_u32 v5, v23, 11, v60
    v_subrev_u32 v6, 6144, v5
    v_bfrev_b32 v60, 1
    v_cmp_eq_u32 vcc, 0, v23
    s_nop 1
    v_cndmask_b32 v6, v6, v60, vcc
    v_lshlrev_b32 v7, 3, v4
    v_sub_u32 v8, 2040, v23
    v_lshlrev_b32 v8, 1, v8
    v_lshl_add_u32 v8, v4, 12, v8
    v_add_u32 v9, 16384, v8
    s_lshl_b32 s13, s4, 1
    s_add_u32 s13, s13, s9
    s_lshl_b32 s13, s13, 5
    s_add_u32 s13, s13, s5
    s_lshl_b32 s13, s13, 3
    v_mov_b32 v25, 16
    s_mov_b32 s15, 0
L_i1_w:
    ds_read_b64 v[60:61], v21 offset:16
    s_waitcnt lgkmcnt(0)
    v_min_u32 v60, v60, v61
    v_cmp_gt_u32 vcc, 4, v60
    s_cbranch_vccz L_i1_ok
    s_sleep 2
    s_add_u32 s15, s15, 1
    s_cmp_lt_u32 s15, 160000
    s_cbranch_scc1 L_i1_w
L_i1_ok:
    buffer_load_dwordx4 v[64:67], v7, s[60:63], 0 offen offset:0
    buffer_load_dwordx4 v[68:71], v7, s[60:63], 0 offen offset:16
    buffer_load_dwordx4 v[72:75], v7, s[60:63], 0 offen offset:32
    buffer_load_dwordx4 v[76:79], v7, s[60:63], 0 offen offset:48
    buffer_load_dwordx4 v[92:95], v5, s[52:55], 0 offen offset:0 nt
    buffer_load_dwordx4 v[96:99], v5, s[52:55], 0 offen offset:2048 nt
    buffer_load_dwordx4 v[100:103], v5, s[52:55], s32 offen offset:0 nt
    buffer_load_dwordx4 v[104:107], v5, s[52:55], s32 offen offset:2048 nt
    buffer_load_dwordx4 v[108:111], v5, s[52:55], s33 offen offset:0 nt
    buffer_load_dwordx4 v[112:115], v5, s[52:55], s33 offen offset:2048 nt
    buffer_load_dwordx4 v[116:119], v5, s[52:55], s34 offen offset:0 nt
    buffer_load_dwordx4 v[120:123], v5, s[52:55], s34 offen offset:2048 nt
    buffer_load_dwordx4 v[80:83], v6, s[52:55], 0 offen offset:0 nt
    buffer_load_dwordx4 v[84:87], v6, s[52:55], 0 offen offset:2048 nt
    buffer_load_dwordx4 v[88:91], v6, s[52:55], s32 offen offset:0 nt
    buffer_load_dwordx4 v[124:127], v5, s[56:59], 0 offen offset:0 nt
    buffer_load_dwordx4 v[128:131], v5, s[56:59], 0 offen offset:2048 nt
    buffer_load_dwordx4 v[132:135], v5, s[56:59], s32 offen offset:0 nt
    buffer_load_dwordx4 v[136:139], v5, s[56:59], s32 offen offset:2048 nt
    buffer_load_dwordx4 v[140:143], v5, s[56:59], s33 offen offset:0 nt
    buffer_load_dwordx4 v[144:147], v5, s[56:59], s33 offen offset:2048 nt
    buffer_load_dwordx4 v[148:151], v5, s[56:59], s34 offen offset:0 nt
    buffer_load_dwordx4 v[152:155], v5, s[56:59], s34 offen offset:2048 nt
    buffer_load_dwordx2 v[0:1], v19, s[76:79], 0 offen sc1
    s_waitcnt vmcnt(20)
    v_lshlrev_b32 v156, 16, v64
    v_and_b32 v160, 0xffff0000, v64
    v_lshlrev_b32 v164, 16, v65
    v_and_b32 v168, 0xffff0000, v65
    v_lshlrev_b32 v157, 16, v66
    v_and_b32 v161, 0xffff0000, v66
    v_lshlrev_b32 v165, 16, v67
    v_and_b32 v169, 0xffff0000, v67
    v_lshlrev_b32 v158, 16, v68
    v_and_b32 v162, 0xffff0000, v68
    v_lshlrev_b32 v166, 16, v69
    v_and_b32 v170, 0xffff0000, v69
    v_lshlrev_b32 v159, 16, v70
    v_and_b32 v163, 0xffff0000, v70
    v_lshlrev_b32 v167, 16, v71
    v_and_b32 v171, 0xffff0000, v71
    s_waitcnt vmcnt(9)
    v_lshlrev_b32 v172, 16, v80
    v_and_b32 v173, 0xffff0000, v80
    v_lshlrev_b32 v174, 16, v81
    v_and_b32 v175, 0xffff0000, v81
    v_lshlrev_b32 v176, 16, v84
    v_and_b32 v177, 0xffff0000, v84
    v_lshlrev_b32 v178, 16, v85
    v_and_b32 v179, 0xffff0000, v85
    v_lshlrev_b32 v180, 16, v88
    v_and_b32 v181, 0xffff0000, v88
    v_lshlrev_b32 v182, 16, v89
    v_and_b32 v183, 0xffff0000, v89
    v_lshlrev_b32 v184, 16, v92
    v_and_b32 v185, 0xffff0000, v92
    v_lshlrev_b32 v186, 16, v93
    v_and_b32 v187, 0xffff0000, v93
    v_lshlrev_b32 v188, 16, v96
    v_and_b32 v189, 0xffff0000, v96
    v_lshlrev_b32 v190, 16, v97
    v_and_b32 v191, 0xffff0000, v97
    v_lshlrev_b32 v192, 16, v100
    v_and_b32 v193, 0xffff0000, v100
    v_lshlrev_b32 v194, 16, v101
    v_and_b32 v195, 0xffff0000, v101
    v_lshlrev_b32 v196, 16, v104
    v_and_b32 v197, 0xffff0000, v104
    v_lshlrev_b32 v198, 16, v105
    v_and_b32 v199, 0xffff0000, v105
    v_lshlrev_b32 v200, 16, v108
    v_and_b32 v201, 0xffff0000, v108
    v_lshlrev_b32 v202, 16, v109
    v_and_b32 v203, 0xffff0000, v109
    v_lshlrev_b32 v204, 16, v112
    v_and_b32 v205, 0xffff0000, v112
    v_lshlrev_b32 v206, 16, v113
    v_and_b32 v207, 0xffff0000, v113
    v_lshlrev_b32 v208, 16, v116
    v_and_b32 v209, 0xffff0000, v116
    v_lshlrev_b32 v210, 16, v117
    v_and_b32 v211, 0xffff0000, v117
    v_lshlrev_b32 v212, 16, v120
    v_and_b32 v213, 0xffff0000, v120
    v_lshlrev_b32 v214, 16, v121
    v_and_b32 v215, 0xffff0000, v121
    v_mul_f32 v216, v184, v156
    v_mul_f32 v217, v185, v157
    v_mul_f32 v218, v186, v158
    v_mul_f32 v219, v187, v159
    v_mul_f32 v220, v188, v156
    v_mul_f32 v221, v189, v157
    v_mul_f32 v222, v190, v158
    v_mul_f32 v223, v191, v159
    v_mul_f32 v224, v192, v156
    v_mul_f32 v225, v193, v157
    v_mul_f32 v226, v194, v158
    v_mul_f32 v227, v195, v159
    v_mul_f32 v228, v196, v156
    v_mul_f32 v229, v197, v157
    v_mul_f32 v230, v198, v158
    v_mul_f32 v231, v199, v159
    v_mul_f32 v232, v200, v156
    v_mul_f32 v233, v201, v157
    v_mul_f32 v234, v202, v158
    v_mul_f32 v235, v203, v159
    v_mul_f32 v236, v204, v156
    v_mul_f32 v237, v205, v157
    v_mul_f32 v238, v206, v158
    v_mul_f32 v239, v207, v159
    v_mul_f32 v240, v208, v156
    v_mul_f32 v241, v209, v157
    v_mul_f32 v242, v210, v158
    v_mul_f32 v243, v211, v159
    v_mul_f32 v244, v212, v156
    v_mul_f32 v245, v213, v157
    v_mul_f32 v246, v214, v158
    v_mul_f32 v247, v215, v159
    v_fmac_f32 v216, v180, v160
    v_fmac_f32 v217, v181, v161
    v_fmac_f32 v218, v182, v162
    v_fmac_f32 v219, v183, v163
    v_fmac_f32 v220, v184, v160
    v_fmac_f32 v221, v185, v161
    v_fmac_f32 v222, v186, v162
    v_fmac_f32 v223, v187, v163
    v_fmac_f32 v224, v188, v160
    v_fmac_f32 v225, v189, v161
    v_fmac_f32 v226, v190, v162
    v_fmac_f32 v227, v191, v163
    v_fmac_f32 v228, v192, v160
    v_fmac_f32 v229, v193, v161
    v_fmac_f32 v230, v194, v162
    v_fmac_f32 v231, v195, v163
    v_fmac_f32 v232, v196, v160
    v_fmac_f32 v233, v197, v161
    v_fmac_f32 v234, v198, v162
    v_fmac_f32 v235, v199, v163
    v_fmac_f32 v236, v200, v160
    v_fmac_f32 v237, v201, v161
    v_fmac_f32 v238, v202, v162
    v_fmac_f32 v239, v203, v163
    v_fmac_f32 v240, v204, v160
    v_fmac_f32 v241, v205, v161
    v_fmac_f32 v242, v206, v162
    v_fmac_f32 v243, v207, v163
    v_fmac_f32 v244, v208, v160
    v_fmac_f32 v245, v209, v161
    v_fmac_f32 v246, v210, v162
    v_fmac_f32 v247, v211, v163
    v_fmac_f32 v216, v176, v164
    v_fmac_f32 v217, v177, v165
    v_fmac_f32 v218, v178, v166
    v_fmac_f32 v219, v179, v167
    v_fmac_f32 v220, v180, v164
    v_fmac_f32 v221, v181, v165
    v_fmac_f32 v222, v182, v166
    v_fmac_f32 v223, v183, v167
    v_fmac_f32 v224, v184, v164
    v_fmac_f32 v225, v185, v165
    v_fmac_f32 v226, v186, v166
    v_fmac_f32 v227, v187, v167
    v_fmac_f32 v228, v188, v164
    v_fmac_f32 v229, v189, v165
    v_fmac_f32 v230, v190, v166
    v_fmac_f32 v231, v191, v167
    v_fmac_f32 v232, v192, v164
    v_fmac_f32 v233, v193, v165
    v_fmac_f32 v234, v194, v166
    v_fmac_f32 v235, v195, v167
    v_fmac_f32 v236, v196, v164
    v_fmac_f32 v237, v197, v165
    v_fmac_f32 v238, v198, v166
    v_fmac_f32 v239, v199, v167
    v_fmac_f32 v240, v200, v164
    v_fmac_f32 v241, v201, v165
    v_fmac_f32 v242, v202, v166
    v_fmac_f32 v243, v203, v167
    v_fmac_f32 v244, v204, v164
    v_fmac_f32 v245, v205, v165
    v_fmac_f32 v246, v206, v166
    v_fmac_f32 v247, v207, v167
    v_fmac_f32 v216, v172, v168
    v_fmac_f32 v217, v173, v169
    v_fmac_f32 v218, v174, v170
    v_fmac_f32 v219, v175, v171
    v_fmac_f32 v220, v176, v168
    v_fmac_f32 v221, v177, v169
    v_fmac_f32 v222, v178, v170
    v_fmac_f32 v223, v179, v171
    v_fmac_f32 v224, v180, v168
    v_fmac_f32 v225, v181, v169
    v_fmac_f32 v226, v182, v170
    v_fmac_f32 v227, v183, v171
    v_fmac_f32 v228, v184, v168
    v_fmac_f32 v229, v185, v169
    v_fmac_f32 v230, v186, v170
    v_fmac_f32 v231, v187, v171
    v_fmac_f32 v232, v188, v168
    v_fmac_f32 v233, v189, v169
    v_fmac_f32 v234, v190, v170
    v_fmac_f32 v235, v191, v171
    v_fmac_f32 v236, v192, v168
    v_fmac_f32 v237, v193, v169
    v_fmac_f32 v238, v194, v170
    v_fmac_f32 v239, v195, v171
    v_fmac_f32 v240, v196, v168
    v_fmac_f32 v241, v197, v169
    v_fmac_f32 v242, v198, v170
    v_fmac_f32 v243, v199, v171
    v_fmac_f32 v244, v200, v168
    v_fmac_f32 v245, v201, v169
    v_fmac_f32 v246, v202, v170
    v_fmac_f32 v247, v203, v171
    s_waitcnt vmcnt(0)
    s_mov_b32 s12, 0
L_np:
    v_cmp_eq_u32 vcc, 0, v0
    s_cbranch_vccz L_nok
    buffer_load_dwordx2 v[0:1], v19, s[76:79], 0 offen sc1
    s_add_u32 s12, s12, 1
    s_waitcnt vmcnt(0)
    s_cmp_lt_u32 s12, 20000
    s_cbranch_scc1 L_np
L_nok:
    ds_write_b64 v21, v[0:1] offset:32
    v_lshlrev_b32 v172, 16, v124
    v_and_b32 v173, 0xffff0000, v124
    v_lshlrev_b32 v174, 16, v125
    v_and_b32 v175, 0xffff0000, v125
    v_lshlrev_b32 v176, 16, v128
    v_and_b32 v177, 0xffff0000, v128
    v_lshlrev_b32 v178, 16, v129
    v_and_b32 v179, 0xffff0000, v129
    v_lshlrev_b32 v180, 16, v132
    v_and_b32 v181, 0xffff0000, v132
    v_lshlrev_b32 v182, 16, v133
    v_and_b32 v183, 0xffff0000, v133
    v_lshlrev_b32 v184, 16, v136
    v_and_b32 v185, 0xffff0000, v136
    v_lshlrev_b32 v186, 16, v137
    v_and_b32 v187, 0xffff0000, v137
    v_lshlrev_b32 v188, 16, v140
    v_and_b32 v189, 0xffff0000, v140
    v_lshlrev_b32 v190, 16, v141
    v_and_b32 v191, 0xffff0000, v141
    v_lshlrev_b32 v192, 16, v144
    v_and_b32 v193, 0xffff0000, v144
    v_lshlrev_b32 v194, 16, v145
    v_and_b32 v195, 0xffff0000, v145
    v_lshlrev_b32 v196, 16, v148
    v_and_b32 v197, 0xffff0000, v148
    v_lshlrev_b32 v198, 16, v149
    v_and_b32 v199, 0xffff0000, v149
    v_lshlrev_b32 v200, 16, v152
    v_and_b32 v201, 0xffff0000, v152
    v_lshlrev_b32 v202, 16, v153
    v_and_b32 v203, 0xffff0000, v153
    v_mul_f32 v216, v216, v172
    v_mul_f32 v217, v217, v173
    v_mul_f32 v218, v218, v174
    v_mul_f32 v219, v219, v175
    v_mul_f32 v220, v220, v176
    v_mul_f32 v221, v221, v177
    v_mul_f32 v222, v222, v178
    v_mul_f32 v223, v223, v179
    v_mul_f32 v224, v224, v180
    v_mul_f32 v225, v225, v181
    v_mul_f32 v226, v226, v182
    v_mul_f32 v227, v227, v183
    v_mul_f32 v228, v228, v184
    v_mul_f32 v229, v229, v185
    v_mul_f32 v230, v230, v186
    v_mul_f32 v231, v231, v187
    v_mul_f32 v232, v232, v188
    v_mul_f32 v233, v233, v189
    v_mul_f32 v234, v234, v190
    v_mul_f32 v235, v235, v191
    v_mul_f32 v236, v236, v192
    v_mul_f32 v237, v237, v193
    v_mul_f32 v238, v238, v194
    v_mul_f32 v239, v239, v195
    v_mul_f32 v240, v240, v196
    v_mul_f32 v241, v241, v197
    v_mul_f32 v242, v242, v198
    v_mul_f32 v243, v243, v199
    v_mul_f32 v244, v244, v200
    v_mul_f32 v245, v245, v201
    v_mul_f32 v246, v246, v202
    v_mul_f32 v247, v247, v203
    v_cvt_pk_bf16_f32 v40, v244, v240
    v_cvt_pk_bf16_f32 v41, v236, v232
    v_cvt_pk_bf16_f32 v42, v228, v224
    v_cvt_pk_bf16_f32 v43, v220, v216
    buffer_store_dwordx4 v[40:43], v8, s[64:67], 0 offen sc1
    v_cvt_pk_bf16_f32 v44, v245, v241
    v_cvt_pk_bf16_f32 v45, v237, v233
    v_cvt_pk_bf16_f32 v46, v229, v225
    v_cvt_pk_bf16_f32 v47, v221, v217
    buffer_store_dwordx4 v[44:47], v8, s[64:67], s32 offen sc1
    v_cvt_pk_bf16_f32 v48, v246, v242
    v_cvt_pk_bf16_f32 v49, v238, v234
    v_cvt_pk_bf16_f32 v50, v230, v226
    v_cvt_pk_bf16_f32 v51, v222, v218
    buffer_store_dwordx4 v[48:51], v8, s[64:67], s33 offen sc1
    v_cvt_pk_bf16_f32 v52, v247, v243
    v_cvt_pk_bf16_f32 v53, v239, v235
    v_cvt_pk_bf16_f32 v54, v231, v227
    v_cvt_pk_bf16_f32 v55, v223, v219
    buffer_store_dwordx4 v[52:55], v8, s[64:67], s34 offen sc1
    v_lshlrev_b32 v156, 16, v72
    v_and_b32 v160, 0xffff0000, v72
    v_lshlrev_b32 v164, 16, v73
    v_and_b32 v168, 0xffff0000, v73
    v_lshlrev_b32 v157, 16, v74
    v_and_b32 v161, 0xffff0000, v74
    v_lshlrev_b32 v165, 16, v75
    v_and_b32 v169, 0xffff0000, v75
    v_lshlrev_b32 v158, 16, v76
    v_and_b32 v162, 0xffff0000, v76
    v_lshlrev_b32 v166, 16, v77
    v_and_b32 v170, 0xffff0000, v77
    v_lshlrev_b32 v159, 16, v78
    v_and_b32 v163, 0xffff0000, v78
    v_lshlrev_b32 v167, 16, v79
    v_and_b32 v171, 0xffff0000, v79
    v_lshlrev_b32 v172, 16, v82
    v_and_b32 v173, 0xffff0000, v82
    v_lshlrev_b32 v174, 16, v83
    v_and_b32 v175, 0xffff0000, v83
    v_lshlrev_b32 v176, 16, v86
    v_and_b32 v177, 0xffff0000, v86
    v_lshlrev_b32 v178, 16, v87
    v_and_b32 v179, 0xffff0000, v87
    v_lshlrev_b32 v180, 16, v90
    v_and_b32 v181, 0xffff0000, v90
    v_lshlrev_b32 v182, 16, v91
    v_and_b32 v183, 0xffff0000, v91
    v_lshlrev_b32 v184, 16, v94
    v_and_b32 v185, 0xffff0000, v94
    v_lshlrev_b32 v186, 16, v95
    v_and_b32 v187, 0xffff0000, v95
    v_lshlrev_b32 v188, 16, v98
    v_and_b32 v189, 0xffff0000, v98
    v_lshlrev_b32 v190, 16, v99
    v_and_b32 v191, 0xffff0000, v99
    v_lshlrev_b32 v192, 16, v102
    v_and_b32 v193, 0xffff0000, v102
    v_lshlrev_b32 v194, 16, v103
    v_and_b32 v195, 0xffff0000, v103
    v_lshlrev_b32 v196, 16, v106
    v_and_b32 v197, 0xffff0000, v106
    v_lshlrev_b32 v198, 16, v107
    v_and_b32 v199, 0xffff0000, v107
    v_lshlrev_b32 v200, 16, v110
    v_and_b32 v201, 0xffff0000, v110
    v_lshlrev_b32 v202, 16, v111
    v_and_b32 v203, 0xffff0000, v111
    v_lshlrev_b32 v204, 16, v114
    v_and_b32 v205, 0xffff0000, v114
    v_lshlrev_b32 v206, 16, v115
    v_and_b32 v207, 0xffff0000, v115
    v_lshlrev_b32 v208, 16, v118
    v_and_b32 v209, 0xffff0000, v118
    v_lshlrev_b32 v210, 16, v119
    v_and_b32 v211, 0xffff0000, v119
    v_lshlrev_b32 v212, 16, v122
    v_and_b32 v213, 0xffff0000, v122
    v_lshlrev_b32 v214, 16, v123
    v_and_b32 v215, 0xffff0000, v123
    v_mul_f32 v216, v184, v156
    v_mul_f32 v217, v185, v157
    v_mul_f32 v218, v186, v158
    v_mul_f32 v219, v187, v159
    v_mul_f32 v220, v188, v156
    v_mul_f32 v221, v189, v157
    v_mul_f32 v222, v190, v158
    v_mul_f32 v223, v191, v159
    v_mul_f32 v224, v192, v156
    v_mul_f32 v225, v193, v157
    v_mul_f32 v226, v194, v158
    v_mul_f32 v227, v195, v159
    v_mul_f32 v228, v196, v156
    v_mul_f32 v229, v197, v157
    v_mul_f32 v230, v198, v158
    v_mul_f32 v231, v199, v159
    v_mul_f32 v232, v200, v156
    v_mul_f32 v233, v201, v157
    v_mul_f32 v234, v202, v158
    v_mul_f32 v235, v203, v159
    v_mul_f32 v236, v204, v156
    v_mul_f32 v237, v205, v157
    v_mul_f32 v238, v206, v158
    v_mul_f32 v239, v207, v159
    v_mul_f32 v240, v208, v156
    v_mul_f32 v241, v209, v157
    v_mul_f32 v242, v210, v158
    v_mul_f32 v243, v211, v159
    v_mul_f32 v244, v212, v156
    v_mul_f32 v245, v213, v157
    v_mul_f32 v246, v214, v158
    v_mul_f32 v247, v215, v159
    v_fmac_f32 v216, v180, v160
    v_fmac_f32 v217, v181, v161
    v_fmac_f32 v218, v182, v162
    v_fmac_f32 v219, v183, v163
    v_fmac_f32 v220, v184, v160
    v_fmac_f32 v221, v185, v161
    v_fmac_f32 v222, v186, v162
    v_fmac_f32 v223, v187, v163
    v_fmac_f32 v224, v188, v160
    v_fmac_f32 v225, v189, v161
    v_fmac_f32 v226, v190, v162
    v_fmac_f32 v227, v191, v163
    v_fmac_f32 v228, v192, v160
    v_fmac_f32 v229, v193, v161
    v_fmac_f32 v230, v194, v162
    v_fmac_f32 v231, v195, v163
    v_fmac_f32 v232, v196, v160
    v_fmac_f32 v233, v197, v161
    v_fmac_f32 v234, v198, v162
    v_fmac_f32 v235, v199, v163
    v_fmac_f32 v236, v200, v160
    v_fmac_f32 v237, v201, v161
    v_fmac_f32 v238, v202, v162
    v_fmac_f32 v239, v203, v163
    v_fmac_f32 v240, v204, v160
    v_fmac_f32 v241, v205, v161
    v_fmac_f32 v242, v206, v162
    v_fmac_f32 v243, v207, v163
    v_fmac_f32 v244, v208, v160
    v_fmac_f32 v245, v209, v161
    v_fmac_f32 v246, v210, v162
    v_fmac_f32 v247, v211, v163
    v_fmac_f32 v216, v176, v164
    v_fmac_f32 v217, v177, v165
    v_fmac_f32 v218, v178, v166
    v_fmac_f32 v219, v179, v167
    v_fmac_f32 v220, v180, v164
    v_fmac_f32 v221, v181, v165
    v_fmac_f32 v222, v182, v166
    v_fmac_f32 v223, v183, v167
    v_fmac_f32 v224, v184, v164
    v_fmac_f32 v225, v185, v165
    v_fmac_f32 v226, v186, v166
    v_fmac_f32 v227, v187, v167
    v_fmac_f32 v228, v188, v164
    v_fmac_f32 v229, v189, v165
    v_fmac_f32 v230, v190, v166
    v_fmac_f32 v231, v191, v167
    v_fmac_f32 v232, v192, v164
    v_fmac_f32 v233, v193, v165
    v_fmac_f32 v234, v194, v166
    v_fmac_f32 v235, v195, v167
    v_fmac_f32 v236, v196, v164
    v_fmac_f32 v237, v197, v165
    v_fmac_f32 v238, v198, v166
    v_fmac_f32 v239, v199, v167
    v_fmac_f32 v240, v200, v164
    v_fmac_f32 v241, v201, v165
    v_fmac_f32 v242, v202, v166
    v_fmac_f32 v243, v203, v167
    v_fmac_f32 v244, v204, v164
    v_fmac_f32 v245, v205, v165
    v_fmac_f32 v246, v206, v166
    v_fmac_f32 v247, v207, v167
    v_fmac_f32 v216, v172, v168
    v_fmac_f32 v217, v173, v169
    v_fmac_f32 v218, v174, v170
    v_fmac_f32 v219, v175, v171
    v_fmac_f32 v220, v176, v168
    v_fmac_f32 v221, v177, v169
    v_fmac_f32 v222, v178, v170
    v_fmac_f32 v223, v179, v171
    v_fmac_f32 v224, v180, v168
    v_fmac_f32 v225, v181, v169
    v_fmac_f32 v226, v182, v170
    v_fmac_f32 v227, v183, v171
    v_fmac_f32 v228, v184, v168
    v_fmac_f32 v229, v185, v169
    v_fmac_f32 v230, v186, v170
    v_fmac_f32 v231, v187, v171
    v_fmac_f32 v232, v188, v168
    v_fmac_f32 v233, v189, v169
    v_fmac_f32 v234, v190, v170
    v_fmac_f32 v235, v191, v171
    v_fmac_f32 v236, v192, v168
    v_fmac_f32 v237, v193, v169
    v_fmac_f32 v238, v194, v170
    v_fmac_f32 v239, v195, v171
    v_fmac_f32 v240, v196, v168
    v_fmac_f32 v241, v197, v169
    v_fmac_f32 v242, v198, v170
    v_fmac_f32 v243, v199, v171
    v_fmac_f32 v244, v200, v168
    v_fmac_f32 v245, v201, v169
    v_fmac_f32 v246, v202, v170
    v_fmac_f32 v247, v203, v171
    v_lshlrev_b32 v172, 16, v126
    v_and_b32 v173, 0xffff0000, v126
    v_lshlrev_b32 v174, 16, v127
    v_and_b32 v175, 0xffff0000, v127
    v_lshlrev_b32 v176, 16, v130
    v_and_b32 v177, 0xffff0000, v130
    v_lshlrev_b32 v178, 16, v131
    v_and_b32 v179, 0xffff0000, v131
    v_lshlrev_b32 v180, 16, v134
    v_and_b32 v181, 0xffff0000, v134
    v_lshlrev_b32 v182, 16, v135
    v_and_b32 v183, 0xffff0000, v135
    v_lshlrev_b32 v184, 16, v138
    v_and_b32 v185, 0xffff0000, v138
    v_lshlrev_b32 v186, 16, v139
    v_and_b32 v187, 0xffff0000, v139
    v_lshlrev_b32 v188, 16, v142
    v_and_b32 v189, 0xffff0000, v142
    v_lshlrev_b32 v190, 16, v143
    v_and_b32 v191, 0xffff0000, v143
    v_lshlrev_b32 v192, 16, v146
    v_and_b32 v193, 0xffff0000, v146
    v_lshlrev_b32 v194, 16, v147
    v_and_b32 v195, 0xffff0000, v147
    v_lshlrev_b32 v196, 16, v150
    v_and_b32 v197, 0xffff0000, v150
    v_lshlrev_b32 v198, 16, v151
    v_and_b32 v199, 0xffff0000, v151
    v_lshlrev_b32 v200, 16, v154
    v_and_b32 v201, 0xffff0000, v154
    v_lshlrev_b32 v202, 16, v155
    v_and_b32 v203, 0xffff0000, v155
    v_mul_f32 v216, v216, v172
    v_mul_f32 v217, v217, v173
    v_mul_f32 v218, v218, v174
    v_mul_f32 v219, v219, v175
    v_mul_f32 v220, v220, v176
    v_mul_f32 v221, v221, v177
    v_mul_f32 v222, v222, v178
    v_mul_f32 v223, v223, v179
    v_mul_f32 v224, v224, v180
    v_mul_f32 v225, v225, v181
    v_mul_f32 v226, v226, v182
    v_mul_f32 v227, v227, v183
    v_mul_f32 v228, v228, v184
    v_mul_f32 v229, v229, v185
    v_mul_f32 v230, v230, v186
    v_mul_f32 v231, v231, v187
    v_mul_f32 v232, v232, v188
    v_mul_f32 v233, v233, v189
    v_mul_f32 v234, v234, v190
    v_mul_f32 v235, v235, v191
    v_mul_f32 v236, v236, v192
    v_mul_f32 v237, v237, v193
    v_mul_f32 v238, v238, v194
    v_mul_f32 v239, v239, v195
    v_mul_f32 v240, v240, v196
    v_mul_f32 v241, v241, v197
    v_mul_f32 v242, v242, v198
    v_mul_f32 v243, v243, v199
    v_mul_f32 v244, v244, v200
    v_mul_f32 v245, v245, v201
    v_mul_f32 v246, v246, v202
    v_mul_f32 v247, v247, v203
    v_cvt_pk_bf16_f32 v40, v244, v240
    v_cvt_pk_bf16_f32 v41, v236, v232
    v_cvt_pk_bf16_f32 v42, v228, v224
    v_cvt_pk_bf16_f32 v43, v220, v216
    buffer_store_dwordx4 v[40:43], v9, s[64:67], 0 offen sc1
    v_cvt_pk_bf16_f32 v44, v245, v241
    v_cvt_pk_bf16_f32 v45, v237, v233
    v_cvt_pk_bf16_f32 v46, v229, v225
    v_cvt_pk_bf16_f32 v47, v221, v217
    buffer_store_dwordx4 v[44:47], v9, s[64:67], s32 offen sc1
    v_cvt_pk_bf16_f32 v48, v246, v242
    v_cvt_pk_bf16_f32 v49, v238, v234
    v_cvt_pk_bf16_f32 v50, v230, v226
    v_cvt_pk_bf16_f32 v51, v222, v218
    buffer_store_dwordx4 v[48:51], v9, s[64:67], s33 offen sc1
    v_cvt_pk_bf16_f32 v52, v247, v243
    v_cvt_pk_bf16_f32 v53, v239, v235
    v_cvt_pk_bf16_f32 v54, v231, v227
    v_cvt_pk_bf16_f32 v55, v223, v219
    buffer_store_dwordx4 v[52:55], v9, s[64:67], s34 offen sc1
    s_waitcnt vmcnt(0)
    s_mov_b64 exec, 1
    buffer_store_dwordx2 v[0:1], v19, s[72:75], s13 offen sc1
    s_mov_b64 exec, -1
    s_cmp_eq_u32 s8, 3
    s_cbranch_scc0 L_id2
    s_mov_b32 s15, 0
L_i2_w:
    ds_read_b64 v[60:61], v21 offset:16
    s_waitcnt lgkmcnt(0)
    v_min_u32 v60, v60, v61
    v_cmp_gt_u32 vcc, 14, v60
    s_cbranch_vccz L_i2_ok
    s_sleep 2
    s_add_u32 s15, s15, 1
    s_cmp_lt_u32 s15, 160000
    s_cbranch_scc1 L_i2_w
L_i2_ok:
    s_mov_b32 s15, 0
LK_poll:
    buffer_load_dwordx2 v[60:61], v20, s[72:75], 0 offen sc1
    s_waitcnt vmcnt(0)
    v_cmp_ne_u64 vcc, v[60:61], v[0:1]
    s_cbranch_vccz LK_ok
    s_add_u32 s15, s15, 1
    s_cmp_lt_u32 s15, 20000
    s_cbranch_scc1 LK_poll
LK_ok:
    ds_write_b32 v21, v25 offset:44
L_id2:
    s_mov_b32 s15, 0
L_is1_w:
    ds_read_b32 v60, v21 offset:40
    s_waitcnt lgkmcnt(0)
    v_cmp_gt_u32 vcc, 2, v60
    s_cbranch_vccz L_is1_ok
    s_sleep 2
    s_add_u32 s15, s15, 1
    s_cmp_lt_u32 s15, 160000
    s_cbranch_scc1 L_is1_w
L_is1_ok:
    buffer_load_dwordx4 v[192:195], v26, s[68:71], s36 offen offset:0 nt
    buffer_load_dwordx4 v[196:199], v26, s[68:71], s36 offen offset:1024 nt
    buffer_load_dwordx4 v[200:203], v26, s[68:71], s36 offen offset:2048 nt
    buffer_load_dwordx4 v[204:207], v26, s[68:71], s36 offen offset:3072 nt
L_t2:
    s_mov_b32 s52, s50
    s_mov_b32 s53, s51
    s_mov_b32 s54, 4194304
    s_mov_b32 s55, 0x00020000
    s_mov_b32 s56, s50
    s_mov_b32 s57, s51
    s_mov_b32 s58, 4194304
    s_mov_b32 s59, 0x00020000
    s_mov_b32 s60, s16
    s_mov_b32 s61, s17
    s_mov_b32 s62, 4194304
    s_mov_b32 s63, 0x00020000
    s_mov_b32 s64, s46
    s_mov_b32 s65, s47
    s_mov_b32 s66, 16777216
    s_mov_b32 s67, 0x00020000
    s_mov_b32 s15, 0
L_fk_w:
    ds_read_b32 v60, v21 offset:44
    s_waitcnt lgkmcnt(0)
    v_cmp_gt_u32 vcc, 1, v60
    s_cbranch_vccz L_fk_ok
    s_sleep 1
    s_add_u32 s15, s15, 1
    s_cmp_lt_u32 s15, 160000
    s_cbranch_scc1 L_fk_w
L_fk_ok:
    ds_read_b64 v[0:1], v21 offset:32
    buffer_load_dwordx4 v[224:227], v26, s[52:55], s36 offen offset:0 sc1
    buffer_load_dwordx4 v[228:231], v26, s[52:55], s36 offen offset:1024 sc1
    buffer_load_dwordx4 v[232:235], v26, s[52:55], s36 offen offset:2048 sc1
    buffer_load_dwordx4 v[236:239], v26, s[52:55], s36 offen offset:3072 sc1
    buffer_load_dwordx2 v[4:5], v16, s[60:63], 0 offen offset:0 nt
    buffer_load_dwordx2 v[6:7], v16, s[60:63], 0 offen offset:2048 nt
    buffer_load_dwordx2 v[8:9], v16, s[60:63], s32 offen offset:0 nt
    buffer_load_dwordx2 v[10:11], v16, s[60:63], s32 offen offset:2048 nt
    buffer_load_dwordx2 v[14:15], v16, s[60:63], s33 offen offset:0 nt
    buffer_load_dwordx2 v[56:57], v16, s[60:63], s33 offen offset:2048 nt
    buffer_load_dwordx2 v[58:59], v16, s[60:63], s34 offen offset:0 nt
    buffer_load_dwordx2 v[34:35], v16, s[60:63], s34 offen offset:2048 nt
    s_lshl_b32 s14, s9, 13
    s_lshl_b32 s10, s11, 12
    s_add_u32 s14, s14, s10
    s_mov_b32 s15, 0
L_c1_w:
    ds_read_b128 v[60:63], v21 offset:0
    s_waitcnt lgkmcnt(0)
    v_min3_u32 v60, v60, v61, v62
    v_min_u32 v60, v60, v63
    v_cmp_gt_u32 vcc, 14, v60
    s_cbranch_vccz L_c1_ok
    s_sleep 1
    s_add_u32 s15, s15, 1
    s_cmp_lt_u32 s15, 160000
    s_cbranch_scc1 L_c1_w
L_c1_ok:
    s_bfe_u32 s13, s37, 0 + (4 << 16)
    s_lshl_b32 s13, s13, 7
    s_add_u32 m0, s14, 0
    s_nop 0
    buffer_load_dwordx4 v12, s[80:83], s13 offen offset:0 lds
    buffer_load_dwordx4 v13, s[80:83], s13 offen offset:1024 lds
    buffer_load_dwordx4 v12, s[80:83], s13 offen offset:2048 lds
    buffer_load_dwordx4 v13, s[80:83], s13 offen offset:3072 lds
    s_bfe_u32 s13, s37, 4 + (4 << 16)
    s_lshl_b32 s13, s13, 7
    s_add_u32 m0, s14, 16384
    s_nop 0
    buffer_load_dwordx4 v12, s[80:83], s13 offen offset:0 lds
    buffer_load_dwordx4 v13, s[80:83], s13 offen offset:1024 lds
    buffer_load_dwordx4 v12, s[80:83], s13 offen offset:2048 lds
    buffer_load_dwordx4 v13, s[80:83], s13 offen offset:3072 lds
    s_bfe_u32 s13, s37, 8 + (4 << 16)
    s_lshl_b32 s13, s13, 7
    s_add_u32 m0, s14, 32768
    s_nop 0
    buffer_load_dwordx4 v12, s[80:83], s13 offen offset:0 lds
    buffer_load_dwordx4 v13, s[80:83], s13 offen offset:1024 lds
    buffer_load_dwordx4 v12, s[80:83], s13 offen offset:2048 lds
    buffer_load_dwordx4 v13, s[80:83], s13 offen offset:3072 lds
    s_bfe_u32 s13, s37, 12 + (4 << 16)
    s_lshl_b32 s13, s13, 7
    s_add_u32 m0, s14, 49152
    s_nop 0
    buffer_load_dwordx4 v12, s[80:83], s13 offen offset:0 lds
    buffer_load_dwordx4 v13, s[80:83], s13 offen offset:1024 lds
    buffer_load_dwordx4 v12, s[80:83], s13 offen offset:2048 lds
    buffer_load_dwordx4 v13, s[80:83], s13 offen offset:3072 lds
    s_bitcmp1_b32 s100, 0
    s_cselect_b32 s10, 16, 0
    s_lshr_b32 s31, s31, s10
    s_and_b32 s31, s31, 0xffff
    v_lshlrev_b32 v60, 3, v27
    v_sub_u32 v60, v60, v17
    v_add_u32 v60, -9, v60
    v_and_b32 v61, 1, v60
    v_lshlrev_b32 v61, 4, v61
    v_lshlrev_b32 v61, v61, s31
    v_ashrrev_i32 v60, 1, v60
    v_cmp_eq_u32 vcc, 0, v60
    s_nop 1
    v_cndmask_b32 v36, 0, v61, vcc
    v_cmp_eq_u32 vcc, 1, v60
    s_nop 1
    v_cndmask_b32 v37, 0, v61, vcc
    v_cmp_eq_u32 vcc, 2, v60
    s_nop 1
    v_cndmask_b32 v38, 0, v61, vcc
    v_cmp_eq_u32 vcc, 3, v60
    s_nop 1
    v_cndmask_b32 v39, 0, v61, vcc
    v_mov_b32 v128, 0
    v_mov_b32 v129, 0
    v_mov_b32 v130, 0
    v_mov_b32 v131, 0
    v_and_b32 v60, 1, v27
    v_lshlrev_b32 v60, 9, v60
    v_lshl_add_u32 v60, v17, 5, v60
    v_lshrrev_b32 v61, 1, v27
    v_lshl_add_u32 v17, v61, 4, v60
    s_waitcnt vmcnt(28)
    v_mov_b32 v208, 0
    v_alignbit_b32 v209, v193, v192, 16
    v_alignbit_b32 v210, v194, v193, 16
    v_alignbit_b32 v211, v195, v194, 16
    s_nop 0
    v_mov_b32_dpp v208, v195 wave_shr:1 row_mask:0xf bank_mask:0xf
    v_alignbit_b32 v208, v192, v208, 16
    v_readlane_b32 s10, v195, 63
    v_alignbit_b32 v213, v197, v196, 16
    v_alignbit_b32 v214, v198, v197, 16
    v_mov_b32 v212, s10
    v_alignbit_b32 v215, v199, v198, 16
    s_nop 0
    v_mov_b32_dpp v212, v199 wave_shr:1 row_mask:0xf bank_mask:0xf
    v_alignbit_b32 v212, v196, v212, 16
    v_readlane_b32 s10, v199, 63
    v_alignbit_b32 v217, v201, v200, 16
    v_alignbit_b32 v218, v202, v201, 16
    v_mov_b32 v216, s10
    v_alignbit_b32 v219, v203, v202, 16
    s_nop 0
    v_mov_b32_dpp v216, v203 wave_shr:1 row_mask:0xf bank_mask:0xf
    v_alignbit_b32 v216, v200, v216, 16
    v_readlane_b32 s10, v203, 63
    v_alignbit_b32 v221, v205, v204, 16
    v_alignbit_b32 v222, v206, v205, 16
    v_mov_b32 v220, s10
    v_alignbit_b32 v223, v207, v206, 16
    s_nop 0
    v_mov_b32_dpp v220, v207 wave_shr:1 row_mask:0xf bank_mask:0xf
    v_alignbit_b32 v220, v204, v220, 16
    s_mov_b32 s15, 0
L_c2_w:
    ds_read_b128 v[60:63], v21 offset:0
    s_waitcnt lgkmcnt(0)
    v_min3_u32 v60, v60, v61, v62
    v_min_u32 v60, v60, v63
    v_cmp_gt_u32 vcc, 16, v60
    s_cbranch_vccz L_c2_ok
    s_sleep 1
    s_add_u32 s15, s15, 1
    s_cmp_lt_u32 s15, 160000
    s_cbranch_scc1 L_c2_w
L_c2_ok:
    s_setprio 0
    ds_write_b128 v18, v[128:131]
    v_add_u32 v62, -8288, v33
    ds_write_b128 v62, v[192:195] offset:0
    ds_write_b128 v62, v[196:199] offset:1024
    ds_write_b128 v62, v[200:203] offset:2048
    ds_write_b128 v62, v[204:207] offset:3072
    ds_write_b128 v62, v[208:211] offset:4160
    ds_write_b128 v62, v[212:215] offset:5184
    ds_write_b128 v62, v[216:219] offset:6208
    ds_write_b128 v62, v[220:223] offset:7232
    ds_read2_b32 v[128:129], v28 offset0:0 offset1:1
    ds_read2_b32 v[130:131], v28 offset0:2 offset1:3
    ds_read2_b32 v[132:133], v28 offset0:128 offset1:129
    ds_read2_b32 v[134:135], v28 offset0:130 offset1:131
    ds_read2_b32 v[136:137], v29 offset0:0 offset1:1
    ds_read2_b32 v[138:139], v29 offset0:2 offset1:3
    ds_read2_b32 v[140:141], v29 offset0:128 offset1:129
    ds_read2_b32 v[142:143], v29 offset0:130 offset1:131
    ds_read2_b32 v[144:145], v30 offset0:0 offset1:1
    ds_read2_b32 v[146:147], v30 offset0:2 offset1:3
    ds_read2_b32 v[148:149], v30 offset0:128 offset1:129
    ds_read2_b32 v[150:151], v30 offset0:130 offset1:131
    ds_read2_b32 v[152:153], v31 offset0:0 offset1:1
    ds_read2_b32 v[154:155], v31 offset0:2 offset1:3
    ds_read2_b32 v[156:157], v31 offset0:128 offset1:129
    ds_read2_b32 v[158:159], v31 offset0:130 offset1:131
    s_waitcnt vmcnt(27)
    ds_write_b128 v33, v[224:227] offset:0
    s_waitcnt vmcnt(26)
    ds_write_b128 v33, v[228:231] offset:1024
    s_waitcnt vmcnt(25)
    ds_write_b128 v33, v[232:235] offset:2048
    s_waitcnt vmcnt(24)
    ds_write_b128 v33, v[236:239] offset:3072
    ds_read_b128 v[160:163], v32 offset:3584
    ds_read_b128 v[164:167], v32 offset:3072
    ds_read_b128 v[168:171], v32 offset:2560
    ds_read_b128 v[172:175], v32 offset:2048
    ds_read_b128 v[176:179], v32 offset:1536
    ds_read_b128 v[180:183], v32 offset:1024
    ds_read_b128 v[184:187], v32 offset:512
    ds_read_b128 v[188:191], v32 offset:0
    s_setprio 2
    s_waitcnt lgkmcnt(0)
    v_mfma_f32_16x16x32_bf16 v[96:99], v[36:39], v[160:163], 0
    v_mfma_f32_16x16x32_bf16 v[100:103], v[36:39], v[164:167], 0
    v_mfma_f32_16x16x32_bf16 v[104:107], v[36:39], v[168:171], 0
    v_mfma_f32_16x16x32_bf16 v[108:111], v[36:39], v[172:175], 0
    v_mfma_f32_16x16x32_bf16 v[112:115], v[36:39], v[176:179], 0
    v_mfma_f32_16x16x32_bf16 v[116:119], v[36:39], v[180:183], 0
    v_mfma_f32_16x16x32_bf16 v[120:123], v[36:39], v[184:187], 0
    v_mfma_f32_16x16x32_bf16 v[124:127], v[36:39], v[188:191], 0
    v_mfma_f32_16x16x32_bf16 v[96:99], v[128:131], v[160:163], v[96:99]
    ds_read2_b32 v[192:193], v28 offset0:16 offset1:17
    s_bfe_u32 s13, s30, 28 + (4 << 16)
    s_lshl_b32 s13, s13, 7
    buffer_load_dwordx4 v[40:43], v12, s[80:83], s13 offen offset:0
    v_mfma_f32_16x16x32_bf16 v[100:103], v[128:131], v[164:167], v[100:103]
    ds_read2_b32 v[194:195], v28 offset0:18 offset1:19
    v_mfma_f32_16x16x32_bf16 v[104:107], v[128:131], v[168:171], v[104:107]
    ds_read_b128 v[224:227], v32 offset:3648
    v_mfma_f32_16x16x32_bf16 v[108:111], v[128:131], v[172:175], v[108:111]
    ds_read2_b32 v[196:197], v28 offset0:144 offset1:145
    v_mfma_f32_16x16x32_bf16 v[112:115], v[128:131], v[176:179], v[112:115]
    ds_read2_b32 v[198:199], v28 offset0:146 offset1:147
    v_mfma_f32_16x16x32_bf16 v[116:119], v[128:131], v[180:183], v[116:119]
    ds_read_b128 v[228:231], v32 offset:3136
    v_mfma_f32_16x16x32_bf16 v[120:123], v[128:131], v[184:187], v[120:123]
    ds_read2_b32 v[200:201], v29 offset0:16 offset1:17
    buffer_load_dwordx4 v[44:47], v13, s[80:83], s13 offen offset:1024
    v_mfma_f32_16x16x32_bf16 v[124:127], v[128:131], v[188:191], v[124:127]
    ds_read2_b32 v[202:203], v29 offset0:18 offset1:19
    v_mfma_f32_16x16x32_bf16 v[100:103], v[132:135], v[160:163], v[100:103]
    ds_read_b128 v[232:235], v32 offset:2624
    v_mfma_f32_16x16x32_bf16 v[104:107], v[132:135], v[164:167], v[104:107]
    ds_read2_b32 v[204:205], v29 offset0:144 offset1:145
    v_mfma_f32_16x16x32_bf16 v[108:111], v[132:135], v[168:171], v[108:111]
    ds_read2_b32 v[206:207], v29 offset0:146 offset1:147
    v_mfma_f32_16x16x32_bf16 v[112:115], v[132:135], v[172:175], v[112:115]
    ds_read_b128 v[236:239], v32 offset:2112
    v_mfma_f32_16x16x32_bf16 v[116:119], v[132:135], v[176:179], v[116:119]
    ds_read2_b32 v[208:209], v30 offset0:16 offset1:17
    buffer_load_dwordx4 v[48:51], v12, s[80:83], s13 offen offset:2048
    v_mfma_f32_16x16x32_bf16 v[120:123], v[132:135], v[180:183], v[120:123]
    ds_read2_b32 v[210:211], v30 offset0:18 offset1:19
    v_mfma_f32_16x16x32_bf16 v[124:127], v[132:135], v[184:187], v[124:127]
    ds_read_b128 v[240:243], v32 offset:1600
    v_mfma_f32_16x16x32_bf16 v[104:107], v[136:139], v[160:163], v[104:107]
    ds_read2_b32 v[212:213], v30 offset0:144 offset1:145
    v_mfma_f32_16x16x32_bf16 v[108:111], v[136:139], v[164:167], v[108:111]
    ds_read2_b32 v[214:215], v30 offset0:146 offset1:147
    v_mfma_f32_16x16x32_bf16 v[112:115], v[136:139], v[168:171], v[112:115]
    ds_read_b128 v[244:247], v32 offset:1088
    v_mfma_f32_16x16x32_bf16 v[116:119], v[136:139], v[172:175], v[116:119]
    ds_read2_b32 v[216:217], v31 offset0:16 offset1:17
    buffer_load_dwordx4 v[52:55], v13, s[80:83], s13 offen offset:3072
    v_mfma_f32_16x16x32_bf16 v[120:123], v[136:139], v[176:179], v[120:123]
    ds_read2_b32 v[218:219], v31 offset0:18 offset1:19
    v_mfma_f32_16x16x32_bf16 v[124:127], v[136:139], v[180:183], v[124:127]
    ds_read_b128 v[248:251], v32 offset:576
    v_mfma_f32_16x16x32_bf16 v[108:111], v[140:143], v[160:163], v[108:111]
    ds_read2_b32 v[220:221], v31 offset0:144 offset1:145
    v_mfma_f32_16x16x32_bf16 v[112:115], v[140:143], v[164:167], v[112:115]
    ds_read2_b32 v[222:223], v31 offset0:146 offset1:147
    v_mfma_f32_16x16x32_bf16 v[116:119], v[140:143], v[168:171], v[116:119]
    ds_read_b128 v[252:255], v32 offset:64
    v_mfma_f32_16x16x32_bf16 v[120:123], v[140:143], v[172:175], v[120:123]
    s_bfe_u32 s13, s30, 24 + (4 << 16)
    s_lshl_b32 s13, s13, 7
    buffer_load_dwordx4 v[80:83], v12, s[80:83], s13 offen offset:0
    v_mfma_f32_16x16x32_bf16 v[124:127], v[140:143], v[176:179], v[124:127]
    v_mfma_f32_16x16x32_bf16 v[112:115], v[144:147], v[160:163], v[112:115]
    v_mfma_f32_16x16x32_bf16 v[116:119], v[144:147], v[164:167], v[116:119]
    v_mfma_f32_16x16x32_bf16 v[120:123], v[144:147], v[168:171], v[120:123]
    v_mfma_f32_16x16x32_bf16 v[124:127], v[144:147], v[172:175], v[124:127]
    v_mfma_f32_16x16x32_bf16 v[116:119], v[148:151], v[160:163], v[116:119]
    buffer_load_dwordx4 v[84:87], v13, s[80:83], s13 offen offset:1024
    s_waitcnt vmcnt(6)
    v_mov_b32 v60, 1
    s_mov_b64 exec, 1
    ds_add_u32 v21, v60 offset:60
    s_mov_b64 exec, -1
    v_mfma_f32_16x16x32_bf16 v[120:123], v[148:151], v[164:167], v[120:123]
    v_mfma_f32_16x16x32_bf16 v[124:127], v[148:151], v[168:171], v[124:127]
    v_mfma_f32_16x16x32_bf16 v[120:123], v[152:155], v[160:163], v[120:123]
    v_mfma_f32_16x16x32_bf16 v[124:127], v[152:155], v[164:167], v[124:127]
    v_mfma_f32_16x16x32_bf16 v[124:127], v[156:159], v[160:163], v[124:127]
    s_waitcnt lgkmcnt(0)
    v_mfma_f32_16x16x32_bf16 v[96:99], v[192:195], v[224:227], v[96:99]
    ds_read2_b32 v[128:129], v28 offset0:32 offset1:33
    buffer_load_dwordx4 v[88:91], v12, s[80:83], s13 offen offset:2048
    v_mfma_f32_16x16x32_bf16 v[100:103], v[192:195], v[228:231], v[100:103]
    ds_read2_b32 v[130:131], v28 offset0:34 offset1:35
    v_mfma_f32_16x16x32_bf16 v[104:107], v[192:195], v[232:235], v[104:107]
    ds_read_b128 v[160:163], v32 offset:3712
    v_mfma_f32_16x16x32_bf16 v[108:111], v[192:195], v[236:239], v[108:111]
    ds_read2_b32 v[132:133], v28 offset0:160 offset1:161
    v_mfma_f32_16x16x32_bf16 v[112:115], v[192:195], v[240:243], v[112:115]
    ds_read2_b32 v[134:135], v28 offset0:162 offset1:163
    v_mfma_f32_16x16x32_bf16 v[116:119], v[192:195], v[244:247], v[116:119]
    ds_read_b128 v[164:167], v32 offset:3200
    v_mfma_f32_16x16x32_bf16 v[120:123], v[192:195], v[248:251], v[120:123]
    ds_read2_b32 v[136:137], v29 offset0:32 offset1:33
    buffer_load_dwordx4 v[92:95], v13, s[80:83], s13 offen offset:3072
    v_mfma_f32_16x16x32_bf16 v[124:127], v[192:195], v[252:255], v[124:127]
    ds_read2_b32 v[138:139], v29 offset0:34 offset1:35
    v_mfma_f32_16x16x32_bf16 v[100:103], v[196:199], v[224:227], v[100:103]
    ds_read_b128 v[168:171], v32 offset:2688
    v_mfma_f32_16x16x32_bf16 v[104:107], v[196:199], v[228:231], v[104:107]
    ds_read2_b32 v[140:141], v29 offset0:160 offset1:161
    v_mfma_f32_16x16x32_bf16 v[108:111], v[196:199], v[232:235], v[108:111]
    ds_read2_b32 v[142:143], v29 offset0:162 offset1:163
    v_mfma_f32_16x16x32_bf16 v[112:115], v[196:199], v[236:239], v[112:115]
    ds_read_b128 v[172:175], v32 offset:2176
    v_mfma_f32_16x16x32_bf16 v[116:119], v[196:199], v[240:243], v[116:119]
    ds_read2_b32 v[144:145], v30 offset0:32 offset1:33
    s_bfe_u32 s13, s30, 20 + (4 << 16)
    s_lshl_b32 s13, s13, 7
    buffer_load_dwordx4 v[64:67], v12, s[80:83], s13 offen offset:0
    v_mfma_f32_16x16x32_bf16 v[120:123], v[196:199], v[244:247], v[120:123]
    ds_read2_b32 v[146:147], v30 offset0:34 offset1:35
    v_mfma_f32_16x16x32_bf16 v[124:127], v[196:199], v[248:251], v[124:127]
    ds_read_b128 v[176:179], v32 offset:1664
    v_mfma_f32_16x16x32_bf16 v[104:107], v[200:203], v[224:227], v[104:107]
    ds_read2_b32 v[148:149], v30 offset0:160 offset1:161
    v_mfma_f32_16x16x32_bf16 v[108:111], v[200:203], v[228:231], v[108:111]
    ds_read2_b32 v[150:151], v30 offset0:162 offset1:163
    v_mfma_f32_16x16x32_bf16 v[112:115], v[200:203], v[232:235], v[112:115]
    ds_read_b128 v[180:183], v32 offset:1152
    v_mfma_f32_16x16x32_bf16 v[116:119], v[200:203], v[236:239], v[116:119]
    ds_read2_b32 v[152:153], v31 offset0:32 offset1:33
    buffer_load_dwordx4 v[68:71], v13, s[80:83], s13 offen offset:1024
    v_mfma_f32_16x16x32_bf16 v[120:123], v[200:203], v[240:243], v[120:123]
    ds_read2_b32 v[154:155], v31 offset0:34 offset1:35
    v_mfma_f32_16x16x32_bf16 v[124:127], v[200:203], v[244:247], v[124:127]
    ds_read_b128 v[184:187], v32 offset:640
    v_mfma_f32_16x16x32_bf16 v[108:111], v[204:207], v[224:227], v[108:111]
    ds_read2_b32 v[156:157], v31 offset0:160 offset1:161
    v_mfma_f32_16x16x32_bf16 v[112:115], v[204:207], v[228:231], v[112:115]
    ds_read2_b32 v[158:159], v31 offset0:162 offset1:163
    v_mfma_f32_16x16x32_bf16 v[116:119], v[204:207], v[232:235], v[116:119]
    ds_read_b128 v[188:191], v32 offset:128
    v_mfma_f32_16x16x32_bf16 v[120:123], v[204:207], v[236:239], v[120:123]
    buffer_load_dwordx4 v[72:75], v12, s[80:83], s13 offen offset:2048
    v_mfma_f32_16x16x32_bf16 v[124:127], v[204:207], v[240:243], v[124:127]
    v_mfma_f32_16x16x32_bf16 v[112:115], v[208:211], v[224:227], v[112:115]
    v_mfma_f32_16x16x32_bf16 v[116:119], v[208:211], v[228:231], v[116:119]
    v_mfma_f32_16x16x32_bf16 v[120:123], v[208:211], v[232:235], v[120:123]
    v_mfma_f32_16x16x32_bf16 v[124:127], v[208:211], v[236:239], v[124:127]
    v_mfma_f32_16x16x32_bf16 v[116:119], v[212:215], v[224:227], v[116:119]
    buffer_load_dwordx4 v[76:79], v13, s[80:83], s13 offen offset:3072
    v_mfma_f32_16x16x32_bf16 v[120:123], v[212:215], v[228:231], v[120:123]
    v_mfma_f32_16x16x32_bf16 v[124:127], v[212:215], v[232:235], v[124:127]
    v_mfma_f32_16x16x32_bf16 v[120:123], v[216:219], v[224:227], v[120:123]
    v_mfma_f32_16x16x32_bf16 v[124:127], v[216:219], v[228:231], v[124:127]
    v_mfma_f32_16x16x32_bf16 v[124:127], v[220:223], v[224:227], v[124:127]
    s_waitcnt lgkmcnt(0)
    v_mfma_f32_16x16x32_bf16 v[96:99], v[128:131], v[160:163], v[96:99]
    ds_read2_b32 v[192:193], v28 offset0:48 offset1:49
    v_mfma_f32_16x16x32_bf16 v[100:103], v[128:131], v[164:167], v[100:103]
    ds_read2_b32 v[194:195], v28 offset0:50 offset1:51
    v_mfma_f32_16x16x32_bf16 v[104:107], v[128:131], v[168:171], v[104:107]
    ds_read_b128 v[224:227], v32 offset:3776
    v_mfma_f32_16x16x32_bf16 v[108:111], v[128:131], v[172:175], v[108:111]
    ds_read2_b32 v[196:197], v28 offset0:176 offset1:177
    v_mfma_f32_16x16x32_bf16 v[112:115], v[128:131], v[176:179], v[112:115]
    ds_read2_b32 v[198:199], v28 offset0:178 offset1:179
    v_mfma_f32_16x16x32_bf16 v[116:119], v[128:131], v[180:183], v[116:119]
    ds_read_b128 v[228:231], v32 offset:3264
    v_mfma_f32_16x16x32_bf16 v[120:123], v[128:131], v[184:187], v[120:123]
    ds_read2_b32 v[200:201], v29 offset0:48 offset1:49
    v_mfma_f32_16x16x32_bf16 v[124:127], v[128:131], v[188:191], v[124:127]
    ds_read2_b32 v[202:203], v29 offset0:50 offset1:51
    v_mfma_f32_16x16x32_bf16 v[100:103], v[132:135], v[160:163], v[100:103]
    ds_read_b128 v[232:235], v32 offset:2752
    v_mfma_f32_16x16x32_bf16 v[104:107], v[132:135], v[164:167], v[104:107]
    ds_read2_b32 v[204:205], v29 offset0:176 offset1:177
    v_mfma_f32_16x16x32_bf16 v[108:111], v[132:135], v[168:171], v[108:111]
    ds_read2_b32 v[206:207], v29 offset0:178 offset1:179
    v_mfma_f32_16x16x32_bf16 v[112:115], v[132:135], v[172:175], v[112:115]
    ds_read_b128 v[236:239], v32 offset:2240
    v_mfma_f32_16x16x32_bf16 v[116:119], v[132:135], v[176:179], v[116:119]
    ds_read2_b32 v[208:209], v30 offset0:48 offset1:49
    v_mfma_f32_16x16x32_bf16 v[120:123], v[132:135], v[180:183], v[120:123]
    ds_read2_b32 v[210:211], v30 offset0:50 offset1:51
    v_mfma_f32_16x16x32_bf16 v[124:127], v[132:135], v[184:187], v[124:127]
    ds_read_b128 v[240:243], v32 offset:1728
    v_mfma_f32_16x16x32_bf16 v[104:107], v[136:139], v[160:163], v[104:107]
    ds_read2_b32 v[212:213], v30 offset0:176 offset1:177
    v_mfma_f32_16x16x32_bf16 v[108:111], v[136:139], v[164:167], v[108:111]
    ds_read2_b32 v[214:215], v30 offset0:178 offset1:179
    v_mfma_f32_16x16x32_bf16 v[112:115], v[136:139], v[168:171], v[112:115]
    ds_read_b128 v[244:247], v32 offset:1216
    v_mfma_f32_16x16x32_bf16 v[116:119], v[136:139], v[172:175], v[116:119]
    ds_read2_b32 v[216:217], v31 offset0:48 offset1:49
    v_mfma_f32_16x16x32_bf16 v[120:123], v[136:139], v[176:179], v[120:123]
    ds_read2_b32 v[218:219], v31 offset0:50 offset1:51
    v_mfma_f32_16x16x32_bf16 v[124:127], v[136:139], v[180:183], v[124:127]
    ds_read_b128 v[248:251], v32 offset:704
    v_mfma_f32_16x16x32_bf16 v[108:111], v[140:143], v[160:163], v[108:111]
    ds_read2_b32 v[220:221], v31 offset0:176 offset1:177
    v_mfma_f32_16x16x32_bf16 v[112:115], v[140:143], v[164:167], v[112:115]
    ds_read2_b32 v[222:223], v31 offset0:178 offset1:179
    v_mfma_f32_16x16x32_bf16 v[116:119], v[140:143], v[168:171], v[116:119]
    ds_read_b128 v[252:255], v32 offset:192
    v_mfma_f32_16x16x32_bf16 v[120:123], v[140:143], v[172:175], v[120:123]
    v_mfma_f32_16x16x32_bf16 v[124:127], v[140:143], v[176:179], v[124:127]
    v_mfma_f32_16x16x32_bf16 v[112:115], v[144:147], v[160:163], v[112:115]
    v_mfma_f32_16x16x32_bf16 v[116:119], v[144:147], v[164:167], v[116:119]
    v_mfma_f32_16x16x32_bf16 v[120:123], v[144:147], v[168:171], v[120:123]
    v_mfma_f32_16x16x32_bf16 v[124:127], v[144:147], v[172:175], v[124:127]
    v_mfma_f32_16x16x32_bf16 v[116:119], v[148:151], v[160:163], v[116:119]
    v_mfma_f32_16x16x32_bf16 v[120:123], v[148:151], v[164:167], v[120:123]
    v_mfma_f32_16x16x32_bf16 v[124:127], v[148:151], v[168:171], v[124:127]
    v_mfma_f32_16x16x32_bf16 v[120:123], v[152:155], v[160:163], v[120:123]
    v_mfma_f32_16x16x32_bf16 v[124:127], v[152:155], v[164:167], v[124:127]
    v_mfma_f32_16x16x32_bf16 v[124:127], v[156:159], v[160:163], v[124:127]
    s_waitcnt lgkmcnt(0)
    v_mfma_f32_16x16x32_bf16 v[96:99], v[192:195], v[224:227], v[96:99]
    ds_read2_b32 v[128:129], v28 offset0:64 offset1:65
    v_mfma_f32_16x16x32_bf16 v[100:103], v[192:195], v[228:231], v[100:103]
    ds_read2_b32 v[130:131], v28 offset0:66 offset1:67
    v_mfma_f32_16x16x32_bf16 v[104:107], v[192:195], v[232:235], v[104:107]
    ds_read_b128 v[160:163], v32 offset:3840
    v_mfma_f32_16x16x32_bf16 v[108:111], v[192:195], v[236:239], v[108:111]
    ds_read2_b32 v[132:133], v28 offset0:192 offset1:193
    v_mfma_f32_16x16x32_bf16 v[112:115], v[192:195], v[240:243], v[112:115]
    ds_read2_b32 v[134:135], v28 offset0:194 offset1:195
    v_mfma_f32_16x16x32_bf16 v[116:119], v[192:195], v[244:247], v[116:119]
    ds_read_b128 v[164:167], v32 offset:3328
    v_mfma_f32_16x16x32_bf16 v[120:123], v[192:195], v[248:251], v[120:123]
    ds_read2_b32 v[136:137], v29 offset0:64 offset1:65
    v_mfma_f32_16x16x32_bf16 v[124:127], v[192:195], v[252:255], v[124:127]
    ds_read2_b32 v[138:139], v29 offset0:66 offset1:67
    v_mfma_f32_16x16x32_bf16 v[100:103], v[196:199], v[224:227], v[100:103]
    ds_read_b128 v[168:171], v32 offset:2816
    v_mfma_f32_16x16x32_bf16 v[104:107], v[196:199], v[228:231], v[104:107]
    ds_read2_b32 v[140:141], v29 offset0:192 offset1:193
    v_mfma_f32_16x16x32_bf16 v[108:111], v[196:199], v[232:235], v[108:111]
    ds_read2_b32 v[142:143], v29 offset0:194 offset1:195
    v_mfma_f32_16x16x32_bf16 v[112:115], v[196:199], v[236:239], v[112:115]
    ds_read_b128 v[172:175], v32 offset:2304
    v_mfma_f32_16x16x32_bf16 v[116:119], v[196:199], v[240:243], v[116:119]
    ds_read2_b32 v[144:145], v30 offset0:64 offset1:65
    v_mfma_f32_16x16x32_bf16 v[120:123], v[196:199], v[244:247], v[120:123]
    ds_read2_b32 v[146:147], v30 offset0:66 offset1:67
    v_mfma_f32_16x16x32_bf16 v[124:127], v[196:199], v[248:251], v[124:127]
    ds_read_b128 v[176:179], v32 offset:1792
    v_mfma_f32_16x16x32_bf16 v[104:107], v[200:203], v[224:227], v[104:107]
    ds_read2_b32 v[148:149], v30 offset0:192 offset1:193
    v_mfma_f32_16x16x32_bf16 v[108:111], v[200:203], v[228:231], v[108:111]
    ds_read2_b32 v[150:151], v30 offset0:194 offset1:195
    v_mfma_f32_16x16x32_bf16 v[112:115], v[200:203], v[232:235], v[112:115]
    ds_read_b128 v[180:183], v32 offset:1280
    v_mfma_f32_16x16x32_bf16 v[116:119], v[200:203], v[236:239], v[116:119]
    ds_read2_b32 v[152:153], v31 offset0:64 offset1:65
    v_mfma_f32_16x16x32_bf16 v[120:123], v[200:203], v[240:243], v[120:123]
    ds_read2_b32 v[154:155], v31 offset0:66 offset1:67
    v_mfma_f32_16x16x32_bf16 v[124:127], v[200:203], v[244:247], v[124:127]
    ds_read_b128 v[184:187], v32 offset:768
    v_mfma_f32_16x16x32_bf16 v[108:111], v[204:207], v[224:227], v[108:111]
    ds_read2_b32 v[156:157], v31 offset0:192 offset1:193
    v_mfma_f32_16x16x32_bf16 v[112:115], v[204:207], v[228:231], v[112:115]
    ds_read2_b32 v[158:159], v31 offset0:194 offset1:195
    v_mfma_f32_16x16x32_bf16 v[116:119], v[204:207], v[232:235], v[116:119]
    ds_read_b128 v[188:191], v32 offset:256
    v_mfma_f32_16x16x32_bf16 v[120:123], v[204:207], v[236:239], v[120:123]
    v_mfma_f32_16x16x32_bf16 v[124:127], v[204:207], v[240:243], v[124:127]
    v_mfma_f32_16x16x32_bf16 v[112:115], v[208:211], v[224:227], v[112:115]
    v_mfma_f32_16x16x32_bf16 v[116:119], v[208:211], v[228:231], v[116:119]
    v_mfma_f32_16x16x32_bf16 v[120:123], v[208:211], v[232:235], v[120:123]
    v_mfma_f32_16x16x32_bf16 v[124:127], v[208:211], v[236:239], v[124:127]
    v_mfma_f32_16x16x32_bf16 v[116:119], v[212:215], v[224:227], v[116:119]
    v_mfma_f32_16x16x32_bf16 v[120:123], v[212:215], v[228:231], v[120:123]
    v_mfma_f32_16x16x32_bf16 v[124:127], v[212:215], v[232:235], v[124:127]
    v_mfma_f32_16x16x32_bf16 v[120:123], v[216:219], v[224:227], v[120:123]
    v_mfma_f32_16x16x32_bf16 v[124:127], v[216:219], v[228:231], v[124:127]
    v_mfma_f32_16x16x32_bf16 v[124:127], v[220:223], v[224:227], v[124:127]
    s_waitcnt lgkmcnt(0)
    v_mfma_f32_16x16x32_bf16 v[96:99], v[128:131], v[160:163], v[96:99]
    ds_read2_b32 v[192:193], v28 offset0:80 offset1:81
    v_mfma_f32_16x16x32_bf16 v[100:103], v[128:131], v[164:167], v[100:103]
    ds_read2_b32 v[194:195], v28 offset0:82 offset1:83
    v_mfma_f32_16x16x32_bf16 v[104:107], v[128:131], v[168:171], v[104:107]
    ds_read_b128 v[224:227], v32 offset:3904
    v_mfma_f32_16x16x32_bf16 v[108:111], v[128:131], v[172:175], v[108:111]
    ds_read2_b32 v[196:197], v28 offset0:208 offset1:209
    v_mfma_f32_16x16x32_bf16 v[112:115], v[128:131], v[176:179], v[112:115]
    ds_read2_b32 v[198:199], v28 offset0:210 offset1:211
    v_mfma_f32_16x16x32_bf16 v[116:119], v[128:131], v[180:183], v[116:119]
    ds_read_b128 v[228:231], v32 offset:3392
    v_mfma_f32_16x16x32_bf16 v[120:123], v[128:131], v[184:187], v[120:123]
    ds_read2_b32 v[200:201], v29 offset0:80 offset1:81
    v_mfma_f32_16x16x32_bf16 v[124:127], v[128:131], v[188:191], v[124:127]
    ds_read2_b32 v[202:203], v29 offset0:82 offset1:83
    v_mfma_f32_16x16x32_bf16 v[100:103], v[132:135], v[160:163], v[100:103]
    ds_read_b128 v[232:235], v32 offset:2880
    v_mfma_f32_16x16x32_bf16 v[104:107], v[132:135], v[164:167], v[104:107]
    ds_read2_b32 v[204:205], v29 offset0:208 offset1:209
    v_mfma_f32_16x16x32_bf16 v[108:111], v[132:135], v[168:171], v[108:111]
    ds_read2_b32 v[206:207], v29 offset0:210 offset1:211
    v_mfma_f32_16x16x32_bf16 v[112:115], v[132:135], v[172:175], v[112:115]
    ds_read_b128 v[236:239], v32 offset:2368
    v_mfma_f32_16x16x32_bf16 v[116:119], v[132:135], v[176:179], v[116:119]
    ds_read2_b32 v[208:209], v30 offset0:80 offset1:81
    v_mfma_f32_16x16x32_bf16 v[120:123], v[132:135], v[180:183], v[120:123]
    ds_read2_b32 v[210:211], v30 offset0:82 offset1:83
    v_mfma_f32_16x16x32_bf16 v[124:127], v[132:135], v[184:187], v[124:127]
    ds_read_b128 v[240:243], v32 offset:1856
    v_mfma_f32_16x16x32_bf16 v[104:107], v[136:139], v[160:163], v[104:107]
    ds_read2_b32 v[212:213], v30 offset0:208 offset1:209
    v_mfma_f32_16x16x32_bf16 v[108:111], v[136:139], v[164:167], v[108:111]
    ds_read2_b32 v[214:215], v30 offset0:210 offset1:211
    v_mfma_f32_16x16x32_bf16 v[112:115], v[136:139], v[168:171], v[112:115]
    ds_read_b128 v[244:247], v32 offset:1344
    v_mfma_f32_16x16x32_bf16 v[116:119], v[136:139], v[172:175], v[116:119]
    ds_read2_b32 v[216:217], v31 offset0:80 offset1:81
    v_mfma_f32_16x16x32_bf16 v[120:123], v[136:139], v[176:179], v[120:123]
    ds_read2_b32 v[218:219], v31 offset0:82 offset1:83
    v_mfma_f32_16x16x32_bf16 v[124:127], v[136:139], v[180:183], v[124:127]
    ds_read_b128 v[248:251], v32 offset:832
    v_mfma_f32_16x16x32_bf16 v[108:111], v[140:143], v[160:163], v[108:111]
    ds_read2_b32 v[220:221], v31 offset0:208 offset1:209
    v_mfma_f32_16x16x32_bf16 v[112:115], v[140:143], v[164:167], v[112:115]
    ds_read2_b32 v[222:223], v31 offset0:210 offset1:211
    v_mfma_f32_16x16x32_bf16 v[116:119], v[140:143], v[168:171], v[116:119]
    ds_read_b128 v[252:255], v32 offset:320
    v_mfma_f32_16x16x32_bf16 v[120:123], v[140:143], v[172:175], v[120:123]
    v_mfma_f32_16x16x32_bf16 v[124:127], v[140:143], v[176:179], v[124:127]
    v_mfma_f32_16x16x32_bf16 v[112:115], v[144:147], v[160:163], v[112:115]
    v_mfma_f32_16x16x32_bf16 v[116:119], v[144:147], v[164:167], v[116:119]
    v_mfma_f32_16x16x32_bf16 v[120:123], v[144:147], v[168:171], v[120:123]
    v_mfma_f32_16x16x32_bf16 v[124:127], v[144:147], v[172:175], v[124:127]
    v_mfma_f32_16x16x32_bf16 v[116:119], v[148:151], v[160:163], v[116:119]
    v_mfma_f32_16x16x32_bf16 v[120:123], v[148:151], v[164:167], v[120:123]
    v_mfma_f32_16x16x32_bf16 v[124:127], v[148:151], v[168:171], v[124:127]
    v_mfma_f32_16x16x32_bf16 v[120:123], v[152:155], v[160:163], v[120:123]
    v_mfma_f32_16x16x32_bf16 v[124:127], v[152:155], v[164:167], v[124:127]
    v_mfma_f32_16x16x32_bf16 v[124:127], v[156:159], v[160:163], v[124:127]
    s_waitcnt lgkmcnt(0)
    v_mfma_f32_16x16x32_bf16 v[96:99], v[192:195], v[224:227], v[96:99]
    ds_read2_b32 v[128:129], v28 offset0:96 offset1:97
    v_mfma_f32_16x16x32_bf16 v[100:103], v[192:195], v[228:231], v[100:103]
    ds_read2_b32 v[130:131], v28 offset0:98 offset1:99
    v_mfma_f32_16x16x32_bf16 v[104:107], v[192:195], v[232:235], v[104:107]
    ds_read_b128 v[160:163], v32 offset:3968
    v_mfma_f32_16x16x32_bf16 v[108:111], v[192:195], v[236:239], v[108:111]
    ds_read2_b32 v[132:133], v28 offset0:224 offset1:225
    v_mfma_f32_16x16x32_bf16 v[112:115], v[192:195], v[240:243], v[112:115]
    ds_read2_b32 v[134:135], v28 offset0:226 offset1:227
    v_mfma_f32_16x16x32_bf16 v[116:119], v[192:195], v[244:247], v[116:119]
    ds_read_b128 v[164:167], v32 offset:3456
    v_mfma_f32_16x16x32_bf16 v[120:123], v[192:195], v[248:251], v[120:123]
    ds_read2_b32 v[136:137], v29 offset0:96 offset1:97
    v_mfma_f32_16x16x32_bf16 v[124:127], v[192:195], v[252:255], v[124:127]
    ds_read2_b32 v[138:139], v29 offset0:98 offset1:99
    v_mfma_f32_16x16x32_bf16 v[100:103], v[196:199], v[224:227], v[100:103]
    ds_read_b128 v[168:171], v32 offset:2944
    v_mfma_f32_16x16x32_bf16 v[104:107], v[196:199], v[228:231], v[104:107]
    ds_read2_b32 v[140:141], v29 offset0:224 offset1:225
    v_mfma_f32_16x16x32_bf16 v[108:111], v[196:199], v[232:235], v[108:111]
    ds_read2_b32 v[142:143], v29 offset0:226 offset1:227
    v_mfma_f32_16x16x32_bf16 v[112:115], v[196:199], v[236:239], v[112:115]
    ds_read_b128 v[172:175], v32 offset:2432
    v_mfma_f32_16x16x32_bf16 v[116:119], v[196:199], v[240:243], v[116:119]
    ds_read2_b32 v[144:145], v30 offset0:96 offset1:97
    v_mfma_f32_16x16x32_bf16 v[120:123], v[196:199], v[244:247], v[120:123]
    ds_read2_b32 v[146:147], v30 offset0:98 offset1:99
    v_mfma_f32_16x16x32_bf16 v[124:127], v[196:199], v[248:251], v[124:127]
    ds_read_b128 v[176:179], v32 offset:1920
    v_mfma_f32_16x16x32_bf16 v[104:107], v[200:203], v[224:227], v[104:107]
    ds_read2_b32 v[148:149], v30 offset0:224 offset1:225
    v_mfma_f32_16x16x32_bf16 v[108:111], v[200:203], v[228:231], v[108:111]
    ds_read2_b32 v[150:151], v30 offset0:226 offset1:227
    v_mfma_f32_16x16x32_bf16 v[112:115], v[200:203], v[232:235], v[112:115]
    ds_read_b128 v[180:183], v32 offset:1408
    v_mfma_f32_16x16x32_bf16 v[116:119], v[200:203], v[236:239], v[116:119]
    ds_read2_b32 v[152:153], v31 offset0:96 offset1:97
    v_mfma_f32_16x16x32_bf16 v[120:123], v[200:203], v[240:243], v[120:123]
    ds_read2_b32 v[154:155], v31 offset0:98 offset1:99
    v_mfma_f32_16x16x32_bf16 v[124:127], v[200:203], v[244:247], v[124:127]
    ds_read_b128 v[184:187], v32 offset:896
    v_mfma_f32_16x16x32_bf16 v[108:111], v[204:207], v[224:227], v[108:111]
    ds_read2_b32 v[156:157], v31 offset0:224 offset1:225
    v_mfma_f32_16x16x32_bf16 v[112:115], v[204:207], v[228:231], v[112:115]
    ds_read2_b32 v[158:159], v31 offset0:226 offset1:227
    v_mfma_f32_16x16x32_bf16 v[116:119], v[204:207], v[232:235], v[116:119]
    ds_read_b128 v[188:191], v32 offset:384
    v_mfma_f32_16x16x32_bf16 v[120:123], v[204:207], v[236:239], v[120:123]
    v_mfma_f32_16x16x32_bf16 v[124:127], v[204:207], v[240:243], v[124:127]
    v_mfma_f32_16x16x32_bf16 v[112:115], v[208:211], v[224:227], v[112:115]
    v_mfma_f32_16x16x32_bf16 v[116:119], v[208:211], v[228:231], v[116:119]
    v_mfma_f32_16x16x32_bf16 v[120:123], v[208:211], v[232:235], v[120:123]
    v_mfma_f32_16x16x32_bf16 v[124:127], v[208:211], v[236:239], v[124:127]
    v_mfma_f32_16x16x32_bf16 v[116:119], v[212:215], v[224:227], v[116:119]
    v_mfma_f32_16x16x32_bf16 v[120:123], v[212:215], v[228:231], v[120:123]
    v_mfma_f32_16x16x32_bf16 v[124:127], v[212:215], v[232:235], v[124:127]
    v_mfma_f32_16x16x32_bf16 v[120:123], v[216:219], v[224:227], v[120:123]
    v_mfma_f32_16x16x32_bf16 v[124:127], v[216:219], v[228:231], v[124:127]
    v_mfma_f32_16x16x32_bf16 v[124:127], v[220:223], v[224:227], v[124:127]
    s_waitcnt lgkmcnt(0)
    v_mfma_f32_16x16x32_bf16 v[96:99], v[128:131], v[160:163], v[96:99]
    ds_read2_b32 v[192:193], v28 offset0:112 offset1:113
    v_mfma_f32_16x16x32_bf16 v[100:103], v[128:131], v[164:167], v[100:103]
    ds_read2_b32 v[194:195], v28 offset0:114 offset1:115
    v_mfma_f32_16x16x32_bf16 v[104:107], v[128:131], v[168:171], v[104:107]
    ds_read_b128 v[224:227], v32 offset:4032
    v_mfma_f32_16x16x32_bf16 v[108:111], v[128:131], v[172:175], v[108:111]
    ds_read2_b32 v[196:197], v28 offset0:240 offset1:241
    v_mfma_f32_16x16x32_bf16 v[112:115], v[128:131], v[176:179], v[112:115]
    ds_read2_b32 v[198:199], v28 offset0:242 offset1:243
    v_mfma_f32_16x16x32_bf16 v[116:119], v[128:131], v[180:183], v[116:119]
    ds_read_b128 v[228:231], v32 offset:3520
    v_mfma_f32_16x16x32_bf16 v[120:123], v[128:131], v[184:187], v[120:123]
    ds_read2_b32 v[200:201], v29 offset0:112 offset1:113
    v_mfma_f32_16x16x32_bf16 v[124:127], v[128:131], v[188:191], v[124:127]
    ds_read2_b32 v[202:203], v29 offset0:114 offset1:115
    v_mfma_f32_16x16x32_bf16 v[100:103], v[132:135], v[160:163], v[100:103]
    ds_read_b128 v[232:235], v32 offset:3008
    v_mfma_f32_16x16x32_bf16 v[104:107], v[132:135], v[164:167], v[104:107]
    ds_read2_b32 v[204:205], v29 offset0:240 offset1:241
    v_mfma_f32_16x16x32_bf16 v[108:111], v[132:135], v[168:171], v[108:111]
    ds_read2_b32 v[206:207], v29 offset0:242 offset1:243
    v_mfma_f32_16x16x32_bf16 v[112:115], v[132:135], v[172:175], v[112:115]
    ds_read_b128 v[236:239], v32 offset:2496
    v_mfma_f32_16x16x32_bf16 v[116:119], v[132:135], v[176:179], v[116:119]
    ds_read2_b32 v[208:209], v30 offset0:112 offset1:113
    v_mfma_f32_16x16x32_bf16 v[120:123], v[132:135], v[180:183], v[120:123]
    ds_read2_b32 v[210:211], v30 offset0:114 offset1:115
    v_mfma_f32_16x16x32_bf16 v[124:127], v[132:135], v[184:187], v[124:127]
    ds_read_b128 v[240:243], v32 offset:1984
    v_mfma_f32_16x16x32_bf16 v[104:107], v[136:139], v[160:163], v[104:107]
    ds_read2_b32 v[212:213], v30 offset0:240 offset1:241
    v_mfma_f32_16x16x32_bf16 v[108:111], v[136:139], v[164:167], v[108:111]
    ds_read2_b32 v[214:215], v30 offset0:242 offset1:243
    v_mfma_f32_16x16x32_bf16 v[112:115], v[136:139], v[168:171], v[112:115]
    ds_read_b128 v[244:247], v32 offset:1472
    v_mfma_f32_16x16x32_bf16 v[116:119], v[136:139], v[172:175], v[116:119]
    ds_read2_b32 v[216:217], v31 offset0:112 offset1:113
    v_mfma_f32_16x16x32_bf16 v[120:123], v[136:139], v[176:179], v[120:123]
    ds_read2_b32 v[218:219], v31 offset0:114 offset1:115
    v_mfma_f32_16x16x32_bf16 v[124:127], v[136:139], v[180:183], v[124:127]
    ds_read_b128 v[248:251], v32 offset:960
    v_mfma_f32_16x16x32_bf16 v[108:111], v[140:143], v[160:163], v[108:111]
    ds_read2_b32 v[220:221], v31 offset0:240 offset1:241
    v_mfma_f32_16x16x32_bf16 v[112:115], v[140:143], v[164:167], v[112:115]
    ds_read2_b32 v[222:223], v31 offset0:242 offset1:243
    v_mfma_f32_16x16x32_bf16 v[116:119], v[140:143], v[168:171], v[116:119]
    ds_read_b128 v[252:255], v32 offset:448
    v_mfma_f32_16x16x32_bf16 v[120:123], v[140:143], v[172:175], v[120:123]
    v_mfma_f32_16x16x32_bf16 v[124:127], v[140:143], v[176:179], v[124:127]
    v_mfma_f32_16x16x32_bf16 v[112:115], v[144:147], v[160:163], v[112:115]
    v_mfma_f32_16x16x32_bf16 v[116:119], v[144:147], v[164:167], v[116:119]
    v_mfma_f32_16x16x32_bf16 v[120:123], v[144:147], v[168:171], v[120:123]
    v_mfma_f32_16x16x32_bf16 v[124:127], v[144:147], v[172:175], v[124:127]
    v_mfma_f32_16x16x32_bf16 v[116:119], v[148:151], v[160:163], v[116:119]
    v_mfma_f32_16x16x32_bf16 v[120:123], v[148:151], v[164:167], v[120:123]
    v_mfma_f32_16x16x32_bf16 v[124:127], v[148:151], v[168:171], v[124:127]
    v_mfma_f32_16x16x32_bf16 v[120:123], v[152:155], v[160:163], v[120:123]
    v_mfma_f32_16x16x32_bf16 v[124:127], v[152:155], v[164:167], v[124:127]
    v_mfma_f32_16x16x32_bf16 v[124:127], v[156:159], v[160:163], v[124:127]
    s_waitcnt lgkmcnt(0)
    v_mfma_f32_16x16x32_bf16 v[96:99], v[192:195], v[224:227], v[96:99]
    v_mfma_f32_16x16x32_bf16 v[100:103], v[192:195], v[228:231], v[100:103]
    v_mfma_f32_16x16x32_bf16 v[104:107], v[192:195], v[232:235], v[104:107]
    v_mfma_f32_16x16x32_bf16 v[108:111], v[192:195], v[236:239], v[108:111]
    v_mfma_f32_16x16x32_bf16 v[112:115], v[192:195], v[240:243], v[112:115]
    v_mfma_f32_16x16x32_bf16 v[116:119], v[192:195], v[244:247], v[116:119]
    v_mfma_f32_16x16x32_bf16 v[120:123], v[192:195], v[248:251], v[120:123]
    v_mfma_f32_16x16x32_bf16 v[124:127], v[192:195], v[252:255], v[124:127]
    v_mfma_f32_16x16x32_bf16 v[100:103], v[196:199], v[224:227], v[100:103]
    v_mfma_f32_16x16x32_bf16 v[104:107], v[196:199], v[228:231], v[104:107]
    v_mfma_f32_16x16x32_bf16 v[108:111], v[196:199], v[232:235], v[108:111]
    v_mfma_f32_16x16x32_bf16 v[112:115], v[196:199], v[236:239], v[112:115]
    v_mfma_f32_16x16x32_bf16 v[116:119], v[196:199], v[240:243], v[116:119]
    v_mfma_f32_16x16x32_bf16 v[120:123], v[196:199], v[244:247], v[120:123]
    v_mfma_f32_16x16x32_bf16 v[124:127], v[196:199], v[248:251], v[124:127]
    v_mfma_f32_16x16x32_bf16 v[104:107], v[200:203], v[224:227], v[104:107]
    v_mfma_f32_16x16x32_bf16 v[108:111], v[200:203], v[228:231], v[108:111]
    v_mfma_f32_16x16x32_bf16 v[112:115], v[200:203], v[232:235], v[112:115]
    v_mfma_f32_16x16x32_bf16 v[116:119], v[200:203], v[236:239], v[116:119]
    v_mfma_f32_16x16x32_bf16 v[120:123], v[200:203], v[240:243], v[120:123]
    v_mfma_f32_16x16x32_bf16 v[124:127], v[200:203], v[244:247], v[124:127]
    v_mfma_f32_16x16x32_bf16 v[108:111], v[204:207], v[224:227], v[108:111]
    v_mfma_f32_16x16x32_bf16 v[112:115], v[204:207], v[228:231], v[112:115]
    v_mfma_f32_16x16x32_bf16 v[116:119], v[204:207], v[232:235], v[116:119]
    v_mfma_f32_16x16x32_bf16 v[120:123], v[204:207], v[236:239], v[120:123]
    v_mfma_f32_16x16x32_bf16 v[124:127], v[204:207], v[240:243], v[124:127]
    v_mfma_f32_16x16x32_bf16 v[112:115], v[208:211], v[224:227], v[112:115]
    v_mfma_f32_16x16x32_bf16 v[116:119], v[208:211], v[228:231], v[116:119]
    v_mfma_f32_16x16x32_bf16 v[120:123], v[208:211], v[232:235], v[120:123]
    v_mfma_f32_16x16x32_bf16 v[124:127], v[208:211], v[236:239], v[124:127]
    v_mfma_f32_16x16x32_bf16 v[116:119], v[212:215], v[224:227], v[116:119]
    v_mfma_f32_16x16x32_bf16 v[120:123], v[212:215], v[228:231], v[120:123]
    v_mfma_f32_16x16x32_bf16 v[124:127], v[212:215], v[232:235], v[124:127]
    v_mfma_f32_16x16x32_bf16 v[120:123], v[216:219], v[224:227], v[120:123]
    v_mfma_f32_16x16x32_bf16 v[124:127], v[216:219], v[228:231], v[124:127]
    v_mfma_f32_16x16x32_bf16 v[124:127], v[220:223], v[224:227], v[124:127]
    s_setprio 0
    v_cvt_pk_bf16_f32 v192, v96, v97
    v_cvt_pk_bf16_f32 v193, v98, v99
    v_cvt_pk_bf16_f32 v194, v100, v101
    v_cvt_pk_bf16_f32 v195, v102, v103
    v_cvt_pk_bf16_f32 v196, v104, v105
    v_cvt_pk_bf16_f32 v197, v106, v107
    v_cvt_pk_bf16_f32 v198, v108, v109
    v_cvt_pk_bf16_f32 v199, v110, v111
    v_cvt_pk_bf16_f32 v200, v112, v113
    v_cvt_pk_bf16_f32 v201, v114, v115
    v_cvt_pk_bf16_f32 v202, v116, v117
    v_cvt_pk_bf16_f32 v203, v118, v119
    v_cvt_pk_bf16_f32 v204, v120, v121
    v_cvt_pk_bf16_f32 v205, v122, v123
    v_cvt_pk_bf16_f32 v206, v124, v125
    v_cvt_pk_bf16_f32 v207, v126, v127
    v_add_u32 v33, s101, v26
    s_waitcnt vmcnt(0)
    ds_write_b128 v33, v[64:67] offset:0
    ds_write_b128 v33, v[68:71] offset:1024
    ds_write_b128 v33, v[72:75] offset:2048
    ds_write_b128 v33, v[76:79] offset:3072
    ds_write_b128 v33, v[80:83] offset:4096
    ds_write_b128 v33, v[84:87] offset:5120
    ds_write_b128 v33, v[88:91] offset:6144
    ds_write_b128 v33, v[92:95] offset:7168
    ds_write_b128 v33, v[40:43] offset:8192
    ds_write_b128 v33, v[44:47] offset:9216
    ds_write_b128 v33, v[48:51] offset:10240
    ds_write_b128 v33, v[52:55] offset:11264
    v_mov_b32 v60, 1
    s_mov_b64 exec, 1
    ds_add_u32 v21, v60 offset:68
    s_mov_b64 exec, -1
    s_mov_b32 s15, 0
L_zs_w:
    ds_read_b32 v60, v21 offset:56
    s_waitcnt lgkmcnt(0)
    v_cmp_gt_u32 vcc, 1, v60
    s_cbranch_vccz L_zs_ok
    s_sleep 2
    s_add_u32 s15, s15, 1
    s_cmp_lt_u32 s15, 160000
    s_cbranch_scc1 L_zs_w
L_zs_ok:
    v_permlane16_swap_b32 v192, v194
    v_permlane16_swap_b32 v193, v195
    buffer_store_dwordx4 v[192:195], v17, s[56:59], s36 offen offset:0 sc1
    v_permlane16_swap_b32 v196, v198
    v_permlane16_swap_b32 v197, v199
    buffer_store_dwordx4 v[196:199], v17, s[56:59], s36 offen offset:1024 sc1
    v_permlane16_swap_b32 v200, v202
    v_permlane16_swap_b32 v201, v203
    buffer_store_dwordx4 v[200:203], v17, s[56:59], s36 offen offset:2048 sc1
    v_permlane16_swap_b32 v204, v206
    v_permlane16_swap_b32 v205, v207
    buffer_store_dwordx4 v[204:207], v17, s[56:59], s36 offen offset:3072 sc1
    s_lshl_b32 s12, s100, 3
    s_add_u32 s12, s12, 8192
    v_lshlrev_b32 v28, 1, v23
    v_lshl_add_u32 v28, v24, 12, v28
    v_lshlrev_b32 v29, 2, v24
    v_lshl_add_u32 v29, v23, 13, v29
    s_waitcnt vmcnt(0)
    s_mov_b64 exec, 1
    buffer_store_dwordx2 v[0:1], v19, s[72:75], s12 offen sc1
    s_mov_b64 exec, -1
    s_mov_b32 s15, 0
L_zw_w:
    ds_read_b128 v[60:63], v21 offset:0
    s_waitcnt lgkmcnt(0)
    v_min3_u32 v60, v60, v61, v62
    v_min_u32 v60, v60, v63
    v_cmp_gt_u32 vcc, 24, v60
    s_cbranch_vccz L_zw_ok
    s_sleep 4
    s_add_u32 s15, s15, 1
    s_cmp_lt_u32 s15, 160000
    s_cbranch_scc1 L_zw_w
L_zw_ok:
    s_cmp_eq_u32 s8, 0
    s_cbranch_scc0 L_z1
    s_mov_b32 s15, 0
LZ_poll:
    buffer_load_dwordx4 v[60:63], v3, s[72:75], 0 offen sc1
    s_waitcnt vmcnt(0)
LZ_chk:
    v_cmp_ne_u64 vcc, v[60:61], v[0:1]
    v_cmp_ne_u64 s[10:11], v[62:63], v[0:1]
    s_or_b64 vcc, vcc, s[10:11]
    s_cbranch_scc0 LZ_ok
    s_sleep 4
    s_add_u32 s15, s15, 1
    s_cmp_lt_u32 s15, 20000
    s_cbranch_scc1 LZ_poll
LZ_ok:
    ds_write_b32 v21, v25 offset:48
L_z1:
    s_waitcnt vmcnt(0)
    v_lshlrev_b32 v128, 16, v4
    v_and_b32 v129, 0xffff0000, v4
    v_lshlrev_b32 v130, 16, v5
    v_and_b32 v131, 0xffff0000, v5
    v_lshlrev_b32 v132, 16, v6
    v_and_b32 v133, 0xffff0000, v6
    v_lshlrev_b32 v134, 16, v7
    v_and_b32 v135, 0xffff0000, v7
    v_lshlrev_b32 v136, 16, v8
    v_and_b32 v137, 0xffff0000, v8
    v_lshlrev_b32 v138, 16, v9
    v_and_b32 v139, 0xffff0000, v9
    v_lshlrev_b32 v140, 16, v10
    v_and_b32 v141, 0xffff0000, v10
    v_lshlrev_b32 v142, 16, v11
    v_and_b32 v143, 0xffff0000, v11
    v_lshlrev_b32 v144, 16, v14
    v_and_b32 v145, 0xffff0000, v14
    v_lshlrev_b32 v146, 16, v15
    v_and_b32 v147, 0xffff0000, v15
    v_lshlrev_b32 v148, 16, v56
    v_and_b32 v149, 0xffff0000, v56
    v_lshlrev_b32 v150, 16, v57
    v_and_b32 v151, 0xffff0000, v57
    v_lshlrev_b32 v152, 16, v58
    v_and_b32 v153, 0xffff0000, v58
    v_lshlrev_b32 v154, 16, v59
    v_and_b32 v155, 0xffff0000, v59
    v_lshlrev_b32 v156, 16, v34
    v_and_b32 v157, 0xffff0000, v34
    v_lshlrev_b32 v158, 16, v35
    v_and_b32 v159, 0xffff0000, v35
    s_mov_b32 s15, 0
L_fz_w:
    ds_read_b32 v60, v21 offset:48
    s_waitcnt lgkmcnt(0)
    v_cmp_gt_u32 vcc, 1, v60
    s_cbranch_vccz L_fz_ok
    s_sleep 1
    s_add_u32 s15, s15, 1
    s_cmp_lt_u32 s15, 160000
    s_cbranch_scc1 L_fz_w
L_fz_ok:
    buffer_load_dwordx4 v[64:67], v28, s[56:59], 0 offen sc1
    buffer_load_dwordx4 v[68:71], v28, s[56:59], s32 offen sc1
    buffer_load_dwordx4 v[72:75], v28, s[56:59], s33 offen sc1
    buffer_load_dwordx4 v[76:79], v28, s[56:59], s34 offen sc1
    s_waitcnt vmcnt(0)
    v_lshlrev_b32 v160, 16, v64
    v_lshlrev_b32 v161, 16, v68
    v_lshlrev_b32 v162, 16, v72
    v_lshlrev_b32 v163, 16, v76
    v_mul_f32 v160, v160, v128
    v_mul_f32 v161, v161, v129
    v_mul_f32 v162, v162, v130
    v_mul_f32 v163, v163, v131
    s_mov_b32 s10, 0
    buffer_store_dwordx4 v[160:163], v29, s[64:67], s10 offen nt
    v_and_b32 v164, 0xffff0000, v64
    v_and_b32 v165, 0xffff0000, v68
    v_and_b32 v166, 0xffff0000, v72
    v_and_b32 v167, 0xffff0000, v76
    v_mul_f32 v164, v164, v132
    v_mul_f32 v165, v165, v133
    v_mul_f32 v166, v166, v134
    v_mul_f32 v167, v167, v135
    s_mov_b32 s10, 8192
    buffer_store_dwordx4 v[164:167], v29, s[64:67], s10 offen nt
    v_lshlrev_b32 v168, 16, v65
    v_lshlrev_b32 v169, 16, v69
    v_lshlrev_b32 v170, 16, v73
    v_lshlrev_b32 v171, 16, v77
    v_mul_f32 v168, v168, v136
    v_mul_f32 v169, v169, v137
    v_mul_f32 v170, v170, v138
    v_mul_f32 v171, v171, v139
    s_mov_b32 s10, 16384
    buffer_store_dwordx4 v[168:171], v29, s[64:67], s10 offen nt
    v_and_b32 v172, 0xffff0000, v65
    v_and_b32 v173, 0xffff0000, v69
    v_and_b32 v174, 0xffff0000, v73
    v_and_b32 v175, 0xffff0000, v77
    v_mul_f32 v172, v172, v140
    v_mul_f32 v173, v173, v141
    v_mul_f32 v174, v174, v142
    v_mul_f32 v175, v175, v143
    s_mov_b32 s10, 24576
    buffer_store_dwordx4 v[172:175], v29, s[64:67], s10 offen nt
    v_lshlrev_b32 v176, 16, v66
    v_lshlrev_b32 v177, 16, v70
    v_lshlrev_b32 v178, 16, v74
    v_lshlrev_b32 v179, 16, v78
    v_mul_f32 v176, v176, v144
    v_mul_f32 v177, v177, v145
    v_mul_f32 v178, v178, v146
    v_mul_f32 v179, v179, v147
    s_mov_b32 s10, 32768
    buffer_store_dwordx4 v[176:179], v29, s[64:67], s10 offen nt
    v_and_b32 v180, 0xffff0000, v66
    v_and_b32 v181, 0xffff0000, v70
    v_and_b32 v182, 0xffff0000, v74
    v_and_b32 v183, 0xffff0000, v78
    v_mul_f32 v180, v180, v148
    v_mul_f32 v181, v181, v149
    v_mul_f32 v182, v182, v150
    v_mul_f32 v183, v183, v151
    s_mov_b32 s10, 40960
    buffer_store_dwordx4 v[180:183], v29, s[64:67], s10 offen nt
    v_lshlrev_b32 v184, 16, v67
    v_lshlrev_b32 v185, 16, v71
    v_lshlrev_b32 v186, 16, v75
    v_lshlrev_b32 v187, 16, v79
    v_mul_f32 v184, v184, v152
    v_mul_f32 v185, v185, v153
    v_mul_f32 v186, v186, v154
    v_mul_f32 v187, v187, v155
    s_mov_b32 s10, 49152
    buffer_store_dwordx4 v[184:187], v29, s[64:67], s10 offen nt
    v_and_b32 v188, 0xffff0000, v67
    v_and_b32 v189, 0xffff0000, v71
    v_and_b32 v190, 0xffff0000, v75
    v_and_b32 v191, 0xffff0000, v79
    v_mul_f32 v188, v188, v156
    v_mul_f32 v189, v189, v157
    v_mul_f32 v190, v190, v158
    v_mul_f32 v191, v191, v159
    s_mov_b32 s10, 57344
    buffer_store_dwordx4 v[188:191], v29, s[64:67], s10 offen nt
    s_waitcnt vmcnt(0)
    s_endpgm
Y_G:
    s_setprio 0
    v_and_b32 v3, 31, v2
    v_mov_b32 v23, 0
    v_mov_b32 v11, 163712
    v_lshrrev_b32 v4, 5, v2
    s_lshr_b32 s8, s3, 1
    s_and_b32 s9, s3, 1
    s_lshl_b32 s10, s7, 6
    s_lshl_b32 s11, s9, 5
    s_add_u32 s10, s10, s11
    v_add_u32 v5, s10, v3
    v_lshlrev_b32 v48, 1, v5
    s_lshl_b32 s10, s7, 7
    v_and_b32 v49, 15, v2
    v_lshl_add_u32 v49, v49, 3, s10
    s_lshl_b32 s10, s3, 2
    s_add_u32 s10, s10, 163712
    v_mov_b32 v10, s10
    s_waitcnt lgkmcnt(0)
    s_mov_b32 s76, s48
    s_mov_b32 s77, s49
    s_mov_b32 s78, 256
    s_mov_b32 s79, 0x00020000
    s_or_b32 s10, s2, s3
    s_cmp_eq_u32 s10, 0
    s_cbranch_scc0 G_nononce
    s_memrealtime s[10:11]
    s_waitcnt lgkmcnt(0)
    s_or_b32 s10, s10, 1
    v_mov_b32 v54, s10
    v_mov_b32 v55, s11
    s_mov_b64 exec, 1
    buffer_store_dwordx2 v[54:55], v23, s[76:79], 0 offen sc1
    s_mov_b64 exec, -1
G_nononce:
    s_mov_b32 s52, s42
    s_mov_b32 s53, s43
    s_mov_b32 s54, 2048
    s_mov_b32 s55, 0x00020000
    buffer_load_ushort v12, v48, s[52:55], 0 offen
    s_mov_b32 s52, s30
    s_mov_b32 s53, s31
    buffer_load_ushort v13, v48, s[52:55], 0 offen
    s_mov_b32 s52, s32
    s_mov_b32 s53, s33
    buffer_load_ushort v14, v48, s[52:55], 0 offen
    s_mov_b32 s52, s44
    s_mov_b32 s53, s45
    buffer_load_dwordx2 v[24:25], v49, s[52:55], 0 offen
    s_mov_b32 s52, s28
    s_mov_b32 s53, s29
    s_mov_b32 s54, 4194304
    s_mov_b32 s55, 0x00020000
    s_mov_b32 s60, s46
    s_mov_b32 s61, s47
    s_mov_b32 s62, 16777216
    s_mov_b32 s63, 0x00020000
    s_add_u32 s64, s50, 16777216
    s_addc_u32 s65, s51, 0
    s_mov_b32 s66, 278528
    s_mov_b32 s67, 0x00020000
    s_add_u32 s68, s50, 8388608
    s_addc_u32 s69, s51, 0
    s_mov_b32 s70, 8388608
    s_mov_b32 s71, 0x00020000
    s_add_u32 s72, s50, 17825792
    s_addc_u32 s73, s51, 0
    s_mov_b32 s74, 65536
    s_mov_b32 s75, 0x00020000
    s_cmp_eq_u32 s9, 1
    s_cselect_b32 s80, s40, s38
    s_cselect_b32 s81, s41, s39
    s_mov_b32 s82, 2097152
    s_mov_b32 s83, 0x00020000
    s_lshl_b32 s10, s6, 7
    s_lshl_b32 s11, s3, 5
    s_add_u32 s10, s10, s11
    v_lshrrev_b32 v50, 4, v2
    v_lshl_add_u32 v50, v50, 2, s10
    v_lshl_add_u32 v22, v50, 11, v49
    v_xor_b32 v50, 1, v4
    v_lshlrev_b32 v50, 14, v50
    v_lshl_add_u32 v53, v5, 4, v50
    v_lshlrev_b32 v26, 4, v2
    v_add_u32 v27, 4096, v26
    v_lshrrev_b32 v50, 1, v3
    v_and_b32 v50, 7, v50
    v_xor_b32 v50, v50, v4
    v_lshlrev_b32 v50, 4, v50
    v_lshl_add_u32 v50, v3, 7, v50
    s_lshl_b32 s10, s8, 13
    s_lshl_b32 s11, s9, 13
    s_add_u32 s11, s11, 16384
    v_add_u32 v32, s10, v50
    v_add_u32 v36, s11, v50
    v_xor_b32 v33, 32, v32
    v_xor_b32 v37, 32, v36
    v_xor_b32 v34, 64, v32
    v_xor_b32 v38, 64, v36
    v_xor_b32 v35, 96, v32
    v_xor_b32 v39, 96, v36
    v_add_u32 v40, 65536, v32
    v_add_u32 v41, 65536, v33
    v_add_u32 v42, 65536, v34
    v_add_u32 v43, 65536, v35
    v_add_u32 v44, 65536, v36
    v_add_u32 v45, 65536, v37
    v_add_u32 v46, 65536, v38
    v_add_u32 v47, 65536, v39
    v_mov_b32 v64, 0
    v_mov_b32 v65, 0
    v_mov_b32 v66, 0
    v_mov_b32 v67, 0
    v_mov_b32 v68, 0
    v_mov_b32 v69, 0
    v_mov_b32 v70, 0
    v_mov_b32 v71, 0
    v_mov_b32 v72, 0
    v_mov_b32 v73, 0
    v_mov_b32 v74, 0
    v_mov_b32 v75, 0
    v_mov_b32 v76, 0
    v_mov_b32 v77, 0
    v_mov_b32 v78, 0
    v_mov_b32 v79, 0
    v_mov_b32 v80, 0
    v_mov_b32 v81, 0
    v_mov_b32 v82, 0
    v_mov_b32 v83, 0
    v_mov_b32 v84, 0
    v_mov_b32 v85, 0
    v_mov_b32 v86, 0
    v_mov_b32 v87, 0
    v_mov_b32 v88, 0
    v_mov_b32 v89, 0
    v_mov_b32 v90, 0
    v_mov_b32 v91, 0
    v_mov_b32 v92, 0
    v_mov_b32 v93, 0
    v_mov_b32 v94, 0
    v_mov_b32 v95, 0
    v_mov_b32 v96, 0
    v_mov_b32 v97, 0
    v_mov_b32 v98, 0
    v_mov_b32 v99, 0
    v_mov_b32 v100, 0
    v_mov_b32 v101, 0
    v_mov_b32 v102, 0
    v_mov_b32 v103, 0
    v_mov_b32 v104, 0
    v_mov_b32 v105, 0
    v_mov_b32 v106, 0
    v_mov_b32 v107, 0
    v_mov_b32 v108, 0
    v_mov_b32 v109, 0
    v_mov_b32 v110, 0
    v_mov_b32 v111, 0
    v_mov_b32 v112, 0
    v_mov_b32 v113, 0
    v_mov_b32 v114, 0
    v_mov_b32 v115, 0
    v_mov_b32 v116, 0
    v_mov_b32 v117, 0
    v_mov_b32 v118, 0
    v_mov_b32 v119, 0
    v_mov_b32 v120, 0
    v_mov_b32 v121, 0
    v_mov_b32 v122, 0
    v_mov_b32 v123, 0
    v_mov_b32 v124, 0
    v_mov_b32 v125, 0
    v_mov_b32 v126, 0
    v_mov_b32 v127, 0
    s_lshl_b32 s10, s8, 10
    s_lshl_b32 s11, s9, 9
    s_add_u32 s10, s10, s11
    s_add_u32 s10, s10, 151552
    v_lshl_add_u32 v0, v3, 4, s10
    v_xor_b32 v1, 1024, v0
    s_lshl_b32 s10, s8, 1
    s_sub_i32 s10, s6, s10
    v_sub_u32 v56, s10, v4
    v_add_u32 v57, 0, v56
    v_max_i32 v57, 0, v57
    v_lshlrev_b32 v57, 14, v57
    v_lshl_add_u32 v60, v5, 4, v57
    v_add_u32 v57, -4, v56
    v_max_i32 v57, 0, v57
    v_lshlrev_b32 v57, 14, v57
    v_lshl_add_u32 v61, v5, 4, v57
    v_add_u32 v57, -8, v56
    v_max_i32 v57, 0, v57
    v_lshlrev_b32 v57, 14, v57
    v_lshl_add_u32 v62, v5, 4, v57
    v_add_u32 v57, -12, v56
    v_max_i32 v57, 0, v57
    v_lshlrev_b32 v57, 14, v57
    v_lshl_add_u32 v63, v5, 4, v57
    s_mov_b32 s15, 0
G_s0_w:
    ds_read_b64 v[48:49], v11 offset:16
    s_waitcnt lgkmcnt(0)
    v_min_u32 v48, v48, v49
    v_cmp_gt_u32 vcc, 1, v48
    s_cbranch_vccz G_s0_ok
    s_add_u32 s15, s15, 1
    s_cmp_lt_u32 s15, 160000
    s_cbranch_scc1 G_s0_w
G_s0_ok:
    ds_read_b128 v[128:131], v32 offset:0
    ds_read_b128 v[136:139], v36 offset:0
    ds_read_b128 v[140:143], v36 offset:4096
    ds_read_b128 v[132:135], v32 offset:4096
    ds_read_b128 v[144:147], v33 offset:0
    ds_read_b128 v[152:155], v37 offset:0
    ds_read_b128 v[156:159], v37 offset:4096
    ds_read_b128 v[148:151], v33 offset:4096
    ds_read_b128 v[160:163], v34 offset:0
    ds_read_b128 v[168:171], v38 offset:0
    ds_read_b128 v[172:175], v38 offset:4096
    ds_read_b128 v[164:167], v34 offset:4096
    ds_read_b128 v[176:179], v35 offset:0
    ds_read_b128 v[184:187], v39 offset:0
    ds_read_b128 v[188:191], v39 offset:4096
    ds_read_b128 v[180:183], v35 offset:4096
    ds_read_b64 v[48:49], v11 offset:16
    v_mov_b32 v52, 1
    s_mov_b32 s12, 2
    s_waitcnt lgkmcnt(0)
    ds_write_b32 v10, v52
G1_loop:
    v_mfma_f32_32x32x16_bf16 v[64:79], v[128:131], v[136:139], v[64:79]
    s_waitcnt lgkmcnt(0)
    v_min_u32 v48, v48, v49
    v_cmp_gt_u32 vcc, s12, v48
    s_cbranch_vccnz G1_slow0
G1_back0:
    ds_read_b128 v[192:195], v32 offset:32768
    ds_read_b128 v[200:203], v36 offset:32768
    v_mfma_f32_32x32x16_bf16 v[80:95], v[128:131], v[140:143], v[80:95]
    ds_read_b128 v[204:207], v36 offset:36864
    ds_read_b128 v[196:199], v32 offset:36864
    v_mfma_f32_32x32x16_bf16 v[96:111], v[132:135], v[136:139], v[96:111]
    ds_read_b128 v[208:211], v33 offset:32768
    ds_read_b128 v[216:219], v37 offset:32768
    v_mfma_f32_32x32x16_bf16 v[112:127], v[132:135], v[140:143], v[112:127]
    ds_read_b128 v[220:223], v37 offset:36864
    ds_read_b128 v[212:215], v33 offset:36864
    v_mfma_f32_32x32x16_bf16 v[64:79], v[144:147], v[152:155], v[64:79]
    ds_read_b128 v[224:227], v34 offset:32768
    ds_read_b128 v[232:235], v38 offset:32768
    v_mfma_f32_32x32x16_bf16 v[80:95], v[144:147], v[156:159], v[80:95]
    ds_read_b128 v[236:239], v38 offset:36864
    ds_read_b128 v[228:231], v34 offset:36864
    v_mfma_f32_32x32x16_bf16 v[96:111], v[148:151], v[152:155], v[96:111]
    ds_read_b128 v[240:243], v35 offset:32768
    ds_read_b128 v[248:251], v39 offset:32768
    v_mfma_f32_32x32x16_bf16 v[112:127], v[148:151], v[156:159], v[112:127]
    ds_read_b128 v[252:255], v39 offset:36864
    ds_read_b128 v[244:247], v35 offset:36864
    v_mfma_f32_32x32x16_bf16 v[64:79], v[160:163], v[168:171], v[64:79]
    v_mfma_f32_32x32x16_bf16 v[80:95], v[160:163], v[172:175], v[80:95]
    v_mfma_f32_32x32x16_bf16 v[96:111], v[164:167], v[168:171], v[96:111]
    v_mfma_f32_32x32x16_bf16 v[112:127], v[164:167], v[172:175], v[112:127]
    v_mfma_f32_32x32x16_bf16 v[64:79], v[176:179], v[184:187], v[64:79]
    v_mov_b32 v52, s12
    s_waitcnt lgkmcnt(0)
    ds_write_b32 v10, v52
    s_add_u32 s12, s12, 1
    v_mfma_f32_32x32x16_bf16 v[80:95], v[176:179], v[188:191], v[80:95]
    ds_read_b64 v[48:49], v11 offset:16
    v_mfma_f32_32x32x16_bf16 v[96:111], v[180:183], v[184:187], v[96:111]
    v_mfma_f32_32x32x16_bf16 v[112:127], v[180:183], v[188:191], v[112:127]
    v_mfma_f32_32x32x16_bf16 v[64:79], v[192:195], v[200:203], v[64:79]
    s_waitcnt lgkmcnt(0)
    v_min_u32 v48, v48, v49
    v_cmp_gt_u32 vcc, s12, v48
    s_cbranch_vccnz G1_slow1
G1_back1:
    ds_read_b128 v[128:131], v40 offset:0
    ds_read_b128 v[136:139], v44 offset:0
    v_mfma_f32_32x32x16_bf16 v[80:95], v[192:195], v[204:207], v[80:95]
    ds_read_b128 v[140:143], v44 offset:4096
    ds_read_b128 v[132:135], v40 offset:4096
    v_mfma_f32_32x32x16_bf16 v[96:111], v[196:199], v[200:203], v[96:111]
    ds_read_b128 v[144:147], v41 offset:0
    ds_read_b128 v[152:155], v45 offset:0
    v_mfma_f32_32x32x16_bf16 v[112:127], v[196:199], v[204:207], v[112:127]
    ds_read_b128 v[156:159], v45 offset:4096
    ds_read_b128 v[148:151], v41 offset:4096
    v_mfma_f32_32x32x16_bf16 v[64:79], v[208:211], v[216:219], v[64:79]
    ds_read_b128 v[160:163], v42 offset:0
    ds_read_b128 v[168:171], v46 offset:0
    v_mfma_f32_32x32x16_bf16 v[80:95], v[208:211], v[220:223], v[80:95]
    ds_read_b128 v[172:175], v46 offset:4096
    ds_read_b128 v[164:167], v42 offset:4096
    v_mfma_f32_32x32x16_bf16 v[96:111], v[212:215], v[216:219], v[96:111]
    ds_read_b128 v[176:179], v43 offset:0
    ds_read_b128 v[184:187], v47 offset:0
    v_mfma_f32_32x32x16_bf16 v[112:127], v[212:215], v[220:223], v[112:127]
    ds_read_b128 v[188:191], v47 offset:4096
    ds_read_b128 v[180:183], v43 offset:4096
    v_mfma_f32_32x32x16_bf16 v[64:79], v[224:227], v[232:235], v[64:79]
    v_mfma_f32_32x32x16_bf16 v[80:95], v[224:227], v[236:239], v[80:95]
    v_mfma_f32_32x32x16_bf16 v[96:111], v[228:231], v[232:235], v[96:111]
    v_mfma_f32_32x32x16_bf16 v[112:127], v[228:231], v[236:239], v[112:127]
    v_mfma_f32_32x32x16_bf16 v[64:79], v[240:243], v[248:251], v[64:79]
    v_mov_b32 v52, s12
    s_waitcnt lgkmcnt(0)
    ds_write_b32 v10, v52
    s_add_u32 s12, s12, 1
    v_mfma_f32_32x32x16_bf16 v[80:95], v[240:243], v[252:255], v[80:95]
    ds_read_b64 v[48:49], v11 offset:16
    v_mfma_f32_32x32x16_bf16 v[96:111], v[244:247], v[248:251], v[96:111]
    v_mfma_f32_32x32x16_bf16 v[112:127], v[244:247], v[252:255], v[112:127]
    v_mfma_f32_32x32x16_bf16 v[64:79], v[128:131], v[136:139], v[64:79]
    s_waitcnt lgkmcnt(0)
    v_min_u32 v48, v48, v49
    v_cmp_gt_u32 vcc, s12, v48
    s_cbranch_vccnz G1_slow2
G1_back2:
    ds_read_b128 v[192:195], v40 offset:32768
    ds_read_b128 v[200:203], v44 offset:32768
    v_mfma_f32_32x32x16_bf16 v[80:95], v[128:131], v[140:143], v[80:95]
    ds_read_b128 v[204:207], v44 offset:36864
    ds_read_b128 v[196:199], v40 offset:36864
    v_mfma_f32_32x32x16_bf16 v[96:111], v[132:135], v[136:139], v[96:111]
    ds_read_b128 v[208:211], v41 offset:32768
    ds_read_b128 v[216:219], v45 offset:32768
    v_mfma_f32_32x32x16_bf16 v[112:127], v[132:135], v[140:143], v[112:127]
    ds_read_b128 v[220:223], v45 offset:36864
    ds_read_b128 v[212:215], v41 offset:36864
    v_mfma_f32_32x32x16_bf16 v[64:79], v[144:147], v[152:155], v[64:79]
    ds_read_b128 v[224:227], v42 offset:32768
    ds_read_b128 v[232:235], v46 offset:32768
    v_mfma_f32_32x32x16_bf16 v[80:95], v[144:147], v[156:159], v[80:95]
    ds_read_b128 v[236:239], v46 offset:36864
    ds_read_b128 v[228:231], v42 offset:36864
    v_mfma_f32_32x32x16_bf16 v[96:111], v[148:151], v[152:155], v[96:111]
    ds_read_b128 v[240:243], v43 offset:32768
    ds_read_b128 v[248:251], v47 offset:32768
    v_mfma_f32_32x32x16_bf16 v[112:127], v[148:151], v[156:159], v[112:127]
    ds_read_b128 v[252:255], v47 offset:36864
    ds_read_b128 v[244:247], v43 offset:36864
    v_mfma_f32_32x32x16_bf16 v[64:79], v[160:163], v[168:171], v[64:79]
    v_mfma_f32_32x32x16_bf16 v[80:95], v[160:163], v[172:175], v[80:95]
    v_mfma_f32_32x32x16_bf16 v[96:111], v[164:167], v[168:171], v[96:111]
    v_mfma_f32_32x32x16_bf16 v[112:127], v[164:167], v[172:175], v[112:127]
    v_mfma_f32_32x32x16_bf16 v[64:79], v[176:179], v[184:187], v[64:79]
    v_mov_b32 v52, s12
    s_waitcnt lgkmcnt(0)
    ds_write_b32 v10, v52
    s_add_u32 s12, s12, 1
    v_mfma_f32_32x32x16_bf16 v[80:95], v[176:179], v[188:191], v[80:95]
    ds_read_b64 v[48:49], v11 offset:16
    v_mfma_f32_32x32x16_bf16 v[96:111], v[180:183], v[184:187], v[96:111]
    v_mfma_f32_32x32x16_bf16 v[112:127], v[180:183], v[188:191], v[112:127]
    s_cmp_eq_u32 s12, 17
    s_cbranch_scc1 G1_last
    v_mfma_f32_32x32x16_bf16 v[64:79], v[192:195], v[200:203], v[64:79]
    s_waitcnt lgkmcnt(0)
    v_min_u32 v48, v48, v49
    v_cmp_gt_u32 vcc, s12, v48
    s_cbranch_vccnz G1_slow3
G1_back3:
    ds_read_b128 v[128:131], v32 offset:0
    ds_read_b128 v[136:139], v36 offset:0
    v_mfma_f32_32x32x16_bf16 v[80:95], v[192:195], v[204:207], v[80:95]
    ds_read_b128 v[140:143], v36 offset:4096
    ds_read_b128 v[132:135], v32 offset:4096
    v_mfma_f32_32x32x16_bf16 v[96:111], v[196:199], v[200:203], v[96:111]
    ds_read_b128 v[144:147], v33 offset:0
    ds_read_b128 v[152:155], v37 offset:0
    v_mfma_f32_32x32x16_bf16 v[112:127], v[196:199], v[204:207], v[112:127]
    ds_read_b128 v[156:159], v37 offset:4096
    ds_read_b128 v[148:151], v33 offset:4096
    v_mfma_f32_32x32x16_bf16 v[64:79], v[208:211], v[216:219], v[64:79]
    ds_read_b128 v[160:163], v34 offset:0
    ds_read_b128 v[168:171], v38 offset:0
    v_mfma_f32_32x32x16_bf16 v[80:95], v[208:211], v[220:223], v[80:95]
    ds_read_b128 v[172:175], v38 offset:4096
    ds_read_b128 v[164:167], v34 offset:4096
    v_mfma_f32_32x32x16_bf16 v[96:111], v[212:215], v[216:219], v[96:111]
    ds_read_b128 v[176:179], v35 offset:0
    ds_read_b128 v[184:187], v39 offset:0
    v_mfma_f32_32x32x16_bf16 v[112:127], v[212:215], v[220:223], v[112:127]
    ds_read_b128 v[188:191], v39 offset:4096
    ds_read_b128 v[180:183], v35 offset:4096
    v_mfma_f32_32x32x16_bf16 v[64:79], v[224:227], v[232:235], v[64:79]
    v_mfma_f32_32x32x16_bf16 v[80:95], v[224:227], v[236:239], v[80:95]
    v_mfma_f32_32x32x16_bf16 v[96:111], v[228:231], v[232:235], v[96:111]
    v_mfma_f32_32x32x16_bf16 v[112:127], v[228:231], v[236:239], v[112:127]
    v_mfma_f32_32x32x16_bf16 v[64:79], v[240:243], v[248:251], v[64:79]
    v_mov_b32 v52, s12
    s_waitcnt lgkmcnt(0)
    ds_write_b32 v10, v52
    s_add_u32 s12, s12, 1
    v_mfma_f32_32x32x16_bf16 v[80:95], v[240:243], v[252:255], v[80:95]
    ds_read_b64 v[48:49], v11 offset:16
    v_mfma_f32_32x32x16_bf16 v[96:111], v[244:247], v[248:251], v[96:111]
    v_mfma_f32_32x32x16_bf16 v[112:127], v[244:247], v[252:255], v[112:127]
    s_branch G1_loop
G1_slow0:
    s_mov_b32 s15, 0
G1_sl0_w:
    ds_read_b64 v[48:49], v11 offset:16
    s_waitcnt lgkmcnt(0)
    v_min_u32 v48, v48, v49
    v_cmp_gt_u32 vcc, s12, v48
    s_cbranch_vccz G1_sl0_ok
    s_add_u32 s15, s15, 1
    s_cmp_lt_u32 s15, 160000
    s_cbranch_scc1 G1_sl0_w
G1_sl0_ok:
    s_branch G1_back0
G1_slow1:
    s_mov_b32 s15, 0
G1_sl1_w:
    ds_read_b64 v[48:49], v11 offset:16
    s_waitcnt lgkmcnt(0)
    v_min_u32 v48, v48, v49
    v_cmp_gt_u32 vcc, s12, v48
    s_cbranch_vccz G1_sl1_ok
    s_add_u32 s15, s15, 1
    s_cmp_lt_u32 s15, 160000
    s_cbranch_scc1 G1_sl1_w
G1_sl1_ok:
    s_branch G1_back1
G1_slow2:
    s_mov_b32 s15, 0
G1_sl2_w:
    ds_read_b64 v[48:49], v11 offset:16
    s_waitcnt lgkmcnt(0)
    v_min_u32 v48, v48, v49
    v_cmp_gt_u32 vcc, s12, v48
    s_cbranch_vccz G1_sl2_ok
    s_add_u32 s15, s15, 1
    s_cmp_lt_u32 s15, 160000
    s_cbranch_scc1 G1_sl2_w
G1_sl2_ok:
    s_branch G1_back2
G1_slow3:
    s_mov_b32 s15, 0
G1_sl3_w:
    ds_read_b64 v[48:49], v11 offset:16
    s_waitcnt lgkmcnt(0)
    v_min_u32 v48, v48, v49
    v_cmp_gt_u32 vcc, s12, v48
    s_cbranch_vccz G1_sl3_ok
    s_add_u32 s15, s15, 1
    s_cmp_lt_u32 s15, 160000
    s_cbranch_scc1 G1_sl3_w
G1_sl3_ok:
    s_branch G1_back3
G1_last:
    v_mfma_f32_32x32x16_bf16 v[64:79], v[192:195], v[200:203], v[64:79]
    s_setprio 3
    s_waitcnt vmcnt(0)
    ds_read_b64 v[30:31], v11 offset:32
    v_lshlrev_b32 v133, 16, v12
    v_lshlrev_b32 v134, 16, v13
    v_lshlrev_b32 v135, 16, v14
    v_mul_f32 v133, 0x3fb8aa3b, v133
    v_mfma_f32_32x32x16_bf16 v[80:95], v[192:195], v[204:207], v[80:95]
    v_exp_f32 v133, v133
    v_mul_f32 v140, v134, v134
    v_cvt_pk_bf16_f32 v133, v133, v133
    v_fmac_f32 v140, v135, v135
    v_mfma_f32_32x32x16_bf16 v[96:111], v[196:199], v[200:203], v[96:111]
    v_lshlrev_b32 v133, 16, v133
    v_rcp_f32 v140, v140
    v_mul_f32 v136, v133, v134
    v_mul_f32 v137, v133, v135
    v_mfma_f32_32x32x16_bf16 v[112:127], v[196:199], v[204:207], v[112:127]
    v_mul_f32 v136, 0x3fb8aa3b, v136
    v_exp_f32 v136, v136
    v_mul_f32 v137, 0.15915494, v137
    v_cos_f32 v138, v137
    v_mfma_f32_32x32x16_bf16 v[64:79], v[208:211], v[216:219], v[64:79]
    v_sin_f32 v139, v137
    v_add_f32 v140, v140, v140
    v_mul_f32 v6, v136, v138
    v_mul_f32 v7, v136, v139
    v_mfma_f32_32x32x16_bf16 v[80:95], v[208:211], v[220:223], v[80:95]
    v_mul_f32 v128, v6, v6
    v_mul_f32 v129, v6, v7
    v_fma_f32 v128, -v7, v7, v128
    v_fmac_f32 v129, v7, v6
    v_mfma_f32_32x32x16_bf16 v[96:111], v[212:215], v[216:219], v[96:111]
    v_mul_f32 v130, v128, v128
    v_mul_f32 v131, v128, v129
    v_fma_f32 v130, -v129, v129, v130
    v_fmac_f32 v131, v129, v128
    v_mfma_f32_32x32x16_bf16 v[112:127], v[212:215], v[220:223], v[112:127]
    v_mul_f32 v12, v130, v130
    v_mul_f32 v13, v130, v131
    v_fma_f32 v12, -v131, v131, v12
    v_fmac_f32 v13, v131, v130
    v_mfma_f32_32x32x16_bf16 v[64:79], v[224:227], v[232:235], v[64:79]
    v_mul_f32 v14, v12, v12
    v_mul_f32 v15, v12, v13
    v_fma_f32 v14, -v13, v13, v14
    v_fmac_f32 v15, v13, v12
    v_mfma_f32_32x32x16_bf16 v[80:95], v[224:227], v[236:239], v[80:95]
    v_mul_f32 v16, v14, v14
    v_mul_f32 v17, v14, v15
    v_fma_f32 v16, -v15, v15, v16
    v_fmac_f32 v17, v15, v14
    v_mfma_f32_32x32x16_bf16 v[96:111], v[228:231], v[232:235], v[96:111]
    v_add_f32 v136, -1.0, v6
    v_mul_f32 v138, v136, v134
    v_fmac_f32 v138, v7, v135
    v_mul_f32 v139, v7, v134
    v_mfma_f32_32x32x16_bf16 v[112:127], v[228:231], v[236:239], v[112:127]
    v_fma_f32 v139, -v136, v135, v139
    v_mul_f32 v8, v138, v140
    v_mul_f32 v9, v139, v140
    v_mul_f32 v18, v16, v16
    v_mfma_f32_32x32x16_bf16 v[64:79], v[240:243], v[248:251], v[64:79]
    v_mul_f32 v19, v16, v17
    v_fma_f32 v18, -v17, v17, v18
    v_fmac_f32 v19, v17, v16
    v_mul_f32 v20, v18, v18
    v_mfma_f32_32x32x16_bf16 v[80:95], v[240:243], v[252:255], v[80:95]
    v_mul_f32 v21, v18, v19
    v_fma_f32 v20, -v19, v19, v20
    v_fmac_f32 v21, v19, v18
    v_mfma_f32_32x32x16_bf16 v[96:111], v[244:247], v[248:251], v[96:111]
    v_mfma_f32_32x32x16_bf16 v[112:127], v[244:247], v[252:255], v[112:127]
    s_nop 1
    v_fma_f32 v40, v6, v64, v66
    v_fma_f32 v41, v6, v65, v67
    s_nop 2
    v_fma_f32 v42, v6, v80, v82
    v_fma_f32 v43, v6, v81, v83
    s_nop 1
    v_fma_f32 v44, v6, v96, v98
    v_fma_f32 v45, v6, v97, v99
    v_fma_f32 v46, v6, v112, v114
    v_fma_f32 v47, v6, v113, v115
    v_fma_f32 v40, -v7, v80, v40
    v_fma_f32 v41, -v7, v81, v41
    v_fmac_f32 v42, v7, v64
    v_fmac_f32 v43, v7, v65
    v_fma_f32 v44, -v7, v112, v44
    v_fma_f32 v45, -v7, v113, v45
    v_fmac_f32 v46, v7, v96
    v_fmac_f32 v47, v7, v97
    v_fma_f32 v32, v6, v40, v68
    v_fma_f32 v33, v6, v41, v69
    v_fma_f32 v34, v6, v42, v84
    v_fma_f32 v35, v6, v43, v85
    v_fma_f32 v36, v6, v44, v100
    v_fma_f32 v37, v6, v45, v101
    v_fma_f32 v38, v6, v46, v116
    v_fma_f32 v39, v6, v47, v117
    v_fma_f32 v32, -v7, v42, v32
    v_fma_f32 v33, -v7, v43, v33
    v_fmac_f32 v34, v7, v40
    v_fmac_f32 v35, v7, v41
    v_fma_f32 v36, -v7, v46, v36
    v_fma_f32 v37, -v7, v47, v37
    v_fmac_f32 v38, v7, v44
    v_fmac_f32 v39, v7, v45
    v_fma_f32 v40, v6, v32, v70
    v_fma_f32 v41, v6, v33, v71
    v_fma_f32 v42, v6, v34, v86
    v_fma_f32 v43, v6, v35, v87
    v_fma_f32 v44, v6, v36, v102
    v_fma_f32 v45, v6, v37, v103
    v_fma_f32 v46, v6, v38, v118
    v_fma_f32 v47, v6, v39, v119
    v_fma_f32 v40, -v7, v34, v40
    v_fma_f32 v41, -v7, v35, v41
    v_fmac_f32 v42, v7, v32
    v_fmac_f32 v43, v7, v33
    v_fma_f32 v44, -v7, v38, v44
    v_fma_f32 v45, -v7, v39, v45
    v_fmac_f32 v46, v7, v36
    v_fmac_f32 v47, v7, v37
    v_fma_f32 v32, v6, v40, v72
    v_fma_f32 v33, v6, v41, v73
    v_fma_f32 v34, v6, v42, v88
    v_fma_f32 v35, v6, v43, v89
    v_fma_f32 v36, v6, v44, v104
    v_fma_f32 v37, v6, v45, v105
    v_fma_f32 v38, v6, v46, v120
    v_fma_f32 v39, v6, v47, v121
    v_fma_f32 v32, -v7, v42, v32
    v_fma_f32 v33, -v7, v43, v33
    v_fmac_f32 v34, v7, v40
    v_fmac_f32 v35, v7, v41
    v_fma_f32 v36, -v7, v46, v36
    v_fma_f32 v37, -v7, v47, v37
    v_fmac_f32 v38, v7, v44
    v_fmac_f32 v39, v7, v45
    v_fma_f32 v40, v6, v32, v74
    v_fma_f32 v41, v6, v33, v75
    v_fma_f32 v42, v6, v34, v90
    v_fma_f32 v43, v6, v35, v91
    v_fma_f32 v44, v6, v36, v106
    v_fma_f32 v45, v6, v37, v107
    v_fma_f32 v46, v6, v38, v122
    v_fma_f32 v47, v6, v39, v123
    v_fma_f32 v40, -v7, v34, v40
    v_fma_f32 v41, -v7, v35, v41
    v_fmac_f32 v42, v7, v32
    v_fmac_f32 v43, v7, v33
    v_fma_f32 v44, -v7, v38, v44
    v_fma_f32 v45, -v7, v39, v45
    v_fmac_f32 v46, v7, v36
    v_fmac_f32 v47, v7, v37
    v_fma_f32 v32, v6, v40, v76
    v_fma_f32 v33, v6, v41, v77
    v_fma_f32 v34, v6, v42, v92
    v_fma_f32 v35, v6, v43, v93
    v_fma_f32 v36, v6, v44, v108
    v_fma_f32 v37, v6, v45, v109
    v_fma_f32 v38, v6, v46, v124
    v_fma_f32 v39, v6, v47, v125
    v_fma_f32 v32, -v7, v42, v32
    v_fma_f32 v33, -v7, v43, v33
    v_fmac_f32 v34, v7, v40
    v_fmac_f32 v35, v7, v41
    v_fma_f32 v36, -v7, v46, v36
    v_fma_f32 v37, -v7, v47, v37
    v_fmac_f32 v38, v7, v44
    v_fmac_f32 v39, v7, v45
    v_fma_f32 v40, v6, v32, v78
    v_fma_f32 v41, v6, v33, v79
    v_fma_f32 v42, v6, v34, v94
    v_fma_f32 v43, v6, v35, v95
    v_fma_f32 v44, v6, v36, v110
    v_fma_f32 v45, v6, v37, v111
    v_fma_f32 v46, v6, v38, v126
    v_fma_f32 v47, v6, v39, v127
    v_fma_f32 v40, -v7, v34, v40
    v_fma_f32 v41, -v7, v35, v41
    v_fmac_f32 v42, v7, v32
    v_fmac_f32 v43, v7, v33
    v_fma_f32 v44, -v7, v38, v44
    v_fma_f32 v45, -v7, v39, v45
    v_fmac_f32 v46, v7, v36
    v_fmac_f32 v47, v7, v37
    v_fmac_f32 v44, v12, v40
    v_fmac_f32 v45, v12, v41
    v_fmac_f32 v46, v12, v42
    v_fmac_f32 v47, v12, v43
    v_fma_f32 v44, -v13, v42, v44
    v_fma_f32 v45, -v13, v43, v45
    v_fmac_f32 v46, v13, v40
    v_fmac_f32 v47, v13, v41
    v_fma_f32 v32, v14, v44, v45
    v_fma_f32 v34, v14, v46, v47
    v_fma_f32 v32, -v15, v46, v32
    v_fmac_f32 v34, v15, v44
    v_mov_b32 v33, v32
    v_mov_b32 v35, v34
    s_lshl_b32 s12, s6, 1
    s_add_u32 s12, s12, s8
    v_permlane32_swap_b32 v32, v33
    v_permlane32_swap_b32 v34, v35
    v_fma_f32 v28, v16, v32, v33
    v_fma_f32 v29, v16, v34, v35
    v_fma_f32 v28, -v17, v34, v28
    v_fmac_f32 v29, v17, v32
    s_waitcnt lgkmcnt(0)
    s_mov_b32 s15, 0
G_nw:
    v_cmp_eq_u32 vcc, 0, v30
    s_cbranch_vccz G_nok
    ds_read_b64 v[30:31], v11 offset:32
    s_add_u32 s15, s15, 1
    s_waitcnt lgkmcnt(0)
    s_cmp_lt_u32 s15, 160000
    s_cbranch_scc1 G_nw
G_nok:
    s_cmp_eq_u32 s8, 0
    s_cbranch_scc0 G_pw1
    ds_write_b128 v0, v[28:31] offset:2048
    s_branch G_pub1
G_pw1:
    s_mov_b32 s15, 0
G_x1:
    ds_read_b128 v[56:59], v1 offset:2048
    s_add_u32 s15, s15, 1
    s_waitcnt lgkmcnt(0)
    v_cmp_ne_u64 vcc, v[58:59], v[30:31]
    s_cbranch_vccz G_x1_ok
    s_cmp_lt_u32 s15, 160000
    s_cbranch_scc1 G_x1
G_x1_ok:
    v_fmac_f32 v28, v18, v56
    v_fmac_f32 v29, v18, v57
    s_lshl_b32 s13, s6, 14
    v_fma_f32 v28, -v19, v57, v28
    v_fmac_f32 v29, v19, v56
    s_mov_b32 exec_hi, 0
    buffer_store_dwordx4 v[28:31], v53, s[64:67], s13 offen sc1
    s_cmp_eq_u32 s6, 0
    s_cbranch_scc0 G_pub1
    s_not_b64 exec, exec
    v_mov_b32 v28, 0
    v_mov_b32 v29, 0
    buffer_store_dwordx4 v[28:31], v53, s[64:67], 0 offen sc1
G_pub1:
    s_mov_b64 exec, -1
    v_mul_f32 v128, v8, v64
    v_mul_f32 v129, v8, v65
    v_mul_f32 v144, -v8, v80
    v_mul_f32 v145, -v8, v81
    v_mul_f32 v160, v8, v96
    v_mul_f32 v161, v8, v97
    v_mul_f32 v176, -v8, v112
    v_mul_f32 v177, -v8, v113
    v_fma_f32 v128, -v9, v80, v128
    v_fma_f32 v129, -v9, v81, v129
    v_fma_f32 v144, -v9, v64, v144
    v_fma_f32 v145, -v9, v65, v145
    v_fma_f32 v160, -v9, v112, v160
    v_fma_f32 v161, -v9, v113, v161
    v_fma_f32 v176, -v9, v96, v176
    v_fma_f32 v177, -v9, v97, v177
    v_mul_f32 v130, v8, v66
    v_mul_f32 v131, v8, v67
    v_mul_f32 v146, -v8, v82
    v_mul_f32 v147, -v8, v83
    v_mul_f32 v162, v8, v98
    v_mul_f32 v163, v8, v99
    v_mul_f32 v178, -v8, v114
    v_mul_f32 v179, -v8, v115
    v_fma_f32 v130, -v9, v82, v130
    v_fma_f32 v131, -v9, v83, v131
    v_fma_f32 v146, -v9, v66, v146
    v_fma_f32 v147, -v9, v67, v147
    v_fma_f32 v162, -v9, v114, v162
    v_fma_f32 v163, -v9, v115, v163
    v_fma_f32 v178, -v9, v98, v178
    v_fma_f32 v179, -v9, v99, v179
    v_mul_f32 v132, v8, v68
    v_mul_f32 v133, v8, v69
    v_mul_f32 v148, -v8, v84
    v_mul_f32 v149, -v8, v85
    v_mul_f32 v164, v8, v100
    v_mul_f32 v165, v8, v101
    v_mul_f32 v180, -v8, v116
    v_mul_f32 v181, -v8, v117
    v_fma_f32 v132, -v9, v84, v132
    v_fma_f32 v133, -v9, v85, v133
    v_fma_f32 v148, -v9, v68, v148
    v_fma_f32 v149, -v9, v69, v149
    v_fma_f32 v164, -v9, v116, v164
    v_fma_f32 v165, -v9, v117, v165
    v_fma_f32 v180, -v9, v100, v180
    v_fma_f32 v181, -v9, v101, v181
    v_mul_f32 v134, v8, v70
    v_mul_f32 v135, v8, v71
    v_mul_f32 v150, -v8, v86
    v_mul_f32 v151, -v8, v87
    v_mul_f32 v166, v8, v102
    v_mul_f32 v167, v8, v103
    v_mul_f32 v182, -v8, v118
    v_mul_f32 v183, -v8, v119
    v_fma_f32 v134, -v9, v86, v134
    v_fma_f32 v135, -v9, v87, v135
    v_fma_f32 v150, -v9, v70, v150
    v_fma_f32 v151, -v9, v71, v151
    v_fma_f32 v166, -v9, v118, v166
    v_fma_f32 v167, -v9, v119, v167
    v_fma_f32 v182, -v9, v102, v182
    v_fma_f32 v183, -v9, v103, v183
    v_mul_f32 v136, v8, v72
    v_mul_f32 v137, v8, v73
    v_mul_f32 v152, -v8, v88
    v_mul_f32 v153, -v8, v89
    v_mul_f32 v168, v8, v104
    v_mul_f32 v169, v8, v105
    v_mul_f32 v184, -v8, v120
    v_mul_f32 v185, -v8, v121
    v_fma_f32 v136, -v9, v88, v136
    v_fma_f32 v137, -v9, v89, v137
    v_fma_f32 v152, -v9, v72, v152
    v_fma_f32 v153, -v9, v73, v153
    v_fma_f32 v168, -v9, v120, v168
    v_fma_f32 v169, -v9, v121, v169
    v_fma_f32 v184, -v9, v104, v184
    v_fma_f32 v185, -v9, v105, v185
    v_mul_f32 v138, v8, v74
    v_mul_f32 v139, v8, v75
    v_mul_f32 v154, -v8, v90
    v_mul_f32 v155, -v8, v91
    v_mul_f32 v170, v8, v106
    v_mul_f32 v171, v8, v107
    v_mul_f32 v186, -v8, v122
    v_mul_f32 v187, -v8, v123
    v_fma_f32 v138, -v9, v90, v138
    v_fma_f32 v139, -v9, v91, v139
    v_fma_f32 v154, -v9, v74, v154
    v_fma_f32 v155, -v9, v75, v155
    v_fma_f32 v170, -v9, v122, v170
    v_fma_f32 v171, -v9, v123, v171
    v_fma_f32 v186, -v9, v106, v186
    v_fma_f32 v187, -v9, v107, v187
    v_mul_f32 v140, v8, v76
    v_mul_f32 v141, v8, v77
    v_mul_f32 v156, -v8, v92
    v_mul_f32 v157, -v8, v93
    v_mul_f32 v172, v8, v108
    v_mul_f32 v173, v8, v109
    v_mul_f32 v188, -v8, v124
    v_mul_f32 v189, -v8, v125
    v_fma_f32 v140, -v9, v92, v140
    v_fma_f32 v141, -v9, v93, v141
    v_fma_f32 v156, -v9, v76, v156
    v_fma_f32 v157, -v9, v77, v157
    v_fma_f32 v172, -v9, v124, v172
    v_fma_f32 v173, -v9, v125, v173
    v_fma_f32 v188, -v9, v108, v188
    v_fma_f32 v189, -v9, v109, v189
    v_mul_f32 v142, v8, v78
    v_mul_f32 v143, v8, v79
    v_mul_f32 v158, -v8, v94
    v_mul_f32 v159, -v8, v95
    v_mul_f32 v174, v8, v110
    v_mul_f32 v175, v8, v111
    v_mul_f32 v190, -v8, v126
    v_mul_f32 v191, -v8, v127
    v_fma_f32 v142, -v9, v94, v142
    v_fma_f32 v143, -v9, v95, v143
    v_fma_f32 v158, -v9, v78, v158
    v_fma_f32 v159, -v9, v79, v159
    v_fma_f32 v174, -v9, v126, v174
    v_fma_f32 v175, -v9, v127, v175
    v_fma_f32 v190, -v9, v110, v190
    v_fma_f32 v191, -v9, v111, v191
    s_mov_b32 s13, 0
    buffer_load_dwordx2 v[80:81], v22, s[52:55], s13 offen offset:0
    buffer_load_dwordx2 v[82:83], v22, s[52:55], s13 offen offset:2048
    s_mov_b32 s13, 4096
    buffer_load_dwordx2 v[84:85], v22, s[52:55], s13 offen offset:0
    buffer_load_dwordx2 v[86:87], v22, s[52:55], s13 offen offset:2048
    s_mov_b32 s13, 32768
    buffer_load_dwordx2 v[88:89], v22, s[52:55], s13 offen offset:0
    buffer_load_dwordx2 v[90:91], v22, s[52:55], s13 offen offset:2048
    s_mov_b32 s13, 36864
    buffer_load_dwordx2 v[92:93], v22, s[52:55], s13 offen offset:0
    buffer_load_dwordx2 v[94:95], v22, s[52:55], s13 offen offset:2048
    v_cmp_eq_u32 vcc, 1, v4
    v_mov_b32 v36, 1.0
    s_nop 0
    v_cndmask_b32 v72, v36, v20, vcc
    v_cndmask_b32 v73, 0, v21, vcc
    v_cndmask_b32 v96, 0, v32, vcc
    v_cndmask_b32 v98, 0, v34, vcc
    v_cndmask_b32 v36, v36, v16, vcc
    v_cndmask_b32 v37, 0, v17, vcc
    s_cmp_eq_u32 s8, 1
    s_cselect_b64 s[14:15], -1, 0
    v_mul_f32 v74, v20, v20
    v_fma_f32 v97, v14, v96, v44
    v_mul_f32 v75, v20, v21
    v_fma_f32 v99, v14, v98, v46
    v_fma_f32 v74, -v21, v21, v74
    v_fma_f32 v97, -v15, v98, v97
    v_fmac_f32 v75, v21, v20
    v_fmac_f32 v99, v15, v96
    v_mul_f32 v76, v74, v74
    v_fma_f32 v100, v12, v96, v40
    v_mul_f32 v77, v74, v75
    v_fma_f32 v101, v12, v97, v41
    v_fma_f32 v76, -v75, v75, v76
    v_fma_f32 v102, v12, v98, v42
    v_fmac_f32 v77, v75, v74
    v_fma_f32 v103, v12, v99, v43
    v_cndmask_b32 v74, 1.0, v74, s[14:15]
    v_fma_f32 v100, -v13, v98, v100
    v_cndmask_b32 v75, 0, v75, s[14:15]
    v_fma_f32 v101, -v13, v99, v101
    v_mul_f32 v64, v72, v74
    v_fmac_f32 v102, v13, v96
    v_mul_f32 v65, v72, v75
    v_fmac_f32 v103, v13, v97
    v_fma_f32 v64, -v73, v75, v64
    v_mul_f32 v104, v8, v36
    v_fmac_f32 v65, v73, v74
    v_mul_f32 v106, v8, v37
    v_mul_f32 v66, v64, v76
    v_fma_f32 v104, -v9, v37, v104
    v_mul_f32 v67, v64, v77
    v_fmac_f32 v106, v9, v36
    v_fma_f32 v66, -v65, v77, v66
    v_mul_f32 v105, v14, v104
    v_fmac_f32 v67, v65, v76
    v_mul_f32 v107, v14, v106
    v_mul_f32 v68, v66, v76
    v_fma_f32 v105, -v15, v106, v105
    v_mul_f32 v69, v66, v77
    v_fmac_f32 v107, v15, v104
    v_fma_f32 v68, -v67, v77, v68
    v_mul_f32 v108, v12, v104
    v_fmac_f32 v69, v67, v76
    v_mul_f32 v109, v12, v105
    v_mul_f32 v70, v68, v76
    v_mul_f32 v110, v12, v106
    v_mul_f32 v71, v68, v77
    v_mul_f32 v111, v12, v107
    v_fma_f32 v70, -v69, v77, v70
    v_fma_f32 v108, -v13, v106, v108
    v_fmac_f32 v71, v69, v76
    v_fma_f32 v109, -v13, v107, v109
    v_fmac_f32 v110, v13, v104
    v_fmac_f32 v111, v13, v105
    v_mul_f32 v112, v8, v96
    v_mul_f32 v113, v8, v97
    v_mul_f32 v114, -v8, v98
    v_mul_f32 v115, -v8, v99
    v_fma_f32 v112, -v9, v98, v112
    v_fma_f32 v113, -v9, v99, v113
    v_fma_f32 v114, -v9, v96, v114
    v_fma_f32 v115, -v9, v97, v115
    v_mul_f32 v116, v8, v100
    v_mul_f32 v117, v8, v101
    v_mul_f32 v118, -v8, v102
    v_mul_f32 v119, -v8, v103
    v_fma_f32 v116, -v9, v102, v116
    v_fma_f32 v117, -v9, v103, v117
    v_fma_f32 v118, -v9, v100, v118
    v_fma_f32 v119, -v9, v101, v119
    s_lshl_b32 s13, s3, 13
    s_add_u32 s13, s13, 65536
    v_and_b32 v32, 1, v2
    v_and_b32 v33, 2, v2
    v_lshl_or_b32 v32, v33, 1, v32
    v_lshrrev_b32 v33, 1, v2
    v_xor_b32 v33, v33, v2
    v_bfe_u32 v33, v33, 2, 1
    v_lshl_or_b32 v32, v33, 1, v32
    v_lshlrev_b32 v33, 2, v4
    v_xor_b32 v32, v32, v33
    v_lshlrev_b32 v32, 4, v32
    v_lshl_add_u32 v32, v3, 7, v32
    v_add_u32 v120, s13, v32
    v_xor_b32 v121, 16, v120
    v_xor_b32 v122, 32, v120
    v_xor_b32 v123, 48, v120
    v_bfe_u32 v32, v2, 2, 2
    v_lshrrev_b32 v33, 4, v2
    v_lshl_add_u32 v33, v33, 3, v32
    v_lshlrev_b32 v33, 7, v33
    v_and_b32 v34, 1, v32
    v_and_b32 v32, 2, v32
    v_lshl_or_b32 v32, v32, 1, v34
    v_bfe_u32 v34, v2, 4, 1
    v_bfe_u32 v35, v2, 1, 1
    v_lshl_or_b32 v34, v34, 1, v35
    v_xor_b32 v32, v32, v34
    v_lshl_add_u32 v33, v32, 4, v33
    v_and_b32 v32, 1, v2
    v_lshl_add_u32 v33, v32, 3, v33
    v_add_u32 v124, s13, v33
    v_xor_b32 v125, 64, v124
    v_xor_b32 v126, 32, v124
    v_xor_b32 v127, 64, v126
    s_lshl_b32 s10, s7, 5
    s_add_u32 s10, s10, s8
    s_lshl_b32 s10, s10, 12
    v_lshrrev_b32 v40, 3, v2
    v_lshl_add_u32 v40, v40, 13, s10
    v_lshrrev_b32 v41, 4, v2
    v_xor_b32 v41, v41, v2
    v_and_b32 v41, 7, v41
    v_lshl_add_u32 v16, v41, 4, v40
    v_xor_b32 v17, 64, v16
    v_add_u32 v17, 64512, v17
    s_lshl_b32 s16, s6, 2
    s_add_u32 s16, s16, s3
    s_lshl_b32 s16, s16, 17
    s_lshl_b32 s22, s9, 13
    s_lshl_b32 s10, s8, 12
    s_add_u32 s22, s22, s10
    s_lshl_b32 s10, s9, 6
    s_lshl_b32 s11, s9, 13
    v_xor_b32 v20, s10, v124
    v_xor_b32 v21, s10, v126
    v_subrev_u32 v20, s11, v20
    v_subrev_u32 v21, s11, v21
    s_mov_b32 s15, 0
G_all16_w:
    ds_read_b128 v[48:51], v11 offset:0
    s_waitcnt lgkmcnt(0)
    v_min3_u32 v48, v48, v49, v50
    v_min_u32 v48, v48, v51
    v_cmp_gt_u32 vcc, 16, v48
    s_cbranch_vccz G_all16_ok
    s_add_u32 s15, s15, 1
    s_cmp_lt_u32 s15, 160000
    s_cbranch_scc1 G_all16_w
G_all16_ok:
    v_mov_b32 v36, 0
    v_mov_b32 v37, 0
    s_mov_b32 s15, 0
    s_cmp_eq_u32 s6, 0
    s_cbranch_scc1 G_lb4
    s_lshl_b32 s14, s8, 1
    s_sub_i32 s14, s6, s14
    s_cmp_le_i32 s14, 0
    s_cbranch_scc1 G_lb3
G_lb:
    buffer_load_dwordx4 v[192:195], v60, s[64:67], 0 offen sc1
    s_cmp_le_i32 s14, 4
    s_cbranch_scc1 G_lb1
    buffer_load_dwordx4 v[196:199], v61, s[64:67], 0 offen sc1
    s_cmp_le_i32 s14, 8
    s_cbranch_scc1 G_lb1
    buffer_load_dwordx4 v[200:203], v62, s[64:67], 0 offen sc1
    s_cmp_le_i32 s14, 12
    s_cbranch_scc1 G_lb1
    buffer_load_dwordx4 v[204:207], v63, s[64:67], 0 offen sc1
G_lb1:
    v_mov_b32 v36, 0
    v_mov_b32 v37, 0
    s_mov_b64 s[10:11], 0
    s_waitcnt vmcnt(0)
    v_cmp_ne_u64 vcc, v[194:195], v[30:31]
    v_fmac_f32 v36, v64, v192
    v_fmac_f32 v37, v64, v193
    s_or_b64 s[10:11], s[10:11], vcc
    v_fma_f32 v36, -v65, v193, v36
    v_fmac_f32 v37, v65, v192
    s_cmp_le_i32 s14, 4
    s_cbranch_scc1 G_lb2
    v_cmp_ne_u64 vcc, v[198:199], v[30:31]
    v_fmac_f32 v36, v66, v196
    v_fmac_f32 v37, v66, v197
    s_or_b64 s[10:11], s[10:11], vcc
    v_fma_f32 v36, -v67, v197, v36
    v_fmac_f32 v37, v67, v196
    s_cmp_le_i32 s14, 8
    s_cbranch_scc1 G_lb2
    v_cmp_ne_u64 vcc, v[202:203], v[30:31]
    v_fmac_f32 v36, v68, v200
    v_fmac_f32 v37, v68, v201
    s_or_b64 s[10:11], s[10:11], vcc
    v_fma_f32 v36, -v69, v201, v36
    v_fmac_f32 v37, v69, v200
    s_cmp_le_i32 s14, 12
    s_cbranch_scc1 G_lb2
    v_cmp_ne_u64 vcc, v[206:207], v[30:31]
    v_fmac_f32 v36, v70, v204
    v_fmac_f32 v37, v70, v205
    s_or_b64 s[10:11], s[10:11], vcc
    v_fma_f32 v36, -v71, v205, v36
    v_fmac_f32 v37, v71, v204
G_lb2:
    s_cmp_eq_u64 s[10:11], 0
    s_cbranch_scc1 G_lb2b
    s_add_u32 s15, s15, 1
    s_cmp_lt_u32 s15, 20000
    s_cbranch_scc1 G_lb
G_lb2b:
    v_mov_b32 v38, v36
    v_mov_b32 v39, v37
    s_nop 0
    v_permlane32_swap_b32 v36, v38
    v_permlane32_swap_b32 v37, v39
    v_add_f32 v36, v36, v38
    v_add_f32 v37, v37, v39
G_lb3:
    v_mov_b32 v28, v36
    v_mov_b32 v29, v37
    ds_write_b128 v0, v[28:31]
    s_mov_b32 s15, 0
G_x2:
    ds_read_b128 v[192:195], v1 offset:0
    s_add_u32 s15, s15, 1
    s_waitcnt lgkmcnt(0)
    v_cmp_ne_u64 vcc, v[194:195], v[30:31]
    s_cbranch_vccz G_x2_ok
    s_cmp_lt_u32 s15, 160000
    s_cbranch_scc1 G_x2
G_x2_ok:
    v_add_f32 v36, v36, v192
    v_add_f32 v37, v37, v193
G_lb4:
    s_cmp_eq_u32 s8, 0
    s_cbranch_scc1 G_lbdone
    v_fma_f32 v56, v18, v36, v56
    v_fma_f32 v57, v18, v37, v57
    v_fma_f32 v56, -v19, v37, v56
    v_fma_f32 v37, v19, v36, v57
    v_mov_b32 v36, v56
G_lbdone:
    v_fmac_f32 v112, v36, v104
    v_fmac_f32 v113, v36, v105
    v_fma_f32 v114, -v37, v104, v114
    v_fma_f32 v115, -v37, v105, v115
    v_fmac_f32 v116, v36, v108
    v_fmac_f32 v117, v36, v109
    v_fma_f32 v118, -v37, v108, v118
    v_fma_f32 v119, -v37, v109, v119
    v_fma_f32 v112, -v37, v106, v112
    v_fma_f32 v113, -v37, v107, v113
    v_fma_f32 v114, -v36, v106, v114
    v_fma_f32 v115, -v36, v107, v115
    v_fma_f32 v116, -v37, v110, v116
    v_fma_f32 v117, -v37, v111, v117
    v_fma_f32 v118, -v36, v110, v118
    v_fma_f32 v119, -v36, v111, v119
    s_bfe_u32 s18, s100, 28 + (4 << 16)
    s_lshl_b32 s18, s18, 7
    buffer_load_dwordx4 v[224:227], v16, s[80:83], s18 offen offset:0
    v_fmac_f32 v128, v6, v112
    v_fmac_f32 v129, v6, v113
    v_fmac_f32 v144, v6, v114
    v_fmac_f32 v145, v6, v115
    v_fmac_f32 v160, v6, v116
    v_fmac_f32 v161, v6, v117
    v_fmac_f32 v176, v6, v118
    v_fmac_f32 v177, v6, v119
    v_fmac_f32 v128, v7, v114
    v_fmac_f32 v129, v7, v115
    v_fma_f32 v144, -v7, v112, v144
    v_fma_f32 v145, -v7, v113, v145
    v_fmac_f32 v160, v7, v118
    v_fmac_f32 v161, v7, v119
    v_fma_f32 v176, -v7, v116, v176
    v_fma_f32 v177, -v7, v117, v177
    buffer_load_dwordx4 v[228:231], v17, s[80:83], s18 offen offset:1024
    v_fmac_f32 v130, v6, v128
    v_fmac_f32 v131, v6, v129
    v_fmac_f32 v146, v6, v144
    v_fmac_f32 v147, v6, v145
    v_fmac_f32 v162, v6, v160
    v_fmac_f32 v163, v6, v161
    v_fmac_f32 v178, v6, v176
    v_fmac_f32 v179, v6, v177
    v_fmac_f32 v130, v7, v144
    v_fmac_f32 v131, v7, v145
    v_fma_f32 v146, -v7, v128, v146
    v_fma_f32 v147, -v7, v129, v147
    v_fmac_f32 v162, v7, v176
    v_fmac_f32 v163, v7, v177
    v_fma_f32 v178, -v7, v160, v178
    v_fma_f32 v179, -v7, v161, v179
    buffer_load_dwordx4 v[232:235], v16, s[80:83], s18 offen offset:2048
    v_fmac_f32 v132, v6, v130
    v_fmac_f32 v133, v6, v131
    v_fmac_f32 v148, v6, v146
    v_fmac_f32 v149, v6, v147
    v_fmac_f32 v164, v6, v162
    v_fmac_f32 v165, v6, v163
    v_fmac_f32 v180, v6, v178
    v_fmac_f32 v181, v6, v179
    v_fmac_f32 v132, v7, v146
    v_fmac_f32 v133, v7, v147
    v_fma_f32 v148, -v7, v130, v148
    v_fma_f32 v149, -v7, v131, v149
    v_fmac_f32 v164, v7, v178
    v_fmac_f32 v165, v7, v179
    v_fma_f32 v180, -v7, v162, v180
    v_fma_f32 v181, -v7, v163, v181
    buffer_load_dwordx4 v[236:239], v17, s[80:83], s18 offen offset:3072
    v_fmac_f32 v134, v6, v132
    v_fmac_f32 v135, v6, v133
    v_fmac_f32 v150, v6, v148
    v_fmac_f32 v151, v6, v149
    v_fmac_f32 v166, v6, v164
    v_fmac_f32 v167, v6, v165
    v_fmac_f32 v182, v6, v180
    v_fmac_f32 v183, v6, v181
    v_fmac_f32 v134, v7, v148
    v_fmac_f32 v135, v7, v149
    v_fma_f32 v150, -v7, v132, v150
    v_fma_f32 v151, -v7, v133, v151
    v_fmac_f32 v166, v7, v180
    v_fmac_f32 v167, v7, v181
    v_fma_f32 v182, -v7, v164, v182
    v_fma_f32 v183, -v7, v165, v183
    s_bfe_u32 s18, s101, 0 + (4 << 16)
    s_lshl_b32 s18, s18, 7
    buffer_load_dwordx4 v[240:243], v16, s[80:83], s18 offen offset:0
    v_fmac_f32 v136, v6, v134
    v_fmac_f32 v137, v6, v135
    v_fmac_f32 v152, v6, v150
    v_fmac_f32 v153, v6, v151
    v_fmac_f32 v168, v6, v166
    v_fmac_f32 v169, v6, v167
    v_fmac_f32 v184, v6, v182
    v_fmac_f32 v185, v6, v183
    v_fmac_f32 v136, v7, v150
    v_fmac_f32 v137, v7, v151
    v_fma_f32 v152, -v7, v134, v152
    v_fma_f32 v153, -v7, v135, v153
    v_fmac_f32 v168, v7, v182
    v_fmac_f32 v169, v7, v183
    v_fma_f32 v184, -v7, v166, v184
    v_fma_f32 v185, -v7, v167, v185
    buffer_load_dwordx4 v[244:247], v17, s[80:83], s18 offen offset:1024
    v_fmac_f32 v138, v6, v136
    v_fmac_f32 v139, v6, v137
    v_fmac_f32 v154, v6, v152
    v_fmac_f32 v155, v6, v153
    v_fmac_f32 v170, v6, v168
    v_fmac_f32 v171, v6, v169
    v_fmac_f32 v186, v6, v184
    v_fmac_f32 v187, v6, v185
    v_fmac_f32 v138, v7, v152
    v_fmac_f32 v139, v7, v153
    v_fma_f32 v154, -v7, v136, v154
    v_fma_f32 v155, -v7, v137, v155
    v_fmac_f32 v170, v7, v184
    v_fmac_f32 v171, v7, v185
    v_fma_f32 v186, -v7, v168, v186
    v_fma_f32 v187, -v7, v169, v187
    buffer_load_dwordx4 v[248:251], v16, s[80:83], s18 offen offset:2048
    v_fmac_f32 v140, v6, v138
    v_fmac_f32 v141, v6, v139
    v_fmac_f32 v156, v6, v154
    v_fmac_f32 v157, v6, v155
    v_fmac_f32 v172, v6, v170
    v_fmac_f32 v173, v6, v171
    v_fmac_f32 v188, v6, v186
    v_fmac_f32 v189, v6, v187
    v_fmac_f32 v140, v7, v154
    v_fmac_f32 v141, v7, v155
    v_fma_f32 v156, -v7, v138, v156
    v_fma_f32 v157, -v7, v139, v157
    v_fmac_f32 v172, v7, v186
    v_fmac_f32 v173, v7, v187
    v_fma_f32 v188, -v7, v170, v188
    v_fma_f32 v189, -v7, v171, v189
    buffer_load_dwordx4 v[252:255], v17, s[80:83], s18 offen offset:3072
    v_fmac_f32 v142, v6, v140
    v_fmac_f32 v143, v6, v141
    v_fmac_f32 v158, v6, v156
    v_fmac_f32 v159, v6, v157
    v_fmac_f32 v174, v6, v172
    v_fmac_f32 v175, v6, v173
    v_fmac_f32 v190, v6, v188
    v_fmac_f32 v191, v6, v189
    v_fmac_f32 v142, v7, v156
    v_fmac_f32 v143, v7, v157
    v_fma_f32 v158, -v7, v140, v158
    v_fma_f32 v159, -v7, v141, v159
    v_fmac_f32 v174, v7, v188
    v_fmac_f32 v175, v7, v189
    v_fma_f32 v190, -v7, v172, v190
    v_fma_f32 v191, -v7, v173, v191
    v_cvt_pk_bf16_f32 v192, v128, v130
    v_cvt_pk_bf16_f32 v193, v132, v134
    v_cvt_pk_bf16_f32 v194, v136, v138
    v_cvt_pk_bf16_f32 v195, v140, v142
    ds_write_b128 v120, v[192:195] offset:0
    v_cvt_pk_bf16_f32 v196, v160, v162
    v_cvt_pk_bf16_f32 v197, v164, v166
    v_cvt_pk_bf16_f32 v198, v168, v170
    v_cvt_pk_bf16_f32 v199, v172, v174
    ds_write_b128 v121, v[196:199] offset:0
    v_cvt_pk_bf16_f32 v200, v129, v131
    v_cvt_pk_bf16_f32 v201, v133, v135
    v_cvt_pk_bf16_f32 v202, v137, v139
    v_cvt_pk_bf16_f32 v203, v141, v143
    ds_write_b128 v122, v[200:203] offset:0
    v_cvt_pk_bf16_f32 v204, v161, v163
    v_cvt_pk_bf16_f32 v205, v165, v167
    v_cvt_pk_bf16_f32 v206, v169, v171
    v_cvt_pk_bf16_f32 v207, v173, v175
    ds_write_b128 v123, v[204:207] offset:0
    v_cvt_pk_bf16_f32 v208, v144, v146
    v_cvt_pk_bf16_f32 v209, v148, v150
    v_cvt_pk_bf16_f32 v210, v152, v154
    v_cvt_pk_bf16_f32 v211, v156, v158
    ds_write_b128 v120, v[208:211] offset:4096
    v_cvt_pk_bf16_f32 v212, v176, v178
    v_cvt_pk_bf16_f32 v213, v180, v182
    v_cvt_pk_bf16_f32 v214, v184, v186
    v_cvt_pk_bf16_f32 v215, v188, v190
    ds_write_b128 v121, v[212:215] offset:4096
    v_cvt_pk_bf16_f32 v216, v145, v147
    v_cvt_pk_bf16_f32 v217, v149, v151
    v_cvt_pk_bf16_f32 v218, v153, v155
    v_cvt_pk_bf16_f32 v219, v157, v159
    ds_write_b128 v122, v[216:219] offset:4096
    v_cvt_pk_bf16_f32 v220, v177, v179
    v_cvt_pk_bf16_f32 v221, v181, v183
    v_cvt_pk_bf16_f32 v222, v185, v187
    v_cvt_pk_bf16_f32 v223, v189, v191
    ds_write_b128 v123, v[220:223] offset:4096
    s_lshl_b32 s10, s12, 18
    s_lshl_b32 s11, s7, 13
    s_add_u32 s10, s10, s11
    s_lshl_b32 s11, s9, 11
    s_add_u32 s10, s10, s11
    s_add_u32 s11, s10, 131072
    v_mov_b32 v22, 17
    s_waitcnt lgkmcnt(0)
    ds_read_b64_tr_b16 v[160:161], v124 offset:0
    ds_read_b64_tr_b16 v[162:163], v126 offset:512
    ds_read_b64_tr_b16 v[164:165], v126 offset:0
    ds_read_b64_tr_b16 v[166:167], v124 offset:512
    ds_read_b64_tr_b16 v[168:169], v125 offset:0
    ds_read_b64_tr_b16 v[170:171], v127 offset:512
    ds_read_b64_tr_b16 v[172:173], v127 offset:0
    ds_read_b64_tr_b16 v[174:175], v125 offset:512
    ds_read_b64_tr_b16 v[176:177], v124 offset:4096
    ds_read_b64_tr_b16 v[178:179], v126 offset:4608
    ds_read_b64_tr_b16 v[180:181], v126 offset:4096
    ds_read_b64_tr_b16 v[182:183], v124 offset:4608
    ds_read_b64_tr_b16 v[184:185], v125 offset:4096
    ds_read_b64_tr_b16 v[186:187], v127 offset:4608
    ds_read_b64_tr_b16 v[188:189], v127 offset:4096
    ds_read_b64_tr_b16 v[190:191], v125 offset:4608
    s_waitcnt lgkmcnt(14)
    buffer_store_dwordx4 v[160:163], v26, s[68:71], s10 offen offset:0 sc1
    s_waitcnt lgkmcnt(12)
    buffer_store_dwordx4 v[164:167], v26, s[68:71], s10 offen offset:1024 sc1
    s_waitcnt lgkmcnt(10)
    buffer_store_dwordx4 v[168:171], v26, s[68:71], s11 offen offset:0 sc1
    s_waitcnt lgkmcnt(8)
    buffer_store_dwordx4 v[172:175], v26, s[68:71], s11 offen offset:1024 sc1
    s_waitcnt lgkmcnt(6)
    buffer_store_dwordx4 v[176:179], v27, s[68:71], s10 offen offset:0 sc1
    s_waitcnt lgkmcnt(4)
    buffer_store_dwordx4 v[180:183], v27, s[68:71], s10 offen offset:1024 sc1
    s_waitcnt lgkmcnt(2)
    buffer_store_dwordx4 v[184:187], v27, s[68:71], s11 offen offset:0 sc1
    s_waitcnt lgkmcnt(0)
    buffer_store_dwordx4 v[188:191], v27, s[68:71], s11 offen offset:1024 sc1
    ds_write_b32 v10, v22
    v_and_b32 v112, 15, v2
    v_lshrrev_b32 v113, 1, v112
    v_lshrrev_b32 v114, 4, v2
    v_xor_b32 v113, v113, v114
    v_lshlrev_b32 v113, 4, v113
    v_lshl_add_u32 v6, v112, 7, v113
    v_xor_b32 v7, 64, v6
    v_add_u32 v8, 65536, v6
    v_add_u32 v9, 65536, v7
    v_add_u32 v0, s22, v26
    v_add_u32 v1, 65536, v0
    s_lshl_b32 s10, s6, 11
    s_add_u32 s10, s10, 32768
    s_lshl_b32 s11, s7, 7
    s_add_u32 s11, s11, s10
    v_lshl_add_u32 v5, v112, 7, s10
    v_cmp_ne_u32 s[20:21], s7, v112
    v_lshlrev_b32 v116, 16, v24
    v_and_b32 v117, 0xffff0000, v24
    v_lshlrev_b32 v118, 16, v25
    v_and_b32 v119, 0xffff0000, v25
    v_add_u32 v26, s16, v26
    v_add_u32 v27, s16, v27
    s_waitcnt vmcnt(16)
    v_lshlrev_b32 v192, 16, v80
    v_and_b32 v193, 0xffff0000, v80
    v_lshlrev_b32 v194, 16, v81
    v_and_b32 v195, 0xffff0000, v81
    v_lshlrev_b32 v196, 16, v82
    v_and_b32 v197, 0xffff0000, v82
    v_lshlrev_b32 v198, 16, v83
    v_and_b32 v199, 0xffff0000, v83
    v_lshlrev_b32 v200, 16, v84
    v_and_b32 v201, 0xffff0000, v84
    v_lshlrev_b32 v202, 16, v85
    v_and_b32 v203, 0xffff0000, v85
    v_lshlrev_b32 v204, 16, v86
    v_and_b32 v205, 0xffff0000, v86
    v_lshlrev_b32 v206, 16, v87
    v_and_b32 v207, 0xffff0000, v87
    v_lshlrev_b32 v208, 16, v88
    v_and_b32 v209, 0xffff0000, v88
    v_lshlrev_b32 v210, 16, v89
    v_and_b32 v211, 0xffff0000, v89
    v_lshlrev_b32 v212, 16, v90
    v_and_b32 v213, 0xffff0000, v90
    v_lshlrev_b32 v214, 16, v91
    v_and_b32 v215, 0xffff0000, v91
    v_lshlrev_b32 v216, 16, v92
    v_and_b32 v217, 0xffff0000, v92
    v_lshlrev_b32 v218, 16, v93
    v_and_b32 v219, 0xffff0000, v93
    v_lshlrev_b32 v220, 16, v94
    v_and_b32 v221, 0xffff0000, v94
    v_lshlrev_b32 v222, 16, v95
    v_and_b32 v223, 0xffff0000, v95
    v_mul_f32 v64, v192, v116
    v_mul_f32 v72, v193, v117
    v_mul_f32 v80, v194, v118
    v_mul_f32 v88, v195, v119
    v_mul_f32 v65, v196, v116
    v_mul_f32 v73, v197, v117
    v_mul_f32 v81, v198, v118
    v_mul_f32 v89, v199, v119
    v_mul_f32 v66, v200, v116
    v_mul_f32 v74, v201, v117
    v_mul_f32 v82, v202, v118
    v_mul_f32 v90, v203, v119
    v_mul_f32 v67, v204, v116
    v_mul_f32 v75, v205, v117
    v_mul_f32 v83, v206, v118
    v_mul_f32 v91, v207, v119
    v_mul_f32 v68, v208, v116
    v_mul_f32 v76, v209, v117
    v_mul_f32 v84, v210, v118
    v_mul_f32 v92, v211, v119
    v_mul_f32 v69, v212, v116
    v_mul_f32 v77, v213, v117
    v_mul_f32 v85, v214, v118
    v_mul_f32 v93, v215, v119
    v_mul_f32 v70, v216, v116
    v_mul_f32 v78, v217, v117
    v_mul_f32 v86, v218, v118
    v_mul_f32 v94, v219, v119
    v_mul_f32 v71, v220, v116
    v_mul_f32 v79, v221, v117
    v_mul_f32 v87, v222, v118
    v_mul_f32 v95, v223, v119
    s_mov_b32 s15, 0
G_all17_w:
    ds_read_b128 v[12:15], v11 offset:0
    s_waitcnt lgkmcnt(0)
    v_min3_u32 v12, v12, v13, v14
    v_min_u32 v12, v12, v15
    v_cmp_gt_u32 vcc, 17, v12
    s_cbranch_vccz G_all17_ok
    s_add_u32 s15, s15, 1
    s_cmp_lt_u32 s15, 160000
    s_cbranch_scc1 G_all17_w
G_all17_ok:
    ds_read_b64_tr_b16 v[128:129], v20 offset:0
    ds_read_b64_tr_b16 v[130:131], v21 offset:512
    ds_read_b64_tr_b16 v[132:133], v21 offset:0
    ds_read_b64_tr_b16 v[134:135], v20 offset:512
    ds_read_b64_tr_b16 v[136:137], v20 offset:8192
    ds_read_b64_tr_b16 v[138:139], v21 offset:8704
    ds_read_b64_tr_b16 v[140:141], v21 offset:8192
    ds_read_b64_tr_b16 v[142:143], v20 offset:8704
    ds_read_b64_tr_b16 v[144:145], v20 offset:4096
    ds_read_b64_tr_b16 v[146:147], v21 offset:4608
    ds_read_b64_tr_b16 v[148:149], v21 offset:4096
    ds_read_b64_tr_b16 v[150:151], v20 offset:4608
    ds_read_b64_tr_b16 v[152:153], v20 offset:12288
    ds_read_b64_tr_b16 v[154:155], v21 offset:12800
    ds_read_b64_tr_b16 v[156:157], v21 offset:12288
    ds_read_b64_tr_b16 v[158:159], v20 offset:12800
    v_mov_b32 v18, 1
    s_waitcnt vmcnt(0)
    s_mov_b64 exec, 1
    ds_add_rtn_u32 v18, v11, v18 offset:52
    s_waitcnt lgkmcnt(0)
    v_readfirstlane_b32 s14, v18
    s_cmp_eq_u32 s14, 3
    s_cbranch_scc0 G_nl
    buffer_store_dwordx2 v[30:31], v23, s[72:75], s11 offen sc1
    s_mov_b64 exec, -1
    buffer_load_dwordx2 v[28:29], v5, s[72:75], 0 offen sc1
G_nl:
    s_mov_b64 exec, -1
    s_mov_b32 s15, 0
G_f0_w:
    ds_read_b32 v18, v11 offset:60
    s_waitcnt lgkmcnt(0)
    v_cmp_gt_u32 vcc, 4, v18
    s_cbranch_vccz G_f0_ok
    s_sleep 1
    s_add_u32 s15, s15, 1
    s_cmp_lt_u32 s15, 160000
    s_cbranch_scc1 G_f0_w
G_f0_ok:
    ds_read_b128 v[192:195], v6 offset:0
    ds_read_b128 v[196:199], v6 offset:2048
    ds_read_b128 v[200:203], v6 offset:4096
    ds_read_b128 v[204:207], v6 offset:6144
    ds_read_b128 v[208:211], v7 offset:0
    ds_read_b128 v[212:215], v7 offset:2048
    ds_read_b128 v[216:219], v7 offset:4096
    s_waitcnt lgkmcnt(6)
    v_mfma_f32_16x16x32_bf16 v[64:67], v[128:131], v[192:195], v[64:67]
    ds_read_b128 v[220:223], v7 offset:6144
    v_mfma_f32_16x16x32_bf16 v[68:71], v[132:135], v[192:195], v[68:71]
    s_bfe_u32 s18, s101, 4 + (4 << 16)
    s_lshl_b32 s18, s18, 7
    buffer_load_dwordx4 v[48:51], v16, s[80:83], s18 offen offset:0
    s_waitcnt lgkmcnt(6)
    v_mfma_f32_16x16x32_bf16 v[72:75], v[128:131], v[196:199], v[72:75]
    ds_read_b128 v[192:195], v6 offset:8192
    v_mfma_f32_16x16x32_bf16 v[76:79], v[132:135], v[196:199], v[76:79]
    s_waitcnt lgkmcnt(6)
    v_mfma_f32_16x16x32_bf16 v[80:83], v[128:131], v[200:203], v[80:83]
    ds_read_b128 v[196:199], v6 offset:10240
    v_mfma_f32_16x16x32_bf16 v[84:87], v[132:135], v[200:203], v[84:87]
    buffer_load_dwordx4 v[52:55], v17, s[80:83], s18 offen offset:1024
    s_waitcnt lgkmcnt(6)
    v_mfma_f32_16x16x32_bf16 v[88:91], v[128:131], v[204:207], v[88:91]
    ds_read_b128 v[200:203], v6 offset:12288
    v_mfma_f32_16x16x32_bf16 v[92:95], v[132:135], v[204:207], v[92:95]
    s_waitcnt lgkmcnt(6)
    v_mfma_f32_16x16x32_bf16 v[64:67], v[136:139], v[208:211], v[64:67]
    ds_read_b128 v[204:207], v6 offset:14336
    v_mfma_f32_16x16x32_bf16 v[68:71], v[140:143], v[208:211], v[68:71]
    buffer_load_dwordx4 v[56:59], v16, s[80:83], s18 offen offset:2048
    s_waitcnt lgkmcnt(6)
    v_mfma_f32_16x16x32_bf16 v[72:75], v[136:139], v[212:215], v[72:75]
    ds_read_b128 v[208:211], v7 offset:8192
    v_mfma_f32_16x16x32_bf16 v[76:79], v[140:143], v[212:215], v[76:79]
    s_waitcnt lgkmcnt(6)
    v_mfma_f32_16x16x32_bf16 v[80:83], v[136:139], v[216:219], v[80:83]
    ds_read_b128 v[212:215], v7 offset:10240
    v_mfma_f32_16x16x32_bf16 v[84:87], v[140:143], v[216:219], v[84:87]
    buffer_load_dwordx4 v[60:63], v17, s[80:83], s18 offen offset:3072
    s_waitcnt lgkmcnt(6)
    v_mfma_f32_16x16x32_bf16 v[88:91], v[136:139], v[220:223], v[88:91]
    ds_read_b128 v[216:219], v7 offset:12288
    v_mfma_f32_16x16x32_bf16 v[92:95], v[140:143], v[220:223], v[92:95]
    s_waitcnt lgkmcnt(6)
    v_mfma_f32_16x16x32_bf16 v[64:67], v[144:147], v[192:195], v[64:67]
    ds_read_b128 v[220:223], v7 offset:14336
    v_mfma_f32_16x16x32_bf16 v[68:71], v[148:151], v[192:195], v[68:71]
    s_bfe_u32 s18, s101, 8 + (4 << 16)
    s_lshl_b32 s18, s18, 7
    buffer_load_dwordx4 v[32:35], v16, s[80:83], s18 offen offset:0
    s_waitcnt lgkmcnt(6)
    v_mfma_f32_16x16x32_bf16 v[72:75], v[144:147], v[196:199], v[72:75]
    ds_read_b128 v[192:195], v6 offset:16384
    v_mfma_f32_16x16x32_bf16 v[76:79], v[148:151], v[196:199], v[76:79]
    s_waitcnt lgkmcnt(6)
    v_mfma_f32_16x16x32_bf16 v[80:83], v[144:147], v[200:203], v[80:83]
    ds_read_b128 v[196:199], v6 offset:18432
    v_mfma_f32_16x16x32_bf16 v[84:87], v[148:151], v[200:203], v[84:87]
    buffer_load_dwordx4 v[36:39], v17, s[80:83], s18 offen offset:1024
    s_waitcnt lgkmcnt(6)
    v_mfma_f32_16x16x32_bf16 v[88:91], v[144:147], v[204:207], v[88:91]
    ds_read_b128 v[200:203], v6 offset:20480
    v_mfma_f32_16x16x32_bf16 v[92:95], v[148:151], v[204:207], v[92:95]
    s_waitcnt lgkmcnt(6)
    v_mfma_f32_16x16x32_bf16 v[64:67], v[152:155], v[208:211], v[64:67]
    ds_read_b128 v[204:207], v6 offset:22528
    v_mfma_f32_16x16x32_bf16 v[68:71], v[156:159], v[208:211], v[68:71]
    buffer_load_dwordx4 v[40:43], v16, s[80:83], s18 offen offset:2048
    s_waitcnt lgkmcnt(6)
    v_mfma_f32_16x16x32_bf16 v[72:75], v[152:155], v[212:215], v[72:75]
    ds_read_b128 v[208:211], v7 offset:16384
    v_mfma_f32_16x16x32_bf16 v[76:79], v[156:159], v[212:215], v[76:79]
    s_waitcnt lgkmcnt(6)
    v_mfma_f32_16x16x32_bf16 v[80:83], v[152:155], v[216:219], v[80:83]
    ds_read_b128 v[212:215], v7 offset:18432
    v_mfma_f32_16x16x32_bf16 v[84:87], v[156:159], v[216:219], v[84:87]
    buffer_load_dwordx4 v[44:47], v17, s[80:83], s18 offen offset:3072
    s_waitcnt lgkmcnt(6)
    v_mfma_f32_16x16x32_bf16 v[88:91], v[152:155], v[220:223], v[88:91]
    ds_read_b128 v[216:219], v7 offset:20480
    v_mfma_f32_16x16x32_bf16 v[92:95], v[156:159], v[220:223], v[92:95]
    v_mov_b32 v22, 18
    ds_write_b32 v10, v22
    s_bfe_u32 s18, s101, 12 + (4 << 16)
    s_lshl_b32 s18, s18, 7
    buffer_load_dwordx4 v[96:99], v16, s[80:83], s18 offen offset:0
    buffer_load_dwordx4 v[100:103], v17, s[80:83], s18 offen offset:1024
    buffer_load_dwordx4 v[104:107], v16, s[80:83], s18 offen offset:2048
    buffer_load_dwordx4 v[108:111], v17, s[80:83], s18 offen offset:3072
    s_bfe_u32 s18, s101, 16 + (4 << 16)
    s_lshl_b32 s18, s18, 7
    buffer_load_dwordx4 v[112:115], v16, s[80:83], s18 offen offset:0
    buffer_load_dwordx4 v[116:119], v17, s[80:83], s18 offen offset:1024
    buffer_load_dwordx4 v[120:123], v16, s[80:83], s18 offen offset:2048
    buffer_load_dwordx4 v[124:127], v17, s[80:83], s18 offen offset:3072
    s_mov_b32 s15, 0
G_all18_w:
    ds_read_b128 v[12:15], v11 offset:0
    s_waitcnt lgkmcnt(0)
    v_min3_u32 v12, v12, v13, v14
    v_min_u32 v12, v12, v15
    v_cmp_gt_u32 vcc, 18, v12
    s_cbranch_vccz G_all18_ok
    s_add_u32 s15, s15, 1
    s_cmp_lt_u32 s15, 160000
    s_cbranch_scc1 G_all18_w
G_all18_ok:
    s_bfe_u32 s18, s100, 16 + (4 << 16)
    s_lshl_b32 s18, s18, 7
    s_add_u32 m0, s22, 65536
    s_nop 0
    buffer_load_dwordx4 v16, s[80:83], s18 offen offset:0 lds
    buffer_load_dwordx4 v17, s[80:83], s18 offen offset:1024 lds
    buffer_load_dwordx4 v16, s[80:83], s18 offen offset:2048 lds
    buffer_load_dwordx4 v17, s[80:83], s18 offen offset:3072 lds
    s_bfe_u32 s18, s100, 20 + (4 << 16)
    s_lshl_b32 s18, s18, 7
    s_add_u32 m0, s22, 81920
    s_nop 0
    buffer_load_dwordx4 v16, s[80:83], s18 offen offset:0 lds
    buffer_load_dwordx4 v17, s[80:83], s18 offen offset:1024 lds
    buffer_load_dwordx4 v16, s[80:83], s18 offen offset:2048 lds
    buffer_load_dwordx4 v17, s[80:83], s18 offen offset:3072 lds
    s_bfe_u32 s18, s100, 24 + (4 << 16)
    s_lshl_b32 s18, s18, 7
    s_add_u32 m0, s22, 0
    s_nop 0
    buffer_load_dwordx4 v16, s[80:83], s18 offen offset:0 lds
    buffer_load_dwordx4 v17, s[80:83], s18 offen offset:1024 lds
    buffer_load_dwordx4 v16, s[80:83], s18 offen offset:2048 lds
    buffer_load_dwordx4 v17, s[80:83], s18 offen offset:3072 lds
    s_mov_b32 s15, 0
    s_cmp_eq_u32 s14, 3
    s_cbranch_scc0 G_np
    s_waitcnt vmcnt(28)
GH_chk:
    v_cmp_ne_u64 vcc, v[28:29], v[30:31]
    s_and_b64 vcc, vcc, s[20:21]
    s_cbranch_scc0 GH_ok
    buffer_load_dwordx2 v[28:29], v5, s[72:75], 0 offen sc1
    s_add_u32 s15, s15, 1
    s_cmp_lt_u32 s15, 20000
    s_waitcnt vmcnt(0)
    s_cbranch_scc1 GH_chk
GH_ok:
    ds_write_b32 v11, v22 offset:56
    s_branch G_go
G_np:
    s_mov_b32 s15, 0
G_fho_w:
    ds_read_b32 v18, v11 offset:56
    s_waitcnt lgkmcnt(0)
    v_cmp_gt_u32 vcc, 1, v18
    s_cbranch_vccz G_fho_ok
    s_sleep 1
    s_add_u32 s15, s15, 1
    s_cmp_lt_u32 s15, 160000
    s_cbranch_scc1 G_fho_w
G_fho_ok:
G_go:
    s_bfe_u32 s19, s100, 4 + (4 << 16)
    s_lshl_b32 s19, s19, 13
    buffer_load_dwordx4 v[160:163], v26, s[68:71], s19 offen offset:0 sc1
    buffer_load_dwordx4 v[164:167], v26, s[68:71], s19 offen offset:1024 sc1
    buffer_load_dwordx4 v[168:171], v26, s[68:71], s19 offen offset:2048 sc1
    buffer_load_dwordx4 v[172:175], v26, s[68:71], s19 offen offset:3072 sc1
    buffer_load_dwordx4 v[176:179], v27, s[68:71], s19 offen offset:0 sc1
    buffer_load_dwordx4 v[180:183], v27, s[68:71], s19 offen offset:1024 sc1
    buffer_load_dwordx4 v[184:187], v27, s[68:71], s19 offen offset:2048 sc1
    buffer_load_dwordx4 v[188:191], v27, s[68:71], s19 offen offset:3072 sc1
    s_bfe_u32 s19, s100, 8 + (4 << 16)
    s_lshl_b32 s19, s19, 13
    buffer_load_dwordx4 v[128:131], v26, s[68:71], s19 offen offset:0 sc1
    buffer_load_dwordx4 v[132:135], v26, s[68:71], s19 offen offset:1024 sc1
    buffer_load_dwordx4 v[136:139], v26, s[68:71], s19 offen offset:2048 sc1
    buffer_load_dwordx4 v[140:143], v26, s[68:71], s19 offen offset:3072 sc1
    buffer_load_dwordx4 v[144:147], v27, s[68:71], s19 offen offset:0 sc1
    buffer_load_dwordx4 v[148:151], v27, s[68:71], s19 offen offset:1024 sc1
    buffer_load_dwordx4 v[152:155], v27, s[68:71], s19 offen offset:2048 sc1
    buffer_load_dwordx4 v[156:159], v27, s[68:71], s19 offen offset:3072 sc1
    s_setprio 1
    s_waitcnt vmcnt(14)
    v_mfma_f32_16x16x32_bf16 v[64:67], v[160:163], v[192:195], v[64:67]
    ds_read_b128 v[220:223], v7 offset:22528
    v_mfma_f32_16x16x32_bf16 v[68:71], v[164:167], v[192:195], v[68:71]
    v_mfma_f32_16x16x32_bf16 v[72:75], v[160:163], v[196:199], v[72:75]
    ds_read_b128 v[192:195], v6 offset:24576
    v_mfma_f32_16x16x32_bf16 v[76:79], v[164:167], v[196:199], v[76:79]
    v_mfma_f32_16x16x32_bf16 v[80:83], v[160:163], v[200:203], v[80:83]
    ds_read_b128 v[196:199], v6 offset:26624
    v_mfma_f32_16x16x32_bf16 v[84:87], v[164:167], v[200:203], v[84:87]
    v_mfma_f32_16x16x32_bf16 v[88:91], v[160:163], v[204:207], v[88:91]
    ds_read_b128 v[200:203], v6 offset:28672
    s_bfe_u32 s19, s100, 12 + (4 << 16)
    v_mfma_f32_16x16x32_bf16 v[92:95], v[164:167], v[204:207], v[92:95]
    s_lshl_b32 s19, s19, 13
    s_waitcnt vmcnt(12)
    v_mfma_f32_16x16x32_bf16 v[64:67], v[168:171], v[208:211], v[64:67]
    ds_read_b128 v[204:207], v6 offset:30720
    v_mfma_f32_16x16x32_bf16 v[68:71], v[172:175], v[208:211], v[68:71]
    buffer_load_dwordx4 v[160:163], v26, s[68:71], s19 offen offset:0 sc1
    v_mfma_f32_16x16x32_bf16 v[72:75], v[168:171], v[212:215], v[72:75]
    ds_read_b128 v[208:211], v7 offset:24576
    v_mfma_f32_16x16x32_bf16 v[76:79], v[172:175], v[212:215], v[76:79]
    v_mfma_f32_16x16x32_bf16 v[80:83], v[168:171], v[216:219], v[80:83]
    ds_read_b128 v[212:215], v7 offset:26624
    v_mfma_f32_16x16x32_bf16 v[84:87], v[172:175], v[216:219], v[84:87]
    buffer_load_dwordx4 v[164:167], v26, s[68:71], s19 offen offset:1024 sc1
    s_waitcnt lgkmcnt(6)
    v_mfma_f32_16x16x32_bf16 v[88:91], v[168:171], v[220:223], v[88:91]
    ds_read_b128 v[216:219], v7 offset:28672
    v_mfma_f32_16x16x32_bf16 v[92:95], v[172:175], v[220:223], v[92:95]
    s_waitcnt vmcnt(12) lgkmcnt(6)
    v_mfma_f32_16x16x32_bf16 v[64:67], v[176:179], v[192:195], v[64:67]
    ds_read_b128 v[220:223], v7 offset:30720
    v_mfma_f32_16x16x32_bf16 v[68:71], v[180:183], v[192:195], v[68:71]
    buffer_load_dwordx4 v[168:171], v26, s[68:71], s19 offen offset:2048 sc1
    s_waitcnt lgkmcnt(6)
    v_mfma_f32_16x16x32_bf16 v[72:75], v[176:179], v[196:199], v[72:75]
    ds_read_b128 v[192:195], v6 offset:32768
    v_mfma_f32_16x16x32_bf16 v[76:79], v[180:183], v[196:199], v[76:79]
    s_waitcnt lgkmcnt(6)
    v_mfma_f32_16x16x32_bf16 v[80:83], v[176:179], v[200:203], v[80:83]
    ds_read_b128 v[196:199], v6 offset:34816
    v_mfma_f32_16x16x32_bf16 v[84:87], v[180:183], v[200:203], v[84:87]
    buffer_load_dwordx4 v[172:175], v26, s[68:71], s19 offen offset:3072 sc1
    s_waitcnt lgkmcnt(6)
    v_mfma_f32_16x16x32_bf16 v[88:91], v[176:179], v[204:207], v[88:91]
    ds_read_b128 v[200:203], v6 offset:36864
    v_mfma_f32_16x16x32_bf16 v[92:95], v[180:183], v[204:207], v[92:95]
    s_waitcnt vmcnt(12) lgkmcnt(6)
    v_mfma_f32_16x16x32_bf16 v[64:67], v[184:187], v[208:211], v[64:67]
    ds_read_b128 v[204:207], v6 offset:38912
    v_mfma_f32_16x16x32_bf16 v[68:71], v[188:191], v[208:211], v[68:71]
    buffer_load_dwordx4 v[176:179], v27, s[68:71], s19 offen offset:0 sc1
    s_waitcnt lgkmcnt(6)
    v_mfma_f32_16x16x32_bf16 v[72:75], v[184:187], v[212:215], v[72:75]
    ds_read_b128 v[208:211], v7 offset:32768
    v_mfma_f32_16x16x32_bf16 v[76:79], v[188:191], v[212:215], v[76:79]
    s_waitcnt lgkmcnt(6)
    v_mfma_f32_16x16x32_bf16 v[80:83], v[184:187], v[216:219], v[80:83]
    ds_read_b128 v[212:215], v7 offset:34816
    v_mfma_f32_16x16x32_bf16 v[84:87], v[188:191], v[216:219], v[84:87]
    buffer_load_dwordx4 v[180:183], v27, s[68:71], s19 offen offset:1024 sc1
    s_waitcnt lgkmcnt(6)
    v_mfma_f32_16x16x32_bf16 v[88:91], v[184:187], v[220:223], v[88:91]
    ds_read_b128 v[216:219], v7 offset:36864
    v_mfma_f32_16x16x32_bf16 v[92:95], v[188:191], v[220:223], v[92:95]
    s_waitcnt vmcnt(12) lgkmcnt(6)
    v_mfma_f32_16x16x32_bf16 v[64:67], v[128:131], v[192:195], v[64:67]
    ds_read_b128 v[220:223], v7 offset:38912
    v_mov_b32 v22, 20
    v_mfma_f32_16x16x32_bf16 v[68:71], v[132:135], v[192:195], v[68:71]
    buffer_load_dwordx4 v[184:187], v27, s[68:71], s19 offen offset:2048 sc1
    s_waitcnt lgkmcnt(6)
    v_mfma_f32_16x16x32_bf16 v[72:75], v[128:131], v[196:199], v[72:75]
    ds_read_b128 v[192:195], v6 offset:40960
    v_mfma_f32_16x16x32_bf16 v[76:79], v[132:135], v[196:199], v[76:79]
    ds_write_b32 v10, v22
    s_waitcnt lgkmcnt(7)
    v_mfma_f32_16x16x32_bf16 v[80:83], v[128:131], v[200:203], v[80:83]
    ds_read_b128 v[196:199], v6 offset:43008
    v_mfma_f32_16x16x32_bf16 v[84:87], v[132:135], v[200:203], v[84:87]
    buffer_load_dwordx4 v[188:191], v27, s[68:71], s19 offen offset:3072 sc1
    s_waitcnt lgkmcnt(7)
    v_mfma_f32_16x16x32_bf16 v[88:91], v[128:131], v[204:207], v[88:91]
    ds_read_b128 v[200:203], v6 offset:45056
    s_bfe_u32 s19, s100, 16 + (4 << 16)
    v_mfma_f32_16x16x32_bf16 v[92:95], v[132:135], v[204:207], v[92:95]
    s_lshl_b32 s19, s19, 13
    s_waitcnt vmcnt(12) lgkmcnt(7)
    v_mfma_f32_16x16x32_bf16 v[64:67], v[136:139], v[208:211], v[64:67]
    ds_read_b128 v[204:207], v6 offset:47104
    v_mfma_f32_16x16x32_bf16 v[68:71], v[140:143], v[208:211], v[68:71]
    buffer_load_dwordx4 v[128:131], v26, s[68:71], s19 offen offset:0 sc1
    s_waitcnt lgkmcnt(7)
    v_mfma_f32_16x16x32_bf16 v[72:75], v[136:139], v[212:215], v[72:75]
    ds_read_b128 v[208:211], v7 offset:40960
    v_mfma_f32_16x16x32_bf16 v[76:79], v[140:143], v[212:215], v[76:79]
    s_waitcnt lgkmcnt(7)
    v_mfma_f32_16x16x32_bf16 v[80:83], v[136:139], v[216:219], v[80:83]
    ds_read_b128 v[212:215], v7 offset:43008
    v_mfma_f32_16x16x32_bf16 v[84:87], v[140:143], v[216:219], v[84:87]
    buffer_load_dwordx4 v[132:135], v26, s[68:71], s19 offen offset:1024 sc1
    s_waitcnt lgkmcnt(7)
    v_mfma_f32_16x16x32_bf16 v[88:91], v[136:139], v[220:223], v[88:91]
    ds_read_b128 v[216:219], v7 offset:45056
    v_mfma_f32_16x16x32_bf16 v[92:95], v[140:143], v[220:223], v[92:95]
    s_waitcnt vmcnt(12) lgkmcnt(7)
    v_mfma_f32_16x16x32_bf16 v[64:67], v[144:147], v[192:195], v[64:67]
    ds_read_b128 v[220:223], v7 offset:47104
    v_mfma_f32_16x16x32_bf16 v[68:71], v[148:151], v[192:195], v[68:71]
    buffer_load_dwordx4 v[136:139], v26, s[68:71], s19 offen offset:2048 sc1
    s_waitcnt lgkmcnt(6)
    v_mfma_f32_16x16x32_bf16 v[72:75], v[144:147], v[196:199], v[72:75]
    ds_read_b128 v[192:195], v6 offset:49152
    v_mfma_f32_16x16x32_bf16 v[76:79], v[148:151], v[196:199], v[76:79]
    s_waitcnt lgkmcnt(6)
    v_mfma_f32_16x16x32_bf16 v[80:83], v[144:147], v[200:203], v[80:83]
    ds_read_b128 v[196:199], v6 offset:51200
    ds_read_b128 v[12:15], v11
    v_mfma_f32_16x16x32_bf16 v[84:87], v[148:151], v[200:203], v[84:87]
    buffer_load_dwordx4 v[140:143], v26, s[68:71], s19 offen offset:3072 sc1
    s_waitcnt lgkmcnt(7)
    v_mfma_f32_16x16x32_bf16 v[88:91], v[144:147], v[204:207], v[88:91]
    ds_read_b128 v[200:203], v6 offset:53248
    v_mfma_f32_16x16x32_bf16 v[92:95], v[148:151], v[204:207], v[92:95]
    s_waitcnt vmcnt(12) lgkmcnt(7)
    v_mfma_f32_16x16x32_bf16 v[64:67], v[152:155], v[208:211], v[64:67]
    ds_read_b128 v[204:207], v6 offset:55296
    v_mfma_f32_16x16x32_bf16 v[68:71], v[156:159], v[208:211], v[68:71]
    buffer_load_dwordx4 v[144:147], v27, s[68:71], s19 offen offset:0 sc1
    s_waitcnt lgkmcnt(7)
    v_mfma_f32_16x16x32_bf16 v[72:75], v[152:155], v[212:215], v[72:75]
    ds_read_b128 v[208:211], v7 offset:49152
    v_mfma_f32_16x16x32_bf16 v[76:79], v[156:159], v[212:215], v[76:79]
    s_waitcnt lgkmcnt(7)
    v_mfma_f32_16x16x32_bf16 v[80:83], v[152:155], v[216:219], v[80:83]
    ds_read_b128 v[212:215], v7 offset:51200
    v_mfma_f32_16x16x32_bf16 v[84:87], v[156:159], v[216:219], v[84:87]
    buffer_load_dwordx4 v[148:151], v27, s[68:71], s19 offen offset:1024 sc1
    s_waitcnt lgkmcnt(7)
    v_mfma_f32_16x16x32_bf16 v[88:91], v[152:155], v[220:223], v[88:91]
    ds_read_b128 v[216:219], v7 offset:53248
    v_mfma_f32_16x16x32_bf16 v[92:95], v[156:159], v[220:223], v[92:95]
    s_waitcnt vmcnt(12) lgkmcnt(7)
    v_mfma_f32_16x16x32_bf16 v[64:67], v[160:163], v[192:195], v[64:67]
    ds_read_b128 v[220:223], v7 offset:55296
    v_mov_b32 v22, 21
    v_mfma_f32_16x16x32_bf16 v[68:71], v[164:167], v[192:195], v[68:71]
    buffer_load_dwordx4 v[152:155], v27, s[68:71], s19 offen offset:2048 sc1
    s_waitcnt lgkmcnt(7)
    v_mfma_f32_16x16x32_bf16 v[72:75], v[160:163], v[196:199], v[72:75]
    ds_read_b128 v[192:195], v6 offset:57344
    s_waitcnt lgkmcnt(7)
    v_min3_u32 v12, v12, v13, v14
    v_mfma_f32_16x16x32_bf16 v[76:79], v[164:167], v[196:199], v[76:79]
    ds_write_b32 v10, v22
    s_waitcnt lgkmcnt(7)
    v_mfma_f32_16x16x32_bf16 v[80:83], v[160:163], v[200:203], v[80:83]
    ds_read_b128 v[196:199], v6 offset:59392
    v_min_u32 v12, v12, v15
    v_mfma_f32_16x16x32_bf16 v[84:87], v[164:167], v[200:203], v[84:87]
    buffer_load_dwordx4 v[156:159], v27, s[68:71], s19 offen offset:3072 sc1
    s_waitcnt lgkmcnt(7)
    v_mfma_f32_16x16x32_bf16 v[88:91], v[160:163], v[204:207], v[88:91]
    ds_read_b128 v[200:203], v6 offset:61440
    s_bfe_u32 s19, s100, 20 + (4 << 16)
    v_mfma_f32_16x16x32_bf16 v[92:95], v[164:167], v[204:207], v[92:95]
    s_lshl_b32 s19, s19, 13
    s_waitcnt vmcnt(12) lgkmcnt(7)
    v_mfma_f32_16x16x32_bf16 v[64:67], v[168:171], v[208:211], v[64:67]
    ds_read_b128 v[204:207], v6 offset:63488
    v_cmp_gt_u32 vcc, 20, v12
    v_mfma_f32_16x16x32_bf16 v[68:71], v[172:175], v[208:211], v[68:71]
    buffer_load_dwordx4 v[160:163], v26, s[68:71], s19 offen offset:0 sc1
    s_waitcnt lgkmcnt(7)
    v_mfma_f32_16x16x32_bf16 v[72:75], v[168:171], v[212:215], v[72:75]
    ds_read_b128 v[208:211], v7 offset:57344
    s_cbranch_vccnz G2_slow3
G2_back3:
    v_mfma_f32_16x16x32_bf16 v[76:79], v[172:175], v[212:215], v[76:79]
    ds_write_b64 v0, v[224:225] offset:16384
    s_waitcnt lgkmcnt(8)
    v_mfma_f32_16x16x32_bf16 v[80:83], v[168:171], v[216:219], v[80:83]
    ds_read_b128 v[212:215], v7 offset:59392
    v_mfma_f32_16x16x32_bf16 v[84:87], v[172:175], v[216:219], v[84:87]
    buffer_load_dwordx4 v[164:167], v26, s[68:71], s19 offen offset:1024 sc1
    s_waitcnt lgkmcnt(8)
    v_mfma_f32_16x16x32_bf16 v[88:91], v[168:171], v[220:223], v[88:91]
    ds_read_b128 v[216:219], v7 offset:61440
    v_mfma_f32_16x16x32_bf16 v[92:95], v[172:175], v[220:223], v[92:95]
    ds_write_b64 v0, v[226:227] offset:16392
    s_waitcnt vmcnt(12) lgkmcnt(9)
    v_mfma_f32_16x16x32_bf16 v[64:67], v[176:179], v[192:195], v[64:67]
    ds_read_b128 v[220:223], v7 offset:63488
    ds_write_b64 v0, v[228:229] offset:17408
    v_mfma_f32_16x16x32_bf16 v[68:71], v[180:183], v[192:195], v[68:71]
    buffer_load_dwordx4 v[168:171], v26, s[68:71], s19 offen offset:2048 sc1
    s_waitcnt lgkmcnt(9)
    v_mfma_f32_16x16x32_bf16 v[72:75], v[176:179], v[196:199], v[72:75]
    ds_read_b128 v[192:195], v8 offset:0
    v_mfma_f32_16x16x32_bf16 v[76:79], v[180:183], v[196:199], v[76:79]
    ds_write_b64 v0, v[230:231] offset:17416
    s_waitcnt lgkmcnt(10)
    v_mfma_f32_16x16x32_bf16 v[80:83], v[176:179], v[200:203], v[80:83]
    ds_read_b128 v[196:199], v8 offset:2048
    ds_read_b128 v[12:15], v11
    v_mfma_f32_16x16x32_bf16 v[84:87], v[180:183], v[200:203], v[84:87]
    buffer_load_dwordx4 v[172:175], v26, s[68:71], s19 offen offset:3072 sc1
    s_waitcnt lgkmcnt(11)
    v_mfma_f32_16x16x32_bf16 v[88:91], v[176:179], v[204:207], v[88:91]
    ds_read_b128 v[200:203], v8 offset:4096
    v_mfma_f32_16x16x32_bf16 v[92:95], v[180:183], v[204:207], v[92:95]
    ds_write_b64 v0, v[232:233] offset:18432
    s_waitcnt vmcnt(12) lgkmcnt(12)
    v_mfma_f32_16x16x32_bf16 v[64:67], v[184:187], v[208:211], v[64:67]
    ds_read_b128 v[204:207], v8 offset:6144
    ds_write_b64 v0, v[234:235] offset:18440
    v_mfma_f32_16x16x32_bf16 v[68:71], v[188:191], v[208:211], v[68:71]
    buffer_load_dwordx4 v[176:179], v27, s[68:71], s19 offen offset:0 sc1
    s_waitcnt lgkmcnt(12)
    v_mfma_f32_16x16x32_bf16 v[72:75], v[184:187], v[212:215], v[72:75]
    ds_read_b128 v[208:211], v9 offset:0
    v_mfma_f32_16x16x32_bf16 v[76:79], v[188:191], v[212:215], v[76:79]
    ds_write_b64 v0, v[236:237] offset:19456
    s_waitcnt lgkmcnt(13)
    v_mfma_f32_16x16x32_bf16 v[80:83], v[184:187], v[216:219], v[80:83]
    ds_read_b128 v[212:215], v9 offset:2048
    v_mfma_f32_16x16x32_bf16 v[84:87], v[188:191], v[216:219], v[84:87]
    buffer_load_dwordx4 v[180:183], v27, s[68:71], s19 offen offset:1024 sc1
    s_waitcnt lgkmcnt(12)
    v_mfma_f32_16x16x32_bf16 v[88:91], v[184:187], v[220:223], v[88:91]
    ds_read_b128 v[216:219], v9 offset:4096
    v_mfma_f32_16x16x32_bf16 v[92:95], v[188:191], v[220:223], v[92:95]
    ds_write_b64 v0, v[238:239] offset:19464
    s_waitcnt vmcnt(12) lgkmcnt(12)
    v_mfma_f32_16x16x32_bf16 v[64:67], v[128:131], v[192:195], v[64:67]
    ds_read_b128 v[220:223], v9 offset:6144
    v_mov_b32 v22, 22
    v_mfma_f32_16x16x32_bf16 v[68:71], v[132:135], v[192:195], v[68:71]
    buffer_load_dwordx4 v[184:187], v27, s[68:71], s19 offen offset:2048 sc1
    s_waitcnt lgkmcnt(11)
    v_mfma_f32_16x16x32_bf16 v[72:75], v[128:131], v[196:199], v[72:75]
    ds_read_b128 v[192:195], v8 offset:8192
    s_waitcnt lgkmcnt(11)
    v_min3_u32 v12, v12, v13, v14
    v_mfma_f32_16x16x32_bf16 v[76:79], v[132:135], v[196:199], v[76:79]
    ds_write_b32 v10, v22
    s_waitcnt lgkmcnt(11)
    v_mfma_f32_16x16x32_bf16 v[80:83], v[128:131], v[200:203], v[80:83]
    ds_read_b128 v[196:199], v8 offset:10240
    v_min_u32 v12, v12, v15
    v_mfma_f32_16x16x32_bf16 v[84:87], v[132:135], v[200:203], v[84:87]
    buffer_load_dwordx4 v[188:191], v27, s[68:71], s19 offen offset:3072 sc1
    s_waitcnt lgkmcnt(10)
    v_mfma_f32_16x16x32_bf16 v[88:91], v[128:131], v[204:207], v[88:91]
    ds_read_b128 v[200:203], v8 offset:12288
    s_bfe_u32 s19, s100, 24 + (4 << 16)
    v_mfma_f32_16x16x32_bf16 v[92:95], v[132:135], v[204:207], v[92:95]
    s_lshl_b32 s19, s19, 13
    s_waitcnt vmcnt(12) lgkmcnt(9)
    v_mfma_f32_16x16x32_bf16 v[64:67], v[136:139], v[208:211], v[64:67]
    ds_read_b128 v[204:207], v8 offset:14336
    v_cmp_gt_u32 vcc, 21, v12
    v_mfma_f32_16x16x32_bf16 v[68:71], v[140:143], v[208:211], v[68:71]
    buffer_load_dwordx4 v[128:131], v26, s[68:71], s19 offen offset:0 sc1
    s_waitcnt lgkmcnt(8)
    v_mfma_f32_16x16x32_bf16 v[72:75], v[136:139], v[212:215], v[72:75]
    ds_read_b128 v[208:211], v9 offset:8192
    s_cbranch_vccnz G2_slow4
G2_back4:
    v_mfma_f32_16x16x32_bf16 v[76:79], v[140:143], v[212:215], v[76:79]
    ds_write_b64 v0, v[240:241] offset:32768
    s_waitcnt lgkmcnt(9)
    v_mfma_f32_16x16x32_bf16 v[80:83], v[136:139], v[216:219], v[80:83]
    ds_read_b128 v[212:215], v9 offset:10240
    v_mfma_f32_16x16x32_bf16 v[84:87], v[140:143], v[216:219], v[84:87]
    buffer_load_dwordx4 v[132:135], v26, s[68:71], s19 offen offset:1024 sc1
    s_waitcnt lgkmcnt(8)
    v_mfma_f32_16x16x32_bf16 v[88:91], v[136:139], v[220:223], v[88:91]
    ds_read_b128 v[216:219], v9 offset:12288
    v_mfma_f32_16x16x32_bf16 v[92:95], v[140:143], v[220:223], v[92:95]
    ds_write_b64 v0, v[242:243] offset:32776
    s_waitcnt vmcnt(12) lgkmcnt(9)
    v_mfma_f32_16x16x32_bf16 v[64:67], v[144:147], v[192:195], v[64:67]
    ds_read_b128 v[220:223], v9 offset:14336
    ds_write_b64 v0, v[244:245] offset:33792
    v_mfma_f32_16x16x32_bf16 v[68:71], v[148:151], v[192:195], v[68:71]
    buffer_load_dwordx4 v[136:139], v26, s[68:71], s19 offen offset:2048 sc1
    s_waitcnt lgkmcnt(9)
    v_mfma_f32_16x16x32_bf16 v[72:75], v[144:147], v[196:199], v[72:75]
    ds_read_b128 v[192:195], v8 offset:16384
    v_mfma_f32_16x16x32_bf16 v[76:79], v[148:151], v[196:199], v[76:79]
    ds_write_b64 v0, v[246:247] offset:33800
    s_waitcnt lgkmcnt(10)
    v_mfma_f32_16x16x32_bf16 v[80:83], v[144:147], v[200:203], v[80:83]
    ds_read_b128 v[196:199], v8 offset:18432
    ds_read_b128 v[12:15], v11
    v_mfma_f32_16x16x32_bf16 v[84:87], v[148:151], v[200:203], v[84:87]
    buffer_load_dwordx4 v[140:143], v26, s[68:71], s19 offen offset:3072 sc1
    s_waitcnt lgkmcnt(11)
    v_mfma_f32_16x16x32_bf16 v[88:91], v[144:147], v[204:207], v[88:91]
    ds_read_b128 v[200:203], v8 offset:20480
    v_mfma_f32_16x16x32_bf16 v[92:95], v[148:151], v[204:207], v[92:95]
    ds_write_b64 v0, v[248:249] offset:34816
    s_waitcnt vmcnt(12) lgkmcnt(12)
    v_mfma_f32_16x16x32_bf16 v[64:67], v[152:155], v[208:211], v[64:67]
    ds_read_b128 v[204:207], v8 offset:22528
    ds_write_b64 v0, v[250:251] offset:34824
    v_mfma_f32_16x16x32_bf16 v[68:71], v[156:159], v[208:211], v[68:71]
    buffer_load_dwordx4 v[144:147], v27, s[68:71], s19 offen offset:0 sc1
    s_waitcnt lgkmcnt(12)
    v_mfma_f32_16x16x32_bf16 v[72:75], v[152:155], v[212:215], v[72:75]
    ds_read_b128 v[208:211], v9 offset:16384
    v_mfma_f32_16x16x32_bf16 v[76:79], v[156:159], v[212:215], v[76:79]
    ds_write_b64 v0, v[252:253] offset:35840
    s_waitcnt lgkmcnt(13)
    v_mfma_f32_16x16x32_bf16 v[80:83], v[152:155], v[216:219], v[80:83]
    ds_read_b128 v[212:215], v9 offset:18432
    v_mfma_f32_16x16x32_bf16 v[84:87], v[156:159], v[216:219], v[84:87]
    buffer_load_dwordx4 v[148:151], v27, s[68:71], s19 offen offset:1024 sc1
    s_waitcnt lgkmcnt(12)
    v_mfma_f32_16x16x32_bf16 v[88:91], v[152:155], v[220:223], v[88:91]
    ds_read_b128 v[216:219], v9 offset:20480
    v_mfma_f32_16x16x32_bf16 v[92:95], v[156:159], v[220:223], v[92:95]
    ds_write_b64 v0, v[254:255] offset:35848
    s_waitcnt vmcnt(12) lgkmcnt(12)
    v_mfma_f32_16x16x32_bf16 v[64:67], v[160:163], v[192:195], v[64:67]
    ds_read_b128 v[220:223], v9 offset:22528
    v_mov_b32 v22, 23
    v_mfma_f32_16x16x32_bf16 v[68:71], v[164:167], v[192:195], v[68:71]
    buffer_load_dwordx4 v[152:155], v27, s[68:71], s19 offen offset:2048 sc1
    s_waitcnt lgkmcnt(11)
    v_mfma_f32_16x16x32_bf16 v[72:75], v[160:163], v[196:199], v[72:75]
    ds_read_b128 v[192:195], v8 offset:24576
    s_waitcnt lgkmcnt(11)
    v_min3_u32 v12, v12, v13, v14
    v_mfma_f32_16x16x32_bf16 v[76:79], v[164:167], v[196:199], v[76:79]
    ds_write_b32 v10, v22
    s_waitcnt lgkmcnt(11)
    v_mfma_f32_16x16x32_bf16 v[80:83], v[160:163], v[200:203], v[80:83]
    ds_read_b128 v[196:199], v8 offset:26624
    v_min_u32 v12, v12, v15
    v_mfma_f32_16x16x32_bf16 v[84:87], v[164:167], v[200:203], v[84:87]
    buffer_load_dwordx4 v[156:159], v27, s[68:71], s19 offen offset:3072 sc1
    s_waitcnt lgkmcnt(10)
    v_mfma_f32_16x16x32_bf16 v[88:91], v[160:163], v[204:207], v[88:91]
    ds_read_b128 v[200:203], v8 offset:28672
    s_bfe_u32 s19, s100, 28 + (4 << 16)
    v_mfma_f32_16x16x32_bf16 v[92:95], v[164:167], v[204:207], v[92:95]
    s_lshl_b32 s19, s19, 13
    s_waitcnt vmcnt(12) lgkmcnt(9)
    v_mfma_f32_16x16x32_bf16 v[64:67], v[168:171], v[208:211], v[64:67]
    ds_read_b128 v[204:207], v8 offset:30720
    v_cmp_gt_u32 vcc, 22, v12
    v_mfma_f32_16x16x32_bf16 v[68:71], v[172:175], v[208:211], v[68:71]
    buffer_load_dwordx4 v[160:163], v26, s[68:71], s19 offen offset:0 sc1
    s_waitcnt lgkmcnt(8)
    v_mfma_f32_16x16x32_bf16 v[72:75], v[168:171], v[212:215], v[72:75]
    ds_read_b128 v[208:211], v9 offset:24576
    s_cbranch_vccnz G2_slow5
G2_back5:
    v_mfma_f32_16x16x32_bf16 v[76:79], v[172:175], v[212:215], v[76:79]
    ds_write_b64 v0, v[48:49] offset:49152
    s_waitcnt lgkmcnt(9)
    v_mfma_f32_16x16x32_bf16 v[80:83], v[168:171], v[216:219], v[80:83]
    ds_read_b128 v[212:215], v9 offset:26624
    v_mfma_f32_16x16x32_bf16 v[84:87], v[172:175], v[216:219], v[84:87]
    buffer_load_dwordx4 v[164:167], v26, s[68:71], s19 offen offset:1024 sc1
    s_waitcnt lgkmcnt(8)
    v_mfma_f32_16x16x32_bf16 v[88:91], v[168:171], v[220:223], v[88:91]
    ds_read_b128 v[216:219], v9 offset:28672
    v_mfma_f32_16x16x32_bf16 v[92:95], v[172:175], v[220:223], v[92:95]
    ds_write_b64 v0, v[50:51] offset:49160
    s_waitcnt vmcnt(12) lgkmcnt(9)
    v_mfma_f32_16x16x32_bf16 v[64:67], v[176:179], v[192:195], v[64:67]
    ds_read_b128 v[220:223], v9 offset:30720
    ds_write_b64 v0, v[52:53] offset:50176
    v_mfma_f32_16x16x32_bf16 v[68:71], v[180:183], v[192:195], v[68:71]
    buffer_load_dwordx4 v[168:171], v26, s[68:71], s19 offen offset:2048 sc1
    s_waitcnt lgkmcnt(9)
    v_mfma_f32_16x16x32_bf16 v[72:75], v[176:179], v[196:199], v[72:75]
    ds_read_b128 v[192:195], v6 offset:0
    v_mfma_f32_16x16x32_bf16 v[76:79], v[180:183], v[196:199], v[76:79]
    ds_write_b64 v0, v[54:55] offset:50184
    s_waitcnt lgkmcnt(10)
    v_mfma_f32_16x16x32_bf16 v[80:83], v[176:179], v[200:203], v[80:83]
    ds_read_b128 v[196:199], v6 offset:2048
    ds_read_b128 v[12:15], v11
    v_mfma_f32_16x16x32_bf16 v[84:87], v[180:183], v[200:203], v[84:87]
    buffer_load_dwordx4 v[172:175], v26, s[68:71], s19 offen offset:3072 sc1
    s_waitcnt lgkmcnt(11)
    v_mfma_f32_16x16x32_bf16 v[88:91], v[176:179], v[204:207], v[88:91]
    ds_read_b128 v[200:203], v6 offset:4096
    v_mfma_f32_16x16x32_bf16 v[92:95], v[180:183], v[204:207], v[92:95]
    ds_write_b64 v0, v[56:57] offset:51200
    s_waitcnt vmcnt(12) lgkmcnt(12)
    v_mfma_f32_16x16x32_bf16 v[64:67], v[184:187], v[208:211], v[64:67]
    ds_read_b128 v[204:207], v6 offset:6144
    ds_write_b64 v0, v[58:59] offset:51208
    v_mfma_f32_16x16x32_bf16 v[68:71], v[188:191], v[208:211], v[68:71]
    buffer_load_dwordx4 v[176:179], v27, s[68:71], s19 offen offset:0 sc1
    s_waitcnt lgkmcnt(12)
    v_mfma_f32_16x16x32_bf16 v[72:75], v[184:187], v[212:215], v[72:75]
    ds_read_b128 v[208:211], v7 offset:0
    v_mfma_f32_16x16x32_bf16 v[76:79], v[188:191], v[212:215], v[76:79]
    ds_write_b64 v0, v[60:61] offset:52224
    s_waitcnt lgkmcnt(13)
    v_mfma_f32_16x16x32_bf16 v[80:83], v[184:187], v[216:219], v[80:83]
    ds_read_b128 v[212:215], v7 offset:2048
    v_mfma_f32_16x16x32_bf16 v[84:87], v[188:191], v[216:219], v[84:87]
    buffer_load_dwordx4 v[180:183], v27, s[68:71], s19 offen offset:1024 sc1
    s_waitcnt lgkmcnt(12)
    v_mfma_f32_16x16x32_bf16 v[88:91], v[184:187], v[220:223], v[88:91]
    ds_read_b128 v[216:219], v7 offset:4096
    v_mfma_f32_16x16x32_bf16 v[92:95], v[188:191], v[220:223], v[92:95]
    ds_write_b64 v0, v[62:63] offset:52232
    s_waitcnt vmcnt(12) lgkmcnt(12)
    v_mfma_f32_16x16x32_bf16 v[64:67], v[128:131], v[192:195], v[64:67]
    ds_read_b128 v[220:223], v7 offset:6144
    v_mov_b32 v22, 24
    v_mfma_f32_16x16x32_bf16 v[68:71], v[132:135], v[192:195], v[68:71]
    buffer_load_dwordx4 v[184:187], v27, s[68:71], s19 offen offset:2048 sc1
    s_waitcnt lgkmcnt(11)
    v_mfma_f32_16x16x32_bf16 v[72:75], v[128:131], v[196:199], v[72:75]
    ds_read_b128 v[192:195], v6 offset:8192
    s_waitcnt lgkmcnt(11)
    v_min3_u32 v12, v12, v13, v14
    v_mfma_f32_16x16x32_bf16 v[76:79], v[132:135], v[196:199], v[76:79]
    ds_write_b32 v10, v22
    s_waitcnt lgkmcnt(11)
    v_mfma_f32_16x16x32_bf16 v[80:83], v[128:131], v[200:203], v[80:83]
    ds_read_b128 v[196:199], v6 offset:10240
    v_min_u32 v12, v12, v15
    v_mfma_f32_16x16x32_bf16 v[84:87], v[132:135], v[200:203], v[84:87]
    buffer_load_dwordx4 v[188:191], v27, s[68:71], s19 offen offset:3072 sc1
    s_waitcnt lgkmcnt(10)
    v_mfma_f32_16x16x32_bf16 v[88:91], v[128:131], v[204:207], v[88:91]
    ds_read_b128 v[200:203], v6 offset:12288
    s_bfe_u32 s19, s101, 0 + (4 << 16)
    v_mfma_f32_16x16x32_bf16 v[92:95], v[132:135], v[204:207], v[92:95]
    s_lshl_b32 s19, s19, 13
    s_waitcnt vmcnt(12) lgkmcnt(9)
    v_mfma_f32_16x16x32_bf16 v[64:67], v[136:139], v[208:211], v[64:67]
    ds_read_b128 v[204:207], v6 offset:14336
    v_cmp_gt_u32 vcc, 23, v12
    v_mfma_f32_16x16x32_bf16 v[68:71], v[140:143], v[208:211], v[68:71]
    buffer_load_dwordx4 v[128:131], v26, s[68:71], s19 offen offset:0 sc1
    s_waitcnt lgkmcnt(8)
    v_mfma_f32_16x16x32_bf16 v[72:75], v[136:139], v[212:215], v[72:75]
    ds_read_b128 v[208:211], v7 offset:8192
    s_cbranch_vccnz G2_slow6
G2_back6:
    v_mfma_f32_16x16x32_bf16 v[76:79], v[140:143], v[212:215], v[76:79]
    ds_write_b64 v1, v[32:33] offset:0
    s_waitcnt lgkmcnt(9)
    v_mfma_f32_16x16x32_bf16 v[80:83], v[136:139], v[216:219], v[80:83]
    ds_read_b128 v[212:215], v7 offset:10240
    v_mfma_f32_16x16x32_bf16 v[84:87], v[140:143], v[216:219], v[84:87]
    buffer_load_dwordx4 v[132:135], v26, s[68:71], s19 offen offset:1024 sc1
    s_waitcnt lgkmcnt(8)
    v_mfma_f32_16x16x32_bf16 v[88:91], v[136:139], v[220:223], v[88:91]
    ds_read_b128 v[216:219], v7 offset:12288
    v_mfma_f32_16x16x32_bf16 v[92:95], v[140:143], v[220:223], v[92:95]
    ds_write_b64 v1, v[34:35] offset:8
    s_waitcnt vmcnt(12) lgkmcnt(9)
    v_mfma_f32_16x16x32_bf16 v[64:67], v[144:147], v[192:195], v[64:67]
    ds_read_b128 v[220:223], v7 offset:14336
    ds_write_b64 v1, v[36:37] offset:1024
    v_mfma_f32_16x16x32_bf16 v[68:71], v[148:151], v[192:195], v[68:71]
    buffer_load_dwordx4 v[136:139], v26, s[68:71], s19 offen offset:2048 sc1
    s_waitcnt lgkmcnt(9)
    v_mfma_f32_16x16x32_bf16 v[72:75], v[144:147], v[196:199], v[72:75]
    ds_read_b128 v[192:195], v6 offset:16384
    v_mfma_f32_16x16x32_bf16 v[76:79], v[148:151], v[196:199], v[76:79]
    ds_write_b64 v1, v[38:39] offset:1032
    s_waitcnt lgkmcnt(10)
    v_mfma_f32_16x16x32_bf16 v[80:83], v[144:147], v[200:203], v[80:83]
    ds_read_b128 v[196:199], v6 offset:18432
    ds_read_b128 v[12:15], v11
    v_mfma_f32_16x16x32_bf16 v[84:87], v[148:151], v[200:203], v[84:87]
    buffer_load_dwordx4 v[140:143], v26, s[68:71], s19 offen offset:3072 sc1
    s_waitcnt lgkmcnt(11)
    v_mfma_f32_16x16x32_bf16 v[88:91], v[144:147], v[204:207], v[88:91]
    ds_read_b128 v[200:203], v6 offset:20480
    v_mfma_f32_16x16x32_bf16 v[92:95], v[148:151], v[204:207], v[92:95]
    ds_write_b64 v1, v[40:41] offset:2048
    s_waitcnt vmcnt(12) lgkmcnt(12)
    v_mfma_f32_16x16x32_bf16 v[64:67], v[152:155], v[208:211], v[64:67]
    ds_read_b128 v[204:207], v6 offset:22528
    ds_write_b64 v1, v[42:43] offset:2056
    v_mfma_f32_16x16x32_bf16 v[68:71], v[156:159], v[208:211], v[68:71]
    buffer_load_dwordx4 v[144:147], v27, s[68:71], s19 offen offset:0 sc1
    s_waitcnt lgkmcnt(12)
    v_mfma_f32_16x16x32_bf16 v[72:75], v[152:155], v[212:215], v[72:75]
    ds_read_b128 v[208:211], v7 offset:16384
    v_mfma_f32_16x16x32_bf16 v[76:79], v[156:159], v[212:215], v[76:79]
    ds_write_b64 v1, v[44:45] offset:3072
    s_waitcnt lgkmcnt(13)
    v_mfma_f32_16x16x32_bf16 v[80:83], v[152:155], v[216:219], v[80:83]
    ds_read_b128 v[212:215], v7 offset:18432
    v_mfma_f32_16x16x32_bf16 v[84:87], v[156:159], v[216:219], v[84:87]
    buffer_load_dwordx4 v[148:151], v27, s[68:71], s19 offen offset:1024 sc1
    s_waitcnt lgkmcnt(12)
    v_mfma_f32_16x16x32_bf16 v[88:91], v[152:155], v[220:223], v[88:91]
    ds_read_b128 v[216:219], v7 offset:20480
    v_mfma_f32_16x16x32_bf16 v[92:95], v[156:159], v[220:223], v[92:95]
    ds_write_b64 v1, v[46:47] offset:3080
    s_waitcnt vmcnt(12) lgkmcnt(12)
    v_mfma_f32_16x16x32_bf16 v[64:67], v[160:163], v[192:195], v[64:67]
    ds_read_b128 v[220:223], v7 offset:22528
    v_mov_b32 v22, 25
    v_mfma_f32_16x16x32_bf16 v[68:71], v[164:167], v[192:195], v[68:71]
    buffer_load_dwordx4 v[152:155], v27, s[68:71], s19 offen offset:2048 sc1
    s_waitcnt lgkmcnt(11)
    v_mfma_f32_16x16x32_bf16 v[72:75], v[160:163], v[196:199], v[72:75]
    ds_read_b128 v[192:195], v6 offset:24576
    s_waitcnt lgkmcnt(11)
    v_min3_u32 v12, v12, v13, v14
    v_mfma_f32_16x16x32_bf16 v[76:79], v[164:167], v[196:199], v[76:79]
    ds_write_b32 v10, v22
    s_waitcnt lgkmcnt(11)
    v_mfma_f32_16x16x32_bf16 v[80:83], v[160:163], v[200:203], v[80:83]
    ds_read_b128 v[196:199], v6 offset:26624
    v_min_u32 v12, v12, v15
    v_mfma_f32_16x16x32_bf16 v[84:87], v[164:167], v[200:203], v[84:87]
    buffer_load_dwordx4 v[156:159], v27, s[68:71], s19 offen offset:3072 sc1
    s_waitcnt lgkmcnt(10)
    v_mfma_f32_16x16x32_bf16 v[88:91], v[160:163], v[204:207], v[88:91]
    ds_read_b128 v[200:203], v6 offset:28672
    s_bfe_u32 s19, s101, 4 + (4 << 16)
    v_mfma_f32_16x16x32_bf16 v[92:95], v[164:167], v[204:207], v[92:95]
    s_lshl_b32 s19, s19, 13
    s_waitcnt vmcnt(12) lgkmcnt(9)
    v_mfma_f32_16x16x32_bf16 v[64:67], v[168:171], v[208:211], v[64:67]
    ds_read_b128 v[204:207], v6 offset:30720
    v_cmp_gt_u32 vcc, 24, v12
    v_mfma_f32_16x16x32_bf16 v[68:71], v[172:175], v[208:211], v[68:71]
    buffer_load_dwordx4 v[160:163], v26, s[68:71], s19 offen offset:0 sc1
    s_waitcnt lgkmcnt(8)
    v_mfma_f32_16x16x32_bf16 v[72:75], v[168:171], v[212:215], v[72:75]
    ds_read_b128 v[208:211], v7 offset:24576
    s_cbranch_vccnz G2_slow7
G2_back7:
    v_mfma_f32_16x16x32_bf16 v[76:79], v[172:175], v[212:215], v[76:79]
    ds_write_b64 v1, v[96:97] offset:16384
    s_waitcnt lgkmcnt(9)
    v_mfma_f32_16x16x32_bf16 v[80:83], v[168:171], v[216:219], v[80:83]
    ds_read_b128 v[212:215], v7 offset:26624
    v_mfma_f32_16x16x32_bf16 v[84:87], v[172:175], v[216:219], v[84:87]
    buffer_load_dwordx4 v[164:167], v26, s[68:71], s19 offen offset:1024 sc1
    s_waitcnt lgkmcnt(8)
    v_mfma_f32_16x16x32_bf16 v[88:91], v[168:171], v[220:223], v[88:91]
    ds_read_b128 v[216:219], v7 offset:28672
    v_mfma_f32_16x16x32_bf16 v[92:95], v[172:175], v[220:223], v[92:95]
    ds_write_b64 v1, v[98:99] offset:16392
    s_waitcnt vmcnt(12) lgkmcnt(9)
    v_mfma_f32_16x16x32_bf16 v[64:67], v[176:179], v[192:195], v[64:67]
    ds_read_b128 v[220:223], v7 offset:30720
    ds_write_b64 v1, v[100:101] offset:17408
    v_mfma_f32_16x16x32_bf16 v[68:71], v[180:183], v[192:195], v[68:71]
    buffer_load_dwordx4 v[168:171], v26, s[68:71], s19 offen offset:2048 sc1
    s_waitcnt lgkmcnt(9)
    v_mfma_f32_16x16x32_bf16 v[72:75], v[176:179], v[196:199], v[72:75]
    ds_read_b128 v[192:195], v6 offset:32768
    v_mfma_f32_16x16x32_bf16 v[76:79], v[180:183], v[196:199], v[76:79]
    ds_write_b64 v1, v[102:103] offset:17416
    s_waitcnt lgkmcnt(10)
    v_mfma_f32_16x16x32_bf16 v[80:83], v[176:179], v[200:203], v[80:83]
    ds_read_b128 v[196:199], v6 offset:34816
    ds_read_b128 v[12:15], v11
    v_mfma_f32_16x16x32_bf16 v[84:87], v[180:183], v[200:203], v[84:87]
    buffer_load_dwordx4 v[172:175], v26, s[68:71], s19 offen offset:3072 sc1
    s_waitcnt lgkmcnt(11)
    v_mfma_f32_16x16x32_bf16 v[88:91], v[176:179], v[204:207], v[88:91]
    ds_read_b128 v[200:203], v6 offset:36864
    v_mfma_f32_16x16x32_bf16 v[92:95], v[180:183], v[204:207], v[92:95]
    ds_write_b64 v1, v[104:105] offset:18432
    s_waitcnt vmcnt(12) lgkmcnt(12)
    v_mfma_f32_16x16x32_bf16 v[64:67], v[184:187], v[208:211], v[64:67]
    ds_read_b128 v[204:207], v6 offset:38912
    ds_write_b64 v1, v[106:107] offset:18440
    v_mfma_f32_16x16x32_bf16 v[68:71], v[188:191], v[208:211], v[68:71]
    buffer_load_dwordx4 v[176:179], v27, s[68:71], s19 offen offset:0 sc1
    s_waitcnt lgkmcnt(12)
    v_mfma_f32_16x16x32_bf16 v[72:75], v[184:187], v[212:215], v[72:75]
    ds_read_b128 v[208:211], v7 offset:32768
    v_mfma_f32_16x16x32_bf16 v[76:79], v[188:191], v[212:215], v[76:79]
    ds_write_b64 v1, v[108:109] offset:19456
    s_waitcnt lgkmcnt(13)
    v_mfma_f32_16x16x32_bf16 v[80:83], v[184:187], v[216:219], v[80:83]
    ds_read_b128 v[212:215], v7 offset:34816
    v_mfma_f32_16x16x32_bf16 v[84:87], v[188:191], v[216:219], v[84:87]
    buffer_load_dwordx4 v[180:183], v27, s[68:71], s19 offen offset:1024 sc1
    s_waitcnt lgkmcnt(12)
    v_mfma_f32_16x16x32_bf16 v[88:91], v[184:187], v[220:223], v[88:91]
    ds_read_b128 v[216:219], v7 offset:36864
    v_mfma_f32_16x16x32_bf16 v[92:95], v[188:191], v[220:223], v[92:95]
    ds_write_b64 v1, v[110:111] offset:19464
    s_waitcnt vmcnt(12) lgkmcnt(12)
    v_mfma_f32_16x16x32_bf16 v[64:67], v[128:131], v[192:195], v[64:67]
    ds_read_b128 v[220:223], v7 offset:38912
    v_mfma_f32_16x16x32_bf16 v[68:71], v[132:135], v[192:195], v[68:71]
    buffer_load_dwordx4 v[184:187], v27, s[68:71], s19 offen offset:2048 sc1
    s_waitcnt lgkmcnt(11)
    v_mfma_f32_16x16x32_bf16 v[72:75], v[128:131], v[196:199], v[72:75]
    ds_read_b128 v[192:195], v6 offset:40960
    s_waitcnt lgkmcnt(11)
    v_min3_u32 v12, v12, v13, v14
    v_mfma_f32_16x16x32_bf16 v[76:79], v[132:135], v[196:199], v[76:79]
    s_waitcnt lgkmcnt(10)
    v_mfma_f32_16x16x32_bf16 v[80:83], v[128:131], v[200:203], v[80:83]
    ds_read_b128 v[196:199], v6 offset:43008
    v_min_u32 v12, v12, v15
    v_mfma_f32_16x16x32_bf16 v[84:87], v[132:135], v[200:203], v[84:87]
    buffer_load_dwordx4 v[188:191], v27, s[68:71], s19 offen offset:3072 sc1
    s_waitcnt lgkmcnt(9)
    v_mfma_f32_16x16x32_bf16 v[88:91], v[128:131], v[204:207], v[88:91]
    ds_read_b128 v[200:203], v6 offset:45056
    s_bfe_u32 s19, s101, 8 + (4 << 16)
    v_mfma_f32_16x16x32_bf16 v[92:95], v[132:135], v[204:207], v[92:95]
    s_lshl_b32 s19, s19, 13
    s_waitcnt vmcnt(12) lgkmcnt(8)
    v_mfma_f32_16x16x32_bf16 v[64:67], v[136:139], v[208:211], v[64:67]
    ds_read_b128 v[204:207], v6 offset:47104
    v_cmp_gt_u32 vcc, 25, v12
    v_mfma_f32_16x16x32_bf16 v[68:71], v[140:143], v[208:211], v[68:71]
    buffer_load_dwordx4 v[128:131], v26, s[68:71], s19 offen offset:0 sc1
    s_waitcnt lgkmcnt(7)
    v_mfma_f32_16x16x32_bf16 v[72:75], v[136:139], v[212:215], v[72:75]
    ds_read_b128 v[208:211], v7 offset:40960
    s_cbranch_vccnz G2_slow8
G2_back8:
    v_mfma_f32_16x16x32_bf16 v[76:79], v[140:143], v[212:215], v[76:79]
    ds_write_b64 v0, v[112:113] offset:0
    s_waitcnt lgkmcnt(8)
    v_mfma_f32_16x16x32_bf16 v[80:83], v[136:139], v[216:219], v[80:83]
    ds_read_b128 v[212:215], v7 offset:43008
    v_mfma_f32_16x16x32_bf16 v[84:87], v[140:143], v[216:219], v[84:87]
    buffer_load_dwordx4 v[132:135], v26, s[68:71], s19 offen offset:1024 sc1
    s_waitcnt lgkmcnt(7)
    v_mfma_f32_16x16x32_bf16 v[88:91], v[136:139], v[220:223], v[88:91]
    ds_read_b128 v[216:219], v7 offset:45056
    v_mfma_f32_16x16x32_bf16 v[92:95], v[140:143], v[220:223], v[92:95]
    ds_write_b64 v0, v[114:115] offset:8
    s_waitcnt vmcnt(12) lgkmcnt(8)
    v_mfma_f32_16x16x32_bf16 v[64:67], v[144:147], v[192:195], v[64:67]
    ds_read_b128 v[220:223], v7 offset:47104
    ds_write_b64 v0, v[116:117] offset:1024
    v_mfma_f32_16x16x32_bf16 v[68:71], v[148:151], v[192:195], v[68:71]
    buffer_load_dwordx4 v[136:139], v26, s[68:71], s19 offen offset:2048 sc1
    s_waitcnt lgkmcnt(9)
    v_mfma_f32_16x16x32_bf16 v[72:75], v[144:147], v[196:199], v[72:75]
    ds_read_b128 v[192:195], v6 offset:49152
    v_mfma_f32_16x16x32_bf16 v[76:79], v[148:151], v[196:199], v[76:79]
    ds_write_b64 v0, v[118:119] offset:1032
    s_waitcnt lgkmcnt(10)
    v_mfma_f32_16x16x32_bf16 v[80:83], v[144:147], v[200:203], v[80:83]
    ds_read_b128 v[196:199], v6 offset:51200
    v_mfma_f32_16x16x32_bf16 v[84:87], v[148:151], v[200:203], v[84:87]
    buffer_load_dwordx4 v[140:143], v26, s[68:71], s19 offen offset:3072 sc1
    s_waitcnt lgkmcnt(10)
    v_mfma_f32_16x16x32_bf16 v[88:91], v[144:147], v[204:207], v[88:91]
    ds_read_b128 v[200:203], v6 offset:53248
    v_mfma_f32_16x16x32_bf16 v[92:95], v[148:151], v[204:207], v[92:95]
    ds_write_b64 v0, v[120:121] offset:2048
    s_waitcnt vmcnt(12) lgkmcnt(11)
    v_mfma_f32_16x16x32_bf16 v[64:67], v[152:155], v[208:211], v[64:67]
    ds_read_b128 v[204:207], v6 offset:55296
    ds_write_b64 v0, v[122:123] offset:2056
    v_mfma_f32_16x16x32_bf16 v[68:71], v[156:159], v[208:211], v[68:71]
    buffer_load_dwordx4 v[144:147], v27, s[68:71], s19 offen offset:0 sc1
    s_waitcnt lgkmcnt(11)
    v_mfma_f32_16x16x32_bf16 v[72:75], v[152:155], v[212:215], v[72:75]
    ds_read_b128 v[208:211], v7 offset:49152
    v_mfma_f32_16x16x32_bf16 v[76:79], v[156:159], v[212:215], v[76:79]
    ds_write_b64 v0, v[124:125] offset:3072
    s_waitcnt lgkmcnt(12)
    v_mfma_f32_16x16x32_bf16 v[80:83], v[152:155], v[216:219], v[80:83]
    ds_read_b128 v[212:215], v7 offset:51200
    v_mfma_f32_16x16x32_bf16 v[84:87], v[156:159], v[216:219], v[84:87]
    buffer_load_dwordx4 v[148:151], v27, s[68:71], s19 offen offset:1024 sc1
    s_waitcnt lgkmcnt(11)
    v_mfma_f32_16x16x32_bf16 v[88:91], v[152:155], v[220:223], v[88:91]
    ds_read_b128 v[216:219], v7 offset:53248
    v_mfma_f32_16x16x32_bf16 v[92:95], v[156:159], v[220:223], v[92:95]
    ds_write_b64 v0, v[126:127] offset:3080
    s_waitcnt vmcnt(12) lgkmcnt(11)
    v_mfma_f32_16x16x32_bf16 v[64:67], v[160:163], v[192:195], v[64:67]
    ds_read_b128 v[220:223], v7 offset:55296
    v_mov_b32 v22, 27
    v_mfma_f32_16x16x32_bf16 v[68:71], v[164:167], v[192:195], v[68:71]
    buffer_load_dwordx4 v[152:155], v27, s[68:71], s19 offen offset:2048 sc1
    s_waitcnt lgkmcnt(10)
    v_mfma_f32_16x16x32_bf16 v[72:75], v[160:163], v[196:199], v[72:75]
    ds_read_b128 v[192:195], v6 offset:57344
    v_mfma_f32_16x16x32_bf16 v[76:79], v[164:167], v[196:199], v[76:79]
    ds_write_b32 v10, v22
    s_waitcnt lgkmcnt(11)
    v_mfma_f32_16x16x32_bf16 v[80:83], v[160:163], v[200:203], v[80:83]
    ds_read_b128 v[196:199], v6 offset:59392
    v_mfma_f32_16x16x32_bf16 v[84:87], v[164:167], v[200:203], v[84:87]
    buffer_load_dwordx4 v[156:159], v27, s[68:71], s19 offen offset:3072 sc1
    s_waitcnt lgkmcnt(10)
    v_mfma_f32_16x16x32_bf16 v[88:91], v[160:163], v[204:207], v[88:91]
    ds_read_b128 v[200:203], v6 offset:61440
    s_bfe_u32 s19, s101, 12 + (4 << 16)
    v_mfma_f32_16x16x32_bf16 v[92:95], v[164:167], v[204:207], v[92:95]
    s_lshl_b32 s19, s19, 13
    s_waitcnt vmcnt(12) lgkmcnt(9)
    v_mfma_f32_16x16x32_bf16 v[64:67], v[168:171], v[208:211], v[64:67]
    ds_read_b128 v[204:207], v6 offset:63488
    v_mfma_f32_16x16x32_bf16 v[68:71], v[172:175], v[208:211], v[68:71]
    buffer_load_dwordx4 v[160:163], v26, s[68:71], s19 offen offset:0 sc1
    s_waitcnt lgkmcnt(8)
    v_mfma_f32_16x16x32_bf16 v[72:75], v[168:171], v[212:215], v[72:75]
    ds_read_b128 v[208:211], v7 offset:57344
    v_mfma_f32_16x16x32_bf16 v[76:79], v[172:175], v[212:215], v[76:79]
    s_waitcnt lgkmcnt(8)
    v_mfma_f32_16x16x32_bf16 v[80:83], v[168:171], v[216:219], v[80:83]
    ds_read_b128 v[212:215], v7 offset:59392
    v_mfma_f32_16x16x32_bf16 v[84:87], v[172:175], v[216:219], v[84:87]
    buffer_load_dwordx4 v[164:167], v26, s[68:71], s19 offen offset:1024 sc1
    s_waitcnt lgkmcnt(7)
    v_mfma_f32_16x16x32_bf16 v[88:91], v[168:171], v[220:223], v[88:91]
    ds_read_b128 v[216:219], v7 offset:61440
    v_mfma_f32_16x16x32_bf16 v[92:95], v[172:175], v[220:223], v[92:95]
    s_waitcnt vmcnt(12) lgkmcnt(7)
    v_mfma_f32_16x16x32_bf16 v[64:67], v[176:179], v[192:195], v[64:67]
    ds_read_b128 v[220:223], v7 offset:63488
    v_mfma_f32_16x16x32_bf16 v[68:71], v[180:183], v[192:195], v[68:71]
    buffer_load_dwordx4 v[168:171], v26, s[68:71], s19 offen offset:2048 sc1
    s_waitcnt lgkmcnt(6)
    v_mfma_f32_16x16x32_bf16 v[72:75], v[176:179], v[196:199], v[72:75]
    ds_read_b128 v[192:195], v8 offset:0
    v_mfma_f32_16x16x32_bf16 v[76:79], v[180:183], v[196:199], v[76:79]
    s_waitcnt lgkmcnt(6)
    v_mfma_f32_16x16x32_bf16 v[80:83], v[176:179], v[200:203], v[80:83]
    ds_read_b128 v[196:199], v8 offset:2048
    ds_read_b128 v[12:15], v11
    v_mfma_f32_16x16x32_bf16 v[84:87], v[180:183], v[200:203], v[84:87]
    buffer_load_dwordx4 v[172:175], v26, s[68:71], s19 offen offset:3072 sc1
    s_waitcnt lgkmcnt(7)
    v_mfma_f32_16x16x32_bf16 v[88:91], v[176:179], v[204:207], v[88:91]
    ds_read_b128 v[200:203], v8 offset:4096
    v_mfma_f32_16x16x32_bf16 v[92:95], v[180:183], v[204:207], v[92:95]
    s_waitcnt vmcnt(12) lgkmcnt(7)
    v_mfma_f32_16x16x32_bf16 v[64:67], v[184:187], v[208:211], v[64:67]
    ds_read_b128 v[204:207], v8 offset:6144
    v_mfma_f32_16x16x32_bf16 v[68:71], v[188:191], v[208:211], v[68:71]
    buffer_load_dwordx4 v[176:179], v27, s[68:71], s19 offen offset:0 sc1
    s_waitcnt lgkmcnt(7)
    v_mfma_f32_16x16x32_bf16 v[72:75], v[184:187], v[212:215], v[72:75]
    ds_read_b128 v[208:211], v9 offset:0
    v_mfma_f32_16x16x32_bf16 v[76:79], v[188:191], v[212:215], v[76:79]
    s_waitcnt lgkmcnt(7)
    v_mfma_f32_16x16x32_bf16 v[80:83], v[184:187], v[216:219], v[80:83]
    ds_read_b128 v[212:215], v9 offset:2048
    v_mfma_f32_16x16x32_bf16 v[84:87], v[188:191], v[216:219], v[84:87]
    buffer_load_dwordx4 v[180:183], v27, s[68:71], s19 offen offset:1024 sc1
    s_waitcnt lgkmcnt(7)
    v_mfma_f32_16x16x32_bf16 v[88:91], v[184:187], v[220:223], v[88:91]
    ds_read_b128 v[216:219], v9 offset:4096
    v_mfma_f32_16x16x32_bf16 v[92:95], v[188:191], v[220:223], v[92:95]
    s_waitcnt vmcnt(12) lgkmcnt(7)
    v_mfma_f32_16x16x32_bf16 v[64:67], v[128:131], v[192:195], v[64:67]
    ds_read_b128 v[220:223], v9 offset:6144
    v_mfma_f32_16x16x32_bf16 v[68:71], v[132:135], v[192:195], v[68:71]
    buffer_load_dwordx4 v[184:187], v27, s[68:71], s19 offen offset:2048 sc1
    s_waitcnt lgkmcnt(7)
    v_mfma_f32_16x16x32_bf16 v[72:75], v[128:131], v[196:199], v[72:75]
    ds_read_b128 v[192:195], v8 offset:8192
    s_waitcnt lgkmcnt(7)
    v_min3_u32 v12, v12, v13, v14
    v_mfma_f32_16x16x32_bf16 v[76:79], v[132:135], v[196:199], v[76:79]
    s_waitcnt lgkmcnt(6)
    v_mfma_f32_16x16x32_bf16 v[80:83], v[128:131], v[200:203], v[80:83]
    ds_read_b128 v[196:199], v8 offset:10240
    v_min_u32 v12, v12, v15
    v_mfma_f32_16x16x32_bf16 v[84:87], v[132:135], v[200:203], v[84:87]
    buffer_load_dwordx4 v[188:191], v27, s[68:71], s19 offen offset:3072 sc1
    s_waitcnt lgkmcnt(6)
    v_mfma_f32_16x16x32_bf16 v[88:91], v[128:131], v[204:207], v[88:91]
    ds_read_b128 v[200:203], v8 offset:12288
    s_bfe_u32 s19, s101, 16 + (4 << 16)
    v_mfma_f32_16x16x32_bf16 v[92:95], v[132:135], v[204:207], v[92:95]
    s_lshl_b32 s19, s19, 13
    s_waitcnt vmcnt(12) lgkmcnt(6)
    v_mfma_f32_16x16x32_bf16 v[64:67], v[136:139], v[208:211], v[64:67]
    ds_read_b128 v[204:207], v8 offset:14336
    v_cmp_gt_u32 vcc, 27, v12
    v_mfma_f32_16x16x32_bf16 v[68:71], v[140:143], v[208:211], v[68:71]
    buffer_load_dwordx4 v[128:131], v26, s[68:71], s19 offen offset:0 sc1
    s_waitcnt lgkmcnt(6)
    v_mfma_f32_16x16x32_bf16 v[72:75], v[136:139], v[212:215], v[72:75]
    ds_read_b128 v[208:211], v9 offset:8192
    s_cbranch_vccnz G2_slow10
G2_back10:
    v_mfma_f32_16x16x32_bf16 v[76:79], v[140:143], v[212:215], v[76:79]
    s_waitcnt lgkmcnt(6)
    v_mfma_f32_16x16x32_bf16 v[80:83], v[136:139], v[216:219], v[80:83]
    ds_read_b128 v[212:215], v9 offset:10240
    v_mfma_f32_16x16x32_bf16 v[84:87], v[140:143], v[216:219], v[84:87]
    buffer_load_dwordx4 v[132:135], v26, s[68:71], s19 offen offset:1024 sc1
    s_waitcnt lgkmcnt(6)
    v_mfma_f32_16x16x32_bf16 v[88:91], v[136:139], v[220:223], v[88:91]
    ds_read_b128 v[216:219], v9 offset:12288
    v_mfma_f32_16x16x32_bf16 v[92:95], v[140:143], v[220:223], v[92:95]
    s_waitcnt vmcnt(12) lgkmcnt(6)
    v_mfma_f32_16x16x32_bf16 v[64:67], v[144:147], v[192:195], v[64:67]
    ds_read_b128 v[220:223], v9 offset:14336
    v_mfma_f32_16x16x32_bf16 v[68:71], v[148:151], v[192:195], v[68:71]
    buffer_load_dwordx4 v[136:139], v26, s[68:71], s19 offen offset:2048 sc1
    s_waitcnt lgkmcnt(6)
    v_mfma_f32_16x16x32_bf16 v[72:75], v[144:147], v[196:199], v[72:75]
    ds_read_b128 v[192:195], v8 offset:16384
    v_mfma_f32_16x16x32_bf16 v[76:79], v[148:151], v[196:199], v[76:79]
    s_waitcnt lgkmcnt(6)
    v_mfma_f32_16x16x32_bf16 v[80:83], v[144:147], v[200:203], v[80:83]
    ds_read_b128 v[196:199], v8 offset:18432
    v_mfma_f32_16x16x32_bf16 v[84:87], v[148:151], v[200:203], v[84:87]
    buffer_load_dwordx4 v[140:143], v26, s[68:71], s19 offen offset:3072 sc1
    s_waitcnt lgkmcnt(6)
    v_mfma_f32_16x16x32_bf16 v[88:91], v[144:147], v[204:207], v[88:91]
    ds_read_b128 v[200:203], v8 offset:20480
    v_mfma_f32_16x16x32_bf16 v[92:95], v[148:151], v[204:207], v[92:95]
    s_waitcnt vmcnt(12) lgkmcnt(6)
    v_mfma_f32_16x16x32_bf16 v[64:67], v[152:155], v[208:211], v[64:67]
    ds_read_b128 v[204:207], v8 offset:22528
    v_mfma_f32_16x16x32_bf16 v[68:71], v[156:159], v[208:211], v[68:71]
    buffer_load_dwordx4 v[144:147], v27, s[68:71], s19 offen offset:0 sc1
    s_waitcnt lgkmcnt(6)
    v_mfma_f32_16x16x32_bf16 v[72:75], v[152:155], v[212:215], v[72:75]
    ds_read_b128 v[208:211], v9 offset:16384
    v_mfma_f32_16x16x32_bf16 v[76:79], v[156:159], v[212:215], v[76:79]
    s_waitcnt lgkmcnt(6)
    v_mfma_f32_16x16x32_bf16 v[80:83], v[152:155], v[216:219], v[80:83]
    ds_read_b128 v[212:215], v9 offset:18432
    v_mfma_f32_16x16x32_bf16 v[84:87], v[156:159], v[216:219], v[84:87]
    buffer_load_dwordx4 v[148:151], v27, s[68:71], s19 offen offset:1024 sc1
    s_waitcnt lgkmcnt(6)
    v_mfma_f32_16x16x32_bf16 v[88:91], v[152:155], v[220:223], v[88:91]
    ds_read_b128 v[216:219], v9 offset:20480
    v_mfma_f32_16x16x32_bf16 v[92:95], v[156:159], v[220:223], v[92:95]
    s_waitcnt vmcnt(12) lgkmcnt(6)
    v_mfma_f32_16x16x32_bf16 v[64:67], v[160:163], v[192:195], v[64:67]
    ds_read_b128 v[220:223], v9 offset:22528
    v_mfma_f32_16x16x32_bf16 v[68:71], v[164:167], v[192:195], v[68:71]
    buffer_load_dwordx4 v[152:155], v27, s[68:71], s19 offen offset:2048 sc1
    s_waitcnt lgkmcnt(6)
    v_mfma_f32_16x16x32_bf16 v[72:75], v[160:163], v[196:199], v[72:75]
    ds_read_b128 v[192:195], v8 offset:24576
    v_mfma_f32_16x16x32_bf16 v[76:79], v[164:167], v[196:199], v[76:79]
    s_waitcnt lgkmcnt(6)
    v_mfma_f32_16x16x32_bf16 v[80:83], v[160:163], v[200:203], v[80:83]
    ds_read_b128 v[196:199], v8 offset:26624
    v_mfma_f32_16x16x32_bf16 v[84:87], v[164:167], v[200:203], v[84:87]
    buffer_load_dwordx4 v[156:159], v27, s[68:71], s19 offen offset:3072 sc1
    s_waitcnt lgkmcnt(6)
    v_mfma_f32_16x16x32_bf16 v[88:91], v[160:163], v[204:207], v[88:91]
    ds_read_b128 v[200:203], v8 offset:28672
    s_bfe_u32 s19, s101, 20 + (4 << 16)
    v_mfma_f32_16x16x32_bf16 v[92:95], v[164:167], v[204:207], v[92:95]
    s_lshl_b32 s19, s19, 13
    s_waitcnt vmcnt(12) lgkmcnt(6)
    v_mfma_f32_16x16x32_bf16 v[64:67], v[168:171], v[208:211], v[64:67]
    ds_read_b128 v[204:207], v8 offset:30720
    v_mfma_f32_16x16x32_bf16 v[68:71], v[172:175], v[208:211], v[68:71]
    buffer_load_dwordx4 v[160:163], v26, s[68:71], s19 offen offset:0 sc1
    s_waitcnt lgkmcnt(6)
    v_mfma_f32_16x16x32_bf16 v[72:75], v[168:171], v[212:215], v[72:75]
    ds_read_b128 v[208:211], v9 offset:24576
    v_mfma_f32_16x16x32_bf16 v[76:79], v[172:175], v[212:215], v[76:79]
    s_waitcnt lgkmcnt(6)
    v_mfma_f32_16x16x32_bf16 v[80:83], v[168:171], v[216:219], v[80:83]
    ds_read_b128 v[212:215], v9 offset:26624
    v_mfma_f32_16x16x32_bf16 v[84:87], v[172:175], v[216:219], v[84:87]
    buffer_load_dwordx4 v[164:167], v26, s[68:71], s19 offen offset:1024 sc1
    s_waitcnt lgkmcnt(6)
    v_mfma_f32_16x16x32_bf16 v[88:91], v[168:171], v[220:223], v[88:91]
    ds_read_b128 v[216:219], v9 offset:28672
    v_mfma_f32_16x16x32_bf16 v[92:95], v[172:175], v[220:223], v[92:95]
    s_waitcnt vmcnt(12) lgkmcnt(6)
    v_mfma_f32_16x16x32_bf16 v[64:67], v[176:179], v[192:195], v[64:67]
    ds_read_b128 v[220:223], v9 offset:30720
    v_mfma_f32_16x16x32_bf16 v[68:71], v[180:183], v[192:195], v[68:71]
    buffer_load_dwordx4 v[168:171], v26, s[68:71], s19 offen offset:2048 sc1
    s_waitcnt lgkmcnt(6)
    v_mfma_f32_16x16x32_bf16 v[72:75], v[176:179], v[196:199], v[72:75]
    ds_read_b128 v[192:195], v6 offset:0
    v_mfma_f32_16x16x32_bf16 v[76:79], v[180:183], v[196:199], v[76:79]
    s_waitcnt lgkmcnt(6)
    v_mfma_f32_16x16x32_bf16 v[80:83], v[176:179], v[200:203], v[80:83]
    ds_read_b128 v[196:199], v6 offset:2048
    v_mfma_f32_16x16x32_bf16 v[84:87], v[180:183], v[200:203], v[84:87]
    buffer_load_dwordx4 v[172:175], v26, s[68:71], s19 offen offset:3072 sc1
    s_waitcnt lgkmcnt(6)
    v_mfma_f32_16x16x32_bf16 v[88:91], v[176:179], v[204:207], v[88:91]
    ds_read_b128 v[200:203], v6 offset:4096
    v_mfma_f32_16x16x32_bf16 v[92:95], v[180:183], v[204:207], v[92:95]
    s_waitcnt vmcnt(12) lgkmcnt(6)
    v_mfma_f32_16x16x32_bf16 v[64:67], v[184:187], v[208:211], v[64:67]
    ds_read_b128 v[204:207], v6 offset:6144
    v_mfma_f32_16x16x32_bf16 v[68:71], v[188:191], v[208:211], v[68:71]
    buffer_load_dwordx4 v[176:179], v27, s[68:71], s19 offen offset:0 sc1
    s_waitcnt lgkmcnt(6)
    v_mfma_f32_16x16x32_bf16 v[72:75], v[184:187], v[212:215], v[72:75]
    ds_read_b128 v[208:211], v7 offset:0
    ds_read_b32 v18, v11 offset:68
    v_mfma_f32_16x16x32_bf16 v[76:79], v[188:191], v[212:215], v[76:79]
    s_waitcnt lgkmcnt(7)
    v_mfma_f32_16x16x32_bf16 v[80:83], v[184:187], v[216:219], v[80:83]
    ds_read_b128 v[212:215], v7 offset:2048
    v_mfma_f32_16x16x32_bf16 v[84:87], v[188:191], v[216:219], v[84:87]
    buffer_load_dwordx4 v[180:183], v27, s[68:71], s19 offen offset:1024 sc1
    s_waitcnt lgkmcnt(7)
    v_mfma_f32_16x16x32_bf16 v[88:91], v[184:187], v[220:223], v[88:91]
    ds_read_b128 v[216:219], v7 offset:4096
    v_mfma_f32_16x16x32_bf16 v[92:95], v[188:191], v[220:223], v[92:95]
    s_waitcnt vmcnt(12) lgkmcnt(7)
    v_mfma_f32_16x16x32_bf16 v[64:67], v[128:131], v[192:195], v[64:67]
    ds_read_b128 v[220:223], v7 offset:6144
    v_mfma_f32_16x16x32_bf16 v[68:71], v[132:135], v[192:195], v[68:71]
    buffer_load_dwordx4 v[184:187], v27, s[68:71], s19 offen offset:2048 sc1
    s_waitcnt lgkmcnt(7)
    v_mfma_f32_16x16x32_bf16 v[72:75], v[128:131], v[196:199], v[72:75]
    ds_read_b128 v[192:195], v6 offset:8192
    v_mfma_f32_16x16x32_bf16 v[76:79], v[132:135], v[196:199], v[76:79]
    s_waitcnt lgkmcnt(7)
    v_mfma_f32_16x16x32_bf16 v[80:83], v[128:131], v[200:203], v[80:83]
    ds_read_b128 v[196:199], v6 offset:10240
    v_add_u32 v8, 32768, v8
    v_mfma_f32_16x16x32_bf16 v[84:87], v[132:135], v[200:203], v[84:87]
    buffer_load_dwordx4 v[188:191], v27, s[68:71], s19 offen offset:3072 sc1
    s_waitcnt lgkmcnt(7)
    v_mfma_f32_16x16x32_bf16 v[88:91], v[128:131], v[204:207], v[88:91]
    ds_read_b128 v[200:203], v6 offset:12288
    s_bfe_u32 s19, s101, 24 + (4 << 16)
    v_mfma_f32_16x16x32_bf16 v[92:95], v[132:135], v[204:207], v[92:95]
    s_lshl_b32 s19, s19, 13
    s_waitcnt vmcnt(12) lgkmcnt(7)
    v_mfma_f32_16x16x32_bf16 v[64:67], v[136:139], v[208:211], v[64:67]
    ds_read_b128 v[204:207], v6 offset:14336
    v_add_u32 v9, 32768, v9
    v_mfma_f32_16x16x32_bf16 v[68:71], v[140:143], v[208:211], v[68:71]
    buffer_load_dwordx4 v[128:131], v26, s[68:71], s19 offen offset:0 sc1
    s_waitcnt lgkmcnt(6)
    v_mfma_f32_16x16x32_bf16 v[72:75], v[136:139], v[212:215], v[72:75]
    ds_read_b128 v[208:211], v7 offset:8192
    v_cmp_gt_u32 vcc, 4, v18
    v_mfma_f32_16x16x32_bf16 v[76:79], v[140:143], v[212:215], v[76:79]
    s_waitcnt lgkmcnt(6)
    v_mfma_f32_16x16x32_bf16 v[80:83], v[136:139], v[216:219], v[80:83]
    ds_read_b128 v[212:215], v7 offset:10240
    v_mfma_f32_16x16x32_bf16 v[84:87], v[140:143], v[216:219], v[84:87]
    buffer_load_dwordx4 v[132:135], v26, s[68:71], s19 offen offset:1024 sc1
    s_waitcnt lgkmcnt(6)
    v_mfma_f32_16x16x32_bf16 v[88:91], v[136:139], v[220:223], v[88:91]
    ds_read_b128 v[216:219], v7 offset:12288
    s_cbranch_vccnz G2_slowc
G2_backc:
    v_mfma_f32_16x16x32_bf16 v[92:95], v[140:143], v[220:223], v[92:95]
    s_waitcnt vmcnt(12) lgkmcnt(6)
    v_mfma_f32_16x16x32_bf16 v[64:67], v[144:147], v[192:195], v[64:67]
    ds_read_b128 v[220:223], v7 offset:14336
    v_mfma_f32_16x16x32_bf16 v[68:71], v[148:151], v[192:195], v[68:71]
    buffer_load_dwordx4 v[136:139], v26, s[68:71], s19 offen offset:2048 sc1
    s_waitcnt lgkmcnt(6)
    v_mfma_f32_16x16x32_bf16 v[72:75], v[144:147], v[196:199], v[72:75]
    ds_read_b128 v[192:195], v8 offset:0
    v_mfma_f32_16x16x32_bf16 v[76:79], v[148:151], v[196:199], v[76:79]
    s_waitcnt lgkmcnt(6)
    v_mfma_f32_16x16x32_bf16 v[80:83], v[144:147], v[200:203], v[80:83]
    ds_read_b128 v[196:199], v8 offset:2048
    v_mfma_f32_16x16x32_bf16 v[84:87], v[148:151], v[200:203], v[84:87]
    buffer_load_dwordx4 v[140:143], v26, s[68:71], s19 offen offset:3072 sc1
    s_waitcnt lgkmcnt(6)
    v_mfma_f32_16x16x32_bf16 v[88:91], v[144:147], v[204:207], v[88:91]
    ds_read_b128 v[200:203], v8 offset:25856
    v_mfma_f32_16x16x32_bf16 v[92:95], v[148:151], v[204:207], v[92:95]
    s_waitcnt vmcnt(12) lgkmcnt(6)
    v_mfma_f32_16x16x32_bf16 v[64:67], v[152:155], v[208:211], v[64:67]
    ds_read_b128 v[204:207], v8 offset:27904
    v_mfma_f32_16x16x32_bf16 v[68:71], v[156:159], v[208:211], v[68:71]
    buffer_load_dwordx4 v[144:147], v27, s[68:71], s19 offen offset:0 sc1
    s_waitcnt lgkmcnt(6)
    v_mfma_f32_16x16x32_bf16 v[72:75], v[152:155], v[212:215], v[72:75]
    ds_read_b128 v[208:211], v9 offset:0
    v_mfma_f32_16x16x32_bf16 v[76:79], v[156:159], v[212:215], v[76:79]
    s_waitcnt lgkmcnt(6)
    v_mfma_f32_16x16x32_bf16 v[80:83], v[152:155], v[216:219], v[80:83]
    ds_read_b128 v[212:215], v9 offset:2048
    v_mfma_f32_16x16x32_bf16 v[84:87], v[156:159], v[216:219], v[84:87]
    buffer_load_dwordx4 v[148:151], v27, s[68:71], s19 offen offset:1024 sc1
    s_waitcnt lgkmcnt(6)
    v_mfma_f32_16x16x32_bf16 v[88:91], v[152:155], v[220:223], v[88:91]
    ds_read_b128 v[216:219], v9 offset:25856
    v_mfma_f32_16x16x32_bf16 v[92:95], v[156:159], v[220:223], v[92:95]
    s_waitcnt vmcnt(12) lgkmcnt(6)
    v_mfma_f32_16x16x32_bf16 v[64:67], v[160:163], v[192:195], v[64:67]
    ds_read_b128 v[220:223], v9 offset:27904
    v_mfma_f32_16x16x32_bf16 v[68:71], v[164:167], v[192:195], v[68:71]
    buffer_load_dwordx4 v[152:155], v27, s[68:71], s19 offen offset:2048 sc1
    s_waitcnt lgkmcnt(6)
    v_mfma_f32_16x16x32_bf16 v[72:75], v[160:163], v[196:199], v[72:75]
    ds_read_b128 v[192:195], v8 offset:12928
    v_mfma_f32_16x16x32_bf16 v[76:79], v[164:167], v[196:199], v[76:79]
    s_waitcnt lgkmcnt(6)
    v_mfma_f32_16x16x32_bf16 v[80:83], v[160:163], v[200:203], v[80:83]
    ds_read_b128 v[196:199], v8 offset:14976
    v_mfma_f32_16x16x32_bf16 v[84:87], v[164:167], v[200:203], v[84:87]
    buffer_load_dwordx4 v[156:159], v27, s[68:71], s19 offen offset:3072 sc1
    s_waitcnt lgkmcnt(6)
    v_mfma_f32_16x16x32_bf16 v[88:91], v[160:163], v[204:207], v[88:91]
    ds_read_b128 v[200:203], v8 offset:38784
    s_bfe_u32 s19, s101, 28 + (4 << 16)
    v_mfma_f32_16x16x32_bf16 v[92:95], v[164:167], v[204:207], v[92:95]
    s_lshl_b32 s19, s19, 13
    s_waitcnt vmcnt(12) lgkmcnt(6)
    v_mfma_f32_16x16x32_bf16 v[64:67], v[168:171], v[208:211], v[64:67]
    ds_read_b128 v[204:207], v8 offset:40832
    v_mfma_f32_16x16x32_bf16 v[68:71], v[172:175], v[208:211], v[68:71]
    buffer_load_dwordx4 v[160:163], v26, s[68:71], s19 offen offset:0 sc1
    s_waitcnt lgkmcnt(6)
    v_mfma_f32_16x16x32_bf16 v[72:75], v[168:171], v[212:215], v[72:75]
    ds_read_b128 v[208:211], v9 offset:12928
    v_mfma_f32_16x16x32_bf16 v[76:79], v[172:175], v[212:215], v[76:79]
    s_waitcnt lgkmcnt(6)
    v_mfma_f32_16x16x32_bf16 v[80:83], v[168:171], v[216:219], v[80:83]
    ds_read_b128 v[212:215], v9 offset:14976
    v_mfma_f32_16x16x32_bf16 v[84:87], v[172:175], v[216:219], v[84:87]
    buffer_load_dwordx4 v[164:167], v26, s[68:71], s19 offen offset:1024 sc1
    s_waitcnt lgkmcnt(6)
    v_mfma_f32_16x16x32_bf16 v[88:91], v[168:171], v[220:223], v[88:91]
    ds_read_b128 v[216:219], v9 offset:38784
    v_mfma_f32_16x16x32_bf16 v[92:95], v[172:175], v[220:223], v[92:95]
    s_waitcnt vmcnt(12) lgkmcnt(6)
    v_mfma_f32_16x16x32_bf16 v[64:67], v[176:179], v[192:195], v[64:67]
    ds_read_b128 v[220:223], v9 offset:40832
    v_mfma_f32_16x16x32_bf16 v[68:71], v[180:183], v[192:195], v[68:71]
    buffer_load_dwordx4 v[168:171], v26, s[68:71], s19 offen offset:2048 sc1
    s_waitcnt lgkmcnt(6)
    v_mfma_f32_16x16x32_bf16 v[72:75], v[176:179], v[196:199], v[72:75]
    ds_read_b128 v[192:195], v8 offset:4096
    v_mfma_f32_16x16x32_bf16 v[76:79], v[180:183], v[196:199], v[76:79]
    s_waitcnt lgkmcnt(6)
    v_mfma_f32_16x16x32_bf16 v[80:83], v[176:179], v[200:203], v[80:83]
    ds_read_b128 v[196:199], v8 offset:6144
    v_mfma_f32_16x16x32_bf16 v[84:87], v[180:183], v[200:203], v[84:87]
    buffer_load_dwordx4 v[172:175], v26, s[68:71], s19 offen offset:3072 sc1
    s_waitcnt lgkmcnt(6)
    v_mfma_f32_16x16x32_bf16 v[88:91], v[176:179], v[204:207], v[88:91]
    ds_read_b128 v[200:203], v8 offset:29952
    v_mfma_f32_16x16x32_bf16 v[92:95], v[180:183], v[204:207], v[92:95]
    s_waitcnt vmcnt(12) lgkmcnt(6)
    v_mfma_f32_16x16x32_bf16 v[64:67], v[184:187], v[208:211], v[64:67]
    ds_read_b128 v[204:207], v8 offset:32000
    v_mfma_f32_16x16x32_bf16 v[68:71], v[188:191], v[208:211], v[68:71]
    buffer_load_dwordx4 v[176:179], v27, s[68:71], s19 offen offset:0 sc1
    s_waitcnt lgkmcnt(6)
    v_mfma_f32_16x16x32_bf16 v[72:75], v[184:187], v[212:215], v[72:75]
    ds_read_b128 v[208:211], v9 offset:4096
    v_mfma_f32_16x16x32_bf16 v[76:79], v[188:191], v[212:215], v[76:79]
    s_waitcnt lgkmcnt(6)
    v_mfma_f32_16x16x32_bf16 v[80:83], v[184:187], v[216:219], v[80:83]
    ds_read_b128 v[212:215], v9 offset:6144
    v_mfma_f32_16x16x32_bf16 v[84:87], v[188:191], v[216:219], v[84:87]
    buffer_load_dwordx4 v[180:183], v27, s[68:71], s19 offen offset:1024 sc1
    s_waitcnt lgkmcnt(6)
    v_mfma_f32_16x16x32_bf16 v[88:91], v[184:187], v[220:223], v[88:91]
    ds_read_b128 v[216:219], v9 offset:29952
    v_mfma_f32_16x16x32_bf16 v[92:95], v[188:191], v[220:223], v[92:95]
    s_waitcnt vmcnt(12) lgkmcnt(6)
    v_mfma_f32_16x16x32_bf16 v[64:67], v[128:131], v[192:195], v[64:67]
    ds_read_b128 v[220:223], v9 offset:32000
    v_mfma_f32_16x16x32_bf16 v[68:71], v[132:135], v[192:195], v[68:71]
    buffer_load_dwordx4 v[184:187], v27, s[68:71], s19 offen offset:2048 sc1
    s_waitcnt lgkmcnt(6)
    v_mfma_f32_16x16x32_bf16 v[72:75], v[128:131], v[196:199], v[72:75]
    ds_read_b128 v[192:195], v8 offset:17024
    v_mfma_f32_16x16x32_bf16 v[76:79], v[132:135], v[196:199], v[76:79]
    s_waitcnt lgkmcnt(6)
    v_mfma_f32_16x16x32_bf16 v[80:83], v[128:131], v[200:203], v[80:83]
    ds_read_b128 v[196:199], v8 offset:19072
    v_mfma_f32_16x16x32_bf16 v[84:87], v[132:135], v[200:203], v[84:87]
    buffer_load_dwordx4 v[188:191], v27, s[68:71], s19 offen offset:3072 sc1
    s_waitcnt lgkmcnt(6)
    v_mfma_f32_16x16x32_bf16 v[88:91], v[128:131], v[204:207], v[88:91]
    ds_read_b128 v[200:203], v8 offset:42880
    v_mfma_f32_16x16x32_bf16 v[92:95], v[132:135], v[204:207], v[92:95]
    s_waitcnt vmcnt(12) lgkmcnt(6)
    v_mfma_f32_16x16x32_bf16 v[64:67], v[136:139], v[208:211], v[64:67]
    ds_read_b128 v[204:207], v8 offset:44928
    v_mfma_f32_16x16x32_bf16 v[68:71], v[140:143], v[208:211], v[68:71]
    s_waitcnt lgkmcnt(6)
    v_mfma_f32_16x16x32_bf16 v[72:75], v[136:139], v[212:215], v[72:75]
    ds_read_b128 v[208:211], v9 offset:17024
    v_mfma_f32_16x16x32_bf16 v[76:79], v[140:143], v[212:215], v[76:79]
    s_waitcnt lgkmcnt(6)
    v_mfma_f32_16x16x32_bf16 v[80:83], v[136:139], v[216:219], v[80:83]
    ds_read_b128 v[212:215], v9 offset:19072
    v_mfma_f32_16x16x32_bf16 v[84:87], v[140:143], v[216:219], v[84:87]
    s_waitcnt lgkmcnt(6)
    v_mfma_f32_16x16x32_bf16 v[88:91], v[136:139], v[220:223], v[88:91]
    ds_read_b128 v[216:219], v9 offset:42880
    v_mfma_f32_16x16x32_bf16 v[92:95], v[140:143], v[220:223], v[92:95]
    s_waitcnt vmcnt(10) lgkmcnt(6)
    v_mfma_f32_16x16x32_bf16 v[64:67], v[144:147], v[192:195], v[64:67]
    ds_read_b128 v[220:223], v9 offset:44928
    v_mfma_f32_16x16x32_bf16 v[68:71], v[148:151], v[192:195], v[68:71]
    s_waitcnt lgkmcnt(6)
    v_mfma_f32_16x16x32_bf16 v[72:75], v[144:147], v[196:199], v[72:75]
    ds_read_b128 v[192:195], v8 offset:8192
    v_mfma_f32_16x16x32_bf16 v[76:79], v[148:151], v[196:199], v[76:79]
    s_waitcnt lgkmcnt(6)
    v_mfma_f32_16x16x32_bf16 v[80:83], v[144:147], v[200:203], v[80:83]
    ds_read_b128 v[196:199], v8 offset:10240
    v_mfma_f32_16x16x32_bf16 v[84:87], v[148:151], v[200:203], v[84:87]
    s_waitcnt lgkmcnt(6)
    v_mfma_f32_16x16x32_bf16 v[88:91], v[144:147], v[204:207], v[88:91]
    ds_read_b128 v[200:203], v8 offset:34048
    v_mfma_f32_16x16x32_bf16 v[92:95], v[148:151], v[204:207], v[92:95]
    s_waitcnt vmcnt(8) lgkmcnt(6)
    v_mfma_f32_16x16x32_bf16 v[64:67], v[152:155], v[208:211], v[64:67]
    ds_read_b128 v[204:207], v8 offset:36096
    v_mfma_f32_16x16x32_bf16 v[68:71], v[156:159], v[208:211], v[68:71]
    s_waitcnt lgkmcnt(6)
    v_mfma_f32_16x16x32_bf16 v[72:75], v[152:155], v[212:215], v[72:75]
    ds_read_b128 v[208:211], v9 offset:8192
    v_mfma_f32_16x16x32_bf16 v[76:79], v[156:159], v[212:215], v[76:79]
    s_waitcnt lgkmcnt(6)
    v_mfma_f32_16x16x32_bf16 v[80:83], v[152:155], v[216:219], v[80:83]
    ds_read_b128 v[212:215], v9 offset:10240
    v_mfma_f32_16x16x32_bf16 v[84:87], v[156:159], v[216:219], v[84:87]
    s_waitcnt lgkmcnt(6)
    v_mfma_f32_16x16x32_bf16 v[88:91], v[152:155], v[220:223], v[88:91]
    ds_read_b128 v[216:219], v9 offset:34048
    v_mfma_f32_16x16x32_bf16 v[92:95], v[156:159], v[220:223], v[92:95]
    s_waitcnt vmcnt(6) lgkmcnt(6)
    v_mfma_f32_16x16x32_bf16 v[64:67], v[160:163], v[192:195], v[64:67]
    ds_read_b128 v[220:223], v9 offset:36096
    v_mfma_f32_16x16x32_bf16 v[68:71], v[164:167], v[192:195], v[68:71]
    s_waitcnt lgkmcnt(6)
    v_mfma_f32_16x16x32_bf16 v[72:75], v[160:163], v[196:199], v[72:75]
    ds_read_b128 v[192:195], v8 offset:21120
    v_mfma_f32_16x16x32_bf16 v[76:79], v[164:167], v[196:199], v[76:79]
    s_waitcnt lgkmcnt(6)
    v_mfma_f32_16x16x32_bf16 v[80:83], v[160:163], v[200:203], v[80:83]
    ds_read_b128 v[196:199], v8 offset:23168
    v_mfma_f32_16x16x32_bf16 v[84:87], v[164:167], v[200:203], v[84:87]
    s_waitcnt lgkmcnt(6)
    v_mfma_f32_16x16x32_bf16 v[88:91], v[160:163], v[204:207], v[88:91]
    ds_read_b128 v[200:203], v8 offset:46976
    v_mfma_f32_16x16x32_bf16 v[92:95], v[164:167], v[204:207], v[92:95]
    s_waitcnt vmcnt(4) lgkmcnt(6)
    v_mfma_f32_16x16x32_bf16 v[64:67], v[168:171], v[208:211], v[64:67]
    ds_read_b128 v[204:207], v8 offset:49024
    v_mfma_f32_16x16x32_bf16 v[68:71], v[172:175], v[208:211], v[68:71]
    s_waitcnt lgkmcnt(6)
    v_mfma_f32_16x16x32_bf16 v[72:75], v[168:171], v[212:215], v[72:75]
    ds_read_b128 v[208:211], v9 offset:21120
    v_mfma_f32_16x16x32_bf16 v[76:79], v[172:175], v[212:215], v[76:79]
    s_waitcnt lgkmcnt(6)
    v_mfma_f32_16x16x32_bf16 v[80:83], v[168:171], v[216:219], v[80:83]
    ds_read_b128 v[212:215], v9 offset:23168
    v_mfma_f32_16x16x32_bf16 v[84:87], v[172:175], v[216:219], v[84:87]
    s_waitcnt lgkmcnt(6)
    v_mfma_f32_16x16x32_bf16 v[88:91], v[168:171], v[220:223], v[88:91]
    ds_read_b128 v[216:219], v9 offset:46976
    v_mfma_f32_16x16x32_bf16 v[92:95], v[172:175], v[220:223], v[92:95]
    s_waitcnt vmcnt(2) lgkmcnt(6)
    v_mfma_f32_16x16x32_bf16 v[64:67], v[176:179], v[192:195], v[64:67]
    ds_read_b128 v[220:223], v9 offset:49024
    v_mfma_f32_16x16x32_bf16 v[68:71], v[180:183], v[192:195], v[68:71]
    s_waitcnt lgkmcnt(6)
    v_mfma_f32_16x16x32_bf16 v[72:75], v[176:179], v[196:199], v[72:75]
    v_mfma_f32_16x16x32_bf16 v[76:79], v[180:183], v[196:199], v[76:79]
    s_waitcnt lgkmcnt(5)
    v_mfma_f32_16x16x32_bf16 v[80:83], v[176:179], v[200:203], v[80:83]
    v_mfma_f32_16x16x32_bf16 v[84:87], v[180:183], v[200:203], v[84:87]
    s_waitcnt lgkmcnt(4)
    v_mfma_f32_16x16x32_bf16 v[88:91], v[176:179], v[204:207], v[88:91]
    v_mfma_f32_16x16x32_bf16 v[92:95], v[180:183], v[204:207], v[92:95]
    s_waitcnt vmcnt(0) lgkmcnt(3)
    v_mfma_f32_16x16x32_bf16 v[64:67], v[184:187], v[208:211], v[64:67]
    v_mfma_f32_16x16x32_bf16 v[68:71], v[188:191], v[208:211], v[68:71]
    s_waitcnt lgkmcnt(2)
    v_mfma_f32_16x16x32_bf16 v[72:75], v[184:187], v[212:215], v[72:75]
    v_mfma_f32_16x16x32_bf16 v[76:79], v[188:191], v[212:215], v[76:79]
    s_waitcnt lgkmcnt(1)
    v_mfma_f32_16x16x32_bf16 v[80:83], v[184:187], v[216:219], v[80:83]
    v_mfma_f32_16x16x32_bf16 v[84:87], v[188:191], v[216:219], v[84:87]
    s_waitcnt lgkmcnt(0)
    v_mfma_f32_16x16x32_bf16 v[88:91], v[184:187], v[220:223], v[88:91]
    v_mfma_f32_16x16x32_bf16 v[92:95], v[188:191], v[220:223], v[92:95]
    s_lshl_b32 s10, s6, 7
    s_lshl_b32 s11, s3, 5
    s_add_u32 s10, s10, s11
    v_lshrrev_b32 v32, 4, v2
    v_lshl_add_u32 v32, v32, 2, s10
    s_lshl_b32 s10, s7, 8
    s_add_u32 s10, s10, 4096
    v_and_b32 v33, 15, v2
    v_lshl_add_u32 v33, v33, 4, s10
    v_lshl_add_u32 v32, v32, 13, v33
    v_mov_b32 v224, v64
    v_mov_b32 v225, v72
    v_mov_b32 v226, v80
    v_mov_b32 v227, v88
    s_mov_b32 s10, 0
    buffer_store_dwordx4 v[224:227], v32, s[60:63], s10 offen sc1
    v_mov_b32 v228, v65
    v_mov_b32 v229, v73
    v_mov_b32 v230, v81
    v_mov_b32 v231, v89
    s_mov_b32 s10, 8192
    buffer_store_dwordx4 v[228:231], v32, s[60:63], s10 offen sc1
    v_mov_b32 v232, v66
    v_mov_b32 v233, v74
    v_mov_b32 v234, v82
    v_mov_b32 v235, v90
    s_mov_b32 s10, 16384
    buffer_store_dwordx4 v[232:235], v32, s[60:63], s10 offen sc1
    v_mov_b32 v236, v67
    v_mov_b32 v237, v75
    v_mov_b32 v238, v83
    v_mov_b32 v239, v91
    s_mov_b32 s10, 24576
    buffer_store_dwordx4 v[236:239], v32, s[60:63], s10 offen sc1
    v_mov_b32 v240, v68
    v_mov_b32 v241, v76
    v_mov_b32 v242, v84
    v_mov_b32 v243, v92
    s_mov_b32 s10, 131072
    buffer_store_dwordx4 v[240:243], v32, s[60:63], s10 offen sc1
    v_mov_b32 v244, v69
    v_mov_b32 v245, v77
    v_mov_b32 v246, v85
    v_mov_b32 v247, v93
    s_mov_b32 s10, 139264
    buffer_store_dwordx4 v[244:247], v32, s[60:63], s10 offen sc1
    v_mov_b32 v248, v70
    v_mov_b32 v249, v78
    v_mov_b32 v250, v86
    v_mov_b32 v251, v94
    s_mov_b32 s10, 147456
    buffer_store_dwordx4 v[248:251], v32, s[60:63], s10 offen sc1
    v_mov_b32 v252, v71
    v_mov_b32 v253, v79
    v_mov_b32 v254, v87
    v_mov_b32 v255, v95
    s_mov_b32 s10, 155648
    buffer_store_dwordx4 v[252:255], v32, s[60:63], s10 offen sc1
    s_waitcnt vmcnt(0) lgkmcnt(0)
    s_endpgm
G2_slow3:
    s_mov_b32 s15, 0
G2_sl3_w:
    ds_read_b128 v[12:15], v11 offset:0
    s_waitcnt lgkmcnt(0)
    v_min3_u32 v12, v12, v13, v14
    v_min_u32 v12, v12, v15
    v_cmp_gt_u32 vcc, 20, v12
    s_cbranch_vccz G2_sl3_ok
    s_add_u32 s15, s15, 1
    s_cmp_lt_u32 s15, 160000
    s_cbranch_scc1 G2_sl3_w
G2_sl3_ok:
    s_branch G2_back3
G2_slow4:
    s_mov_b32 s15, 0
G2_sl4_w:
    ds_read_b128 v[12:15], v11 offset:0
    s_waitcnt lgkmcnt(0)
    v_min3_u32 v12, v12, v13, v14
    v_min_u32 v12, v12, v15
    v_cmp_gt_u32 vcc, 21, v12
    s_cbranch_vccz G2_sl4_ok
    s_add_u32 s15, s15, 1
    s_cmp_lt_u32 s15, 160000
    s_cbranch_scc1 G2_sl4_w
G2_sl4_ok:
    s_branch G2_back4
G2_slow5:
    s_mov_b32 s15, 0
G2_sl5_w:
    ds_read_b128 v[12:15], v11 offset:0
    s_waitcnt lgkmcnt(0)
    v_min3_u32 v12, v12, v13, v14
    v_min_u32 v12, v12, v15
    v_cmp_gt_u32 vcc, 22, v12
    s_cbranch_vccz G2_sl5_ok
    s_add_u32 s15, s15, 1
    s_cmp_lt_u32 s15, 160000
    s_cbranch_scc1 G2_sl5_w
G2_sl5_ok:
    s_branch G2_back5
G2_slow6:
    s_mov_b32 s15, 0
G2_sl6_w:
    ds_read_b128 v[12:15], v11 offset:0
    s_waitcnt lgkmcnt(0)
    v_min3_u32 v12, v12, v13, v14
    v_min_u32 v12, v12, v15
    v_cmp_gt_u32 vcc, 23, v12
    s_cbranch_vccz G2_sl6_ok
    s_add_u32 s15, s15, 1
    s_cmp_lt_u32 s15, 160000
    s_cbranch_scc1 G2_sl6_w
G2_sl6_ok:
    s_branch G2_back6
G2_slow7:
    s_mov_b32 s15, 0
G2_sl7_w:
    ds_read_b128 v[12:15], v11 offset:0
    s_waitcnt lgkmcnt(0)
    v_min3_u32 v12, v12, v13, v14
    v_min_u32 v12, v12, v15
    v_cmp_gt_u32 vcc, 24, v12
    s_cbranch_vccz G2_sl7_ok
    s_add_u32 s15, s15, 1
    s_cmp_lt_u32 s15, 160000
    s_cbranch_scc1 G2_sl7_w
G2_sl7_ok:
    s_branch G2_back7
G2_slow8:
    s_mov_b32 s15, 0
G2_sl8_w:
    ds_read_b128 v[12:15], v11 offset:0
    s_waitcnt lgkmcnt(0)
    v_min3_u32 v12, v12, v13, v14
    v_min_u32 v12, v12, v15
    v_cmp_gt_u32 vcc, 25, v12
    s_cbranch_vccz G2_sl8_ok
    s_add_u32 s15, s15, 1
    s_cmp_lt_u32 s15, 160000
    s_cbranch_scc1 G2_sl8_w
G2_sl8_ok:
    s_branch G2_back8
G2_slow10:
    s_mov_b32 s15, 0
G2_sl10_w:
    ds_read_b128 v[12:15], v11 offset:0
    s_waitcnt lgkmcnt(0)
    v_min3_u32 v12, v12, v13, v14
    v_min_u32 v12, v12, v15
    v_cmp_gt_u32 vcc, 27, v12
    s_cbranch_vccz G2_sl10_ok
    s_add_u32 s15, s15, 1
    s_cmp_lt_u32 s15, 160000
    s_cbranch_scc1 G2_sl10_w
G2_sl10_ok:
    s_branch G2_back10
G2_slowc:
    s_mov_b32 s15, 0
G2_slc_w:
    ds_read_b32 v18, v11 offset:68
    s_waitcnt lgkmcnt(0)
    v_cmp_gt_u32 vcc, 4, v18
    s_cbranch_vccz G2_slc_ok
    s_add_u32 s15, s15, 1
    s_cmp_lt_u32 s15, 160000
    s_cbranch_scc1 G2_slc_w
G2_slc_ok:
    s_branch G2_backc
Y_done:
    s_endpgm
Y_end:
.section .rodata,"a"
.p2align 6
.amdhsa_kernel concat_heads__ssm_conv_h3__ssm_conv_s5__prompt_kernel
  .amdhsa_next_free_vgpr 256
  .amdhsa_next_free_sgpr 102
  .amdhsa_accum_offset 256
  .amdhsa_group_segment_fixed_size 0
  .amdhsa_kernarg_size 144
  .amdhsa_user_sgpr_count 2
  .amdhsa_user_sgpr_kernarg_segment_ptr 1
  .amdhsa_system_sgpr_workgroup_id_x 1
.end_amdhsa_kernel
```

```asm
; @launch grid=(256,1,1) block=(512,1,1) lds=163840
.amdgcn_target "amdgcn-amd-amdhsa--gfx950"
.text
.globl concat_heads__ssm_conv_h3__ssm_conv_s5__prompt_kernel
.p2align 8
.type concat_heads__ssm_conv_h3__ssm_conv_s5__prompt_kernel,@function
concat_heads__ssm_conv_h3__ssm_conv_s5__prompt_kernel:
    s_cmp_ge_u32 s2, 256
    s_cbranch_scc1 Y_done
    s_load_dwordx16 s[16:31], s[0:1], 0
    s_load_dwordx16 s[32:47], s[0:1], 64
    s_load_dwordx4 s[48:51], s[0:1], 128
    s_getpc_b64 s[52:53]
Y_pc:
    v_lshrrev_b32 v1, 6, v0
    v_and_b32 v2, 63, v0
    s_and_b32 s4, s2, 7
    v_readfirstlane_b32 s3, v1
    s_lshr_b32 s5, s2, 3
    s_and_b32 s6, s4, 3
    s_lshl_b32 s6, s6, 2
    s_and_b32 s7, s5, 3
    s_add_u32 s6, s6, s7
    s_and_b32 s7, s4, 4
    s_lshl_b32 s7, s7, 1
    s_lshr_b32 s8, s5, 2
    s_add_u32 s7, s7, s8
    s_lshl_b32 s54, s5, 3
    s_add_u32 s54, s54, s3
    s_lshl_b32 s54, s54, 6
    s_load_dword s56, s[52:53], s54
    s_add_u32 s54, s54, 16384
    s_min_u32 s54, s54, Y_end-Y_pc-4
    s_load_dword s57, s[52:53], s54
    s_and_b32 s9, s5, 3
    s_add_u32 s13, s8, s9
    s_lshl_b32 s13, s13, 2
    s_and_b32 s9, s4, 3
    s_add_u32 s13, s13, s9
    s_lshr_b32 s9, s4, 2
    s_lshl_b32 s9, s9, 1
    s_add_u32 s13, s13, s9
    s_lshl_b32 s13, s13, 1
    s_and_b32 s13, s13, 15
    s_add_u32 s12, s5, s4
    s_lshr_b32 s9, s4, 2
    s_lshl_b32 s9, s9, 1
    s_add_u32 s12, s12, s9
    s_lshl_b32 s12, s12, 2
    s_and_b32 s12, s12, 15
    s_lshl_b32 s13, s13, 7
    s_mov_b32 s100, 0x76543210
    s_mov_b32 s101, 0xfedcba98
    s_lshl_b32 s9, s12, 2
    s_lshr_b64 s[10:11], s[100:101], s9
    s_sub_u32 s9, 64, s9
    s_lshl_b64 s[100:101], s[100:101], s9
    s_or_b64 s[100:101], s[100:101], s[10:11]
    s_sub_u32 s9, s7, s12
    s_and_b32 s9, s9, 15
    s_lshl_b32 s9, s9, 2
    s_bfm_b64 s[10:11], s9, 0
    s_and_b64 s[14:15], s[100:101], s[10:11]
    s_lshl_b64 s[14:15], s[14:15], 4
    s_lshl_b64 s[10:11], s[10:11], 4
    s_or_b32 s10, s10, 15
    s_andn2_b64 s[100:101], s[100:101], s[10:11]
    s_or_b64 s[100:101], s[100:101], s[14:15]
    s_or_b32 s100, s100, s7
    s_cmp_lt_u32 s3, 4
    s_cbranch_scc0 Y_L
    v_and_b32 v3, 31, v2
    v_mov_b32 v23, 0
    v_mov_b32 v11, 163712
    v_lshl_add_u32 v48, v3, 2, v11
    ds_write_b32 v48, v23
    s_waitcnt lgkmcnt(0)
    s_barrier
    s_branch Y_G
Y_L:
    s_setprio 2
    s_sub_u32 s8, s3, 4
    s_lshr_b32 s11, s8, 1
    s_and_b32 s9, s8, 1
    s_cmp_eq_u32 s11, 1
    s_cbranch_scc1 L_ns0
    s_lshl_b32 s10, s6, 7
    s_lshl_b32 s12, s9, 6
    s_add_u32 s10, s10, s12
    v_and_b32 v24, 32, v2
    v_bfe_u32 v25, v2, 3, 1
    v_lshl_add_u32 v24, v25, 4, v24
    v_bfe_u32 v25, v2, 4, 1
    v_add_u32 v24, v24, v25
    v_add_u32 v24, s10, v24
    v_lshlrev_b32 v24, 11, v24
    v_lshrrev_b32 v25, 4, v2
    v_xor_b32 v25, v25, v2
    v_and_b32 v25, 7, v25
    v_lshl_add_u32 v4, v25, 4, v24
    v_xor_b32 v5, 64, v4
    v_add_u32 v5, 3072, v5
    v_add_u32 v6, 6144, v4
    v_add_u32 v7, 6144, v5
    s_lshl_b32 s10, s7, 6
    v_lshrrev_b32 v24, 3, v2
    s_lshl_b32 s12, s9, 5
    s_add_u32 s10, s10, s12
    v_add_u32 v24, s10, v24
    v_lshlrev_b32 v24, 11, v24
    v_lshrrev_b32 v25, 4, v2
    v_xor_b32 v25, v25, v2
    v_and_b32 v25, 7, v25
    v_lshl_add_u32 v8, v25, 4, v24
    v_xor_b32 v9, 64, v8
    v_add_u32 v9, 15360, v9
    v_add_u32 v10, 30720, v8
    v_add_u32 v11, 30720, v9
    s_lshl_b32 s14, s8, 13
    s_waitcnt lgkmcnt(0)
    s_mov_b32 s52, s28
    s_mov_b32 s53, s29
    s_mov_b32 s54, 4194304
    s_mov_b32 s55, 0x00020000
    s_mov_b32 s56, s34
    s_mov_b32 s57, s35
    s_mov_b32 s58, 2097152
    s_mov_b32 s59, 0x00020000
    s_mov_b32 s60, s36
    s_mov_b32 s61, s37
    s_mov_b32 s62, 2097152
    s_mov_b32 s63, 0x00020000
    s_add_u32 m0, s14, 0
    s_nop 0
    buffer_load_dwordx4 v4, s[52:55], s13 offen offset:0 lds
    buffer_load_dwordx4 v5, s[52:55], s13 offen offset:1024 lds
    buffer_load_dwordx4 v6, s[52:55], s13 offen offset:2048 lds
    buffer_load_dwordx4 v7, s[52:55], s13 offen offset:3072 lds
    s_add_u32 m0, s14, 16384
    s_nop 0
    buffer_load_dwordx4 v8, s[56:59], s13 offen offset:0 lds
    buffer_load_dwordx4 v9, s[56:59], s13 offen offset:1024 lds
    buffer_load_dwordx4 v10, s[56:59], s13 offen offset:2048 lds
    buffer_load_dwordx4 v11, s[56:59], s13 offen offset:3072 lds
    s_add_u32 m0, s14, 4096
    s_add_u32 s12, s13, 16384
    buffer_load_dwordx4 v4, s[52:55], s12 offen offset:0 lds
    buffer_load_dwordx4 v5, s[52:55], s12 offen offset:1024 lds
    buffer_load_dwordx4 v6, s[52:55], s12 offen offset:2048 lds
    buffer_load_dwordx4 v7, s[52:55], s12 offen offset:3072 lds
    s_add_u32 m0, s14, 20480
    s_nop 0
    buffer_load_dwordx4 v8, s[60:63], s13 offen offset:0 lds
    buffer_load_dwordx4 v9, s[60:63], s13 offen offset:1024 lds
    buffer_load_dwordx4 v10, s[60:63], s13 offen offset:2048 lds
    buffer_load_dwordx4 v11, s[60:63], s13 offen offset:3072 lds
    s_add_u32 s13, s13, 128
    s_and_b32 s13, s13, 2047
    s_add_u32 s14, s14, 32768
    s_and_b32 s14, s14, 131071
L_ns0:
    s_waitcnt lgkmcnt(0)
    s_barrier
    v_mov_b32 v19, 0
    s_lshl_b32 s10, s3, 2
    s_add_u32 s10, s10, 163712
    v_mov_b32 v22, s10
    v_mov_b32 v21, 163712
    s_add_u32 s72, s50, 17825792
    s_addc_u32 s73, s51, 0
    s_mov_b32 s74, 24576
    s_mov_b32 s75, 0x00020000
    s_mov_b32 s76, s48
    s_mov_b32 s77, s49
    s_mov_b32 s78, 256
    s_mov_b32 s79, 0x00020000
    s_mov_b32 s37, s100
    s_mov_b32 s30, s101
    s_lshl_b32 s100, s4, 7
    s_lshl_b32 s10, s5, 2
    s_add_u32 s100, s100, s10
    s_add_u32 s100, s100, s8
    s_lshr_b32 s10, s100, 1
    s_lshl_b32 s10, s10, 2
    s_load_dword s31, s[26:27], s10
    s_mul_i32 s101, s8, 12928
    s_add_u32 s101, s101, 98304
    s_lshl_b32 s10, s7, 5
    s_add_u32 s10, s10, s11
    s_lshl_b32 s10, s10, 12
    v_lshrrev_b32 v24, 3, v2
    v_lshl_add_u32 v24, v24, 13, s10
    v_lshrrev_b32 v25, 4, v2
    v_xor_b32 v25, v25, v2
    v_and_b32 v25, 7, v25
    v_lshl_add_u32 v12, v25, 4, v24
    v_xor_b32 v13, 64, v12
    v_add_u32 v13, 64512, v13
    s_cmp_eq_u32 s9, 1
    s_cselect_b32 s80, s40, s38
    s_cselect_b32 s81, s41, s39
    s_mov_b32 s82, 2097152
    s_mov_b32 s83, 0x00020000
    s_mov_b32 s68, s24
    s_mov_b32 s69, s25
    s_mov_b32 s70, 4194304
    s_mov_b32 s71, 0x00020000
    s_movk_i32 s32, 4096
    s_movk_i32 s33, 8192
    s_movk_i32 s34, 12288
    s_lshl_b32 s10, s5, 6
    v_and_b32 v23, 56, v2
    v_add_u32 v23, s10, v23
    v_lshlrev_b32 v26, 4, v2
    s_lshl_b32 s36, s100, 12
    s_lshl_b32 s10, s4, 1
    s_lshr_b32 s12, s5, 4
    s_add_u32 s10, s10, s12
    s_lshl_b32 s10, s10, 8
    v_and_b32 v60, 31, v2
    v_lshl_add_u32 v20, v60, 3, s10
    s_lshl_b32 s10, s4, 7
    s_lshl_b32 s12, s8, 5
    s_add_u32 s35, s10, s12
    v_and_b32 v25, 7, v2
    v_lshl_add_u32 v24, v25, 2, s35
    v_lshlrev_b32 v25, 1, v24
    v_lshl_add_u32 v16, v23, 11, v25
    v_add_u32 v60, 12416, v26
    v_and_b32 v61, 16, v26
    v_and_b32 v62, 32, v26
    v_mul_u32_u24 v62, 130, v62
    v_add_u32 v61, v61, v62
    v_cmp_gt_u32 vcc, 32, v2
    s_nop 1
    v_cndmask_b32 v60, v61, v60, vcc
    v_add_u32 v18, s101, v60
    s_lshl_b32 s10, s4, 10
    s_add_u32 s10, s10, 8192
    v_add_u32 v3, s10, v26
    v_and_b32 v17, 15, v2
    v_lshrrev_b32 v27, 4, v2
    v_lshlrev_b32 v60, 1, v17
    v_lshlrev_b32 v61, 4, v27
    v_sub_u32 v60, v60, v61
    v_and_b32 v62, 1, v17
    v_mov_b32 v63, 4212
    v_cmp_eq_u32 vcc, 1, v62
    s_nop 1
    v_cndmask_b32 v63, v63, 50, vcc
    v_add3_u32 v28, v60, v63, s101
    v_add_u32 v29, 1024, v28
    v_add_u32 v30, 2048, v28
    v_add_u32 v31, 3072, v28
    v_lshl_add_u32 v60, v17, 5, v61
    s_add_u32 s10, s101, 8848
    v_sub_u32 v32, s10, v60
    s_add_u32 s10, s101, 8320
    v_add_u32 v33, s10, v26
    s_cmp_eq_u32 s11, 1
    s_cbranch_scc1 L_idle
    s_mov_b32 s29, 1
    v_mov_b32 v25, 1
    s_branch L_free
L_loop:
    s_sub_i32 s28, s29, 3
    s_max_i32 s28, s28, 0
    s_waitcnt lgkmcnt(0)
    v_min3_u32 v60, v60, v61, v62
    v_min_u32 v60, v60, v63
    v_mov_b32 v25, s29
    v_cmp_gt_u32 vcc, s28, v60
    s_cbranch_vccz L_free
    s_mov_b32 s15, 0
L_slot_w:
    ds_read_b128 v[60:63], v21 offset:0
    s_waitcnt lgkmcnt(0)
    v_min3_u32 v60, v60, v61, v62
    v_min_u32 v60, v60, v63
    v_cmp_gt_u32 vcc, s28, v60
    s_cbranch_vccz L_slot_ok
    s_sleep 1
    s_add_u32 s15, s15, 1
    s_cmp_lt_u32 s15, 160000
    s_cbranch_scc1 L_slot_w
L_slot_ok:
L_free:
    s_cmp_ge_u32 s29, 8
    s_cbranch_scc1 L_sh
    s_add_u32 m0, s14, 0
    s_waitcnt vmcnt(15)
    buffer_load_dwordx4 v4, s[52:55], s13 offen offset:0 lds
    s_waitcnt vmcnt(15)
    buffer_load_dwordx4 v5, s[52:55], s13 offen offset:1024 lds
    s_waitcnt vmcnt(15)
    buffer_load_dwordx4 v6, s[52:55], s13 offen offset:2048 lds
    s_waitcnt vmcnt(15)
    buffer_load_dwordx4 v7, s[52:55], s13 offen offset:3072 lds
    s_add_u32 m0, s14, 16384
    s_waitcnt vmcnt(15)
    buffer_load_dwordx4 v8, s[56:59], s13 offen offset:0 lds
    s_waitcnt vmcnt(15)
    buffer_load_dwordx4 v9, s[56:59], s13 offen offset:1024 lds
    s_waitcnt vmcnt(15)
    buffer_load_dwordx4 v10, s[56:59], s13 offen offset:2048 lds
    s_waitcnt vmcnt(15)
    buffer_load_dwordx4 v11, s[56:59], s13 offen offset:3072 lds
    s_add_u32 m0, s14, 4096
    s_add_u32 s12, s13, 16384
    s_waitcnt vmcnt(15)
    buffer_load_dwordx4 v4, s[52:55], s12 offen offset:0 lds
    s_waitcnt vmcnt(15)
    buffer_load_dwordx4 v5, s[52:55], s12 offen offset:1024 lds
    s_waitcnt vmcnt(15)
    buffer_load_dwordx4 v6, s[52:55], s12 offen offset:2048 lds
    s_waitcnt vmcnt(15)
    buffer_load_dwordx4 v7, s[52:55], s12 offen offset:3072 lds
    ds_read_b128 v[60:63], v21
    s_add_u32 m0, s14, 20480
    s_waitcnt vmcnt(15)
    buffer_load_dwordx4 v8, s[60:63], s13 offen offset:0 lds
    s_waitcnt vmcnt(15)
    buffer_load_dwordx4 v9, s[60:63], s13 offen offset:1024 lds
    s_waitcnt vmcnt(15)
    buffer_load_dwordx4 v10, s[60:63], s13 offen offset:2048 lds
    s_waitcnt vmcnt(15)
    ds_write_b32 v22, v25
    buffer_load_dwordx4 v11, s[60:63], s13 offen offset:3072 lds
    s_add_u32 s13, s13, 128
    s_and_b32 s13, s13, 2047
    s_add_u32 s14, s14, 32768
    s_and_b32 s14, s14, 131071
    s_add_u32 s29, s29, 1
    s_branch L_loop
L_sh:
    s_add_u32 m0, s14, 0
    s_waitcnt vmcnt(7)
    buffer_load_dwordx4 v4, s[52:55], s13 offen offset:0 lds
    s_waitcnt vmcnt(7)
    buffer_load_dwordx4 v5, s[52:55], s13 offen offset:1024 lds
    s_waitcnt vmcnt(7)
    buffer_load_dwordx4 v6, s[52:55], s13 offen offset:2048 lds
    s_waitcnt vmcnt(7)
    buffer_load_dwordx4 v7, s[52:55], s13 offen offset:3072 lds
    s_add_u32 m0, s14, 16384
    s_waitcnt vmcnt(7)
    buffer_load_dwordx4 v8, s[56:59], s13 offen offset:0 lds
    s_waitcnt vmcnt(7)
    buffer_load_dwordx4 v9, s[56:59], s13 offen offset:1024 lds
    s_waitcnt vmcnt(7)
    buffer_load_dwordx4 v10, s[56:59], s13 offen offset:2048 lds
    s_waitcnt vmcnt(7)
    ds_write_b32 v22, v25
    buffer_load_dwordx4 v11, s[56:59], s13 offen offset:3072 lds
    s_add_u32 m0, s14, 4096
    s_add_u32 s12, s13, 16384
    s_waitcnt vmcnt(7)
    buffer_load_dwordx4 v4, s[52:55], s12 offen offset:0 lds
    s_waitcnt vmcnt(7)
    buffer_load_dwordx4 v5, s[52:55], s12 offen offset:1024 lds
    s_waitcnt vmcnt(7)
    buffer_load_dwordx4 v6, s[52:55], s12 offen offset:2048 lds
    s_waitcnt vmcnt(7)
    buffer_load_dwordx4 v7, s[52:55], s12 offen offset:3072 lds
    ds_read_b128 v[60:63], v21
    s_add_u32 m0, s14, 20480
    s_waitcnt vmcnt(7)
    buffer_load_dwordx4 v8, s[60:63], s13 offen offset:0 lds
    s_waitcnt vmcnt(7)
    buffer_load_dwordx4 v9, s[60:63], s13 offen offset:1024 lds
    s_waitcnt vmcnt(7)
    buffer_load_dwordx4 v10, s[60:63], s13 offen offset:2048 lds
    s_waitcnt vmcnt(7)
    buffer_load_dwordx4 v11, s[60:63], s13 offen offset:3072 lds
    s_add_u32 s13, s13, 128
    s_and_b32 s13, s13, 2047
    s_add_u32 s14, s14, 32768
    s_and_b32 s14, s14, 131071
    s_add_u32 s29, s29, 1
    s_cmp_lt_u32 s29, 16
    s_cbranch_scc1 L_loop
    v_mov_b32 v25, 16
    v_mov_b32 v60, 1
    s_mov_b64 exec, 1
    ds_add_u32 v21, v60 offset:40
    s_mov_b64 exec, -1
    s_waitcnt vmcnt(0)
    ds_write_b32 v22, v25
    s_mov_b32 s15, 0
L_is0_w:
    ds_read_b32 v60, v21 offset:40
    s_waitcnt lgkmcnt(0)
    v_cmp_gt_u32 vcc, 2, v60
    s_cbranch_vccz L_is0_ok
    s_add_u32 s15, s15, 1
    s_cmp_lt_u32 s15, 160000
    s_cbranch_scc1 L_is0_w
L_is0_ok:
    buffer_load_dwordx4 v[192:195], v26, s[68:71], s36 offen offset:0 nt
    buffer_load_dwordx4 v[196:199], v26, s[68:71], s36 offen offset:1024 nt
    buffer_load_dwordx4 v[200:203], v26, s[68:71], s36 offen offset:2048 nt
    buffer_load_dwordx4 v[204:207], v26, s[68:71], s36 offen offset:3072 nt
    s_branch L_t2
L_idle:
    s_setprio 0
    s_mov_b32 s52, s18
    s_mov_b32 s53, s19
    s_mov_b32 s54, 4194304
    s_mov_b32 s55, 0x00020000
    s_mov_b32 s56, s20
    s_mov_b32 s57, s21
    s_mov_b32 s58, 4194304
    s_mov_b32 s59, 0x00020000
    s_mov_b32 s60, s22
    s_mov_b32 s61, s23
    s_mov_b32 s62, 8192
    s_mov_b32 s63, 0x00020000
    s_mov_b32 s64, s50
    s_mov_b32 s65, s51
    s_mov_b32 s66, 4194304
    s_mov_b32 s67, 0x00020000
    s_lshl_b32 s10, s4, 7
    s_lshl_b32 s12, s9, 6
    s_add_u32 s10, s10, s12
    v_and_b32 v60, 7, v2
    v_lshl_add_u32 v4, v60, 3, s10
    v_lshlrev_b32 v60, 1, v4
    v_lshl_add_u32 v5, v23, 11, v60
    v_subrev_u32 v6, 6144, v5
    v_bfrev_b32 v60, 1
    v_cmp_eq_u32 vcc, 0, v23
    s_nop 1
    v_cndmask_b32 v6, v6, v60, vcc
    v_lshlrev_b32 v7, 3, v4
    v_sub_u32 v8, 2040, v23
    v_lshlrev_b32 v8, 1, v8
    v_lshl_add_u32 v8, v4, 12, v8
    v_add_u32 v9, 16384, v8
    s_lshl_b32 s13, s4, 1
    s_add_u32 s13, s13, s9
    s_lshl_b32 s13, s13, 5
    s_add_u32 s13, s13, s5
    s_lshl_b32 s13, s13, 3
    v_mov_b32 v25, 16
    s_mov_b32 s15, 0
L_x0_w:
    ds_read_b64 v[60:61], v21 offset:16
    s_waitcnt lgkmcnt(0)
    v_min_u32 v60, v60, v61
    v_cmp_gt_u32 vcc, 1, v60
    s_cbranch_vccz L_x0_ok
    s_sleep 2
    s_add_u32 s15, s15, 1
    s_cmp_lt_u32 s15, 160000
    s_cbranch_scc1 L_x0_w
L_x0_ok:
    buffer_load_dwordx2 v[0:1], v19, s[76:79], 0 offen sc1
    s_getreg_b32 s14, hwreg(HW_REG_XCC_ID, 0, 8)
    s_add_u32 s14, s14, 1
    s_lshl_b32 s14, s14, 20
    s_lshl_b32 s10, s4, 8
    s_add_u32 s10, s10, 4096
    v_and_b32 v14, 31, v2
    v_lshl_add_u32 v14, v14, 3, s10
    s_lshl_b32 s28, s5, 3
    s_add_u32 s28, s28, s10
    s_waitcnt vmcnt(0)
    s_mov_b32 s12, 0
L_np:
    v_cmp_eq_u32 vcc, 0, v0
    s_cbranch_vccz L_nok
    buffer_load_dwordx2 v[0:1], v19, s[76:79], 0 offen sc1
    s_add_u32 s12, s12, 1
    s_waitcnt vmcnt(0)
    s_cmp_lt_u32 s12, 20000
    s_cbranch_scc1 L_np
L_nok:
    ds_write_b64 v21, v[0:1] offset:32
    v_mov_b32 v10, v0
    v_xor_b32 v11, s14, v1
    s_cmp_eq_u32 s9, 0
    s_cbranch_scc0 L_x1
    s_mov_b64 exec, 1
    buffer_store_dwordx2 v[10:11], v19, s[72:75], s28 offen sc1
    s_mov_b64 exec, -1
L_x1:
    s_mov_b32 s15, 0
L_i1_w:
    ds_read_b64 v[60:61], v21 offset:16
    s_waitcnt lgkmcnt(0)
    v_min_u32 v60, v60, v61
    v_cmp_gt_u32 vcc, 4, v60
    s_cbranch_vccz L_i1_ok
    s_sleep 2
    s_add_u32 s15, s15, 1
    s_cmp_lt_u32 s15, 160000
    s_cbranch_scc1 L_i1_w
L_i1_ok:
    buffer_load_dwordx4 v[64:67], v7, s[60:63], 0 offen offset:0
    buffer_load_dwordx4 v[68:71], v7, s[60:63], 0 offen offset:16
    buffer_load_dwordx4 v[72:75], v7, s[60:63], 0 offen offset:32
    buffer_load_dwordx4 v[76:79], v7, s[60:63], 0 offen offset:48
    buffer_load_dwordx4 v[92:95], v5, s[52:55], 0 offen offset:0 nt
    buffer_load_dwordx4 v[96:99], v5, s[52:55], 0 offen offset:2048 nt
    buffer_load_dwordx4 v[100:103], v5, s[52:55], s32 offen offset:0 nt
    buffer_load_dwordx4 v[104:107], v5, s[52:55], s32 offen offset:2048 nt
    buffer_load_dwordx4 v[108:111], v5, s[52:55], s33 offen offset:0 nt
    buffer_load_dwordx4 v[112:115], v5, s[52:55], s33 offen offset:2048 nt
    buffer_load_dwordx4 v[116:119], v5, s[52:55], s34 offen offset:0 nt
    buffer_load_dwordx4 v[120:123], v5, s[52:55], s34 offen offset:2048 nt
    buffer_load_dwordx4 v[80:83], v6, s[52:55], 0 offen offset:0 nt
    buffer_load_dwordx4 v[84:87], v6, s[52:55], 0 offen offset:2048 nt
    buffer_load_dwordx4 v[88:91], v6, s[52:55], s32 offen offset:0 nt
    buffer_load_dwordx4 v[124:127], v5, s[56:59], 0 offen offset:0 nt
    buffer_load_dwordx4 v[128:131], v5, s[56:59], 0 offen offset:2048 nt
    buffer_load_dwordx4 v[132:135], v5, s[56:59], s32 offen offset:0 nt
    buffer_load_dwordx4 v[136:139], v5, s[56:59], s32 offen offset:2048 nt
    buffer_load_dwordx4 v[140:143], v5, s[56:59], s33 offen offset:0 nt
    buffer_load_dwordx4 v[144:147], v5, s[56:59], s33 offen offset:2048 nt
    buffer_load_dwordx4 v[148:151], v5, s[56:59], s34 offen offset:0 nt
    buffer_load_dwordx4 v[152:155], v5, s[56:59], s34 offen offset:2048 nt
    buffer_load_dwordx2 v[58:59], v14, s[72:75], 0 offen sc1
    s_waitcnt vmcnt(20)
    v_lshlrev_b32 v156, 16, v64
    v_and_b32 v160, 0xffff0000, v64
    v_lshlrev_b32 v164, 16, v65
    v_and_b32 v168, 0xffff0000, v65
    v_lshlrev_b32 v157, 16, v66
    v_and_b32 v161, 0xffff0000, v66
    v_lshlrev_b32 v165, 16, v67
    v_and_b32 v169, 0xffff0000, v67
    v_lshlrev_b32 v158, 16, v68
    v_and_b32 v162, 0xffff0000, v68
    v_lshlrev_b32 v166, 16, v69
    v_and_b32 v170, 0xffff0000, v69
    v_lshlrev_b32 v159, 16, v70
    v_and_b32 v163, 0xffff0000, v70
    v_lshlrev_b32 v167, 16, v71
    v_and_b32 v171, 0xffff0000, v71
    s_waitcnt vmcnt(9)
    v_lshlrev_b32 v172, 16, v80
    v_and_b32 v173, 0xffff0000, v80
    v_lshlrev_b32 v174, 16, v81
    v_and_b32 v175, 0xffff0000, v81
    v_lshlrev_b32 v176, 16, v84
    v_and_b32 v177, 0xffff0000, v84
    v_lshlrev_b32 v178, 16, v85
    v_and_b32 v179, 0xffff0000, v85
    v_lshlrev_b32 v180, 16, v88
    v_and_b32 v181, 0xffff0000, v88
    v_lshlrev_b32 v182, 16, v89
    v_and_b32 v183, 0xffff0000, v89
    v_lshlrev_b32 v184, 16, v92
    v_and_b32 v185, 0xffff0000, v92
    v_lshlrev_b32 v186, 16, v93
    v_and_b32 v187, 0xffff0000, v93
    v_lshlrev_b32 v188, 16, v96
    v_and_b32 v189, 0xffff0000, v96
    v_lshlrev_b32 v190, 16, v97
    v_and_b32 v191, 0xffff0000, v97
    v_lshlrev_b32 v192, 16, v100
    v_and_b32 v193, 0xffff0000, v100
    v_lshlrev_b32 v194, 16, v101
    v_and_b32 v195, 0xffff0000, v101
    v_lshlrev_b32 v196, 16, v104
    v_and_b32 v197, 0xffff0000, v104
    v_lshlrev_b32 v198, 16, v105
    v_and_b32 v199, 0xffff0000, v105
    v_lshlrev_b32 v200, 16, v108
    v_and_b32 v201, 0xffff0000, v108
    v_lshlrev_b32 v202, 16, v109
    v_and_b32 v203, 0xffff0000, v109
    v_lshlrev_b32 v204, 16, v112
    v_and_b32 v205, 0xffff0000, v112
    v_lshlrev_b32 v206, 16, v113
    v_and_b32 v207, 0xffff0000, v113
    v_lshlrev_b32 v208, 16, v116
    v_and_b32 v209, 0xffff0000, v116
    v_lshlrev_b32 v210, 16, v117
    v_and_b32 v211, 0xffff0000, v117
    v_lshlrev_b32 v212, 16, v120
    v_and_b32 v213, 0xffff0000, v120
    v_lshlrev_b32 v214, 16, v121
    v_and_b32 v215, 0xffff0000, v121
    v_mul_f32 v216, v184, v156
    v_mul_f32 v217, v185, v157
    v_mul_f32 v218, v186, v158
    v_mul_f32 v219, v187, v159
    v_mul_f32 v220, v188, v156
    v_mul_f32 v221, v189, v157
    v_mul_f32 v222, v190, v158
    v_mul_f32 v223, v191, v159
    v_mul_f32 v224, v192, v156
    v_mul_f32 v225, v193, v157
    v_mul_f32 v226, v194, v158
    v_mul_f32 v227, v195, v159
    v_mul_f32 v228, v196, v156
    v_mul_f32 v229, v197, v157
    v_mul_f32 v230, v198, v158
    v_mul_f32 v231, v199, v159
    v_mul_f32 v232, v200, v156
    v_mul_f32 v233, v201, v157
    v_mul_f32 v234, v202, v158
    v_mul_f32 v235, v203, v159
    v_mul_f32 v236, v204, v156
    v_mul_f32 v237, v205, v157
    v_mul_f32 v238, v206, v158
    v_mul_f32 v239, v207, v159
    v_mul_f32 v240, v208, v156
    v_mul_f32 v241, v209, v157
    v_mul_f32 v242, v210, v158
    v_mul_f32 v243, v211, v159
    v_mul_f32 v244, v212, v156
    v_mul_f32 v245, v213, v157
    v_mul_f32 v246, v214, v158
    v_mul_f32 v247, v215, v159
    v_fmac_f32 v216, v180, v160
    v_fmac_f32 v217, v181, v161
    v_fmac_f32 v218, v182, v162
    v_fmac_f32 v219, v183, v163
    v_fmac_f32 v220, v184, v160
    v_fmac_f32 v221, v185, v161
    v_fmac_f32 v222, v186, v162
    v_fmac_f32 v223, v187, v163
    v_fmac_f32 v224, v188, v160
    v_fmac_f32 v225, v189, v161
    v_fmac_f32 v226, v190, v162
    v_fmac_f32 v227, v191, v163
    v_fmac_f32 v228, v192, v160
    v_fmac_f32 v229, v193, v161
    v_fmac_f32 v230, v194, v162
    v_fmac_f32 v231, v195, v163
    v_fmac_f32 v232, v196, v160
    v_fmac_f32 v233, v197, v161
    v_fmac_f32 v234, v198, v162
    v_fmac_f32 v235, v199, v163
    v_fmac_f32 v236, v200, v160
    v_fmac_f32 v237, v201, v161
    v_fmac_f32 v238, v202, v162
    v_fmac_f32 v239, v203, v163
    v_fmac_f32 v240, v204, v160
    v_fmac_f32 v241, v205, v161
    v_fmac_f32 v242, v206, v162
    v_fmac_f32 v243, v207, v163
    v_fmac_f32 v244, v208, v160
    v_fmac_f32 v245, v209, v161
    v_fmac_f32 v246, v210, v162
    v_fmac_f32 v247, v211, v163
    v_fmac_f32 v216, v176, v164
    v_fmac_f32 v217, v177, v165
    v_fmac_f32 v218, v178, v166
    v_fmac_f32 v219, v179, v167
    v_fmac_f32 v220, v180, v164
    v_fmac_f32 v221, v181, v165
    v_fmac_f32 v222, v182, v166
    v_fmac_f32 v223, v183, v167
    v_fmac_f32 v224, v184, v164
    v_fmac_f32 v225, v185, v165
    v_fmac_f32 v226, v186, v166
    v_fmac_f32 v227, v187, v167
    v_fmac_f32 v228, v188, v164
    v_fmac_f32 v229, v189, v165
    v_fmac_f32 v230, v190, v166
    v_fmac_f32 v231, v191, v167
    v_fmac_f32 v232, v192, v164
    v_fmac_f32 v233, v193, v165
    v_fmac_f32 v234, v194, v166
    v_fmac_f32 v235, v195, v167
    v_fmac_f32 v236, v196, v164
    v_fmac_f32 v237, v197, v165
    v_fmac_f32 v238, v198, v166
    v_fmac_f32 v239, v199, v167
    v_fmac_f32 v240, v200, v164
    v_fmac_f32 v241, v201, v165
    v_fmac_f32 v242, v202, v166
    v_fmac_f32 v243, v203, v167
    v_fmac_f32 v244, v204, v164
    v_fmac_f32 v245, v205, v165
    v_fmac_f32 v246, v206, v166
    v_fmac_f32 v247, v207, v167
    v_fmac_f32 v216, v172, v168
    v_fmac_f32 v217, v173, v169
    v_fmac_f32 v218, v174, v170
    v_fmac_f32 v219, v175, v171
    v_fmac_f32 v220, v176, v168
    v_fmac_f32 v221, v177, v169
    v_fmac_f32 v222, v178, v170
    v_fmac_f32 v223, v179, v171
    v_fmac_f32 v224, v180, v168
    v_fmac_f32 v225, v181, v169
    v_fmac_f32 v226, v182, v170
    v_fmac_f32 v227, v183, v171
    v_fmac_f32 v228, v184, v168
    v_fmac_f32 v229, v185, v169
    v_fmac_f32 v230, v186, v170
    v_fmac_f32 v231, v187, v171
    v_fmac_f32 v232, v188, v168
    v_fmac_f32 v233, v189, v169
    v_fmac_f32 v234, v190, v170
    v_fmac_f32 v235, v191, v171
    v_fmac_f32 v236, v192, v168
    v_fmac_f32 v237, v193, v169
    v_fmac_f32 v238, v194, v170
    v_fmac_f32 v239, v195, v171
    v_fmac_f32 v240, v196, v168
    v_fmac_f32 v241, v197, v169
    v_fmac_f32 v242, v198, v170
    v_fmac_f32 v243, v199, v171
    v_fmac_f32 v244, v200, v168
    v_fmac_f32 v245, v201, v169
    v_fmac_f32 v246, v202, v170
    v_fmac_f32 v247, v203, v171
    s_waitcnt vmcnt(0)
    v_cmp_ne_u64 vcc, v[58:59], v[10:11]
    s_cmp_eq_u64 vcc, 0
    s_cselect_b32 s14, 1, 0
    v_mov_b32 v58, s14
    ds_or_b32 v21, v58 offset:72
    v_lshlrev_b32 v172, 16, v124
    v_and_b32 v173, 0xffff0000, v124
    v_lshlrev_b32 v174, 16, v125
    v_and_b32 v175, 0xffff0000, v125
    v_lshlrev_b32 v176, 16, v128
    v_and_b32 v177, 0xffff0000, v128
    v_lshlrev_b32 v178, 16, v129
    v_and_b32 v179, 0xffff0000, v129
    v_lshlrev_b32 v180, 16, v132
    v_and_b32 v181, 0xffff0000, v132
    v_lshlrev_b32 v182, 16, v133
    v_and_b32 v183, 0xffff0000, v133
    v_lshlrev_b32 v184, 16, v136
    v_and_b32 v185, 0xffff0000, v136
    v_lshlrev_b32 v186, 16, v137
    v_and_b32 v187, 0xffff0000, v137
    v_lshlrev_b32 v188, 16, v140
    v_and_b32 v189, 0xffff0000, v140
    v_lshlrev_b32 v190, 16, v141
    v_and_b32 v191, 0xffff0000, v141
    v_lshlrev_b32 v192, 16, v144
    v_and_b32 v193, 0xffff0000, v144
    v_lshlrev_b32 v194, 16, v145
    v_and_b32 v195, 0xffff0000, v145
    v_lshlrev_b32 v196, 16, v148
    v_and_b32 v197, 0xffff0000, v148
    v_lshlrev_b32 v198, 16, v149
    v_and_b32 v199, 0xffff0000, v149
    v_lshlrev_b32 v200, 16, v152
    v_and_b32 v201, 0xffff0000, v152
    v_lshlrev_b32 v202, 16, v153
    v_and_b32 v203, 0xffff0000, v153
    v_mul_f32 v216, v216, v172
    v_mul_f32 v217, v217, v173
    v_mul_f32 v218, v218, v174
    v_mul_f32 v219, v219, v175
    v_mul_f32 v220, v220, v176
    v_mul_f32 v221, v221, v177
    v_mul_f32 v222, v222, v178
    v_mul_f32 v223, v223, v179
    v_mul_f32 v224, v224, v180
    v_mul_f32 v225, v225, v181
    v_mul_f32 v226, v226, v182
    v_mul_f32 v227, v227, v183
    v_mul_f32 v228, v228, v184
    v_mul_f32 v229, v229, v185
    v_mul_f32 v230, v230, v186
    v_mul_f32 v231, v231, v187
    v_mul_f32 v232, v232, v188
    v_mul_f32 v233, v233, v189
    v_mul_f32 v234, v234, v190
    v_mul_f32 v235, v235, v191
    v_mul_f32 v236, v236, v192
    v_mul_f32 v237, v237, v193
    v_mul_f32 v238, v238, v194
    v_mul_f32 v239, v239, v195
    v_mul_f32 v240, v240, v196
    v_mul_f32 v241, v241, v197
    v_mul_f32 v242, v242, v198
    v_mul_f32 v243, v243, v199
    v_mul_f32 v244, v244, v200
    v_mul_f32 v245, v245, v201
    v_mul_f32 v246, v246, v202
    v_mul_f32 v247, v247, v203
    v_cvt_pk_bf16_f32 v40, v244, v240
    v_cvt_pk_bf16_f32 v41, v236, v232
    v_cvt_pk_bf16_f32 v42, v228, v224
    v_cvt_pk_bf16_f32 v43, v220, v216
    v_cvt_pk_bf16_f32 v44, v245, v241
    v_cvt_pk_bf16_f32 v45, v237, v233
    v_cvt_pk_bf16_f32 v46, v229, v225
    v_cvt_pk_bf16_f32 v47, v221, v217
    v_cvt_pk_bf16_f32 v48, v246, v242
    v_cvt_pk_bf16_f32 v49, v238, v234
    v_cvt_pk_bf16_f32 v50, v230, v226
    v_cvt_pk_bf16_f32 v51, v222, v218
    v_cvt_pk_bf16_f32 v52, v247, v243
    v_cvt_pk_bf16_f32 v53, v239, v235
    v_cvt_pk_bf16_f32 v54, v231, v227
    v_cvt_pk_bf16_f32 v55, v223, v219
    s_cmp_eq_u32 s14, 1
    s_cbranch_scc1 L_xp0
    buffer_store_dwordx4 v[40:43], v8, s[64:67], 0 offen sc1
    buffer_store_dwordx4 v[44:47], v8, s[64:67], s32 offen sc1
    buffer_store_dwordx4 v[48:51], v8, s[64:67], s33 offen sc1
    buffer_store_dwordx4 v[52:55], v8, s[64:67], s34 offen sc1
    s_branch L_xq0
L_xp0:
    buffer_store_dwordx4 v[40:43], v8, s[64:67], 0 offen
    buffer_store_dwordx4 v[44:47], v8, s[64:67], s32 offen
    buffer_store_dwordx4 v[48:51], v8, s[64:67], s33 offen
    buffer_store_dwordx4 v[52:55], v8, s[64:67], s34 offen
L_xq0:
    v_lshlrev_b32 v156, 16, v72
    v_and_b32 v160, 0xffff0000, v72
    v_lshlrev_b32 v164, 16, v73
    v_and_b32 v168, 0xffff0000, v73
    v_lshlrev_b32 v157, 16, v74
    v_and_b32 v161, 0xffff0000, v74
    v_lshlrev_b32 v165, 16, v75
    v_and_b32 v169, 0xffff0000, v75
    v_lshlrev_b32 v158, 16, v76
    v_and_b32 v162, 0xffff0000, v76
    v_lshlrev_b32 v166, 16, v77
    v_and_b32 v170, 0xffff0000, v77
    v_lshlrev_b32 v159, 16, v78
    v_and_b32 v163, 0xffff0000, v78
    v_lshlrev_b32 v167, 16, v79
    v_and_b32 v171, 0xffff0000, v79
    v_lshlrev_b32 v172, 16, v82
    v_and_b32 v173, 0xffff0000, v82
    v_lshlrev_b32 v174, 16, v83
    v_and_b32 v175, 0xffff0000, v83
    v_lshlrev_b32 v176, 16, v86
    v_and_b32 v177, 0xffff0000, v86
    v_lshlrev_b32 v178, 16, v87
    v_and_b32 v179, 0xffff0000, v87
    v_lshlrev_b32 v180, 16, v90
    v_and_b32 v181, 0xffff0000, v90
    v_lshlrev_b32 v182, 16, v91
    v_and_b32 v183, 0xffff0000, v91
    v_lshlrev_b32 v184, 16, v94
    v_and_b32 v185, 0xffff0000, v94
    v_lshlrev_b32 v186, 16, v95
    v_and_b32 v187, 0xffff0000, v95
    v_lshlrev_b32 v188, 16, v98
    v_and_b32 v189, 0xffff0000, v98
    v_lshlrev_b32 v190, 16, v99
    v_and_b32 v191, 0xffff0000, v99
    v_lshlrev_b32 v192, 16, v102
    v_and_b32 v193, 0xffff0000, v102
    v_lshlrev_b32 v194, 16, v103
    v_and_b32 v195, 0xffff0000, v103
    v_lshlrev_b32 v196, 16, v106
    v_and_b32 v197, 0xffff0000, v106
    v_lshlrev_b32 v198, 16, v107
    v_and_b32 v199, 0xffff0000, v107
    v_lshlrev_b32 v200, 16, v110
    v_and_b32 v201, 0xffff0000, v110
    v_lshlrev_b32 v202, 16, v111
    v_and_b32 v203, 0xffff0000, v111
    v_lshlrev_b32 v204, 16, v114
    v_and_b32 v205, 0xffff0000, v114
    v_lshlrev_b32 v206, 16, v115
    v_and_b32 v207, 0xffff0000, v115
    v_lshlrev_b32 v208, 16, v118
    v_and_b32 v209, 0xffff0000, v118
    v_lshlrev_b32 v210, 16, v119
    v_and_b32 v211, 0xffff0000, v119
    v_lshlrev_b32 v212, 16, v122
    v_and_b32 v213, 0xffff0000, v122
    v_lshlrev_b32 v214, 16, v123
    v_and_b32 v215, 0xffff0000, v123
    v_mul_f32 v216, v184, v156
    v_mul_f32 v217, v185, v157
    v_mul_f32 v218, v186, v158
    v_mul_f32 v219, v187, v159
    v_mul_f32 v220, v188, v156
    v_mul_f32 v221, v189, v157
    v_mul_f32 v222, v190, v158
    v_mul_f32 v223, v191, v159
    v_mul_f32 v224, v192, v156
    v_mul_f32 v225, v193, v157
    v_mul_f32 v226, v194, v158
    v_mul_f32 v227, v195, v159
    v_mul_f32 v228, v196, v156
    v_mul_f32 v229, v197, v157
    v_mul_f32 v230, v198, v158
    v_mul_f32 v231, v199, v159
    v_mul_f32 v232, v200, v156
    v_mul_f32 v233, v201, v157
    v_mul_f32 v234, v202, v158
    v_mul_f32 v235, v203, v159
    v_mul_f32 v236, v204, v156
    v_mul_f32 v237, v205, v157
    v_mul_f32 v238, v206, v158
    v_mul_f32 v239, v207, v159
    v_mul_f32 v240, v208, v156
    v_mul_f32 v241, v209, v157
    v_mul_f32 v242, v210, v158
    v_mul_f32 v243, v211, v159
    v_mul_f32 v244, v212, v156
    v_mul_f32 v245, v213, v157
    v_mul_f32 v246, v214, v158
    v_mul_f32 v247, v215, v159
    v_fmac_f32 v216, v180, v160
    v_fmac_f32 v217, v181, v161
    v_fmac_f32 v218, v182, v162
    v_fmac_f32 v219, v183, v163
    v_fmac_f32 v220, v184, v160
    v_fmac_f32 v221, v185, v161
    v_fmac_f32 v222, v186, v162
    v_fmac_f32 v223, v187, v163
    v_fmac_f32 v224, v188, v160
    v_fmac_f32 v225, v189, v161
    v_fmac_f32 v226, v190, v162
    v_fmac_f32 v227, v191, v163
    v_fmac_f32 v228, v192, v160
    v_fmac_f32 v229, v193, v161
    v_fmac_f32 v230, v194, v162
    v_fmac_f32 v231, v195, v163
    v_fmac_f32 v232, v196, v160
    v_fmac_f32 v233, v197, v161
    v_fmac_f32 v234, v198, v162
    v_fmac_f32 v235, v199, v163
    v_fmac_f32 v236, v200, v160
    v_fmac_f32 v237, v201, v161
    v_fmac_f32 v238, v202, v162
    v_fmac_f32 v239, v203, v163
    v_fmac_f32 v240, v204, v160
    v_fmac_f32 v241, v205, v161
    v_fmac_f32 v242, v206, v162
    v_fmac_f32 v243, v207, v163
    v_fmac_f32 v244, v208, v160
    v_fmac_f32 v245, v209, v161
    v_fmac_f32 v246, v210, v162
    v_fmac_f32 v247, v211, v163
    v_fmac_f32 v216, v176, v164
    v_fmac_f32 v217, v177, v165
    v_fmac_f32 v218, v178, v166
    v_fmac_f32 v219, v179, v167
    v_fmac_f32 v220, v180, v164
    v_fmac_f32 v221, v181, v165
    v_fmac_f32 v222, v182, v166
    v_fmac_f32 v223, v183, v167
    v_fmac_f32 v224, v184, v164
    v_fmac_f32 v225, v185, v165
    v_fmac_f32 v226, v186, v166
    v_fmac_f32 v227, v187, v167
    v_fmac_f32 v228, v188, v164
    v_fmac_f32 v229, v189, v165
    v_fmac_f32 v230, v190, v166
    v_fmac_f32 v231, v191, v167
    v_fmac_f32 v232, v192, v164
    v_fmac_f32 v233, v193, v165
    v_fmac_f32 v234, v194, v166
    v_fmac_f32 v235, v195, v167
    v_fmac_f32 v236, v196, v164
    v_fmac_f32 v237, v197, v165
    v_fmac_f32 v238, v198, v166
    v_fmac_f32 v239, v199, v167
    v_fmac_f32 v240, v200, v164
    v_fmac_f32 v241, v201, v165
    v_fmac_f32 v242, v202, v166
    v_fmac_f32 v243, v203, v167
    v_fmac_f32 v244, v204, v164
    v_fmac_f32 v245, v205, v165
    v_fmac_f32 v246, v206, v166
    v_fmac_f32 v247, v207, v167
    v_fmac_f32 v216, v172, v168
    v_fmac_f32 v217, v173, v169
    v_fmac_f32 v218, v174, v170
    v_fmac_f32 v219, v175, v171
    v_fmac_f32 v220, v176, v168
    v_fmac_f32 v221, v177, v169
    v_fmac_f32 v222, v178, v170
    v_fmac_f32 v223, v179, v171
    v_fmac_f32 v224, v180, v168
    v_fmac_f32 v225, v181, v169
    v_fmac_f32 v226, v182, v170
    v_fmac_f32 v227, v183, v171
    v_fmac_f32 v228, v184, v168
    v_fmac_f32 v229, v185, v169
    v_fmac_f32 v230, v186, v170
    v_fmac_f32 v231, v187, v171
    v_fmac_f32 v232, v188, v168
    v_fmac_f32 v233, v189, v169
    v_fmac_f32 v234, v190, v170
    v_fmac_f32 v235, v191, v171
    v_fmac_f32 v236, v192, v168
    v_fmac_f32 v237, v193, v169
    v_fmac_f32 v238, v194, v170
    v_fmac_f32 v239, v195, v171
    v_fmac_f32 v240, v196, v168
    v_fmac_f32 v241, v197, v169
    v_fmac_f32 v242, v198, v170
    v_fmac_f32 v243, v199, v171
    v_fmac_f32 v244, v200, v168
    v_fmac_f32 v245, v201, v169
    v_fmac_f32 v246, v202, v170
    v_fmac_f32 v247, v203, v171
    v_lshlrev_b32 v172, 16, v126
    v_and_b32 v173, 0xffff0000, v126
    v_lshlrev_b32 v174, 16, v127
    v_and_b32 v175, 0xffff0000, v127
    v_lshlrev_b32 v176, 16, v130
    v_and_b32 v177, 0xffff0000, v130
    v_lshlrev_b32 v178, 16, v131
    v_and_b32 v179, 0xffff0000, v131
    v_lshlrev_b32 v180, 16, v134
    v_and_b32 v181, 0xffff0000, v134
    v_lshlrev_b32 v182, 16, v135
    v_and_b32 v183, 0xffff0000, v135
    v_lshlrev_b32 v184, 16, v138
    v_and_b32 v185, 0xffff0000, v138
    v_lshlrev_b32 v186, 16, v139
    v_and_b32 v187, 0xffff0000, v139
    v_lshlrev_b32 v188, 16, v142
    v_and_b32 v189, 0xffff0000, v142
    v_lshlrev_b32 v190, 16, v143
    v_and_b32 v191, 0xffff0000, v143
    v_lshlrev_b32 v192, 16, v146
    v_and_b32 v193, 0xffff0000, v146
    v_lshlrev_b32 v194, 16, v147
    v_and_b32 v195, 0xffff0000, v147
    v_lshlrev_b32 v196, 16, v150
    v_and_b32 v197, 0xffff0000, v150
    v_lshlrev_b32 v198, 16, v151
    v_and_b32 v199, 0xffff0000, v151
    v_lshlrev_b32 v200, 16, v154
    v_and_b32 v201, 0xffff0000, v154
    v_lshlrev_b32 v202, 16, v155
    v_and_b32 v203, 0xffff0000, v155
    v_mul_f32 v216, v216, v172
    v_mul_f32 v217, v217, v173
    v_mul_f32 v218, v218, v174
    v_mul_f32 v219, v219, v175
    v_mul_f32 v220, v220, v176
    v_mul_f32 v221, v221, v177
    v_mul_f32 v222, v222, v178
    v_mul_f32 v223, v223, v179
    v_mul_f32 v224, v224, v180
    v_mul_f32 v225, v225, v181
    v_mul_f32 v226, v226, v182
    v_mul_f32 v227, v227, v183
    v_mul_f32 v228, v228, v184
    v_mul_f32 v229, v229, v185
    v_mul_f32 v230, v230, v186
    v_mul_f32 v231, v231, v187
    v_mul_f32 v232, v232, v188
    v_mul_f32 v233, v233, v189
    v_mul_f32 v234, v234, v190
    v_mul_f32 v235, v235, v191
    v_mul_f32 v236, v236, v192
    v_mul_f32 v237, v237, v193
    v_mul_f32 v238, v238, v194
    v_mul_f32 v239, v239, v195
    v_mul_f32 v240, v240, v196
    v_mul_f32 v241, v241, v197
    v_mul_f32 v242, v242, v198
    v_mul_f32 v243, v243, v199
    v_mul_f32 v244, v244, v200
    v_mul_f32 v245, v245, v201
    v_mul_f32 v246, v246, v202
    v_mul_f32 v247, v247, v203
    v_cvt_pk_bf16_f32 v40, v244, v240
    v_cvt_pk_bf16_f32 v41, v236, v232
    v_cvt_pk_bf16_f32 v42, v228, v224
    v_cvt_pk_bf16_f32 v43, v220, v216
    v_cvt_pk_bf16_f32 v44, v245, v241
    v_cvt_pk_bf16_f32 v45, v237, v233
    v_cvt_pk_bf16_f32 v46, v229, v225
    v_cvt_pk_bf16_f32 v47, v221, v217
    v_cvt_pk_bf16_f32 v48, v246, v242
    v_cvt_pk_bf16_f32 v49, v238, v234
    v_cvt_pk_bf16_f32 v50, v230, v226
    v_cvt_pk_bf16_f32 v51, v222, v218
    v_cvt_pk_bf16_f32 v52, v247, v243
    v_cvt_pk_bf16_f32 v53, v239, v235
    v_cvt_pk_bf16_f32 v54, v231, v227
    v_cvt_pk_bf16_f32 v55, v223, v219
    s_cmp_eq_u32 s14, 1
    s_cbranch_scc1 L_xp1
    buffer_store_dwordx4 v[40:43], v9, s[64:67], 0 offen sc1
    buffer_store_dwordx4 v[44:47], v9, s[64:67], s32 offen sc1
    buffer_store_dwordx4 v[48:51], v9, s[64:67], s33 offen sc1
    buffer_store_dwordx4 v[52:55], v9, s[64:67], s34 offen sc1
    s_branch L_xq1
L_xp1:
    buffer_store_dwordx4 v[40:43], v9, s[64:67], 0 offen
    buffer_store_dwordx4 v[44:47], v9, s[64:67], s32 offen
    buffer_store_dwordx4 v[48:51], v9, s[64:67], s33 offen
    buffer_store_dwordx4 v[52:55], v9, s[64:67], s34 offen
L_xq1:
    s_waitcnt vmcnt(0)
    s_mov_b64 exec, 1
    s_cmp_eq_u32 s14, 1
    s_cbranch_scc0 L_xf0
    buffer_store_dwordx2 v[0:1], v19, s[72:75], s13 offen
    s_branch L_xf1
L_xf0:
    buffer_store_dwordx2 v[0:1], v19, s[72:75], s13 offen sc1
L_xf1:
    s_mov_b64 exec, -1
    s_cmp_eq_u32 s8, 3
    s_cbranch_scc0 L_id2
    s_mov_b32 s15, 0
L_i2_w:
    ds_read_b64 v[60:61], v21 offset:16
    s_waitcnt lgkmcnt(0)
    v_min_u32 v60, v60, v61
    v_cmp_gt_u32 vcc, 14, v60
    s_cbranch_vccz L_i2_ok
    s_sleep 2
    s_add_u32 s15, s15, 1
    s_cmp_lt_u32 s15, 160000
    s_cbranch_scc1 L_i2_w
L_i2_ok:
    s_mov_b32 s15, 0
LK_poll:
    buffer_load_dwordx2 v[60:61], v20, s[72:75], 0 offen sc1
    s_waitcnt vmcnt(0)
    v_cmp_ne_u64 vcc, v[60:61], v[0:1]
    s_cbranch_vccz LK_ok
    s_add_u32 s15, s15, 1
    s_cmp_lt_u32 s15, 20000
    s_cbranch_scc1 LK_poll
LK_ok:
    ds_write_b32 v21, v25 offset:44
L_id2:
    s_mov_b32 s15, 0
L_is1_w:
    ds_read_b32 v60, v21 offset:40
    s_waitcnt lgkmcnt(0)
    v_cmp_gt_u32 vcc, 2, v60
    s_cbranch_vccz L_is1_ok
    s_sleep 2
    s_add_u32 s15, s15, 1
    s_cmp_lt_u32 s15, 160000
    s_cbranch_scc1 L_is1_w
L_is1_ok:
    buffer_load_dwordx4 v[192:195], v26, s[68:71], s36 offen offset:0 nt
    buffer_load_dwordx4 v[196:199], v26, s[68:71], s36 offen offset:1024 nt
    buffer_load_dwordx4 v[200:203], v26, s[68:71], s36 offen offset:2048 nt
    buffer_load_dwordx4 v[204:207], v26, s[68:71], s36 offen offset:3072 nt
L_t2:
    s_mov_b32 s52, s50
    s_mov_b32 s53, s51
    s_mov_b32 s54, 4194304
    s_mov_b32 s55, 0x00020000
    s_mov_b32 s56, s50
    s_mov_b32 s57, s51
    s_mov_b32 s58, 4194304
    s_mov_b32 s59, 0x00020000
    s_mov_b32 s60, s16
    s_mov_b32 s61, s17
    s_mov_b32 s62, 4194304
    s_mov_b32 s63, 0x00020000
    s_mov_b32 s64, s46
    s_mov_b32 s65, s47
    s_mov_b32 s66, 16777216
    s_mov_b32 s67, 0x00020000
    s_mov_b32 s15, 0
L_fk_w:
    ds_read_b32 v60, v21 offset:44
    s_waitcnt lgkmcnt(0)
    v_cmp_gt_u32 vcc, 1, v60
    s_cbranch_vccz L_fk_ok
    s_sleep 1
    s_add_u32 s15, s15, 1
    s_cmp_lt_u32 s15, 160000
    s_cbranch_scc1 L_fk_w
L_fk_ok:
    ds_read_b64 v[0:1], v21 offset:32
    buffer_load_dwordx4 v[224:227], v26, s[52:55], s36 offen offset:0 sc1
    buffer_load_dwordx4 v[228:231], v26, s[52:55], s36 offen offset:1024 sc1
    buffer_load_dwordx4 v[232:235], v26, s[52:55], s36 offen offset:2048 sc1
    buffer_load_dwordx4 v[236:239], v26, s[52:55], s36 offen offset:3072 sc1
    buffer_load_dwordx2 v[4:5], v16, s[60:63], 0 offen offset:0 nt
    buffer_load_dwordx2 v[6:7], v16, s[60:63], 0 offen offset:2048 nt
    buffer_load_dwordx2 v[8:9], v16, s[60:63], s32 offen offset:0 nt
    buffer_load_dwordx2 v[10:11], v16, s[60:63], s32 offen offset:2048 nt
    buffer_load_dwordx2 v[14:15], v16, s[60:63], s33 offen offset:0 nt
    buffer_load_dwordx2 v[56:57], v16, s[60:63], s33 offen offset:2048 nt
    buffer_load_dwordx2 v[58:59], v16, s[60:63], s34 offen offset:0 nt
    buffer_load_dwordx2 v[34:35], v16, s[60:63], s34 offen offset:2048 nt
    s_lshl_b32 s14, s9, 13
    s_lshl_b32 s10, s11, 12
    s_add_u32 s14, s14, s10
    s_mov_b32 s15, 0
L_c1_w:
    ds_read_b128 v[60:63], v21 offset:0
    s_waitcnt lgkmcnt(0)
    v_min3_u32 v60, v60, v61, v62
    v_min_u32 v60, v60, v63
    v_cmp_gt_u32 vcc, 14, v60
    s_cbranch_vccz L_c1_ok
    s_sleep 1
    s_add_u32 s15, s15, 1
    s_cmp_lt_u32 s15, 160000
    s_cbranch_scc1 L_c1_w
L_c1_ok:
    s_bfe_u32 s13, s37, 0 + (4 << 16)
    s_lshl_b32 s13, s13, 7
    s_add_u32 m0, s14, 0
    s_nop 0
    buffer_load_dwordx4 v12, s[80:83], s13 offen offset:0 lds
    buffer_load_dwordx4 v13, s[80:83], s13 offen offset:1024 lds
    buffer_load_dwordx4 v12, s[80:83], s13 offen offset:2048 lds
    buffer_load_dwordx4 v13, s[80:83], s13 offen offset:3072 lds
    s_bfe_u32 s13, s37, 4 + (4 << 16)
    s_lshl_b32 s13, s13, 7
    s_add_u32 m0, s14, 16384
    s_nop 0
    buffer_load_dwordx4 v12, s[80:83], s13 offen offset:0 lds
    buffer_load_dwordx4 v13, s[80:83], s13 offen offset:1024 lds
    buffer_load_dwordx4 v12, s[80:83], s13 offen offset:2048 lds
    buffer_load_dwordx4 v13, s[80:83], s13 offen offset:3072 lds
    s_bfe_u32 s13, s37, 8 + (4 << 16)
    s_lshl_b32 s13, s13, 7
    s_add_u32 m0, s14, 32768
    s_nop 0
    buffer_load_dwordx4 v12, s[80:83], s13 offen offset:0 lds
    buffer_load_dwordx4 v13, s[80:83], s13 offen offset:1024 lds
    buffer_load_dwordx4 v12, s[80:83], s13 offen offset:2048 lds
    buffer_load_dwordx4 v13, s[80:83], s13 offen offset:3072 lds
    s_bfe_u32 s13, s37, 12 + (4 << 16)
    s_lshl_b32 s13, s13, 7
    s_add_u32 m0, s14, 49152
    s_nop 0
    buffer_load_dwordx4 v12, s[80:83], s13 offen offset:0 lds
    buffer_load_dwordx4 v13, s[80:83], s13 offen offset:1024 lds
    buffer_load_dwordx4 v12, s[80:83], s13 offen offset:2048 lds
    buffer_load_dwordx4 v13, s[80:83], s13 offen offset:3072 lds
    s_bitcmp1_b32 s100, 0
    s_cselect_b32 s10, 16, 0
    s_lshr_b32 s31, s31, s10
    s_and_b32 s31, s31, 0xffff
    v_lshlrev_b32 v60, 3, v27
    v_sub_u32 v60, v60, v17
    v_add_u32 v60, -9, v60
    v_and_b32 v61, 1, v60
    v_lshlrev_b32 v61, 4, v61
    v_lshlrev_b32 v61, v61, s31
    v_ashrrev_i32 v60, 1, v60
    v_cmp_eq_u32 vcc, 0, v60
    s_nop 1
    v_cndmask_b32 v36, 0, v61, vcc
    v_cmp_eq_u32 vcc, 1, v60
    s_nop 1
    v_cndmask_b32 v37, 0, v61, vcc
    v_cmp_eq_u32 vcc, 2, v60
    s_nop 1
    v_cndmask_b32 v38, 0, v61, vcc
    v_cmp_eq_u32 vcc, 3, v60
    s_nop 1
    v_cndmask_b32 v39, 0, v61, vcc
    v_mov_b32 v128, 0
    v_mov_b32 v129, 0
    v_mov_b32 v130, 0
    v_mov_b32 v131, 0
    v_and_b32 v60, 1, v27
    v_lshlrev_b32 v60, 9, v60
    v_lshl_add_u32 v60, v17, 5, v60
    v_lshrrev_b32 v61, 1, v27
    v_lshl_add_u32 v17, v61, 4, v60
    v_and_b32 v60, 1, v2
    v_lshrrev_b32 v61, 5, v2
    v_lshl_add_u32 v60, v60, 1, v61
    v_bfe_u32 v61, v2, 1, 4
    v_lshl_add_u32 v60, v60, 4, v61
    v_lshlrev_b32 v17, 2, v60
    s_waitcnt vmcnt(28)
    v_mov_b32 v208, 0
    v_alignbit_b32 v209, v193, v192, 16
    v_alignbit_b32 v210, v194, v193, 16
    v_alignbit_b32 v211, v195, v194, 16
    s_nop 0
    v_mov_b32_dpp v208, v195 wave_shr:1 row_mask:0xf bank_mask:0xf
    v_alignbit_b32 v208, v192, v208, 16
    v_readlane_b32 s10, v195, 63
    v_alignbit_b32 v213, v197, v196, 16
    v_alignbit_b32 v214, v198, v197, 16
    v_mov_b32 v212, s10
    v_alignbit_b32 v215, v199, v198, 16
    s_nop 0
    v_mov_b32_dpp v212, v199 wave_shr:1 row_mask:0xf bank_mask:0xf
    v_alignbit_b32 v212, v196, v212, 16
    v_readlane_b32 s10, v199, 63
    v_alignbit_b32 v217, v201, v200, 16
    v_alignbit_b32 v218, v202, v201, 16
    v_mov_b32 v216, s10
    v_alignbit_b32 v219, v203, v202, 16
    s_nop 0
    v_mov_b32_dpp v216, v203 wave_shr:1 row_mask:0xf bank_mask:0xf
    v_alignbit_b32 v216, v200, v216, 16
    v_readlane_b32 s10, v203, 63
    v_alignbit_b32 v221, v205, v204, 16
    v_alignbit_b32 v222, v206, v205, 16
    v_mov_b32 v220, s10
    v_alignbit_b32 v223, v207, v206, 16
    s_nop 0
    v_mov_b32_dpp v220, v207 wave_shr:1 row_mask:0xf bank_mask:0xf
    v_alignbit_b32 v220, v204, v220, 16
    s_mov_b32 s15, 0
L_c2_w:
    ds_read_b128 v[60:63], v21 offset:0
    s_waitcnt lgkmcnt(0)
    v_min3_u32 v60, v60, v61, v62
    v_min_u32 v60, v60, v63
    v_cmp_gt_u32 vcc, 16, v60
    s_cbranch_vccz L_c2_ok
    s_sleep 1
    s_add_u32 s15, s15, 1
    s_cmp_lt_u32 s15, 160000
    s_cbranch_scc1 L_c2_w
L_c2_ok:
    s_setprio 0
    ds_write_b128 v18, v[128:131]
    v_add_u32 v62, -8288, v33
    ds_write_b128 v62, v[192:195] offset:0
    ds_write_b128 v62, v[196:199] offset:1024
    ds_write_b128 v62, v[200:203] offset:2048
    ds_write_b128 v62, v[204:207] offset:3072
    ds_write_b128 v62, v[208:211] offset:4160
    ds_write_b128 v62, v[212:215] offset:5184
    ds_write_b128 v62, v[216:219] offset:6208
    ds_write_b128 v62, v[220:223] offset:7232
    ds_read2_b32 v[128:129], v28 offset0:0 offset1:1
    ds_read2_b32 v[130:131], v28 offset0:2 offset1:3
    ds_read2_b32 v[132:133], v28 offset0:128 offset1:129
    ds_read2_b32 v[134:135], v28 offset0:130 offset1:131
    ds_read2_b32 v[136:137], v29 offset0:0 offset1:1
    ds_read2_b32 v[138:139], v29 offset0:2 offset1:3
    ds_read2_b32 v[140:141], v29 offset0:128 offset1:129
    ds_read2_b32 v[142:143], v29 offset0:130 offset1:131
    ds_read2_b32 v[144:145], v30 offset0:0 offset1:1
    ds_read2_b32 v[146:147], v30 offset0:2 offset1:3
    ds_read2_b32 v[148:149], v30 offset0:128 offset1:129
    ds_read2_b32 v[150:151], v30 offset0:130 offset1:131
    ds_read2_b32 v[152:153], v31 offset0:0 offset1:1
    ds_read2_b32 v[154:155], v31 offset0:2 offset1:3
    ds_read2_b32 v[156:157], v31 offset0:128 offset1:129
    ds_read2_b32 v[158:159], v31 offset0:130 offset1:131
    s_waitcnt vmcnt(27)
    ds_write_b128 v33, v[224:227] offset:0
    s_waitcnt vmcnt(26)
    ds_write_b128 v33, v[228:231] offset:1024
    s_waitcnt vmcnt(25)
    ds_write_b128 v33, v[232:235] offset:2048
    s_waitcnt vmcnt(24)
    ds_write_b128 v33, v[236:239] offset:3072
    ds_read_b128 v[160:163], v32 offset:3584
    ds_read_b128 v[164:167], v32 offset:3072
    ds_read_b128 v[168:171], v32 offset:2560
    ds_read_b128 v[172:175], v32 offset:2048
    ds_read_b128 v[176:179], v32 offset:1536
    ds_read_b128 v[180:183], v32 offset:1024
    ds_read_b128 v[184:187], v32 offset:512
    ds_read_b128 v[188:191], v32 offset:0
    s_setprio 2
    s_waitcnt lgkmcnt(0)
    v_mfma_f32_16x16x32_bf16 v[96:99], v[36:39], v[160:163], 0
    v_mfma_f32_16x16x32_bf16 v[100:103], v[36:39], v[164:167], 0
    v_mfma_f32_16x16x32_bf16 v[104:107], v[36:39], v[168:171], 0
    v_mfma_f32_16x16x32_bf16 v[108:111], v[36:39], v[172:175], 0
    v_mfma_f32_16x16x32_bf16 v[112:115], v[36:39], v[176:179], 0
    v_mfma_f32_16x16x32_bf16 v[116:119], v[36:39], v[180:183], 0
    v_mfma_f32_16x16x32_bf16 v[120:123], v[36:39], v[184:187], 0
    v_mfma_f32_16x16x32_bf16 v[124:127], v[36:39], v[188:191], 0
    v_mfma_f32_16x16x32_bf16 v[96:99], v[128:131], v[160:163], v[96:99]
    ds_read2_b32 v[192:193], v28 offset0:16 offset1:17
    s_bfe_u32 s13, s30, 28 + (4 << 16)
    s_lshl_b32 s13, s13, 7
    buffer_load_dwordx4 v[40:43], v12, s[80:83], s13 offen offset:0
    v_mfma_f32_16x16x32_bf16 v[100:103], v[128:131], v[164:167], v[100:103]
    ds_read2_b32 v[194:195], v28 offset0:18 offset1:19
    v_mfma_f32_16x16x32_bf16 v[104:107], v[128:131], v[168:171], v[104:107]
    ds_read_b128 v[224:227], v32 offset:3648
    v_mfma_f32_16x16x32_bf16 v[108:111], v[128:131], v[172:175], v[108:111]
    ds_read2_b32 v[196:197], v28 offset0:144 offset1:145
    v_mfma_f32_16x16x32_bf16 v[112:115], v[128:131], v[176:179], v[112:115]
    ds_read2_b32 v[198:199], v28 offset0:146 offset1:147
    v_mfma_f32_16x16x32_bf16 v[116:119], v[128:131], v[180:183], v[116:119]
    ds_read_b128 v[228:231], v32 offset:3136
    v_mfma_f32_16x16x32_bf16 v[120:123], v[128:131], v[184:187], v[120:123]
    ds_read2_b32 v[200:201], v29 offset0:16 offset1:17
    buffer_load_dwordx4 v[44:47], v13, s[80:83], s13 offen offset:1024
    v_mfma_f32_16x16x32_bf16 v[124:127], v[128:131], v[188:191], v[124:127]
    ds_read2_b32 v[202:203], v29 offset0:18 offset1:19
    v_mfma_f32_16x16x32_bf16 v[100:103], v[132:135], v[160:163], v[100:103]
    ds_read_b128 v[232:235], v32 offset:2624
    v_mfma_f32_16x16x32_bf16 v[104:107], v[132:135], v[164:167], v[104:107]
    ds_read2_b32 v[204:205], v29 offset0:144 offset1:145
    v_mfma_f32_16x16x32_bf16 v[108:111], v[132:135], v[168:171], v[108:111]
    ds_read2_b32 v[206:207], v29 offset0:146 offset1:147
    v_mfma_f32_16x16x32_bf16 v[112:115], v[132:135], v[172:175], v[112:115]
    ds_read_b128 v[236:239], v32 offset:2112
    v_mfma_f32_16x16x32_bf16 v[116:119], v[132:135], v[176:179], v[116:119]
    ds_read2_b32 v[208:209], v30 offset0:16 offset1:17
    buffer_load_dwordx4 v[48:51], v12, s[80:83], s13 offen offset:2048
    v_mfma_f32_16x16x32_bf16 v[120:123], v[132:135], v[180:183], v[120:123]
    ds_read2_b32 v[210:211], v30 offset0:18 offset1:19
    v_mfma_f32_16x16x32_bf16 v[124:127], v[132:135], v[184:187], v[124:127]
    ds_read_b128 v[240:243], v32 offset:1600
    v_mfma_f32_16x16x32_bf16 v[104:107], v[136:139], v[160:163], v[104:107]
    ds_read2_b32 v[212:213], v30 offset0:144 offset1:145
    v_mfma_f32_16x16x32_bf16 v[108:111], v[136:139], v[164:167], v[108:111]
    ds_read2_b32 v[214:215], v30 offset0:146 offset1:147
    v_mfma_f32_16x16x32_bf16 v[112:115], v[136:139], v[168:171], v[112:115]
    ds_read_b128 v[244:247], v32 offset:1088
    v_mfma_f32_16x16x32_bf16 v[116:119], v[136:139], v[172:175], v[116:119]
    ds_read2_b32 v[216:217], v31 offset0:16 offset1:17
    buffer_load_dwordx4 v[52:55], v13, s[80:83], s13 offen offset:3072
    v_mfma_f32_16x16x32_bf16 v[120:123], v[136:139], v[176:179], v[120:123]
    ds_read2_b32 v[218:219], v31 offset0:18 offset1:19
    v_mfma_f32_16x16x32_bf16 v[124:127], v[136:139], v[180:183], v[124:127]
    ds_read_b128 v[248:251], v32 offset:576
    v_mfma_f32_16x16x32_bf16 v[108:111], v[140:143], v[160:163], v[108:111]
    ds_read2_b32 v[220:221], v31 offset0:144 offset1:145
    v_mfma_f32_16x16x32_bf16 v[112:115], v[140:143], v[164:167], v[112:115]
    ds_read2_b32 v[222:223], v31 offset0:146 offset1:147
    v_mfma_f32_16x16x32_bf16 v[116:119], v[140:143], v[168:171], v[116:119]
    ds_read_b128 v[252:255], v32 offset:64
    v_mfma_f32_16x16x32_bf16 v[120:123], v[140:143], v[172:175], v[120:123]
    s_bfe_u32 s13, s30, 24 + (4 << 16)
    s_lshl_b32 s13, s13, 7
    buffer_load_dwordx4 v[80:83], v12, s[80:83], s13 offen offset:0
    v_mfma_f32_16x16x32_bf16 v[124:127], v[140:143], v[176:179], v[124:127]
    v_mfma_f32_16x16x32_bf16 v[112:115], v[144:147], v[160:163], v[112:115]
    v_mfma_f32_16x16x32_bf16 v[116:119], v[144:147], v[164:167], v[116:119]
    v_mfma_f32_16x16x32_bf16 v[120:123], v[144:147], v[168:171], v[120:123]
    v_mfma_f32_16x16x32_bf16 v[124:127], v[144:147], v[172:175], v[124:127]
    v_mfma_f32_16x16x32_bf16 v[116:119], v[148:151], v[160:163], v[116:119]
    buffer_load_dwordx4 v[84:87], v13, s[80:83], s13 offen offset:1024
    s_waitcnt vmcnt(6)
    v_mov_b32 v60, 1
    s_mov_b64 exec, 1
    ds_add_u32 v21, v60 offset:60
    s_mov_b64 exec, -1
    v_mfma_f32_16x16x32_bf16 v[120:123], v[148:151], v[164:167], v[120:123]
    v_mfma_f32_16x16x32_bf16 v[124:127], v[148:151], v[168:171], v[124:127]
    v_mfma_f32_16x16x32_bf16 v[120:123], v[152:155], v[160:163], v[120:123]
    v_mfma_f32_16x16x32_bf16 v[124:127], v[152:155], v[164:167], v[124:127]
    v_mfma_f32_16x16x32_bf16 v[124:127], v[156:159], v[160:163], v[124:127]
    s_waitcnt lgkmcnt(0)
    v_mfma_f32_16x16x32_bf16 v[96:99], v[192:195], v[224:227], v[96:99]
    ds_read2_b32 v[128:129], v28 offset0:32 offset1:33
    buffer_load_dwordx4 v[88:91], v12, s[80:83], s13 offen offset:2048
    v_mfma_f32_16x16x32_bf16 v[100:103], v[192:195], v[228:231], v[100:103]
    ds_read2_b32 v[130:131], v28 offset0:34 offset1:35
    v_mfma_f32_16x16x32_bf16 v[104:107], v[192:195], v[232:235], v[104:107]
    ds_read_b128 v[160:163], v32 offset:3712
    v_mfma_f32_16x16x32_bf16 v[108:111], v[192:195], v[236:239], v[108:111]
    ds_read2_b32 v[132:133], v28 offset0:160 offset1:161
    v_mfma_f32_16x16x32_bf16 v[112:115], v[192:195], v[240:243], v[112:115]
    ds_read2_b32 v[134:135], v28 offset0:162 offset1:163
    v_mfma_f32_16x16x32_bf16 v[116:119], v[192:195], v[244:247], v[116:119]
    ds_read_b128 v[164:167], v32 offset:3200
    v_mfma_f32_16x16x32_bf16 v[120:123], v[192:195], v[248:251], v[120:123]
    ds_read2_b32 v[136:137], v29 offset0:32 offset1:33
    buffer_load_dwordx4 v[92:95], v13, s[80:83], s13 offen offset:3072
    v_mfma_f32_16x16x32_bf16 v[124:127], v[192:195], v[252:255], v[124:127]
    ds_read2_b32 v[138:139], v29 offset0:34 offset1:35
    v_mfma_f32_16x16x32_bf16 v[100:103], v[196:199], v[224:227], v[100:103]
    ds_read_b128 v[168:171], v32 offset:2688
    v_mfma_f32_16x16x32_bf16 v[104:107], v[196:199], v[228:231], v[104:107]
    ds_read2_b32 v[140:141], v29 offset0:160 offset1:161
    v_mfma_f32_16x16x32_bf16 v[108:111], v[196:199], v[232:235], v[108:111]
    ds_read2_b32 v[142:143], v29 offset0:162 offset1:163
    v_mfma_f32_16x16x32_bf16 v[112:115], v[196:199], v[236:239], v[112:115]
    ds_read_b128 v[172:175], v32 offset:2176
    v_mfma_f32_16x16x32_bf16 v[116:119], v[196:199], v[240:243], v[116:119]
    ds_read2_b32 v[144:145], v30 offset0:32 offset1:33
    s_bfe_u32 s13, s30, 20 + (4 << 16)
    s_lshl_b32 s13, s13, 7
    buffer_load_dwordx4 v[64:67], v12, s[80:83], s13 offen offset:0
    v_mfma_f32_16x16x32_bf16 v[120:123], v[196:199], v[244:247], v[120:123]
    ds_read2_b32 v[146:147], v30 offset0:34 offset1:35
    v_mfma_f32_16x16x32_bf16 v[124:127], v[196:199], v[248:251], v[124:127]
    ds_read_b128 v[176:179], v32 offset:1664
    v_mfma_f32_16x16x32_bf16 v[104:107], v[200:203], v[224:227], v[104:107]
    ds_read2_b32 v[148:149], v30 offset0:160 offset1:161
    v_mfma_f32_16x16x32_bf16 v[108:111], v[200:203], v[228:231], v[108:111]
    ds_read2_b32 v[150:151], v30 offset0:162 offset1:163
    v_mfma_f32_16x16x32_bf16 v[112:115], v[200:203], v[232:235], v[112:115]
    ds_read_b128 v[180:183], v32 offset:1152
    v_mfma_f32_16x16x32_bf16 v[116:119], v[200:203], v[236:239], v[116:119]
    ds_read2_b32 v[152:153], v31 offset0:32 offset1:33
    buffer_load_dwordx4 v[68:71], v13, s[80:83], s13 offen offset:1024
    v_mfma_f32_16x16x32_bf16 v[120:123], v[200:203], v[240:243], v[120:123]
    ds_read2_b32 v[154:155], v31 offset0:34 offset1:35
    v_mfma_f32_16x16x32_bf16 v[124:127], v[200:203], v[244:247], v[124:127]
    ds_read_b128 v[184:187], v32 offset:640
    v_mfma_f32_16x16x32_bf16 v[108:111], v[204:207], v[224:227], v[108:111]
    ds_read2_b32 v[156:157], v31 offset0:160 offset1:161
    v_mfma_f32_16x16x32_bf16 v[112:115], v[204:207], v[228:231], v[112:115]
    ds_read2_b32 v[158:159], v31 offset0:162 offset1:163
    v_mfma_f32_16x16x32_bf16 v[116:119], v[204:207], v[232:235], v[116:119]
    ds_read_b128 v[188:191], v32 offset:128
    v_mfma_f32_16x16x32_bf16 v[120:123], v[204:207], v[236:239], v[120:123]
    buffer_load_dwordx4 v[72:75], v12, s[80:83], s13 offen offset:2048
    v_mfma_f32_16x16x32_bf16 v[124:127], v[204:207], v[240:243], v[124:127]
    v_mfma_f32_16x16x32_bf16 v[112:115], v[208:211], v[224:227], v[112:115]
    v_mfma_f32_16x16x32_bf16 v[116:119], v[208:211], v[228:231], v[116:119]
    v_mfma_f32_16x16x32_bf16 v[120:123], v[208:211], v[232:235], v[120:123]
    v_mfma_f32_16x16x32_bf16 v[124:127], v[208:211], v[236:239], v[124:127]
    v_mfma_f32_16x16x32_bf16 v[116:119], v[212:215], v[224:227], v[116:119]
    buffer_load_dwordx4 v[76:79], v13, s[80:83], s13 offen offset:3072
    v_mfma_f32_16x16x32_bf16 v[120:123], v[212:215], v[228:231], v[120:123]
    v_mfma_f32_16x16x32_bf16 v[124:127], v[212:215], v[232:235], v[124:127]
    v_mfma_f32_16x16x32_bf16 v[120:123], v[216:219], v[224:227], v[120:123]
    v_mfma_f32_16x16x32_bf16 v[124:127], v[216:219], v[228:231], v[124:127]
    v_mfma_f32_16x16x32_bf16 v[124:127], v[220:223], v[224:227], v[124:127]
    s_waitcnt lgkmcnt(0)
    v_mfma_f32_16x16x32_bf16 v[96:99], v[128:131], v[160:163], v[96:99]
    ds_read2_b32 v[192:193], v28 offset0:48 offset1:49
    v_mfma_f32_16x16x32_bf16 v[100:103], v[128:131], v[164:167], v[100:103]
    ds_read2_b32 v[194:195], v28 offset0:50 offset1:51
    v_mfma_f32_16x16x32_bf16 v[104:107], v[128:131], v[168:171], v[104:107]
    ds_read_b128 v[224:227], v32 offset:3776
    v_mfma_f32_16x16x32_bf16 v[108:111], v[128:131], v[172:175], v[108:111]
    ds_read2_b32 v[196:197], v28 offset0:176 offset1:177
    v_mfma_f32_16x16x32_bf16 v[112:115], v[128:131], v[176:179], v[112:115]
    ds_read2_b32 v[198:199], v28 offset0:178 offset1:179
    v_mfma_f32_16x16x32_bf16 v[116:119], v[128:131], v[180:183], v[116:119]
    ds_read_b128 v[228:231], v32 offset:3264
    v_mfma_f32_16x16x32_bf16 v[120:123], v[128:131], v[184:187], v[120:123]
    ds_read2_b32 v[200:201], v29 offset0:48 offset1:49
    v_mfma_f32_16x16x32_bf16 v[124:127], v[128:131], v[188:191], v[124:127]
    ds_read2_b32 v[202:203], v29 offset0:50 offset1:51
    v_mfma_f32_16x16x32_bf16 v[100:103], v[132:135], v[160:163], v[100:103]
    ds_read_b128 v[232:235], v32 offset:2752
    v_mfma_f32_16x16x32_bf16 v[104:107], v[132:135], v[164:167], v[104:107]
    ds_read2_b32 v[204:205], v29 offset0:176 offset1:177
    v_mfma_f32_16x16x32_bf16 v[108:111], v[132:135], v[168:171], v[108:111]
    ds_read2_b32 v[206:207], v29 offset0:178 offset1:179
    v_mfma_f32_16x16x32_bf16 v[112:115], v[132:135], v[172:175], v[112:115]
    ds_read_b128 v[236:239], v32 offset:2240
    v_mfma_f32_16x16x32_bf16 v[116:119], v[132:135], v[176:179], v[116:119]
    ds_read2_b32 v[208:209], v30 offset0:48 offset1:49
    v_mfma_f32_16x16x32_bf16 v[120:123], v[132:135], v[180:183], v[120:123]
    ds_read2_b32 v[210:211], v30 offset0:50 offset1:51
    v_mfma_f32_16x16x32_bf16 v[124:127], v[132:135], v[184:187], v[124:127]
    ds_read_b128 v[240:243], v32 offset:1728
    v_mfma_f32_16x16x32_bf16 v[104:107], v[136:139], v[160:163], v[104:107]
    ds_read2_b32 v[212:213], v30 offset0:176 offset1:177
    v_mfma_f32_16x16x32_bf16 v[108:111], v[136:139], v[164:167], v[108:111]
    ds_read2_b32 v[214:215], v30 offset0:178 offset1:179
    v_mfma_f32_16x16x32_bf16 v[112:115], v[136:139], v[168:171], v[112:115]
    ds_read_b128 v[244:247], v32 offset:1216
    v_mfma_f32_16x16x32_bf16 v[116:119], v[136:139], v[172:175], v[116:119]
    ds_read2_b32 v[216:217], v31 offset0:48 offset1:49
    v_mfma_f32_16x16x32_bf16 v[120:123], v[136:139], v[176:179], v[120:123]
    ds_read2_b32 v[218:219], v31 offset0:50 offset1:51
    v_mfma_f32_16x16x32_bf16 v[124:127], v[136:139], v[180:183], v[124:127]
    ds_read_b128 v[248:251], v32 offset:704
    v_mfma_f32_16x16x32_bf16 v[108:111], v[140:143], v[160:163], v[108:111]
    ds_read2_b32 v[220:221], v31 offset0:176 offset1:177
    v_mfma_f32_16x16x32_bf16 v[112:115], v[140:143], v[164:167], v[112:115]
    ds_read2_b32 v[222:223], v31 offset0:178 offset1:179
    v_mfma_f32_16x16x32_bf16 v[116:119], v[140:143], v[168:171], v[116:119]
    ds_read_b128 v[252:255], v32 offset:192
    v_mfma_f32_16x16x32_bf16 v[120:123], v[140:143], v[172:175], v[120:123]
    v_mfma_f32_16x16x32_bf16 v[124:127], v[140:143], v[176:179], v[124:127]
    v_mfma_f32_16x16x32_bf16 v[112:115], v[144:147], v[160:163], v[112:115]
    v_mfma_f32_16x16x32_bf16 v[116:119], v[144:147], v[164:167], v[116:119]
    v_mfma_f32_16x16x32_bf16 v[120:123], v[144:147], v[168:171], v[120:123]
    v_mfma_f32_16x16x32_bf16 v[124:127], v[144:147], v[172:175], v[124:127]
    v_mfma_f32_16x16x32_bf16 v[116:119], v[148:151], v[160:163], v[116:119]
    v_mfma_f32_16x16x32_bf16 v[120:123], v[148:151], v[164:167], v[120:123]
    v_mfma_f32_16x16x32_bf16 v[124:127], v[148:151], v[168:171], v[124:127]
    v_mfma_f32_16x16x32_bf16 v[120:123], v[152:155], v[160:163], v[120:123]
    v_mfma_f32_16x16x32_bf16 v[124:127], v[152:155], v[164:167], v[124:127]
    v_mfma_f32_16x16x32_bf16 v[124:127], v[156:159], v[160:163], v[124:127]
    s_waitcnt lgkmcnt(0)
    v_mfma_f32_16x16x32_bf16 v[96:99], v[192:195], v[224:227], v[96:99]
    ds_read2_b32 v[128:129], v28 offset0:64 offset1:65
    v_mfma_f32_16x16x32_bf16 v[100:103], v[192:195], v[228:231], v[100:103]
    ds_read2_b32 v[130:131], v28 offset0:66 offset1:67
    v_mfma_f32_16x16x32_bf16 v[104:107], v[192:195], v[232:235], v[104:107]
    ds_read_b128 v[160:163], v32 offset:3840
    v_mfma_f32_16x16x32_bf16 v[108:111], v[192:195], v[236:239], v[108:111]
    ds_read2_b32 v[132:133], v28 offset0:192 offset1:193
    v_mfma_f32_16x16x32_bf16 v[112:115], v[192:195], v[240:243], v[112:115]
    ds_read2_b32 v[134:135], v28 offset0:194 offset1:195
    v_mfma_f32_16x16x32_bf16 v[116:119], v[192:195], v[244:247], v[116:119]
    ds_read_b128 v[164:167], v32 offset:3328
    v_mfma_f32_16x16x32_bf16 v[120:123], v[192:195], v[248:251], v[120:123]
    ds_read2_b32 v[136:137], v29 offset0:64 offset1:65
    v_mfma_f32_16x16x32_bf16 v[124:127], v[192:195], v[252:255], v[124:127]
    ds_read2_b32 v[138:139], v29 offset0:66 offset1:67
    v_mfma_f32_16x16x32_bf16 v[100:103], v[196:199], v[224:227], v[100:103]
    ds_read_b128 v[168:171], v32 offset:2816
    v_mfma_f32_16x16x32_bf16 v[104:107], v[196:199], v[228:231], v[104:107]
    ds_read2_b32 v[140:141], v29 offset0:192 offset1:193
    v_mfma_f32_16x16x32_bf16 v[108:111], v[196:199], v[232:235], v[108:111]
    ds_read2_b32 v[142:143], v29 offset0:194 offset1:195
    v_mfma_f32_16x16x32_bf16 v[112:115], v[196:199], v[236:239], v[112:115]
    ds_read_b128 v[172:175], v32 offset:2304
    v_mfma_f32_16x16x32_bf16 v[116:119], v[196:199], v[240:243], v[116:119]
    ds_read2_b32 v[144:145], v30 offset0:64 offset1:65
    v_mfma_f32_16x16x32_bf16 v[120:123], v[196:199], v[244:247], v[120:123]
    ds_read2_b32 v[146:147], v30 offset0:66 offset1:67
    v_mfma_f32_16x16x32_bf16 v[124:127], v[196:199], v[248:251], v[124:127]
    ds_read_b128 v[176:179], v32 offset:1792
    v_mfma_f32_16x16x32_bf16 v[104:107], v[200:203], v[224:227], v[104:107]
    ds_read2_b32 v[148:149], v30 offset0:192 offset1:193
    v_mfma_f32_16x16x32_bf16 v[108:111], v[200:203], v[228:231], v[108:111]
    ds_read2_b32 v[150:151], v30 offset0:194 offset1:195
    v_mfma_f32_16x16x32_bf16 v[112:115], v[200:203], v[232:235], v[112:115]
    ds_read_b128 v[180:183], v32 offset:1280
    v_mfma_f32_16x16x32_bf16 v[116:119], v[200:203], v[236:239], v[116:119]
    ds_read2_b32 v[152:153], v31 offset0:64 offset1:65
    v_mfma_f32_16x16x32_bf16 v[120:123], v[200:203], v[240:243], v[120:123]
    ds_read2_b32 v[154:155], v31 offset0:66 offset1:67
    v_mfma_f32_16x16x32_bf16 v[124:127], v[200:203], v[244:247], v[124:127]
    ds_read_b128 v[184:187], v32 offset:768
    v_mfma_f32_16x16x32_bf16 v[108:111], v[204:207], v[224:227], v[108:111]
    ds_read2_b32 v[156:157], v31 offset0:192 offset1:193
    v_mfma_f32_16x16x32_bf16 v[112:115], v[204:207], v[228:231], v[112:115]
    ds_read2_b32 v[158:159], v31 offset0:194 offset1:195
    v_mfma_f32_16x16x32_bf16 v[116:119], v[204:207], v[232:235], v[116:119]
    ds_read_b128 v[188:191], v32 offset:256
    v_mfma_f32_16x16x32_bf16 v[120:123], v[204:207], v[236:239], v[120:123]
    v_mfma_f32_16x16x32_bf16 v[124:127], v[204:207], v[240:243], v[124:127]
    v_mfma_f32_16x16x32_bf16 v[112:115], v[208:211], v[224:227], v[112:115]
    v_mfma_f32_16x16x32_bf16 v[116:119], v[208:211], v[228:231], v[116:119]
    v_mfma_f32_16x16x32_bf16 v[120:123], v[208:211], v[232:235], v[120:123]
    v_mfma_f32_16x16x32_bf16 v[124:127], v[208:211], v[236:239], v[124:127]
    v_mfma_f32_16x16x32_bf16 v[116:119], v[212:215], v[224:227], v[116:119]
    v_mfma_f32_16x16x32_bf16 v[120:123], v[212:215], v[228:231], v[120:123]
    v_mfma_f32_16x16x32_bf16 v[124:127], v[212:215], v[232:235], v[124:127]
    v_mfma_f32_16x16x32_bf16 v[120:123], v[216:219], v[224:227], v[120:123]
    v_mfma_f32_16x16x32_bf16 v[124:127], v[216:219], v[228:231], v[124:127]
    v_mfma_f32_16x16x32_bf16 v[124:127], v[220:223], v[224:227], v[124:127]
    s_waitcnt lgkmcnt(0)
    v_mfma_f32_16x16x32_bf16 v[96:99], v[128:131], v[160:163], v[96:99]
    ds_read2_b32 v[192:193], v28 offset0:80 offset1:81
    v_mfma_f32_16x16x32_bf16 v[100:103], v[128:131], v[164:167], v[100:103]
    ds_read2_b32 v[194:195], v28 offset0:82 offset1:83
    v_mfma_f32_16x16x32_bf16 v[104:107], v[128:131], v[168:171], v[104:107]
    ds_read_b128 v[224:227], v32 offset:3904
    v_mfma_f32_16x16x32_bf16 v[108:111], v[128:131], v[172:175], v[108:111]
    ds_read2_b32 v[196:197], v28 offset0:208 offset1:209
    v_mfma_f32_16x16x32_bf16 v[112:115], v[128:131], v[176:179], v[112:115]
    ds_read2_b32 v[198:199], v28 offset0:210 offset1:211
    v_mfma_f32_16x16x32_bf16 v[116:119], v[128:131], v[180:183], v[116:119]
    ds_read_b128 v[228:231], v32 offset:3392
    v_mfma_f32_16x16x32_bf16 v[120:123], v[128:131], v[184:187], v[120:123]
    ds_read2_b32 v[200:201], v29 offset0:80 offset1:81
    v_mfma_f32_16x16x32_bf16 v[124:127], v[128:131], v[188:191], v[124:127]
    ds_read2_b32 v[202:203], v29 offset0:82 offset1:83
    v_mfma_f32_16x16x32_bf16 v[100:103], v[132:135], v[160:163], v[100:103]
    ds_read_b128 v[232:235], v32 offset:2880
    v_mfma_f32_16x16x32_bf16 v[104:107], v[132:135], v[164:167], v[104:107]
    ds_read2_b32 v[204:205], v29 offset0:208 offset1:209
    v_mfma_f32_16x16x32_bf16 v[108:111], v[132:135], v[168:171], v[108:111]
    ds_read2_b32 v[206:207], v29 offset0:210 offset1:211
    v_mfma_f32_16x16x32_bf16 v[112:115], v[132:135], v[172:175], v[112:115]
    ds_read_b128 v[236:239], v32 offset:2368
    v_mfma_f32_16x16x32_bf16 v[116:119], v[132:135], v[176:179], v[116:119]
    ds_read2_b32 v[208:209], v30 offset0:80 offset1:81
    v_mfma_f32_16x16x32_bf16 v[120:123], v[132:135], v[180:183], v[120:123]
    ds_read2_b32 v[210:211], v30 offset0:82 offset1:83
    v_mfma_f32_16x16x32_bf16 v[124:127], v[132:135], v[184:187], v[124:127]
    ds_read_b128 v[240:243], v32 offset:1856
    v_mfma_f32_16x16x32_bf16 v[104:107], v[136:139], v[160:163], v[104:107]
    ds_read2_b32 v[212:213], v30 offset0:208 offset1:209
    v_mfma_f32_16x16x32_bf16 v[108:111], v[136:139], v[164:167], v[108:111]
    ds_read2_b32 v[214:215], v30 offset0:210 offset1:211
    v_mfma_f32_16x16x32_bf16 v[112:115], v[136:139], v[168:171], v[112:115]
    ds_read_b128 v[244:247], v32 offset:1344
    v_mfma_f32_16x16x32_bf16 v[116:119], v[136:139], v[172:175], v[116:119]
    ds_read2_b32 v[216:217], v31 offset0:80 offset1:81
    v_mfma_f32_16x16x32_bf16 v[120:123], v[136:139], v[176:179], v[120:123]
    ds_read2_b32 v[218:219], v31 offset0:82 offset1:83
    v_mfma_f32_16x16x32_bf16 v[124:127], v[136:139], v[180:183], v[124:127]
    ds_read_b128 v[248:251], v32 offset:832
    v_mfma_f32_16x16x32_bf16 v[108:111], v[140:143], v[160:163], v[108:111]
    ds_read2_b32 v[220:221], v31 offset0:208 offset1:209
    v_mfma_f32_16x16x32_bf16 v[112:115], v[140:143], v[164:167], v[112:115]
    ds_read2_b32 v[222:223], v31 offset0:210 offset1:211
    v_mfma_f32_16x16x32_bf16 v[116:119], v[140:143], v[168:171], v[116:119]
    ds_read_b128 v[252:255], v32 offset:320
    v_mfma_f32_16x16x32_bf16 v[120:123], v[140:143], v[172:175], v[120:123]
    v_mfma_f32_16x16x32_bf16 v[124:127], v[140:143], v[176:179], v[124:127]
    v_mfma_f32_16x16x32_bf16 v[112:115], v[144:147], v[160:163], v[112:115]
    v_mfma_f32_16x16x32_bf16 v[116:119], v[144:147], v[164:167], v[116:119]
    v_mfma_f32_16x16x32_bf16 v[120:123], v[144:147], v[168:171], v[120:123]
    v_mfma_f32_16x16x32_bf16 v[124:127], v[144:147], v[172:175], v[124:127]
    v_mfma_f32_16x16x32_bf16 v[116:119], v[148:151], v[160:163], v[116:119]
    v_mfma_f32_16x16x32_bf16 v[120:123], v[148:151], v[164:167], v[120:123]
    v_mfma_f32_16x16x32_bf16 v[124:127], v[148:151], v[168:171], v[124:127]
    v_mfma_f32_16x16x32_bf16 v[120:123], v[152:155], v[160:163], v[120:123]
    v_mfma_f32_16x16x32_bf16 v[124:127], v[152:155], v[164:167], v[124:127]
    v_mfma_f32_16x16x32_bf16 v[124:127], v[156:159], v[160:163], v[124:127]
    s_waitcnt lgkmcnt(0)
    v_mfma_f32_16x16x32_bf16 v[96:99], v[192:195], v[224:227], v[96:99]
    ds_read2_b32 v[128:129], v28 offset0:96 offset1:97
    v_mfma_f32_16x16x32_bf16 v[100:103], v[192:195], v[228:231], v[100:103]
    ds_read2_b32 v[130:131], v28 offset0:98 offset1:99
    v_mfma_f32_16x16x32_bf16 v[104:107], v[192:195], v[232:235], v[104:107]
    ds_read_b128 v[160:163], v32 offset:3968
    v_mfma_f32_16x16x32_bf16 v[108:111], v[192:195], v[236:239], v[108:111]
    ds_read2_b32 v[132:133], v28 offset0:224 offset1:225
    v_mfma_f32_16x16x32_bf16 v[112:115], v[192:195], v[240:243], v[112:115]
    ds_read2_b32 v[134:135], v28 offset0:226 offset1:227
    v_mfma_f32_16x16x32_bf16 v[116:119], v[192:195], v[244:247], v[116:119]
    ds_read_b128 v[164:167], v32 offset:3456
    v_mfma_f32_16x16x32_bf16 v[120:123], v[192:195], v[248:251], v[120:123]
    ds_read2_b32 v[136:137], v29 offset0:96 offset1:97
    v_mfma_f32_16x16x32_bf16 v[124:127], v[192:195], v[252:255], v[124:127]
    ds_read2_b32 v[138:139], v29 offset0:98 offset1:99
    v_mfma_f32_16x16x32_bf16 v[100:103], v[196:199], v[224:227], v[100:103]
    ds_read_b128 v[168:171], v32 offset:2944
    v_mfma_f32_16x16x32_bf16 v[104:107], v[196:199], v[228:231], v[104:107]
    ds_read2_b32 v[140:141], v29 offset0:224 offset1:225
    v_mfma_f32_16x16x32_bf16 v[108:111], v[196:199], v[232:235], v[108:111]
    ds_read2_b32 v[142:143], v29 offset0:226 offset1:227
    v_mfma_f32_16x16x32_bf16 v[112:115], v[196:199], v[236:239], v[112:115]
    ds_read_b128 v[172:175], v32 offset:2432
    v_mfma_f32_16x16x32_bf16 v[116:119], v[196:199], v[240:243], v[116:119]
    ds_read2_b32 v[144:145], v30 offset0:96 offset1:97
    v_mfma_f32_16x16x32_bf16 v[120:123], v[196:199], v[244:247], v[120:123]
    ds_read2_b32 v[146:147], v30 offset0:98 offset1:99
    v_mfma_f32_16x16x32_bf16 v[124:127], v[196:199], v[248:251], v[124:127]
    ds_read_b128 v[176:179], v32 offset:1920
    v_mfma_f32_16x16x32_bf16 v[104:107], v[200:203], v[224:227], v[104:107]
    ds_read2_b32 v[148:149], v30 offset0:224 offset1:225
    v_mfma_f32_16x16x32_bf16 v[108:111], v[200:203], v[228:231], v[108:111]
    ds_read2_b32 v[150:151], v30 offset0:226 offset1:227
    v_mfma_f32_16x16x32_bf16 v[112:115], v[200:203], v[232:235], v[112:115]
    ds_read_b128 v[180:183], v32 offset:1408
    v_mfma_f32_16x16x32_bf16 v[116:119], v[200:203], v[236:239], v[116:119]
    ds_read2_b32 v[152:153], v31 offset0:96 offset1:97
    v_mfma_f32_16x16x32_bf16 v[120:123], v[200:203], v[240:243], v[120:123]
    ds_read2_b32 v[154:155], v31 offset0:98 offset1:99
    v_mfma_f32_16x16x32_bf16 v[124:127], v[200:203], v[244:247], v[124:127]
    ds_read_b128 v[184:187], v32 offset:896
    v_mfma_f32_16x16x32_bf16 v[108:111], v[204:207], v[224:227], v[108:111]
    ds_read2_b32 v[156:157], v31 offset0:224 offset1:225
    v_mfma_f32_16x16x32_bf16 v[112:115], v[204:207], v[228:231], v[112:115]
    ds_read2_b32 v[158:159], v31 offset0:226 offset1:227
    v_mfma_f32_16x16x32_bf16 v[116:119], v[204:207], v[232:235], v[116:119]
    ds_read_b128 v[188:191], v32 offset:384
    v_mfma_f32_16x16x32_bf16 v[120:123], v[204:207], v[236:239], v[120:123]
    v_mfma_f32_16x16x32_bf16 v[124:127], v[204:207], v[240:243], v[124:127]
    v_mfma_f32_16x16x32_bf16 v[112:115], v[208:211], v[224:227], v[112:115]
    v_mfma_f32_16x16x32_bf16 v[116:119], v[208:211], v[228:231], v[116:119]
    v_mfma_f32_16x16x32_bf16 v[120:123], v[208:211], v[232:235], v[120:123]
    v_mfma_f32_16x16x32_bf16 v[124:127], v[208:211], v[236:239], v[124:127]
    v_mfma_f32_16x16x32_bf16 v[116:119], v[212:215], v[224:227], v[116:119]
    v_mfma_f32_16x16x32_bf16 v[120:123], v[212:215], v[228:231], v[120:123]
    v_mfma_f32_16x16x32_bf16 v[124:127], v[212:215], v[232:235], v[124:127]
    v_mfma_f32_16x16x32_bf16 v[120:123], v[216:219], v[224:227], v[120:123]
    v_mfma_f32_16x16x32_bf16 v[124:127], v[216:219], v[228:231], v[124:127]
    v_mfma_f32_16x16x32_bf16 v[124:127], v[220:223], v[224:227], v[124:127]
    s_waitcnt lgkmcnt(0)
    v_mfma_f32_16x16x32_bf16 v[96:99], v[128:131], v[160:163], v[96:99]
    ds_read2_b32 v[192:193], v28 offset0:112 offset1:113
    v_mfma_f32_16x16x32_bf16 v[100:103], v[128:131], v[164:167], v[100:103]
    ds_read2_b32 v[194:195], v28 offset0:114 offset1:115
    v_mfma_f32_16x16x32_bf16 v[104:107], v[128:131], v[168:171], v[104:107]
    ds_read_b128 v[224:227], v32 offset:4032
    v_mfma_f32_16x16x32_bf16 v[108:111], v[128:131], v[172:175], v[108:111]
    ds_read2_b32 v[196:197], v28 offset0:240 offset1:241
    v_mfma_f32_16x16x32_bf16 v[112:115], v[128:131], v[176:179], v[112:115]
    ds_read2_b32 v[198:199], v28 offset0:242 offset1:243
    v_mfma_f32_16x16x32_bf16 v[116:119], v[128:131], v[180:183], v[116:119]
    ds_read_b128 v[228:231], v32 offset:3520
    v_mfma_f32_16x16x32_bf16 v[120:123], v[128:131], v[184:187], v[120:123]
    ds_read2_b32 v[200:201], v29 offset0:112 offset1:113
    v_mfma_f32_16x16x32_bf16 v[124:127], v[128:131], v[188:191], v[124:127]
    ds_read2_b32 v[202:203], v29 offset0:114 offset1:115
    v_mfma_f32_16x16x32_bf16 v[100:103], v[132:135], v[160:163], v[100:103]
    ds_read_b128 v[232:235], v32 offset:3008
    v_mfma_f32_16x16x32_bf16 v[104:107], v[132:135], v[164:167], v[104:107]
    ds_read2_b32 v[204:205], v29 offset0:240 offset1:241
    v_mfma_f32_16x16x32_bf16 v[108:111], v[132:135], v[168:171], v[108:111]
    ds_read2_b32 v[206:207], v29 offset0:242 offset1:243
    v_mfma_f32_16x16x32_bf16 v[112:115], v[132:135], v[172:175], v[112:115]
    ds_read_b128 v[236:239], v32 offset:2496
    v_mfma_f32_16x16x32_bf16 v[116:119], v[132:135], v[176:179], v[116:119]
    ds_read2_b32 v[208:209], v30 offset0:112 offset1:113
    v_mfma_f32_16x16x32_bf16 v[120:123], v[132:135], v[180:183], v[120:123]
    ds_read2_b32 v[210:211], v30 offset0:114 offset1:115
    v_mfma_f32_16x16x32_bf16 v[124:127], v[132:135], v[184:187], v[124:127]
    ds_read_b128 v[240:243], v32 offset:1984
    v_mfma_f32_16x16x32_bf16 v[104:107], v[136:139], v[160:163], v[104:107]
    ds_read2_b32 v[212:213], v30 offset0:240 offset1:241
    v_mfma_f32_16x16x32_bf16 v[108:111], v[136:139], v[164:167], v[108:111]
    ds_read2_b32 v[214:215], v30 offset0:242 offset1:243
    v_mfma_f32_16x16x32_bf16 v[112:115], v[136:139], v[168:171], v[112:115]
    ds_read_b128 v[244:247], v32 offset:1472
    v_mfma_f32_16x16x32_bf16 v[116:119], v[136:139], v[172:175], v[116:119]
    ds_read2_b32 v[216:217], v31 offset0:112 offset1:113
    v_mfma_f32_16x16x32_bf16 v[120:123], v[136:139], v[176:179], v[120:123]
    ds_read2_b32 v[218:219], v31 offset0:114 offset1:115
    v_mfma_f32_16x16x32_bf16 v[124:127], v[136:139], v[180:183], v[124:127]
    ds_read_b128 v[248:251], v32 offset:960
    v_mfma_f32_16x16x32_bf16 v[108:111], v[140:143], v[160:163], v[108:111]
    ds_read2_b32 v[220:221], v31 offset0:240 offset1:241
    v_mfma_f32_16x16x32_bf16 v[112:115], v[140:143], v[164:167], v[112:115]
    ds_read2_b32 v[222:223], v31 offset0:242 offset1:243
    v_mfma_f32_16x16x32_bf16 v[116:119], v[140:143], v[168:171], v[116:119]
    ds_read_b128 v[252:255], v32 offset:448
    v_mfma_f32_16x16x32_bf16 v[120:123], v[140:143], v[172:175], v[120:123]
    v_mfma_f32_16x16x32_bf16 v[124:127], v[140:143], v[176:179], v[124:127]
    v_mfma_f32_16x16x32_bf16 v[112:115], v[144:147], v[160:163], v[112:115]
    v_mfma_f32_16x16x32_bf16 v[116:119], v[144:147], v[164:167], v[116:119]
    v_mfma_f32_16x16x32_bf16 v[120:123], v[144:147], v[168:171], v[120:123]
    v_mfma_f32_16x16x32_bf16 v[124:127], v[144:147], v[172:175], v[124:127]
    v_mfma_f32_16x16x32_bf16 v[116:119], v[148:151], v[160:163], v[116:119]
    v_mfma_f32_16x16x32_bf16 v[120:123], v[148:151], v[164:167], v[120:123]
    v_mfma_f32_16x16x32_bf16 v[124:127], v[148:151], v[168:171], v[124:127]
    v_mfma_f32_16x16x32_bf16 v[120:123], v[152:155], v[160:163], v[120:123]
    v_mfma_f32_16x16x32_bf16 v[124:127], v[152:155], v[164:167], v[124:127]
    v_mfma_f32_16x16x32_bf16 v[124:127], v[156:159], v[160:163], v[124:127]
    s_waitcnt lgkmcnt(0)
    v_mfma_f32_16x16x32_bf16 v[96:99], v[192:195], v[224:227], v[96:99]
    v_mfma_f32_16x16x32_bf16 v[100:103], v[192:195], v[228:231], v[100:103]
    v_mfma_f32_16x16x32_bf16 v[104:107], v[192:195], v[232:235], v[104:107]
    v_mfma_f32_16x16x32_bf16 v[108:111], v[192:195], v[236:239], v[108:111]
    v_mfma_f32_16x16x32_bf16 v[112:115], v[192:195], v[240:243], v[112:115]
    v_mfma_f32_16x16x32_bf16 v[116:119], v[192:195], v[244:247], v[116:119]
    v_mfma_f32_16x16x32_bf16 v[120:123], v[192:195], v[248:251], v[120:123]
    v_mfma_f32_16x16x32_bf16 v[124:127], v[192:195], v[252:255], v[124:127]
    v_mfma_f32_16x16x32_bf16 v[100:103], v[196:199], v[224:227], v[100:103]
    v_mfma_f32_16x16x32_bf16 v[104:107], v[196:199], v[228:231], v[104:107]
    v_mfma_f32_16x16x32_bf16 v[108:111], v[196:199], v[232:235], v[108:111]
    v_mfma_f32_16x16x32_bf16 v[112:115], v[196:199], v[236:239], v[112:115]
    v_mfma_f32_16x16x32_bf16 v[116:119], v[196:199], v[240:243], v[116:119]
    v_mfma_f32_16x16x32_bf16 v[120:123], v[196:199], v[244:247], v[120:123]
    v_mfma_f32_16x16x32_bf16 v[124:127], v[196:199], v[248:251], v[124:127]
    v_mfma_f32_16x16x32_bf16 v[104:107], v[200:203], v[224:227], v[104:107]
    v_mfma_f32_16x16x32_bf16 v[108:111], v[200:203], v[228:231], v[108:111]
    v_mfma_f32_16x16x32_bf16 v[112:115], v[200:203], v[232:235], v[112:115]
    v_mfma_f32_16x16x32_bf16 v[116:119], v[200:203], v[236:239], v[116:119]
    v_mfma_f32_16x16x32_bf16 v[120:123], v[200:203], v[240:243], v[120:123]
    v_mfma_f32_16x16x32_bf16 v[124:127], v[200:203], v[244:247], v[124:127]
    v_mfma_f32_16x16x32_bf16 v[108:111], v[204:207], v[224:227], v[108:111]
    v_mfma_f32_16x16x32_bf16 v[112:115], v[204:207], v[228:231], v[112:115]
    v_mfma_f32_16x16x32_bf16 v[116:119], v[204:207], v[232:235], v[116:119]
    v_mfma_f32_16x16x32_bf16 v[120:123], v[204:207], v[236:239], v[120:123]
    v_mfma_f32_16x16x32_bf16 v[124:127], v[204:207], v[240:243], v[124:127]
    v_mfma_f32_16x16x32_bf16 v[112:115], v[208:211], v[224:227], v[112:115]
    v_mfma_f32_16x16x32_bf16 v[116:119], v[208:211], v[228:231], v[116:119]
    v_mfma_f32_16x16x32_bf16 v[120:123], v[208:211], v[232:235], v[120:123]
    v_mfma_f32_16x16x32_bf16 v[124:127], v[208:211], v[236:239], v[124:127]
    v_mfma_f32_16x16x32_bf16 v[116:119], v[212:215], v[224:227], v[116:119]
    v_mfma_f32_16x16x32_bf16 v[120:123], v[212:215], v[228:231], v[120:123]
    v_mfma_f32_16x16x32_bf16 v[124:127], v[212:215], v[232:235], v[124:127]
    v_mfma_f32_16x16x32_bf16 v[120:123], v[216:219], v[224:227], v[120:123]
    v_mfma_f32_16x16x32_bf16 v[124:127], v[216:219], v[228:231], v[124:127]
    v_mfma_f32_16x16x32_bf16 v[124:127], v[220:223], v[224:227], v[124:127]
    s_setprio 0
    v_cvt_pk_bf16_f32 v192, v96, v97
    v_cvt_pk_bf16_f32 v193, v98, v99
    v_cvt_pk_bf16_f32 v194, v100, v101
    v_cvt_pk_bf16_f32 v195, v102, v103
    v_cvt_pk_bf16_f32 v196, v104, v105
    v_cvt_pk_bf16_f32 v197, v106, v107
    v_cvt_pk_bf16_f32 v198, v108, v109
    v_cvt_pk_bf16_f32 v199, v110, v111
    v_cvt_pk_bf16_f32 v200, v112, v113
    v_cvt_pk_bf16_f32 v201, v114, v115
    v_cvt_pk_bf16_f32 v202, v116, v117
    v_cvt_pk_bf16_f32 v203, v118, v119
    v_cvt_pk_bf16_f32 v204, v120, v121
    v_cvt_pk_bf16_f32 v205, v122, v123
    v_cvt_pk_bf16_f32 v206, v124, v125
    v_cvt_pk_bf16_f32 v207, v126, v127
    v_permlane16_swap_b32 v192, v194
    v_permlane16_swap_b32 v193, v195
    v_permlane16_swap_b32 v196, v198
    v_permlane16_swap_b32 v197, v199
    v_permlane16_swap_b32 v200, v202
    v_permlane16_swap_b32 v201, v203
    v_permlane16_swap_b32 v204, v206
    v_permlane16_swap_b32 v205, v207
    ds_bpermute_b32 v192, v17, v192
    ds_bpermute_b32 v193, v17, v193
    ds_bpermute_b32 v194, v17, v194
    ds_bpermute_b32 v195, v17, v195
    ds_bpermute_b32 v196, v17, v196
    ds_bpermute_b32 v197, v17, v197
    ds_bpermute_b32 v198, v17, v198
    ds_bpermute_b32 v199, v17, v199
    ds_bpermute_b32 v200, v17, v200
    ds_bpermute_b32 v201, v17, v201
    ds_bpermute_b32 v202, v17, v202
    ds_bpermute_b32 v203, v17, v203
    ds_bpermute_b32 v204, v17, v204
    ds_bpermute_b32 v205, v17, v205
    ds_bpermute_b32 v206, v17, v206
    ds_bpermute_b32 v207, v17, v207
    ds_read_b32 v60, v21 offset:72
    s_waitcnt lgkmcnt(0)
    v_cmp_eq_u32 vcc, 1, v60
    s_cbranch_vccnz L_zp
    s_mov_b32 s13, 0
    buffer_store_dwordx4 v[192:195], v26, s[56:59], s36 offen offset:0 sc1
    buffer_store_dwordx4 v[196:199], v26, s[56:59], s36 offen offset:1024 sc1
    buffer_store_dwordx4 v[200:203], v26, s[56:59], s36 offen offset:2048 sc1
    buffer_store_dwordx4 v[204:207], v26, s[56:59], s36 offen offset:3072 sc1
    s_branch L_zq
L_zp:
    s_mov_b32 s13, 1
    buffer_store_dwordx4 v[192:195], v26, s[56:59], s36 offen offset:0
    buffer_store_dwordx4 v[196:199], v26, s[56:59], s36 offen offset:1024
    buffer_store_dwordx4 v[200:203], v26, s[56:59], s36 offen offset:2048
    buffer_store_dwordx4 v[204:207], v26, s[56:59], s36 offen offset:3072
L_zq:
    v_add_u32 v33, s101, v26
    s_waitcnt vmcnt(4)
    ds_write_b128 v33, v[64:67] offset:0
    ds_write_b128 v33, v[68:71] offset:1024
    ds_write_b128 v33, v[72:75] offset:2048
    ds_write_b128 v33, v[76:79] offset:3072
    ds_write_b128 v33, v[80:83] offset:4096
    ds_write_b128 v33, v[84:87] offset:5120
    ds_write_b128 v33, v[88:91] offset:6144
    ds_write_b128 v33, v[92:95] offset:7168
    ds_write_b128 v33, v[40:43] offset:8192
    ds_write_b128 v33, v[44:47] offset:9216
    ds_write_b128 v33, v[48:51] offset:10240
    ds_write_b128 v33, v[52:55] offset:11264
    v_mov_b32 v60, 1
    s_mov_b64 exec, 1
    ds_add_u32 v21, v60 offset:68
    s_mov_b64 exec, -1
    s_lshl_b32 s12, s100, 3
    s_add_u32 s12, s12, 8192
    v_lshlrev_b32 v28, 1, v23
    v_lshl_add_u32 v28, v24, 12, v28
    v_lshlrev_b32 v29, 2, v24
    v_lshl_add_u32 v29, v23, 13, v29
    v_lshrrev_b32 v60, 3, v2
    v_and_b32 v61, 7, v2
    v_lshl_add_u32 v28, v60, 2, s35
    v_lshlrev_b32 v28, 12, v28
    v_lshl_add_u32 v28, v61, 4, v28
    s_lshl_b32 s10, s5, 7
    v_add_u32 v28, s10, v28
    v_lshl_add_u32 v30, v61, 3, v60
    v_lshlrev_b32 v30, 2, v30
    s_waitcnt vmcnt(0)
    s_mov_b64 exec, 1
    s_cmp_eq_u32 s13, 1
    s_cbranch_scc0 L_xf2
    buffer_store_dwordx2 v[0:1], v19, s[72:75], s12 offen
    s_branch L_xf3
L_xf2:
    buffer_store_dwordx2 v[0:1], v19, s[72:75], s12 offen sc1
L_xf3:
    s_mov_b64 exec, -1
    s_mov_b32 s15, 0
L_zw_w:
    ds_read_b128 v[60:63], v21 offset:0
    s_waitcnt lgkmcnt(0)
    v_min3_u32 v60, v60, v61, v62
    v_min_u32 v60, v60, v63
    v_cmp_gt_u32 vcc, 24, v60
    s_cbranch_vccz L_zw_ok
    s_sleep 4
    s_add_u32 s15, s15, 1
    s_cmp_lt_u32 s15, 160000
    s_cbranch_scc1 L_zw_w
L_zw_ok:
    s_cmp_eq_u32 s8, 0
    s_cbranch_scc0 L_z1
    s_mov_b32 s15, 0
LZ_poll:
    buffer_load_dwordx4 v[60:63], v3, s[72:75], 0 offen sc1
    s_waitcnt vmcnt(0)
LZ_chk:
    v_cmp_ne_u64 vcc, v[60:61], v[0:1]
    v_cmp_ne_u64 s[10:11], v[62:63], v[0:1]
    s_or_b64 vcc, vcc, s[10:11]
    s_cbranch_scc0 LZ_ok
    s_sleep 4
    s_add_u32 s15, s15, 1
    s_cmp_lt_u32 s15, 20000
    s_cbranch_scc1 LZ_poll
LZ_ok:
    ds_write_b32 v21, v25 offset:48
L_z1:
    s_waitcnt vmcnt(0)
    v_lshlrev_b32 v128, 16, v4
    v_and_b32 v129, 0xffff0000, v4
    v_lshlrev_b32 v130, 16, v5
    v_and_b32 v131, 0xffff0000, v5
    v_lshlrev_b32 v132, 16, v6
    v_and_b32 v133, 0xffff0000, v6
    v_lshlrev_b32 v134, 16, v7
    v_and_b32 v135, 0xffff0000, v7
    v_lshlrev_b32 v136, 16, v8
    v_and_b32 v137, 0xffff0000, v8
    v_lshlrev_b32 v138, 16, v9
    v_and_b32 v139, 0xffff0000, v9
    v_lshlrev_b32 v140, 16, v10
    v_and_b32 v141, 0xffff0000, v10
    v_lshlrev_b32 v142, 16, v11
    v_and_b32 v143, 0xffff0000, v11
    v_lshlrev_b32 v144, 16, v14
    v_and_b32 v145, 0xffff0000, v14
    v_lshlrev_b32 v146, 16, v15
    v_and_b32 v147, 0xffff0000, v15
    v_lshlrev_b32 v148, 16, v56
    v_and_b32 v149, 0xffff0000, v56
    v_lshlrev_b32 v150, 16, v57
    v_and_b32 v151, 0xffff0000, v57
    v_lshlrev_b32 v152, 16, v58
    v_and_b32 v153, 0xffff0000, v58
    v_lshlrev_b32 v154, 16, v59
    v_and_b32 v155, 0xffff0000, v59
    v_lshlrev_b32 v156, 16, v34
    v_and_b32 v157, 0xffff0000, v34
    v_lshlrev_b32 v158, 16, v35
    v_and_b32 v159, 0xffff0000, v35
    s_mov_b32 s15, 0
L_fz_w:
    ds_read_b32 v60, v21 offset:48
    s_waitcnt lgkmcnt(0)
    v_cmp_gt_u32 vcc, 1, v60
    s_cbranch_vccz L_fz_ok
    s_sleep 1
    s_add_u32 s15, s15, 1
    s_cmp_lt_u32 s15, 160000
    s_cbranch_scc1 L_fz_w
L_fz_ok:
    buffer_load_dwordx4 v[64:67], v28, s[56:59], 0 offen sc1
    buffer_load_dwordx4 v[68:71], v28, s[56:59], s32 offen sc1
    buffer_load_dwordx4 v[72:75], v28, s[56:59], s33 offen sc1
    buffer_load_dwordx4 v[76:79], v28, s[56:59], s34 offen sc1
    s_waitcnt vmcnt(3)
    ds_bpermute_b32 v64, v30, v64
    ds_bpermute_b32 v65, v30, v65
    ds_bpermute_b32 v66, v30, v66
    ds_bpermute_b32 v67, v30, v67
    s_waitcnt vmcnt(2)
    ds_bpermute_b32 v68, v30, v68
    ds_bpermute_b32 v69, v30, v69
    ds_bpermute_b32 v70, v30, v70
    ds_bpermute_b32 v71, v30, v71
    s_waitcnt vmcnt(1)
    ds_bpermute_b32 v72, v30, v72
    ds_bpermute_b32 v73, v30, v73
    ds_bpermute_b32 v74, v30, v74
    ds_bpermute_b32 v75, v30, v75
    s_waitcnt vmcnt(0)
    ds_bpermute_b32 v76, v30, v76
    ds_bpermute_b32 v77, v30, v77
    ds_bpermute_b32 v78, v30, v78
    ds_bpermute_b32 v79, v30, v79
    s_waitcnt lgkmcnt(0)
    s_waitcnt vmcnt(0)
    v_lshlrev_b32 v160, 16, v64
    v_lshlrev_b32 v161, 16, v68
    v_lshlrev_b32 v162, 16, v72
    v_lshlrev_b32 v163, 16, v76
    v_mul_f32 v160, v160, v128
    v_mul_f32 v161, v161, v129
    v_mul_f32 v162, v162, v130
    v_mul_f32 v163, v163, v131
    s_mov_b32 s10, 0
    buffer_store_dwordx4 v[160:163], v29, s[64:67], s10 offen nt
    v_and_b32 v164, 0xffff0000, v64
    v_and_b32 v165, 0xffff0000, v68
    v_and_b32 v166, 0xffff0000, v72
    v_and_b32 v167, 0xffff0000, v76
    v_mul_f32 v164, v164, v132
    v_mul_f32 v165, v165, v133
    v_mul_f32 v166, v166, v134
    v_mul_f32 v167, v167, v135
    s_mov_b32 s10, 8192
    buffer_store_dwordx4 v[164:167], v29, s[64:67], s10 offen nt
    v_lshlrev_b32 v168, 16, v65
    v_lshlrev_b32 v169, 16, v69
    v_lshlrev_b32 v170, 16, v73
    v_lshlrev_b32 v171, 16, v77
    v_mul_f32 v168, v168, v136
    v_mul_f32 v169, v169, v137
    v_mul_f32 v170, v170, v138
    v_mul_f32 v171, v171, v139
    s_mov_b32 s10, 16384
    buffer_store_dwordx4 v[168:171], v29, s[64:67], s10 offen nt
    v_and_b32 v172, 0xffff0000, v65
    v_and_b32 v173, 0xffff0000, v69
    v_and_b32 v174, 0xffff0000, v73
    v_and_b32 v175, 0xffff0000, v77
    v_mul_f32 v172, v172, v140
    v_mul_f32 v173, v173, v141
    v_mul_f32 v174, v174, v142
    v_mul_f32 v175, v175, v143
    s_mov_b32 s10, 24576
    buffer_store_dwordx4 v[172:175], v29, s[64:67], s10 offen nt
    v_lshlrev_b32 v176, 16, v66
    v_lshlrev_b32 v177, 16, v70
    v_lshlrev_b32 v178, 16, v74
    v_lshlrev_b32 v179, 16, v78
    v_mul_f32 v176, v176, v144
    v_mul_f32 v177, v177, v145
    v_mul_f32 v178, v178, v146
    v_mul_f32 v179, v179, v147
    s_mov_b32 s10, 32768
    buffer_store_dwordx4 v[176:179], v29, s[64:67], s10 offen nt
    v_and_b32 v180, 0xffff0000, v66
    v_and_b32 v181, 0xffff0000, v70
    v_and_b32 v182, 0xffff0000, v74
    v_and_b32 v183, 0xffff0000, v78
    v_mul_f32 v180, v180, v148
    v_mul_f32 v181, v181, v149
    v_mul_f32 v182, v182, v150
    v_mul_f32 v183, v183, v151
    s_mov_b32 s10, 40960
    buffer_store_dwordx4 v[180:183], v29, s[64:67], s10 offen nt
    v_lshlrev_b32 v184, 16, v67
    v_lshlrev_b32 v185, 16, v71
    v_lshlrev_b32 v186, 16, v75
    v_lshlrev_b32 v187, 16, v79
    v_mul_f32 v184, v184, v152
    v_mul_f32 v185, v185, v153
    v_mul_f32 v186, v186, v154
    v_mul_f32 v187, v187, v155
    s_mov_b32 s10, 49152
    buffer_store_dwordx4 v[184:187], v29, s[64:67], s10 offen nt
    v_and_b32 v188, 0xffff0000, v67
    v_and_b32 v189, 0xffff0000, v71
    v_and_b32 v190, 0xffff0000, v75
    v_and_b32 v191, 0xffff0000, v79
    v_mul_f32 v188, v188, v156
    v_mul_f32 v189, v189, v157
    v_mul_f32 v190, v190, v158
    v_mul_f32 v191, v191, v159
    s_mov_b32 s10, 57344
    buffer_store_dwordx4 v[188:191], v29, s[64:67], s10 offen nt
    s_waitcnt vmcnt(0)
    s_endpgm
Y_G:
    s_setprio 0
    v_and_b32 v3, 31, v2
    v_mov_b32 v23, 0
    v_mov_b32 v11, 163712
    v_lshrrev_b32 v4, 5, v2
    s_lshr_b32 s8, s3, 1
    s_and_b32 s9, s3, 1
    s_lshl_b32 s10, s7, 6
    s_lshl_b32 s11, s9, 5
    s_add_u32 s10, s10, s11
    v_add_u32 v5, s10, v3
    v_lshlrev_b32 v48, 1, v5
    s_lshl_b32 s10, s7, 7
    v_and_b32 v49, 15, v2
    v_lshl_add_u32 v49, v49, 3, s10
    s_lshl_b32 s10, s3, 2
    s_add_u32 s10, s10, 163712
    v_mov_b32 v10, s10
    s_waitcnt lgkmcnt(0)
    s_mov_b32 s76, s48
    s_mov_b32 s77, s49
    s_mov_b32 s78, 256
    s_mov_b32 s79, 0x00020000
    s_or_b32 s10, s2, s3
    s_cmp_eq_u32 s10, 0
    s_cbranch_scc0 G_nononce
    s_memrealtime s[10:11]
    s_waitcnt lgkmcnt(0)
    s_or_b32 s10, s10, 1
    v_mov_b32 v54, s10
    v_mov_b32 v55, s11
    s_mov_b64 exec, 1
    buffer_store_dwordx2 v[54:55], v23, s[76:79], 0 offen sc1
    s_mov_b64 exec, -1
G_nononce:
    s_mov_b32 s52, s42
    s_mov_b32 s53, s43
    s_mov_b32 s54, 2048
    s_mov_b32 s55, 0x00020000
    buffer_load_ushort v12, v48, s[52:55], 0 offen
    s_mov_b32 s52, s30
    s_mov_b32 s53, s31
    buffer_load_ushort v13, v48, s[52:55], 0 offen
    s_mov_b32 s52, s32
    s_mov_b32 s53, s33
    buffer_load_ushort v14, v48, s[52:55], 0 offen
    s_mov_b32 s52, s44
    s_mov_b32 s53, s45
    buffer_load_dwordx2 v[24:25], v49, s[52:55], 0 offen
    s_mov_b32 s52, s28
    s_mov_b32 s53, s29
    s_mov_b32 s54, 4194304
    s_mov_b32 s55, 0x00020000
    s_mov_b32 s60, s46
    s_mov_b32 s61, s47
    s_mov_b32 s62, 16777216
    s_mov_b32 s63, 0x00020000
    s_add_u32 s64, s50, 16777216
    s_addc_u32 s65, s51, 0
    s_mov_b32 s66, 278528
    s_mov_b32 s67, 0x00020000
    s_add_u32 s68, s50, 8388608
    s_addc_u32 s69, s51, 0
    s_mov_b32 s70, 8388608
    s_mov_b32 s71, 0x00020000
    s_add_u32 s72, s50, 17825792
    s_addc_u32 s73, s51, 0
    s_mov_b32 s74, 65536
    s_mov_b32 s75, 0x00020000
    s_cmp_eq_u32 s9, 1
    s_cselect_b32 s80, s40, s38
    s_cselect_b32 s81, s41, s39
    s_mov_b32 s82, 2097152
    s_mov_b32 s83, 0x00020000
    s_lshl_b32 s10, s6, 7
    s_lshl_b32 s11, s3, 5
    s_add_u32 s10, s10, s11
    v_lshrrev_b32 v50, 4, v2
    v_lshl_add_u32 v50, v50, 2, s10
    v_lshl_add_u32 v22, v50, 11, v49
    v_xor_b32 v50, 1, v4
    v_lshlrev_b32 v50, 14, v50
    v_lshl_add_u32 v53, v5, 4, v50
    v_lshlrev_b32 v26, 4, v2
    v_add_u32 v27, 4096, v26
    v_lshrrev_b32 v50, 1, v3
    v_and_b32 v50, 7, v50
    v_xor_b32 v50, v50, v4
    v_lshlrev_b32 v50, 4, v50
    v_lshl_add_u32 v50, v3, 7, v50
    s_lshl_b32 s10, s8, 13
    s_lshl_b32 s11, s9, 13
    s_add_u32 s11, s11, 16384
    v_add_u32 v32, s10, v50
    v_add_u32 v36, s11, v50
    v_xor_b32 v33, 32, v32
    v_xor_b32 v37, 32, v36
    v_xor_b32 v34, 64, v32
    v_xor_b32 v38, 64, v36
    v_xor_b32 v35, 96, v32
    v_xor_b32 v39, 96, v36
    v_add_u32 v40, 65536, v32
    v_add_u32 v41, 65536, v33
    v_add_u32 v42, 65536, v34
    v_add_u32 v43, 65536, v35
    v_add_u32 v44, 65536, v36
    v_add_u32 v45, 65536, v37
    v_add_u32 v46, 65536, v38
    v_add_u32 v47, 65536, v39
    v_mov_b32 v64, 0
    v_mov_b32 v65, 0
    v_mov_b32 v66, 0
    v_mov_b32 v67, 0
    v_mov_b32 v68, 0
    v_mov_b32 v69, 0
    v_mov_b32 v70, 0
    v_mov_b32 v71, 0
    v_mov_b32 v72, 0
    v_mov_b32 v73, 0
    v_mov_b32 v74, 0
    v_mov_b32 v75, 0
    v_mov_b32 v76, 0
    v_mov_b32 v77, 0
    v_mov_b32 v78, 0
    v_mov_b32 v79, 0
    v_mov_b32 v80, 0
    v_mov_b32 v81, 0
    v_mov_b32 v82, 0
    v_mov_b32 v83, 0
    v_mov_b32 v84, 0
    v_mov_b32 v85, 0
    v_mov_b32 v86, 0
    v_mov_b32 v87, 0
    v_mov_b32 v88, 0
    v_mov_b32 v89, 0
    v_mov_b32 v90, 0
    v_mov_b32 v91, 0
    v_mov_b32 v92, 0
    v_mov_b32 v93, 0
    v_mov_b32 v94, 0
    v_mov_b32 v95, 0
    v_mov_b32 v96, 0
    v_mov_b32 v97, 0
    v_mov_b32 v98, 0
    v_mov_b32 v99, 0
    v_mov_b32 v100, 0
    v_mov_b32 v101, 0
    v_mov_b32 v102, 0
    v_mov_b32 v103, 0
    v_mov_b32 v104, 0
    v_mov_b32 v105, 0
    v_mov_b32 v106, 0
    v_mov_b32 v107, 0
    v_mov_b32 v108, 0
    v_mov_b32 v109, 0
    v_mov_b32 v110, 0
    v_mov_b32 v111, 0
    v_mov_b32 v112, 0
    v_mov_b32 v113, 0
    v_mov_b32 v114, 0
    v_mov_b32 v115, 0
    v_mov_b32 v116, 0
    v_mov_b32 v117, 0
    v_mov_b32 v118, 0
    v_mov_b32 v119, 0
    v_mov_b32 v120, 0
    v_mov_b32 v121, 0
    v_mov_b32 v122, 0
    v_mov_b32 v123, 0
    v_mov_b32 v124, 0
    v_mov_b32 v125, 0
    v_mov_b32 v126, 0
    v_mov_b32 v127, 0
    s_lshl_b32 s10, s8, 10
    s_lshl_b32 s11, s9, 9
    s_add_u32 s10, s10, s11
    s_add_u32 s10, s10, 151552
    v_lshl_add_u32 v0, v3, 4, s10
    v_xor_b32 v1, 1024, v0
    s_lshl_b32 s10, s8, 1
    s_sub_i32 s10, s6, s10
    v_sub_u32 v56, s10, v4
    v_add_u32 v57, 0, v56
    v_max_i32 v57, 0, v57
    v_lshlrev_b32 v57, 14, v57
    v_lshl_add_u32 v60, v5, 4, v57
    v_add_u32 v57, -4, v56
    v_max_i32 v57, 0, v57
    v_lshlrev_b32 v57, 14, v57
    v_lshl_add_u32 v61, v5, 4, v57
    v_add_u32 v57, -8, v56
    v_max_i32 v57, 0, v57
    v_lshlrev_b32 v57, 14, v57
    v_lshl_add_u32 v62, v5, 4, v57
    v_add_u32 v57, -12, v56
    v_max_i32 v57, 0, v57
    v_lshlrev_b32 v57, 14, v57
    v_lshl_add_u32 v63, v5, 4, v57
    s_mov_b32 s15, 0
G_s0_w:
    ds_read_b64 v[48:49], v11 offset:16
    s_waitcnt lgkmcnt(0)
    v_min_u32 v48, v48, v49
    v_cmp_gt_u32 vcc, 1, v48
    s_cbranch_vccz G_s0_ok
    s_add_u32 s15, s15, 1
    s_cmp_lt_u32 s15, 160000
    s_cbranch_scc1 G_s0_w
G_s0_ok:
    ds_read_b128 v[128:131], v32 offset:0
    ds_read_b128 v[136:139], v36 offset:0
    ds_read_b128 v[140:143], v36 offset:4096
    ds_read_b128 v[132:135], v32 offset:4096
    ds_read_b128 v[144:147], v33 offset:0
    ds_read_b128 v[152:155], v37 offset:0
    ds_read_b128 v[156:159], v37 offset:4096
    ds_read_b128 v[148:151], v33 offset:4096
    ds_read_b128 v[160:163], v34 offset:0
    ds_read_b128 v[168:171], v38 offset:0
    ds_read_b128 v[172:175], v38 offset:4096
    ds_read_b128 v[164:167], v34 offset:4096
    ds_read_b128 v[176:179], v35 offset:0
    ds_read_b128 v[184:187], v39 offset:0
    ds_read_b128 v[188:191], v39 offset:4096
    ds_read_b128 v[180:183], v35 offset:4096
    ds_read_b64 v[48:49], v11 offset:16
    v_mov_b32 v52, 1
    s_mov_b32 s12, 2
    s_waitcnt lgkmcnt(0)
    ds_write_b32 v10, v52
G1_loop:
    v_mfma_f32_32x32x16_bf16 v[64:79], v[128:131], v[136:139], v[64:79]
    s_waitcnt lgkmcnt(0)
    v_min_u32 v48, v48, v49
    v_cmp_gt_u32 vcc, s12, v48
    s_cbranch_vccnz G1_slow0
G1_back0:
    ds_read_b128 v[192:195], v32 offset:32768
    ds_read_b128 v[200:203], v36 offset:32768
    v_mfma_f32_32x32x16_bf16 v[80:95], v[128:131], v[140:143], v[80:95]
    ds_read_b128 v[204:207], v36 offset:36864
    ds_read_b128 v[196:199], v32 offset:36864
    v_mfma_f32_32x32x16_bf16 v[96:111], v[132:135], v[136:139], v[96:111]
    ds_read_b128 v[208:211], v33 offset:32768
    ds_read_b128 v[216:219], v37 offset:32768
    v_mfma_f32_32x32x16_bf16 v[112:127], v[132:135], v[140:143], v[112:127]
    ds_read_b128 v[220:223], v37 offset:36864
    ds_read_b128 v[212:215], v33 offset:36864
    v_mfma_f32_32x32x16_bf16 v[64:79], v[144:147], v[152:155], v[64:79]
    ds_read_b128 v[224:227], v34 offset:32768
    ds_read_b128 v[232:235], v38 offset:32768
    v_mfma_f32_32x32x16_bf16 v[80:95], v[144:147], v[156:159], v[80:95]
    ds_read_b128 v[236:239], v38 offset:36864
    ds_read_b128 v[228:231], v34 offset:36864
    v_mfma_f32_32x32x16_bf16 v[96:111], v[148:151], v[152:155], v[96:111]
    ds_read_b128 v[240:243], v35 offset:32768
    ds_read_b128 v[248:251], v39 offset:32768
    v_mfma_f32_32x32x16_bf16 v[112:127], v[148:151], v[156:159], v[112:127]
    ds_read_b128 v[252:255], v39 offset:36864
    ds_read_b128 v[244:247], v35 offset:36864
    v_mfma_f32_32x32x16_bf16 v[64:79], v[160:163], v[168:171], v[64:79]
    v_mfma_f32_32x32x16_bf16 v[80:95], v[160:163], v[172:175], v[80:95]
    v_mfma_f32_32x32x16_bf16 v[96:111], v[164:167], v[168:171], v[96:111]
    v_mfma_f32_32x32x16_bf16 v[112:127], v[164:167], v[172:175], v[112:127]
    v_mfma_f32_32x32x16_bf16 v[64:79], v[176:179], v[184:187], v[64:79]
    v_mov_b32 v52, s12
    s_waitcnt lgkmcnt(0)
    ds_write_b32 v10, v52
    s_add_u32 s12, s12, 1
    v_mfma_f32_32x32x16_bf16 v[80:95], v[176:179], v[188:191], v[80:95]
    ds_read_b64 v[48:49], v11 offset:16
    v_mfma_f32_32x32x16_bf16 v[96:111], v[180:183], v[184:187], v[96:111]
    v_mfma_f32_32x32x16_bf16 v[112:127], v[180:183], v[188:191], v[112:127]
    v_mfma_f32_32x32x16_bf16 v[64:79], v[192:195], v[200:203], v[64:79]
    s_waitcnt lgkmcnt(0)
    v_min_u32 v48, v48, v49
    v_cmp_gt_u32 vcc, s12, v48
    s_cbranch_vccnz G1_slow1
G1_back1:
    ds_read_b128 v[128:131], v40 offset:0
    ds_read_b128 v[136:139], v44 offset:0
    v_mfma_f32_32x32x16_bf16 v[80:95], v[192:195], v[204:207], v[80:95]
    ds_read_b128 v[140:143], v44 offset:4096
    ds_read_b128 v[132:135], v40 offset:4096
    v_mfma_f32_32x32x16_bf16 v[96:111], v[196:199], v[200:203], v[96:111]
    ds_read_b128 v[144:147], v41 offset:0
    ds_read_b128 v[152:155], v45 offset:0
    v_mfma_f32_32x32x16_bf16 v[112:127], v[196:199], v[204:207], v[112:127]
    ds_read_b128 v[156:159], v45 offset:4096
    ds_read_b128 v[148:151], v41 offset:4096
    v_mfma_f32_32x32x16_bf16 v[64:79], v[208:211], v[216:219], v[64:79]
    ds_read_b128 v[160:163], v42 offset:0
    ds_read_b128 v[168:171], v46 offset:0
    v_mfma_f32_32x32x16_bf16 v[80:95], v[208:211], v[220:223], v[80:95]
    ds_read_b128 v[172:175], v46 offset:4096
    ds_read_b128 v[164:167], v42 offset:4096
    v_mfma_f32_32x32x16_bf16 v[96:111], v[212:215], v[216:219], v[96:111]
    ds_read_b128 v[176:179], v43 offset:0
    ds_read_b128 v[184:187], v47 offset:0
    v_mfma_f32_32x32x16_bf16 v[112:127], v[212:215], v[220:223], v[112:127]
    ds_read_b128 v[188:191], v47 offset:4096
    ds_read_b128 v[180:183], v43 offset:4096
    v_mfma_f32_32x32x16_bf16 v[64:79], v[224:227], v[232:235], v[64:79]
    v_mfma_f32_32x32x16_bf16 v[80:95], v[224:227], v[236:239], v[80:95]
    v_mfma_f32_32x32x16_bf16 v[96:111], v[228:231], v[232:235], v[96:111]
    v_mfma_f32_32x32x16_bf16 v[112:127], v[228:231], v[236:239], v[112:127]
    v_mfma_f32_32x32x16_bf16 v[64:79], v[240:243], v[248:251], v[64:79]
    v_mov_b32 v52, s12
    s_waitcnt lgkmcnt(0)
    ds_write_b32 v10, v52
    s_add_u32 s12, s12, 1
    v_mfma_f32_32x32x16_bf16 v[80:95], v[240:243], v[252:255], v[80:95]
    ds_read_b64 v[48:49], v11 offset:16
    v_mfma_f32_32x32x16_bf16 v[96:111], v[244:247], v[248:251], v[96:111]
    v_mfma_f32_32x32x16_bf16 v[112:127], v[244:247], v[252:255], v[112:127]
    v_mfma_f32_32x32x16_bf16 v[64:79], v[128:131], v[136:139], v[64:79]
    s_waitcnt lgkmcnt(0)
    v_min_u32 v48, v48, v49
    v_cmp_gt_u32 vcc, s12, v48
    s_cbranch_vccnz G1_slow2
G1_back2:
    ds_read_b128 v[192:195], v40 offset:32768
    ds_read_b128 v[200:203], v44 offset:32768
    v_mfma_f32_32x32x16_bf16 v[80:95], v[128:131], v[140:143], v[80:95]
    ds_read_b128 v[204:207], v44 offset:36864
    ds_read_b128 v[196:199], v40 offset:36864
    v_mfma_f32_32x32x16_bf16 v[96:111], v[132:135], v[136:139], v[96:111]
    ds_read_b128 v[208:211], v41 offset:32768
    ds_read_b128 v[216:219], v45 offset:32768
    v_mfma_f32_32x32x16_bf16 v[112:127], v[132:135], v[140:143], v[112:127]
    ds_read_b128 v[220:223], v45 offset:36864
    ds_read_b128 v[212:215], v41 offset:36864
    v_mfma_f32_32x32x16_bf16 v[64:79], v[144:147], v[152:155], v[64:79]
    ds_read_b128 v[224:227], v42 offset:32768
    ds_read_b128 v[232:235], v46 offset:32768
    v_mfma_f32_32x32x16_bf16 v[80:95], v[144:147], v[156:159], v[80:95]
    ds_read_b128 v[236:239], v46 offset:36864
    ds_read_b128 v[228:231], v42 offset:36864
    v_mfma_f32_32x32x16_bf16 v[96:111], v[148:151], v[152:155], v[96:111]
    ds_read_b128 v[240:243], v43 offset:32768
    ds_read_b128 v[248:251], v47 offset:32768
    v_mfma_f32_32x32x16_bf16 v[112:127], v[148:151], v[156:159], v[112:127]
    ds_read_b128 v[252:255], v47 offset:36864
    ds_read_b128 v[244:247], v43 offset:36864
    v_mfma_f32_32x32x16_bf16 v[64:79], v[160:163], v[168:171], v[64:79]
    v_mfma_f32_32x32x16_bf16 v[80:95], v[160:163], v[172:175], v[80:95]
    v_mfma_f32_32x32x16_bf16 v[96:111], v[164:167], v[168:171], v[96:111]
    v_mfma_f32_32x32x16_bf16 v[112:127], v[164:167], v[172:175], v[112:127]
    v_mfma_f32_32x32x16_bf16 v[64:79], v[176:179], v[184:187], v[64:79]
    v_mov_b32 v52, s12
    s_waitcnt lgkmcnt(0)
    ds_write_b32 v10, v52
    s_add_u32 s12, s12, 1
    v_mfma_f32_32x32x16_bf16 v[80:95], v[176:179], v[188:191], v[80:95]
    ds_read_b64 v[48:49], v11 offset:16
    v_mfma_f32_32x32x16_bf16 v[96:111], v[180:183], v[184:187], v[96:111]
    v_mfma_f32_32x32x16_bf16 v[112:127], v[180:183], v[188:191], v[112:127]
    s_cmp_eq_u32 s12, 17
    s_cbranch_scc1 G1_last
    v_mfma_f32_32x32x16_bf16 v[64:79], v[192:195], v[200:203], v[64:79]
    s_waitcnt lgkmcnt(0)
    v_min_u32 v48, v48, v49
    v_cmp_gt_u32 vcc, s12, v48
    s_cbranch_vccnz G1_slow3
G1_back3:
    ds_read_b128 v[128:131], v32 offset:0
    ds_read_b128 v[136:139], v36 offset:0
    v_mfma_f32_32x32x16_bf16 v[80:95], v[192:195], v[204:207], v[80:95]
    ds_read_b128 v[140:143], v36 offset:4096
    ds_read_b128 v[132:135], v32 offset:4096
    v_mfma_f32_32x32x16_bf16 v[96:111], v[196:199], v[200:203], v[96:111]
    ds_read_b128 v[144:147], v33 offset:0
    ds_read_b128 v[152:155], v37 offset:0
    v_mfma_f32_32x32x16_bf16 v[112:127], v[196:199], v[204:207], v[112:127]
    ds_read_b128 v[156:159], v37 offset:4096
    ds_read_b128 v[148:151], v33 offset:4096
    v_mfma_f32_32x32x16_bf16 v[64:79], v[208:211], v[216:219], v[64:79]
    ds_read_b128 v[160:163], v34 offset:0
    ds_read_b128 v[168:171], v38 offset:0
    v_mfma_f32_32x32x16_bf16 v[80:95], v[208:211], v[220:223], v[80:95]
    ds_read_b128 v[172:175], v38 offset:4096
    ds_read_b128 v[164:167], v34 offset:4096
    v_mfma_f32_32x32x16_bf16 v[96:111], v[212:215], v[216:219], v[96:111]
    ds_read_b128 v[176:179], v35 offset:0
    ds_read_b128 v[184:187], v39 offset:0
    v_mfma_f32_32x32x16_bf16 v[112:127], v[212:215], v[220:223], v[112:127]
    ds_read_b128 v[188:191], v39 offset:4096
    ds_read_b128 v[180:183], v35 offset:4096
    v_mfma_f32_32x32x16_bf16 v[64:79], v[224:227], v[232:235], v[64:79]
    v_mfma_f32_32x32x16_bf16 v[80:95], v[224:227], v[236:239], v[80:95]
    v_mfma_f32_32x32x16_bf16 v[96:111], v[228:231], v[232:235], v[96:111]
    v_mfma_f32_32x32x16_bf16 v[112:127], v[228:231], v[236:239], v[112:127]
    v_mfma_f32_32x32x16_bf16 v[64:79], v[240:243], v[248:251], v[64:79]
    v_mov_b32 v52, s12
    s_waitcnt lgkmcnt(0)
    ds_write_b32 v10, v52
    s_add_u32 s12, s12, 1
    v_mfma_f32_32x32x16_bf16 v[80:95], v[240:243], v[252:255], v[80:95]
    ds_read_b64 v[48:49], v11 offset:16
    v_mfma_f32_32x32x16_bf16 v[96:111], v[244:247], v[248:251], v[96:111]
    v_mfma_f32_32x32x16_bf16 v[112:127], v[244:247], v[252:255], v[112:127]
    s_branch G1_loop
G1_slow0:
    s_mov_b32 s15, 0
G1_sl0_w:
    ds_read_b64 v[48:49], v11 offset:16
    s_waitcnt lgkmcnt(0)
    v_min_u32 v48, v48, v49
    v_cmp_gt_u32 vcc, s12, v48
    s_cbranch_vccz G1_sl0_ok
    s_add_u32 s15, s15, 1
    s_cmp_lt_u32 s15, 160000
    s_cbranch_scc1 G1_sl0_w
G1_sl0_ok:
    s_branch G1_back0
G1_slow1:
    s_mov_b32 s15, 0
G1_sl1_w:
    ds_read_b64 v[48:49], v11 offset:16
    s_waitcnt lgkmcnt(0)
    v_min_u32 v48, v48, v49
    v_cmp_gt_u32 vcc, s12, v48
    s_cbranch_vccz G1_sl1_ok
    s_add_u32 s15, s15, 1
    s_cmp_lt_u32 s15, 160000
    s_cbranch_scc1 G1_sl1_w
G1_sl1_ok:
    s_branch G1_back1
G1_slow2:
    s_mov_b32 s15, 0
G1_sl2_w:
    ds_read_b64 v[48:49], v11 offset:16
    s_waitcnt lgkmcnt(0)
    v_min_u32 v48, v48, v49
    v_cmp_gt_u32 vcc, s12, v48
    s_cbranch_vccz G1_sl2_ok
    s_add_u32 s15, s15, 1
    s_cmp_lt_u32 s15, 160000
    s_cbranch_scc1 G1_sl2_w
G1_sl2_ok:
    s_branch G1_back2
G1_slow3:
    s_mov_b32 s15, 0
G1_sl3_w:
    ds_read_b64 v[48:49], v11 offset:16
    s_waitcnt lgkmcnt(0)
    v_min_u32 v48, v48, v49
    v_cmp_gt_u32 vcc, s12, v48
    s_cbranch_vccz G1_sl3_ok
    s_add_u32 s15, s15, 1
    s_cmp_lt_u32 s15, 160000
    s_cbranch_scc1 G1_sl3_w
G1_sl3_ok:
    s_branch G1_back3
G1_last:
    v_mfma_f32_32x32x16_bf16 v[64:79], v[192:195], v[200:203], v[64:79]
    s_setprio 3
    s_waitcnt vmcnt(0)
    ds_read_b64 v[30:31], v11 offset:32
    v_lshlrev_b32 v133, 16, v12
    v_lshlrev_b32 v134, 16, v13
    v_lshlrev_b32 v135, 16, v14
    v_mul_f32 v133, 0x3fb8aa3b, v133
    v_mfma_f32_32x32x16_bf16 v[80:95], v[192:195], v[204:207], v[80:95]
    v_exp_f32 v133, v133
    v_mul_f32 v140, v134, v134
    v_cvt_pk_bf16_f32 v133, v133, v133
    v_fmac_f32 v140, v135, v135
    v_mfma_f32_32x32x16_bf16 v[96:111], v[196:199], v[200:203], v[96:111]
    v_lshlrev_b32 v133, 16, v133
    v_rcp_f32 v140, v140
    v_mul_f32 v136, v133, v134
    v_mul_f32 v137, v133, v135
    v_mfma_f32_32x32x16_bf16 v[112:127], v[196:199], v[204:207], v[112:127]
    v_mul_f32 v136, 0x3fb8aa3b, v136
    v_exp_f32 v136, v136
    v_mul_f32 v137, 0.15915494, v137
    v_cos_f32 v138, v137
    v_mfma_f32_32x32x16_bf16 v[64:79], v[208:211], v[216:219], v[64:79]
    v_sin_f32 v139, v137
    v_add_f32 v140, v140, v140
    v_mul_f32 v6, v136, v138
    v_mul_f32 v7, v136, v139
    v_mfma_f32_32x32x16_bf16 v[80:95], v[208:211], v[220:223], v[80:95]
    v_mul_f32 v128, v6, v6
    v_mul_f32 v129, v6, v7
    v_fma_f32 v128, -v7, v7, v128
    v_fmac_f32 v129, v7, v6
    v_mfma_f32_32x32x16_bf16 v[96:111], v[212:215], v[216:219], v[96:111]
    v_mul_f32 v130, v128, v128
    v_mul_f32 v131, v128, v129
    v_fma_f32 v130, -v129, v129, v130
    v_fmac_f32 v131, v129, v128
    v_mfma_f32_32x32x16_bf16 v[112:127], v[212:215], v[220:223], v[112:127]
    v_mul_f32 v12, v130, v130
    v_mul_f32 v13, v130, v131
    v_fma_f32 v12, -v131, v131, v12
    v_fmac_f32 v13, v131, v130
    v_mfma_f32_32x32x16_bf16 v[64:79], v[224:227], v[232:235], v[64:79]
    v_mul_f32 v14, v12, v12
    v_mul_f32 v15, v12, v13
    v_fma_f32 v14, -v13, v13, v14
    v_fmac_f32 v15, v13, v12
    v_mfma_f32_32x32x16_bf16 v[80:95], v[224:227], v[236:239], v[80:95]
    v_mul_f32 v16, v14, v14
    v_mul_f32 v17, v14, v15
    v_fma_f32 v16, -v15, v15, v16
    v_fmac_f32 v17, v15, v14
    v_mfma_f32_32x32x16_bf16 v[96:111], v[228:231], v[232:235], v[96:111]
    v_add_f32 v136, -1.0, v6
    v_mul_f32 v138, v136, v134
    v_fmac_f32 v138, v7, v135
    v_mul_f32 v139, v7, v134
    v_mfma_f32_32x32x16_bf16 v[112:127], v[228:231], v[236:239], v[112:127]
    v_fma_f32 v139, -v136, v135, v139
    v_mul_f32 v8, v138, v140
    v_mul_f32 v9, v139, v140
    v_mul_f32 v18, v16, v16
    v_mfma_f32_32x32x16_bf16 v[64:79], v[240:243], v[248:251], v[64:79]
    v_mul_f32 v19, v16, v17
    v_fma_f32 v18, -v17, v17, v18
    v_fmac_f32 v19, v17, v16
    v_mul_f32 v20, v18, v18
    v_mfma_f32_32x32x16_bf16 v[80:95], v[240:243], v[252:255], v[80:95]
    v_mul_f32 v21, v18, v19
    v_fma_f32 v20, -v19, v19, v20
    v_fmac_f32 v21, v19, v18
    v_mfma_f32_32x32x16_bf16 v[96:111], v[244:247], v[248:251], v[96:111]
    v_mfma_f32_32x32x16_bf16 v[112:127], v[244:247], v[252:255], v[112:127]
    s_nop 1
    v_fma_f32 v40, v6, v64, v66
    v_fma_f32 v41, v6, v65, v67
    s_nop 2
    v_fma_f32 v42, v6, v80, v82
    v_fma_f32 v43, v6, v81, v83
    s_nop 1
    v_fma_f32 v44, v6, v96, v98
    v_fma_f32 v45, v6, v97, v99
    v_fma_f32 v46, v6, v112, v114
    v_fma_f32 v47, v6, v113, v115
    v_fma_f32 v40, -v7, v80, v40
    v_fma_f32 v41, -v7, v81, v41
    v_fmac_f32 v42, v7, v64
    v_fmac_f32 v43, v7, v65
    v_fma_f32 v44, -v7, v112, v44
    v_fma_f32 v45, -v7, v113, v45
    v_fmac_f32 v46, v7, v96
    v_fmac_f32 v47, v7, v97
    v_fma_f32 v32, v6, v40, v68
    v_fma_f32 v33, v6, v41, v69
    v_fma_f32 v34, v6, v42, v84
    v_fma_f32 v35, v6, v43, v85
    v_fma_f32 v36, v6, v44, v100
    v_fma_f32 v37, v6, v45, v101
    v_fma_f32 v38, v6, v46, v116
    v_fma_f32 v39, v6, v47, v117
    v_fma_f32 v32, -v7, v42, v32
    v_fma_f32 v33, -v7, v43, v33
    v_fmac_f32 v34, v7, v40
    v_fmac_f32 v35, v7, v41
    v_fma_f32 v36, -v7, v46, v36
    v_fma_f32 v37, -v7, v47, v37
    v_fmac_f32 v38, v7, v44
    v_fmac_f32 v39, v7, v45
    v_fma_f32 v40, v6, v32, v70
    v_fma_f32 v41, v6, v33, v71
    v_fma_f32 v42, v6, v34, v86
    v_fma_f32 v43, v6, v35, v87
    v_fma_f32 v44, v6, v36, v102
    v_fma_f32 v45, v6, v37, v103
    v_fma_f32 v46, v6, v38, v118
    v_fma_f32 v47, v6, v39, v119
    v_fma_f32 v40, -v7, v34, v40
    v_fma_f32 v41, -v7, v35, v41
    v_fmac_f32 v42, v7, v32
    v_fmac_f32 v43, v7, v33
    v_fma_f32 v44, -v7, v38, v44
    v_fma_f32 v45, -v7, v39, v45
    v_fmac_f32 v46, v7, v36
    v_fmac_f32 v47, v7, v37
    v_fma_f32 v32, v6, v40, v72
    v_fma_f32 v33, v6, v41, v73
    v_fma_f32 v34, v6, v42, v88
    v_fma_f32 v35, v6, v43, v89
    v_fma_f32 v36, v6, v44, v104
    v_fma_f32 v37, v6, v45, v105
    v_fma_f32 v38, v6, v46, v120
    v_fma_f32 v39, v6, v47, v121
    v_fma_f32 v32, -v7, v42, v32
    v_fma_f32 v33, -v7, v43, v33
    v_fmac_f32 v34, v7, v40
    v_fmac_f32 v35, v7, v41
    v_fma_f32 v36, -v7, v46, v36
    v_fma_f32 v37, -v7, v47, v37
    v_fmac_f32 v38, v7, v44
    v_fmac_f32 v39, v7, v45
    v_fma_f32 v40, v6, v32, v74
    v_fma_f32 v41, v6, v33, v75
    v_fma_f32 v42, v6, v34, v90
    v_fma_f32 v43, v6, v35, v91
    v_fma_f32 v44, v6, v36, v106
    v_fma_f32 v45, v6, v37, v107
    v_fma_f32 v46, v6, v38, v122
    v_fma_f32 v47, v6, v39, v123
    v_fma_f32 v40, -v7, v34, v40
    v_fma_f32 v41, -v7, v35, v41
    v_fmac_f32 v42, v7, v32
    v_fmac_f32 v43, v7, v33
    v_fma_f32 v44, -v7, v38, v44
    v_fma_f32 v45, -v7, v39, v45
    v_fmac_f32 v46, v7, v36
    v_fmac_f32 v47, v7, v37
    v_fma_f32 v32, v6, v40, v76
    v_fma_f32 v33, v6, v41, v77
    v_fma_f32 v34, v6, v42, v92
    v_fma_f32 v35, v6, v43, v93
    v_fma_f32 v36, v6, v44, v108
    v_fma_f32 v37, v6, v45, v109
    v_fma_f32 v38, v6, v46, v124
    v_fma_f32 v39, v6, v47, v125
    v_fma_f32 v32, -v7, v42, v32
    v_fma_f32 v33, -v7, v43, v33
    v_fmac_f32 v34, v7, v40
    v_fmac_f32 v35, v7, v41
    v_fma_f32 v36, -v7, v46, v36
    v_fma_f32 v37, -v7, v47, v37
    v_fmac_f32 v38, v7, v44
    v_fmac_f32 v39, v7, v45
    v_fma_f32 v40, v6, v32, v78
    v_fma_f32 v41, v6, v33, v79
    v_fma_f32 v42, v6, v34, v94
    v_fma_f32 v43, v6, v35, v95
    v_fma_f32 v44, v6, v36, v110
    v_fma_f32 v45, v6, v37, v111
    v_fma_f32 v46, v6, v38, v126
    v_fma_f32 v47, v6, v39, v127
    v_fma_f32 v40, -v7, v34, v40
    v_fma_f32 v41, -v7, v35, v41
    v_fmac_f32 v42, v7, v32
    v_fmac_f32 v43, v7, v33
    v_fma_f32 v44, -v7, v38, v44
    v_fma_f32 v45, -v7, v39, v45
    v_fmac_f32 v46, v7, v36
    v_fmac_f32 v47, v7, v37
    v_fmac_f32 v44, v12, v40
    v_fmac_f32 v45, v12, v41
    v_fmac_f32 v46, v12, v42
    v_fmac_f32 v47, v12, v43
    v_fma_f32 v44, -v13, v42, v44
    v_fma_f32 v45, -v13, v43, v45
    v_fmac_f32 v46, v13, v40
    v_fmac_f32 v47, v13, v41
    v_fma_f32 v32, v14, v44, v45
    v_fma_f32 v34, v14, v46, v47
    v_fma_f32 v32, -v15, v46, v32
    v_fmac_f32 v34, v15, v44
    v_mov_b32 v33, v32
    v_mov_b32 v35, v34
    s_lshl_b32 s12, s6, 1
    s_add_u32 s12, s12, s8
    v_permlane32_swap_b32 v32, v33
    v_permlane32_swap_b32 v34, v35
    v_fma_f32 v28, v16, v32, v33
    v_fma_f32 v29, v16, v34, v35
    v_fma_f32 v28, -v17, v34, v28
    v_fmac_f32 v29, v17, v32
    s_waitcnt lgkmcnt(0)
    s_mov_b32 s15, 0
G_nw:
    v_cmp_eq_u32 vcc, 0, v30
    s_cbranch_vccz G_nok
    ds_read_b64 v[30:31], v11 offset:32
    s_add_u32 s15, s15, 1
    s_waitcnt lgkmcnt(0)
    s_cmp_lt_u32 s15, 160000
    s_cbranch_scc1 G_nw
G_nok:
    s_cmp_eq_u32 s8, 0
    s_cbranch_scc0 G_pw1
    ds_write_b128 v0, v[28:31] offset:2048
    s_branch G_pub1
G_pw1:
    s_mov_b32 s15, 0
G_x1:
    ds_read_b128 v[56:59], v1 offset:2048
    s_add_u32 s15, s15, 1
    s_waitcnt lgkmcnt(0)
    v_cmp_ne_u64 vcc, v[58:59], v[30:31]
    s_cbranch_vccz G_x1_ok
    s_cmp_lt_u32 s15, 160000
    s_cbranch_scc1 G_x1
G_x1_ok:
    v_fmac_f32 v28, v18, v56
    v_fmac_f32 v29, v18, v57
    s_lshl_b32 s13, s6, 14
    v_fma_f32 v28, -v19, v57, v28
    v_fmac_f32 v29, v19, v56
    s_mov_b32 exec_hi, 0
    buffer_store_dwordx4 v[28:31], v53, s[64:67], s13 offen sc1
    s_cmp_eq_u32 s6, 0
    s_cbranch_scc0 G_pub1
    s_not_b64 exec, exec
    v_mov_b32 v28, 0
    v_mov_b32 v29, 0
    buffer_store_dwordx4 v[28:31], v53, s[64:67], 0 offen sc1
G_pub1:
    s_mov_b64 exec, -1
    v_mul_f32 v128, v8, v64
    v_mul_f32 v129, v8, v65
    v_mul_f32 v144, -v8, v80
    v_mul_f32 v145, -v8, v81
    v_mul_f32 v160, v8, v96
    v_mul_f32 v161, v8, v97
    v_mul_f32 v176, -v8, v112
    v_mul_f32 v177, -v8, v113
    v_fma_f32 v128, -v9, v80, v128
    v_fma_f32 v129, -v9, v81, v129
    v_fma_f32 v144, -v9, v64, v144
    v_fma_f32 v145, -v9, v65, v145
    v_fma_f32 v160, -v9, v112, v160
    v_fma_f32 v161, -v9, v113, v161
    v_fma_f32 v176, -v9, v96, v176
    v_fma_f32 v177, -v9, v97, v177
    v_mul_f32 v130, v8, v66
    v_mul_f32 v131, v8, v67
    v_mul_f32 v146, -v8, v82
    v_mul_f32 v147, -v8, v83
    v_mul_f32 v162, v8, v98
    v_mul_f32 v163, v8, v99
    v_mul_f32 v178, -v8, v114
    v_mul_f32 v179, -v8, v115
    v_fma_f32 v130, -v9, v82, v130
    v_fma_f32 v131, -v9, v83, v131
    v_fma_f32 v146, -v9, v66, v146
    v_fma_f32 v147, -v9, v67, v147
    v_fma_f32 v162, -v9, v114, v162
    v_fma_f32 v163, -v9, v115, v163
    v_fma_f32 v178, -v9, v98, v178
    v_fma_f32 v179, -v9, v99, v179
    v_mul_f32 v132, v8, v68
    v_mul_f32 v133, v8, v69
    v_mul_f32 v148, -v8, v84
    v_mul_f32 v149, -v8, v85
    v_mul_f32 v164, v8, v100
    v_mul_f32 v165, v8, v101
    v_mul_f32 v180, -v8, v116
    v_mul_f32 v181, -v8, v117
    v_fma_f32 v132, -v9, v84, v132
    v_fma_f32 v133, -v9, v85, v133
    v_fma_f32 v148, -v9, v68, v148
    v_fma_f32 v149, -v9, v69, v149
    v_fma_f32 v164, -v9, v116, v164
    v_fma_f32 v165, -v9, v117, v165
    v_fma_f32 v180, -v9, v100, v180
    v_fma_f32 v181, -v9, v101, v181
    v_mul_f32 v134, v8, v70
    v_mul_f32 v135, v8, v71
    v_mul_f32 v150, -v8, v86
    v_mul_f32 v151, -v8, v87
    v_mul_f32 v166, v8, v102
    v_mul_f32 v167, v8, v103
    v_mul_f32 v182, -v8, v118
    v_mul_f32 v183, -v8, v119
    v_fma_f32 v134, -v9, v86, v134
    v_fma_f32 v135, -v9, v87, v135
    v_fma_f32 v150, -v9, v70, v150
    v_fma_f32 v151, -v9, v71, v151
    v_fma_f32 v166, -v9, v118, v166
    v_fma_f32 v167, -v9, v119, v167
    v_fma_f32 v182, -v9, v102, v182
    v_fma_f32 v183, -v9, v103, v183
    v_mul_f32 v136, v8, v72
    v_mul_f32 v137, v8, v73
    v_mul_f32 v152, -v8, v88
    v_mul_f32 v153, -v8, v89
    v_mul_f32 v168, v8, v104
    v_mul_f32 v169, v8, v105
    v_mul_f32 v184, -v8, v120
    v_mul_f32 v185, -v8, v121
    v_fma_f32 v136, -v9, v88, v136
    v_fma_f32 v137, -v9, v89, v137
    v_fma_f32 v152, -v9, v72, v152
    v_fma_f32 v153, -v9, v73, v153
    v_fma_f32 v168, -v9, v120, v168
    v_fma_f32 v169, -v9, v121, v169
    v_fma_f32 v184, -v9, v104, v184
    v_fma_f32 v185, -v9, v105, v185
    v_mul_f32 v138, v8, v74
    v_mul_f32 v139, v8, v75
    v_mul_f32 v154, -v8, v90
    v_mul_f32 v155, -v8, v91
    v_mul_f32 v170, v8, v106
    v_mul_f32 v171, v8, v107
    v_mul_f32 v186, -v8, v122
    v_mul_f32 v187, -v8, v123
    v_fma_f32 v138, -v9, v90, v138
    v_fma_f32 v139, -v9, v91, v139
    v_fma_f32 v154, -v9, v74, v154
    v_fma_f32 v155, -v9, v75, v155
    v_fma_f32 v170, -v9, v122, v170
    v_fma_f32 v171, -v9, v123, v171
    v_fma_f32 v186, -v9, v106, v186
    v_fma_f32 v187, -v9, v107, v187
    v_mul_f32 v140, v8, v76
    v_mul_f32 v141, v8, v77
    v_mul_f32 v156, -v8, v92
    v_mul_f32 v157, -v8, v93
    v_mul_f32 v172, v8, v108
    v_mul_f32 v173, v8, v109
    v_mul_f32 v188, -v8, v124
    v_mul_f32 v189, -v8, v125
    v_fma_f32 v140, -v9, v92, v140
    v_fma_f32 v141, -v9, v93, v141
    v_fma_f32 v156, -v9, v76, v156
    v_fma_f32 v157, -v9, v77, v157
    v_fma_f32 v172, -v9, v124, v172
    v_fma_f32 v173, -v9, v125, v173
    v_fma_f32 v188, -v9, v108, v188
    v_fma_f32 v189, -v9, v109, v189
    v_mul_f32 v142, v8, v78
    v_mul_f32 v143, v8, v79
    v_mul_f32 v158, -v8, v94
    v_mul_f32 v159, -v8, v95
    v_mul_f32 v174, v8, v110
    v_mul_f32 v175, v8, v111
    v_mul_f32 v190, -v8, v126
    v_mul_f32 v191, -v8, v127
    v_fma_f32 v142, -v9, v94, v142
    v_fma_f32 v143, -v9, v95, v143
    v_fma_f32 v158, -v9, v78, v158
    v_fma_f32 v159, -v9, v79, v159
    v_fma_f32 v174, -v9, v126, v174
    v_fma_f32 v175, -v9, v127, v175
    v_fma_f32 v190, -v9, v110, v190
    v_fma_f32 v191, -v9, v111, v191
    s_mov_b32 s13, 0
    buffer_load_dwordx2 v[80:81], v22, s[52:55], s13 offen offset:0
    buffer_load_dwordx2 v[82:83], v22, s[52:55], s13 offen offset:2048
    s_mov_b32 s13, 4096
    buffer_load_dwordx2 v[84:85], v22, s[52:55], s13 offen offset:0
    buffer_load_dwordx2 v[86:87], v22, s[52:55], s13 offen offset:2048
    s_mov_b32 s13, 32768
    buffer_load_dwordx2 v[88:89], v22, s[52:55], s13 offen offset:0
    buffer_load_dwordx2 v[90:91], v22, s[52:55], s13 offen offset:2048
    s_mov_b32 s13, 36864
    buffer_load_dwordx2 v[92:93], v22, s[52:55], s13 offen offset:0
    buffer_load_dwordx2 v[94:95], v22, s[52:55], s13 offen offset:2048
    v_cmp_eq_u32 vcc, 1, v4
    v_mov_b32 v36, 1.0
    s_nop 0
    v_cndmask_b32 v72, v36, v20, vcc
    v_cndmask_b32 v73, 0, v21, vcc
    v_cndmask_b32 v96, 0, v32, vcc
    v_cndmask_b32 v98, 0, v34, vcc
    v_cndmask_b32 v36, v36, v16, vcc
    v_cndmask_b32 v37, 0, v17, vcc
    s_cmp_eq_u32 s8, 1
    s_cselect_b64 s[14:15], -1, 0
    v_mul_f32 v74, v20, v20
    v_fma_f32 v97, v14, v96, v44
    v_mul_f32 v75, v20, v21
    v_fma_f32 v99, v14, v98, v46
    v_fma_f32 v74, -v21, v21, v74
    v_fma_f32 v97, -v15, v98, v97
    v_fmac_f32 v75, v21, v20
    v_fmac_f32 v99, v15, v96
    v_mul_f32 v76, v74, v74
    v_fma_f32 v100, v12, v96, v40
    v_mul_f32 v77, v74, v75
    v_fma_f32 v101, v12, v97, v41
    v_fma_f32 v76, -v75, v75, v76
    v_fma_f32 v102, v12, v98, v42
    v_fmac_f32 v77, v75, v74
    v_fma_f32 v103, v12, v99, v43
    v_cndmask_b32 v74, 1.0, v74, s[14:15]
    v_fma_f32 v100, -v13, v98, v100
    v_cndmask_b32 v75, 0, v75, s[14:15]
    v_fma_f32 v101, -v13, v99, v101
    v_mul_f32 v64, v72, v74
    v_fmac_f32 v102, v13, v96
    v_mul_f32 v65, v72, v75
    v_fmac_f32 v103, v13, v97
    v_fma_f32 v64, -v73, v75, v64
    v_mul_f32 v104, v8, v36
    v_fmac_f32 v65, v73, v74
    v_mul_f32 v106, v8, v37
    v_mul_f32 v66, v64, v76
    v_fma_f32 v104, -v9, v37, v104
    v_mul_f32 v67, v64, v77
    v_fmac_f32 v106, v9, v36
    v_fma_f32 v66, -v65, v77, v66
    v_mul_f32 v105, v14, v104
    v_fmac_f32 v67, v65, v76
    v_mul_f32 v107, v14, v106
    v_mul_f32 v68, v66, v76
    v_fma_f32 v105, -v15, v106, v105
    v_mul_f32 v69, v66, v77
    v_fmac_f32 v107, v15, v104
    v_fma_f32 v68, -v67, v77, v68
    v_mul_f32 v108, v12, v104
    v_fmac_f32 v69, v67, v76
    v_mul_f32 v109, v12, v105
    v_mul_f32 v70, v68, v76
    v_mul_f32 v110, v12, v106
    v_mul_f32 v71, v68, v77
    v_mul_f32 v111, v12, v107
    v_fma_f32 v70, -v69, v77, v70
    v_fma_f32 v108, -v13, v106, v108
    v_fmac_f32 v71, v69, v76
    v_fma_f32 v109, -v13, v107, v109
    v_fmac_f32 v110, v13, v104
    v_fmac_f32 v111, v13, v105
    v_mul_f32 v112, v8, v96
    v_mul_f32 v113, v8, v97
    v_mul_f32 v114, -v8, v98
    v_mul_f32 v115, -v8, v99
    v_fma_f32 v112, -v9, v98, v112
    v_fma_f32 v113, -v9, v99, v113
    v_fma_f32 v114, -v9, v96, v114
    v_fma_f32 v115, -v9, v97, v115
    v_mul_f32 v116, v8, v100
    v_mul_f32 v117, v8, v101
    v_mul_f32 v118, -v8, v102
    v_mul_f32 v119, -v8, v103
    v_fma_f32 v116, -v9, v102, v116
    v_fma_f32 v117, -v9, v103, v117
    v_fma_f32 v118, -v9, v100, v118
    v_fma_f32 v119, -v9, v101, v119
    s_lshl_b32 s13, s3, 13
    s_add_u32 s13, s13, 65536
    v_and_b32 v32, 1, v2
    v_and_b32 v33, 2, v2
    v_lshl_or_b32 v32, v33, 1, v32
    v_lshrrev_b32 v33, 1, v2
    v_xor_b32 v33, v33, v2
    v_bfe_u32 v33, v33, 2, 1
    v_lshl_or_b32 v32, v33, 1, v32
    v_lshlrev_b32 v33, 2, v4
    v_xor_b32 v32, v32, v33
    v_lshlrev_b32 v32, 4, v32
    v_lshl_add_u32 v32, v3, 7, v32
    v_add_u32 v120, s13, v32
    v_xor_b32 v121, 16, v120
    v_xor_b32 v122, 32, v120
    v_xor_b32 v123, 48, v120
    v_bfe_u32 v32, v2, 2, 2
    v_lshrrev_b32 v33, 4, v2
    v_lshl_add_u32 v33, v33, 3, v32
    v_lshlrev_b32 v33, 7, v33
    v_and_b32 v34, 1, v32
    v_and_b32 v32, 2, v32
    v_lshl_or_b32 v32, v32, 1, v34
    v_bfe_u32 v34, v2, 4, 1
    v_bfe_u32 v35, v2, 1, 1
    v_lshl_or_b32 v34, v34, 1, v35
    v_xor_b32 v32, v32, v34
    v_lshl_add_u32 v33, v32, 4, v33
    v_and_b32 v32, 1, v2
    v_lshl_add_u32 v33, v32, 3, v33
    v_add_u32 v124, s13, v33
    v_xor_b32 v125, 64, v124
    v_xor_b32 v126, 32, v124
    v_xor_b32 v127, 64, v126
    s_lshl_b32 s10, s7, 5
    s_add_u32 s10, s10, s8
    s_lshl_b32 s10, s10, 12
    v_lshrrev_b32 v40, 3, v2
    v_lshl_add_u32 v40, v40, 13, s10
    v_lshrrev_b32 v41, 4, v2
    v_xor_b32 v41, v41, v2
    v_and_b32 v41, 7, v41
    v_lshl_add_u32 v16, v41, 4, v40
    v_xor_b32 v17, 64, v16
    v_add_u32 v17, 64512, v17
    s_lshl_b32 s16, s6, 2
    s_add_u32 s16, s16, s3
    s_lshl_b32 s16, s16, 17
    s_lshl_b32 s22, s9, 13
    s_lshl_b32 s10, s8, 12
    s_add_u32 s22, s22, s10
    s_lshl_b32 s10, s9, 6
    s_lshl_b32 s11, s9, 13
    v_xor_b32 v20, s10, v124
    v_xor_b32 v21, s10, v126
    v_subrev_u32 v20, s11, v20
    v_subrev_u32 v21, s11, v21
    s_mov_b32 s15, 0
G_all16_w:
    ds_read_b128 v[48:51], v11 offset:0
    s_waitcnt lgkmcnt(0)
    v_min3_u32 v48, v48, v49, v50
    v_min_u32 v48, v48, v51
    v_cmp_gt_u32 vcc, 16, v48
    s_cbranch_vccz G_all16_ok
    s_add_u32 s15, s15, 1
    s_cmp_lt_u32 s15, 160000
    s_cbranch_scc1 G_all16_w
G_all16_ok:
    v_mov_b32 v36, 0
    v_mov_b32 v37, 0
    s_mov_b32 s15, 0
    s_cmp_eq_u32 s6, 0
    s_cbranch_scc1 G_lb4
    s_lshl_b32 s14, s8, 1
    s_sub_i32 s14, s6, s14
    s_cmp_le_i32 s14, 0
    s_cbranch_scc1 G_lb3
G_lb:
    buffer_load_dwordx4 v[192:195], v60, s[64:67], 0 offen sc1
    s_cmp_le_i32 s14, 4
    s_cbranch_scc1 G_lb1
    buffer_load_dwordx4 v[196:199], v61, s[64:67], 0 offen sc1
    s_cmp_le_i32 s14, 8
    s_cbranch_scc1 G_lb1
    buffer_load_dwordx4 v[200:203], v62, s[64:67], 0 offen sc1
    s_cmp_le_i32 s14, 12
    s_cbranch_scc1 G_lb1
    buffer_load_dwordx4 v[204:207], v63, s[64:67], 0 offen sc1
G_lb1:
    v_mov_b32 v36, 0
    v_mov_b32 v37, 0
    s_mov_b64 s[10:11], 0
    s_waitcnt vmcnt(0)
    v_cmp_ne_u64 vcc, v[194:195], v[30:31]
    v_fmac_f32 v36, v64, v192
    v_fmac_f32 v37, v64, v193
    s_or_b64 s[10:11], s[10:11], vcc
    v_fma_f32 v36, -v65, v193, v36
    v_fmac_f32 v37, v65, v192
    s_cmp_le_i32 s14, 4
    s_cbranch_scc1 G_lb2
    v_cmp_ne_u64 vcc, v[198:199], v[30:31]
    v_fmac_f32 v36, v66, v196
    v_fmac_f32 v37, v66, v197
    s_or_b64 s[10:11], s[10:11], vcc
    v_fma_f32 v36, -v67, v197, v36
    v_fmac_f32 v37, v67, v196
    s_cmp_le_i32 s14, 8
    s_cbranch_scc1 G_lb2
    v_cmp_ne_u64 vcc, v[202:203], v[30:31]
    v_fmac_f32 v36, v68, v200
    v_fmac_f32 v37, v68, v201
    s_or_b64 s[10:11], s[10:11], vcc
    v_fma_f32 v36, -v69, v201, v36
    v_fmac_f32 v37, v69, v200
    s_cmp_le_i32 s14, 12
    s_cbranch_scc1 G_lb2
    v_cmp_ne_u64 vcc, v[206:207], v[30:31]
    v_fmac_f32 v36, v70, v204
    v_fmac_f32 v37, v70, v205
    s_or_b64 s[10:11], s[10:11], vcc
    v_fma_f32 v36, -v71, v205, v36
    v_fmac_f32 v37, v71, v204
G_lb2:
    s_cmp_eq_u64 s[10:11], 0
    s_cbranch_scc1 G_lb2b
    s_add_u32 s15, s15, 1
    s_cmp_lt_u32 s15, 20000
    s_cbranch_scc1 G_lb
G_lb2b:
    v_mov_b32 v38, v36
    v_mov_b32 v39, v37
    s_nop 0
    v_permlane32_swap_b32 v36, v38
    v_permlane32_swap_b32 v37, v39
    v_add_f32 v36, v36, v38
    v_add_f32 v37, v37, v39
G_lb3:
    v_mov_b32 v28, v36
    v_mov_b32 v29, v37
    ds_write_b128 v0, v[28:31]
    s_mov_b32 s15, 0
G_x2:
    ds_read_b128 v[192:195], v1 offset:0
    s_add_u32 s15, s15, 1
    s_waitcnt lgkmcnt(0)
    v_cmp_ne_u64 vcc, v[194:195], v[30:31]
    s_cbranch_vccz G_x2_ok
    s_cmp_lt_u32 s15, 160000
    s_cbranch_scc1 G_x2
G_x2_ok:
    v_add_f32 v36, v36, v192
    v_add_f32 v37, v37, v193
G_lb4:
    s_cmp_eq_u32 s8, 0
    s_cbranch_scc1 G_lbdone
    v_fma_f32 v56, v18, v36, v56
    v_fma_f32 v57, v18, v37, v57
    v_fma_f32 v56, -v19, v37, v56
    v_fma_f32 v37, v19, v36, v57
    v_mov_b32 v36, v56
G_lbdone:
    v_fmac_f32 v112, v36, v104
    v_fmac_f32 v113, v36, v105
    v_fma_f32 v114, -v37, v104, v114
    v_fma_f32 v115, -v37, v105, v115
    v_fmac_f32 v116, v36, v108
    v_fmac_f32 v117, v36, v109
    v_fma_f32 v118, -v37, v108, v118
    v_fma_f32 v119, -v37, v109, v119
    v_fma_f32 v112, -v37, v106, v112
    v_fma_f32 v113, -v37, v107, v113
    v_fma_f32 v114, -v36, v106, v114
    v_fma_f32 v115, -v36, v107, v115
    v_fma_f32 v116, -v37, v110, v116
    v_fma_f32 v117, -v37, v111, v117
    v_fma_f32 v118, -v36, v110, v118
    v_fma_f32 v119, -v36, v111, v119
    s_bfe_u32 s18, s100, 28 + (4 << 16)
    s_lshl_b32 s18, s18, 7
    buffer_load_dwordx4 v[224:227], v16, s[80:83], s18 offen offset:0
    v_fmac_f32 v128, v6, v112
    v_fmac_f32 v129, v6, v113
    v_fmac_f32 v144, v6, v114
    v_fmac_f32 v145, v6, v115
    v_fmac_f32 v160, v6, v116
    v_fmac_f32 v161, v6, v117
    v_fmac_f32 v176, v6, v118
    v_fmac_f32 v177, v6, v119
    v_fmac_f32 v128, v7, v114
    v_fmac_f32 v129, v7, v115
    v_fma_f32 v144, -v7, v112, v144
    v_fma_f32 v145, -v7, v113, v145
    v_fmac_f32 v160, v7, v118
    v_fmac_f32 v161, v7, v119
    v_fma_f32 v176, -v7, v116, v176
    v_fma_f32 v177, -v7, v117, v177
    buffer_load_dwordx4 v[228:231], v17, s[80:83], s18 offen offset:1024
    v_fmac_f32 v130, v6, v128
    v_fmac_f32 v131, v6, v129
    v_fmac_f32 v146, v6, v144
    v_fmac_f32 v147, v6, v145
    v_fmac_f32 v162, v6, v160
    v_fmac_f32 v163, v6, v161
    v_fmac_f32 v178, v6, v176
    v_fmac_f32 v179, v6, v177
    v_fmac_f32 v130, v7, v144
    v_fmac_f32 v131, v7, v145
    v_fma_f32 v146, -v7, v128, v146
    v_fma_f32 v147, -v7, v129, v147
    v_fmac_f32 v162, v7, v176
    v_fmac_f32 v163, v7, v177
    v_fma_f32 v178, -v7, v160, v178
    v_fma_f32 v179, -v7, v161, v179
    buffer_load_dwordx4 v[232:235], v16, s[80:83], s18 offen offset:2048
    v_fmac_f32 v132, v6, v130
    v_fmac_f32 v133, v6, v131
    v_fmac_f32 v148, v6, v146
    v_fmac_f32 v149, v6, v147
    v_fmac_f32 v164, v6, v162
    v_fmac_f32 v165, v6, v163
    v_fmac_f32 v180, v6, v178
    v_fmac_f32 v181, v6, v179
    v_fmac_f32 v132, v7, v146
    v_fmac_f32 v133, v7, v147
    v_fma_f32 v148, -v7, v130, v148
    v_fma_f32 v149, -v7, v131, v149
    v_fmac_f32 v164, v7, v178
    v_fmac_f32 v165, v7, v179
    v_fma_f32 v180, -v7, v162, v180
    v_fma_f32 v181, -v7, v163, v181
    buffer_load_dwordx4 v[236:239], v17, s[80:83], s18 offen offset:3072
    v_fmac_f32 v134, v6, v132
    v_fmac_f32 v135, v6, v133
    v_fmac_f32 v150, v6, v148
    v_fmac_f32 v151, v6, v149
    v_fmac_f32 v166, v6, v164
    v_fmac_f32 v167, v6, v165
    v_fmac_f32 v182, v6, v180
    v_fmac_f32 v183, v6, v181
    v_fmac_f32 v134, v7, v148
    v_fmac_f32 v135, v7, v149
    v_fma_f32 v150, -v7, v132, v150
    v_fma_f32 v151, -v7, v133, v151
    v_fmac_f32 v166, v7, v180
    v_fmac_f32 v167, v7, v181
    v_fma_f32 v182, -v7, v164, v182
    v_fma_f32 v183, -v7, v165, v183
    s_bfe_u32 s18, s101, 0 + (4 << 16)
    s_lshl_b32 s18, s18, 7
    buffer_load_dwordx4 v[240:243], v16, s[80:83], s18 offen offset:0
    v_fmac_f32 v136, v6, v134
    v_fmac_f32 v137, v6, v135
    v_fmac_f32 v152, v6, v150
    v_fmac_f32 v153, v6, v151
    v_fmac_f32 v168, v6, v166
    v_fmac_f32 v169, v6, v167
    v_fmac_f32 v184, v6, v182
    v_fmac_f32 v185, v6, v183
    v_fmac_f32 v136, v7, v150
    v_fmac_f32 v137, v7, v151
    v_fma_f32 v152, -v7, v134, v152
    v_fma_f32 v153, -v7, v135, v153
    v_fmac_f32 v168, v7, v182
    v_fmac_f32 v169, v7, v183
    v_fma_f32 v184, -v7, v166, v184
    v_fma_f32 v185, -v7, v167, v185
    buffer_load_dwordx4 v[244:247], v17, s[80:83], s18 offen offset:1024
    v_fmac_f32 v138, v6, v136
    v_fmac_f32 v139, v6, v137
    v_fmac_f32 v154, v6, v152
    v_fmac_f32 v155, v6, v153
    v_fmac_f32 v170, v6, v168
    v_fmac_f32 v171, v6, v169
    v_fmac_f32 v186, v6, v184
    v_fmac_f32 v187, v6, v185
    v_fmac_f32 v138, v7, v152
    v_fmac_f32 v139, v7, v153
    v_fma_f32 v154, -v7, v136, v154
    v_fma_f32 v155, -v7, v137, v155
    v_fmac_f32 v170, v7, v184
    v_fmac_f32 v171, v7, v185
    v_fma_f32 v186, -v7, v168, v186
    v_fma_f32 v187, -v7, v169, v187
    buffer_load_dwordx4 v[248:251], v16, s[80:83], s18 offen offset:2048
    v_fmac_f32 v140, v6, v138
    v_fmac_f32 v141, v6, v139
    v_fmac_f32 v156, v6, v154
    v_fmac_f32 v157, v6, v155
    v_fmac_f32 v172, v6, v170
    v_fmac_f32 v173, v6, v171
    v_fmac_f32 v188, v6, v186
    v_fmac_f32 v189, v6, v187
    v_fmac_f32 v140, v7, v154
    v_fmac_f32 v141, v7, v155
    v_fma_f32 v156, -v7, v138, v156
    v_fma_f32 v157, -v7, v139, v157
    v_fmac_f32 v172, v7, v186
    v_fmac_f32 v173, v7, v187
    v_fma_f32 v188, -v7, v170, v188
    v_fma_f32 v189, -v7, v171, v189
    buffer_load_dwordx4 v[252:255], v17, s[80:83], s18 offen offset:3072
    v_fmac_f32 v142, v6, v140
    v_fmac_f32 v143, v6, v141
    v_fmac_f32 v158, v6, v156
    v_fmac_f32 v159, v6, v157
    v_fmac_f32 v174, v6, v172
    v_fmac_f32 v175, v6, v173
    v_fmac_f32 v190, v6, v188
    v_fmac_f32 v191, v6, v189
    v_fmac_f32 v142, v7, v156
    v_fmac_f32 v143, v7, v157
    v_fma_f32 v158, -v7, v140, v158
    v_fma_f32 v159, -v7, v141, v159
    v_fmac_f32 v174, v7, v188
    v_fmac_f32 v175, v7, v189
    v_fma_f32 v190, -v7, v172, v190
    v_fma_f32 v191, -v7, v173, v191
    v_cvt_pk_bf16_f32 v192, v128, v130
    v_cvt_pk_bf16_f32 v193, v132, v134
    v_cvt_pk_bf16_f32 v194, v136, v138
    v_cvt_pk_bf16_f32 v195, v140, v142
    ds_write_b128 v120, v[192:195] offset:0
    v_cvt_pk_bf16_f32 v196, v160, v162
    v_cvt_pk_bf16_f32 v197, v164, v166
    v_cvt_pk_bf16_f32 v198, v168, v170
    v_cvt_pk_bf16_f32 v199, v172, v174
    ds_write_b128 v121, v[196:199] offset:0
    v_cvt_pk_bf16_f32 v200, v129, v131
    v_cvt_pk_bf16_f32 v201, v133, v135
    v_cvt_pk_bf16_f32 v202, v137, v139
    v_cvt_pk_bf16_f32 v203, v141, v143
    ds_write_b128 v122, v[200:203] offset:0
    v_cvt_pk_bf16_f32 v204, v161, v163
    v_cvt_pk_bf16_f32 v205, v165, v167
    v_cvt_pk_bf16_f32 v206, v169, v171
    v_cvt_pk_bf16_f32 v207, v173, v175
    ds_write_b128 v123, v[204:207] offset:0
    v_cvt_pk_bf16_f32 v208, v144, v146
    v_cvt_pk_bf16_f32 v209, v148, v150
    v_cvt_pk_bf16_f32 v210, v152, v154
    v_cvt_pk_bf16_f32 v211, v156, v158
    ds_write_b128 v120, v[208:211] offset:4096
    v_cvt_pk_bf16_f32 v212, v176, v178
    v_cvt_pk_bf16_f32 v213, v180, v182
    v_cvt_pk_bf16_f32 v214, v184, v186
    v_cvt_pk_bf16_f32 v215, v188, v190
    ds_write_b128 v121, v[212:215] offset:4096
    v_cvt_pk_bf16_f32 v216, v145, v147
    v_cvt_pk_bf16_f32 v217, v149, v151
    v_cvt_pk_bf16_f32 v218, v153, v155
    v_cvt_pk_bf16_f32 v219, v157, v159
    ds_write_b128 v122, v[216:219] offset:4096
    v_cvt_pk_bf16_f32 v220, v177, v179
    v_cvt_pk_bf16_f32 v221, v181, v183
    v_cvt_pk_bf16_f32 v222, v185, v187
    v_cvt_pk_bf16_f32 v223, v189, v191
    ds_write_b128 v123, v[220:223] offset:4096
    s_lshl_b32 s10, s12, 18
    s_lshl_b32 s11, s7, 13
    s_add_u32 s10, s10, s11
    s_lshl_b32 s11, s9, 11
    s_add_u32 s10, s10, s11
    s_add_u32 s11, s10, 131072
    v_mov_b32 v22, 17
    s_waitcnt lgkmcnt(0)
    ds_read_b64_tr_b16 v[160:161], v124 offset:0
    ds_read_b64_tr_b16 v[162:163], v126 offset:512
    ds_read_b64_tr_b16 v[164:165], v126 offset:0
    ds_read_b64_tr_b16 v[166:167], v124 offset:512
    ds_read_b64_tr_b16 v[168:169], v125 offset:0
    ds_read_b64_tr_b16 v[170:171], v127 offset:512
    ds_read_b64_tr_b16 v[172:173], v127 offset:0
    ds_read_b64_tr_b16 v[174:175], v125 offset:512
    ds_read_b64_tr_b16 v[176:177], v124 offset:4096
    ds_read_b64_tr_b16 v[178:179], v126 offset:4608
    ds_read_b64_tr_b16 v[180:181], v126 offset:4096
    ds_read_b64_tr_b16 v[182:183], v124 offset:4608
    ds_read_b64_tr_b16 v[184:185], v125 offset:4096
    ds_read_b64_tr_b16 v[186:187], v127 offset:4608
    ds_read_b64_tr_b16 v[188:189], v127 offset:4096
    ds_read_b64_tr_b16 v[190:191], v125 offset:4608
    s_waitcnt lgkmcnt(14)
    buffer_store_dwordx4 v[160:163], v26, s[68:71], s10 offen offset:0 sc1
    s_waitcnt lgkmcnt(12)
    buffer_store_dwordx4 v[164:167], v26, s[68:71], s10 offen offset:1024 sc1
    s_waitcnt lgkmcnt(10)
    buffer_store_dwordx4 v[168:171], v26, s[68:71], s11 offen offset:0 sc1
    s_waitcnt lgkmcnt(8)
    buffer_store_dwordx4 v[172:175], v26, s[68:71], s11 offen offset:1024 sc1
    s_waitcnt lgkmcnt(6)
    buffer_store_dwordx4 v[176:179], v27, s[68:71], s10 offen offset:0 sc1
    s_waitcnt lgkmcnt(4)
    buffer_store_dwordx4 v[180:183], v27, s[68:71], s10 offen offset:1024 sc1
    s_waitcnt lgkmcnt(2)
    buffer_store_dwordx4 v[184:187], v27, s[68:71], s11 offen offset:0 sc1
    s_waitcnt lgkmcnt(0)
    buffer_store_dwordx4 v[188:191], v27, s[68:71], s11 offen offset:1024 sc1
    ds_write_b32 v10, v22
    v_and_b32 v112, 15, v2
    v_lshrrev_b32 v113, 1, v112
    v_lshrrev_b32 v114, 4, v2
    v_xor_b32 v113, v113, v114
    v_lshlrev_b32 v113, 4, v113
    v_lshl_add_u32 v6, v112, 7, v113
    v_xor_b32 v7, 64, v6
    v_add_u32 v8, 65536, v6
    v_add_u32 v9, 65536, v7
    v_add_u32 v0, s22, v26
    v_add_u32 v1, 65536, v0
    s_lshl_b32 s10, s6, 11
    s_add_u32 s10, s10, 32768
    s_lshl_b32 s11, s7, 7
    s_add_u32 s11, s11, s10
    v_lshl_add_u32 v5, v112, 7, s10
    v_cmp_ne_u32 s[20:21], s7, v112
    v_lshlrev_b32 v116, 16, v24
    v_and_b32 v117, 0xffff0000, v24
    v_lshlrev_b32 v118, 16, v25
    v_and_b32 v119, 0xffff0000, v25
    v_add_u32 v26, s16, v26
    v_add_u32 v27, s16, v27
    s_waitcnt vmcnt(16)
    v_lshlrev_b32 v192, 16, v80
    v_and_b32 v193, 0xffff0000, v80
    v_lshlrev_b32 v194, 16, v81
    v_and_b32 v195, 0xffff0000, v81
    v_lshlrev_b32 v196, 16, v82
    v_and_b32 v197, 0xffff0000, v82
    v_lshlrev_b32 v198, 16, v83
    v_and_b32 v199, 0xffff0000, v83
    v_lshlrev_b32 v200, 16, v84
    v_and_b32 v201, 0xffff0000, v84
    v_lshlrev_b32 v202, 16, v85
    v_and_b32 v203, 0xffff0000, v85
    v_lshlrev_b32 v204, 16, v86
    v_and_b32 v205, 0xffff0000, v86
    v_lshlrev_b32 v206, 16, v87
    v_and_b32 v207, 0xffff0000, v87
    v_lshlrev_b32 v208, 16, v88
    v_and_b32 v209, 0xffff0000, v88
    v_lshlrev_b32 v210, 16, v89
    v_and_b32 v211, 0xffff0000, v89
    v_lshlrev_b32 v212, 16, v90
    v_and_b32 v213, 0xffff0000, v90
    v_lshlrev_b32 v214, 16, v91
    v_and_b32 v215, 0xffff0000, v91
    v_lshlrev_b32 v216, 16, v92
    v_and_b32 v217, 0xffff0000, v92
    v_lshlrev_b32 v218, 16, v93
    v_and_b32 v219, 0xffff0000, v93
    v_lshlrev_b32 v220, 16, v94
    v_and_b32 v221, 0xffff0000, v94
    v_lshlrev_b32 v222, 16, v95
    v_and_b32 v223, 0xffff0000, v95
    v_mul_f32 v64, v192, v116
    v_mul_f32 v72, v193, v117
    v_mul_f32 v80, v194, v118
    v_mul_f32 v88, v195, v119
    v_mul_f32 v65, v196, v116
    v_mul_f32 v73, v197, v117
    v_mul_f32 v81, v198, v118
    v_mul_f32 v89, v199, v119
    v_mul_f32 v66, v200, v116
    v_mul_f32 v74, v201, v117
    v_mul_f32 v82, v202, v118
    v_mul_f32 v90, v203, v119
    v_mul_f32 v67, v204, v116
    v_mul_f32 v75, v205, v117
    v_mul_f32 v83, v206, v118
    v_mul_f32 v91, v207, v119
    v_mul_f32 v68, v208, v116
    v_mul_f32 v76, v209, v117
    v_mul_f32 v84, v210, v118
    v_mul_f32 v92, v211, v119
    v_mul_f32 v69, v212, v116
    v_mul_f32 v77, v213, v117
    v_mul_f32 v85, v214, v118
    v_mul_f32 v93, v215, v119
    v_mul_f32 v70, v216, v116
    v_mul_f32 v78, v217, v117
    v_mul_f32 v86, v218, v118
    v_mul_f32 v94, v219, v119
    v_mul_f32 v71, v220, v116
    v_mul_f32 v79, v221, v117
    v_mul_f32 v87, v222, v118
    v_mul_f32 v95, v223, v119
    s_mov_b32 s15, 0
G_all17_w:
    ds_read_b128 v[12:15], v11 offset:0
    s_waitcnt lgkmcnt(0)
    v_min3_u32 v12, v12, v13, v14
    v_min_u32 v12, v12, v15
    v_cmp_gt_u32 vcc, 17, v12
    s_cbranch_vccz G_all17_ok
    s_add_u32 s15, s15, 1
    s_cmp_lt_u32 s15, 160000
    s_cbranch_scc1 G_all17_w
G_all17_ok:
    ds_read_b64_tr_b16 v[128:129], v20 offset:0
    ds_read_b64_tr_b16 v[130:131], v21 offset:512
    ds_read_b64_tr_b16 v[132:133], v21 offset:0
    ds_read_b64_tr_b16 v[134:135], v20 offset:512
    ds_read_b64_tr_b16 v[136:137], v20 offset:8192
    ds_read_b64_tr_b16 v[138:139], v21 offset:8704
    ds_read_b64_tr_b16 v[140:141], v21 offset:8192
    ds_read_b64_tr_b16 v[142:143], v20 offset:8704
    ds_read_b64_tr_b16 v[144:145], v20 offset:4096
    ds_read_b64_tr_b16 v[146:147], v21 offset:4608
    ds_read_b64_tr_b16 v[148:149], v21 offset:4096
    ds_read_b64_tr_b16 v[150:151], v20 offset:4608
    ds_read_b64_tr_b16 v[152:153], v20 offset:12288
    ds_read_b64_tr_b16 v[154:155], v21 offset:12800
    ds_read_b64_tr_b16 v[156:157], v21 offset:12288
    ds_read_b64_tr_b16 v[158:159], v20 offset:12800
    v_mov_b32 v18, 1
    s_waitcnt vmcnt(0)
    s_mov_b64 exec, 1
    ds_add_rtn_u32 v18, v11, v18 offset:52
    s_waitcnt lgkmcnt(0)
    v_readfirstlane_b32 s14, v18
    s_cmp_eq_u32 s14, 3
    s_cbranch_scc0 G_nl
    buffer_store_dwordx2 v[30:31], v23, s[72:75], s11 offen sc1
    s_mov_b64 exec, -1
    buffer_load_dwordx2 v[28:29], v5, s[72:75], 0 offen sc1
G_nl:
    s_mov_b64 exec, -1
    s_mov_b32 s15, 0
G_f0_w:
    ds_read_b32 v18, v11 offset:60
    s_waitcnt lgkmcnt(0)
    v_cmp_gt_u32 vcc, 4, v18
    s_cbranch_vccz G_f0_ok
    s_sleep 1
    s_add_u32 s15, s15, 1
    s_cmp_lt_u32 s15, 160000
    s_cbranch_scc1 G_f0_w
G_f0_ok:
    ds_read_b128 v[192:195], v6 offset:0
    ds_read_b128 v[196:199], v6 offset:2048
    ds_read_b128 v[200:203], v6 offset:4096
    ds_read_b128 v[204:207], v6 offset:6144
    ds_read_b128 v[208:211], v7 offset:0
    ds_read_b128 v[212:215], v7 offset:2048
    ds_read_b128 v[216:219], v7 offset:4096
    s_waitcnt lgkmcnt(6)
    v_mfma_f32_16x16x32_bf16 v[64:67], v[128:131], v[192:195], v[64:67]
    ds_read_b128 v[220:223], v7 offset:6144
    v_mfma_f32_16x16x32_bf16 v[68:71], v[132:135], v[192:195], v[68:71]
    s_bfe_u32 s18, s101, 4 + (4 << 16)
    s_lshl_b32 s18, s18, 7
    buffer_load_dwordx4 v[48:51], v16, s[80:83], s18 offen offset:0
    s_waitcnt lgkmcnt(6)
    v_mfma_f32_16x16x32_bf16 v[72:75], v[128:131], v[196:199], v[72:75]
    ds_read_b128 v[192:195], v6 offset:8192
    v_mfma_f32_16x16x32_bf16 v[76:79], v[132:135], v[196:199], v[76:79]
    s_waitcnt lgkmcnt(6)
    v_mfma_f32_16x16x32_bf16 v[80:83], v[128:131], v[200:203], v[80:83]
    ds_read_b128 v[196:199], v6 offset:10240
    v_mfma_f32_16x16x32_bf16 v[84:87], v[132:135], v[200:203], v[84:87]
    buffer_load_dwordx4 v[52:55], v17, s[80:83], s18 offen offset:1024
    s_waitcnt lgkmcnt(6)
    v_mfma_f32_16x16x32_bf16 v[88:91], v[128:131], v[204:207], v[88:91]
    ds_read_b128 v[200:203], v6 offset:12288
    v_mfma_f32_16x16x32_bf16 v[92:95], v[132:135], v[204:207], v[92:95]
    s_waitcnt lgkmcnt(6)
    v_mfma_f32_16x16x32_bf16 v[64:67], v[136:139], v[208:211], v[64:67]
    ds_read_b128 v[204:207], v6 offset:14336
    v_mfma_f32_16x16x32_bf16 v[68:71], v[140:143], v[208:211], v[68:71]
    buffer_load_dwordx4 v[56:59], v16, s[80:83], s18 offen offset:2048
    s_waitcnt lgkmcnt(6)
    v_mfma_f32_16x16x32_bf16 v[72:75], v[136:139], v[212:215], v[72:75]
    ds_read_b128 v[208:211], v7 offset:8192
    v_mfma_f32_16x16x32_bf16 v[76:79], v[140:143], v[212:215], v[76:79]
    s_waitcnt lgkmcnt(6)
    v_mfma_f32_16x16x32_bf16 v[80:83], v[136:139], v[216:219], v[80:83]
    ds_read_b128 v[212:215], v7 offset:10240
    v_mfma_f32_16x16x32_bf16 v[84:87], v[140:143], v[216:219], v[84:87]
    buffer_load_dwordx4 v[60:63], v17, s[80:83], s18 offen offset:3072
    s_waitcnt lgkmcnt(6)
    v_mfma_f32_16x16x32_bf16 v[88:91], v[136:139], v[220:223], v[88:91]
    ds_read_b128 v[216:219], v7 offset:12288
    v_mfma_f32_16x16x32_bf16 v[92:95], v[140:143], v[220:223], v[92:95]
    s_waitcnt lgkmcnt(6)
    v_mfma_f32_16x16x32_bf16 v[64:67], v[144:147], v[192:195], v[64:67]
    ds_read_b128 v[220:223], v7 offset:14336
    v_mfma_f32_16x16x32_bf16 v[68:71], v[148:151], v[192:195], v[68:71]
    s_bfe_u32 s18, s101, 8 + (4 << 16)
    s_lshl_b32 s18, s18, 7
    buffer_load_dwordx4 v[32:35], v16, s[80:83], s18 offen offset:0
    s_waitcnt lgkmcnt(6)
    v_mfma_f32_16x16x32_bf16 v[72:75], v[144:147], v[196:199], v[72:75]
    ds_read_b128 v[192:195], v6 offset:16384
    v_mfma_f32_16x16x32_bf16 v[76:79], v[148:151], v[196:199], v[76:79]
    s_waitcnt lgkmcnt(6)
    v_mfma_f32_16x16x32_bf16 v[80:83], v[144:147], v[200:203], v[80:83]
    ds_read_b128 v[196:199], v6 offset:18432
    v_mfma_f32_16x16x32_bf16 v[84:87], v[148:151], v[200:203], v[84:87]
    buffer_load_dwordx4 v[36:39], v17, s[80:83], s18 offen offset:1024
    s_waitcnt lgkmcnt(6)
    v_mfma_f32_16x16x32_bf16 v[88:91], v[144:147], v[204:207], v[88:91]
    ds_read_b128 v[200:203], v6 offset:20480
    v_mfma_f32_16x16x32_bf16 v[92:95], v[148:151], v[204:207], v[92:95]
    s_waitcnt lgkmcnt(6)
    v_mfma_f32_16x16x32_bf16 v[64:67], v[152:155], v[208:211], v[64:67]
    ds_read_b128 v[204:207], v6 offset:22528
    v_mfma_f32_16x16x32_bf16 v[68:71], v[156:159], v[208:211], v[68:71]
    buffer_load_dwordx4 v[40:43], v16, s[80:83], s18 offen offset:2048
    s_waitcnt lgkmcnt(6)
    v_mfma_f32_16x16x32_bf16 v[72:75], v[152:155], v[212:215], v[72:75]
    ds_read_b128 v[208:211], v7 offset:16384
    v_mfma_f32_16x16x32_bf16 v[76:79], v[156:159], v[212:215], v[76:79]
    s_waitcnt lgkmcnt(6)
    v_mfma_f32_16x16x32_bf16 v[80:83], v[152:155], v[216:219], v[80:83]
    ds_read_b128 v[212:215], v7 offset:18432
    v_mfma_f32_16x16x32_bf16 v[84:87], v[156:159], v[216:219], v[84:87]
    buffer_load_dwordx4 v[44:47], v17, s[80:83], s18 offen offset:3072
    s_waitcnt lgkmcnt(6)
    v_mfma_f32_16x16x32_bf16 v[88:91], v[152:155], v[220:223], v[88:91]
    ds_read_b128 v[216:219], v7 offset:20480
    v_mfma_f32_16x16x32_bf16 v[92:95], v[156:159], v[220:223], v[92:95]
    v_mov_b32 v22, 18
    ds_write_b32 v10, v22
    s_bfe_u32 s18, s101, 12 + (4 << 16)
    s_lshl_b32 s18, s18, 7
    buffer_load_dwordx4 v[96:99], v16, s[80:83], s18 offen offset:0
    buffer_load_dwordx4 v[100:103], v17, s[80:83], s18 offen offset:1024
    buffer_load_dwordx4 v[104:107], v16, s[80:83], s18 offen offset:2048
    buffer_load_dwordx4 v[108:111], v17, s[80:83], s18 offen offset:3072
    s_bfe_u32 s18, s101, 16 + (4 << 16)
    s_lshl_b32 s18, s18, 7
    buffer_load_dwordx4 v[112:115], v16, s[80:83], s18 offen offset:0
    buffer_load_dwordx4 v[116:119], v17, s[80:83], s18 offen offset:1024
    buffer_load_dwordx4 v[120:123], v16, s[80:83], s18 offen offset:2048
    buffer_load_dwordx4 v[124:127], v17, s[80:83], s18 offen offset:3072
    s_mov_b32 s15, 0
G_all18_w:
    ds_read_b128 v[12:15], v11 offset:0
    s_waitcnt lgkmcnt(0)
    v_min3_u32 v12, v12, v13, v14
    v_min_u32 v12, v12, v15
    v_cmp_gt_u32 vcc, 18, v12
    s_cbranch_vccz G_all18_ok
    s_add_u32 s15, s15, 1
    s_cmp_lt_u32 s15, 160000
    s_cbranch_scc1 G_all18_w
G_all18_ok:
    s_bfe_u32 s18, s100, 16 + (4 << 16)
    s_lshl_b32 s18, s18, 7
    s_add_u32 m0, s22, 65536
    s_nop 0
    buffer_load_dwordx4 v16, s[80:83], s18 offen offset:0 lds
    buffer_load_dwordx4 v17, s[80:83], s18 offen offset:1024 lds
    buffer_load_dwordx4 v16, s[80:83], s18 offen offset:2048 lds
    buffer_load_dwordx4 v17, s[80:83], s18 offen offset:3072 lds
    s_bfe_u32 s18, s100, 20 + (4 << 16)
    s_lshl_b32 s18, s18, 7
    s_add_u32 m0, s22, 81920
    s_nop 0
    buffer_load_dwordx4 v16, s[80:83], s18 offen offset:0 lds
    buffer_load_dwordx4 v17, s[80:83], s18 offen offset:1024 lds
    buffer_load_dwordx4 v16, s[80:83], s18 offen offset:2048 lds
    buffer_load_dwordx4 v17, s[80:83], s18 offen offset:3072 lds
    s_bfe_u32 s18, s100, 24 + (4 << 16)
    s_lshl_b32 s18, s18, 7
    s_add_u32 m0, s22, 0
    s_nop 0
    buffer_load_dwordx4 v16, s[80:83], s18 offen offset:0 lds
    buffer_load_dwordx4 v17, s[80:83], s18 offen offset:1024 lds
    buffer_load_dwordx4 v16, s[80:83], s18 offen offset:2048 lds
    buffer_load_dwordx4 v17, s[80:83], s18 offen offset:3072 lds
    s_mov_b32 s15, 0
    s_cmp_eq_u32 s14, 3
    s_cbranch_scc0 G_np
    s_waitcnt vmcnt(28)
GH_chk:
    v_cmp_ne_u64 vcc, v[28:29], v[30:31]
    s_and_b64 vcc, vcc, s[20:21]
    s_cbranch_scc0 GH_ok
    buffer_load_dwordx2 v[28:29], v5, s[72:75], 0 offen sc1
    s_add_u32 s15, s15, 1
    s_cmp_lt_u32 s15, 20000
    s_waitcnt vmcnt(0)
    s_cbranch_scc1 GH_chk
GH_ok:
    ds_write_b32 v11, v22 offset:56
    s_branch G_go
G_np:
    s_mov_b32 s15, 0
G_fho_w:
    ds_read_b32 v18, v11 offset:56
    s_waitcnt lgkmcnt(0)
    v_cmp_gt_u32 vcc, 1, v18
    s_cbranch_vccz G_fho_ok
    s_sleep 1
    s_add_u32 s15, s15, 1
    s_cmp_lt_u32 s15, 160000
    s_cbranch_scc1 G_fho_w
G_fho_ok:
G_go:
    s_bfe_u32 s19, s100, 4 + (4 << 16)
    s_lshl_b32 s19, s19, 13
    buffer_load_dwordx4 v[160:163], v26, s[68:71], s19 offen offset:0 sc1
    buffer_load_dwordx4 v[164:167], v26, s[68:71], s19 offen offset:1024 sc1
    buffer_load_dwordx4 v[168:171], v26, s[68:71], s19 offen offset:2048 sc1
    buffer_load_dwordx4 v[172:175], v26, s[68:71], s19 offen offset:3072 sc1
    buffer_load_dwordx4 v[176:179], v27, s[68:71], s19 offen offset:0 sc1
    buffer_load_dwordx4 v[180:183], v27, s[68:71], s19 offen offset:1024 sc1
    buffer_load_dwordx4 v[184:187], v27, s[68:71], s19 offen offset:2048 sc1
    buffer_load_dwordx4 v[188:191], v27, s[68:71], s19 offen offset:3072 sc1
    s_bfe_u32 s19, s100, 8 + (4 << 16)
    s_lshl_b32 s19, s19, 13
    buffer_load_dwordx4 v[128:131], v26, s[68:71], s19 offen offset:0 sc1
    buffer_load_dwordx4 v[132:135], v26, s[68:71], s19 offen offset:1024 sc1
    buffer_load_dwordx4 v[136:139], v26, s[68:71], s19 offen offset:2048 sc1
    buffer_load_dwordx4 v[140:143], v26, s[68:71], s19 offen offset:3072 sc1
    buffer_load_dwordx4 v[144:147], v27, s[68:71], s19 offen offset:0 sc1
    buffer_load_dwordx4 v[148:151], v27, s[68:71], s19 offen offset:1024 sc1
    buffer_load_dwordx4 v[152:155], v27, s[68:71], s19 offen offset:2048 sc1
    buffer_load_dwordx4 v[156:159], v27, s[68:71], s19 offen offset:3072 sc1
    s_setprio 1
    s_waitcnt vmcnt(14)
    v_mfma_f32_16x16x32_bf16 v[64:67], v[160:163], v[192:195], v[64:67]
    ds_read_b128 v[220:223], v7 offset:22528
    v_mfma_f32_16x16x32_bf16 v[68:71], v[164:167], v[192:195], v[68:71]
    v_mfma_f32_16x16x32_bf16 v[72:75], v[160:163], v[196:199], v[72:75]
    ds_read_b128 v[192:195], v6 offset:24576
    v_mfma_f32_16x16x32_bf16 v[76:79], v[164:167], v[196:199], v[76:79]
    v_mfma_f32_16x16x32_bf16 v[80:83], v[160:163], v[200:203], v[80:83]
    ds_read_b128 v[196:199], v6 offset:26624
    v_mfma_f32_16x16x32_bf16 v[84:87], v[164:167], v[200:203], v[84:87]
    v_mfma_f32_16x16x32_bf16 v[88:91], v[160:163], v[204:207], v[88:91]
    ds_read_b128 v[200:203], v6 offset:28672
    s_bfe_u32 s19, s100, 12 + (4 << 16)
    v_mfma_f32_16x16x32_bf16 v[92:95], v[164:167], v[204:207], v[92:95]
    s_lshl_b32 s19, s19, 13
    s_waitcnt vmcnt(12)
    v_mfma_f32_16x16x32_bf16 v[64:67], v[168:171], v[208:211], v[64:67]
    ds_read_b128 v[204:207], v6 offset:30720
    v_mfma_f32_16x16x32_bf16 v[68:71], v[172:175], v[208:211], v[68:71]
    buffer_load_dwordx4 v[160:163], v26, s[68:71], s19 offen offset:0 sc1
    v_mfma_f32_16x16x32_bf16 v[72:75], v[168:171], v[212:215], v[72:75]
    ds_read_b128 v[208:211], v7 offset:24576
    v_mfma_f32_16x16x32_bf16 v[76:79], v[172:175], v[212:215], v[76:79]
    v_mfma_f32_16x16x32_bf16 v[80:83], v[168:171], v[216:219], v[80:83]
    ds_read_b128 v[212:215], v7 offset:26624
    v_mfma_f32_16x16x32_bf16 v[84:87], v[172:175], v[216:219], v[84:87]
    buffer_load_dwordx4 v[164:167], v26, s[68:71], s19 offen offset:1024 sc1
    s_waitcnt lgkmcnt(6)
    v_mfma_f32_16x16x32_bf16 v[88:91], v[168:171], v[220:223], v[88:91]
    ds_read_b128 v[216:219], v7 offset:28672
    v_mfma_f32_16x16x32_bf16 v[92:95], v[172:175], v[220:223], v[92:95]
    s_waitcnt vmcnt(12) lgkmcnt(6)
    v_mfma_f32_16x16x32_bf16 v[64:67], v[176:179], v[192:195], v[64:67]
    ds_read_b128 v[220:223], v7 offset:30720
    v_mfma_f32_16x16x32_bf16 v[68:71], v[180:183], v[192:195], v[68:71]
    buffer_load_dwordx4 v[168:171], v26, s[68:71], s19 offen offset:2048 sc1
    s_waitcnt lgkmcnt(6)
    v_mfma_f32_16x16x32_bf16 v[72:75], v[176:179], v[196:199], v[72:75]
    ds_read_b128 v[192:195], v6 offset:32768
    v_mfma_f32_16x16x32_bf16 v[76:79], v[180:183], v[196:199], v[76:79]
    s_waitcnt lgkmcnt(6)
    v_mfma_f32_16x16x32_bf16 v[80:83], v[176:179], v[200:203], v[80:83]
    ds_read_b128 v[196:199], v6 offset:34816
    v_mfma_f32_16x16x32_bf16 v[84:87], v[180:183], v[200:203], v[84:87]
    buffer_load_dwordx4 v[172:175], v26, s[68:71], s19 offen offset:3072 sc1
    s_waitcnt lgkmcnt(6)
    v_mfma_f32_16x16x32_bf16 v[88:91], v[176:179], v[204:207], v[88:91]
    ds_read_b128 v[200:203], v6 offset:36864
    v_mfma_f32_16x16x32_bf16 v[92:95], v[180:183], v[204:207], v[92:95]
    s_waitcnt vmcnt(12) lgkmcnt(6)
    v_mfma_f32_16x16x32_bf16 v[64:67], v[184:187], v[208:211], v[64:67]
    ds_read_b128 v[204:207], v6 offset:38912
    v_mfma_f32_16x16x32_bf16 v[68:71], v[188:191], v[208:211], v[68:71]
    buffer_load_dwordx4 v[176:179], v27, s[68:71], s19 offen offset:0 sc1
    s_waitcnt lgkmcnt(6)
    v_mfma_f32_16x16x32_bf16 v[72:75], v[184:187], v[212:215], v[72:75]
    ds_read_b128 v[208:211], v7 offset:32768
    v_mfma_f32_16x16x32_bf16 v[76:79], v[188:191], v[212:215], v[76:79]
    s_waitcnt lgkmcnt(6)
    v_mfma_f32_16x16x32_bf16 v[80:83], v[184:187], v[216:219], v[80:83]
    ds_read_b128 v[212:215], v7 offset:34816
    v_mfma_f32_16x16x32_bf16 v[84:87], v[188:191], v[216:219], v[84:87]
    buffer_load_dwordx4 v[180:183], v27, s[68:71], s19 offen offset:1024 sc1
    s_waitcnt lgkmcnt(6)
    v_mfma_f32_16x16x32_bf16 v[88:91], v[184:187], v[220:223], v[88:91]
    ds_read_b128 v[216:219], v7 offset:36864
    v_mfma_f32_16x16x32_bf16 v[92:95], v[188:191], v[220:223], v[92:95]
    s_waitcnt vmcnt(12) lgkmcnt(6)
    v_mfma_f32_16x16x32_bf16 v[64:67], v[128:131], v[192:195], v[64:67]
    ds_read_b128 v[220:223], v7 offset:38912
    v_mov_b32 v22, 20
    v_mfma_f32_16x16x32_bf16 v[68:71], v[132:135], v[192:195], v[68:71]
    buffer_load_dwordx4 v[184:187], v27, s[68:71], s19 offen offset:2048 sc1
    s_waitcnt lgkmcnt(6)
    v_mfma_f32_16x16x32_bf16 v[72:75], v[128:131], v[196:199], v[72:75]
    ds_read_b128 v[192:195], v6 offset:40960
    v_mfma_f32_16x16x32_bf16 v[76:79], v[132:135], v[196:199], v[76:79]
    ds_write_b32 v10, v22
    s_waitcnt lgkmcnt(7)
    v_mfma_f32_16x16x32_bf16 v[80:83], v[128:131], v[200:203], v[80:83]
    ds_read_b128 v[196:199], v6 offset:43008
    v_mfma_f32_16x16x32_bf16 v[84:87], v[132:135], v[200:203], v[84:87]
    buffer_load_dwordx4 v[188:191], v27, s[68:71], s19 offen offset:3072 sc1
    s_waitcnt lgkmcnt(7)
    v_mfma_f32_16x16x32_bf16 v[88:91], v[128:131], v[204:207], v[88:91]
    ds_read_b128 v[200:203], v6 offset:45056
    s_bfe_u32 s19, s100, 16 + (4 << 16)
    v_mfma_f32_16x16x32_bf16 v[92:95], v[132:135], v[204:207], v[92:95]
    s_lshl_b32 s19, s19, 13
    s_waitcnt vmcnt(12) lgkmcnt(7)
    v_mfma_f32_16x16x32_bf16 v[64:67], v[136:139], v[208:211], v[64:67]
    ds_read_b128 v[204:207], v6 offset:47104
    v_mfma_f32_16x16x32_bf16 v[68:71], v[140:143], v[208:211], v[68:71]
    buffer_load_dwordx4 v[128:131], v26, s[68:71], s19 offen offset:0 sc1
    s_waitcnt lgkmcnt(7)
    v_mfma_f32_16x16x32_bf16 v[72:75], v[136:139], v[212:215], v[72:75]
    ds_read_b128 v[208:211], v7 offset:40960
    v_mfma_f32_16x16x32_bf16 v[76:79], v[140:143], v[212:215], v[76:79]
    s_waitcnt lgkmcnt(7)
    v_mfma_f32_16x16x32_bf16 v[80:83], v[136:139], v[216:219], v[80:83]
    ds_read_b128 v[212:215], v7 offset:43008
    v_mfma_f32_16x16x32_bf16 v[84:87], v[140:143], v[216:219], v[84:87]
    buffer_load_dwordx4 v[132:135], v26, s[68:71], s19 offen offset:1024 sc1
    s_waitcnt lgkmcnt(7)
    v_mfma_f32_16x16x32_bf16 v[88:91], v[136:139], v[220:223], v[88:91]
    ds_read_b128 v[216:219], v7 offset:45056
    v_mfma_f32_16x16x32_bf16 v[92:95], v[140:143], v[220:223], v[92:95]
    s_waitcnt vmcnt(12) lgkmcnt(7)
    v_mfma_f32_16x16x32_bf16 v[64:67], v[144:147], v[192:195], v[64:67]
    ds_read_b128 v[220:223], v7 offset:47104
    v_mfma_f32_16x16x32_bf16 v[68:71], v[148:151], v[192:195], v[68:71]
    buffer_load_dwordx4 v[136:139], v26, s[68:71], s19 offen offset:2048 sc1
    s_waitcnt lgkmcnt(6)
    v_mfma_f32_16x16x32_bf16 v[72:75], v[144:147], v[196:199], v[72:75]
    ds_read_b128 v[192:195], v6 offset:49152
    v_mfma_f32_16x16x32_bf16 v[76:79], v[148:151], v[196:199], v[76:79]
    s_waitcnt lgkmcnt(6)
    v_mfma_f32_16x16x32_bf16 v[80:83], v[144:147], v[200:203], v[80:83]
    ds_read_b128 v[196:199], v6 offset:51200
    ds_read_b128 v[12:15], v11
    v_mfma_f32_16x16x32_bf16 v[84:87], v[148:151], v[200:203], v[84:87]
    buffer_load_dwordx4 v[140:143], v26, s[68:71], s19 offen offset:3072 sc1
    s_waitcnt lgkmcnt(7)
    v_mfma_f32_16x16x32_bf16 v[88:91], v[144:147], v[204:207], v[88:91]
    ds_read_b128 v[200:203], v6 offset:53248
    v_mfma_f32_16x16x32_bf16 v[92:95], v[148:151], v[204:207], v[92:95]
    s_waitcnt vmcnt(12) lgkmcnt(7)
    v_mfma_f32_16x16x32_bf16 v[64:67], v[152:155], v[208:211], v[64:67]
    ds_read_b128 v[204:207], v6 offset:55296
    v_mfma_f32_16x16x32_bf16 v[68:71], v[156:159], v[208:211], v[68:71]
    buffer_load_dwordx4 v[144:147], v27, s[68:71], s19 offen offset:0 sc1
    s_waitcnt lgkmcnt(7)
    v_mfma_f32_16x16x32_bf16 v[72:75], v[152:155], v[212:215], v[72:75]
    ds_read_b128 v[208:211], v7 offset:49152
    v_mfma_f32_16x16x32_bf16 v[76:79], v[156:159], v[212:215], v[76:79]
    s_waitcnt lgkmcnt(7)
    v_mfma_f32_16x16x32_bf16 v[80:83], v[152:155], v[216:219], v[80:83]
    ds_read_b128 v[212:215], v7 offset:51200
    v_mfma_f32_16x16x32_bf16 v[84:87], v[156:159], v[216:219], v[84:87]
    buffer_load_dwordx4 v[148:151], v27, s[68:71], s19 offen offset:1024 sc1
    s_waitcnt lgkmcnt(7)
    v_mfma_f32_16x16x32_bf16 v[88:91], v[152:155], v[220:223], v[88:91]
    ds_read_b128 v[216:219], v7 offset:53248
    v_mfma_f32_16x16x32_bf16 v[92:95], v[156:159], v[220:223], v[92:95]
    s_waitcnt vmcnt(12) lgkmcnt(7)
    v_mfma_f32_16x16x32_bf16 v[64:67], v[160:163], v[192:195], v[64:67]
    ds_read_b128 v[220:223], v7 offset:55296
    v_mov_b32 v22, 21
    v_mfma_f32_16x16x32_bf16 v[68:71], v[164:167], v[192:195], v[68:71]
    buffer_load_dwordx4 v[152:155], v27, s[68:71], s19 offen offset:2048 sc1
    s_waitcnt lgkmcnt(7)
    v_mfma_f32_16x16x32_bf16 v[72:75], v[160:163], v[196:199], v[72:75]
    ds_read_b128 v[192:195], v6 offset:57344
    s_waitcnt lgkmcnt(7)
    v_min3_u32 v12, v12, v13, v14
    v_mfma_f32_16x16x32_bf16 v[76:79], v[164:167], v[196:199], v[76:79]
    ds_write_b32 v10, v22
    s_waitcnt lgkmcnt(7)
    v_mfma_f32_16x16x32_bf16 v[80:83], v[160:163], v[200:203], v[80:83]
    ds_read_b128 v[196:199], v6 offset:59392
    v_min_u32 v12, v12, v15
    v_mfma_f32_16x16x32_bf16 v[84:87], v[164:167], v[200:203], v[84:87]
    buffer_load_dwordx4 v[156:159], v27, s[68:71], s19 offen offset:3072 sc1
    s_waitcnt lgkmcnt(7)
    v_mfma_f32_16x16x32_bf16 v[88:91], v[160:163], v[204:207], v[88:91]
    ds_read_b128 v[200:203], v6 offset:61440
    s_bfe_u32 s19, s100, 20 + (4 << 16)
    v_mfma_f32_16x16x32_bf16 v[92:95], v[164:167], v[204:207], v[92:95]
    s_lshl_b32 s19, s19, 13
    s_waitcnt vmcnt(12) lgkmcnt(7)
    v_mfma_f32_16x16x32_bf16 v[64:67], v[168:171], v[208:211], v[64:67]
    ds_read_b128 v[204:207], v6 offset:63488
    v_cmp_gt_u32 vcc, 20, v12
    v_mfma_f32_16x16x32_bf16 v[68:71], v[172:175], v[208:211], v[68:71]
    buffer_load_dwordx4 v[160:163], v26, s[68:71], s19 offen offset:0 sc1
    s_waitcnt lgkmcnt(7)
    v_mfma_f32_16x16x32_bf16 v[72:75], v[168:171], v[212:215], v[72:75]
    ds_read_b128 v[208:211], v7 offset:57344
    s_cbranch_vccnz G2_slow3
G2_back3:
    v_mfma_f32_16x16x32_bf16 v[76:79], v[172:175], v[212:215], v[76:79]
    ds_write_b64 v0, v[224:225] offset:16384
    s_waitcnt lgkmcnt(8)
    v_mfma_f32_16x16x32_bf16 v[80:83], v[168:171], v[216:219], v[80:83]
    ds_read_b128 v[212:215], v7 offset:59392
    v_mfma_f32_16x16x32_bf16 v[84:87], v[172:175], v[216:219], v[84:87]
    buffer_load_dwordx4 v[164:167], v26, s[68:71], s19 offen offset:1024 sc1
    s_waitcnt lgkmcnt(8)
    v_mfma_f32_16x16x32_bf16 v[88:91], v[168:171], v[220:223], v[88:91]
    ds_read_b128 v[216:219], v7 offset:61440
    v_mfma_f32_16x16x32_bf16 v[92:95], v[172:175], v[220:223], v[92:95]
    ds_write_b64 v0, v[226:227] offset:16392
    s_waitcnt vmcnt(12) lgkmcnt(9)
    v_mfma_f32_16x16x32_bf16 v[64:67], v[176:179], v[192:195], v[64:67]
    ds_read_b128 v[220:223], v7 offset:63488
    ds_write_b64 v0, v[228:229] offset:17408
    v_mfma_f32_16x16x32_bf16 v[68:71], v[180:183], v[192:195], v[68:71]
    buffer_load_dwordx4 v[168:171], v26, s[68:71], s19 offen offset:2048 sc1
    s_waitcnt lgkmcnt(9)
    v_mfma_f32_16x16x32_bf16 v[72:75], v[176:179], v[196:199], v[72:75]
    ds_read_b128 v[192:195], v8 offset:0
    v_mfma_f32_16x16x32_bf16 v[76:79], v[180:183], v[196:199], v[76:79]
    ds_write_b64 v0, v[230:231] offset:17416
    s_waitcnt lgkmcnt(10)
    v_mfma_f32_16x16x32_bf16 v[80:83], v[176:179], v[200:203], v[80:83]
    ds_read_b128 v[196:199], v8 offset:2048
    ds_read_b128 v[12:15], v11
    v_mfma_f32_16x16x32_bf16 v[84:87], v[180:183], v[200:203], v[84:87]
    buffer_load_dwordx4 v[172:175], v26, s[68:71], s19 offen offset:3072 sc1
    s_waitcnt lgkmcnt(11)
    v_mfma_f32_16x16x32_bf16 v[88:91], v[176:179], v[204:207], v[88:91]
    ds_read_b128 v[200:203], v8 offset:4096
    v_mfma_f32_16x16x32_bf16 v[92:95], v[180:183], v[204:207], v[92:95]
    ds_write_b64 v0, v[232:233] offset:18432
    s_waitcnt vmcnt(12) lgkmcnt(12)
    v_mfma_f32_16x16x32_bf16 v[64:67], v[184:187], v[208:211], v[64:67]
    ds_read_b128 v[204:207], v8 offset:6144
    ds_write_b64 v0, v[234:235] offset:18440
    v_mfma_f32_16x16x32_bf16 v[68:71], v[188:191], v[208:211], v[68:71]
    buffer_load_dwordx4 v[176:179], v27, s[68:71], s19 offen offset:0 sc1
    s_waitcnt lgkmcnt(12)
    v_mfma_f32_16x16x32_bf16 v[72:75], v[184:187], v[212:215], v[72:75]
    ds_read_b128 v[208:211], v9 offset:0
    v_mfma_f32_16x16x32_bf16 v[76:79], v[188:191], v[212:215], v[76:79]
    ds_write_b64 v0, v[236:237] offset:19456
    s_waitcnt lgkmcnt(13)
    v_mfma_f32_16x16x32_bf16 v[80:83], v[184:187], v[216:219], v[80:83]
    ds_read_b128 v[212:215], v9 offset:2048
    v_mfma_f32_16x16x32_bf16 v[84:87], v[188:191], v[216:219], v[84:87]
    buffer_load_dwordx4 v[180:183], v27, s[68:71], s19 offen offset:1024 sc1
    s_waitcnt lgkmcnt(12)
    v_mfma_f32_16x16x32_bf16 v[88:91], v[184:187], v[220:223], v[88:91]
    ds_read_b128 v[216:219], v9 offset:4096
    v_mfma_f32_16x16x32_bf16 v[92:95], v[188:191], v[220:223], v[92:95]
    ds_write_b64 v0, v[238:239] offset:19464
    s_waitcnt vmcnt(12) lgkmcnt(12)
    v_mfma_f32_16x16x32_bf16 v[64:67], v[128:131], v[192:195], v[64:67]
    ds_read_b128 v[220:223], v9 offset:6144
    v_mov_b32 v22, 22
    v_mfma_f32_16x16x32_bf16 v[68:71], v[132:135], v[192:195], v[68:71]
    buffer_load_dwordx4 v[184:187], v27, s[68:71], s19 offen offset:2048 sc1
    s_waitcnt lgkmcnt(11)
    v_mfma_f32_16x16x32_bf16 v[72:75], v[128:131], v[196:199], v[72:75]
    ds_read_b128 v[192:195], v8 offset:8192
    s_waitcnt lgkmcnt(11)
    v_min3_u32 v12, v12, v13, v14
    v_mfma_f32_16x16x32_bf16 v[76:79], v[132:135], v[196:199], v[76:79]
    ds_write_b32 v10, v22
    s_waitcnt lgkmcnt(11)
    v_mfma_f32_16x16x32_bf16 v[80:83], v[128:131], v[200:203], v[80:83]
    ds_read_b128 v[196:199], v8 offset:10240
    v_min_u32 v12, v12, v15
    v_mfma_f32_16x16x32_bf16 v[84:87], v[132:135], v[200:203], v[84:87]
    buffer_load_dwordx4 v[188:191], v27, s[68:71], s19 offen offset:3072 sc1
    s_waitcnt lgkmcnt(10)
    v_mfma_f32_16x16x32_bf16 v[88:91], v[128:131], v[204:207], v[88:91]
    ds_read_b128 v[200:203], v8 offset:12288
    s_bfe_u32 s19, s100, 24 + (4 << 16)
    v_mfma_f32_16x16x32_bf16 v[92:95], v[132:135], v[204:207], v[92:95]
    s_lshl_b32 s19, s19, 13
    s_waitcnt vmcnt(12) lgkmcnt(9)
    v_mfma_f32_16x16x32_bf16 v[64:67], v[136:139], v[208:211], v[64:67]
    ds_read_b128 v[204:207], v8 offset:14336
    v_cmp_gt_u32 vcc, 21, v12
    v_mfma_f32_16x16x32_bf16 v[68:71], v[140:143], v[208:211], v[68:71]
    buffer_load_dwordx4 v[128:131], v26, s[68:71], s19 offen offset:0 sc1
    s_waitcnt lgkmcnt(8)
    v_mfma_f32_16x16x32_bf16 v[72:75], v[136:139], v[212:215], v[72:75]
    ds_read_b128 v[208:211], v9 offset:8192
    s_cbranch_vccnz G2_slow4
G2_back4:
    v_mfma_f32_16x16x32_bf16 v[76:79], v[140:143], v[212:215], v[76:79]
    ds_write_b64 v0, v[240:241] offset:32768
    s_waitcnt lgkmcnt(9)
    v_mfma_f32_16x16x32_bf16 v[80:83], v[136:139], v[216:219], v[80:83]
    ds_read_b128 v[212:215], v9 offset:10240
    v_mfma_f32_16x16x32_bf16 v[84:87], v[140:143], v[216:219], v[84:87]
    buffer_load_dwordx4 v[132:135], v26, s[68:71], s19 offen offset:1024 sc1
    s_waitcnt lgkmcnt(8)
    v_mfma_f32_16x16x32_bf16 v[88:91], v[136:139], v[220:223], v[88:91]
    ds_read_b128 v[216:219], v9 offset:12288
    v_mfma_f32_16x16x32_bf16 v[92:95], v[140:143], v[220:223], v[92:95]
    ds_write_b64 v0, v[242:243] offset:32776
    s_waitcnt vmcnt(12) lgkmcnt(9)
    v_mfma_f32_16x16x32_bf16 v[64:67], v[144:147], v[192:195], v[64:67]
    ds_read_b128 v[220:223], v9 offset:14336
    ds_write_b64 v0, v[244:245] offset:33792
    v_mfma_f32_16x16x32_bf16 v[68:71], v[148:151], v[192:195], v[68:71]
    buffer_load_dwordx4 v[136:139], v26, s[68:71], s19 offen offset:2048 sc1
    s_waitcnt lgkmcnt(9)
    v_mfma_f32_16x16x32_bf16 v[72:75], v[144:147], v[196:199], v[72:75]
    ds_read_b128 v[192:195], v8 offset:16384
    v_mfma_f32_16x16x32_bf16 v[76:79], v[148:151], v[196:199], v[76:79]
    ds_write_b64 v0, v[246:247] offset:33800
    s_waitcnt lgkmcnt(10)
    v_mfma_f32_16x16x32_bf16 v[80:83], v[144:147], v[200:203], v[80:83]
    ds_read_b128 v[196:199], v8 offset:18432
    ds_read_b128 v[12:15], v11
    v_mfma_f32_16x16x32_bf16 v[84:87], v[148:151], v[200:203], v[84:87]
    buffer_load_dwordx4 v[140:143], v26, s[68:71], s19 offen offset:3072 sc1
    s_waitcnt lgkmcnt(11)
    v_mfma_f32_16x16x32_bf16 v[88:91], v[144:147], v[204:207], v[88:91]
    ds_read_b128 v[200:203], v8 offset:20480
    v_mfma_f32_16x16x32_bf16 v[92:95], v[148:151], v[204:207], v[92:95]
    ds_write_b64 v0, v[248:249] offset:34816
    s_waitcnt vmcnt(12) lgkmcnt(12)
    v_mfma_f32_16x16x32_bf16 v[64:67], v[152:155], v[208:211], v[64:67]
    ds_read_b128 v[204:207], v8 offset:22528
    ds_write_b64 v0, v[250:251] offset:34824
    v_mfma_f32_16x16x32_bf16 v[68:71], v[156:159], v[208:211], v[68:71]
    buffer_load_dwordx4 v[144:147], v27, s[68:71], s19 offen offset:0 sc1
    s_waitcnt lgkmcnt(12)
    v_mfma_f32_16x16x32_bf16 v[72:75], v[152:155], v[212:215], v[72:75]
    ds_read_b128 v[208:211], v9 offset:16384
    v_mfma_f32_16x16x32_bf16 v[76:79], v[156:159], v[212:215], v[76:79]
    ds_write_b64 v0, v[252:253] offset:35840
    s_waitcnt lgkmcnt(13)
    v_mfma_f32_16x16x32_bf16 v[80:83], v[152:155], v[216:219], v[80:83]
    ds_read_b128 v[212:215], v9 offset:18432
    v_mfma_f32_16x16x32_bf16 v[84:87], v[156:159], v[216:219], v[84:87]
    buffer_load_dwordx4 v[148:151], v27, s[68:71], s19 offen offset:1024 sc1
    s_waitcnt lgkmcnt(12)
    v_mfma_f32_16x16x32_bf16 v[88:91], v[152:155], v[220:223], v[88:91]
    ds_read_b128 v[216:219], v9 offset:20480
    v_mfma_f32_16x16x32_bf16 v[92:95], v[156:159], v[220:223], v[92:95]
    ds_write_b64 v0, v[254:255] offset:35848
    s_waitcnt vmcnt(12) lgkmcnt(12)
    v_mfma_f32_16x16x32_bf16 v[64:67], v[160:163], v[192:195], v[64:67]
    ds_read_b128 v[220:223], v9 offset:22528
    v_mov_b32 v22, 23
    v_mfma_f32_16x16x32_bf16 v[68:71], v[164:167], v[192:195], v[68:71]
    buffer_load_dwordx4 v[152:155], v27, s[68:71], s19 offen offset:2048 sc1
    s_waitcnt lgkmcnt(11)
    v_mfma_f32_16x16x32_bf16 v[72:75], v[160:163], v[196:199], v[72:75]
    ds_read_b128 v[192:195], v8 offset:24576
    s_waitcnt lgkmcnt(11)
    v_min3_u32 v12, v12, v13, v14
    v_mfma_f32_16x16x32_bf16 v[76:79], v[164:167], v[196:199], v[76:79]
    ds_write_b32 v10, v22
    s_waitcnt lgkmcnt(11)
    v_mfma_f32_16x16x32_bf16 v[80:83], v[160:163], v[200:203], v[80:83]
    ds_read_b128 v[196:199], v8 offset:26624
    v_min_u32 v12, v12, v15
    v_mfma_f32_16x16x32_bf16 v[84:87], v[164:167], v[200:203], v[84:87]
    buffer_load_dwordx4 v[156:159], v27, s[68:71], s19 offen offset:3072 sc1
    s_waitcnt lgkmcnt(10)
    v_mfma_f32_16x16x32_bf16 v[88:91], v[160:163], v[204:207], v[88:91]
    ds_read_b128 v[200:203], v8 offset:28672
    s_bfe_u32 s19, s100, 28 + (4 << 16)
    v_mfma_f32_16x16x32_bf16 v[92:95], v[164:167], v[204:207], v[92:95]
    s_lshl_b32 s19, s19, 13
    s_waitcnt vmcnt(12) lgkmcnt(9)
    v_mfma_f32_16x16x32_bf16 v[64:67], v[168:171], v[208:211], v[64:67]
    ds_read_b128 v[204:207], v8 offset:30720
    v_cmp_gt_u32 vcc, 22, v12
    v_mfma_f32_16x16x32_bf16 v[68:71], v[172:175], v[208:211], v[68:71]
    buffer_load_dwordx4 v[160:163], v26, s[68:71], s19 offen offset:0 sc1
    s_waitcnt lgkmcnt(8)
    v_mfma_f32_16x16x32_bf16 v[72:75], v[168:171], v[212:215], v[72:75]
    ds_read_b128 v[208:211], v9 offset:24576
    s_cbranch_vccnz G2_slow5
G2_back5:
    v_mfma_f32_16x16x32_bf16 v[76:79], v[172:175], v[212:215], v[76:79]
    ds_write_b64 v0, v[48:49] offset:49152
    s_waitcnt lgkmcnt(9)
    v_mfma_f32_16x16x32_bf16 v[80:83], v[168:171], v[216:219], v[80:83]
    ds_read_b128 v[212:215], v9 offset:26624
    v_mfma_f32_16x16x32_bf16 v[84:87], v[172:175], v[216:219], v[84:87]
    buffer_load_dwordx4 v[164:167], v26, s[68:71], s19 offen offset:1024 sc1
    s_waitcnt lgkmcnt(8)
    v_mfma_f32_16x16x32_bf16 v[88:91], v[168:171], v[220:223], v[88:91]
    ds_read_b128 v[216:219], v9 offset:28672
    v_mfma_f32_16x16x32_bf16 v[92:95], v[172:175], v[220:223], v[92:95]
    ds_write_b64 v0, v[50:51] offset:49160
    s_waitcnt vmcnt(12) lgkmcnt(9)
    v_mfma_f32_16x16x32_bf16 v[64:67], v[176:179], v[192:195], v[64:67]
    ds_read_b128 v[220:223], v9 offset:30720
    ds_write_b64 v0, v[52:53] offset:50176
    v_mfma_f32_16x16x32_bf16 v[68:71], v[180:183], v[192:195], v[68:71]
    buffer_load_dwordx4 v[168:171], v26, s[68:71], s19 offen offset:2048 sc1
    s_waitcnt lgkmcnt(9)
    v_mfma_f32_16x16x32_bf16 v[72:75], v[176:179], v[196:199], v[72:75]
    ds_read_b128 v[192:195], v6 offset:0
    v_mfma_f32_16x16x32_bf16 v[76:79], v[180:183], v[196:199], v[76:79]
    ds_write_b64 v0, v[54:55] offset:50184
    s_waitcnt lgkmcnt(10)
    v_mfma_f32_16x16x32_bf16 v[80:83], v[176:179], v[200:203], v[80:83]
    ds_read_b128 v[196:199], v6 offset:2048
    ds_read_b128 v[12:15], v11
    v_mfma_f32_16x16x32_bf16 v[84:87], v[180:183], v[200:203], v[84:87]
    buffer_load_dwordx4 v[172:175], v26, s[68:71], s19 offen offset:3072 sc1
    s_waitcnt lgkmcnt(11)
    v_mfma_f32_16x16x32_bf16 v[88:91], v[176:179], v[204:207], v[88:91]
    ds_read_b128 v[200:203], v6 offset:4096
    v_mfma_f32_16x16x32_bf16 v[92:95], v[180:183], v[204:207], v[92:95]
    ds_write_b64 v0, v[56:57] offset:51200
    s_waitcnt vmcnt(12) lgkmcnt(12)
    v_mfma_f32_16x16x32_bf16 v[64:67], v[184:187], v[208:211], v[64:67]
    ds_read_b128 v[204:207], v6 offset:6144
    ds_write_b64 v0, v[58:59] offset:51208
    v_mfma_f32_16x16x32_bf16 v[68:71], v[188:191], v[208:211], v[68:71]
    buffer_load_dwordx4 v[176:179], v27, s[68:71], s19 offen offset:0 sc1
    s_waitcnt lgkmcnt(12)
    v_mfma_f32_16x16x32_bf16 v[72:75], v[184:187], v[212:215], v[72:75]
    ds_read_b128 v[208:211], v7 offset:0
    v_mfma_f32_16x16x32_bf16 v[76:79], v[188:191], v[212:215], v[76:79]
    ds_write_b64 v0, v[60:61] offset:52224
    s_waitcnt lgkmcnt(13)
    v_mfma_f32_16x16x32_bf16 v[80:83], v[184:187], v[216:219], v[80:83]
    ds_read_b128 v[212:215], v7 offset:2048
    v_mfma_f32_16x16x32_bf16 v[84:87], v[188:191], v[216:219], v[84:87]
    buffer_load_dwordx4 v[180:183], v27, s[68:71], s19 offen offset:1024 sc1
    s_waitcnt lgkmcnt(12)
    v_mfma_f32_16x16x32_bf16 v[88:91], v[184:187], v[220:223], v[88:91]
    ds_read_b128 v[216:219], v7 offset:4096
    v_mfma_f32_16x16x32_bf16 v[92:95], v[188:191], v[220:223], v[92:95]
    ds_write_b64 v0, v[62:63] offset:52232
    s_waitcnt vmcnt(12) lgkmcnt(12)
    v_mfma_f32_16x16x32_bf16 v[64:67], v[128:131], v[192:195], v[64:67]
    ds_read_b128 v[220:223], v7 offset:6144
    v_mov_b32 v22, 24
    v_mfma_f32_16x16x32_bf16 v[68:71], v[132:135], v[192:195], v[68:71]
    buffer_load_dwordx4 v[184:187], v27, s[68:71], s19 offen offset:2048 sc1
    s_waitcnt lgkmcnt(11)
    v_mfma_f32_16x16x32_bf16 v[72:75], v[128:131], v[196:199], v[72:75]
    ds_read_b128 v[192:195], v6 offset:8192
    s_waitcnt lgkmcnt(11)
    v_min3_u32 v12, v12, v13, v14
    v_mfma_f32_16x16x32_bf16 v[76:79], v[132:135], v[196:199], v[76:79]
    ds_write_b32 v10, v22
    s_waitcnt lgkmcnt(11)
    v_mfma_f32_16x16x32_bf16 v[80:83], v[128:131], v[200:203], v[80:83]
    ds_read_b128 v[196:199], v6 offset:10240
    v_min_u32 v12, v12, v15
    v_mfma_f32_16x16x32_bf16 v[84:87], v[132:135], v[200:203], v[84:87]
    buffer_load_dwordx4 v[188:191], v27, s[68:71], s19 offen offset:3072 sc1
    s_waitcnt lgkmcnt(10)
    v_mfma_f32_16x16x32_bf16 v[88:91], v[128:131], v[204:207], v[88:91]
    ds_read_b128 v[200:203], v6 offset:12288
    s_bfe_u32 s19, s101, 0 + (4 << 16)
    v_mfma_f32_16x16x32_bf16 v[92:95], v[132:135], v[204:207], v[92:95]
    s_lshl_b32 s19, s19, 13
    s_waitcnt vmcnt(12) lgkmcnt(9)
    v_mfma_f32_16x16x32_bf16 v[64:67], v[136:139], v[208:211], v[64:67]
    ds_read_b128 v[204:207], v6 offset:14336
    v_cmp_gt_u32 vcc, 23, v12
    v_mfma_f32_16x16x32_bf16 v[68:71], v[140:143], v[208:211], v[68:71]
    buffer_load_dwordx4 v[128:131], v26, s[68:71], s19 offen offset:0 sc1
    s_waitcnt lgkmcnt(8)
    v_mfma_f32_16x16x32_bf16 v[72:75], v[136:139], v[212:215], v[72:75]
    ds_read_b128 v[208:211], v7 offset:8192
    s_cbranch_vccnz G2_slow6
G2_back6:
    v_mfma_f32_16x16x32_bf16 v[76:79], v[140:143], v[212:215], v[76:79]
    ds_write_b64 v1, v[32:33] offset:0
    s_waitcnt lgkmcnt(9)
    v_mfma_f32_16x16x32_bf16 v[80:83], v[136:139], v[216:219], v[80:83]
    ds_read_b128 v[212:215], v7 offset:10240
    v_mfma_f32_16x16x32_bf16 v[84:87], v[140:143], v[216:219], v[84:87]
    buffer_load_dwordx4 v[132:135], v26, s[68:71], s19 offen offset:1024 sc1
    s_waitcnt lgkmcnt(8)
    v_mfma_f32_16x16x32_bf16 v[88:91], v[136:139], v[220:223], v[88:91]
    ds_read_b128 v[216:219], v7 offset:12288
    v_mfma_f32_16x16x32_bf16 v[92:95], v[140:143], v[220:223], v[92:95]
    ds_write_b64 v1, v[34:35] offset:8
    s_waitcnt vmcnt(12) lgkmcnt(9)
    v_mfma_f32_16x16x32_bf16 v[64:67], v[144:147], v[192:195], v[64:67]
    ds_read_b128 v[220:223], v7 offset:14336
    ds_write_b64 v1, v[36:37] offset:1024
    v_mfma_f32_16x16x32_bf16 v[68:71], v[148:151], v[192:195], v[68:71]
    buffer_load_dwordx4 v[136:139], v26, s[68:71], s19 offen offset:2048 sc1
    s_waitcnt lgkmcnt(9)
    v_mfma_f32_16x16x32_bf16 v[72:75], v[144:147], v[196:199], v[72:75]
    ds_read_b128 v[192:195], v6 offset:16384
    v_mfma_f32_16x16x32_bf16 v[76:79], v[148:151], v[196:199], v[76:79]
    ds_write_b64 v1, v[38:39] offset:1032
    s_waitcnt lgkmcnt(10)
    v_mfma_f32_16x16x32_bf16 v[80:83], v[144:147], v[200:203], v[80:83]
    ds_read_b128 v[196:199], v6 offset:18432
    ds_read_b128 v[12:15], v11
    v_mfma_f32_16x16x32_bf16 v[84:87], v[148:151], v[200:203], v[84:87]
    buffer_load_dwordx4 v[140:143], v26, s[68:71], s19 offen offset:3072 sc1
    s_waitcnt lgkmcnt(11)
    v_mfma_f32_16x16x32_bf16 v[88:91], v[144:147], v[204:207], v[88:91]
    ds_read_b128 v[200:203], v6 offset:20480
    v_mfma_f32_16x16x32_bf16 v[92:95], v[148:151], v[204:207], v[92:95]
    ds_write_b64 v1, v[40:41] offset:2048
    s_waitcnt vmcnt(12) lgkmcnt(12)
    v_mfma_f32_16x16x32_bf16 v[64:67], v[152:155], v[208:211], v[64:67]
    ds_read_b128 v[204:207], v6 offset:22528
    ds_write_b64 v1, v[42:43] offset:2056
    v_mfma_f32_16x16x32_bf16 v[68:71], v[156:159], v[208:211], v[68:71]
    buffer_load_dwordx4 v[144:147], v27, s[68:71], s19 offen offset:0 sc1
    s_waitcnt lgkmcnt(12)
    v_mfma_f32_16x16x32_bf16 v[72:75], v[152:155], v[212:215], v[72:75]
    ds_read_b128 v[208:211], v7 offset:16384
    v_mfma_f32_16x16x32_bf16 v[76:79], v[156:159], v[212:215], v[76:79]
    ds_write_b64 v1, v[44:45] offset:3072
    s_waitcnt lgkmcnt(13)
    v_mfma_f32_16x16x32_bf16 v[80:83], v[152:155], v[216:219], v[80:83]
    ds_read_b128 v[212:215], v7 offset:18432
    v_mfma_f32_16x16x32_bf16 v[84:87], v[156:159], v[216:219], v[84:87]
    buffer_load_dwordx4 v[148:151], v27, s[68:71], s19 offen offset:1024 sc1
    s_waitcnt lgkmcnt(12)
    v_mfma_f32_16x16x32_bf16 v[88:91], v[152:155], v[220:223], v[88:91]
    ds_read_b128 v[216:219], v7 offset:20480
    v_mfma_f32_16x16x32_bf16 v[92:95], v[156:159], v[220:223], v[92:95]
    ds_write_b64 v1, v[46:47] offset:3080
    s_waitcnt vmcnt(12) lgkmcnt(12)
    v_mfma_f32_16x16x32_bf16 v[64:67], v[160:163], v[192:195], v[64:67]
    ds_read_b128 v[220:223], v7 offset:22528
    v_mov_b32 v22, 25
    v_mfma_f32_16x16x32_bf16 v[68:71], v[164:167], v[192:195], v[68:71]
    buffer_load_dwordx4 v[152:155], v27, s[68:71], s19 offen offset:2048 sc1
    s_waitcnt lgkmcnt(11)
    v_mfma_f32_16x16x32_bf16 v[72:75], v[160:163], v[196:199], v[72:75]
    ds_read_b128 v[192:195], v6 offset:24576
    s_waitcnt lgkmcnt(11)
    v_min3_u32 v12, v12, v13, v14
    v_mfma_f32_16x16x32_bf16 v[76:79], v[164:167], v[196:199], v[76:79]
    ds_write_b32 v10, v22
    s_waitcnt lgkmcnt(11)
    v_mfma_f32_16x16x32_bf16 v[80:83], v[160:163], v[200:203], v[80:83]
    ds_read_b128 v[196:199], v6 offset:26624
    v_min_u32 v12, v12, v15
    v_mfma_f32_16x16x32_bf16 v[84:87], v[164:167], v[200:203], v[84:87]
    buffer_load_dwordx4 v[156:159], v27, s[68:71], s19 offen offset:3072 sc1
    s_waitcnt lgkmcnt(10)
    v_mfma_f32_16x16x32_bf16 v[88:91], v[160:163], v[204:207], v[88:91]
    ds_read_b128 v[200:203], v6 offset:28672
    s_bfe_u32 s19, s101, 4 + (4 << 16)
    v_mfma_f32_16x16x32_bf16 v[92:95], v[164:167], v[204:207], v[92:95]
    s_lshl_b32 s19, s19, 13
    s_waitcnt vmcnt(12) lgkmcnt(9)
    v_mfma_f32_16x16x32_bf16 v[64:67], v[168:171], v[208:211], v[64:67]
    ds_read_b128 v[204:207], v6 offset:30720
    v_cmp_gt_u32 vcc, 24, v12
    v_mfma_f32_16x16x32_bf16 v[68:71], v[172:175], v[208:211], v[68:71]
    buffer_load_dwordx4 v[160:163], v26, s[68:71], s19 offen offset:0 sc1
    s_waitcnt lgkmcnt(8)
    v_mfma_f32_16x16x32_bf16 v[72:75], v[168:171], v[212:215], v[72:75]
    ds_read_b128 v[208:211], v7 offset:24576
    s_cbranch_vccnz G2_slow7
G2_back7:
    v_mfma_f32_16x16x32_bf16 v[76:79], v[172:175], v[212:215], v[76:79]
    ds_write_b64 v1, v[96:97] offset:16384
    s_waitcnt lgkmcnt(9)
    v_mfma_f32_16x16x32_bf16 v[80:83], v[168:171], v[216:219], v[80:83]
    ds_read_b128 v[212:215], v7 offset:26624
    v_mfma_f32_16x16x32_bf16 v[84:87], v[172:175], v[216:219], v[84:87]
    buffer_load_dwordx4 v[164:167], v26, s[68:71], s19 offen offset:1024 sc1
    s_waitcnt lgkmcnt(8)
    v_mfma_f32_16x16x32_bf16 v[88:91], v[168:171], v[220:223], v[88:91]
    ds_read_b128 v[216:219], v7 offset:28672
    v_mfma_f32_16x16x32_bf16 v[92:95], v[172:175], v[220:223], v[92:95]
    ds_write_b64 v1, v[98:99] offset:16392
    s_waitcnt vmcnt(12) lgkmcnt(9)
    v_mfma_f32_16x16x32_bf16 v[64:67], v[176:179], v[192:195], v[64:67]
    ds_read_b128 v[220:223], v7 offset:30720
    ds_write_b64 v1, v[100:101] offset:17408
    v_mfma_f32_16x16x32_bf16 v[68:71], v[180:183], v[192:195], v[68:71]
    buffer_load_dwordx4 v[168:171], v26, s[68:71], s19 offen offset:2048 sc1
    s_waitcnt lgkmcnt(9)
    v_mfma_f32_16x16x32_bf16 v[72:75], v[176:179], v[196:199], v[72:75]
    ds_read_b128 v[192:195], v6 offset:32768
    v_mfma_f32_16x16x32_bf16 v[76:79], v[180:183], v[196:199], v[76:79]
    ds_write_b64 v1, v[102:103] offset:17416
    s_waitcnt lgkmcnt(10)
    v_mfma_f32_16x16x32_bf16 v[80:83], v[176:179], v[200:203], v[80:83]
    ds_read_b128 v[196:199], v6 offset:34816
    ds_read_b128 v[12:15], v11
    v_mfma_f32_16x16x32_bf16 v[84:87], v[180:183], v[200:203], v[84:87]
    buffer_load_dwordx4 v[172:175], v26, s[68:71], s19 offen offset:3072 sc1
    s_waitcnt lgkmcnt(11)
    v_mfma_f32_16x16x32_bf16 v[88:91], v[176:179], v[204:207], v[88:91]
    ds_read_b128 v[200:203], v6 offset:36864
    v_mfma_f32_16x16x32_bf16 v[92:95], v[180:183], v[204:207], v[92:95]
    ds_write_b64 v1, v[104:105] offset:18432
    s_waitcnt vmcnt(12) lgkmcnt(12)
    v_mfma_f32_16x16x32_bf16 v[64:67], v[184:187], v[208:211], v[64:67]
    ds_read_b128 v[204:207], v6 offset:38912
    ds_write_b64 v1, v[106:107] offset:18440
    v_mfma_f32_16x16x32_bf16 v[68:71], v[188:191], v[208:211], v[68:71]
    buffer_load_dwordx4 v[176:179], v27, s[68:71], s19 offen offset:0 sc1
    s_waitcnt lgkmcnt(12)
    v_mfma_f32_16x16x32_bf16 v[72:75], v[184:187], v[212:215], v[72:75]
    ds_read_b128 v[208:211], v7 offset:32768
    v_mfma_f32_16x16x32_bf16 v[76:79], v[188:191], v[212:215], v[76:79]
    ds_write_b64 v1, v[108:109] offset:19456
    s_waitcnt lgkmcnt(13)
    v_mfma_f32_16x16x32_bf16 v[80:83], v[184:187], v[216:219], v[80:83]
    ds_read_b128 v[212:215], v7 offset:34816
    v_mfma_f32_16x16x32_bf16 v[84:87], v[188:191], v[216:219], v[84:87]
    buffer_load_dwordx4 v[180:183], v27, s[68:71], s19 offen offset:1024 sc1
    s_waitcnt lgkmcnt(12)
    v_mfma_f32_16x16x32_bf16 v[88:91], v[184:187], v[220:223], v[88:91]
    ds_read_b128 v[216:219], v7 offset:36864
    v_mfma_f32_16x16x32_bf16 v[92:95], v[188:191], v[220:223], v[92:95]
    ds_write_b64 v1, v[110:111] offset:19464
    s_waitcnt vmcnt(12) lgkmcnt(12)
    v_mfma_f32_16x16x32_bf16 v[64:67], v[128:131], v[192:195], v[64:67]
    ds_read_b128 v[220:223], v7 offset:38912
    v_mfma_f32_16x16x32_bf16 v[68:71], v[132:135], v[192:195], v[68:71]
    buffer_load_dwordx4 v[184:187], v27, s[68:71], s19 offen offset:2048 sc1
    s_waitcnt lgkmcnt(11)
    v_mfma_f32_16x16x32_bf16 v[72:75], v[128:131], v[196:199], v[72:75]
    ds_read_b128 v[192:195], v6 offset:40960
    s_waitcnt lgkmcnt(11)
    v_min3_u32 v12, v12, v13, v14
    v_mfma_f32_16x16x32_bf16 v[76:79], v[132:135], v[196:199], v[76:79]
    s_waitcnt lgkmcnt(10)
    v_mfma_f32_16x16x32_bf16 v[80:83], v[128:131], v[200:203], v[80:83]
    ds_read_b128 v[196:199], v6 offset:43008
    v_min_u32 v12, v12, v15
    v_mfma_f32_16x16x32_bf16 v[84:87], v[132:135], v[200:203], v[84:87]
    buffer_load_dwordx4 v[188:191], v27, s[68:71], s19 offen offset:3072 sc1
    s_waitcnt lgkmcnt(9)
    v_mfma_f32_16x16x32_bf16 v[88:91], v[128:131], v[204:207], v[88:91]
    ds_read_b128 v[200:203], v6 offset:45056
    s_bfe_u32 s19, s101, 8 + (4 << 16)
    v_mfma_f32_16x16x32_bf16 v[92:95], v[132:135], v[204:207], v[92:95]
    s_lshl_b32 s19, s19, 13
    s_waitcnt vmcnt(12) lgkmcnt(8)
    v_mfma_f32_16x16x32_bf16 v[64:67], v[136:139], v[208:211], v[64:67]
    ds_read_b128 v[204:207], v6 offset:47104
    v_cmp_gt_u32 vcc, 25, v12
    v_mfma_f32_16x16x32_bf16 v[68:71], v[140:143], v[208:211], v[68:71]
    buffer_load_dwordx4 v[128:131], v26, s[68:71], s19 offen offset:0 sc1
    s_waitcnt lgkmcnt(7)
    v_mfma_f32_16x16x32_bf16 v[72:75], v[136:139], v[212:215], v[72:75]
    ds_read_b128 v[208:211], v7 offset:40960
    s_cbranch_vccnz G2_slow8
G2_back8:
    v_mfma_f32_16x16x32_bf16 v[76:79], v[140:143], v[212:215], v[76:79]
    ds_write_b64 v0, v[112:113] offset:0
    s_waitcnt lgkmcnt(8)
    v_mfma_f32_16x16x32_bf16 v[80:83], v[136:139], v[216:219], v[80:83]
    ds_read_b128 v[212:215], v7 offset:43008
    v_mfma_f32_16x16x32_bf16 v[84:87], v[140:143], v[216:219], v[84:87]
    buffer_load_dwordx4 v[132:135], v26, s[68:71], s19 offen offset:1024 sc1
    s_waitcnt lgkmcnt(7)
    v_mfma_f32_16x16x32_bf16 v[88:91], v[136:139], v[220:223], v[88:91]
    ds_read_b128 v[216:219], v7 offset:45056
    v_mfma_f32_16x16x32_bf16 v[92:95], v[140:143], v[220:223], v[92:95]
    ds_write_b64 v0, v[114:115] offset:8
    s_waitcnt vmcnt(12) lgkmcnt(8)
    v_mfma_f32_16x16x32_bf16 v[64:67], v[144:147], v[192:195], v[64:67]
    ds_read_b128 v[220:223], v7 offset:47104
    ds_write_b64 v0, v[116:117] offset:1024
    v_mfma_f32_16x16x32_bf16 v[68:71], v[148:151], v[192:195], v[68:71]
    buffer_load_dwordx4 v[136:139], v26, s[68:71], s19 offen offset:2048 sc1
    s_waitcnt lgkmcnt(9)
    v_mfma_f32_16x16x32_bf16 v[72:75], v[144:147], v[196:199], v[72:75]
    ds_read_b128 v[192:195], v6 offset:49152
    v_mfma_f32_16x16x32_bf16 v[76:79], v[148:151], v[196:199], v[76:79]
    ds_write_b64 v0, v[118:119] offset:1032
    s_waitcnt lgkmcnt(10)
    v_mfma_f32_16x16x32_bf16 v[80:83], v[144:147], v[200:203], v[80:83]
    ds_read_b128 v[196:199], v6 offset:51200
    v_mfma_f32_16x16x32_bf16 v[84:87], v[148:151], v[200:203], v[84:87]
    buffer_load_dwordx4 v[140:143], v26, s[68:71], s19 offen offset:3072 sc1
    s_waitcnt lgkmcnt(10)
    v_mfma_f32_16x16x32_bf16 v[88:91], v[144:147], v[204:207], v[88:91]
    ds_read_b128 v[200:203], v6 offset:53248
    v_mfma_f32_16x16x32_bf16 v[92:95], v[148:151], v[204:207], v[92:95]
    ds_write_b64 v0, v[120:121] offset:2048
    s_waitcnt vmcnt(12) lgkmcnt(11)
    v_mfma_f32_16x16x32_bf16 v[64:67], v[152:155], v[208:211], v[64:67]
    ds_read_b128 v[204:207], v6 offset:55296
    ds_write_b64 v0, v[122:123] offset:2056
    v_mfma_f32_16x16x32_bf16 v[68:71], v[156:159], v[208:211], v[68:71]
    buffer_load_dwordx4 v[144:147], v27, s[68:71], s19 offen offset:0 sc1
    s_waitcnt lgkmcnt(11)
    v_mfma_f32_16x16x32_bf16 v[72:75], v[152:155], v[212:215], v[72:75]
    ds_read_b128 v[208:211], v7 offset:49152
    v_mfma_f32_16x16x32_bf16 v[76:79], v[156:159], v[212:215], v[76:79]
    ds_write_b64 v0, v[124:125] offset:3072
    s_waitcnt lgkmcnt(12)
    v_mfma_f32_16x16x32_bf16 v[80:83], v[152:155], v[216:219], v[80:83]
    ds_read_b128 v[212:215], v7 offset:51200
    v_mfma_f32_16x16x32_bf16 v[84:87], v[156:159], v[216:219], v[84:87]
    buffer_load_dwordx4 v[148:151], v27, s[68:71], s19 offen offset:1024 sc1
    s_waitcnt lgkmcnt(11)
    v_mfma_f32_16x16x32_bf16 v[88:91], v[152:155], v[220:223], v[88:91]
    ds_read_b128 v[216:219], v7 offset:53248
    v_mfma_f32_16x16x32_bf16 v[92:95], v[156:159], v[220:223], v[92:95]
    ds_write_b64 v0, v[126:127] offset:3080
    s_waitcnt vmcnt(12) lgkmcnt(11)
    v_mfma_f32_16x16x32_bf16 v[64:67], v[160:163], v[192:195], v[64:67]
    ds_read_b128 v[220:223], v7 offset:55296
    v_mov_b32 v22, 27
    v_mfma_f32_16x16x32_bf16 v[68:71], v[164:167], v[192:195], v[68:71]
    buffer_load_dwordx4 v[152:155], v27, s[68:71], s19 offen offset:2048 sc1
    s_waitcnt lgkmcnt(10)
    v_mfma_f32_16x16x32_bf16 v[72:75], v[160:163], v[196:199], v[72:75]
    ds_read_b128 v[192:195], v6 offset:57344
    v_mfma_f32_16x16x32_bf16 v[76:79], v[164:167], v[196:199], v[76:79]
    ds_write_b32 v10, v22
    s_waitcnt lgkmcnt(11)
    v_mfma_f32_16x16x32_bf16 v[80:83], v[160:163], v[200:203], v[80:83]
    ds_read_b128 v[196:199], v6 offset:59392
    v_mfma_f32_16x16x32_bf16 v[84:87], v[164:167], v[200:203], v[84:87]
    buffer_load_dwordx4 v[156:159], v27, s[68:71], s19 offen offset:3072 sc1
    s_waitcnt lgkmcnt(10)
    v_mfma_f32_16x16x32_bf16 v[88:91], v[160:163], v[204:207], v[88:91]
    ds_read_b128 v[200:203], v6 offset:61440
    s_bfe_u32 s19, s101, 12 + (4 << 16)
    v_mfma_f32_16x16x32_bf16 v[92:95], v[164:167], v[204:207], v[92:95]
    s_lshl_b32 s19, s19, 13
    s_waitcnt vmcnt(12) lgkmcnt(9)
    v_mfma_f32_16x16x32_bf16 v[64:67], v[168:171], v[208:211], v[64:67]
    ds_read_b128 v[204:207], v6 offset:63488
    v_mfma_f32_16x16x32_bf16 v[68:71], v[172:175], v[208:211], v[68:71]
    buffer_load_dwordx4 v[160:163], v26, s[68:71], s19 offen offset:0 sc1
    s_waitcnt lgkmcnt(8)
    v_mfma_f32_16x16x32_bf16 v[72:75], v[168:171], v[212:215], v[72:75]
    ds_read_b128 v[208:211], v7 offset:57344
    v_mfma_f32_16x16x32_bf16 v[76:79], v[172:175], v[212:215], v[76:79]
    s_waitcnt lgkmcnt(8)
    v_mfma_f32_16x16x32_bf16 v[80:83], v[168:171], v[216:219], v[80:83]
    ds_read_b128 v[212:215], v7 offset:59392
    v_mfma_f32_16x16x32_bf16 v[84:87], v[172:175], v[216:219], v[84:87]
    buffer_load_dwordx4 v[164:167], v26, s[68:71], s19 offen offset:1024 sc1
    s_waitcnt lgkmcnt(7)
    v_mfma_f32_16x16x32_bf16 v[88:91], v[168:171], v[220:223], v[88:91]
    ds_read_b128 v[216:219], v7 offset:61440
    v_mfma_f32_16x16x32_bf16 v[92:95], v[172:175], v[220:223], v[92:95]
    s_waitcnt vmcnt(12) lgkmcnt(7)
    v_mfma_f32_16x16x32_bf16 v[64:67], v[176:179], v[192:195], v[64:67]
    ds_read_b128 v[220:223], v7 offset:63488
    v_mfma_f32_16x16x32_bf16 v[68:71], v[180:183], v[192:195], v[68:71]
    buffer_load_dwordx4 v[168:171], v26, s[68:71], s19 offen offset:2048 sc1
    s_waitcnt lgkmcnt(6)
    v_mfma_f32_16x16x32_bf16 v[72:75], v[176:179], v[196:199], v[72:75]
    ds_read_b128 v[192:195], v8 offset:0
    v_mfma_f32_16x16x32_bf16 v[76:79], v[180:183], v[196:199], v[76:79]
    s_waitcnt lgkmcnt(6)
    v_mfma_f32_16x16x32_bf16 v[80:83], v[176:179], v[200:203], v[80:83]
    ds_read_b128 v[196:199], v8 offset:2048
    ds_read_b128 v[12:15], v11
    v_mfma_f32_16x16x32_bf16 v[84:87], v[180:183], v[200:203], v[84:87]
    buffer_load_dwordx4 v[172:175], v26, s[68:71], s19 offen offset:3072 sc1
    s_waitcnt lgkmcnt(7)
    v_mfma_f32_16x16x32_bf16 v[88:91], v[176:179], v[204:207], v[88:91]
    ds_read_b128 v[200:203], v8 offset:4096
    v_mfma_f32_16x16x32_bf16 v[92:95], v[180:183], v[204:207], v[92:95]
    s_waitcnt vmcnt(12) lgkmcnt(7)
    v_mfma_f32_16x16x32_bf16 v[64:67], v[184:187], v[208:211], v[64:67]
    ds_read_b128 v[204:207], v8 offset:6144
    v_mfma_f32_16x16x32_bf16 v[68:71], v[188:191], v[208:211], v[68:71]
    buffer_load_dwordx4 v[176:179], v27, s[68:71], s19 offen offset:0 sc1
    s_waitcnt lgkmcnt(7)
    v_mfma_f32_16x16x32_bf16 v[72:75], v[184:187], v[212:215], v[72:75]
    ds_read_b128 v[208:211], v9 offset:0
    v_mfma_f32_16x16x32_bf16 v[76:79], v[188:191], v[212:215], v[76:79]
    s_waitcnt lgkmcnt(7)
    v_mfma_f32_16x16x32_bf16 v[80:83], v[184:187], v[216:219], v[80:83]
    ds_read_b128 v[212:215], v9 offset:2048
    v_mfma_f32_16x16x32_bf16 v[84:87], v[188:191], v[216:219], v[84:87]
    buffer_load_dwordx4 v[180:183], v27, s[68:71], s19 offen offset:1024 sc1
    s_waitcnt lgkmcnt(7)
    v_mfma_f32_16x16x32_bf16 v[88:91], v[184:187], v[220:223], v[88:91]
    ds_read_b128 v[216:219], v9 offset:4096
    v_mfma_f32_16x16x32_bf16 v[92:95], v[188:191], v[220:223], v[92:95]
    s_waitcnt vmcnt(12) lgkmcnt(7)
    v_mfma_f32_16x16x32_bf16 v[64:67], v[128:131], v[192:195], v[64:67]
    ds_read_b128 v[220:223], v9 offset:6144
    v_mfma_f32_16x16x32_bf16 v[68:71], v[132:135], v[192:195], v[68:71]
    buffer_load_dwordx4 v[184:187], v27, s[68:71], s19 offen offset:2048 sc1
    s_waitcnt lgkmcnt(7)
    v_mfma_f32_16x16x32_bf16 v[72:75], v[128:131], v[196:199], v[72:75]
    ds_read_b128 v[192:195], v8 offset:8192
    s_waitcnt lgkmcnt(7)
    v_min3_u32 v12, v12, v13, v14
    v_mfma_f32_16x16x32_bf16 v[76:79], v[132:135], v[196:199], v[76:79]
    s_waitcnt lgkmcnt(6)
    v_mfma_f32_16x16x32_bf16 v[80:83], v[128:131], v[200:203], v[80:83]
    ds_read_b128 v[196:199], v8 offset:10240
    v_min_u32 v12, v12, v15
    v_mfma_f32_16x16x32_bf16 v[84:87], v[132:135], v[200:203], v[84:87]
    buffer_load_dwordx4 v[188:191], v27, s[68:71], s19 offen offset:3072 sc1
    s_waitcnt lgkmcnt(6)
    v_mfma_f32_16x16x32_bf16 v[88:91], v[128:131], v[204:207], v[88:91]
    ds_read_b128 v[200:203], v8 offset:12288
    s_bfe_u32 s19, s101, 16 + (4 << 16)
    v_mfma_f32_16x16x32_bf16 v[92:95], v[132:135], v[204:207], v[92:95]
    s_lshl_b32 s19, s19, 13
    s_waitcnt vmcnt(12) lgkmcnt(6)
    v_mfma_f32_16x16x32_bf16 v[64:67], v[136:139], v[208:211], v[64:67]
    ds_read_b128 v[204:207], v8 offset:14336
    v_cmp_gt_u32 vcc, 27, v12
    v_mfma_f32_16x16x32_bf16 v[68:71], v[140:143], v[208:211], v[68:71]
    buffer_load_dwordx4 v[128:131], v26, s[68:71], s19 offen offset:0 sc1
    s_waitcnt lgkmcnt(6)
    v_mfma_f32_16x16x32_bf16 v[72:75], v[136:139], v[212:215], v[72:75]
    ds_read_b128 v[208:211], v9 offset:8192
    s_cbranch_vccnz G2_slow10
G2_back10:
    v_mfma_f32_16x16x32_bf16 v[76:79], v[140:143], v[212:215], v[76:79]
    s_waitcnt lgkmcnt(6)
    v_mfma_f32_16x16x32_bf16 v[80:83], v[136:139], v[216:219], v[80:83]
    ds_read_b128 v[212:215], v9 offset:10240
    v_mfma_f32_16x16x32_bf16 v[84:87], v[140:143], v[216:219], v[84:87]
    buffer_load_dwordx4 v[132:135], v26, s[68:71], s19 offen offset:1024 sc1
    s_waitcnt lgkmcnt(6)
    v_mfma_f32_16x16x32_bf16 v[88:91], v[136:139], v[220:223], v[88:91]
    ds_read_b128 v[216:219], v9 offset:12288
    v_mfma_f32_16x16x32_bf16 v[92:95], v[140:143], v[220:223], v[92:95]
    s_waitcnt vmcnt(12) lgkmcnt(6)
    v_mfma_f32_16x16x32_bf16 v[64:67], v[144:147], v[192:195], v[64:67]
    ds_read_b128 v[220:223], v9 offset:14336
    v_mfma_f32_16x16x32_bf16 v[68:71], v[148:151], v[192:195], v[68:71]
    buffer_load_dwordx4 v[136:139], v26, s[68:71], s19 offen offset:2048 sc1
    s_waitcnt lgkmcnt(6)
    v_mfma_f32_16x16x32_bf16 v[72:75], v[144:147], v[196:199], v[72:75]
    ds_read_b128 v[192:195], v8 offset:16384
    v_mfma_f32_16x16x32_bf16 v[76:79], v[148:151], v[196:199], v[76:79]
    s_waitcnt lgkmcnt(6)
    v_mfma_f32_16x16x32_bf16 v[80:83], v[144:147], v[200:203], v[80:83]
    ds_read_b128 v[196:199], v8 offset:18432
    v_mfma_f32_16x16x32_bf16 v[84:87], v[148:151], v[200:203], v[84:87]
    buffer_load_dwordx4 v[140:143], v26, s[68:71], s19 offen offset:3072 sc1
    s_waitcnt lgkmcnt(6)
    v_mfma_f32_16x16x32_bf16 v[88:91], v[144:147], v[204:207], v[88:91]
    ds_read_b128 v[200:203], v8 offset:20480
    v_mfma_f32_16x16x32_bf16 v[92:95], v[148:151], v[204:207], v[92:95]
    s_waitcnt vmcnt(12) lgkmcnt(6)
    v_mfma_f32_16x16x32_bf16 v[64:67], v[152:155], v[208:211], v[64:67]
    ds_read_b128 v[204:207], v8 offset:22528
    v_mfma_f32_16x16x32_bf16 v[68:71], v[156:159], v[208:211], v[68:71]
    buffer_load_dwordx4 v[144:147], v27, s[68:71], s19 offen offset:0 sc1
    s_waitcnt lgkmcnt(6)
    v_mfma_f32_16x16x32_bf16 v[72:75], v[152:155], v[212:215], v[72:75]
    ds_read_b128 v[208:211], v9 offset:16384
    v_mfma_f32_16x16x32_bf16 v[76:79], v[156:159], v[212:215], v[76:79]
    s_waitcnt lgkmcnt(6)
    v_mfma_f32_16x16x32_bf16 v[80:83], v[152:155], v[216:219], v[80:83]
    ds_read_b128 v[212:215], v9 offset:18432
    v_mfma_f32_16x16x32_bf16 v[84:87], v[156:159], v[216:219], v[84:87]
    buffer_load_dwordx4 v[148:151], v27, s[68:71], s19 offen offset:1024 sc1
    s_waitcnt lgkmcnt(6)
    v_mfma_f32_16x16x32_bf16 v[88:91], v[152:155], v[220:223], v[88:91]
    ds_read_b128 v[216:219], v9 offset:20480
    v_mfma_f32_16x16x32_bf16 v[92:95], v[156:159], v[220:223], v[92:95]
    s_waitcnt vmcnt(12) lgkmcnt(6)
    v_mfma_f32_16x16x32_bf16 v[64:67], v[160:163], v[192:195], v[64:67]
    ds_read_b128 v[220:223], v9 offset:22528
    v_mfma_f32_16x16x32_bf16 v[68:71], v[164:167], v[192:195], v[68:71]
    buffer_load_dwordx4 v[152:155], v27, s[68:71], s19 offen offset:2048 sc1
    s_waitcnt lgkmcnt(6)
    v_mfma_f32_16x16x32_bf16 v[72:75], v[160:163], v[196:199], v[72:75]
    ds_read_b128 v[192:195], v8 offset:24576
    v_mfma_f32_16x16x32_bf16 v[76:79], v[164:167], v[196:199], v[76:79]
    s_waitcnt lgkmcnt(6)
    v_mfma_f32_16x16x32_bf16 v[80:83], v[160:163], v[200:203], v[80:83]
    ds_read_b128 v[196:199], v8 offset:26624
    v_mfma_f32_16x16x32_bf16 v[84:87], v[164:167], v[200:203], v[84:87]
    buffer_load_dwordx4 v[156:159], v27, s[68:71], s19 offen offset:3072 sc1
    s_waitcnt lgkmcnt(6)
    v_mfma_f32_16x16x32_bf16 v[88:91], v[160:163], v[204:207], v[88:91]
    ds_read_b128 v[200:203], v8 offset:28672
    s_bfe_u32 s19, s101, 20 + (4 << 16)
    v_mfma_f32_16x16x32_bf16 v[92:95], v[164:167], v[204:207], v[92:95]
    s_lshl_b32 s19, s19, 13
    s_waitcnt vmcnt(12) lgkmcnt(6)
    v_mfma_f32_16x16x32_bf16 v[64:67], v[168:171], v[208:211], v[64:67]
    ds_read_b128 v[204:207], v8 offset:30720
    v_mfma_f32_16x16x32_bf16 v[68:71], v[172:175], v[208:211], v[68:71]
    buffer_load_dwordx4 v[160:163], v26, s[68:71], s19 offen offset:0 sc1
    s_waitcnt lgkmcnt(6)
    v_mfma_f32_16x16x32_bf16 v[72:75], v[168:171], v[212:215], v[72:75]
    ds_read_b128 v[208:211], v9 offset:24576
    v_mfma_f32_16x16x32_bf16 v[76:79], v[172:175], v[212:215], v[76:79]
    s_waitcnt lgkmcnt(6)
    v_mfma_f32_16x16x32_bf16 v[80:83], v[168:171], v[216:219], v[80:83]
    ds_read_b128 v[212:215], v9 offset:26624
    v_mfma_f32_16x16x32_bf16 v[84:87], v[172:175], v[216:219], v[84:87]
    buffer_load_dwordx4 v[164:167], v26, s[68:71], s19 offen offset:1024 sc1
    s_waitcnt lgkmcnt(6)
    v_mfma_f32_16x16x32_bf16 v[88:91], v[168:171], v[220:223], v[88:91]
    ds_read_b128 v[216:219], v9 offset:28672
    v_mfma_f32_16x16x32_bf16 v[92:95], v[172:175], v[220:223], v[92:95]
    s_waitcnt vmcnt(12) lgkmcnt(6)
    v_mfma_f32_16x16x32_bf16 v[64:67], v[176:179], v[192:195], v[64:67]
    ds_read_b128 v[220:223], v9 offset:30720
    v_mfma_f32_16x16x32_bf16 v[68:71], v[180:183], v[192:195], v[68:71]
    buffer_load_dwordx4 v[168:171], v26, s[68:71], s19 offen offset:2048 sc1
    s_waitcnt lgkmcnt(6)
    v_mfma_f32_16x16x32_bf16 v[72:75], v[176:179], v[196:199], v[72:75]
    ds_read_b128 v[192:195], v6 offset:0
    v_mfma_f32_16x16x32_bf16 v[76:79], v[180:183], v[196:199], v[76:79]
    s_waitcnt lgkmcnt(6)
    v_mfma_f32_16x16x32_bf16 v[80:83], v[176:179], v[200:203], v[80:83]
    ds_read_b128 v[196:199], v6 offset:2048
    v_mfma_f32_16x16x32_bf16 v[84:87], v[180:183], v[200:203], v[84:87]
    buffer_load_dwordx4 v[172:175], v26, s[68:71], s19 offen offset:3072 sc1
    s_waitcnt lgkmcnt(6)
    v_mfma_f32_16x16x32_bf16 v[88:91], v[176:179], v[204:207], v[88:91]
    ds_read_b128 v[200:203], v6 offset:4096
    v_mfma_f32_16x16x32_bf16 v[92:95], v[180:183], v[204:207], v[92:95]
    s_waitcnt vmcnt(12) lgkmcnt(6)
    v_mfma_f32_16x16x32_bf16 v[64:67], v[184:187], v[208:211], v[64:67]
    ds_read_b128 v[204:207], v6 offset:6144
    v_mfma_f32_16x16x32_bf16 v[68:71], v[188:191], v[208:211], v[68:71]
    buffer_load_dwordx4 v[176:179], v27, s[68:71], s19 offen offset:0 sc1
    s_waitcnt lgkmcnt(6)
    v_mfma_f32_16x16x32_bf16 v[72:75], v[184:187], v[212:215], v[72:75]
    ds_read_b128 v[208:211], v7 offset:0
    ds_read_b32 v18, v11 offset:68
    v_mfma_f32_16x16x32_bf16 v[76:79], v[188:191], v[212:215], v[76:79]
    s_waitcnt lgkmcnt(7)
    v_mfma_f32_16x16x32_bf16 v[80:83], v[184:187], v[216:219], v[80:83]
    ds_read_b128 v[212:215], v7 offset:2048
    v_mfma_f32_16x16x32_bf16 v[84:87], v[188:191], v[216:219], v[84:87]
    buffer_load_dwordx4 v[180:183], v27, s[68:71], s19 offen offset:1024 sc1
    s_waitcnt lgkmcnt(7)
    v_mfma_f32_16x16x32_bf16 v[88:91], v[184:187], v[220:223], v[88:91]
    ds_read_b128 v[216:219], v7 offset:4096
    v_mfma_f32_16x16x32_bf16 v[92:95], v[188:191], v[220:223], v[92:95]
    s_waitcnt vmcnt(12) lgkmcnt(7)
    v_mfma_f32_16x16x32_bf16 v[64:67], v[128:131], v[192:195], v[64:67]
    ds_read_b128 v[220:223], v7 offset:6144
    v_mfma_f32_16x16x32_bf16 v[68:71], v[132:135], v[192:195], v[68:71]
    buffer_load_dwordx4 v[184:187], v27, s[68:71], s19 offen offset:2048 sc1
    s_waitcnt lgkmcnt(7)
    v_mfma_f32_16x16x32_bf16 v[72:75], v[128:131], v[196:199], v[72:75]
    ds_read_b128 v[192:195], v6 offset:8192
    v_mfma_f32_16x16x32_bf16 v[76:79], v[132:135], v[196:199], v[76:79]
    s_waitcnt lgkmcnt(7)
    v_mfma_f32_16x16x32_bf16 v[80:83], v[128:131], v[200:203], v[80:83]
    ds_read_b128 v[196:199], v6 offset:10240
    v_add_u32 v8, 32768, v8
    v_mfma_f32_16x16x32_bf16 v[84:87], v[132:135], v[200:203], v[84:87]
    buffer_load_dwordx4 v[188:191], v27, s[68:71], s19 offen offset:3072 sc1
    s_waitcnt lgkmcnt(7)
    v_mfma_f32_16x16x32_bf16 v[88:91], v[128:131], v[204:207], v[88:91]
    ds_read_b128 v[200:203], v6 offset:12288
    s_bfe_u32 s19, s101, 24 + (4 << 16)
    v_mfma_f32_16x16x32_bf16 v[92:95], v[132:135], v[204:207], v[92:95]
    s_lshl_b32 s19, s19, 13
    s_waitcnt vmcnt(12) lgkmcnt(7)
    v_mfma_f32_16x16x32_bf16 v[64:67], v[136:139], v[208:211], v[64:67]
    ds_read_b128 v[204:207], v6 offset:14336
    v_add_u32 v9, 32768, v9
    v_mfma_f32_16x16x32_bf16 v[68:71], v[140:143], v[208:211], v[68:71]
    buffer_load_dwordx4 v[128:131], v26, s[68:71], s19 offen offset:0 sc1
    s_waitcnt lgkmcnt(6)
    v_mfma_f32_16x16x32_bf16 v[72:75], v[136:139], v[212:215], v[72:75]
    ds_read_b128 v[208:211], v7 offset:8192
    v_cmp_gt_u32 vcc, 4, v18
    v_mfma_f32_16x16x32_bf16 v[76:79], v[140:143], v[212:215], v[76:79]
    s_waitcnt lgkmcnt(6)
    v_mfma_f32_16x16x32_bf16 v[80:83], v[136:139], v[216:219], v[80:83]
    ds_read_b128 v[212:215], v7 offset:10240
    v_mfma_f32_16x16x32_bf16 v[84:87], v[140:143], v[216:219], v[84:87]
    buffer_load_dwordx4 v[132:135], v26, s[68:71], s19 offen offset:1024 sc1
    s_waitcnt lgkmcnt(6)
    v_mfma_f32_16x16x32_bf16 v[88:91], v[136:139], v[220:223], v[88:91]
    ds_read_b128 v[216:219], v7 offset:12288
    s_cbranch_vccnz G2_slowc
G2_backc:
    v_mfma_f32_16x16x32_bf16 v[92:95], v[140:143], v[220:223], v[92:95]
    s_waitcnt vmcnt(12) lgkmcnt(6)
    v_mfma_f32_16x16x32_bf16 v[64:67], v[144:147], v[192:195], v[64:67]
    ds_read_b128 v[220:223], v7 offset:14336
    v_mfma_f32_16x16x32_bf16 v[68:71], v[148:151], v[192:195], v[68:71]
    buffer_load_dwordx4 v[136:139], v26, s[68:71], s19 offen offset:2048 sc1
    s_waitcnt lgkmcnt(6)
    v_mfma_f32_16x16x32_bf16 v[72:75], v[144:147], v[196:199], v[72:75]
    ds_read_b128 v[192:195], v8 offset:0
    v_mfma_f32_16x16x32_bf16 v[76:79], v[148:151], v[196:199], v[76:79]
    s_waitcnt lgkmcnt(6)
    v_mfma_f32_16x16x32_bf16 v[80:83], v[144:147], v[200:203], v[80:83]
    ds_read_b128 v[196:199], v8 offset:2048
    v_mfma_f32_16x16x32_bf16 v[84:87], v[148:151], v[200:203], v[84:87]
    buffer_load_dwordx4 v[140:143], v26, s[68:71], s19 offen offset:3072 sc1
    s_waitcnt lgkmcnt(6)
    v_mfma_f32_16x16x32_bf16 v[88:91], v[144:147], v[204:207], v[88:91]
    ds_read_b128 v[200:203], v8 offset:25856
    v_mfma_f32_16x16x32_bf16 v[92:95], v[148:151], v[204:207], v[92:95]
    s_waitcnt vmcnt(12) lgkmcnt(6)
    v_mfma_f32_16x16x32_bf16 v[64:67], v[152:155], v[208:211], v[64:67]
    ds_read_b128 v[204:207], v8 offset:27904
    v_mfma_f32_16x16x32_bf16 v[68:71], v[156:159], v[208:211], v[68:71]
    buffer_load_dwordx4 v[144:147], v27, s[68:71], s19 offen offset:0 sc1
    s_waitcnt lgkmcnt(6)
    v_mfma_f32_16x16x32_bf16 v[72:75], v[152:155], v[212:215], v[72:75]
    ds_read_b128 v[208:211], v9 offset:0
    v_mfma_f32_16x16x32_bf16 v[76:79], v[156:159], v[212:215], v[76:79]
    s_waitcnt lgkmcnt(6)
    v_mfma_f32_16x16x32_bf16 v[80:83], v[152:155], v[216:219], v[80:83]
    ds_read_b128 v[212:215], v9 offset:2048
    v_mfma_f32_16x16x32_bf16 v[84:87], v[156:159], v[216:219], v[84:87]
    buffer_load_dwordx4 v[148:151], v27, s[68:71], s19 offen offset:1024 sc1
    s_waitcnt lgkmcnt(6)
    v_mfma_f32_16x16x32_bf16 v[88:91], v[152:155], v[220:223], v[88:91]
    ds_read_b128 v[216:219], v9 offset:25856
    v_mfma_f32_16x16x32_bf16 v[92:95], v[156:159], v[220:223], v[92:95]
    s_waitcnt vmcnt(12) lgkmcnt(6)
    v_mfma_f32_16x16x32_bf16 v[64:67], v[160:163], v[192:195], v[64:67]
    ds_read_b128 v[220:223], v9 offset:27904
    v_mfma_f32_16x16x32_bf16 v[68:71], v[164:167], v[192:195], v[68:71]
    buffer_load_dwordx4 v[152:155], v27, s[68:71], s19 offen offset:2048 sc1
    s_waitcnt lgkmcnt(6)
    v_mfma_f32_16x16x32_bf16 v[72:75], v[160:163], v[196:199], v[72:75]
    ds_read_b128 v[192:195], v8 offset:12928
    v_mfma_f32_16x16x32_bf16 v[76:79], v[164:167], v[196:199], v[76:79]
    s_waitcnt lgkmcnt(6)
    v_mfma_f32_16x16x32_bf16 v[80:83], v[160:163], v[200:203], v[80:83]
    ds_read_b128 v[196:199], v8 offset:14976
    v_mfma_f32_16x16x32_bf16 v[84:87], v[164:167], v[200:203], v[84:87]
    buffer_load_dwordx4 v[156:159], v27, s[68:71], s19 offen offset:3072 sc1
    s_waitcnt lgkmcnt(6)
    v_mfma_f32_16x16x32_bf16 v[88:91], v[160:163], v[204:207], v[88:91]
    ds_read_b128 v[200:203], v8 offset:38784
    s_bfe_u32 s19, s101, 28 + (4 << 16)
    v_mfma_f32_16x16x32_bf16 v[92:95], v[164:167], v[204:207], v[92:95]
    s_lshl_b32 s19, s19, 13
    s_waitcnt vmcnt(12) lgkmcnt(6)
    v_mfma_f32_16x16x32_bf16 v[64:67], v[168:171], v[208:211], v[64:67]
    ds_read_b128 v[204:207], v8 offset:40832
    v_mfma_f32_16x16x32_bf16 v[68:71], v[172:175], v[208:211], v[68:71]
    buffer_load_dwordx4 v[160:163], v26, s[68:71], s19 offen offset:0 sc1
    s_waitcnt lgkmcnt(6)
    v_mfma_f32_16x16x32_bf16 v[72:75], v[168:171], v[212:215], v[72:75]
    ds_read_b128 v[208:211], v9 offset:12928
    v_mfma_f32_16x16x32_bf16 v[76:79], v[172:175], v[212:215], v[76:79]
    s_waitcnt lgkmcnt(6)
    v_mfma_f32_16x16x32_bf16 v[80:83], v[168:171], v[216:219], v[80:83]
    ds_read_b128 v[212:215], v9 offset:14976
    v_mfma_f32_16x16x32_bf16 v[84:87], v[172:175], v[216:219], v[84:87]
    buffer_load_dwordx4 v[164:167], v26, s[68:71], s19 offen offset:1024 sc1
    s_waitcnt lgkmcnt(6)
    v_mfma_f32_16x16x32_bf16 v[88:91], v[168:171], v[220:223], v[88:91]
    ds_read_b128 v[216:219], v9 offset:38784
    v_mfma_f32_16x16x32_bf16 v[92:95], v[172:175], v[220:223], v[92:95]
    s_waitcnt vmcnt(12) lgkmcnt(6)
    v_mfma_f32_16x16x32_bf16 v[64:67], v[176:179], v[192:195], v[64:67]
    ds_read_b128 v[220:223], v9 offset:40832
    v_mfma_f32_16x16x32_bf16 v[68:71], v[180:183], v[192:195], v[68:71]
    buffer_load_dwordx4 v[168:171], v26, s[68:71], s19 offen offset:2048 sc1
    s_waitcnt lgkmcnt(6)
    v_mfma_f32_16x16x32_bf16 v[72:75], v[176:179], v[196:199], v[72:75]
    ds_read_b128 v[192:195], v8 offset:4096
    v_mfma_f32_16x16x32_bf16 v[76:79], v[180:183], v[196:199], v[76:79]
    s_waitcnt lgkmcnt(6)
    v_mfma_f32_16x16x32_bf16 v[80:83], v[176:179], v[200:203], v[80:83]
    ds_read_b128 v[196:199], v8 offset:6144
    v_mfma_f32_16x16x32_bf16 v[84:87], v[180:183], v[200:203], v[84:87]
    buffer_load_dwordx4 v[172:175], v26, s[68:71], s19 offen offset:3072 sc1
    s_waitcnt lgkmcnt(6)
    v_mfma_f32_16x16x32_bf16 v[88:91], v[176:179], v[204:207], v[88:91]
    ds_read_b128 v[200:203], v8 offset:29952
    v_mfma_f32_16x16x32_bf16 v[92:95], v[180:183], v[204:207], v[92:95]
    s_waitcnt vmcnt(12) lgkmcnt(6)
    v_mfma_f32_16x16x32_bf16 v[64:67], v[184:187], v[208:211], v[64:67]
    ds_read_b128 v[204:207], v8 offset:32000
    v_mfma_f32_16x16x32_bf16 v[68:71], v[188:191], v[208:211], v[68:71]
    buffer_load_dwordx4 v[176:179], v27, s[68:71], s19 offen offset:0 sc1
    s_waitcnt lgkmcnt(6)
    v_mfma_f32_16x16x32_bf16 v[72:75], v[184:187], v[212:215], v[72:75]
    ds_read_b128 v[208:211], v9 offset:4096
    v_mfma_f32_16x16x32_bf16 v[76:79], v[188:191], v[212:215], v[76:79]
    s_waitcnt lgkmcnt(6)
    v_mfma_f32_16x16x32_bf16 v[80:83], v[184:187], v[216:219], v[80:83]
    ds_read_b128 v[212:215], v9 offset:6144
    v_mfma_f32_16x16x32_bf16 v[84:87], v[188:191], v[216:219], v[84:87]
    buffer_load_dwordx4 v[180:183], v27, s[68:71], s19 offen offset:1024 sc1
    s_waitcnt lgkmcnt(6)
    v_mfma_f32_16x16x32_bf16 v[88:91], v[184:187], v[220:223], v[88:91]
    ds_read_b128 v[216:219], v9 offset:29952
    v_mfma_f32_16x16x32_bf16 v[92:95], v[188:191], v[220:223], v[92:95]
    s_waitcnt vmcnt(12) lgkmcnt(6)
    v_mfma_f32_16x16x32_bf16 v[64:67], v[128:131], v[192:195], v[64:67]
    ds_read_b128 v[220:223], v9 offset:32000
    v_mfma_f32_16x16x32_bf16 v[68:71], v[132:135], v[192:195], v[68:71]
    buffer_load_dwordx4 v[184:187], v27, s[68:71], s19 offen offset:2048 sc1
    s_waitcnt lgkmcnt(6)
    v_mfma_f32_16x16x32_bf16 v[72:75], v[128:131], v[196:199], v[72:75]
    ds_read_b128 v[192:195], v8 offset:17024
    v_mfma_f32_16x16x32_bf16 v[76:79], v[132:135], v[196:199], v[76:79]
    s_waitcnt lgkmcnt(6)
    v_mfma_f32_16x16x32_bf16 v[80:83], v[128:131], v[200:203], v[80:83]
    ds_read_b128 v[196:199], v8 offset:19072
    v_mfma_f32_16x16x32_bf16 v[84:87], v[132:135], v[200:203], v[84:87]
    buffer_load_dwordx4 v[188:191], v27, s[68:71], s19 offen offset:3072 sc1
    s_waitcnt lgkmcnt(6)
    v_mfma_f32_16x16x32_bf16 v[88:91], v[128:131], v[204:207], v[88:91]
    ds_read_b128 v[200:203], v8 offset:42880
    v_mfma_f32_16x16x32_bf16 v[92:95], v[132:135], v[204:207], v[92:95]
    s_waitcnt vmcnt(12) lgkmcnt(6)
    v_mfma_f32_16x16x32_bf16 v[64:67], v[136:139], v[208:211], v[64:67]
    ds_read_b128 v[204:207], v8 offset:44928
    v_mfma_f32_16x16x32_bf16 v[68:71], v[140:143], v[208:211], v[68:71]
    s_waitcnt lgkmcnt(6)
    v_mfma_f32_16x16x32_bf16 v[72:75], v[136:139], v[212:215], v[72:75]
    ds_read_b128 v[208:211], v9 offset:17024
    v_mfma_f32_16x16x32_bf16 v[76:79], v[140:143], v[212:215], v[76:79]
    s_waitcnt lgkmcnt(6)
    v_mfma_f32_16x16x32_bf16 v[80:83], v[136:139], v[216:219], v[80:83]
    ds_read_b128 v[212:215], v9 offset:19072
    v_mfma_f32_16x16x32_bf16 v[84:87], v[140:143], v[216:219], v[84:87]
    s_waitcnt lgkmcnt(6)
    v_mfma_f32_16x16x32_bf16 v[88:91], v[136:139], v[220:223], v[88:91]
    ds_read_b128 v[216:219], v9 offset:42880
    v_mfma_f32_16x16x32_bf16 v[92:95], v[140:143], v[220:223], v[92:95]
    s_waitcnt vmcnt(10) lgkmcnt(6)
    v_mfma_f32_16x16x32_bf16 v[64:67], v[144:147], v[192:195], v[64:67]
    ds_read_b128 v[220:223], v9 offset:44928
    v_mfma_f32_16x16x32_bf16 v[68:71], v[148:151], v[192:195], v[68:71]
    s_waitcnt lgkmcnt(6)
    v_mfma_f32_16x16x32_bf16 v[72:75], v[144:147], v[196:199], v[72:75]
    ds_read_b128 v[192:195], v8 offset:8192
    v_mfma_f32_16x16x32_bf16 v[76:79], v[148:151], v[196:199], v[76:79]
    s_waitcnt lgkmcnt(6)
    v_mfma_f32_16x16x32_bf16 v[80:83], v[144:147], v[200:203], v[80:83]
    ds_read_b128 v[196:199], v8 offset:10240
    v_mfma_f32_16x16x32_bf16 v[84:87], v[148:151], v[200:203], v[84:87]
    s_waitcnt lgkmcnt(6)
    v_mfma_f32_16x16x32_bf16 v[88:91], v[144:147], v[204:207], v[88:91]
    ds_read_b128 v[200:203], v8 offset:34048
    v_mfma_f32_16x16x32_bf16 v[92:95], v[148:151], v[204:207], v[92:95]
    s_waitcnt vmcnt(8) lgkmcnt(6)
    v_mfma_f32_16x16x32_bf16 v[64:67], v[152:155], v[208:211], v[64:67]
    ds_read_b128 v[204:207], v8 offset:36096
    v_mfma_f32_16x16x32_bf16 v[68:71], v[156:159], v[208:211], v[68:71]
    s_waitcnt lgkmcnt(6)
    v_mfma_f32_16x16x32_bf16 v[72:75], v[152:155], v[212:215], v[72:75]
    ds_read_b128 v[208:211], v9 offset:8192
    v_mfma_f32_16x16x32_bf16 v[76:79], v[156:159], v[212:215], v[76:79]
    s_waitcnt lgkmcnt(6)
    v_mfma_f32_16x16x32_bf16 v[80:83], v[152:155], v[216:219], v[80:83]
    ds_read_b128 v[212:215], v9 offset:10240
    v_mfma_f32_16x16x32_bf16 v[84:87], v[156:159], v[216:219], v[84:87]
    s_waitcnt lgkmcnt(6)
    v_mfma_f32_16x16x32_bf16 v[88:91], v[152:155], v[220:223], v[88:91]
    ds_read_b128 v[216:219], v9 offset:34048
    v_mfma_f32_16x16x32_bf16 v[92:95], v[156:159], v[220:223], v[92:95]
    s_waitcnt vmcnt(6) lgkmcnt(6)
    v_mfma_f32_16x16x32_bf16 v[64:67], v[160:163], v[192:195], v[64:67]
    ds_read_b128 v[220:223], v9 offset:36096
    v_mfma_f32_16x16x32_bf16 v[68:71], v[164:167], v[192:195], v[68:71]
    s_waitcnt lgkmcnt(6)
    v_mfma_f32_16x16x32_bf16 v[72:75], v[160:163], v[196:199], v[72:75]
    ds_read_b128 v[192:195], v8 offset:21120
    v_mfma_f32_16x16x32_bf16 v[76:79], v[164:167], v[196:199], v[76:79]
    s_waitcnt lgkmcnt(6)
    v_mfma_f32_16x16x32_bf16 v[80:83], v[160:163], v[200:203], v[80:83]
    ds_read_b128 v[196:199], v8 offset:23168
    v_mfma_f32_16x16x32_bf16 v[84:87], v[164:167], v[200:203], v[84:87]
    s_waitcnt lgkmcnt(6)
    v_mfma_f32_16x16x32_bf16 v[88:91], v[160:163], v[204:207], v[88:91]
    ds_read_b128 v[200:203], v8 offset:46976
    v_mfma_f32_16x16x32_bf16 v[92:95], v[164:167], v[204:207], v[92:95]
    s_waitcnt vmcnt(4) lgkmcnt(6)
    v_mfma_f32_16x16x32_bf16 v[64:67], v[168:171], v[208:211], v[64:67]
    ds_read_b128 v[204:207], v8 offset:49024
    v_mfma_f32_16x16x32_bf16 v[68:71], v[172:175], v[208:211], v[68:71]
    s_waitcnt lgkmcnt(6)
    v_mfma_f32_16x16x32_bf16 v[72:75], v[168:171], v[212:215], v[72:75]
    ds_read_b128 v[208:211], v9 offset:21120
    v_mfma_f32_16x16x32_bf16 v[76:79], v[172:175], v[212:215], v[76:79]
    s_waitcnt lgkmcnt(6)
    v_mfma_f32_16x16x32_bf16 v[80:83], v[168:171], v[216:219], v[80:83]
    ds_read_b128 v[212:215], v9 offset:23168
    v_mfma_f32_16x16x32_bf16 v[84:87], v[172:175], v[216:219], v[84:87]
    s_waitcnt lgkmcnt(6)
    v_mfma_f32_16x16x32_bf16 v[88:91], v[168:171], v[220:223], v[88:91]
    ds_read_b128 v[216:219], v9 offset:46976
    v_mfma_f32_16x16x32_bf16 v[92:95], v[172:175], v[220:223], v[92:95]
    s_waitcnt vmcnt(2) lgkmcnt(6)
    v_mfma_f32_16x16x32_bf16 v[64:67], v[176:179], v[192:195], v[64:67]
    ds_read_b128 v[220:223], v9 offset:49024
    v_mfma_f32_16x16x32_bf16 v[68:71], v[180:183], v[192:195], v[68:71]
    s_waitcnt lgkmcnt(6)
    v_mfma_f32_16x16x32_bf16 v[72:75], v[176:179], v[196:199], v[72:75]
    v_mfma_f32_16x16x32_bf16 v[76:79], v[180:183], v[196:199], v[76:79]
    s_waitcnt lgkmcnt(5)
    v_mfma_f32_16x16x32_bf16 v[80:83], v[176:179], v[200:203], v[80:83]
    v_mfma_f32_16x16x32_bf16 v[84:87], v[180:183], v[200:203], v[84:87]
    s_waitcnt lgkmcnt(4)
    v_mfma_f32_16x16x32_bf16 v[88:91], v[176:179], v[204:207], v[88:91]
    v_mfma_f32_16x16x32_bf16 v[92:95], v[180:183], v[204:207], v[92:95]
    s_waitcnt vmcnt(0) lgkmcnt(3)
    v_mfma_f32_16x16x32_bf16 v[64:67], v[184:187], v[208:211], v[64:67]
    v_mfma_f32_16x16x32_bf16 v[68:71], v[188:191], v[208:211], v[68:71]
    s_waitcnt lgkmcnt(2)
    v_mfma_f32_16x16x32_bf16 v[72:75], v[184:187], v[212:215], v[72:75]
    v_mfma_f32_16x16x32_bf16 v[76:79], v[188:191], v[212:215], v[76:79]
    s_waitcnt lgkmcnt(1)
    v_mfma_f32_16x16x32_bf16 v[80:83], v[184:187], v[216:219], v[80:83]
    v_mfma_f32_16x16x32_bf16 v[84:87], v[188:191], v[216:219], v[84:87]
    s_waitcnt lgkmcnt(0)
    v_mfma_f32_16x16x32_bf16 v[88:91], v[184:187], v[220:223], v[88:91]
    v_mfma_f32_16x16x32_bf16 v[92:95], v[188:191], v[220:223], v[92:95]
    s_lshl_b32 s10, s6, 7
    s_lshl_b32 s11, s3, 5
    s_add_u32 s10, s10, s11
    v_lshrrev_b32 v32, 4, v2
    v_lshl_add_u32 v32, v32, 2, s10
    s_lshl_b32 s10, s7, 8
    s_add_u32 s10, s10, 4096
    v_and_b32 v33, 15, v2
    v_lshl_add_u32 v33, v33, 4, s10
    v_lshl_add_u32 v32, v32, 13, v33
    v_mov_b32 v224, v64
    v_mov_b32 v225, v72
    v_mov_b32 v226, v80
    v_mov_b32 v227, v88
    s_mov_b32 s10, 0
    buffer_store_dwordx4 v[224:227], v32, s[60:63], s10 offen sc1
    v_mov_b32 v228, v65
    v_mov_b32 v229, v73
    v_mov_b32 v230, v81
    v_mov_b32 v231, v89
    s_mov_b32 s10, 8192
    buffer_store_dwordx4 v[228:231], v32, s[60:63], s10 offen sc1
    v_mov_b32 v232, v66
    v_mov_b32 v233, v74
    v_mov_b32 v234, v82
    v_mov_b32 v235, v90
    s_mov_b32 s10, 16384
    buffer_store_dwordx4 v[232:235], v32, s[60:63], s10 offen sc1
    v_mov_b32 v236, v67
    v_mov_b32 v237, v75
    v_mov_b32 v238, v83
    v_mov_b32 v239, v91
    s_mov_b32 s10, 24576
    buffer_store_dwordx4 v[236:239], v32, s[60:63], s10 offen sc1
    v_mov_b32 v240, v68
    v_mov_b32 v241, v76
    v_mov_b32 v242, v84
    v_mov_b32 v243, v92
    s_mov_b32 s10, 131072
    buffer_store_dwordx4 v[240:243], v32, s[60:63], s10 offen sc1
    v_mov_b32 v244, v69
    v_mov_b32 v245, v77
    v_mov_b32 v246, v85
    v_mov_b32 v247, v93
    s_mov_b32 s10, 139264
    buffer_store_dwordx4 v[244:247], v32, s[60:63], s10 offen sc1
    v_mov_b32 v248, v70
    v_mov_b32 v249, v78
    v_mov_b32 v250, v86
    v_mov_b32 v251, v94
    s_mov_b32 s10, 147456
    buffer_store_dwordx4 v[248:251], v32, s[60:63], s10 offen sc1
    v_mov_b32 v252, v71
    v_mov_b32 v253, v79
    v_mov_b32 v254, v87
    v_mov_b32 v255, v95
    s_mov_b32 s10, 155648
    buffer_store_dwordx4 v[252:255], v32, s[60:63], s10 offen sc1
    s_waitcnt vmcnt(0) lgkmcnt(0)
    s_endpgm
G2_slow3:
    s_mov_b32 s15, 0
G2_sl3_w:
    ds_read_b128 v[12:15], v11 offset:0
    s_waitcnt lgkmcnt(0)
    v_min3_u32 v12, v12, v13, v14
    v_min_u32 v12, v12, v15
    v_cmp_gt_u32 vcc, 20, v12
    s_cbranch_vccz G2_sl3_ok
    s_add_u32 s15, s15, 1
    s_cmp_lt_u32 s15, 160000
    s_cbranch_scc1 G2_sl3_w
G2_sl3_ok:
    s_branch G2_back3
G2_slow4:
    s_mov_b32 s15, 0
G2_sl4_w:
    ds_read_b128 v[12:15], v11 offset:0
    s_waitcnt lgkmcnt(0)
    v_min3_u32 v12, v12, v13, v14
    v_min_u32 v12, v12, v15
    v_cmp_gt_u32 vcc, 21, v12
    s_cbranch_vccz G2_sl4_ok
    s_add_u32 s15, s15, 1
    s_cmp_lt_u32 s15, 160000
    s_cbranch_scc1 G2_sl4_w
G2_sl4_ok:
    s_branch G2_back4
G2_slow5:
    s_mov_b32 s15, 0
G2_sl5_w:
    ds_read_b128 v[12:15], v11 offset:0
    s_waitcnt lgkmcnt(0)
    v_min3_u32 v12, v12, v13, v14
    v_min_u32 v12, v12, v15
    v_cmp_gt_u32 vcc, 22, v12
    s_cbranch_vccz G2_sl5_ok
    s_add_u32 s15, s15, 1
    s_cmp_lt_u32 s15, 160000
    s_cbranch_scc1 G2_sl5_w
G2_sl5_ok:
    s_branch G2_back5
G2_slow6:
    s_mov_b32 s15, 0
G2_sl6_w:
    ds_read_b128 v[12:15], v11 offset:0
    s_waitcnt lgkmcnt(0)
    v_min3_u32 v12, v12, v13, v14
    v_min_u32 v12, v12, v15
    v_cmp_gt_u32 vcc, 23, v12
    s_cbranch_vccz G2_sl6_ok
    s_add_u32 s15, s15, 1
    s_cmp_lt_u32 s15, 160000
    s_cbranch_scc1 G2_sl6_w
G2_sl6_ok:
    s_branch G2_back6
G2_slow7:
    s_mov_b32 s15, 0
G2_sl7_w:
    ds_read_b128 v[12:15], v11 offset:0
    s_waitcnt lgkmcnt(0)
    v_min3_u32 v12, v12, v13, v14
    v_min_u32 v12, v12, v15
    v_cmp_gt_u32 vcc, 24, v12
    s_cbranch_vccz G2_sl7_ok
    s_add_u32 s15, s15, 1
    s_cmp_lt_u32 s15, 160000
    s_cbranch_scc1 G2_sl7_w
G2_sl7_ok:
    s_branch G2_back7
G2_slow8:
    s_mov_b32 s15, 0
G2_sl8_w:
    ds_read_b128 v[12:15], v11 offset:0
    s_waitcnt lgkmcnt(0)
    v_min3_u32 v12, v12, v13, v14
    v_min_u32 v12, v12, v15
    v_cmp_gt_u32 vcc, 25, v12
    s_cbranch_vccz G2_sl8_ok
    s_add_u32 s15, s15, 1
    s_cmp_lt_u32 s15, 160000
    s_cbranch_scc1 G2_sl8_w
G2_sl8_ok:
    s_branch G2_back8
G2_slow10:
    s_mov_b32 s15, 0
G2_sl10_w:
    ds_read_b128 v[12:15], v11 offset:0
    s_waitcnt lgkmcnt(0)
    v_min3_u32 v12, v12, v13, v14
    v_min_u32 v12, v12, v15
    v_cmp_gt_u32 vcc, 27, v12
    s_cbranch_vccz G2_sl10_ok
    s_add_u32 s15, s15, 1
    s_cmp_lt_u32 s15, 160000
    s_cbranch_scc1 G2_sl10_w
G2_sl10_ok:
    s_branch G2_back10
G2_slowc:
    s_mov_b32 s15, 0
G2_slc_w:
    ds_read_b32 v18, v11 offset:68
    s_waitcnt lgkmcnt(0)
    v_cmp_gt_u32 vcc, 4, v18
    s_cbranch_vccz G2_slc_ok
    s_add_u32 s15, s15, 1
    s_cmp_lt_u32 s15, 160000
    s_cbranch_scc1 G2_slc_w
G2_slc_ok:
    s_branch G2_backc
Y_done:
    s_endpgm
Y_end:
.section .rodata,"a"
.p2align 6
.amdhsa_kernel concat_heads__ssm_conv_h3__ssm_conv_s5__prompt_kernel
  .amdhsa_next_free_vgpr 256
  .amdhsa_next_free_sgpr 102
  .amdhsa_accum_offset 256
  .amdhsa_group_segment_fixed_size 0
  .amdhsa_kernarg_size 144
  .amdhsa_user_sgpr_count 2
  .amdhsa_user_sgpr_kernarg_segment_ptr 1
  .amdhsa_system_sgpr_workgroup_id_x 1
.end_amdhsa_kernel
```

```asm
; @launch grid=(256,1,1) block=(512,1,1) lds=163840
.amdgcn_target "amdgcn-amd-amdhsa--gfx950"
.text
.globl concat_heads__ssm_conv_h3__ssm_conv_s5__prompt_kernel
.p2align 8
.type concat_heads__ssm_conv_h3__ssm_conv_s5__prompt_kernel,@function
concat_heads__ssm_conv_h3__ssm_conv_s5__prompt_kernel:
    s_cmp_ge_u32 s2, 256
    s_cbranch_scc1 Y_done
    s_load_dwordx16 s[16:31], s[0:1], 0
    s_load_dwordx16 s[32:47], s[0:1], 64
    s_load_dwordx4 s[48:51], s[0:1], 128
    s_getpc_b64 s[52:53]
Y_pc:
    v_lshrrev_b32 v1, 6, v0
    v_and_b32 v2, 63, v0
    s_and_b32 s4, s2, 7
    v_readfirstlane_b32 s3, v1
    s_lshr_b32 s5, s2, 3
    s_and_b32 s6, s4, 3
    s_lshl_b32 s6, s6, 2
    s_and_b32 s7, s5, 3
    s_add_u32 s6, s6, s7
    s_and_b32 s7, s4, 4
    s_lshl_b32 s7, s7, 1
    s_lshr_b32 s8, s5, 2
    s_add_u32 s7, s7, s8
    s_and_b32 s6, s4, 1
    s_lshl_b32 s6, s6, 3
    s_and_b32 s7, s5, 7
    s_add_u32 s6, s6, s7
    s_and_b32 s7, s4, 6
    s_lshl_b32 s7, s7, 1
    s_lshr_b32 s8, s5, 3
    s_add_u32 s7, s7, s8
    s_lshl_b32 s54, s5, 3
    s_add_u32 s54, s54, s3
    s_lshl_b32 s54, s54, 6
    s_load_dword s56, s[52:53], s54
    s_add_u32 s54, s54, 16384
    s_min_u32 s54, s54, Y_end-Y_pc-4
    s_load_dword s57, s[52:53], s54
    s_add_u32 s13, s5, s8
    s_lshl_b32 s13, s13, 3
    s_and_b32 s9, s4, 6
    s_add_u32 s13, s13, s9
    s_and_b32 s9, s4, 1
    s_lshl_b32 s9, s9, 2
    s_add_u32 s13, s13, s9
    s_and_b32 s13, s13, 15
    s_and_b32 s9, s4, 6
    s_add_u32 s12, s5, s9
    s_lshl_b32 s12, s12, 1
    s_and_b32 s9, s4, 1
    s_add_u32 s12, s12, s9
    s_and_b32 s12, s12, 15
    s_lshl_b32 s13, s13, 7
    s_mov_b32 s100, 0x76543210
    s_mov_b32 s101, 0xfedcba98
    s_lshl_b32 s9, s12, 2
    s_lshr_b64 s[10:11], s[100:101], s9
    s_sub_u32 s9, 64, s9
    s_lshl_b64 s[100:101], s[100:101], s9
    s_or_b64 s[100:101], s[100:101], s[10:11]
    s_sub_u32 s9, s7, s12
    s_and_b32 s9, s9, 15
    s_lshl_b32 s9, s9, 2
    s_bfm_b64 s[10:11], s9, 0
    s_and_b64 s[14:15], s[100:101], s[10:11]
    s_lshl_b64 s[14:15], s[14:15], 4
    s_lshl_b64 s[10:11], s[10:11], 4
    s_or_b32 s10, s10, 15
    s_andn2_b64 s[100:101], s[100:101], s[10:11]
    s_or_b64 s[100:101], s[100:101], s[14:15]
    s_or_b32 s100, s100, s7
    s_cmp_lt_u32 s3, 4
    s_cbranch_scc0 Y_L
    v_and_b32 v3, 31, v2
    v_mov_b32 v23, 0
    v_mov_b32 v11, 163712
    v_lshl_add_u32 v48, v3, 2, v11
    ds_write_b32 v48, v23
    s_waitcnt lgkmcnt(0)
    s_barrier
    s_branch Y_G
Y_L:
    s_setprio 2
    s_sub_u32 s8, s3, 4
    s_lshr_b32 s11, s8, 1
    s_and_b32 s9, s8, 1
    s_cmp_eq_u32 s11, 1
    s_cbranch_scc1 L_ns0
    s_lshl_b32 s10, s6, 7
    s_lshl_b32 s12, s9, 6
    s_add_u32 s10, s10, s12
    v_and_b32 v24, 32, v2
    v_bfe_u32 v25, v2, 3, 1
    v_lshl_add_u32 v24, v25, 4, v24
    v_bfe_u32 v25, v2, 4, 1
    v_add_u32 v24, v24, v25
    v_add_u32 v24, s10, v24
    v_lshlrev_b32 v24, 11, v24
    v_lshrrev_b32 v25, 4, v2
    v_xor_b32 v25, v25, v2
    v_and_b32 v25, 7, v25
    v_lshl_add_u32 v4, v25, 4, v24
    v_xor_b32 v5, 64, v4
    v_add_u32 v5, 3072, v5
    v_add_u32 v6, 6144, v4
    v_add_u32 v7, 6144, v5
    s_lshl_b32 s10, s7, 6
    v_lshrrev_b32 v24, 3, v2
    s_lshl_b32 s12, s9, 5
    s_add_u32 s10, s10, s12
    v_add_u32 v24, s10, v24
    v_lshlrev_b32 v24, 11, v24
    v_lshrrev_b32 v25, 4, v2
    v_xor_b32 v25, v25, v2
    v_and_b32 v25, 7, v25
    v_lshl_add_u32 v8, v25, 4, v24
    v_xor_b32 v9, 64, v8
    v_add_u32 v9, 15360, v9
    v_add_u32 v10, 30720, v8
    v_add_u32 v11, 30720, v9
    s_lshl_b32 s14, s8, 13
    s_waitcnt lgkmcnt(0)
    s_mov_b32 s52, s28
    s_mov_b32 s53, s29
    s_mov_b32 s54, 4194304
    s_mov_b32 s55, 0x00020000
    s_mov_b32 s56, s34
    s_mov_b32 s57, s35
    s_mov_b32 s58, 2097152
    s_mov_b32 s59, 0x00020000
    s_mov_b32 s60, s36
    s_mov_b32 s61, s37
    s_mov_b32 s62, 2097152
    s_mov_b32 s63, 0x00020000
    s_add_u32 m0, s14, 0
    s_nop 0
    buffer_load_dwordx4 v4, s[52:55], s13 offen offset:0 lds
    buffer_load_dwordx4 v5, s[52:55], s13 offen offset:1024 lds
    buffer_load_dwordx4 v6, s[52:55], s13 offen offset:2048 lds
    buffer_load_dwordx4 v7, s[52:55], s13 offen offset:3072 lds
    s_add_u32 m0, s14, 16384
    s_nop 0
    buffer_load_dwordx4 v8, s[56:59], s13 offen offset:0 lds
    buffer_load_dwordx4 v9, s[56:59], s13 offen offset:1024 lds
    buffer_load_dwordx4 v10, s[56:59], s13 offen offset:2048 lds
    buffer_load_dwordx4 v11, s[56:59], s13 offen offset:3072 lds
    s_add_u32 m0, s14, 4096
    s_add_u32 s12, s13, 16384
    buffer_load_dwordx4 v4, s[52:55], s12 offen offset:0 lds
    buffer_load_dwordx4 v5, s[52:55], s12 offen offset:1024 lds
    buffer_load_dwordx4 v6, s[52:55], s12 offen offset:2048 lds
    buffer_load_dwordx4 v7, s[52:55], s12 offen offset:3072 lds
    s_add_u32 m0, s14, 20480
    s_nop 0
    buffer_load_dwordx4 v8, s[60:63], s13 offen offset:0 lds
    buffer_load_dwordx4 v9, s[60:63], s13 offen offset:1024 lds
    buffer_load_dwordx4 v10, s[60:63], s13 offen offset:2048 lds
    buffer_load_dwordx4 v11, s[60:63], s13 offen offset:3072 lds
    s_add_u32 s13, s13, 128
    s_and_b32 s13, s13, 2047
    s_add_u32 s14, s14, 32768
    s_and_b32 s14, s14, 131071
L_ns0:
    s_waitcnt lgkmcnt(0)
    s_barrier
    v_mov_b32 v19, 0
    s_lshl_b32 s10, s3, 2
    s_add_u32 s10, s10, 163712
    v_mov_b32 v22, s10
    v_mov_b32 v21, 163712
    s_add_u32 s72, s50, 17825792
    s_addc_u32 s73, s51, 0
    s_mov_b32 s74, 24576
    s_mov_b32 s75, 0x00020000
    s_mov_b32 s76, s48
    s_mov_b32 s77, s49
    s_mov_b32 s78, 256
    s_mov_b32 s79, 0x00020000
    s_mov_b32 s37, s100
    s_mov_b32 s30, s101
    s_lshl_b32 s100, s4, 7
    s_lshl_b32 s10, s5, 2
    s_add_u32 s100, s100, s10
    s_add_u32 s100, s100, s8
    s_lshr_b32 s10, s100, 1
    s_lshl_b32 s10, s10, 2
    s_load_dword s31, s[26:27], s10
    s_mul_i32 s101, s8, 12928
    s_add_u32 s101, s101, 98304
    s_lshl_b32 s10, s7, 5
    s_add_u32 s10, s10, s11
    s_lshl_b32 s10, s10, 12
    v_lshrrev_b32 v24, 3, v2
    v_lshl_add_u32 v24, v24, 13, s10
    v_lshrrev_b32 v25, 4, v2
    v_xor_b32 v25, v25, v2
    v_and_b32 v25, 7, v25
    v_lshl_add_u32 v12, v25, 4, v24
    v_xor_b32 v13, 64, v12
    v_add_u32 v13, 64512, v13
    s_cmp_eq_u32 s9, 1
    s_cselect_b32 s80, s40, s38
    s_cselect_b32 s81, s41, s39
    s_mov_b32 s82, 2097152
    s_mov_b32 s83, 0x00020000
    s_mov_b32 s68, s24
    s_mov_b32 s69, s25
    s_mov_b32 s70, 4194304
    s_mov_b32 s71, 0x00020000
    s_movk_i32 s32, 4096
    s_movk_i32 s33, 8192
    s_movk_i32 s34, 12288
    s_lshl_b32 s10, s5, 6
    v_and_b32 v23, 56, v2
    v_add_u32 v23, s10, v23
    v_lshlrev_b32 v26, 4, v2
    s_lshl_b32 s36, s100, 12
    s_lshl_b32 s10, s4, 1
    s_lshr_b32 s12, s5, 4
    s_add_u32 s10, s10, s12
    s_lshl_b32 s10, s10, 8
    v_and_b32 v60, 31, v2
    v_lshl_add_u32 v20, v60, 3, s10
    s_lshl_b32 s10, s4, 7
    s_lshl_b32 s12, s8, 5
    s_add_u32 s35, s10, s12
    v_and_b32 v25, 7, v2
    v_lshl_add_u32 v24, v25, 2, s35
    v_lshlrev_b32 v25, 1, v24
    v_lshl_add_u32 v16, v23, 11, v25
    v_add_u32 v60, 12416, v26
    v_and_b32 v61, 16, v26
    v_and_b32 v62, 32, v26
    v_mul_u32_u24 v62, 130, v62
    v_add_u32 v61, v61, v62
    v_cmp_gt_u32 vcc, 32, v2
    s_nop 1
    v_cndmask_b32 v60, v61, v60, vcc
    v_add_u32 v18, s101, v60
    s_lshl_b32 s10, s4, 10
    s_add_u32 s10, s10, 8192
    v_add_u32 v3, s10, v26
    v_and_b32 v17, 15, v2
    v_lshrrev_b32 v27, 4, v2
    v_lshlrev_b32 v60, 1, v17
    v_lshlrev_b32 v61, 4, v27
    v_sub_u32 v60, v60, v61
    v_and_b32 v62, 1, v17
    v_mov_b32 v63, 4212
    v_cmp_eq_u32 vcc, 1, v62
    s_nop 1
    v_cndmask_b32 v63, v63, 50, vcc
    v_add3_u32 v28, v60, v63, s101
    v_add_u32 v29, 1024, v28
    v_add_u32 v30, 2048, v28
    v_add_u32 v31, 3072, v28
    v_lshl_add_u32 v60, v17, 5, v61
    s_add_u32 s10, s101, 8848
    v_sub_u32 v32, s10, v60
    s_add_u32 s10, s101, 8320
    v_add_u32 v33, s10, v26
    s_cmp_eq_u32 s11, 1
    s_cbranch_scc1 L_idle
    s_mov_b32 s29, 1
    v_mov_b32 v25, 1
    s_branch L_free
L_loop:
    s_sub_i32 s28, s29, 3
    s_max_i32 s28, s28, 0
    s_waitcnt lgkmcnt(0)
    v_min3_u32 v60, v60, v61, v62
    v_min_u32 v60, v60, v63
    v_mov_b32 v25, s29
    v_cmp_gt_u32 vcc, s28, v60
    s_cbranch_vccz L_free
    s_mov_b32 s15, 0
L_slot_w:
    ds_read_b128 v[60:63], v21 offset:0
    s_waitcnt lgkmcnt(0)
    v_min3_u32 v60, v60, v61, v62
    v_min_u32 v60, v60, v63
    v_cmp_gt_u32 vcc, s28, v60
    s_cbranch_vccz L_slot_ok
    s_sleep 1
    s_add_u32 s15, s15, 1
    s_cmp_lt_u32 s15, 160000
    s_cbranch_scc1 L_slot_w
L_slot_ok:
L_free:
    s_cmp_ge_u32 s29, 8
    s_cbranch_scc1 L_sh
    s_add_u32 m0, s14, 0
    s_waitcnt vmcnt(15)
    buffer_load_dwordx4 v4, s[52:55], s13 offen offset:0 lds
    s_waitcnt vmcnt(15)
    buffer_load_dwordx4 v5, s[52:55], s13 offen offset:1024 lds
    s_waitcnt vmcnt(15)
    buffer_load_dwordx4 v6, s[52:55], s13 offen offset:2048 lds
    s_waitcnt vmcnt(15)
    buffer_load_dwordx4 v7, s[52:55], s13 offen offset:3072 lds
    s_add_u32 m0, s14, 16384
    s_waitcnt vmcnt(15)
    buffer_load_dwordx4 v8, s[56:59], s13 offen offset:0 lds
    s_waitcnt vmcnt(15)
    buffer_load_dwordx4 v9, s[56:59], s13 offen offset:1024 lds
    s_waitcnt vmcnt(15)
    buffer_load_dwordx4 v10, s[56:59], s13 offen offset:2048 lds
    s_waitcnt vmcnt(15)
    buffer_load_dwordx4 v11, s[56:59], s13 offen offset:3072 lds
    s_add_u32 m0, s14, 4096
    s_add_u32 s12, s13, 16384
    s_waitcnt vmcnt(15)
    buffer_load_dwordx4 v4, s[52:55], s12 offen offset:0 lds
    s_waitcnt vmcnt(15)
    buffer_load_dwordx4 v5, s[52:55], s12 offen offset:1024 lds
    s_waitcnt vmcnt(15)
    buffer_load_dwordx4 v6, s[52:55], s12 offen offset:2048 lds
    s_waitcnt vmcnt(15)
    buffer_load_dwordx4 v7, s[52:55], s12 offen offset:3072 lds
    ds_read_b128 v[60:63], v21
    s_add_u32 m0, s14, 20480
    s_waitcnt vmcnt(15)
    buffer_load_dwordx4 v8, s[60:63], s13 offen offset:0 lds
    s_waitcnt vmcnt(15)
    buffer_load_dwordx4 v9, s[60:63], s13 offen offset:1024 lds
    s_waitcnt vmcnt(15)
    buffer_load_dwordx4 v10, s[60:63], s13 offen offset:2048 lds
    s_waitcnt vmcnt(15)
    ds_write_b32 v22, v25
    buffer_load_dwordx4 v11, s[60:63], s13 offen offset:3072 lds
    s_add_u32 s13, s13, 128
    s_and_b32 s13, s13, 2047
    s_add_u32 s14, s14, 32768
    s_and_b32 s14, s14, 131071
    s_add_u32 s29, s29, 1
    s_branch L_loop
L_sh:
    s_add_u32 m0, s14, 0
    s_waitcnt vmcnt(7)
    buffer_load_dwordx4 v4, s[52:55], s13 offen offset:0 lds
    s_waitcnt vmcnt(7)
    buffer_load_dwordx4 v5, s[52:55], s13 offen offset:1024 lds
    s_waitcnt vmcnt(7)
    buffer_load_dwordx4 v6, s[52:55], s13 offen offset:2048 lds
    s_waitcnt vmcnt(7)
    buffer_load_dwordx4 v7, s[52:55], s13 offen offset:3072 lds
    s_add_u32 m0, s14, 16384
    s_waitcnt vmcnt(7)
    buffer_load_dwordx4 v8, s[56:59], s13 offen offset:0 lds
    s_waitcnt vmcnt(7)
    buffer_load_dwordx4 v9, s[56:59], s13 offen offset:1024 lds
    s_waitcnt vmcnt(7)
    buffer_load_dwordx4 v10, s[56:59], s13 offen offset:2048 lds
    s_waitcnt vmcnt(7)
    ds_write_b32 v22, v25
    buffer_load_dwordx4 v11, s[56:59], s13 offen offset:3072 lds
    s_add_u32 m0, s14, 4096
    s_add_u32 s12, s13, 16384
    s_waitcnt vmcnt(7)
    buffer_load_dwordx4 v4, s[52:55], s12 offen offset:0 lds
    s_waitcnt vmcnt(7)
    buffer_load_dwordx4 v5, s[52:55], s12 offen offset:1024 lds
    s_waitcnt vmcnt(7)
    buffer_load_dwordx4 v6, s[52:55], s12 offen offset:2048 lds
    s_waitcnt vmcnt(7)
    buffer_load_dwordx4 v7, s[52:55], s12 offen offset:3072 lds
    ds_read_b128 v[60:63], v21
    s_add_u32 m0, s14, 20480
    s_waitcnt vmcnt(7)
    buffer_load_dwordx4 v8, s[60:63], s13 offen offset:0 lds
    s_waitcnt vmcnt(7)
    buffer_load_dwordx4 v9, s[60:63], s13 offen offset:1024 lds
    s_waitcnt vmcnt(7)
    buffer_load_dwordx4 v10, s[60:63], s13 offen offset:2048 lds
    s_waitcnt vmcnt(7)
    buffer_load_dwordx4 v11, s[60:63], s13 offen offset:3072 lds
    s_add_u32 s13, s13, 128
    s_and_b32 s13, s13, 2047
    s_add_u32 s14, s14, 32768
    s_and_b32 s14, s14, 131071
    s_add_u32 s29, s29, 1
    s_cmp_lt_u32 s29, 16
    s_cbranch_scc1 L_loop
    v_mov_b32 v25, 16
    v_mov_b32 v60, 1
    s_mov_b64 exec, 1
    ds_add_u32 v21, v60 offset:40
    s_mov_b64 exec, -1
    s_waitcnt vmcnt(0)
    ds_write_b32 v22, v25
    s_mov_b32 s15, 0
L_is0_w:
    ds_read_b32 v60, v21 offset:40
    s_waitcnt lgkmcnt(0)
    v_cmp_gt_u32 vcc, 2, v60
    s_cbranch_vccz L_is0_ok
    s_add_u32 s15, s15, 1
    s_cmp_lt_u32 s15, 160000
    s_cbranch_scc1 L_is0_w
L_is0_ok:
    buffer_load_dwordx4 v[192:195], v26, s[68:71], s36 offen offset:0 nt
    buffer_load_dwordx4 v[196:199], v26, s[68:71], s36 offen offset:1024 nt
    buffer_load_dwordx4 v[200:203], v26, s[68:71], s36 offen offset:2048 nt
    buffer_load_dwordx4 v[204:207], v26, s[68:71], s36 offen offset:3072 nt
    s_branch L_t2
L_idle:
    s_setprio 0
    s_mov_b32 s52, s18
    s_mov_b32 s53, s19
    s_mov_b32 s54, 4194304
    s_mov_b32 s55, 0x00020000
    s_mov_b32 s56, s20
    s_mov_b32 s57, s21
    s_mov_b32 s58, 4194304
    s_mov_b32 s59, 0x00020000
    s_mov_b32 s60, s22
    s_mov_b32 s61, s23
    s_mov_b32 s62, 8192
    s_mov_b32 s63, 0x00020000
    s_mov_b32 s64, s50
    s_mov_b32 s65, s51
    s_mov_b32 s66, 4194304
    s_mov_b32 s67, 0x00020000
    s_lshl_b32 s10, s4, 7
    s_lshl_b32 s12, s9, 6
    s_add_u32 s10, s10, s12
    v_and_b32 v60, 7, v2
    v_lshl_add_u32 v4, v60, 3, s10
    v_lshlrev_b32 v60, 1, v4
    v_lshl_add_u32 v5, v23, 11, v60
    v_subrev_u32 v6, 6144, v5
    v_bfrev_b32 v60, 1
    v_cmp_eq_u32 vcc, 0, v23
    s_nop 1
    v_cndmask_b32 v6, v6, v60, vcc
    v_lshlrev_b32 v7, 3, v4
    v_sub_u32 v8, 2040, v23
    v_lshlrev_b32 v8, 1, v8
    v_lshl_add_u32 v8, v4, 12, v8
    v_add_u32 v9, 16384, v8
    s_lshl_b32 s13, s4, 1
    s_add_u32 s13, s13, s9
    s_lshl_b32 s13, s13, 5
    s_add_u32 s13, s13, s5
    s_lshl_b32 s13, s13, 3
    v_mov_b32 v25, 16
    s_getreg_b32 s14, hwreg(HW_REG_XCC_ID, 0, 8)
    s_add_u32 s14, s14, 1
    s_lshl_b32 s14, s14, 20
    s_lshl_b32 s10, s4, 8
    s_add_u32 s10, s10, 4096
    v_and_b32 v14, 31, v2
    v_lshl_add_u32 v14, v14, 3, s10
    s_lshl_b32 s28, s5, 3
    s_add_u32 s28, s28, s10
    s_cmp_eq_u32 s9, 0
    s_cbranch_scc0 L_x1
    s_mov_b32 s15, 0
L_x0_w:
    ds_read_b64 v[60:61], v21 offset:16
    s_waitcnt lgkmcnt(0)
    v_min_u32 v60, v60, v61
    v_cmp_gt_u32 vcc, 1, v60
    s_cbranch_vccz L_x0_ok
    s_sleep 2
    s_add_u32 s15, s15, 1
    s_cmp_lt_u32 s15, 160000
    s_cbranch_scc1 L_x0_w
L_x0_ok:
    buffer_load_dwordx2 v[10:11], v19, s[76:79], 0 offen sc1
    s_waitcnt vmcnt(0)
    s_mov_b32 s12, 0
LX_np:
    v_cmp_eq_u32 vcc, 0, v10
    s_cbranch_vccz LX_nok
    buffer_load_dwordx2 v[10:11], v19, s[76:79], 0 offen sc1
    s_add_u32 s12, s12, 1
    s_waitcnt vmcnt(0)
    s_cmp_lt_u32 s12, 20000
    s_cbranch_scc1 LX_np
LX_nok:
    v_xor_b32 v11, s14, v11
    s_mov_b64 exec, 1
    buffer_store_dwordx2 v[10:11], v19, s[72:75], s28 offen sc1
    s_mov_b64 exec, -1
L_x1:
    s_mov_b32 s15, 0
L_i1_w:
    ds_read_b64 v[60:61], v21 offset:16
    s_waitcnt lgkmcnt(0)
    v_min_u32 v60, v60, v61
    v_cmp_gt_u32 vcc, 4, v60
    s_cbranch_vccz L_i1_ok
    s_sleep 2
    s_add_u32 s15, s15, 1
    s_cmp_lt_u32 s15, 160000
    s_cbranch_scc1 L_i1_w
L_i1_ok:
    buffer_load_dwordx4 v[64:67], v7, s[60:63], 0 offen offset:0
    buffer_load_dwordx4 v[68:71], v7, s[60:63], 0 offen offset:16
    buffer_load_dwordx4 v[72:75], v7, s[60:63], 0 offen offset:32
    buffer_load_dwordx4 v[76:79], v7, s[60:63], 0 offen offset:48
    buffer_load_dwordx4 v[92:95], v5, s[52:55], 0 offen offset:0 nt
    buffer_load_dwordx4 v[96:99], v5, s[52:55], 0 offen offset:2048 nt
    buffer_load_dwordx4 v[100:103], v5, s[52:55], s32 offen offset:0 nt
    buffer_load_dwordx4 v[104:107], v5, s[52:55], s32 offen offset:2048 nt
    buffer_load_dwordx4 v[108:111], v5, s[52:55], s33 offen offset:0 nt
    buffer_load_dwordx4 v[112:115], v5, s[52:55], s33 offen offset:2048 nt
    buffer_load_dwordx4 v[116:119], v5, s[52:55], s34 offen offset:0 nt
    buffer_load_dwordx4 v[120:123], v5, s[52:55], s34 offen offset:2048 nt
    buffer_load_dwordx4 v[80:83], v6, s[52:55], 0 offen offset:0 nt
    buffer_load_dwordx4 v[84:87], v6, s[52:55], 0 offen offset:2048 nt
    buffer_load_dwordx4 v[88:91], v6, s[52:55], s32 offen offset:0 nt
    buffer_load_dwordx4 v[124:127], v5, s[56:59], 0 offen offset:0 nt
    buffer_load_dwordx4 v[128:131], v5, s[56:59], 0 offen offset:2048 nt
    buffer_load_dwordx4 v[132:135], v5, s[56:59], s32 offen offset:0 nt
    buffer_load_dwordx4 v[136:139], v5, s[56:59], s32 offen offset:2048 nt
    buffer_load_dwordx4 v[140:143], v5, s[56:59], s33 offen offset:0 nt
    buffer_load_dwordx4 v[144:147], v5, s[56:59], s33 offen offset:2048 nt
    buffer_load_dwordx4 v[148:151], v5, s[56:59], s34 offen offset:0 nt
    buffer_load_dwordx4 v[152:155], v5, s[56:59], s34 offen offset:2048 nt
    buffer_load_dwordx2 v[58:59], v14, s[72:75], 0 offen sc1
    buffer_load_dwordx2 v[0:1], v19, s[76:79], 0 offen sc1
    s_waitcnt vmcnt(21)
    v_lshlrev_b32 v156, 16, v64
    v_and_b32 v160, 0xffff0000, v64
    v_lshlrev_b32 v164, 16, v65
    v_and_b32 v168, 0xffff0000, v65
    v_lshlrev_b32 v157, 16, v66
    v_and_b32 v161, 0xffff0000, v66
    v_lshlrev_b32 v165, 16, v67
    v_and_b32 v169, 0xffff0000, v67
    v_lshlrev_b32 v158, 16, v68
    v_and_b32 v162, 0xffff0000, v68
    v_lshlrev_b32 v166, 16, v69
    v_and_b32 v170, 0xffff0000, v69
    v_lshlrev_b32 v159, 16, v70
    v_and_b32 v163, 0xffff0000, v70
    v_lshlrev_b32 v167, 16, v71
    v_and_b32 v171, 0xffff0000, v71
    s_waitcnt vmcnt(10)
    v_lshlrev_b32 v172, 16, v80
    v_and_b32 v173, 0xffff0000, v80
    v_lshlrev_b32 v174, 16, v81
    v_and_b32 v175, 0xffff0000, v81
    v_lshlrev_b32 v176, 16, v84
    v_and_b32 v177, 0xffff0000, v84
    v_lshlrev_b32 v178, 16, v85
    v_and_b32 v179, 0xffff0000, v85
    v_lshlrev_b32 v180, 16, v88
    v_and_b32 v181, 0xffff0000, v88
    v_lshlrev_b32 v182, 16, v89
    v_and_b32 v183, 0xffff0000, v89
    v_lshlrev_b32 v184, 16, v92
    v_and_b32 v185, 0xffff0000, v92
    v_lshlrev_b32 v186, 16, v93
    v_and_b32 v187, 0xffff0000, v93
    v_lshlrev_b32 v188, 16, v96
    v_and_b32 v189, 0xffff0000, v96
    v_lshlrev_b32 v190, 16, v97
    v_and_b32 v191, 0xffff0000, v97
    v_lshlrev_b32 v192, 16, v100
    v_and_b32 v193, 0xffff0000, v100
    v_lshlrev_b32 v194, 16, v101
    v_and_b32 v195, 0xffff0000, v101
    v_lshlrev_b32 v196, 16, v104
    v_and_b32 v197, 0xffff0000, v104
    v_lshlrev_b32 v198, 16, v105
    v_and_b32 v199, 0xffff0000, v105
    v_lshlrev_b32 v200, 16, v108
    v_and_b32 v201, 0xffff0000, v108
    v_lshlrev_b32 v202, 16, v109
    v_and_b32 v203, 0xffff0000, v109
    v_lshlrev_b32 v204, 16, v112
    v_and_b32 v205, 0xffff0000, v112
    v_lshlrev_b32 v206, 16, v113
    v_and_b32 v207, 0xffff0000, v113
    v_lshlrev_b32 v208, 16, v116
    v_and_b32 v209, 0xffff0000, v116
    v_lshlrev_b32 v210, 16, v117
    v_and_b32 v211, 0xffff0000, v117
    v_lshlrev_b32 v212, 16, v120
    v_and_b32 v213, 0xffff0000, v120
    v_lshlrev_b32 v214, 16, v121
    v_and_b32 v215, 0xffff0000, v121
    v_mul_f32 v216, v184, v156
    v_mul_f32 v217, v185, v157
    v_mul_f32 v218, v186, v158
    v_mul_f32 v219, v187, v159
    v_mul_f32 v220, v188, v156
    v_mul_f32 v221, v189, v157
    v_mul_f32 v222, v190, v158
    v_mul_f32 v223, v191, v159
    v_mul_f32 v224, v192, v156
    v_mul_f32 v225, v193, v157
    v_mul_f32 v226, v194, v158
    v_mul_f32 v227, v195, v159
    v_mul_f32 v228, v196, v156
    v_mul_f32 v229, v197, v157
    v_mul_f32 v230, v198, v158
    v_mul_f32 v231, v199, v159
    v_mul_f32 v232, v200, v156
    v_mul_f32 v233, v201, v157
    v_mul_f32 v234, v202, v158
    v_mul_f32 v235, v203, v159
    v_mul_f32 v236, v204, v156
    v_mul_f32 v237, v205, v157
    v_mul_f32 v238, v206, v158
    v_mul_f32 v239, v207, v159
    v_mul_f32 v240, v208, v156
    v_mul_f32 v241, v209, v157
    v_mul_f32 v242, v210, v158
    v_mul_f32 v243, v211, v159
    v_mul_f32 v244, v212, v156
    v_mul_f32 v245, v213, v157
    v_mul_f32 v246, v214, v158
    v_mul_f32 v247, v215, v159
    v_fmac_f32 v216, v180, v160
    v_fmac_f32 v217, v181, v161
    v_fmac_f32 v218, v182, v162
    v_fmac_f32 v219, v183, v163
    v_fmac_f32 v220, v184, v160
    v_fmac_f32 v221, v185, v161
    v_fmac_f32 v222, v186, v162
    v_fmac_f32 v223, v187, v163
    v_fmac_f32 v224, v188, v160
    v_fmac_f32 v225, v189, v161
    v_fmac_f32 v226, v190, v162
    v_fmac_f32 v227, v191, v163
    v_fmac_f32 v228, v192, v160
    v_fmac_f32 v229, v193, v161
    v_fmac_f32 v230, v194, v162
    v_fmac_f32 v231, v195, v163
    v_fmac_f32 v232, v196, v160
    v_fmac_f32 v233, v197, v161
    v_fmac_f32 v234, v198, v162
    v_fmac_f32 v235, v199, v163
    v_fmac_f32 v236, v200, v160
    v_fmac_f32 v237, v201, v161
    v_fmac_f32 v238, v202, v162
    v_fmac_f32 v239, v203, v163
    v_fmac_f32 v240, v204, v160
    v_fmac_f32 v241, v205, v161
    v_fmac_f32 v242, v206, v162
    v_fmac_f32 v243, v207, v163
    v_fmac_f32 v244, v208, v160
    v_fmac_f32 v245, v209, v161
    v_fmac_f32 v246, v210, v162
    v_fmac_f32 v247, v211, v163
    v_fmac_f32 v216, v176, v164
    v_fmac_f32 v217, v177, v165
    v_fmac_f32 v218, v178, v166
    v_fmac_f32 v219, v179, v167
    v_fmac_f32 v220, v180, v164
    v_fmac_f32 v221, v181, v165
    v_fmac_f32 v222, v182, v166
    v_fmac_f32 v223, v183, v167
    v_fmac_f32 v224, v184, v164
    v_fmac_f32 v225, v185, v165
    v_fmac_f32 v226, v186, v166
    v_fmac_f32 v227, v187, v167
    v_fmac_f32 v228, v188, v164
    v_fmac_f32 v229, v189, v165
    v_fmac_f32 v230, v190, v166
    v_fmac_f32 v231, v191, v167
    v_fmac_f32 v232, v192, v164
    v_fmac_f32 v233, v193, v165
    v_fmac_f32 v234, v194, v166
    v_fmac_f32 v235, v195, v167
    v_fmac_f32 v236, v196, v164
    v_fmac_f32 v237, v197, v165
    v_fmac_f32 v238, v198, v166
    v_fmac_f32 v239, v199, v167
    v_fmac_f32 v240, v200, v164
    v_fmac_f32 v241, v201, v165
    v_fmac_f32 v242, v202, v166
    v_fmac_f32 v243, v203, v167
    v_fmac_f32 v244, v204, v164
    v_fmac_f32 v245, v205, v165
    v_fmac_f32 v246, v206, v166
    v_fmac_f32 v247, v207, v167
    v_fmac_f32 v216, v172, v168
    v_fmac_f32 v217, v173, v169
    v_fmac_f32 v218, v174, v170
    v_fmac_f32 v219, v175, v171
    v_fmac_f32 v220, v176, v168
    v_fmac_f32 v221, v177, v169
    v_fmac_f32 v222, v178, v170
    v_fmac_f32 v223, v179, v171
    v_fmac_f32 v224, v180, v168
    v_fmac_f32 v225, v181, v169
    v_fmac_f32 v226, v182, v170
    v_fmac_f32 v227, v183, v171
    v_fmac_f32 v228, v184, v168
    v_fmac_f32 v229, v185, v169
    v_fmac_f32 v230, v186, v170
    v_fmac_f32 v231, v187, v171
    v_fmac_f32 v232, v188, v168
    v_fmac_f32 v233, v189, v169
    v_fmac_f32 v234, v190, v170
    v_fmac_f32 v235, v191, v171
    v_fmac_f32 v236, v192, v168
    v_fmac_f32 v237, v193, v169
    v_fmac_f32 v238, v194, v170
    v_fmac_f32 v239, v195, v171
    v_fmac_f32 v240, v196, v168
    v_fmac_f32 v241, v197, v169
    v_fmac_f32 v242, v198, v170
    v_fmac_f32 v243, v199, v171
    v_fmac_f32 v244, v200, v168
    v_fmac_f32 v245, v201, v169
    v_fmac_f32 v246, v202, v170
    v_fmac_f32 v247, v203, v171
    s_waitcnt vmcnt(0)
    s_mov_b32 s12, 0
L_np:
    v_cmp_eq_u32 vcc, 0, v0
    s_cbranch_vccz L_nok
    buffer_load_dwordx2 v[0:1], v19, s[76:79], 0 offen sc1
    s_add_u32 s12, s12, 1
    s_waitcnt vmcnt(0)
    s_cmp_lt_u32 s12, 20000
    s_cbranch_scc1 L_np
L_nok:
    ds_write_b64 v21, v[0:1] offset:32
    v_xor_b32 v59, s14, v59
    v_cmp_ne_u64 vcc, v[58:59], v[0:1]
    s_cmp_eq_u64 vcc, 0
    s_cselect_b32 s14, 1, 0
    v_mov_b32 v58, s14
    ds_or_b32 v21, v58 offset:72
    v_lshlrev_b32 v172, 16, v124
    v_and_b32 v173, 0xffff0000, v124
    v_lshlrev_b32 v174, 16, v125
    v_and_b32 v175, 0xffff0000, v125
    v_lshlrev_b32 v176, 16, v128
    v_and_b32 v177, 0xffff0000, v128
    v_lshlrev_b32 v178, 16, v129
    v_and_b32 v179, 0xffff0000, v129
    v_lshlrev_b32 v180, 16, v132
    v_and_b32 v181, 0xffff0000, v132
    v_lshlrev_b32 v182, 16, v133
    v_and_b32 v183, 0xffff0000, v133
    v_lshlrev_b32 v184, 16, v136
    v_and_b32 v185, 0xffff0000, v136
    v_lshlrev_b32 v186, 16, v137
    v_and_b32 v187, 0xffff0000, v137
    v_lshlrev_b32 v188, 16, v140
    v_and_b32 v189, 0xffff0000, v140
    v_lshlrev_b32 v190, 16, v141
    v_and_b32 v191, 0xffff0000, v141
    v_lshlrev_b32 v192, 16, v144
    v_and_b32 v193, 0xffff0000, v144
    v_lshlrev_b32 v194, 16, v145
    v_and_b32 v195, 0xffff0000, v145
    v_lshlrev_b32 v196, 16, v148
    v_and_b32 v197, 0xffff0000, v148
    v_lshlrev_b32 v198, 16, v149
    v_and_b32 v199, 0xffff0000, v149
    v_lshlrev_b32 v200, 16, v152
    v_and_b32 v201, 0xffff0000, v152
    v_lshlrev_b32 v202, 16, v153
    v_and_b32 v203, 0xffff0000, v153
    v_mul_f32 v216, v216, v172
    v_mul_f32 v217, v217, v173
    v_mul_f32 v218, v218, v174
    v_mul_f32 v219, v219, v175
    v_mul_f32 v220, v220, v176
    v_mul_f32 v221, v221, v177
    v_mul_f32 v222, v222, v178
    v_mul_f32 v223, v223, v179
    v_mul_f32 v224, v224, v180
    v_mul_f32 v225, v225, v181
    v_mul_f32 v226, v226, v182
    v_mul_f32 v227, v227, v183
    v_mul_f32 v228, v228, v184
    v_mul_f32 v229, v229, v185
    v_mul_f32 v230, v230, v186
    v_mul_f32 v231, v231, v187
    v_mul_f32 v232, v232, v188
    v_mul_f32 v233, v233, v189
    v_mul_f32 v234, v234, v190
    v_mul_f32 v235, v235, v191
    v_mul_f32 v236, v236, v192
    v_mul_f32 v237, v237, v193
    v_mul_f32 v238, v238, v194
    v_mul_f32 v239, v239, v195
    v_mul_f32 v240, v240, v196
    v_mul_f32 v241, v241, v197
    v_mul_f32 v242, v242, v198
    v_mul_f32 v243, v243, v199
    v_mul_f32 v244, v244, v200
    v_mul_f32 v245, v245, v201
    v_mul_f32 v246, v246, v202
    v_mul_f32 v247, v247, v203
    v_cvt_pk_bf16_f32 v40, v244, v240
    v_cvt_pk_bf16_f32 v41, v236, v232
    v_cvt_pk_bf16_f32 v42, v228, v224
    v_cvt_pk_bf16_f32 v43, v220, v216
    v_cvt_pk_bf16_f32 v44, v245, v241
    v_cvt_pk_bf16_f32 v45, v237, v233
    v_cvt_pk_bf16_f32 v46, v229, v225
    v_cvt_pk_bf16_f32 v47, v221, v217
    v_cvt_pk_bf16_f32 v48, v246, v242
    v_cvt_pk_bf16_f32 v49, v238, v234
    v_cvt_pk_bf16_f32 v50, v230, v226
    v_cvt_pk_bf16_f32 v51, v222, v218
    v_cvt_pk_bf16_f32 v52, v247, v243
    v_cvt_pk_bf16_f32 v53, v239, v235
    v_cvt_pk_bf16_f32 v54, v231, v227
    v_cvt_pk_bf16_f32 v55, v223, v219
    s_cmp_eq_u32 s14, 1
    s_cbranch_scc1 L_xp0
    buffer_store_dwordx4 v[40:43], v8, s[64:67], 0 offen sc1
    buffer_store_dwordx4 v[44:47], v8, s[64:67], s32 offen sc1
    buffer_store_dwordx4 v[48:51], v8, s[64:67], s33 offen sc1
    buffer_store_dwordx4 v[52:55], v8, s[64:67], s34 offen sc1
    s_branch L_xq0
L_xp0:
    buffer_store_dwordx4 v[40:43], v8, s[64:67], 0 offen
    buffer_store_dwordx4 v[44:47], v8, s[64:67], s32 offen
    buffer_store_dwordx4 v[48:51], v8, s[64:67], s33 offen
    buffer_store_dwordx4 v[52:55], v8, s[64:67], s34 offen
L_xq0:
    v_lshlrev_b32 v156, 16, v72
    v_and_b32 v160, 0xffff0000, v72
    v_lshlrev_b32 v164, 16, v73
    v_and_b32 v168, 0xffff0000, v73
    v_lshlrev_b32 v157, 16, v74
    v_and_b32 v161, 0xffff0000, v74
    v_lshlrev_b32 v165, 16, v75
    v_and_b32 v169, 0xffff0000, v75
    v_lshlrev_b32 v158, 16, v76
    v_and_b32 v162, 0xffff0000, v76
    v_lshlrev_b32 v166, 16, v77
    v_and_b32 v170, 0xffff0000, v77
    v_lshlrev_b32 v159, 16, v78
    v_and_b32 v163, 0xffff0000, v78
    v_lshlrev_b32 v167, 16, v79
    v_and_b32 v171, 0xffff0000, v79
    v_lshlrev_b32 v172, 16, v82
    v_and_b32 v173, 0xffff0000, v82
    v_lshlrev_b32 v174, 16, v83
    v_and_b32 v175, 0xffff0000, v83
    v_lshlrev_b32 v176, 16, v86
    v_and_b32 v177, 0xffff0000, v86
    v_lshlrev_b32 v178, 16, v87
    v_and_b32 v179, 0xffff0000, v87
    v_lshlrev_b32 v180, 16, v90
    v_and_b32 v181, 0xffff0000, v90
    v_lshlrev_b32 v182, 16, v91
    v_and_b32 v183, 0xffff0000, v91
    v_lshlrev_b32 v184, 16, v94
    v_and_b32 v185, 0xffff0000, v94
    v_lshlrev_b32 v186, 16, v95
    v_and_b32 v187, 0xffff0000, v95
    v_lshlrev_b32 v188, 16, v98
    v_and_b32 v189, 0xffff0000, v98
    v_lshlrev_b32 v190, 16, v99
    v_and_b32 v191, 0xffff0000, v99
    v_lshlrev_b32 v192, 16, v102
    v_and_b32 v193, 0xffff0000, v102
    v_lshlrev_b32 v194, 16, v103
    v_and_b32 v195, 0xffff0000, v103
    v_lshlrev_b32 v196, 16, v106
    v_and_b32 v197, 0xffff0000, v106
    v_lshlrev_b32 v198, 16, v107
    v_and_b32 v199, 0xffff0000, v107
    v_lshlrev_b32 v200, 16, v110
    v_and_b32 v201, 0xffff0000, v110
    v_lshlrev_b32 v202, 16, v111
    v_and_b32 v203, 0xffff0000, v111
    v_lshlrev_b32 v204, 16, v114
    v_and_b32 v205, 0xffff0000, v114
    v_lshlrev_b32 v206, 16, v115
    v_and_b32 v207, 0xffff0000, v115
    v_lshlrev_b32 v208, 16, v118
    v_and_b32 v209, 0xffff0000, v118
    v_lshlrev_b32 v210, 16, v119
    v_and_b32 v211, 0xffff0000, v119
    v_lshlrev_b32 v212, 16, v122
    v_and_b32 v213, 0xffff0000, v122
    v_lshlrev_b32 v214, 16, v123
    v_and_b32 v215, 0xffff0000, v123
    v_mul_f32 v216, v184, v156
    v_mul_f32 v217, v185, v157
    v_mul_f32 v218, v186, v158
    v_mul_f32 v219, v187, v159
    v_mul_f32 v220, v188, v156
    v_mul_f32 v221, v189, v157
    v_mul_f32 v222, v190, v158
    v_mul_f32 v223, v191, v159
    v_mul_f32 v224, v192, v156
    v_mul_f32 v225, v193, v157
    v_mul_f32 v226, v194, v158
    v_mul_f32 v227, v195, v159
    v_mul_f32 v228, v196, v156
    v_mul_f32 v229, v197, v157
    v_mul_f32 v230, v198, v158
    v_mul_f32 v231, v199, v159
    v_mul_f32 v232, v200, v156
    v_mul_f32 v233, v201, v157
    v_mul_f32 v234, v202, v158
    v_mul_f32 v235, v203, v159
    v_mul_f32 v236, v204, v156
    v_mul_f32 v237, v205, v157
    v_mul_f32 v238, v206, v158
    v_mul_f32 v239, v207, v159
    v_mul_f32 v240, v208, v156
    v_mul_f32 v241, v209, v157
    v_mul_f32 v242, v210, v158
    v_mul_f32 v243, v211, v159
    v_mul_f32 v244, v212, v156
    v_mul_f32 v245, v213, v157
    v_mul_f32 v246, v214, v158
    v_mul_f32 v247, v215, v159
    v_fmac_f32 v216, v180, v160
    v_fmac_f32 v217, v181, v161
    v_fmac_f32 v218, v182, v162
    v_fmac_f32 v219, v183, v163
    v_fmac_f32 v220, v184, v160
    v_fmac_f32 v221, v185, v161
    v_fmac_f32 v222, v186, v162
    v_fmac_f32 v223, v187, v163
    v_fmac_f32 v224, v188, v160
    v_fmac_f32 v225, v189, v161
    v_fmac_f32 v226, v190, v162
    v_fmac_f32 v227, v191, v163
    v_fmac_f32 v228, v192, v160
    v_fmac_f32 v229, v193, v161
    v_fmac_f32 v230, v194, v162
    v_fmac_f32 v231, v195, v163
    v_fmac_f32 v232, v196, v160
    v_fmac_f32 v233, v197, v161
    v_fmac_f32 v234, v198, v162
    v_fmac_f32 v235, v199, v163
    v_fmac_f32 v236, v200, v160
    v_fmac_f32 v237, v201, v161
    v_fmac_f32 v238, v202, v162
    v_fmac_f32 v239, v203, v163
    v_fmac_f32 v240, v204, v160
    v_fmac_f32 v241, v205, v161
    v_fmac_f32 v242, v206, v162
    v_fmac_f32 v243, v207, v163
    v_fmac_f32 v244, v208, v160
    v_fmac_f32 v245, v209, v161
    v_fmac_f32 v246, v210, v162
    v_fmac_f32 v247, v211, v163
    v_fmac_f32 v216, v176, v164
    v_fmac_f32 v217, v177, v165
    v_fmac_f32 v218, v178, v166
    v_fmac_f32 v219, v179, v167
    v_fmac_f32 v220, v180, v164
    v_fmac_f32 v221, v181, v165
    v_fmac_f32 v222, v182, v166
    v_fmac_f32 v223, v183, v167
    v_fmac_f32 v224, v184, v164
    v_fmac_f32 v225, v185, v165
    v_fmac_f32 v226, v186, v166
    v_fmac_f32 v227, v187, v167
    v_fmac_f32 v228, v188, v164
    v_fmac_f32 v229, v189, v165
    v_fmac_f32 v230, v190, v166
    v_fmac_f32 v231, v191, v167
    v_fmac_f32 v232, v192, v164
    v_fmac_f32 v233, v193, v165
    v_fmac_f32 v234, v194, v166
    v_fmac_f32 v235, v195, v167
    v_fmac_f32 v236, v196, v164
    v_fmac_f32 v237, v197, v165
    v_fmac_f32 v238, v198, v166
    v_fmac_f32 v239, v199, v167
    v_fmac_f32 v240, v200, v164
    v_fmac_f32 v241, v201, v165
    v_fmac_f32 v242, v202, v166
    v_fmac_f32 v243, v203, v167
    v_fmac_f32 v244, v204, v164
    v_fmac_f32 v245, v205, v165
    v_fmac_f32 v246, v206, v166
    v_fmac_f32 v247, v207, v167
    v_fmac_f32 v216, v172, v168
    v_fmac_f32 v217, v173, v169
    v_fmac_f32 v218, v174, v170
    v_fmac_f32 v219, v175, v171
    v_fmac_f32 v220, v176, v168
    v_fmac_f32 v221, v177, v169
    v_fmac_f32 v222, v178, v170
    v_fmac_f32 v223, v179, v171
    v_fmac_f32 v224, v180, v168
    v_fmac_f32 v225, v181, v169
    v_fmac_f32 v226, v182, v170
    v_fmac_f32 v227, v183, v171
    v_fmac_f32 v228, v184, v168
    v_fmac_f32 v229, v185, v169
    v_fmac_f32 v230, v186, v170
    v_fmac_f32 v231, v187, v171
    v_fmac_f32 v232, v188, v168
    v_fmac_f32 v233, v189, v169
    v_fmac_f32 v234, v190, v170
    v_fmac_f32 v235, v191, v171
    v_fmac_f32 v236, v192, v168
    v_fmac_f32 v237, v193, v169
    v_fmac_f32 v238, v194, v170
    v_fmac_f32 v239, v195, v171
    v_fmac_f32 v240, v196, v168
    v_fmac_f32 v241, v197, v169
    v_fmac_f32 v242, v198, v170
    v_fmac_f32 v243, v199, v171
    v_fmac_f32 v244, v200, v168
    v_fmac_f32 v245, v201, v169
    v_fmac_f32 v246, v202, v170
    v_fmac_f32 v247, v203, v171
    v_lshlrev_b32 v172, 16, v126
    v_and_b32 v173, 0xffff0000, v126
    v_lshlrev_b32 v174, 16, v127
    v_and_b32 v175, 0xffff0000, v127
    v_lshlrev_b32 v176, 16, v130
    v_and_b32 v177, 0xffff0000, v130
    v_lshlrev_b32 v178, 16, v131
    v_and_b32 v179, 0xffff0000, v131
    v_lshlrev_b32 v180, 16, v134
    v_and_b32 v181, 0xffff0000, v134
    v_lshlrev_b32 v182, 16, v135
    v_and_b32 v183, 0xffff0000, v135
    v_lshlrev_b32 v184, 16, v138
    v_and_b32 v185, 0xffff0000, v138
    v_lshlrev_b32 v186, 16, v139
    v_and_b32 v187, 0xffff0000, v139
    v_lshlrev_b32 v188, 16, v142
    v_and_b32 v189, 0xffff0000, v142
    v_lshlrev_b32 v190, 16, v143
    v_and_b32 v191, 0xffff0000, v143
    v_lshlrev_b32 v192, 16, v146
    v_and_b32 v193, 0xffff0000, v146
    v_lshlrev_b32 v194, 16, v147
    v_and_b32 v195, 0xffff0000, v147
    v_lshlrev_b32 v196, 16, v150
    v_and_b32 v197, 0xffff0000, v150
    v_lshlrev_b32 v198, 16, v151
    v_and_b32 v199, 0xffff0000, v151
    v_lshlrev_b32 v200, 16, v154
    v_and_b32 v201, 0xffff0000, v154
    v_lshlrev_b32 v202, 16, v155
    v_and_b32 v203, 0xffff0000, v155
    v_mul_f32 v216, v216, v172
    v_mul_f32 v217, v217, v173
    v_mul_f32 v218, v218, v174
    v_mul_f32 v219, v219, v175
    v_mul_f32 v220, v220, v176
    v_mul_f32 v221, v221, v177
    v_mul_f32 v222, v222, v178
    v_mul_f32 v223, v223, v179
    v_mul_f32 v224, v224, v180
    v_mul_f32 v225, v225, v181
    v_mul_f32 v226, v226, v182
    v_mul_f32 v227, v227, v183
    v_mul_f32 v228, v228, v184
    v_mul_f32 v229, v229, v185
    v_mul_f32 v230, v230, v186
    v_mul_f32 v231, v231, v187
    v_mul_f32 v232, v232, v188
    v_mul_f32 v233, v233, v189
    v_mul_f32 v234, v234, v190
    v_mul_f32 v235, v235, v191
    v_mul_f32 v236, v236, v192
    v_mul_f32 v237, v237, v193
    v_mul_f32 v238, v238, v194
    v_mul_f32 v239, v239, v195
    v_mul_f32 v240, v240, v196
    v_mul_f32 v241, v241, v197
    v_mul_f32 v242, v242, v198
    v_mul_f32 v243, v243, v199
    v_mul_f32 v244, v244, v200
    v_mul_f32 v245, v245, v201
    v_mul_f32 v246, v246, v202
    v_mul_f32 v247, v247, v203
    v_cvt_pk_bf16_f32 v40, v244, v240
    v_cvt_pk_bf16_f32 v41, v236, v232
    v_cvt_pk_bf16_f32 v42, v228, v224
    v_cvt_pk_bf16_f32 v43, v220, v216
    v_cvt_pk_bf16_f32 v44, v245, v241
    v_cvt_pk_bf16_f32 v45, v237, v233
    v_cvt_pk_bf16_f32 v46, v229, v225
    v_cvt_pk_bf16_f32 v47, v221, v217
    v_cvt_pk_bf16_f32 v48, v246, v242
    v_cvt_pk_bf16_f32 v49, v238, v234
    v_cvt_pk_bf16_f32 v50, v230, v226
    v_cvt_pk_bf16_f32 v51, v222, v218
    v_cvt_pk_bf16_f32 v52, v247, v243
    v_cvt_pk_bf16_f32 v53, v239, v235
    v_cvt_pk_bf16_f32 v54, v231, v227
    v_cvt_pk_bf16_f32 v55, v223, v219
    s_cmp_eq_u32 s14, 1
    s_cbranch_scc1 L_xp1
    buffer_store_dwordx4 v[40:43], v9, s[64:67], 0 offen sc1
    buffer_store_dwordx4 v[44:47], v9, s[64:67], s32 offen sc1
    buffer_store_dwordx4 v[48:51], v9, s[64:67], s33 offen sc1
    buffer_store_dwordx4 v[52:55], v9, s[64:67], s34 offen sc1
    s_branch L_xq1
L_xp1:
    buffer_store_dwordx4 v[40:43], v9, s[64:67], 0 offen
    buffer_store_dwordx4 v[44:47], v9, s[64:67], s32 offen
    buffer_store_dwordx4 v[48:51], v9, s[64:67], s33 offen
    buffer_store_dwordx4 v[52:55], v9, s[64:67], s34 offen
L_xq1:
    s_waitcnt vmcnt(0)
    s_mov_b64 exec, 1
    s_cmp_eq_u32 s14, 1
    s_cbranch_scc0 L_xf0
    buffer_store_dwordx2 v[0:1], v19, s[72:75], s13 offen
    s_branch L_xf1
L_xf0:
    buffer_store_dwordx2 v[0:1], v19, s[72:75], s13 offen sc1
L_xf1:
    s_mov_b64 exec, -1
    s_cmp_eq_u32 s8, 3
    s_cbranch_scc0 L_id2
    s_mov_b32 s15, 0
L_i2_w:
    ds_read_b64 v[60:61], v21 offset:16
    s_waitcnt lgkmcnt(0)
    v_min_u32 v60, v60, v61
    v_cmp_gt_u32 vcc, 14, v60
    s_cbranch_vccz L_i2_ok
    s_sleep 2
    s_add_u32 s15, s15, 1
    s_cmp_lt_u32 s15, 160000
    s_cbranch_scc1 L_i2_w
L_i2_ok:
    s_mov_b32 s15, 0
LK_poll:
    buffer_load_dwordx2 v[60:61], v20, s[72:75], 0 offen sc1
    s_waitcnt vmcnt(0)
    v_cmp_ne_u64 vcc, v[60:61], v[0:1]
    s_cbranch_vccz LK_ok
    s_add_u32 s15, s15, 1
    s_cmp_lt_u32 s15, 20000
    s_cbranch_scc1 LK_poll
LK_ok:
    ds_write_b32 v21, v25 offset:44
L_id2:
    s_mov_b32 s15, 0
L_is1_w:
    ds_read_b32 v60, v21 offset:40
    s_waitcnt lgkmcnt(0)
    v_cmp_gt_u32 vcc, 2, v60
    s_cbranch_vccz L_is1_ok
    s_sleep 2
    s_add_u32 s15, s15, 1
    s_cmp_lt_u32 s15, 160000
    s_cbranch_scc1 L_is1_w
L_is1_ok:
    buffer_load_dwordx4 v[192:195], v26, s[68:71], s36 offen offset:0 nt
    buffer_load_dwordx4 v[196:199], v26, s[68:71], s36 offen offset:1024 nt
    buffer_load_dwordx4 v[200:203], v26, s[68:71], s36 offen offset:2048 nt
    buffer_load_dwordx4 v[204:207], v26, s[68:71], s36 offen offset:3072 nt
L_t2:
    s_mov_b32 s52, s50
    s_mov_b32 s53, s51
    s_mov_b32 s54, 4194304
    s_mov_b32 s55, 0x00020000
    s_mov_b32 s56, s50
    s_mov_b32 s57, s51
    s_mov_b32 s58, 4194304
    s_mov_b32 s59, 0x00020000
    s_mov_b32 s60, s16
    s_mov_b32 s61, s17
    s_mov_b32 s62, 4194304
    s_mov_b32 s63, 0x00020000
    s_mov_b32 s64, s46
    s_mov_b32 s65, s47
    s_mov_b32 s66, 16777216
    s_mov_b32 s67, 0x00020000
    s_mov_b32 s15, 0
L_fk_w:
    ds_read_b32 v60, v21 offset:44
    s_waitcnt lgkmcnt(0)
    v_cmp_gt_u32 vcc, 1, v60
    s_cbranch_vccz L_fk_ok
    s_sleep 1
    s_add_u32 s15, s15, 1
    s_cmp_lt_u32 s15, 160000
    s_cbranch_scc1 L_fk_w
L_fk_ok:
    ds_read_b64 v[0:1], v21 offset:32
    buffer_load_dwordx4 v[224:227], v26, s[52:55], s36 offen offset:0 sc1
    buffer_load_dwordx4 v[228:231], v26, s[52:55], s36 offen offset:1024 sc1
    buffer_load_dwordx4 v[232:235], v26, s[52:55], s36 offen offset:2048 sc1
    buffer_load_dwordx4 v[236:239], v26, s[52:55], s36 offen offset:3072 sc1
    buffer_load_dwordx2 v[4:5], v16, s[60:63], 0 offen offset:0 nt
    buffer_load_dwordx2 v[6:7], v16, s[60:63], 0 offen offset:2048 nt
    s_waitcnt vmcnt(9)
    buffer_load_dwordx2 v[8:9], v16, s[60:63], s32 offen offset:0 nt
    s_waitcnt vmcnt(9)
    buffer_load_dwordx2 v[10:11], v16, s[60:63], s32 offen offset:2048 nt
    s_waitcnt vmcnt(9)
    buffer_load_dwordx2 v[14:15], v16, s[60:63], s33 offen offset:0 nt
    s_waitcnt vmcnt(9)
    buffer_load_dwordx2 v[56:57], v16, s[60:63], s33 offen offset:2048 nt
    s_waitcnt vmcnt(9)
    buffer_load_dwordx2 v[58:59], v16, s[60:63], s34 offen offset:0 nt
    s_waitcnt vmcnt(9)
    buffer_load_dwordx2 v[34:35], v16, s[60:63], s34 offen offset:2048 nt
    s_lshl_b32 s14, s9, 13
    s_lshl_b32 s10, s11, 12
    s_add_u32 s14, s14, s10
    s_mov_b32 s15, 0
L_c1_w:
    ds_read_b128 v[60:63], v21 offset:0
    s_waitcnt lgkmcnt(0)
    v_min3_u32 v60, v60, v61, v62
    v_min_u32 v60, v60, v63
    v_cmp_gt_u32 vcc, 14, v60
    s_cbranch_vccz L_c1_ok
    s_sleep 1
    s_add_u32 s15, s15, 1
    s_cmp_lt_u32 s15, 160000
    s_cbranch_scc1 L_c1_w
L_c1_ok:
    s_waitcnt vmcnt(9)
    s_bfe_u32 s13, s37, 0 + (4 << 16)
    s_lshl_b32 s13, s13, 7
    s_add_u32 m0, s14, 0
    s_nop 0
    buffer_load_dwordx4 v12, s[80:83], s13 offen offset:0 lds
    s_waitcnt vmcnt(9)
    buffer_load_dwordx4 v13, s[80:83], s13 offen offset:1024 lds
    s_waitcnt vmcnt(9)
    buffer_load_dwordx4 v12, s[80:83], s13 offen offset:2048 lds
    s_waitcnt vmcnt(9)
    buffer_load_dwordx4 v13, s[80:83], s13 offen offset:3072 lds
    s_waitcnt vmcnt(9)
    s_bfe_u32 s13, s37, 4 + (4 << 16)
    s_lshl_b32 s13, s13, 7
    s_add_u32 m0, s14, 16384
    s_nop 0
    buffer_load_dwordx4 v12, s[80:83], s13 offen offset:0 lds
    s_waitcnt vmcnt(9)
    buffer_load_dwordx4 v13, s[80:83], s13 offen offset:1024 lds
    s_waitcnt vmcnt(9)
    buffer_load_dwordx4 v12, s[80:83], s13 offen offset:2048 lds
    s_waitcnt vmcnt(9)
    buffer_load_dwordx4 v13, s[80:83], s13 offen offset:3072 lds
    s_waitcnt vmcnt(9)
    s_bfe_u32 s13, s37, 8 + (4 << 16)
    s_lshl_b32 s13, s13, 7
    s_add_u32 m0, s14, 32768
    s_nop 0
    buffer_load_dwordx4 v12, s[80:83], s13 offen offset:0 lds
    s_waitcnt vmcnt(9)
    buffer_load_dwordx4 v13, s[80:83], s13 offen offset:1024 lds
    s_waitcnt vmcnt(9)
    buffer_load_dwordx4 v12, s[80:83], s13 offen offset:2048 lds
    s_waitcnt vmcnt(9)
    buffer_load_dwordx4 v13, s[80:83], s13 offen offset:3072 lds
    s_bitcmp1_b32 s100, 0
    s_cselect_b32 s10, 16, 0
    s_lshr_b32 s31, s31, s10
    s_and_b32 s31, s31, 0xffff
    v_lshlrev_b32 v60, 3, v27
    v_sub_u32 v60, v60, v17
    v_add_u32 v60, -9, v60
    v_and_b32 v61, 1, v60
    v_lshlrev_b32 v61, 4, v61
    v_lshlrev_b32 v61, v61, s31
    v_ashrrev_i32 v60, 1, v60
    v_cmp_eq_u32 vcc, 0, v60
    s_nop 1
    v_cndmask_b32 v36, 0, v61, vcc
    v_cmp_eq_u32 vcc, 1, v60
    s_nop 1
    v_cndmask_b32 v37, 0, v61, vcc
    v_cmp_eq_u32 vcc, 2, v60
    s_nop 1
    v_cndmask_b32 v38, 0, v61, vcc
    v_cmp_eq_u32 vcc, 3, v60
    s_nop 1
    v_cndmask_b32 v39, 0, v61, vcc
    v_mov_b32 v128, 0
    v_mov_b32 v129, 0
    v_mov_b32 v130, 0
    v_mov_b32 v131, 0
    v_and_b32 v60, 1, v27
    v_lshlrev_b32 v60, 9, v60
    v_lshl_add_u32 v60, v17, 5, v60
    v_lshrrev_b32 v61, 1, v27
    v_lshl_add_u32 v17, v61, 4, v60
    v_and_b32 v60, 1, v2
    v_lshrrev_b32 v61, 5, v2
    v_lshl_add_u32 v60, v60, 1, v61
    v_bfe_u32 v61, v2, 1, 4
    v_lshl_add_u32 v60, v60, 4, v61
    v_lshlrev_b32 v17, 2, v60
    s_waitcnt vmcnt(24)
    v_mov_b32 v208, 0
    v_alignbit_b32 v209, v193, v192, 16
    v_alignbit_b32 v210, v194, v193, 16
    v_alignbit_b32 v211, v195, v194, 16
    s_nop 0
    v_mov_b32_dpp v208, v195 wave_shr:1 row_mask:0xf bank_mask:0xf
    v_alignbit_b32 v208, v192, v208, 16
    v_readlane_b32 s10, v195, 63
    v_alignbit_b32 v213, v197, v196, 16
    v_alignbit_b32 v214, v198, v197, 16
    v_mov_b32 v212, s10
    v_alignbit_b32 v215, v199, v198, 16
    s_nop 0
    v_mov_b32_dpp v212, v199 wave_shr:1 row_mask:0xf bank_mask:0xf
    v_alignbit_b32 v212, v196, v212, 16
    v_readlane_b32 s10, v199, 63
    v_alignbit_b32 v217, v201, v200, 16
    v_alignbit_b32 v218, v202, v201, 16
    v_mov_b32 v216, s10
    v_alignbit_b32 v219, v203, v202, 16
    s_nop 0
    v_mov_b32_dpp v216, v203 wave_shr:1 row_mask:0xf bank_mask:0xf
    v_alignbit_b32 v216, v200, v216, 16
    v_readlane_b32 s10, v203, 63
    v_alignbit_b32 v221, v205, v204, 16
    v_alignbit_b32 v222, v206, v205, 16
    v_mov_b32 v220, s10
    v_alignbit_b32 v223, v207, v206, 16
    s_nop 0
    v_mov_b32_dpp v220, v207 wave_shr:1 row_mask:0xf bank_mask:0xf
    v_alignbit_b32 v220, v204, v220, 16
    s_mov_b32 s15, 0
L_c2_w:
    ds_read_b128 v[60:63], v21 offset:0
    s_waitcnt lgkmcnt(0)
    v_min3_u32 v60, v60, v61, v62
    v_min_u32 v60, v60, v63
    v_cmp_gt_u32 vcc, 16, v60
    s_cbranch_vccz L_c2_ok
    s_sleep 1
    s_add_u32 s15, s15, 1
    s_cmp_lt_u32 s15, 160000
    s_cbranch_scc1 L_c2_w
L_c2_ok:
    s_setprio 0
    ds_write_b128 v18, v[128:131]
    v_add_u32 v62, -8288, v33
    ds_write_b128 v62, v[192:195] offset:0
    ds_write_b128 v62, v[196:199] offset:1024
    ds_write_b128 v62, v[200:203] offset:2048
    ds_write_b128 v62, v[204:207] offset:3072
    ds_write_b128 v62, v[208:211] offset:4160
    ds_write_b128 v62, v[212:215] offset:5184
    ds_write_b128 v62, v[216:219] offset:6208
    ds_write_b128 v62, v[220:223] offset:7232
    ds_read2_b32 v[128:129], v28 offset0:0 offset1:1
    ds_read2_b32 v[130:131], v28 offset0:2 offset1:3
    ds_read2_b32 v[132:133], v28 offset0:128 offset1:129
    ds_read2_b32 v[134:135], v28 offset0:130 offset1:131
    ds_read2_b32 v[136:137], v29 offset0:0 offset1:1
    ds_read2_b32 v[138:139], v29 offset0:2 offset1:3
    ds_read2_b32 v[140:141], v29 offset0:128 offset1:129
    ds_read2_b32 v[142:143], v29 offset0:130 offset1:131
    ds_read2_b32 v[144:145], v30 offset0:0 offset1:1
    ds_read2_b32 v[146:147], v30 offset0:2 offset1:3
    ds_read2_b32 v[148:149], v30 offset0:128 offset1:129
    ds_read2_b32 v[150:151], v30 offset0:130 offset1:131
    ds_read2_b32 v[152:153], v31 offset0:0 offset1:1
    ds_read2_b32 v[154:155], v31 offset0:2 offset1:3
    ds_read2_b32 v[156:157], v31 offset0:128 offset1:129
    ds_read2_b32 v[158:159], v31 offset0:130 offset1:131
    s_waitcnt vmcnt(23)
    ds_write_b128 v33, v[224:227] offset:0
    s_waitcnt vmcnt(22)
    ds_write_b128 v33, v[228:231] offset:1024
    s_waitcnt vmcnt(21)
    ds_write_b128 v33, v[232:235] offset:2048
    s_waitcnt vmcnt(20)
    ds_write_b128 v33, v[236:239] offset:3072
    ds_read_b128 v[160:163], v32 offset:3584
    ds_read_b128 v[164:167], v32 offset:3072
    ds_read_b128 v[168:171], v32 offset:2560
    ds_read_b128 v[172:175], v32 offset:2048
    ds_read_b128 v[176:179], v32 offset:1536
    ds_read_b128 v[180:183], v32 offset:1024
    ds_read_b128 v[184:187], v32 offset:512
    ds_read_b128 v[188:191], v32 offset:0
    s_setprio 2
    s_waitcnt lgkmcnt(0)
    v_mfma_f32_16x16x32_bf16 v[96:99], v[36:39], v[160:163], 0
    v_mfma_f32_16x16x32_bf16 v[100:103], v[36:39], v[164:167], 0
    v_mfma_f32_16x16x32_bf16 v[104:107], v[36:39], v[168:171], 0
    v_mfma_f32_16x16x32_bf16 v[108:111], v[36:39], v[172:175], 0
    v_mfma_f32_16x16x32_bf16 v[112:115], v[36:39], v[176:179], 0
    v_mfma_f32_16x16x32_bf16 v[116:119], v[36:39], v[180:183], 0
    v_mfma_f32_16x16x32_bf16 v[120:123], v[36:39], v[184:187], 0
    v_mfma_f32_16x16x32_bf16 v[124:127], v[36:39], v[188:191], 0
    v_mfma_f32_16x16x32_bf16 v[96:99], v[128:131], v[160:163], v[96:99]
    ds_read2_b32 v[192:193], v28 offset0:16 offset1:17
    s_bfe_u32 s13, s37, 12 + (4 << 16)
    s_lshl_b32 s13, s13, 7
    s_add_u32 m0, s14, 49152
    s_nop 0
    buffer_load_dwordx4 v12, s[80:83], s13 offen offset:0 lds
    v_mfma_f32_16x16x32_bf16 v[100:103], v[128:131], v[164:167], v[100:103]
    ds_read2_b32 v[194:195], v28 offset0:18 offset1:19
    v_mfma_f32_16x16x32_bf16 v[104:107], v[128:131], v[168:171], v[104:107]
    ds_read_b128 v[224:227], v32 offset:3648
    v_mfma_f32_16x16x32_bf16 v[108:111], v[128:131], v[172:175], v[108:111]
    ds_read2_b32 v[196:197], v28 offset0:144 offset1:145
    v_mfma_f32_16x16x32_bf16 v[112:115], v[128:131], v[176:179], v[112:115]
    ds_read2_b32 v[198:199], v28 offset0:146 offset1:147
    v_mfma_f32_16x16x32_bf16 v[116:119], v[128:131], v[180:183], v[116:119]
    ds_read_b128 v[228:231], v32 offset:3136
    v_mfma_f32_16x16x32_bf16 v[120:123], v[128:131], v[184:187], v[120:123]
    ds_read2_b32 v[200:201], v29 offset0:16 offset1:17
    v_mfma_f32_16x16x32_bf16 v[124:127], v[128:131], v[188:191], v[124:127]
    ds_read2_b32 v[202:203], v29 offset0:18 offset1:19
    v_mfma_f32_16x16x32_bf16 v[100:103], v[132:135], v[160:163], v[100:103]
    ds_read_b128 v[232:235], v32 offset:2624
    buffer_load_dwordx4 v13, s[80:83], s13 offen offset:1024 lds
    v_mfma_f32_16x16x32_bf16 v[104:107], v[132:135], v[164:167], v[104:107]
    ds_read2_b32 v[204:205], v29 offset0:144 offset1:145
    v_mfma_f32_16x16x32_bf16 v[108:111], v[132:135], v[168:171], v[108:111]
    ds_read2_b32 v[206:207], v29 offset0:146 offset1:147
    v_mfma_f32_16x16x32_bf16 v[112:115], v[132:135], v[172:175], v[112:115]
    ds_read_b128 v[236:239], v32 offset:2112
    v_mfma_f32_16x16x32_bf16 v[116:119], v[132:135], v[176:179], v[116:119]
    ds_read2_b32 v[208:209], v30 offset0:16 offset1:17
    v_mfma_f32_16x16x32_bf16 v[120:123], v[132:135], v[180:183], v[120:123]
    ds_read2_b32 v[210:211], v30 offset0:18 offset1:19
    v_mfma_f32_16x16x32_bf16 v[124:127], v[132:135], v[184:187], v[124:127]
    ds_read_b128 v[240:243], v32 offset:1600
    v_mfma_f32_16x16x32_bf16 v[104:107], v[136:139], v[160:163], v[104:107]
    ds_read2_b32 v[212:213], v30 offset0:144 offset1:145
    v_mfma_f32_16x16x32_bf16 v[108:111], v[136:139], v[164:167], v[108:111]
    ds_read2_b32 v[214:215], v30 offset0:146 offset1:147
    buffer_load_dwordx4 v12, s[80:83], s13 offen offset:2048 lds
    v_mfma_f32_16x16x32_bf16 v[112:115], v[136:139], v[168:171], v[112:115]
    ds_read_b128 v[244:247], v32 offset:1088
    v_mfma_f32_16x16x32_bf16 v[116:119], v[136:139], v[172:175], v[116:119]
    ds_read2_b32 v[216:217], v31 offset0:16 offset1:17
    v_mfma_f32_16x16x32_bf16 v[120:123], v[136:139], v[176:179], v[120:123]
    ds_read2_b32 v[218:219], v31 offset0:18 offset1:19
    v_mfma_f32_16x16x32_bf16 v[124:127], v[136:139], v[180:183], v[124:127]
    ds_read_b128 v[248:251], v32 offset:576
    v_mfma_f32_16x16x32_bf16 v[108:111], v[140:143], v[160:163], v[108:111]
    ds_read2_b32 v[220:221], v31 offset0:144 offset1:145
    v_mfma_f32_16x16x32_bf16 v[112:115], v[140:143], v[164:167], v[112:115]
    ds_read2_b32 v[222:223], v31 offset0:146 offset1:147
    v_mfma_f32_16x16x32_bf16 v[116:119], v[140:143], v[168:171], v[116:119]
    ds_read_b128 v[252:255], v32 offset:64
    v_mfma_f32_16x16x32_bf16 v[120:123], v[140:143], v[172:175], v[120:123]
    buffer_load_dwordx4 v13, s[80:83], s13 offen offset:3072 lds
    v_mfma_f32_16x16x32_bf16 v[124:127], v[140:143], v[176:179], v[124:127]
    v_mfma_f32_16x16x32_bf16 v[112:115], v[144:147], v[160:163], v[112:115]
    v_mfma_f32_16x16x32_bf16 v[116:119], v[144:147], v[164:167], v[116:119]
    v_mfma_f32_16x16x32_bf16 v[120:123], v[144:147], v[168:171], v[120:123]
    v_mfma_f32_16x16x32_bf16 v[124:127], v[144:147], v[172:175], v[124:127]
    v_mfma_f32_16x16x32_bf16 v[116:119], v[148:151], v[160:163], v[116:119]
    v_mfma_f32_16x16x32_bf16 v[120:123], v[148:151], v[164:167], v[120:123]
    v_mfma_f32_16x16x32_bf16 v[124:127], v[148:151], v[168:171], v[124:127]
    s_bfe_u32 s13, s30, 28 + (4 << 16)
    s_lshl_b32 s13, s13, 7
    buffer_load_dwordx4 v[40:43], v12, s[80:83], s13 offen offset:0
    v_mfma_f32_16x16x32_bf16 v[120:123], v[152:155], v[160:163], v[120:123]
    v_mfma_f32_16x16x32_bf16 v[124:127], v[152:155], v[164:167], v[124:127]
    v_mfma_f32_16x16x32_bf16 v[124:127], v[156:159], v[160:163], v[124:127]
    s_waitcnt lgkmcnt(0)
    v_mfma_f32_16x16x32_bf16 v[96:99], v[192:195], v[224:227], v[96:99]
    ds_read2_b32 v[128:129], v28 offset0:32 offset1:33
    v_mfma_f32_16x16x32_bf16 v[100:103], v[192:195], v[228:231], v[100:103]
    ds_read2_b32 v[130:131], v28 offset0:34 offset1:35
    v_mfma_f32_16x16x32_bf16 v[104:107], v[192:195], v[232:235], v[104:107]
    ds_read_b128 v[160:163], v32 offset:3712
    v_mfma_f32_16x16x32_bf16 v[108:111], v[192:195], v[236:239], v[108:111]
    ds_read2_b32 v[132:133], v28 offset0:160 offset1:161
    v_mfma_f32_16x16x32_bf16 v[112:115], v[192:195], v[240:243], v[112:115]
    ds_read2_b32 v[134:135], v28 offset0:162 offset1:163
    buffer_load_dwordx4 v[44:47], v13, s[80:83], s13 offen offset:1024
    v_mfma_f32_16x16x32_bf16 v[116:119], v[192:195], v[244:247], v[116:119]
    ds_read_b128 v[164:167], v32 offset:3200
    v_mfma_f32_16x16x32_bf16 v[120:123], v[192:195], v[248:251], v[120:123]
    ds_read2_b32 v[136:137], v29 offset0:32 offset1:33
    v_mfma_f32_16x16x32_bf16 v[124:127], v[192:195], v[252:255], v[124:127]
    ds_read2_b32 v[138:139], v29 offset0:34 offset1:35
    v_mfma_f32_16x16x32_bf16 v[100:103], v[196:199], v[224:227], v[100:103]
    ds_read_b128 v[168:171], v32 offset:2688
    v_mfma_f32_16x16x32_bf16 v[104:107], v[196:199], v[228:231], v[104:107]
    ds_read2_b32 v[140:141], v29 offset0:160 offset1:161
    v_mfma_f32_16x16x32_bf16 v[108:111], v[196:199], v[232:235], v[108:111]
    ds_read2_b32 v[142:143], v29 offset0:162 offset1:163
    v_mfma_f32_16x16x32_bf16 v[112:115], v[196:199], v[236:239], v[112:115]
    ds_read_b128 v[172:175], v32 offset:2176
    v_mfma_f32_16x16x32_bf16 v[116:119], v[196:199], v[240:243], v[116:119]
    ds_read2_b32 v[144:145], v30 offset0:32 offset1:33
    buffer_load_dwordx4 v[48:51], v12, s[80:83], s13 offen offset:2048
    v_mfma_f32_16x16x32_bf16 v[120:123], v[196:199], v[244:247], v[120:123]
    ds_read2_b32 v[146:147], v30 offset0:34 offset1:35
    v_mfma_f32_16x16x32_bf16 v[124:127], v[196:199], v[248:251], v[124:127]
    ds_read_b128 v[176:179], v32 offset:1664
    v_mfma_f32_16x16x32_bf16 v[104:107], v[200:203], v[224:227], v[104:107]
    ds_read2_b32 v[148:149], v30 offset0:160 offset1:161
    v_mfma_f32_16x16x32_bf16 v[108:111], v[200:203], v[228:231], v[108:111]
    ds_read2_b32 v[150:151], v30 offset0:162 offset1:163
    v_mfma_f32_16x16x32_bf16 v[112:115], v[200:203], v[232:235], v[112:115]
    ds_read_b128 v[180:183], v32 offset:1152
    v_mfma_f32_16x16x32_bf16 v[116:119], v[200:203], v[236:239], v[116:119]
    ds_read2_b32 v[152:153], v31 offset0:32 offset1:33
    v_mfma_f32_16x16x32_bf16 v[120:123], v[200:203], v[240:243], v[120:123]
    ds_read2_b32 v[154:155], v31 offset0:34 offset1:35
    v_mfma_f32_16x16x32_bf16 v[124:127], v[200:203], v[244:247], v[124:127]
    ds_read_b128 v[184:187], v32 offset:640
    buffer_load_dwordx4 v[52:55], v13, s[80:83], s13 offen offset:3072
    v_mfma_f32_16x16x32_bf16 v[108:111], v[204:207], v[224:227], v[108:111]
    ds_read2_b32 v[156:157], v31 offset0:160 offset1:161
    v_mfma_f32_16x16x32_bf16 v[112:115], v[204:207], v[228:231], v[112:115]
    ds_read2_b32 v[158:159], v31 offset0:162 offset1:163
    v_mfma_f32_16x16x32_bf16 v[116:119], v[204:207], v[232:235], v[116:119]
    ds_read_b128 v[188:191], v32 offset:128
    v_mfma_f32_16x16x32_bf16 v[120:123], v[204:207], v[236:239], v[120:123]
    v_mfma_f32_16x16x32_bf16 v[124:127], v[204:207], v[240:243], v[124:127]
    v_mfma_f32_16x16x32_bf16 v[112:115], v[208:211], v[224:227], v[112:115]
    v_mfma_f32_16x16x32_bf16 v[116:119], v[208:211], v[228:231], v[116:119]
    v_mfma_f32_16x16x32_bf16 v[120:123], v[208:211], v[232:235], v[120:123]
    s_bfe_u32 s13, s30, 24 + (4 << 16)
    s_lshl_b32 s13, s13, 7
    buffer_load_dwordx4 v[80:83], v12, s[80:83], s13 offen offset:0
    v_mfma_f32_16x16x32_bf16 v[124:127], v[208:211], v[236:239], v[124:127]
    v_mfma_f32_16x16x32_bf16 v[116:119], v[212:215], v[224:227], v[116:119]
    v_mfma_f32_16x16x32_bf16 v[120:123], v[212:215], v[228:231], v[120:123]
    v_mfma_f32_16x16x32_bf16 v[124:127], v[212:215], v[232:235], v[124:127]
    v_mfma_f32_16x16x32_bf16 v[120:123], v[216:219], v[224:227], v[120:123]
    v_mfma_f32_16x16x32_bf16 v[124:127], v[216:219], v[228:231], v[124:127]
    v_mfma_f32_16x16x32_bf16 v[124:127], v[220:223], v[224:227], v[124:127]
    s_waitcnt lgkmcnt(0)
    v_mfma_f32_16x16x32_bf16 v[96:99], v[128:131], v[160:163], v[96:99]
    ds_read2_b32 v[192:193], v28 offset0:48 offset1:49
    buffer_load_dwordx4 v[84:87], v13, s[80:83], s13 offen offset:1024
    v_mfma_f32_16x16x32_bf16 v[100:103], v[128:131], v[164:167], v[100:103]
    ds_read2_b32 v[194:195], v28 offset0:50 offset1:51
    v_mfma_f32_16x16x32_bf16 v[104:107], v[128:131], v[168:171], v[104:107]
    ds_read_b128 v[224:227], v32 offset:3776
    v_mfma_f32_16x16x32_bf16 v[108:111], v[128:131], v[172:175], v[108:111]
    ds_read2_b32 v[196:197], v28 offset0:176 offset1:177
    v_mfma_f32_16x16x32_bf16 v[112:115], v[128:131], v[176:179], v[112:115]
    ds_read2_b32 v[198:199], v28 offset0:178 offset1:179
    v_mfma_f32_16x16x32_bf16 v[116:119], v[128:131], v[180:183], v[116:119]
    ds_read_b128 v[228:231], v32 offset:3264
    v_mfma_f32_16x16x32_bf16 v[120:123], v[128:131], v[184:187], v[120:123]
    ds_read2_b32 v[200:201], v29 offset0:48 offset1:49
    v_mfma_f32_16x16x32_bf16 v[124:127], v[128:131], v[188:191], v[124:127]
    ds_read2_b32 v[202:203], v29 offset0:50 offset1:51
    v_mfma_f32_16x16x32_bf16 v[100:103], v[132:135], v[160:163], v[100:103]
    ds_read_b128 v[232:235], v32 offset:2752
    buffer_load_dwordx4 v[88:91], v12, s[80:83], s13 offen offset:2048
    v_mfma_f32_16x16x32_bf16 v[104:107], v[132:135], v[164:167], v[104:107]
    ds_read2_b32 v[204:205], v29 offset0:176 offset1:177
    v_mfma_f32_16x16x32_bf16 v[108:111], v[132:135], v[168:171], v[108:111]
    ds_read2_b32 v[206:207], v29 offset0:178 offset1:179
    v_mfma_f32_16x16x32_bf16 v[112:115], v[132:135], v[172:175], v[112:115]
    ds_read_b128 v[236:239], v32 offset:2240
    v_mfma_f32_16x16x32_bf16 v[116:119], v[132:135], v[176:179], v[116:119]
    ds_read2_b32 v[208:209], v30 offset0:48 offset1:49
    v_mfma_f32_16x16x32_bf16 v[120:123], v[132:135], v[180:183], v[120:123]
    ds_read2_b32 v[210:211], v30 offset0:50 offset1:51
    v_mfma_f32_16x16x32_bf16 v[124:127], v[132:135], v[184:187], v[124:127]
    ds_read_b128 v[240:243], v32 offset:1728
    v_mfma_f32_16x16x32_bf16 v[104:107], v[136:139], v[160:163], v[104:107]
    ds_read2_b32 v[212:213], v30 offset0:176 offset1:177
    v_mfma_f32_16x16x32_bf16 v[108:111], v[136:139], v[164:167], v[108:111]
    ds_read2_b32 v[214:215], v30 offset0:178 offset1:179
    buffer_load_dwordx4 v[92:95], v13, s[80:83], s13 offen offset:3072
    v_mfma_f32_16x16x32_bf16 v[112:115], v[136:139], v[168:171], v[112:115]
    ds_read_b128 v[244:247], v32 offset:1216
    v_mfma_f32_16x16x32_bf16 v[116:119], v[136:139], v[172:175], v[116:119]
    ds_read2_b32 v[216:217], v31 offset0:48 offset1:49
    v_mfma_f32_16x16x32_bf16 v[120:123], v[136:139], v[176:179], v[120:123]
    ds_read2_b32 v[218:219], v31 offset0:50 offset1:51
    v_mfma_f32_16x16x32_bf16 v[124:127], v[136:139], v[180:183], v[124:127]
    ds_read_b128 v[248:251], v32 offset:704
    v_mfma_f32_16x16x32_bf16 v[108:111], v[140:143], v[160:163], v[108:111]
    ds_read2_b32 v[220:221], v31 offset0:176 offset1:177
    v_mfma_f32_16x16x32_bf16 v[112:115], v[140:143], v[164:167], v[112:115]
    ds_read2_b32 v[222:223], v31 offset0:178 offset1:179
    v_mfma_f32_16x16x32_bf16 v[116:119], v[140:143], v[168:171], v[116:119]
    ds_read_b128 v[252:255], v32 offset:192
    v_mfma_f32_16x16x32_bf16 v[120:123], v[140:143], v[172:175], v[120:123]
    s_bfe_u32 s13, s30, 20 + (4 << 16)
    s_lshl_b32 s13, s13, 7
    buffer_load_dwordx4 v[64:67], v12, s[80:83], s13 offen offset:0
    v_mfma_f32_16x16x32_bf16 v[124:127], v[140:143], v[176:179], v[124:127]
    v_mfma_f32_16x16x32_bf16 v[112:115], v[144:147], v[160:163], v[112:115]
    v_mfma_f32_16x16x32_bf16 v[116:119], v[144:147], v[164:167], v[116:119]
    v_mfma_f32_16x16x32_bf16 v[120:123], v[144:147], v[168:171], v[120:123]
    v_mfma_f32_16x16x32_bf16 v[124:127], v[144:147], v[172:175], v[124:127]
    v_mfma_f32_16x16x32_bf16 v[116:119], v[148:151], v[160:163], v[116:119]
    s_waitcnt vmcnt(9)
    v_mov_b32 v60, 1
    s_mov_b64 exec, 1
    ds_add_u32 v21, v60 offset:60
    s_mov_b64 exec, -1
    v_mfma_f32_16x16x32_bf16 v[120:123], v[148:151], v[164:167], v[120:123]
    v_mfma_f32_16x16x32_bf16 v[124:127], v[148:151], v[168:171], v[124:127]
    buffer_load_dwordx4 v[68:71], v13, s[80:83], s13 offen offset:1024
    v_mfma_f32_16x16x32_bf16 v[120:123], v[152:155], v[160:163], v[120:123]
    v_mfma_f32_16x16x32_bf16 v[124:127], v[152:155], v[164:167], v[124:127]
    v_mfma_f32_16x16x32_bf16 v[124:127], v[156:159], v[160:163], v[124:127]
    s_waitcnt lgkmcnt(0)
    v_mfma_f32_16x16x32_bf16 v[96:99], v[192:195], v[224:227], v[96:99]
    ds_read2_b32 v[128:129], v28 offset0:64 offset1:65
    v_mfma_f32_16x16x32_bf16 v[100:103], v[192:195], v[228:231], v[100:103]
    ds_read2_b32 v[130:131], v28 offset0:66 offset1:67
    v_mfma_f32_16x16x32_bf16 v[104:107], v[192:195], v[232:235], v[104:107]
    ds_read_b128 v[160:163], v32 offset:3840
    v_mfma_f32_16x16x32_bf16 v[108:111], v[192:195], v[236:239], v[108:111]
    ds_read2_b32 v[132:133], v28 offset0:192 offset1:193
    v_mfma_f32_16x16x32_bf16 v[112:115], v[192:195], v[240:243], v[112:115]
    ds_read2_b32 v[134:135], v28 offset0:194 offset1:195
    buffer_load_dwordx4 v[72:75], v12, s[80:83], s13 offen offset:2048
    v_mfma_f32_16x16x32_bf16 v[116:119], v[192:195], v[244:247], v[116:119]
    ds_read_b128 v[164:167], v32 offset:3328
    v_mfma_f32_16x16x32_bf16 v[120:123], v[192:195], v[248:251], v[120:123]
    ds_read2_b32 v[136:137], v29 offset0:64 offset1:65
    v_mfma_f32_16x16x32_bf16 v[124:127], v[192:195], v[252:255], v[124:127]
    ds_read2_b32 v[138:139], v29 offset0:66 offset1:67
    v_mfma_f32_16x16x32_bf16 v[100:103], v[196:199], v[224:227], v[100:103]
    ds_read_b128 v[168:171], v32 offset:2816
    v_mfma_f32_16x16x32_bf16 v[104:107], v[196:199], v[228:231], v[104:107]
    ds_read2_b32 v[140:141], v29 offset0:192 offset1:193
    v_mfma_f32_16x16x32_bf16 v[108:111], v[196:199], v[232:235], v[108:111]
    ds_read2_b32 v[142:143], v29 offset0:194 offset1:195
    v_mfma_f32_16x16x32_bf16 v[112:115], v[196:199], v[236:239], v[112:115]
    ds_read_b128 v[172:175], v32 offset:2304
    v_mfma_f32_16x16x32_bf16 v[116:119], v[196:199], v[240:243], v[116:119]
    ds_read2_b32 v[144:145], v30 offset0:64 offset1:65
    buffer_load_dwordx4 v[76:79], v13, s[80:83], s13 offen offset:3072
    v_mfma_f32_16x16x32_bf16 v[120:123], v[196:199], v[244:247], v[120:123]
    ds_read2_b32 v[146:147], v30 offset0:66 offset1:67
    v_mfma_f32_16x16x32_bf16 v[124:127], v[196:199], v[248:251], v[124:127]
    ds_read_b128 v[176:179], v32 offset:1792
    v_mfma_f32_16x16x32_bf16 v[104:107], v[200:203], v[224:227], v[104:107]
    ds_read2_b32 v[148:149], v30 offset0:192 offset1:193
    v_mfma_f32_16x16x32_bf16 v[108:111], v[200:203], v[228:231], v[108:111]
    ds_read2_b32 v[150:151], v30 offset0:194 offset1:195
    v_mfma_f32_16x16x32_bf16 v[112:115], v[200:203], v[232:235], v[112:115]
    ds_read_b128 v[180:183], v32 offset:1280
    v_mfma_f32_16x16x32_bf16 v[116:119], v[200:203], v[236:239], v[116:119]
    ds_read2_b32 v[152:153], v31 offset0:64 offset1:65
    v_mfma_f32_16x16x32_bf16 v[120:123], v[200:203], v[240:243], v[120:123]
    ds_read2_b32 v[154:155], v31 offset0:66 offset1:67
    v_mfma_f32_16x16x32_bf16 v[124:127], v[200:203], v[244:247], v[124:127]
    ds_read_b128 v[184:187], v32 offset:768
    v_mfma_f32_16x16x32_bf16 v[108:111], v[204:207], v[224:227], v[108:111]
    ds_read2_b32 v[156:157], v31 offset0:192 offset1:193
    v_mfma_f32_16x16x32_bf16 v[112:115], v[204:207], v[228:231], v[112:115]
    ds_read2_b32 v[158:159], v31 offset0:194 offset1:195
    v_mfma_f32_16x16x32_bf16 v[116:119], v[204:207], v[232:235], v[116:119]
    ds_read_b128 v[188:191], v32 offset:256
    v_mfma_f32_16x16x32_bf16 v[120:123], v[204:207], v[236:239], v[120:123]
    v_mfma_f32_16x16x32_bf16 v[124:127], v[204:207], v[240:243], v[124:127]
    v_mfma_f32_16x16x32_bf16 v[112:115], v[208:211], v[224:227], v[112:115]
    v_mfma_f32_16x16x32_bf16 v[116:119], v[208:211], v[228:231], v[116:119]
    v_mfma_f32_16x16x32_bf16 v[120:123], v[208:211], v[232:235], v[120:123]
    v_mfma_f32_16x16x32_bf16 v[124:127], v[208:211], v[236:239], v[124:127]
    v_mfma_f32_16x16x32_bf16 v[116:119], v[212:215], v[224:227], v[116:119]
    v_mfma_f32_16x16x32_bf16 v[120:123], v[212:215], v[228:231], v[120:123]
    v_mfma_f32_16x16x32_bf16 v[124:127], v[212:215], v[232:235], v[124:127]
    v_mfma_f32_16x16x32_bf16 v[120:123], v[216:219], v[224:227], v[120:123]
    v_mfma_f32_16x16x32_bf16 v[124:127], v[216:219], v[228:231], v[124:127]
    v_mfma_f32_16x16x32_bf16 v[124:127], v[220:223], v[224:227], v[124:127]
    s_waitcnt lgkmcnt(0)
    v_mfma_f32_16x16x32_bf16 v[96:99], v[128:131], v[160:163], v[96:99]
    ds_read2_b32 v[192:193], v28 offset0:80 offset1:81
    v_mfma_f32_16x16x32_bf16 v[100:103], v[128:131], v[164:167], v[100:103]
    ds_read2_b32 v[194:195], v28 offset0:82 offset1:83
    v_mfma_f32_16x16x32_bf16 v[104:107], v[128:131], v[168:171], v[104:107]
    ds_read_b128 v[224:227], v32 offset:3904
    v_mfma_f32_16x16x32_bf16 v[108:111], v[128:131], v[172:175], v[108:111]
    ds_read2_b32 v[196:197], v28 offset0:208 offset1:209
    v_mfma_f32_16x16x32_bf16 v[112:115], v[128:131], v[176:179], v[112:115]
    ds_read2_b32 v[198:199], v28 offset0:210 offset1:211
    v_mfma_f32_16x16x32_bf16 v[116:119], v[128:131], v[180:183], v[116:119]
    ds_read_b128 v[228:231], v32 offset:3392
    v_mfma_f32_16x16x32_bf16 v[120:123], v[128:131], v[184:187], v[120:123]
    ds_read2_b32 v[200:201], v29 offset0:80 offset1:81
    v_mfma_f32_16x16x32_bf16 v[124:127], v[128:131], v[188:191], v[124:127]
    ds_read2_b32 v[202:203], v29 offset0:82 offset1:83
    v_mfma_f32_16x16x32_bf16 v[100:103], v[132:135], v[160:163], v[100:103]
    ds_read_b128 v[232:235], v32 offset:2880
    v_mfma_f32_16x16x32_bf16 v[104:107], v[132:135], v[164:167], v[104:107]
    ds_read2_b32 v[204:205], v29 offset0:208 offset1:209
    v_mfma_f32_16x16x32_bf16 v[108:111], v[132:135], v[168:171], v[108:111]
    ds_read2_b32 v[206:207], v29 offset0:210 offset1:211
    v_mfma_f32_16x16x32_bf16 v[112:115], v[132:135], v[172:175], v[112:115]
    ds_read_b128 v[236:239], v32 offset:2368
    v_mfma_f32_16x16x32_bf16 v[116:119], v[132:135], v[176:179], v[116:119]
    ds_read2_b32 v[208:209], v30 offset0:80 offset1:81
    v_mfma_f32_16x16x32_bf16 v[120:123], v[132:135], v[180:183], v[120:123]
    ds_read2_b32 v[210:211], v30 offset0:82 offset1:83
    v_mfma_f32_16x16x32_bf16 v[124:127], v[132:135], v[184:187], v[124:127]
    ds_read_b128 v[240:243], v32 offset:1856
    v_mfma_f32_16x16x32_bf16 v[104:107], v[136:139], v[160:163], v[104:107]
    ds_read2_b32 v[212:213], v30 offset0:208 offset1:209
    v_mfma_f32_16x16x32_bf16 v[108:111], v[136:139], v[164:167], v[108:111]
    ds_read2_b32 v[214:215], v30 offset0:210 offset1:211
    v_mfma_f32_16x16x32_bf16 v[112:115], v[136:139], v[168:171], v[112:115]
    ds_read_b128 v[244:247], v32 offset:1344
    v_mfma_f32_16x16x32_bf16 v[116:119], v[136:139], v[172:175], v[116:119]
    ds_read2_b32 v[216:217], v31 offset0:80 offset1:81
    v_mfma_f32_16x16x32_bf16 v[120:123], v[136:139], v[176:179], v[120:123]
    ds_read2_b32 v[218:219], v31 offset0:82 offset1:83
    v_mfma_f32_16x16x32_bf16 v[124:127], v[136:139], v[180:183], v[124:127]
    ds_read_b128 v[248:251], v32 offset:832
    v_mfma_f32_16x16x32_bf16 v[108:111], v[140:143], v[160:163], v[108:111]
    ds_read2_b32 v[220:221], v31 offset0:208 offset1:209
    v_mfma_f32_16x16x32_bf16 v[112:115], v[140:143], v[164:167], v[112:115]
    ds_read2_b32 v[222:223], v31 offset0:210 offset1:211
    v_mfma_f32_16x16x32_bf16 v[116:119], v[140:143], v[168:171], v[116:119]
    ds_read_b128 v[252:255], v32 offset:320
    v_mfma_f32_16x16x32_bf16 v[120:123], v[140:143], v[172:175], v[120:123]
    v_mfma_f32_16x16x32_bf16 v[124:127], v[140:143], v[176:179], v[124:127]
    v_mfma_f32_16x16x32_bf16 v[112:115], v[144:147], v[160:163], v[112:115]
    v_mfma_f32_16x16x32_bf16 v[116:119], v[144:147], v[164:167], v[116:119]
    v_mfma_f32_16x16x32_bf16 v[120:123], v[144:147], v[168:171], v[120:123]
    v_mfma_f32_16x16x32_bf16 v[124:127], v[144:147], v[172:175], v[124:127]
    v_mfma_f32_16x16x32_bf16 v[116:119], v[148:151], v[160:163], v[116:119]
    v_mfma_f32_16x16x32_bf16 v[120:123], v[148:151], v[164:167], v[120:123]
    v_mfma_f32_16x16x32_bf16 v[124:127], v[148:151], v[168:171], v[124:127]
    v_mfma_f32_16x16x32_bf16 v[120:123], v[152:155], v[160:163], v[120:123]
    v_mfma_f32_16x16x32_bf16 v[124:127], v[152:155], v[164:167], v[124:127]
    v_mfma_f32_16x16x32_bf16 v[124:127], v[156:159], v[160:163], v[124:127]
    s_waitcnt lgkmcnt(0)
    v_mfma_f32_16x16x32_bf16 v[96:99], v[192:195], v[224:227], v[96:99]
    ds_read2_b32 v[128:129], v28 offset0:96 offset1:97
    v_mfma_f32_16x16x32_bf16 v[100:103], v[192:195], v[228:231], v[100:103]
    ds_read2_b32 v[130:131], v28 offset0:98 offset1:99
    v_mfma_f32_16x16x32_bf16 v[104:107], v[192:195], v[232:235], v[104:107]
    ds_read_b128 v[160:163], v32 offset:3968
    v_mfma_f32_16x16x32_bf16 v[108:111], v[192:195], v[236:239], v[108:111]
    ds_read2_b32 v[132:133], v28 offset0:224 offset1:225
    v_mfma_f32_16x16x32_bf16 v[112:115], v[192:195], v[240:243], v[112:115]
    ds_read2_b32 v[134:135], v28 offset0:226 offset1:227
    v_mfma_f32_16x16x32_bf16 v[116:119], v[192:195], v[244:247], v[116:119]
    ds_read_b128 v[164:167], v32 offset:3456
    v_mfma_f32_16x16x32_bf16 v[120:123], v[192:195], v[248:251], v[120:123]
    ds_read2_b32 v[136:137], v29 offset0:96 offset1:97
    v_mfma_f32_16x16x32_bf16 v[124:127], v[192:195], v[252:255], v[124:127]
    ds_read2_b32 v[138:139], v29 offset0:98 offset1:99
    v_mfma_f32_16x16x32_bf16 v[100:103], v[196:199], v[224:227], v[100:103]
    ds_read_b128 v[168:171], v32 offset:2944
    v_mfma_f32_16x16x32_bf16 v[104:107], v[196:199], v[228:231], v[104:107]
    ds_read2_b32 v[140:141], v29 offset0:224 offset1:225
    v_mfma_f32_16x16x32_bf16 v[108:111], v[196:199], v[232:235], v[108:111]
    ds_read2_b32 v[142:143], v29 offset0:226 offset1:227
    v_mfma_f32_16x16x32_bf16 v[112:115], v[196:199], v[236:239], v[112:115]
    ds_read_b128 v[172:175], v32 offset:2432
    v_mfma_f32_16x16x32_bf16 v[116:119], v[196:199], v[240:243], v[116:119]
    ds_read2_b32 v[144:145], v30 offset0:96 offset1:97
    v_mfma_f32_16x16x32_bf16 v[120:123], v[196:199], v[244:247], v[120:123]
    ds_read2_b32 v[146:147], v30 offset0:98 offset1:99
    v_mfma_f32_16x16x32_bf16 v[124:127], v[196:199], v[248:251], v[124:127]
    ds_read_b128 v[176:179], v32 offset:1920
    v_mfma_f32_16x16x32_bf16 v[104:107], v[200:203], v[224:227], v[104:107]
    ds_read2_b32 v[148:149], v30 offset0:224 offset1:225
    v_mfma_f32_16x16x32_bf16 v[108:111], v[200:203], v[228:231], v[108:111]
    ds_read2_b32 v[150:151], v30 offset0:226 offset1:227
    v_mfma_f32_16x16x32_bf16 v[112:115], v[200:203], v[232:235], v[112:115]
    ds_read_b128 v[180:183], v32 offset:1408
    v_mfma_f32_16x16x32_bf16 v[116:119], v[200:203], v[236:239], v[116:119]
    ds_read2_b32 v[152:153], v31 offset0:96 offset1:97
    v_mfma_f32_16x16x32_bf16 v[120:123], v[200:203], v[240:243], v[120:123]
    ds_read2_b32 v[154:155], v31 offset0:98 offset1:99
    v_mfma_f32_16x16x32_bf16 v[124:127], v[200:203], v[244:247], v[124:127]
    ds_read_b128 v[184:187], v32 offset:896
    v_mfma_f32_16x16x32_bf16 v[108:111], v[204:207], v[224:227], v[108:111]
    ds_read2_b32 v[156:157], v31 offset0:224 offset1:225
    v_mfma_f32_16x16x32_bf16 v[112:115], v[204:207], v[228:231], v[112:115]
    ds_read2_b32 v[158:159], v31 offset0:226 offset1:227
    v_mfma_f32_16x16x32_bf16 v[116:119], v[204:207], v[232:235], v[116:119]
    ds_read_b128 v[188:191], v32 offset:384
    v_mfma_f32_16x16x32_bf16 v[120:123], v[204:207], v[236:239], v[120:123]
    v_mfma_f32_16x16x32_bf16 v[124:127], v[204:207], v[240:243], v[124:127]
    v_mfma_f32_16x16x32_bf16 v[112:115], v[208:211], v[224:227], v[112:115]
    v_mfma_f32_16x16x32_bf16 v[116:119], v[208:211], v[228:231], v[116:119]
    v_mfma_f32_16x16x32_bf16 v[120:123], v[208:211], v[232:235], v[120:123]
    v_mfma_f32_16x16x32_bf16 v[124:127], v[208:211], v[236:239], v[124:127]
    v_mfma_f32_16x16x32_bf16 v[116:119], v[212:215], v[224:227], v[116:119]
    v_mfma_f32_16x16x32_bf16 v[120:123], v[212:215], v[228:231], v[120:123]
    v_mfma_f32_16x16x32_bf16 v[124:127], v[212:215], v[232:235], v[124:127]
    v_mfma_f32_16x16x32_bf16 v[120:123], v[216:219], v[224:227], v[120:123]
    v_mfma_f32_16x16x32_bf16 v[124:127], v[216:219], v[228:231], v[124:127]
    v_mfma_f32_16x16x32_bf16 v[124:127], v[220:223], v[224:227], v[124:127]
    s_waitcnt lgkmcnt(0)
    v_mfma_f32_16x16x32_bf16 v[96:99], v[128:131], v[160:163], v[96:99]
    ds_read2_b32 v[192:193], v28 offset0:112 offset1:113
    v_mfma_f32_16x16x32_bf16 v[100:103], v[128:131], v[164:167], v[100:103]
    ds_read2_b32 v[194:195], v28 offset0:114 offset1:115
    v_mfma_f32_16x16x32_bf16 v[104:107], v[128:131], v[168:171], v[104:107]
    ds_read_b128 v[224:227], v32 offset:4032
    v_mfma_f32_16x16x32_bf16 v[108:111], v[128:131], v[172:175], v[108:111]
    ds_read2_b32 v[196:197], v28 offset0:240 offset1:241
    v_mfma_f32_16x16x32_bf16 v[112:115], v[128:131], v[176:179], v[112:115]
    ds_read2_b32 v[198:199], v28 offset0:242 offset1:243
    v_mfma_f32_16x16x32_bf16 v[116:119], v[128:131], v[180:183], v[116:119]
    ds_read_b128 v[228:231], v32 offset:3520
    v_mfma_f32_16x16x32_bf16 v[120:123], v[128:131], v[184:187], v[120:123]
    ds_read2_b32 v[200:201], v29 offset0:112 offset1:113
    v_mfma_f32_16x16x32_bf16 v[124:127], v[128:131], v[188:191], v[124:127]
    ds_read2_b32 v[202:203], v29 offset0:114 offset1:115
    v_mfma_f32_16x16x32_bf16 v[100:103], v[132:135], v[160:163], v[100:103]
    ds_read_b128 v[232:235], v32 offset:3008
    v_mfma_f32_16x16x32_bf16 v[104:107], v[132:135], v[164:167], v[104:107]
    ds_read2_b32 v[204:205], v29 offset0:240 offset1:241
    v_mfma_f32_16x16x32_bf16 v[108:111], v[132:135], v[168:171], v[108:111]
    ds_read2_b32 v[206:207], v29 offset0:242 offset1:243
    v_mfma_f32_16x16x32_bf16 v[112:115], v[132:135], v[172:175], v[112:115]
    ds_read_b128 v[236:239], v32 offset:2496
    v_mfma_f32_16x16x32_bf16 v[116:119], v[132:135], v[176:179], v[116:119]
    ds_read2_b32 v[208:209], v30 offset0:112 offset1:113
    v_mfma_f32_16x16x32_bf16 v[120:123], v[132:135], v[180:183], v[120:123]
    ds_read2_b32 v[210:211], v30 offset0:114 offset1:115
    v_mfma_f32_16x16x32_bf16 v[124:127], v[132:135], v[184:187], v[124:127]
    ds_read_b128 v[240:243], v32 offset:1984
    v_mfma_f32_16x16x32_bf16 v[104:107], v[136:139], v[160:163], v[104:107]
    ds_read2_b32 v[212:213], v30 offset0:240 offset1:241
    v_mfma_f32_16x16x32_bf16 v[108:111], v[136:139], v[164:167], v[108:111]
    ds_read2_b32 v[214:215], v30 offset0:242 offset1:243
    v_mfma_f32_16x16x32_bf16 v[112:115], v[136:139], v[168:171], v[112:115]
    ds_read_b128 v[244:247], v32 offset:1472
    v_mfma_f32_16x16x32_bf16 v[116:119], v[136:139], v[172:175], v[116:119]
    ds_read2_b32 v[216:217], v31 offset0:112 offset1:113
    v_mfma_f32_16x16x32_bf16 v[120:123], v[136:139], v[176:179], v[120:123]
    ds_read2_b32 v[218:219], v31 offset0:114 offset1:115
    v_mfma_f32_16x16x32_bf16 v[124:127], v[136:139], v[180:183], v[124:127]
    ds_read_b128 v[248:251], v32 offset:960
    v_mfma_f32_16x16x32_bf16 v[108:111], v[140:143], v[160:163], v[108:111]
    ds_read2_b32 v[220:221], v31 offset0:240 offset1:241
    v_mfma_f32_16x16x32_bf16 v[112:115], v[140:143], v[164:167], v[112:115]
    ds_read2_b32 v[222:223], v31 offset0:242 offset1:243
    v_mfma_f32_16x16x32_bf16 v[116:119], v[140:143], v[168:171], v[116:119]
    ds_read_b128 v[252:255], v32 offset:448
    v_mfma_f32_16x16x32_bf16 v[120:123], v[140:143], v[172:175], v[120:123]
    v_mfma_f32_16x16x32_bf16 v[124:127], v[140:143], v[176:179], v[124:127]
    v_mfma_f32_16x16x32_bf16 v[112:115], v[144:147], v[160:163], v[112:115]
    v_mfma_f32_16x16x32_bf16 v[116:119], v[144:147], v[164:167], v[116:119]
    v_mfma_f32_16x16x32_bf16 v[120:123], v[144:147], v[168:171], v[120:123]
    v_mfma_f32_16x16x32_bf16 v[124:127], v[144:147], v[172:175], v[124:127]
    v_mfma_f32_16x16x32_bf16 v[116:119], v[148:151], v[160:163], v[116:119]
    v_mfma_f32_16x16x32_bf16 v[120:123], v[148:151], v[164:167], v[120:123]
    v_mfma_f32_16x16x32_bf16 v[124:127], v[148:151], v[168:171], v[124:127]
    v_mfma_f32_16x16x32_bf16 v[120:123], v[152:155], v[160:163], v[120:123]
    v_mfma_f32_16x16x32_bf16 v[124:127], v[152:155], v[164:167], v[124:127]
    v_mfma_f32_16x16x32_bf16 v[124:127], v[156:159], v[160:163], v[124:127]
    s_waitcnt lgkmcnt(0)
    v_mfma_f32_16x16x32_bf16 v[96:99], v[192:195], v[224:227], v[96:99]
    v_mfma_f32_16x16x32_bf16 v[100:103], v[192:195], v[228:231], v[100:103]
    v_mfma_f32_16x16x32_bf16 v[104:107], v[192:195], v[232:235], v[104:107]
    v_mfma_f32_16x16x32_bf16 v[108:111], v[192:195], v[236:239], v[108:111]
    v_mfma_f32_16x16x32_bf16 v[112:115], v[192:195], v[240:243], v[112:115]
    v_mfma_f32_16x16x32_bf16 v[116:119], v[192:195], v[244:247], v[116:119]
    v_mfma_f32_16x16x32_bf16 v[120:123], v[192:195], v[248:251], v[120:123]
    v_mfma_f32_16x16x32_bf16 v[124:127], v[192:195], v[252:255], v[124:127]
    v_mfma_f32_16x16x32_bf16 v[100:103], v[196:199], v[224:227], v[100:103]
    v_mfma_f32_16x16x32_bf16 v[104:107], v[196:199], v[228:231], v[104:107]
    v_mfma_f32_16x16x32_bf16 v[108:111], v[196:199], v[232:235], v[108:111]
    v_mfma_f32_16x16x32_bf16 v[112:115], v[196:199], v[236:239], v[112:115]
    v_mfma_f32_16x16x32_bf16 v[116:119], v[196:199], v[240:243], v[116:119]
    v_mfma_f32_16x16x32_bf16 v[120:123], v[196:199], v[244:247], v[120:123]
    v_mfma_f32_16x16x32_bf16 v[124:127], v[196:199], v[248:251], v[124:127]
    v_mfma_f32_16x16x32_bf16 v[104:107], v[200:203], v[224:227], v[104:107]
    v_mfma_f32_16x16x32_bf16 v[108:111], v[200:203], v[228:231], v[108:111]
    v_mfma_f32_16x16x32_bf16 v[112:115], v[200:203], v[232:235], v[112:115]
    v_mfma_f32_16x16x32_bf16 v[116:119], v[200:203], v[236:239], v[116:119]
    v_mfma_f32_16x16x32_bf16 v[120:123], v[200:203], v[240:243], v[120:123]
    v_mfma_f32_16x16x32_bf16 v[124:127], v[200:203], v[244:247], v[124:127]
    v_mfma_f32_16x16x32_bf16 v[108:111], v[204:207], v[224:227], v[108:111]
    v_mfma_f32_16x16x32_bf16 v[112:115], v[204:207], v[228:231], v[112:115]
    v_mfma_f32_16x16x32_bf16 v[116:119], v[204:207], v[232:235], v[116:119]
    v_mfma_f32_16x16x32_bf16 v[120:123], v[204:207], v[236:239], v[120:123]
    v_mfma_f32_16x16x32_bf16 v[124:127], v[204:207], v[240:243], v[124:127]
    v_mfma_f32_16x16x32_bf16 v[112:115], v[208:211], v[224:227], v[112:115]
    v_mfma_f32_16x16x32_bf16 v[116:119], v[208:211], v[228:231], v[116:119]
    v_mfma_f32_16x16x32_bf16 v[120:123], v[208:211], v[232:235], v[120:123]
    v_mfma_f32_16x16x32_bf16 v[124:127], v[208:211], v[236:239], v[124:127]
    v_mfma_f32_16x16x32_bf16 v[116:119], v[212:215], v[224:227], v[116:119]
    v_mfma_f32_16x16x32_bf16 v[120:123], v[212:215], v[228:231], v[120:123]
    v_mfma_f32_16x16x32_bf16 v[124:127], v[212:215], v[232:235], v[124:127]
    v_mfma_f32_16x16x32_bf16 v[120:123], v[216:219], v[224:227], v[120:123]
    v_mfma_f32_16x16x32_bf16 v[124:127], v[216:219], v[228:231], v[124:127]
    v_mfma_f32_16x16x32_bf16 v[124:127], v[220:223], v[224:227], v[124:127]
    s_setprio 0
    v_cvt_pk_bf16_f32 v192, v96, v97
    v_cvt_pk_bf16_f32 v193, v98, v99
    v_cvt_pk_bf16_f32 v194, v100, v101
    v_cvt_pk_bf16_f32 v195, v102, v103
    v_cvt_pk_bf16_f32 v196, v104, v105
    v_cvt_pk_bf16_f32 v197, v106, v107
    v_cvt_pk_bf16_f32 v198, v108, v109
    v_cvt_pk_bf16_f32 v199, v110, v111
    v_cvt_pk_bf16_f32 v200, v112, v113
    v_cvt_pk_bf16_f32 v201, v114, v115
    v_cvt_pk_bf16_f32 v202, v116, v117
    v_cvt_pk_bf16_f32 v203, v118, v119
    v_cvt_pk_bf16_f32 v204, v120, v121
    v_cvt_pk_bf16_f32 v205, v122, v123
    v_cvt_pk_bf16_f32 v206, v124, v125
    v_cvt_pk_bf16_f32 v207, v126, v127
    v_permlane16_swap_b32 v192, v194
    v_permlane16_swap_b32 v193, v195
    v_permlane16_swap_b32 v196, v198
    v_permlane16_swap_b32 v197, v199
    v_permlane16_swap_b32 v200, v202
    v_permlane16_swap_b32 v201, v203
    v_permlane16_swap_b32 v204, v206
    v_permlane16_swap_b32 v205, v207
    ds_bpermute_b32 v192, v17, v192
    ds_bpermute_b32 v193, v17, v193
    ds_bpermute_b32 v194, v17, v194
    ds_bpermute_b32 v195, v17, v195
    ds_bpermute_b32 v196, v17, v196
    ds_bpermute_b32 v197, v17, v197
    ds_bpermute_b32 v198, v17, v198
    ds_bpermute_b32 v199, v17, v199
    ds_bpermute_b32 v200, v17, v200
    ds_bpermute_b32 v201, v17, v201
    ds_bpermute_b32 v202, v17, v202
    ds_bpermute_b32 v203, v17, v203
    ds_bpermute_b32 v204, v17, v204
    ds_bpermute_b32 v205, v17, v205
    ds_bpermute_b32 v206, v17, v206
    ds_bpermute_b32 v207, v17, v207
    ds_read_b32 v60, v21 offset:72
    s_waitcnt lgkmcnt(0)
    v_cmp_eq_u32 vcc, 1, v60
    s_cbranch_vccnz L_zp
    s_mov_b32 s13, 0
    buffer_store_dwordx4 v[192:195], v26, s[56:59], s36 offen offset:0 sc1
    buffer_store_dwordx4 v[196:199], v26, s[56:59], s36 offen offset:1024 sc1
    buffer_store_dwordx4 v[200:203], v26, s[56:59], s36 offen offset:2048 sc1
    buffer_store_dwordx4 v[204:207], v26, s[56:59], s36 offen offset:3072 sc1
    s_branch L_zq
L_zp:
    s_mov_b32 s13, 1
    buffer_store_dwordx4 v[192:195], v26, s[56:59], s36 offen offset:0
    buffer_store_dwordx4 v[196:199], v26, s[56:59], s36 offen offset:1024
    buffer_store_dwordx4 v[200:203], v26, s[56:59], s36 offen offset:2048
    buffer_store_dwordx4 v[204:207], v26, s[56:59], s36 offen offset:3072
L_zq:
    v_add_u32 v33, s101, v26
    s_waitcnt vmcnt(4)
    ds_write_b128 v33, v[64:67] offset:0
    ds_write_b128 v33, v[68:71] offset:1024
    ds_write_b128 v33, v[72:75] offset:2048
    ds_write_b128 v33, v[76:79] offset:3072
    ds_write_b128 v33, v[80:83] offset:4096
    ds_write_b128 v33, v[84:87] offset:5120
    ds_write_b128 v33, v[88:91] offset:6144
    ds_write_b128 v33, v[92:95] offset:7168
    ds_write_b128 v33, v[40:43] offset:8192
    ds_write_b128 v33, v[44:47] offset:9216
    ds_write_b128 v33, v[48:51] offset:10240
    ds_write_b128 v33, v[52:55] offset:11264
    v_mov_b32 v60, 1
    s_mov_b64 exec, 1
    ds_add_u32 v21, v60 offset:68
    s_mov_b64 exec, -1
    s_lshl_b32 s12, s100, 3
    s_add_u32 s12, s12, 8192
    v_lshlrev_b32 v28, 1, v23
    v_lshl_add_u32 v28, v24, 12, v28
    v_lshlrev_b32 v29, 2, v24
    v_lshl_add_u32 v29, v23, 13, v29
    v_lshrrev_b32 v60, 3, v2
    v_and_b32 v61, 7, v2
    v_lshl_add_u32 v28, v60, 2, s35
    v_lshlrev_b32 v28, 12, v28
    v_lshl_add_u32 v28, v61, 4, v28
    s_lshl_b32 s10, s5, 7
    v_add_u32 v28, s10, v28
    v_lshl_add_u32 v30, v61, 3, v60
    v_lshlrev_b32 v30, 2, v30
    s_waitcnt vmcnt(0)
    s_mov_b64 exec, 1
    s_cmp_eq_u32 s13, 1
    s_cbranch_scc0 L_xf2
    buffer_store_dwordx2 v[0:1], v19, s[72:75], s12 offen
    s_branch L_xf3
L_xf2:
    buffer_store_dwordx2 v[0:1], v19, s[72:75], s12 offen sc1
L_xf3:
    s_mov_b64 exec, -1
    s_mov_b32 s15, 0
L_zw_w:
    ds_read_b128 v[60:63], v21 offset:0
    s_waitcnt lgkmcnt(0)
    v_min3_u32 v60, v60, v61, v62
    v_min_u32 v60, v60, v63
    v_cmp_gt_u32 vcc, 24, v60
    s_cbranch_vccz L_zw_ok
    s_sleep 4
    s_add_u32 s15, s15, 1
    s_cmp_lt_u32 s15, 160000
    s_cbranch_scc1 L_zw_w
L_zw_ok:
    s_cmp_eq_u32 s8, 0
    s_cbranch_scc0 L_z1
    s_mov_b32 s15, 0
LZ_poll:
    buffer_load_dwordx4 v[60:63], v3, s[72:75], 0 offen sc1
    s_waitcnt vmcnt(0)
LZ_chk:
    v_cmp_ne_u64 vcc, v[60:61], v[0:1]
    v_cmp_ne_u64 s[10:11], v[62:63], v[0:1]
    s_or_b64 vcc, vcc, s[10:11]
    s_cbranch_scc0 LZ_ok
    s_sleep 4
    s_add_u32 s15, s15, 1
    s_cmp_lt_u32 s15, 20000
    s_cbranch_scc1 LZ_poll
LZ_ok:
    ds_write_b32 v21, v25 offset:48
L_z1:
    s_waitcnt vmcnt(0)
    v_lshlrev_b32 v128, 16, v4
    v_and_b32 v129, 0xffff0000, v4
    v_lshlrev_b32 v130, 16, v5
    v_and_b32 v131, 0xffff0000, v5
    v_lshlrev_b32 v132, 16, v6
    v_and_b32 v133, 0xffff0000, v6
    v_lshlrev_b32 v134, 16, v7
    v_and_b32 v135, 0xffff0000, v7
    v_lshlrev_b32 v136, 16, v8
    v_and_b32 v137, 0xffff0000, v8
    v_lshlrev_b32 v138, 16, v9
    v_and_b32 v139, 0xffff0000, v9
    v_lshlrev_b32 v140, 16, v10
    v_and_b32 v141, 0xffff0000, v10
    v_lshlrev_b32 v142, 16, v11
    v_and_b32 v143, 0xffff0000, v11
    v_lshlrev_b32 v144, 16, v14
    v_and_b32 v145, 0xffff0000, v14
    v_lshlrev_b32 v146, 16, v15
    v_and_b32 v147, 0xffff0000, v15
    v_lshlrev_b32 v148, 16, v56
    v_and_b32 v149, 0xffff0000, v56
    v_lshlrev_b32 v150, 16, v57
    v_and_b32 v151, 0xffff0000, v57
    v_lshlrev_b32 v152, 16, v58
    v_and_b32 v153, 0xffff0000, v58
    v_lshlrev_b32 v154, 16, v59
    v_and_b32 v155, 0xffff0000, v59
    v_lshlrev_b32 v156, 16, v34
    v_and_b32 v157, 0xffff0000, v34
    v_lshlrev_b32 v158, 16, v35
    v_and_b32 v159, 0xffff0000, v35
    s_mov_b32 s15, 0
L_fz_w:
    ds_read_b32 v60, v21 offset:48
    s_waitcnt lgkmcnt(0)
    v_cmp_gt_u32 vcc, 1, v60
    s_cbranch_vccz L_fz_ok
    s_sleep 1
    s_add_u32 s15, s15, 1
    s_cmp_lt_u32 s15, 160000
    s_cbranch_scc1 L_fz_w
L_fz_ok:
    buffer_load_dwordx4 v[64:67], v28, s[56:59], 0 offen sc1
    buffer_load_dwordx4 v[68:71], v28, s[56:59], s32 offen sc1
    buffer_load_dwordx4 v[72:75], v28, s[56:59], s33 offen sc1
    buffer_load_dwordx4 v[76:79], v28, s[56:59], s34 offen sc1
    s_waitcnt vmcnt(3)
    ds_bpermute_b32 v64, v30, v64
    ds_bpermute_b32 v65, v30, v65
    ds_bpermute_b32 v66, v30, v66
    ds_bpermute_b32 v67, v30, v67
    s_waitcnt vmcnt(2)
    ds_bpermute_b32 v68, v30, v68
    ds_bpermute_b32 v69, v30, v69
    ds_bpermute_b32 v70, v30, v70
    ds_bpermute_b32 v71, v30, v71
    s_waitcnt vmcnt(1)
    ds_bpermute_b32 v72, v30, v72
    ds_bpermute_b32 v73, v30, v73
    ds_bpermute_b32 v74, v30, v74
    ds_bpermute_b32 v75, v30, v75
    s_waitcnt vmcnt(0)
    ds_bpermute_b32 v76, v30, v76
    ds_bpermute_b32 v77, v30, v77
    ds_bpermute_b32 v78, v30, v78
    ds_bpermute_b32 v79, v30, v79
    s_waitcnt lgkmcnt(0)
    s_waitcnt vmcnt(0)
    v_lshlrev_b32 v160, 16, v64
    v_lshlrev_b32 v161, 16, v68
    v_lshlrev_b32 v162, 16, v72
    v_lshlrev_b32 v163, 16, v76
    v_mul_f32 v160, v160, v128
    v_mul_f32 v161, v161, v129
    v_mul_f32 v162, v162, v130
    v_mul_f32 v163, v163, v131
    s_mov_b32 s10, 0
    buffer_store_dwordx4 v[160:163], v29, s[64:67], s10 offen nt
    v_and_b32 v164, 0xffff0000, v64
    v_and_b32 v165, 0xffff0000, v68
    v_and_b32 v166, 0xffff0000, v72
    v_and_b32 v167, 0xffff0000, v76
    v_mul_f32 v164, v164, v132
    v_mul_f32 v165, v165, v133
    v_mul_f32 v166, v166, v134
    v_mul_f32 v167, v167, v135
    s_mov_b32 s10, 8192
    buffer_store_dwordx4 v[164:167], v29, s[64:67], s10 offen nt
    v_lshlrev_b32 v168, 16, v65
    v_lshlrev_b32 v169, 16, v69
    v_lshlrev_b32 v170, 16, v73
    v_lshlrev_b32 v171, 16, v77
    v_mul_f32 v168, v168, v136
    v_mul_f32 v169, v169, v137
    v_mul_f32 v170, v170, v138
    v_mul_f32 v171, v171, v139
    s_mov_b32 s10, 16384
    buffer_store_dwordx4 v[168:171], v29, s[64:67], s10 offen nt
    v_and_b32 v172, 0xffff0000, v65
    v_and_b32 v173, 0xffff0000, v69
    v_and_b32 v174, 0xffff0000, v73
    v_and_b32 v175, 0xffff0000, v77
    v_mul_f32 v172, v172, v140
    v_mul_f32 v173, v173, v141
    v_mul_f32 v174, v174, v142
    v_mul_f32 v175, v175, v143
    s_mov_b32 s10, 24576
    buffer_store_dwordx4 v[172:175], v29, s[64:67], s10 offen nt
    v_lshlrev_b32 v176, 16, v66
    v_lshlrev_b32 v177, 16, v70
    v_lshlrev_b32 v178, 16, v74
    v_lshlrev_b32 v179, 16, v78
    v_mul_f32 v176, v176, v144
    v_mul_f32 v177, v177, v145
    v_mul_f32 v178, v178, v146
    v_mul_f32 v179, v179, v147
    s_mov_b32 s10, 32768
    buffer_store_dwordx4 v[176:179], v29, s[64:67], s10 offen nt
    v_and_b32 v180, 0xffff0000, v66
    v_and_b32 v181, 0xffff0000, v70
    v_and_b32 v182, 0xffff0000, v74
    v_and_b32 v183, 0xffff0000, v78
    v_mul_f32 v180, v180, v148
    v_mul_f32 v181, v181, v149
    v_mul_f32 v182, v182, v150
    v_mul_f32 v183, v183, v151
    s_mov_b32 s10, 40960
    buffer_store_dwordx4 v[180:183], v29, s[64:67], s10 offen nt
    v_lshlrev_b32 v184, 16, v67
    v_lshlrev_b32 v185, 16, v71
    v_lshlrev_b32 v186, 16, v75
    v_lshlrev_b32 v187, 16, v79
    v_mul_f32 v184, v184, v152
    v_mul_f32 v185, v185, v153
    v_mul_f32 v186, v186, v154
    v_mul_f32 v187, v187, v155
    s_mov_b32 s10, 49152
    buffer_store_dwordx4 v[184:187], v29, s[64:67], s10 offen nt
    v_and_b32 v188, 0xffff0000, v67
    v_and_b32 v189, 0xffff0000, v71
    v_and_b32 v190, 0xffff0000, v75
    v_and_b32 v191, 0xffff0000, v79
    v_mul_f32 v188, v188, v156
    v_mul_f32 v189, v189, v157
    v_mul_f32 v190, v190, v158
    v_mul_f32 v191, v191, v159
    s_mov_b32 s10, 57344
    buffer_store_dwordx4 v[188:191], v29, s[64:67], s10 offen nt
    s_waitcnt vmcnt(0)
    s_endpgm
Y_G:
    s_setprio 0
    v_and_b32 v3, 31, v2
    v_mov_b32 v23, 0
    v_mov_b32 v11, 163712
    v_lshrrev_b32 v4, 5, v2
    s_lshr_b32 s8, s3, 1
    s_and_b32 s9, s3, 1
    s_lshl_b32 s10, s7, 6
    s_lshl_b32 s11, s9, 5
    s_add_u32 s10, s10, s11
    v_add_u32 v5, s10, v3
    v_lshlrev_b32 v48, 1, v5
    s_lshl_b32 s10, s7, 7
    v_and_b32 v49, 15, v2
    v_lshl_add_u32 v49, v49, 3, s10
    s_lshl_b32 s10, s3, 2
    s_add_u32 s10, s10, 163712
    v_mov_b32 v10, s10
    s_waitcnt lgkmcnt(0)
    s_mov_b32 s76, s48
    s_mov_b32 s77, s49
    s_mov_b32 s78, 256
    s_mov_b32 s79, 0x00020000
    s_or_b32 s10, s2, s3
    s_cmp_eq_u32 s10, 0
    s_cbranch_scc0 G_nononce
    s_memrealtime s[10:11]
    s_waitcnt lgkmcnt(0)
    s_or_b32 s10, s10, 1
    v_mov_b32 v54, s10
    v_mov_b32 v55, s11
    s_mov_b64 exec, 1
    buffer_store_dwordx2 v[54:55], v23, s[76:79], 0 offen sc1
    s_mov_b64 exec, -1
G_nononce:
    s_mov_b32 s52, s42
    s_mov_b32 s53, s43
    s_mov_b32 s54, 2048
    s_mov_b32 s55, 0x00020000
    buffer_load_ushort v12, v48, s[52:55], 0 offen
    s_mov_b32 s52, s30
    s_mov_b32 s53, s31
    buffer_load_ushort v13, v48, s[52:55], 0 offen
    s_mov_b32 s52, s32
    s_mov_b32 s53, s33
    buffer_load_ushort v14, v48, s[52:55], 0 offen
    s_mov_b32 s52, s44
    s_mov_b32 s53, s45
    buffer_load_dwordx2 v[24:25], v49, s[52:55], 0 offen
    s_mov_b32 s52, s28
    s_mov_b32 s53, s29
    s_mov_b32 s54, 4194304
    s_mov_b32 s55, 0x00020000
    s_mov_b32 s60, s46
    s_mov_b32 s61, s47
    s_mov_b32 s62, 16777216
    s_mov_b32 s63, 0x00020000
    s_add_u32 s64, s50, 16777216
    s_addc_u32 s65, s51, 0
    s_mov_b32 s66, 278528
    s_mov_b32 s67, 0x00020000
    s_add_u32 s68, s50, 8388608
    s_addc_u32 s69, s51, 0
    s_mov_b32 s70, 8388608
    s_mov_b32 s71, 0x00020000
    s_add_u32 s72, s50, 17825792
    s_addc_u32 s73, s51, 0
    s_mov_b32 s74, 65536
    s_mov_b32 s75, 0x00020000
    s_cmp_eq_u32 s9, 1
    s_cselect_b32 s80, s40, s38
    s_cselect_b32 s81, s41, s39
    s_mov_b32 s82, 2097152
    s_mov_b32 s83, 0x00020000
    s_lshl_b32 s10, s6, 7
    s_lshl_b32 s11, s3, 5
    s_add_u32 s10, s10, s11
    v_lshrrev_b32 v50, 4, v2
    v_lshl_add_u32 v50, v50, 2, s10
    v_lshl_add_u32 v22, v50, 11, v49
    v_xor_b32 v50, 1, v4
    v_lshlrev_b32 v50, 14, v50
    v_lshl_add_u32 v53, v5, 4, v50
    v_lshlrev_b32 v26, 4, v2
    v_add_u32 v27, 4096, v26
    v_lshrrev_b32 v50, 1, v3
    v_and_b32 v50, 7, v50
    v_xor_b32 v50, v50, v4
    v_lshlrev_b32 v50, 4, v50
    v_lshl_add_u32 v50, v3, 7, v50
    s_lshl_b32 s10, s8, 13
    s_lshl_b32 s11, s9, 13
    s_add_u32 s11, s11, 16384
    v_add_u32 v32, s10, v50
    v_add_u32 v36, s11, v50
    v_xor_b32 v33, 32, v32
    v_xor_b32 v37, 32, v36
    v_xor_b32 v34, 64, v32
    v_xor_b32 v38, 64, v36
    v_xor_b32 v35, 96, v32
    v_xor_b32 v39, 96, v36
    v_add_u32 v40, 65536, v32
    v_add_u32 v41, 65536, v33
    v_add_u32 v42, 65536, v34
    v_add_u32 v43, 65536, v35
    v_add_u32 v44, 65536, v36
    v_add_u32 v45, 65536, v37
    v_add_u32 v46, 65536, v38
    v_add_u32 v47, 65536, v39
    v_mov_b32 v64, 0
    v_mov_b32 v65, 0
    v_mov_b32 v66, 0
    v_mov_b32 v67, 0
    v_mov_b32 v68, 0
    v_mov_b32 v69, 0
    v_mov_b32 v70, 0
    v_mov_b32 v71, 0
    v_mov_b32 v72, 0
    v_mov_b32 v73, 0
    v_mov_b32 v74, 0
    v_mov_b32 v75, 0
    v_mov_b32 v76, 0
    v_mov_b32 v77, 0
    v_mov_b32 v78, 0
    v_mov_b32 v79, 0
    v_mov_b32 v80, 0
    v_mov_b32 v81, 0
    v_mov_b32 v82, 0
    v_mov_b32 v83, 0
    v_mov_b32 v84, 0
    v_mov_b32 v85, 0
    v_mov_b32 v86, 0
    v_mov_b32 v87, 0
    v_mov_b32 v88, 0
    v_mov_b32 v89, 0
    v_mov_b32 v90, 0
    v_mov_b32 v91, 0
    v_mov_b32 v92, 0
    v_mov_b32 v93, 0
    v_mov_b32 v94, 0
    v_mov_b32 v95, 0
    v_mov_b32 v96, 0
    v_mov_b32 v97, 0
    v_mov_b32 v98, 0
    v_mov_b32 v99, 0
    v_mov_b32 v100, 0
    v_mov_b32 v101, 0
    v_mov_b32 v102, 0
    v_mov_b32 v103, 0
    v_mov_b32 v104, 0
    v_mov_b32 v105, 0
    v_mov_b32 v106, 0
    v_mov_b32 v107, 0
    v_mov_b32 v108, 0
    v_mov_b32 v109, 0
    v_mov_b32 v110, 0
    v_mov_b32 v111, 0
    v_mov_b32 v112, 0
    v_mov_b32 v113, 0
    v_mov_b32 v114, 0
    v_mov_b32 v115, 0
    v_mov_b32 v116, 0
    v_mov_b32 v117, 0
    v_mov_b32 v118, 0
    v_mov_b32 v119, 0
    v_mov_b32 v120, 0
    v_mov_b32 v121, 0
    v_mov_b32 v122, 0
    v_mov_b32 v123, 0
    v_mov_b32 v124, 0
    v_mov_b32 v125, 0
    v_mov_b32 v126, 0
    v_mov_b32 v127, 0
    s_lshl_b32 s10, s8, 10
    s_lshl_b32 s11, s9, 9
    s_add_u32 s10, s10, s11
    s_add_u32 s10, s10, 151552
    v_lshl_add_u32 v0, v3, 4, s10
    v_xor_b32 v1, 1024, v0
    s_lshl_b32 s10, s8, 1
    s_sub_i32 s10, s6, s10
    v_sub_u32 v56, s10, v4
    v_add_u32 v57, 0, v56
    v_max_i32 v57, 0, v57
    v_lshlrev_b32 v57, 14, v57
    v_lshl_add_u32 v60, v5, 4, v57
    v_add_u32 v57, -4, v56
    v_max_i32 v57, 0, v57
    v_lshlrev_b32 v57, 14, v57
    v_lshl_add_u32 v61, v5, 4, v57
    v_add_u32 v57, -8, v56
    v_max_i32 v57, 0, v57
    v_lshlrev_b32 v57, 14, v57
    v_lshl_add_u32 v62, v5, 4, v57
    v_add_u32 v57, -12, v56
    v_max_i32 v57, 0, v57
    v_lshlrev_b32 v57, 14, v57
    v_lshl_add_u32 v63, v5, 4, v57
    s_mov_b32 s15, 0
G_s0_w:
    ds_read_b64 v[48:49], v11 offset:16
    s_waitcnt lgkmcnt(0)
    v_min_u32 v48, v48, v49
    v_cmp_gt_u32 vcc, 1, v48
    s_cbranch_vccz G_s0_ok
    s_add_u32 s15, s15, 1
    s_cmp_lt_u32 s15, 160000
    s_cbranch_scc1 G_s0_w
G_s0_ok:
    ds_read_b128 v[128:131], v32 offset:0
    ds_read_b128 v[136:139], v36 offset:0
    ds_read_b128 v[140:143], v36 offset:4096
    ds_read_b128 v[132:135], v32 offset:4096
    ds_read_b128 v[144:147], v33 offset:0
    ds_read_b128 v[152:155], v37 offset:0
    ds_read_b128 v[156:159], v37 offset:4096
    ds_read_b128 v[148:151], v33 offset:4096
    ds_read_b128 v[160:163], v34 offset:0
    ds_read_b128 v[168:171], v38 offset:0
    ds_read_b128 v[172:175], v38 offset:4096
    ds_read_b128 v[164:167], v34 offset:4096
    ds_read_b128 v[176:179], v35 offset:0
    ds_read_b128 v[184:187], v39 offset:0
    ds_read_b128 v[188:191], v39 offset:4096
    ds_read_b128 v[180:183], v35 offset:4096
    ds_read_b64 v[48:49], v11 offset:16
    v_mov_b32 v52, 1
    s_mov_b32 s12, 2
    s_waitcnt lgkmcnt(0)
    ds_write_b32 v10, v52
G1_loop:
    v_mfma_f32_32x32x16_bf16 v[64:79], v[128:131], v[136:139], v[64:79]
    s_waitcnt lgkmcnt(0)
    v_min_u32 v48, v48, v49
    v_cmp_gt_u32 vcc, s12, v48
    s_cbranch_vccnz G1_slow0
G1_back0:
    ds_read_b128 v[192:195], v32 offset:32768
    ds_read_b128 v[200:203], v36 offset:32768
    v_mfma_f32_32x32x16_bf16 v[80:95], v[128:131], v[140:143], v[80:95]
    ds_read_b128 v[204:207], v36 offset:36864
    ds_read_b128 v[196:199], v32 offset:36864
    v_mfma_f32_32x32x16_bf16 v[96:111], v[132:135], v[136:139], v[96:111]
    ds_read_b128 v[208:211], v33 offset:32768
    ds_read_b128 v[216:219], v37 offset:32768
    v_mfma_f32_32x32x16_bf16 v[112:127], v[132:135], v[140:143], v[112:127]
    ds_read_b128 v[220:223], v37 offset:36864
    ds_read_b128 v[212:215], v33 offset:36864
    v_mfma_f32_32x32x16_bf16 v[64:79], v[144:147], v[152:155], v[64:79]
    ds_read_b128 v[224:227], v34 offset:32768
    ds_read_b128 v[232:235], v38 offset:32768
    v_mfma_f32_32x32x16_bf16 v[80:95], v[144:147], v[156:159], v[80:95]
    ds_read_b128 v[236:239], v38 offset:36864
    ds_read_b128 v[228:231], v34 offset:36864
    v_mfma_f32_32x32x16_bf16 v[96:111], v[148:151], v[152:155], v[96:111]
    ds_read_b128 v[240:243], v35 offset:32768
    ds_read_b128 v[248:251], v39 offset:32768
    v_mfma_f32_32x32x16_bf16 v[112:127], v[148:151], v[156:159], v[112:127]
    ds_read_b128 v[252:255], v39 offset:36864
    ds_read_b128 v[244:247], v35 offset:36864
    v_mfma_f32_32x32x16_bf16 v[64:79], v[160:163], v[168:171], v[64:79]
    v_mfma_f32_32x32x16_bf16 v[80:95], v[160:163], v[172:175], v[80:95]
    v_mfma_f32_32x32x16_bf16 v[96:111], v[164:167], v[168:171], v[96:111]
    v_mfma_f32_32x32x16_bf16 v[112:127], v[164:167], v[172:175], v[112:127]
    v_mfma_f32_32x32x16_bf16 v[64:79], v[176:179], v[184:187], v[64:79]
    v_mov_b32 v52, s12
    s_waitcnt lgkmcnt(0)
    ds_write_b32 v10, v52
    s_add_u32 s12, s12, 1
    v_mfma_f32_32x32x16_bf16 v[80:95], v[176:179], v[188:191], v[80:95]
    ds_read_b64 v[48:49], v11 offset:16
    v_mfma_f32_32x32x16_bf16 v[96:111], v[180:183], v[184:187], v[96:111]
    v_mfma_f32_32x32x16_bf16 v[112:127], v[180:183], v[188:191], v[112:127]
    v_mfma_f32_32x32x16_bf16 v[64:79], v[192:195], v[200:203], v[64:79]
    s_waitcnt lgkmcnt(0)
    v_min_u32 v48, v48, v49
    v_cmp_gt_u32 vcc, s12, v48
    s_cbranch_vccnz G1_slow1
G1_back1:
    ds_read_b128 v[128:131], v40 offset:0
    ds_read_b128 v[136:139], v44 offset:0
    v_mfma_f32_32x32x16_bf16 v[80:95], v[192:195], v[204:207], v[80:95]
    ds_read_b128 v[140:143], v44 offset:4096
    ds_read_b128 v[132:135], v40 offset:4096
    v_mfma_f32_32x32x16_bf16 v[96:111], v[196:199], v[200:203], v[96:111]
    ds_read_b128 v[144:147], v41 offset:0
    ds_read_b128 v[152:155], v45 offset:0
    v_mfma_f32_32x32x16_bf16 v[112:127], v[196:199], v[204:207], v[112:127]
    ds_read_b128 v[156:159], v45 offset:4096
    ds_read_b128 v[148:151], v41 offset:4096
    v_mfma_f32_32x32x16_bf16 v[64:79], v[208:211], v[216:219], v[64:79]
    ds_read_b128 v[160:163], v42 offset:0
    ds_read_b128 v[168:171], v46 offset:0
    v_mfma_f32_32x32x16_bf16 v[80:95], v[208:211], v[220:223], v[80:95]
    ds_read_b128 v[172:175], v46 offset:4096
    ds_read_b128 v[164:167], v42 offset:4096
    v_mfma_f32_32x32x16_bf16 v[96:111], v[212:215], v[216:219], v[96:111]
    ds_read_b128 v[176:179], v43 offset:0
    ds_read_b128 v[184:187], v47 offset:0
    v_mfma_f32_32x32x16_bf16 v[112:127], v[212:215], v[220:223], v[112:127]
    ds_read_b128 v[188:191], v47 offset:4096
    ds_read_b128 v[180:183], v43 offset:4096
    v_mfma_f32_32x32x16_bf16 v[64:79], v[224:227], v[232:235], v[64:79]
    v_mfma_f32_32x32x16_bf16 v[80:95], v[224:227], v[236:239], v[80:95]
    v_mfma_f32_32x32x16_bf16 v[96:111], v[228:231], v[232:235], v[96:111]
    v_mfma_f32_32x32x16_bf16 v[112:127], v[228:231], v[236:239], v[112:127]
    v_mfma_f32_32x32x16_bf16 v[64:79], v[240:243], v[248:251], v[64:79]
    v_mov_b32 v52, s12
    s_waitcnt lgkmcnt(0)
    ds_write_b32 v10, v52
    s_add_u32 s12, s12, 1
    v_mfma_f32_32x32x16_bf16 v[80:95], v[240:243], v[252:255], v[80:95]
    ds_read_b64 v[48:49], v11 offset:16
    v_mfma_f32_32x32x16_bf16 v[96:111], v[244:247], v[248:251], v[96:111]
    v_mfma_f32_32x32x16_bf16 v[112:127], v[244:247], v[252:255], v[112:127]
    v_mfma_f32_32x32x16_bf16 v[64:79], v[128:131], v[136:139], v[64:79]
    s_waitcnt lgkmcnt(0)
    v_min_u32 v48, v48, v49
    v_cmp_gt_u32 vcc, s12, v48
    s_cbranch_vccnz G1_slow2
G1_back2:
    ds_read_b128 v[192:195], v40 offset:32768
    ds_read_b128 v[200:203], v44 offset:32768
    v_mfma_f32_32x32x16_bf16 v[80:95], v[128:131], v[140:143], v[80:95]
    ds_read_b128 v[204:207], v44 offset:36864
    ds_read_b128 v[196:199], v40 offset:36864
    v_mfma_f32_32x32x16_bf16 v[96:111], v[132:135], v[136:139], v[96:111]
    ds_read_b128 v[208:211], v41 offset:32768
    ds_read_b128 v[216:219], v45 offset:32768
    v_mfma_f32_32x32x16_bf16 v[112:127], v[132:135], v[140:143], v[112:127]
    ds_read_b128 v[220:223], v45 offset:36864
    ds_read_b128 v[212:215], v41 offset:36864
    v_mfma_f32_32x32x16_bf16 v[64:79], v[144:147], v[152:155], v[64:79]
    ds_read_b128 v[224:227], v42 offset:32768
    ds_read_b128 v[232:235], v46 offset:32768
    v_mfma_f32_32x32x16_bf16 v[80:95], v[144:147], v[156:159], v[80:95]
    ds_read_b128 v[236:239], v46 offset:36864
    ds_read_b128 v[228:231], v42 offset:36864
    v_mfma_f32_32x32x16_bf16 v[96:111], v[148:151], v[152:155], v[96:111]
    ds_read_b128 v[240:243], v43 offset:32768
    ds_read_b128 v[248:251], v47 offset:32768
    v_mfma_f32_32x32x16_bf16 v[112:127], v[148:151], v[156:159], v[112:127]
    ds_read_b128 v[252:255], v47 offset:36864
    ds_read_b128 v[244:247], v43 offset:36864
    v_mfma_f32_32x32x16_bf16 v[64:79], v[160:163], v[168:171], v[64:79]
    v_mfma_f32_32x32x16_bf16 v[80:95], v[160:163], v[172:175], v[80:95]
    v_mfma_f32_32x32x16_bf16 v[96:111], v[164:167], v[168:171], v[96:111]
    v_mfma_f32_32x32x16_bf16 v[112:127], v[164:167], v[172:175], v[112:127]
    v_mfma_f32_32x32x16_bf16 v[64:79], v[176:179], v[184:187], v[64:79]
    v_mov_b32 v52, s12
    s_waitcnt lgkmcnt(0)
    ds_write_b32 v10, v52
    s_add_u32 s12, s12, 1
    v_mfma_f32_32x32x16_bf16 v[80:95], v[176:179], v[188:191], v[80:95]
    ds_read_b64 v[48:49], v11 offset:16
    v_mfma_f32_32x32x16_bf16 v[96:111], v[180:183], v[184:187], v[96:111]
    v_mfma_f32_32x32x16_bf16 v[112:127], v[180:183], v[188:191], v[112:127]
    s_cmp_eq_u32 s12, 17
    s_cbranch_scc1 G1_last
    v_mfma_f32_32x32x16_bf16 v[64:79], v[192:195], v[200:203], v[64:79]
    s_waitcnt lgkmcnt(0)
    v_min_u32 v48, v48, v49
    v_cmp_gt_u32 vcc, s12, v48
    s_cbranch_vccnz G1_slow3
G1_back3:
    ds_read_b128 v[128:131], v32 offset:0
    ds_read_b128 v[136:139], v36 offset:0
    v_mfma_f32_32x32x16_bf16 v[80:95], v[192:195], v[204:207], v[80:95]
    ds_read_b128 v[140:143], v36 offset:4096
    ds_read_b128 v[132:135], v32 offset:4096
    v_mfma_f32_32x32x16_bf16 v[96:111], v[196:199], v[200:203], v[96:111]
    ds_read_b128 v[144:147], v33 offset:0
    ds_read_b128 v[152:155], v37 offset:0
    v_mfma_f32_32x32x16_bf16 v[112:127], v[196:199], v[204:207], v[112:127]
    ds_read_b128 v[156:159], v37 offset:4096
    ds_read_b128 v[148:151], v33 offset:4096
    v_mfma_f32_32x32x16_bf16 v[64:79], v[208:211], v[216:219], v[64:79]
    ds_read_b128 v[160:163], v34 offset:0
    ds_read_b128 v[168:171], v38 offset:0
    v_mfma_f32_32x32x16_bf16 v[80:95], v[208:211], v[220:223], v[80:95]
    ds_read_b128 v[172:175], v38 offset:4096
    ds_read_b128 v[164:167], v34 offset:4096
    v_mfma_f32_32x32x16_bf16 v[96:111], v[212:215], v[216:219], v[96:111]
    ds_read_b128 v[176:179], v35 offset:0
    ds_read_b128 v[184:187], v39 offset:0
    v_mfma_f32_32x32x16_bf16 v[112:127], v[212:215], v[220:223], v[112:127]
    ds_read_b128 v[188:191], v39 offset:4096
    ds_read_b128 v[180:183], v35 offset:4096
    v_mfma_f32_32x32x16_bf16 v[64:79], v[224:227], v[232:235], v[64:79]
    v_mfma_f32_32x32x16_bf16 v[80:95], v[224:227], v[236:239], v[80:95]
    v_mfma_f32_32x32x16_bf16 v[96:111], v[228:231], v[232:235], v[96:111]
    v_mfma_f32_32x32x16_bf16 v[112:127], v[228:231], v[236:239], v[112:127]
    v_mfma_f32_32x32x16_bf16 v[64:79], v[240:243], v[248:251], v[64:79]
    v_mov_b32 v52, s12
    s_waitcnt lgkmcnt(0)
    ds_write_b32 v10, v52
    s_add_u32 s12, s12, 1
    v_mfma_f32_32x32x16_bf16 v[80:95], v[240:243], v[252:255], v[80:95]
    ds_read_b64 v[48:49], v11 offset:16
    v_mfma_f32_32x32x16_bf16 v[96:111], v[244:247], v[248:251], v[96:111]
    v_mfma_f32_32x32x16_bf16 v[112:127], v[244:247], v[252:255], v[112:127]
    s_branch G1_loop
G1_slow0:
    s_mov_b32 s15, 0
G1_sl0_w:
    ds_read_b64 v[48:49], v11 offset:16
    s_waitcnt lgkmcnt(0)
    v_min_u32 v48, v48, v49
    v_cmp_gt_u32 vcc, s12, v48
    s_cbranch_vccz G1_sl0_ok
    s_add_u32 s15, s15, 1
    s_cmp_lt_u32 s15, 160000
    s_cbranch_scc1 G1_sl0_w
G1_sl0_ok:
    s_branch G1_back0
G1_slow1:
    s_mov_b32 s15, 0
G1_sl1_w:
    ds_read_b64 v[48:49], v11 offset:16
    s_waitcnt lgkmcnt(0)
    v_min_u32 v48, v48, v49
    v_cmp_gt_u32 vcc, s12, v48
    s_cbranch_vccz G1_sl1_ok
    s_add_u32 s15, s15, 1
    s_cmp_lt_u32 s15, 160000
    s_cbranch_scc1 G1_sl1_w
G1_sl1_ok:
    s_branch G1_back1
G1_slow2:
    s_mov_b32 s15, 0
G1_sl2_w:
    ds_read_b64 v[48:49], v11 offset:16
    s_waitcnt lgkmcnt(0)
    v_min_u32 v48, v48, v49
    v_cmp_gt_u32 vcc, s12, v48
    s_cbranch_vccz G1_sl2_ok
    s_add_u32 s15, s15, 1
    s_cmp_lt_u32 s15, 160000
    s_cbranch_scc1 G1_sl2_w
G1_sl2_ok:
    s_branch G1_back2
G1_slow3:
    s_mov_b32 s15, 0
G1_sl3_w:
    ds_read_b64 v[48:49], v11 offset:16
    s_waitcnt lgkmcnt(0)
    v_min_u32 v48, v48, v49
    v_cmp_gt_u32 vcc, s12, v48
    s_cbranch_vccz G1_sl3_ok
    s_add_u32 s15, s15, 1
    s_cmp_lt_u32 s15, 160000
    s_cbranch_scc1 G1_sl3_w
G1_sl3_ok:
    s_branch G1_back3
G1_last:
    v_mfma_f32_32x32x16_bf16 v[64:79], v[192:195], v[200:203], v[64:79]
    s_setprio 3
    s_waitcnt vmcnt(0)
    ds_read_b64 v[30:31], v11 offset:32
    v_lshlrev_b32 v133, 16, v12
    v_lshlrev_b32 v134, 16, v13
    v_lshlrev_b32 v135, 16, v14
    v_mul_f32 v133, 0x3fb8aa3b, v133
    v_mfma_f32_32x32x16_bf16 v[80:95], v[192:195], v[204:207], v[80:95]
    v_exp_f32 v133, v133
    v_mul_f32 v140, v134, v134
    v_cvt_pk_bf16_f32 v133, v133, v133
    v_fmac_f32 v140, v135, v135
    v_mfma_f32_32x32x16_bf16 v[96:111], v[196:199], v[200:203], v[96:111]
    v_lshlrev_b32 v133, 16, v133
    v_rcp_f32 v140, v140
    v_mul_f32 v136, v133, v134
    v_mul_f32 v137, v133, v135
    v_mfma_f32_32x32x16_bf16 v[112:127], v[196:199], v[204:207], v[112:127]
    v_mul_f32 v136, 0x3fb8aa3b, v136
    v_exp_f32 v136, v136
    v_mul_f32 v137, 0.15915494, v137
    v_cos_f32 v138, v137
    v_mfma_f32_32x32x16_bf16 v[64:79], v[208:211], v[216:219], v[64:79]
    v_sin_f32 v139, v137
    v_add_f32 v140, v140, v140
    v_mul_f32 v6, v136, v138
    v_mul_f32 v7, v136, v139
    v_mfma_f32_32x32x16_bf16 v[80:95], v[208:211], v[220:223], v[80:95]
    v_mul_f32 v128, v6, v6
    v_mul_f32 v129, v6, v7
    v_fma_f32 v128, -v7, v7, v128
    v_fmac_f32 v129, v7, v6
    v_mfma_f32_32x32x16_bf16 v[96:111], v[212:215], v[216:219], v[96:111]
    v_mul_f32 v130, v128, v128
    v_mul_f32 v131, v128, v129
    v_fma_f32 v130, -v129, v129, v130
    v_fmac_f32 v131, v129, v128
    v_mfma_f32_32x32x16_bf16 v[112:127], v[212:215], v[220:223], v[112:127]
    v_mul_f32 v12, v130, v130
    v_mul_f32 v13, v130, v131
    v_fma_f32 v12, -v131, v131, v12
    v_fmac_f32 v13, v131, v130
    v_mfma_f32_32x32x16_bf16 v[64:79], v[224:227], v[232:235], v[64:79]
    v_mul_f32 v14, v12, v12
    v_mul_f32 v15, v12, v13
    v_fma_f32 v14, -v13, v13, v14
    v_fmac_f32 v15, v13, v12
    v_mfma_f32_32x32x16_bf16 v[80:95], v[224:227], v[236:239], v[80:95]
    v_mul_f32 v16, v14, v14
    v_mul_f32 v17, v14, v15
    v_fma_f32 v16, -v15, v15, v16
    v_fmac_f32 v17, v15, v14
    v_mfma_f32_32x32x16_bf16 v[96:111], v[228:231], v[232:235], v[96:111]
    v_add_f32 v136, -1.0, v6
    v_mul_f32 v138, v136, v134
    v_fmac_f32 v138, v7, v135
    v_mul_f32 v139, v7, v134
    v_mfma_f32_32x32x16_bf16 v[112:127], v[228:231], v[236:239], v[112:127]
    v_fma_f32 v139, -v136, v135, v139
    v_mul_f32 v8, v138, v140
    v_mul_f32 v9, v139, v140
    v_mul_f32 v18, v16, v16
    v_mfma_f32_32x32x16_bf16 v[64:79], v[240:243], v[248:251], v[64:79]
    v_mul_f32 v19, v16, v17
    v_fma_f32 v18, -v17, v17, v18
    v_fmac_f32 v19, v17, v16
    v_mul_f32 v20, v18, v18
    v_mfma_f32_32x32x16_bf16 v[80:95], v[240:243], v[252:255], v[80:95]
    v_mul_f32 v21, v18, v19
    v_fma_f32 v20, -v19, v19, v20
    v_fmac_f32 v21, v19, v18
    v_mfma_f32_32x32x16_bf16 v[96:111], v[244:247], v[248:251], v[96:111]
    v_mfma_f32_32x32x16_bf16 v[112:127], v[244:247], v[252:255], v[112:127]
    s_nop 1
    v_fma_f32 v40, v6, v64, v66
    v_fma_f32 v41, v6, v65, v67
    s_nop 2
    v_fma_f32 v42, v6, v80, v82
    v_fma_f32 v43, v6, v81, v83
    s_nop 1
    v_fma_f32 v44, v6, v96, v98
    v_fma_f32 v45, v6, v97, v99
    v_fma_f32 v46, v6, v112, v114
    v_fma_f32 v47, v6, v113, v115
    v_fma_f32 v40, -v7, v80, v40
    v_fma_f32 v41, -v7, v81, v41
    v_fmac_f32 v42, v7, v64
    v_fmac_f32 v43, v7, v65
    v_fma_f32 v44, -v7, v112, v44
    v_fma_f32 v45, -v7, v113, v45
    v_fmac_f32 v46, v7, v96
    v_fmac_f32 v47, v7, v97
    v_fma_f32 v32, v6, v40, v68
    v_fma_f32 v33, v6, v41, v69
    v_fma_f32 v34, v6, v42, v84
    v_fma_f32 v35, v6, v43, v85
    v_fma_f32 v36, v6, v44, v100
    v_fma_f32 v37, v6, v45, v101
    v_fma_f32 v38, v6, v46, v116
    v_fma_f32 v39, v6, v47, v117
    v_fma_f32 v32, -v7, v42, v32
    v_fma_f32 v33, -v7, v43, v33
    v_fmac_f32 v34, v7, v40
    v_fmac_f32 v35, v7, v41
    v_fma_f32 v36, -v7, v46, v36
    v_fma_f32 v37, -v7, v47, v37
    v_fmac_f32 v38, v7, v44
    v_fmac_f32 v39, v7, v45
    v_fma_f32 v40, v6, v32, v70
    v_fma_f32 v41, v6, v33, v71
    v_fma_f32 v42, v6, v34, v86
    v_fma_f32 v43, v6, v35, v87
    v_fma_f32 v44, v6, v36, v102
    v_fma_f32 v45, v6, v37, v103
    v_fma_f32 v46, v6, v38, v118
    v_fma_f32 v47, v6, v39, v119
    v_fma_f32 v40, -v7, v34, v40
    v_fma_f32 v41, -v7, v35, v41
    v_fmac_f32 v42, v7, v32
    v_fmac_f32 v43, v7, v33
    v_fma_f32 v44, -v7, v38, v44
    v_fma_f32 v45, -v7, v39, v45
    v_fmac_f32 v46, v7, v36
    v_fmac_f32 v47, v7, v37
    v_fma_f32 v32, v6, v40, v72
    v_fma_f32 v33, v6, v41, v73
    v_fma_f32 v34, v6, v42, v88
    v_fma_f32 v35, v6, v43, v89
    v_fma_f32 v36, v6, v44, v104
    v_fma_f32 v37, v6, v45, v105
    v_fma_f32 v38, v6, v46, v120
    v_fma_f32 v39, v6, v47, v121
    v_fma_f32 v32, -v7, v42, v32
    v_fma_f32 v33, -v7, v43, v33
    v_fmac_f32 v34, v7, v40
    v_fmac_f32 v35, v7, v41
    v_fma_f32 v36, -v7, v46, v36
    v_fma_f32 v37, -v7, v47, v37
    v_fmac_f32 v38, v7, v44
    v_fmac_f32 v39, v7, v45
    v_fma_f32 v40, v6, v32, v74
    v_fma_f32 v41, v6, v33, v75
    v_fma_f32 v42, v6, v34, v90
    v_fma_f32 v43, v6, v35, v91
    v_fma_f32 v44, v6, v36, v106
    v_fma_f32 v45, v6, v37, v107
    v_fma_f32 v46, v6, v38, v122
    v_fma_f32 v47, v6, v39, v123
    v_fma_f32 v40, -v7, v34, v40
    v_fma_f32 v41, -v7, v35, v41
    v_fmac_f32 v42, v7, v32
    v_fmac_f32 v43, v7, v33
    v_fma_f32 v44, -v7, v38, v44
    v_fma_f32 v45, -v7, v39, v45
    v_fmac_f32 v46, v7, v36
    v_fmac_f32 v47, v7, v37
    v_fma_f32 v32, v6, v40, v76
    v_fma_f32 v33, v6, v41, v77
    v_fma_f32 v34, v6, v42, v92
    v_fma_f32 v35, v6, v43, v93
    v_fma_f32 v36, v6, v44, v108
    v_fma_f32 v37, v6, v45, v109
    v_fma_f32 v38, v6, v46, v124
    v_fma_f32 v39, v6, v47, v125
    v_fma_f32 v32, -v7, v42, v32
    v_fma_f32 v33, -v7, v43, v33
    v_fmac_f32 v34, v7, v40
    v_fmac_f32 v35, v7, v41
    v_fma_f32 v36, -v7, v46, v36
    v_fma_f32 v37, -v7, v47, v37
    v_fmac_f32 v38, v7, v44
    v_fmac_f32 v39, v7, v45
    v_fma_f32 v40, v6, v32, v78
    v_fma_f32 v41, v6, v33, v79
    v_fma_f32 v42, v6, v34, v94
    v_fma_f32 v43, v6, v35, v95
    v_fma_f32 v44, v6, v36, v110
    v_fma_f32 v45, v6, v37, v111
    v_fma_f32 v46, v6, v38, v126
    v_fma_f32 v47, v6, v39, v127
    v_fma_f32 v40, -v7, v34, v40
    v_fma_f32 v41, -v7, v35, v41
    v_fmac_f32 v42, v7, v32
    v_fmac_f32 v43, v7, v33
    v_fma_f32 v44, -v7, v38, v44
    v_fma_f32 v45, -v7, v39, v45
    v_fmac_f32 v46, v7, v36
    v_fmac_f32 v47, v7, v37
    v_fmac_f32 v44, v12, v40
    v_fmac_f32 v45, v12, v41
    v_fmac_f32 v46, v12, v42
    v_fmac_f32 v47, v12, v43
    v_fma_f32 v44, -v13, v42, v44
    v_fma_f32 v45, -v13, v43, v45
    v_fmac_f32 v46, v13, v40
    v_fmac_f32 v47, v13, v41
    v_fma_f32 v32, v14, v44, v45
    v_fma_f32 v34, v14, v46, v47
    v_fma_f32 v32, -v15, v46, v32
    v_fmac_f32 v34, v15, v44
    v_mov_b32 v33, v32
    v_mov_b32 v35, v34
    s_lshl_b32 s12, s6, 1
    s_add_u32 s12, s12, s8
    v_permlane32_swap_b32 v32, v33
    v_permlane32_swap_b32 v34, v35
    v_fma_f32 v28, v16, v32, v33
    v_fma_f32 v29, v16, v34, v35
    v_fma_f32 v28, -v17, v34, v28
    v_fmac_f32 v29, v17, v32
    s_waitcnt lgkmcnt(0)
    s_mov_b32 s15, 0
G_nw:
    v_cmp_eq_u32 vcc, 0, v30
    s_cbranch_vccz G_nok
    ds_read_b64 v[30:31], v11 offset:32
    s_add_u32 s15, s15, 1
    s_waitcnt lgkmcnt(0)
    s_cmp_lt_u32 s15, 160000
    s_cbranch_scc1 G_nw
G_nok:
    s_cmp_eq_u32 s8, 0
    s_cbranch_scc0 G_pw1
    ds_write_b128 v0, v[28:31] offset:2048
    s_branch G_pub1
G_pw1:
    s_mov_b32 s15, 0
G_x1:
    ds_read_b128 v[56:59], v1 offset:2048
    s_add_u32 s15, s15, 1
    s_waitcnt lgkmcnt(0)
    v_cmp_ne_u64 vcc, v[58:59], v[30:31]
    s_cbranch_vccz G_x1_ok
    s_cmp_lt_u32 s15, 160000
    s_cbranch_scc1 G_x1
G_x1_ok:
    v_fmac_f32 v28, v18, v56
    v_fmac_f32 v29, v18, v57
    s_lshl_b32 s13, s6, 14
    v_fma_f32 v28, -v19, v57, v28
    v_fmac_f32 v29, v19, v56
    s_mov_b32 exec_hi, 0
    buffer_store_dwordx4 v[28:31], v53, s[64:67], s13 offen sc1
    s_cmp_eq_u32 s6, 0
    s_cbranch_scc0 G_pub1
    s_not_b64 exec, exec
    v_mov_b32 v28, 0
    v_mov_b32 v29, 0
    buffer_store_dwordx4 v[28:31], v53, s[64:67], 0 offen sc1
G_pub1:
    s_mov_b64 exec, -1
    v_mul_f32 v128, v8, v64
    v_mul_f32 v129, v8, v65
    v_mul_f32 v144, -v8, v80
    v_mul_f32 v145, -v8, v81
    v_mul_f32 v160, v8, v96
    v_mul_f32 v161, v8, v97
    v_mul_f32 v176, -v8, v112
    v_mul_f32 v177, -v8, v113
    v_fma_f32 v128, -v9, v80, v128
    v_fma_f32 v129, -v9, v81, v129
    v_fma_f32 v144, -v9, v64, v144
    v_fma_f32 v145, -v9, v65, v145
    v_fma_f32 v160, -v9, v112, v160
    v_fma_f32 v161, -v9, v113, v161
    v_fma_f32 v176, -v9, v96, v176
    v_fma_f32 v177, -v9, v97, v177
    v_mul_f32 v130, v8, v66
    v_mul_f32 v131, v8, v67
    v_mul_f32 v146, -v8, v82
    v_mul_f32 v147, -v8, v83
    v_mul_f32 v162, v8, v98
    v_mul_f32 v163, v8, v99
    v_mul_f32 v178, -v8, v114
    v_mul_f32 v179, -v8, v115
    v_fma_f32 v130, -v9, v82, v130
    v_fma_f32 v131, -v9, v83, v131
    v_fma_f32 v146, -v9, v66, v146
    v_fma_f32 v147, -v9, v67, v147
    v_fma_f32 v162, -v9, v114, v162
    v_fma_f32 v163, -v9, v115, v163
    v_fma_f32 v178, -v9, v98, v178
    v_fma_f32 v179, -v9, v99, v179
    v_mul_f32 v132, v8, v68
    v_mul_f32 v133, v8, v69
    v_mul_f32 v148, -v8, v84
    v_mul_f32 v149, -v8, v85
    v_mul_f32 v164, v8, v100
    v_mul_f32 v165, v8, v101
    v_mul_f32 v180, -v8, v116
    v_mul_f32 v181, -v8, v117
    v_fma_f32 v132, -v9, v84, v132
    v_fma_f32 v133, -v9, v85, v133
    v_fma_f32 v148, -v9, v68, v148
    v_fma_f32 v149, -v9, v69, v149
    v_fma_f32 v164, -v9, v116, v164
    v_fma_f32 v165, -v9, v117, v165
    v_fma_f32 v180, -v9, v100, v180
    v_fma_f32 v181, -v9, v101, v181
    v_mul_f32 v134, v8, v70
    v_mul_f32 v135, v8, v71
    v_mul_f32 v150, -v8, v86
    v_mul_f32 v151, -v8, v87
    v_mul_f32 v166, v8, v102
    v_mul_f32 v167, v8, v103
    v_mul_f32 v182, -v8, v118
    v_mul_f32 v183, -v8, v119
    v_fma_f32 v134, -v9, v86, v134
    v_fma_f32 v135, -v9, v87, v135
    v_fma_f32 v150, -v9, v70, v150
    v_fma_f32 v151, -v9, v71, v151
    v_fma_f32 v166, -v9, v118, v166
    v_fma_f32 v167, -v9, v119, v167
    v_fma_f32 v182, -v9, v102, v182
    v_fma_f32 v183, -v9, v103, v183
    v_mul_f32 v136, v8, v72
    v_mul_f32 v137, v8, v73
    v_mul_f32 v152, -v8, v88
    v_mul_f32 v153, -v8, v89
    v_mul_f32 v168, v8, v104
    v_mul_f32 v169, v8, v105
    v_mul_f32 v184, -v8, v120
    v_mul_f32 v185, -v8, v121
    v_fma_f32 v136, -v9, v88, v136
    v_fma_f32 v137, -v9, v89, v137
    v_fma_f32 v152, -v9, v72, v152
    v_fma_f32 v153, -v9, v73, v153
    v_fma_f32 v168, -v9, v120, v168
    v_fma_f32 v169, -v9, v121, v169
    v_fma_f32 v184, -v9, v104, v184
    v_fma_f32 v185, -v9, v105, v185
    v_mul_f32 v138, v8, v74
    v_mul_f32 v139, v8, v75
    v_mul_f32 v154, -v8, v90
    v_mul_f32 v155, -v8, v91
    v_mul_f32 v170, v8, v106
    v_mul_f32 v171, v8, v107
    v_mul_f32 v186, -v8, v122
    v_mul_f32 v187, -v8, v123
    v_fma_f32 v138, -v9, v90, v138
    v_fma_f32 v139, -v9, v91, v139
    v_fma_f32 v154, -v9, v74, v154
    v_fma_f32 v155, -v9, v75, v155
    v_fma_f32 v170, -v9, v122, v170
    v_fma_f32 v171, -v9, v123, v171
    v_fma_f32 v186, -v9, v106, v186
    v_fma_f32 v187, -v9, v107, v187
    v_mul_f32 v140, v8, v76
    v_mul_f32 v141, v8, v77
    v_mul_f32 v156, -v8, v92
    v_mul_f32 v157, -v8, v93
    v_mul_f32 v172, v8, v108
    v_mul_f32 v173, v8, v109
    v_mul_f32 v188, -v8, v124
    v_mul_f32 v189, -v8, v125
    v_fma_f32 v140, -v9, v92, v140
    v_fma_f32 v141, -v9, v93, v141
    v_fma_f32 v156, -v9, v76, v156
    v_fma_f32 v157, -v9, v77, v157
    v_fma_f32 v172, -v9, v124, v172
    v_fma_f32 v173, -v9, v125, v173
    v_fma_f32 v188, -v9, v108, v188
    v_fma_f32 v189, -v9, v109, v189
    v_mul_f32 v142, v8, v78
    v_mul_f32 v143, v8, v79
    v_mul_f32 v158, -v8, v94
    v_mul_f32 v159, -v8, v95
    v_mul_f32 v174, v8, v110
    v_mul_f32 v175, v8, v111
    v_mul_f32 v190, -v8, v126
    v_mul_f32 v191, -v8, v127
    v_fma_f32 v142, -v9, v94, v142
    v_fma_f32 v143, -v9, v95, v143
    v_fma_f32 v158, -v9, v78, v158
    v_fma_f32 v159, -v9, v79, v159
    v_fma_f32 v174, -v9, v126, v174
    v_fma_f32 v175, -v9, v127, v175
    v_fma_f32 v190, -v9, v110, v190
    v_fma_f32 v191, -v9, v111, v191
    s_mov_b32 s13, 0
    buffer_load_dwordx2 v[80:81], v22, s[52:55], s13 offen offset:0
    buffer_load_dwordx2 v[82:83], v22, s[52:55], s13 offen offset:2048
    s_mov_b32 s13, 4096
    buffer_load_dwordx2 v[84:85], v22, s[52:55], s13 offen offset:0
    buffer_load_dwordx2 v[86:87], v22, s[52:55], s13 offen offset:2048
    s_mov_b32 s13, 32768
    buffer_load_dwordx2 v[88:89], v22, s[52:55], s13 offen offset:0
    buffer_load_dwordx2 v[90:91], v22, s[52:55], s13 offen offset:2048
    s_mov_b32 s13, 36864
    buffer_load_dwordx2 v[92:93], v22, s[52:55], s13 offen offset:0
    buffer_load_dwordx2 v[94:95], v22, s[52:55], s13 offen offset:2048
    v_cmp_eq_u32 vcc, 1, v4
    v_mov_b32 v36, 1.0
    s_nop 0
    v_cndmask_b32 v72, v36, v20, vcc
    v_cndmask_b32 v73, 0, v21, vcc
    v_cndmask_b32 v96, 0, v32, vcc
    v_cndmask_b32 v98, 0, v34, vcc
    v_cndmask_b32 v36, v36, v16, vcc
    v_cndmask_b32 v37, 0, v17, vcc
    s_cmp_eq_u32 s8, 1
    s_cselect_b64 s[14:15], -1, 0
    v_mul_f32 v74, v20, v20
    v_fma_f32 v97, v14, v96, v44
    v_mul_f32 v75, v20, v21
    v_fma_f32 v99, v14, v98, v46
    v_fma_f32 v74, -v21, v21, v74
    v_fma_f32 v97, -v15, v98, v97
    v_fmac_f32 v75, v21, v20
    v_fmac_f32 v99, v15, v96
    v_mul_f32 v76, v74, v74
    v_fma_f32 v100, v12, v96, v40
    v_mul_f32 v77, v74, v75
    v_fma_f32 v101, v12, v97, v41
    v_fma_f32 v76, -v75, v75, v76
    v_fma_f32 v102, v12, v98, v42
    v_fmac_f32 v77, v75, v74
    v_fma_f32 v103, v12, v99, v43
    v_cndmask_b32 v74, 1.0, v74, s[14:15]
    v_fma_f32 v100, -v13, v98, v100
    v_cndmask_b32 v75, 0, v75, s[14:15]
    v_fma_f32 v101, -v13, v99, v101
    v_mul_f32 v64, v72, v74
    v_fmac_f32 v102, v13, v96
    v_mul_f32 v65, v72, v75
    v_fmac_f32 v103, v13, v97
    v_fma_f32 v64, -v73, v75, v64
    v_mul_f32 v104, v8, v36
    v_fmac_f32 v65, v73, v74
    v_mul_f32 v106, v8, v37
    v_mul_f32 v66, v64, v76
    v_fma_f32 v104, -v9, v37, v104
    v_mul_f32 v67, v64, v77
    v_fmac_f32 v106, v9, v36
    v_fma_f32 v66, -v65, v77, v66
    v_mul_f32 v105, v14, v104
    v_fmac_f32 v67, v65, v76
    v_mul_f32 v107, v14, v106
    v_mul_f32 v68, v66, v76
    v_fma_f32 v105, -v15, v106, v105
    v_mul_f32 v69, v66, v77
    v_fmac_f32 v107, v15, v104
    v_fma_f32 v68, -v67, v77, v68
    v_mul_f32 v108, v12, v104
    v_fmac_f32 v69, v67, v76
    v_mul_f32 v109, v12, v105
    v_mul_f32 v70, v68, v76
    v_mul_f32 v110, v12, v106
    v_mul_f32 v71, v68, v77
    v_mul_f32 v111, v12, v107
    v_fma_f32 v70, -v69, v77, v70
    v_fma_f32 v108, -v13, v106, v108
    v_fmac_f32 v71, v69, v76
    v_fma_f32 v109, -v13, v107, v109
    v_fmac_f32 v110, v13, v104
    v_fmac_f32 v111, v13, v105
    v_mul_f32 v112, v8, v96
    v_mul_f32 v113, v8, v97
    v_mul_f32 v114, -v8, v98
    v_mul_f32 v115, -v8, v99
    v_fma_f32 v112, -v9, v98, v112
    v_fma_f32 v113, -v9, v99, v113
    v_fma_f32 v114, -v9, v96, v114
    v_fma_f32 v115, -v9, v97, v115
    v_mul_f32 v116, v8, v100
    v_mul_f32 v117, v8, v101
    v_mul_f32 v118, -v8, v102
    v_mul_f32 v119, -v8, v103
    v_fma_f32 v116, -v9, v102, v116
    v_fma_f32 v117, -v9, v103, v117
    v_fma_f32 v118, -v9, v100, v118
    v_fma_f32 v119, -v9, v101, v119
    s_lshl_b32 s13, s3, 13
    s_add_u32 s13, s13, 65536
    v_and_b32 v32, 1, v2
    v_and_b32 v33, 2, v2
    v_lshl_or_b32 v32, v33, 1, v32
    v_lshrrev_b32 v33, 1, v2
    v_xor_b32 v33, v33, v2
    v_bfe_u32 v33, v33, 2, 1
    v_lshl_or_b32 v32, v33, 1, v32
    v_lshlrev_b32 v33, 2, v4
    v_xor_b32 v32, v32, v33
    v_lshlrev_b32 v32, 4, v32
    v_lshl_add_u32 v32, v3, 7, v32
    v_add_u32 v120, s13, v32
    v_xor_b32 v121, 16, v120
    v_xor_b32 v122, 32, v120
    v_xor_b32 v123, 48, v120
    v_bfe_u32 v32, v2, 2, 2
    v_lshrrev_b32 v33, 4, v2
    v_lshl_add_u32 v33, v33, 3, v32
    v_lshlrev_b32 v33, 7, v33
    v_and_b32 v34, 1, v32
    v_and_b32 v32, 2, v32
    v_lshl_or_b32 v32, v32, 1, v34
    v_bfe_u32 v34, v2, 4, 1
    v_bfe_u32 v35, v2, 1, 1
    v_lshl_or_b32 v34, v34, 1, v35
    v_xor_b32 v32, v32, v34
    v_lshl_add_u32 v33, v32, 4, v33
    v_and_b32 v32, 1, v2
    v_lshl_add_u32 v33, v32, 3, v33
    v_add_u32 v124, s13, v33
    v_xor_b32 v125, 64, v124
    v_xor_b32 v126, 32, v124
    v_xor_b32 v127, 64, v126
    s_lshl_b32 s10, s7, 5
    s_add_u32 s10, s10, s8
    s_lshl_b32 s10, s10, 12
    v_lshrrev_b32 v40, 3, v2
    v_lshl_add_u32 v40, v40, 13, s10
    v_lshrrev_b32 v41, 4, v2
    v_xor_b32 v41, v41, v2
    v_and_b32 v41, 7, v41
    v_lshl_add_u32 v16, v41, 4, v40
    v_xor_b32 v17, 64, v16
    v_add_u32 v17, 64512, v17
    s_lshl_b32 s16, s6, 2
    s_add_u32 s16, s16, s3
    s_lshl_b32 s16, s16, 17
    s_lshl_b32 s22, s9, 13
    s_lshl_b32 s10, s8, 12
    s_add_u32 s22, s22, s10
    s_lshl_b32 s10, s9, 6
    s_lshl_b32 s11, s9, 13
    v_xor_b32 v20, s10, v124
    v_xor_b32 v21, s10, v126
    v_subrev_u32 v20, s11, v20
    v_subrev_u32 v21, s11, v21
    s_mov_b32 s15, 0
G_all16_w:
    ds_read_b128 v[48:51], v11 offset:0
    s_waitcnt lgkmcnt(0)
    v_min3_u32 v48, v48, v49, v50
    v_min_u32 v48, v48, v51
    v_cmp_gt_u32 vcc, 16, v48
    s_cbranch_vccz G_all16_ok
    s_add_u32 s15, s15, 1
    s_cmp_lt_u32 s15, 160000
    s_cbranch_scc1 G_all16_w
G_all16_ok:
    v_mov_b32 v36, 0
    v_mov_b32 v37, 0
    s_mov_b32 s15, 0
    s_cmp_eq_u32 s6, 0
    s_cbranch_scc1 G_lb4
    s_lshl_b32 s14, s8, 1
    s_sub_i32 s14, s6, s14
    s_cmp_le_i32 s14, 0
    s_cbranch_scc1 G_lb3
G_lb:
    buffer_load_dwordx4 v[192:195], v60, s[64:67], 0 offen sc1
    s_cmp_le_i32 s14, 4
    s_cbranch_scc1 G_lb1
    buffer_load_dwordx4 v[196:199], v61, s[64:67], 0 offen sc1
    s_cmp_le_i32 s14, 8
    s_cbranch_scc1 G_lb1
    buffer_load_dwordx4 v[200:203], v62, s[64:67], 0 offen sc1
    s_cmp_le_i32 s14, 12
    s_cbranch_scc1 G_lb1
    buffer_load_dwordx4 v[204:207], v63, s[64:67], 0 offen sc1
G_lb1:
    v_mov_b32 v36, 0
    v_mov_b32 v37, 0
    s_mov_b64 s[10:11], 0
    s_waitcnt vmcnt(0)
    v_cmp_ne_u64 vcc, v[194:195], v[30:31]
    v_fmac_f32 v36, v64, v192
    v_fmac_f32 v37, v64, v193
    s_or_b64 s[10:11], s[10:11], vcc
    v_fma_f32 v36, -v65, v193, v36
    v_fmac_f32 v37, v65, v192
    s_cmp_le_i32 s14, 4
    s_cbranch_scc1 G_lb2
    v_cmp_ne_u64 vcc, v[198:199], v[30:31]
    v_fmac_f32 v36, v66, v196
    v_fmac_f32 v37, v66, v197
    s_or_b64 s[10:11], s[10:11], vcc
    v_fma_f32 v36, -v67, v197, v36
    v_fmac_f32 v37, v67, v196
    s_cmp_le_i32 s14, 8
    s_cbranch_scc1 G_lb2
    v_cmp_ne_u64 vcc, v[202:203], v[30:31]
    v_fmac_f32 v36, v68, v200
    v_fmac_f32 v37, v68, v201
    s_or_b64 s[10:11], s[10:11], vcc
    v_fma_f32 v36, -v69, v201, v36
    v_fmac_f32 v37, v69, v200
    s_cmp_le_i32 s14, 12
    s_cbranch_scc1 G_lb2
    v_cmp_ne_u64 vcc, v[206:207], v[30:31]
    v_fmac_f32 v36, v70, v204
    v_fmac_f32 v37, v70, v205
    s_or_b64 s[10:11], s[10:11], vcc
    v_fma_f32 v36, -v71, v205, v36
    v_fmac_f32 v37, v71, v204
G_lb2:
    s_cmp_eq_u64 s[10:11], 0
    s_cbranch_scc1 G_lb2b
    s_add_u32 s15, s15, 1
    s_cmp_lt_u32 s15, 20000
    s_cbranch_scc1 G_lb
G_lb2b:
    v_mov_b32 v38, v36
    v_mov_b32 v39, v37
    s_nop 0
    v_permlane32_swap_b32 v36, v38
    v_permlane32_swap_b32 v37, v39
    v_add_f32 v36, v36, v38
    v_add_f32 v37, v37, v39
G_lb3:
    v_mov_b32 v28, v36
    v_mov_b32 v29, v37
    ds_write_b128 v0, v[28:31]
    s_mov_b32 s15, 0
G_x2:
    ds_read_b128 v[192:195], v1 offset:0
    s_add_u32 s15, s15, 1
    s_waitcnt lgkmcnt(0)
    v_cmp_ne_u64 vcc, v[194:195], v[30:31]
    s_cbranch_vccz G_x2_ok
    s_cmp_lt_u32 s15, 160000
    s_cbranch_scc1 G_x2
G_x2_ok:
    v_add_f32 v36, v36, v192
    v_add_f32 v37, v37, v193
G_lb4:
    s_cmp_eq_u32 s8, 0
    s_cbranch_scc1 G_lbdone
    v_fma_f32 v56, v18, v36, v56
    v_fma_f32 v57, v18, v37, v57
    v_fma_f32 v56, -v19, v37, v56
    v_fma_f32 v37, v19, v36, v57
    v_mov_b32 v36, v56
G_lbdone:
    v_fmac_f32 v112, v36, v104
    v_fmac_f32 v113, v36, v105
    v_fma_f32 v114, -v37, v104, v114
    v_fma_f32 v115, -v37, v105, v115
    v_fmac_f32 v116, v36, v108
    v_fmac_f32 v117, v36, v109
    v_fma_f32 v118, -v37, v108, v118
    v_fma_f32 v119, -v37, v109, v119
    v_fma_f32 v112, -v37, v106, v112
    v_fma_f32 v113, -v37, v107, v113
    v_fma_f32 v114, -v36, v106, v114
    v_fma_f32 v115, -v36, v107, v115
    v_fma_f32 v116, -v37, v110, v116
    v_fma_f32 v117, -v37, v111, v117
    v_fma_f32 v118, -v36, v110, v118
    v_fma_f32 v119, -v36, v111, v119
    s_bfe_u32 s18, s100, 28 + (4 << 16)
    s_lshl_b32 s18, s18, 7
    buffer_load_dwordx4 v[224:227], v16, s[80:83], s18 offen offset:0
    v_fmac_f32 v128, v6, v112
    v_fmac_f32 v129, v6, v113
    v_fmac_f32 v144, v6, v114
    v_fmac_f32 v145, v6, v115
    v_fmac_f32 v160, v6, v116
    v_fmac_f32 v161, v6, v117
    v_fmac_f32 v176, v6, v118
    v_fmac_f32 v177, v6, v119
    v_fmac_f32 v128, v7, v114
    v_fmac_f32 v129, v7, v115
    v_fma_f32 v144, -v7, v112, v144
    v_fma_f32 v145, -v7, v113, v145
    v_fmac_f32 v160, v7, v118
    v_fmac_f32 v161, v7, v119
    v_fma_f32 v176, -v7, v116, v176
    v_fma_f32 v177, -v7, v117, v177
    buffer_load_dwordx4 v[228:231], v17, s[80:83], s18 offen offset:1024
    v_fmac_f32 v130, v6, v128
    v_fmac_f32 v131, v6, v129
    v_fmac_f32 v146, v6, v144
    v_fmac_f32 v147, v6, v145
    v_fmac_f32 v162, v6, v160
    v_fmac_f32 v163, v6, v161
    v_fmac_f32 v178, v6, v176
    v_fmac_f32 v179, v6, v177
    v_fmac_f32 v130, v7, v144
    v_fmac_f32 v131, v7, v145
    v_fma_f32 v146, -v7, v128, v146
    v_fma_f32 v147, -v7, v129, v147
    v_fmac_f32 v162, v7, v176
    v_fmac_f32 v163, v7, v177
    v_fma_f32 v178, -v7, v160, v178
    v_fma_f32 v179, -v7, v161, v179
    buffer_load_dwordx4 v[232:235], v16, s[80:83], s18 offen offset:2048
    v_fmac_f32 v132, v6, v130
    v_fmac_f32 v133, v6, v131
    v_fmac_f32 v148, v6, v146
    v_fmac_f32 v149, v6, v147
    v_fmac_f32 v164, v6, v162
    v_fmac_f32 v165, v6, v163
    v_fmac_f32 v180, v6, v178
    v_fmac_f32 v181, v6, v179
    v_fmac_f32 v132, v7, v146
    v_fmac_f32 v133, v7, v147
    v_fma_f32 v148, -v7, v130, v148
    v_fma_f32 v149, -v7, v131, v149
    v_fmac_f32 v164, v7, v178
    v_fmac_f32 v165, v7, v179
    v_fma_f32 v180, -v7, v162, v180
    v_fma_f32 v181, -v7, v163, v181
    buffer_load_dwordx4 v[236:239], v17, s[80:83], s18 offen offset:3072
    v_fmac_f32 v134, v6, v132
    v_fmac_f32 v135, v6, v133
    v_fmac_f32 v150, v6, v148
    v_fmac_f32 v151, v6, v149
    v_fmac_f32 v166, v6, v164
    v_fmac_f32 v167, v6, v165
    v_fmac_f32 v182, v6, v180
    v_fmac_f32 v183, v6, v181
    v_fmac_f32 v134, v7, v148
    v_fmac_f32 v135, v7, v149
    v_fma_f32 v150, -v7, v132, v150
    v_fma_f32 v151, -v7, v133, v151
    v_fmac_f32 v166, v7, v180
    v_fmac_f32 v167, v7, v181
    v_fma_f32 v182, -v7, v164, v182
    v_fma_f32 v183, -v7, v165, v183
    s_bfe_u32 s18, s101, 0 + (4 << 16)
    s_lshl_b32 s18, s18, 7
    buffer_load_dwordx4 v[240:243], v16, s[80:83], s18 offen offset:0
    v_fmac_f32 v136, v6, v134
    v_fmac_f32 v137, v6, v135
    v_fmac_f32 v152, v6, v150
    v_fmac_f32 v153, v6, v151
    v_fmac_f32 v168, v6, v166
    v_fmac_f32 v169, v6, v167
    v_fmac_f32 v184, v6, v182
    v_fmac_f32 v185, v6, v183
    v_fmac_f32 v136, v7, v150
    v_fmac_f32 v137, v7, v151
    v_fma_f32 v152, -v7, v134, v152
    v_fma_f32 v153, -v7, v135, v153
    v_fmac_f32 v168, v7, v182
    v_fmac_f32 v169, v7, v183
    v_fma_f32 v184, -v7, v166, v184
    v_fma_f32 v185, -v7, v167, v185
    buffer_load_dwordx4 v[244:247], v17, s[80:83], s18 offen offset:1024
    v_fmac_f32 v138, v6, v136
    v_fmac_f32 v139, v6, v137
    v_fmac_f32 v154, v6, v152
    v_fmac_f32 v155, v6, v153
    v_fmac_f32 v170, v6, v168
    v_fmac_f32 v171, v6, v169
    v_fmac_f32 v186, v6, v184
    v_fmac_f32 v187, v6, v185
    v_fmac_f32 v138, v7, v152
    v_fmac_f32 v139, v7, v153
    v_fma_f32 v154, -v7, v136, v154
    v_fma_f32 v155, -v7, v137, v155
    v_fmac_f32 v170, v7, v184
    v_fmac_f32 v171, v7, v185
    v_fma_f32 v186, -v7, v168, v186
    v_fma_f32 v187, -v7, v169, v187
    buffer_load_dwordx4 v[248:251], v16, s[80:83], s18 offen offset:2048
    v_fmac_f32 v140, v6, v138
    v_fmac_f32 v141, v6, v139
    v_fmac_f32 v156, v6, v154
    v_fmac_f32 v157, v6, v155
    v_fmac_f32 v172, v6, v170
    v_fmac_f32 v173, v6, v171
    v_fmac_f32 v188, v6, v186
    v_fmac_f32 v189, v6, v187
    v_fmac_f32 v140, v7, v154
    v_fmac_f32 v141, v7, v155
    v_fma_f32 v156, -v7, v138, v156
    v_fma_f32 v157, -v7, v139, v157
    v_fmac_f32 v172, v7, v186
    v_fmac_f32 v173, v7, v187
    v_fma_f32 v188, -v7, v170, v188
    v_fma_f32 v189, -v7, v171, v189
    buffer_load_dwordx4 v[252:255], v17, s[80:83], s18 offen offset:3072
    v_fmac_f32 v142, v6, v140
    v_fmac_f32 v143, v6, v141
    v_fmac_f32 v158, v6, v156
    v_fmac_f32 v159, v6, v157
    v_fmac_f32 v174, v6, v172
    v_fmac_f32 v175, v6, v173
    v_fmac_f32 v190, v6, v188
    v_fmac_f32 v191, v6, v189
    v_fmac_f32 v142, v7, v156
    v_fmac_f32 v143, v7, v157
    v_fma_f32 v158, -v7, v140, v158
    v_fma_f32 v159, -v7, v141, v159
    v_fmac_f32 v174, v7, v188
    v_fmac_f32 v175, v7, v189
    v_fma_f32 v190, -v7, v172, v190
    v_fma_f32 v191, -v7, v173, v191
    v_cvt_pk_bf16_f32 v192, v128, v130
    v_cvt_pk_bf16_f32 v193, v132, v134
    v_cvt_pk_bf16_f32 v194, v136, v138
    v_cvt_pk_bf16_f32 v195, v140, v142
    ds_write_b128 v120, v[192:195] offset:0
    v_cvt_pk_bf16_f32 v196, v160, v162
    v_cvt_pk_bf16_f32 v197, v164, v166
    v_cvt_pk_bf16_f32 v198, v168, v170
    v_cvt_pk_bf16_f32 v199, v172, v174
    ds_write_b128 v121, v[196:199] offset:0
    v_cvt_pk_bf16_f32 v200, v129, v131
    v_cvt_pk_bf16_f32 v201, v133, v135
    v_cvt_pk_bf16_f32 v202, v137, v139
    v_cvt_pk_bf16_f32 v203, v141, v143
    ds_write_b128 v122, v[200:203] offset:0
    v_cvt_pk_bf16_f32 v204, v161, v163
    v_cvt_pk_bf16_f32 v205, v165, v167
    v_cvt_pk_bf16_f32 v206, v169, v171
    v_cvt_pk_bf16_f32 v207, v173, v175
    ds_write_b128 v123, v[204:207] offset:0
    v_cvt_pk_bf16_f32 v208, v144, v146
    v_cvt_pk_bf16_f32 v209, v148, v150
    v_cvt_pk_bf16_f32 v210, v152, v154
    v_cvt_pk_bf16_f32 v211, v156, v158
    ds_write_b128 v120, v[208:211] offset:4096
    v_cvt_pk_bf16_f32 v212, v176, v178
    v_cvt_pk_bf16_f32 v213, v180, v182
    v_cvt_pk_bf16_f32 v214, v184, v186
    v_cvt_pk_bf16_f32 v215, v188, v190
    ds_write_b128 v121, v[212:215] offset:4096
    v_cvt_pk_bf16_f32 v216, v145, v147
    v_cvt_pk_bf16_f32 v217, v149, v151
    v_cvt_pk_bf16_f32 v218, v153, v155
    v_cvt_pk_bf16_f32 v219, v157, v159
    ds_write_b128 v122, v[216:219] offset:4096
    v_cvt_pk_bf16_f32 v220, v177, v179
    v_cvt_pk_bf16_f32 v221, v181, v183
    v_cvt_pk_bf16_f32 v222, v185, v187
    v_cvt_pk_bf16_f32 v223, v189, v191
    ds_write_b128 v123, v[220:223] offset:4096
    s_lshl_b32 s10, s12, 18
    s_lshl_b32 s11, s7, 13
    s_add_u32 s10, s10, s11
    s_lshl_b32 s11, s9, 11
    s_add_u32 s10, s10, s11
    s_add_u32 s11, s10, 131072
    v_mov_b32 v22, 17
    s_waitcnt lgkmcnt(0)
    ds_read_b64_tr_b16 v[160:161], v124 offset:0
    ds_read_b64_tr_b16 v[162:163], v126 offset:512
    ds_read_b64_tr_b16 v[164:165], v126 offset:0
    ds_read_b64_tr_b16 v[166:167], v124 offset:512
    ds_read_b64_tr_b16 v[168:169], v125 offset:0
    ds_read_b64_tr_b16 v[170:171], v127 offset:512
    ds_read_b64_tr_b16 v[172:173], v127 offset:0
    ds_read_b64_tr_b16 v[174:175], v125 offset:512
    ds_read_b64_tr_b16 v[176:177], v124 offset:4096
    ds_read_b64_tr_b16 v[178:179], v126 offset:4608
    ds_read_b64_tr_b16 v[180:181], v126 offset:4096
    ds_read_b64_tr_b16 v[182:183], v124 offset:4608
    ds_read_b64_tr_b16 v[184:185], v125 offset:4096
    ds_read_b64_tr_b16 v[186:187], v127 offset:4608
    ds_read_b64_tr_b16 v[188:189], v127 offset:4096
    ds_read_b64_tr_b16 v[190:191], v125 offset:4608
    s_waitcnt lgkmcnt(14)
    buffer_store_dwordx4 v[160:163], v26, s[68:71], s10 offen offset:0 sc1
    s_waitcnt lgkmcnt(12)
    buffer_store_dwordx4 v[164:167], v26, s[68:71], s10 offen offset:1024 sc1
    s_waitcnt lgkmcnt(10)
    buffer_store_dwordx4 v[168:171], v26, s[68:71], s11 offen offset:0 sc1
    s_waitcnt lgkmcnt(8)
    buffer_store_dwordx4 v[172:175], v26, s[68:71], s11 offen offset:1024 sc1
    s_waitcnt lgkmcnt(6)
    buffer_store_dwordx4 v[176:179], v27, s[68:71], s10 offen offset:0 sc1
    s_waitcnt lgkmcnt(4)
    buffer_store_dwordx4 v[180:183], v27, s[68:71], s10 offen offset:1024 sc1
    s_waitcnt lgkmcnt(2)
    buffer_store_dwordx4 v[184:187], v27, s[68:71], s11 offen offset:0 sc1
    s_waitcnt lgkmcnt(0)
    buffer_store_dwordx4 v[188:191], v27, s[68:71], s11 offen offset:1024 sc1
    ds_write_b32 v10, v22
    v_and_b32 v112, 15, v2
    v_lshrrev_b32 v113, 1, v112
    v_lshrrev_b32 v114, 4, v2
    v_xor_b32 v113, v113, v114
    v_lshlrev_b32 v113, 4, v113
    v_lshl_add_u32 v6, v112, 7, v113
    v_xor_b32 v7, 64, v6
    v_add_u32 v8, 65536, v6
    v_add_u32 v9, 65536, v7
    v_add_u32 v0, s22, v26
    v_add_u32 v1, 65536, v0
    s_lshl_b32 s10, s6, 11
    s_add_u32 s10, s10, 32768
    s_lshl_b32 s11, s7, 7
    s_add_u32 s11, s11, s10
    v_lshl_add_u32 v5, v112, 7, s10
    v_cmp_ne_u32 s[20:21], s7, v112
    v_lshlrev_b32 v116, 16, v24
    v_and_b32 v117, 0xffff0000, v24
    v_lshlrev_b32 v118, 16, v25
    v_and_b32 v119, 0xffff0000, v25
    v_add_u32 v26, s16, v26
    v_add_u32 v27, s16, v27
    s_waitcnt vmcnt(16)
    v_lshlrev_b32 v192, 16, v80
    v_and_b32 v193, 0xffff0000, v80
    v_lshlrev_b32 v194, 16, v81
    v_and_b32 v195, 0xffff0000, v81
    v_lshlrev_b32 v196, 16, v82
    v_and_b32 v197, 0xffff0000, v82
    v_lshlrev_b32 v198, 16, v83
    v_and_b32 v199, 0xffff0000, v83
    v_lshlrev_b32 v200, 16, v84
    v_and_b32 v201, 0xffff0000, v84
    v_lshlrev_b32 v202, 16, v85
    v_and_b32 v203, 0xffff0000, v85
    v_lshlrev_b32 v204, 16, v86
    v_and_b32 v205, 0xffff0000, v86
    v_lshlrev_b32 v206, 16, v87
    v_and_b32 v207, 0xffff0000, v87
    v_lshlrev_b32 v208, 16, v88
    v_and_b32 v209, 0xffff0000, v88
    v_lshlrev_b32 v210, 16, v89
    v_and_b32 v211, 0xffff0000, v89
    v_lshlrev_b32 v212, 16, v90
    v_and_b32 v213, 0xffff0000, v90
    v_lshlrev_b32 v214, 16, v91
    v_and_b32 v215, 0xffff0000, v91
    v_lshlrev_b32 v216, 16, v92
    v_and_b32 v217, 0xffff0000, v92
    v_lshlrev_b32 v218, 16, v93
    v_and_b32 v219, 0xffff0000, v93
    v_lshlrev_b32 v220, 16, v94
    v_and_b32 v221, 0xffff0000, v94
    v_lshlrev_b32 v222, 16, v95
    v_and_b32 v223, 0xffff0000, v95
    v_mul_f32 v64, v192, v116
    v_mul_f32 v72, v193, v117
    v_mul_f32 v80, v194, v118
    v_mul_f32 v88, v195, v119
    v_mul_f32 v65, v196, v116
    v_mul_f32 v73, v197, v117
    v_mul_f32 v81, v198, v118
    v_mul_f32 v89, v199, v119
    v_mul_f32 v66, v200, v116
    v_mul_f32 v74, v201, v117
    v_mul_f32 v82, v202, v118
    v_mul_f32 v90, v203, v119
    v_mul_f32 v67, v204, v116
    v_mul_f32 v75, v205, v117
    v_mul_f32 v83, v206, v118
    v_mul_f32 v91, v207, v119
    v_mul_f32 v68, v208, v116
    v_mul_f32 v76, v209, v117
    v_mul_f32 v84, v210, v118
    v_mul_f32 v92, v211, v119
    v_mul_f32 v69, v212, v116
    v_mul_f32 v77, v213, v117
    v_mul_f32 v85, v214, v118
    v_mul_f32 v93, v215, v119
    v_mul_f32 v70, v216, v116
    v_mul_f32 v78, v217, v117
    v_mul_f32 v86, v218, v118
    v_mul_f32 v94, v219, v119
    v_mul_f32 v71, v220, v116
    v_mul_f32 v79, v221, v117
    v_mul_f32 v87, v222, v118
    v_mul_f32 v95, v223, v119
    s_mov_b32 s15, 0
G_all17_w:
    ds_read_b128 v[12:15], v11 offset:0
    s_waitcnt lgkmcnt(0)
    v_min3_u32 v12, v12, v13, v14
    v_min_u32 v12, v12, v15
    v_cmp_gt_u32 vcc, 17, v12
    s_cbranch_vccz G_all17_ok
    s_add_u32 s15, s15, 1
    s_cmp_lt_u32 s15, 160000
    s_cbranch_scc1 G_all17_w
G_all17_ok:
    ds_read_b64_tr_b16 v[128:129], v20 offset:0
    ds_read_b64_tr_b16 v[130:131], v21 offset:512
    ds_read_b64_tr_b16 v[132:133], v21 offset:0
    ds_read_b64_tr_b16 v[134:135], v20 offset:512
    ds_read_b64_tr_b16 v[136:137], v20 offset:8192
    ds_read_b64_tr_b16 v[138:139], v21 offset:8704
    ds_read_b64_tr_b16 v[140:141], v21 offset:8192
    ds_read_b64_tr_b16 v[142:143], v20 offset:8704
    ds_read_b64_tr_b16 v[144:145], v20 offset:4096
    ds_read_b64_tr_b16 v[146:147], v21 offset:4608
    ds_read_b64_tr_b16 v[148:149], v21 offset:4096
    ds_read_b64_tr_b16 v[150:151], v20 offset:4608
    ds_read_b64_tr_b16 v[152:153], v20 offset:12288
    ds_read_b64_tr_b16 v[154:155], v21 offset:12800
    ds_read_b64_tr_b16 v[156:157], v21 offset:12288
    ds_read_b64_tr_b16 v[158:159], v20 offset:12800
    v_mov_b32 v18, 1
    s_waitcnt vmcnt(0)
    s_mov_b64 exec, 1
    ds_add_rtn_u32 v18, v11, v18 offset:52
    s_waitcnt lgkmcnt(0)
    v_readfirstlane_b32 s14, v18
    s_cmp_eq_u32 s14, 3
    s_cbranch_scc0 G_nl
    buffer_store_dwordx2 v[30:31], v23, s[72:75], s11 offen sc1
    s_mov_b64 exec, -1
G_nl:
    s_mov_b64 exec, -1
    s_mov_b32 s15, 0
G_f0_w:
    ds_read_b32 v18, v11 offset:60
    s_waitcnt lgkmcnt(0)
    v_cmp_gt_u32 vcc, 4, v18
    s_cbranch_vccz G_f0_ok
    s_sleep 1
    s_add_u32 s15, s15, 1
    s_cmp_lt_u32 s15, 160000
    s_cbranch_scc1 G_f0_w
G_f0_ok:
    ds_read_b128 v[192:195], v6 offset:0
    ds_read_b128 v[196:199], v6 offset:2048
    ds_read_b128 v[200:203], v6 offset:4096
    ds_read_b128 v[204:207], v6 offset:6144
    ds_read_b128 v[208:211], v7 offset:0
    ds_read_b128 v[212:215], v7 offset:2048
    ds_read_b128 v[216:219], v7 offset:4096
    s_waitcnt lgkmcnt(6)
    v_mfma_f32_16x16x32_bf16 v[64:67], v[128:131], v[192:195], v[64:67]
    ds_read_b128 v[220:223], v7 offset:6144
    v_mfma_f32_16x16x32_bf16 v[68:71], v[132:135], v[192:195], v[68:71]
    s_bfe_u32 s18, s101, 4 + (4 << 16)
    s_lshl_b32 s18, s18, 7
    buffer_load_dwordx4 v[48:51], v16, s[80:83], s18 offen offset:0
    s_waitcnt lgkmcnt(6)
    v_mfma_f32_16x16x32_bf16 v[72:75], v[128:131], v[196:199], v[72:75]
    ds_read_b128 v[192:195], v6 offset:8192
    v_mfma_f32_16x16x32_bf16 v[76:79], v[132:135], v[196:199], v[76:79]
    s_waitcnt lgkmcnt(6)
    v_mfma_f32_16x16x32_bf16 v[80:83], v[128:131], v[200:203], v[80:83]
    ds_read_b128 v[196:199], v6 offset:10240
    v_mfma_f32_16x16x32_bf16 v[84:87], v[132:135], v[200:203], v[84:87]
    buffer_load_dwordx4 v[52:55], v17, s[80:83], s18 offen offset:1024
    s_waitcnt lgkmcnt(6)
    v_mfma_f32_16x16x32_bf16 v[88:91], v[128:131], v[204:207], v[88:91]
    ds_read_b128 v[200:203], v6 offset:12288
    v_mfma_f32_16x16x32_bf16 v[92:95], v[132:135], v[204:207], v[92:95]
    s_waitcnt lgkmcnt(6)
    v_mfma_f32_16x16x32_bf16 v[64:67], v[136:139], v[208:211], v[64:67]
    ds_read_b128 v[204:207], v6 offset:14336
    v_mfma_f32_16x16x32_bf16 v[68:71], v[140:143], v[208:211], v[68:71]
    buffer_load_dwordx4 v[56:59], v16, s[80:83], s18 offen offset:2048
    s_waitcnt lgkmcnt(6)
    v_mfma_f32_16x16x32_bf16 v[72:75], v[136:139], v[212:215], v[72:75]
    ds_read_b128 v[208:211], v7 offset:8192
    v_mfma_f32_16x16x32_bf16 v[76:79], v[140:143], v[212:215], v[76:79]
    s_waitcnt lgkmcnt(6)
    v_mfma_f32_16x16x32_bf16 v[80:83], v[136:139], v[216:219], v[80:83]
    ds_read_b128 v[212:215], v7 offset:10240
    v_mfma_f32_16x16x32_bf16 v[84:87], v[140:143], v[216:219], v[84:87]
    buffer_load_dwordx4 v[60:63], v17, s[80:83], s18 offen offset:3072
    s_waitcnt lgkmcnt(6)
    v_mfma_f32_16x16x32_bf16 v[88:91], v[136:139], v[220:223], v[88:91]
    ds_read_b128 v[216:219], v7 offset:12288
    v_mfma_f32_16x16x32_bf16 v[92:95], v[140:143], v[220:223], v[92:95]
    s_waitcnt lgkmcnt(6)
    v_mfma_f32_16x16x32_bf16 v[64:67], v[144:147], v[192:195], v[64:67]
    ds_read_b128 v[220:223], v7 offset:14336
    v_mfma_f32_16x16x32_bf16 v[68:71], v[148:151], v[192:195], v[68:71]
    s_bfe_u32 s18, s101, 8 + (4 << 16)
    s_lshl_b32 s18, s18, 7
    buffer_load_dwordx4 v[32:35], v16, s[80:83], s18 offen offset:0
    s_waitcnt lgkmcnt(6)
    v_mfma_f32_16x16x32_bf16 v[72:75], v[144:147], v[196:199], v[72:75]
    ds_read_b128 v[192:195], v6 offset:16384
    v_mfma_f32_16x16x32_bf16 v[76:79], v[148:151], v[196:199], v[76:79]
    s_waitcnt lgkmcnt(6)
    v_mfma_f32_16x16x32_bf16 v[80:83], v[144:147], v[200:203], v[80:83]
    ds_read_b128 v[196:199], v6 offset:18432
    v_mfma_f32_16x16x32_bf16 v[84:87], v[148:151], v[200:203], v[84:87]
    buffer_load_dwordx4 v[36:39], v17, s[80:83], s18 offen offset:1024
    s_waitcnt lgkmcnt(6)
    v_mfma_f32_16x16x32_bf16 v[88:91], v[144:147], v[204:207], v[88:91]
    ds_read_b128 v[200:203], v6 offset:20480
    v_mfma_f32_16x16x32_bf16 v[92:95], v[148:151], v[204:207], v[92:95]
    s_waitcnt lgkmcnt(6)
    v_mfma_f32_16x16x32_bf16 v[64:67], v[152:155], v[208:211], v[64:67]
    ds_read_b128 v[204:207], v6 offset:22528
    v_mfma_f32_16x16x32_bf16 v[68:71], v[156:159], v[208:211], v[68:71]
    buffer_load_dwordx4 v[40:43], v16, s[80:83], s18 offen offset:2048
    s_waitcnt lgkmcnt(6)
    v_mfma_f32_16x16x32_bf16 v[72:75], v[152:155], v[212:215], v[72:75]
    ds_read_b128 v[208:211], v7 offset:16384
    v_mfma_f32_16x16x32_bf16 v[76:79], v[156:159], v[212:215], v[76:79]
    s_waitcnt lgkmcnt(6)
    v_mfma_f32_16x16x32_bf16 v[80:83], v[152:155], v[216:219], v[80:83]
    ds_read_b128 v[212:215], v7 offset:18432
    v_mfma_f32_16x16x32_bf16 v[84:87], v[156:159], v[216:219], v[84:87]
    buffer_load_dwordx4 v[44:47], v17, s[80:83], s18 offen offset:3072
    s_waitcnt lgkmcnt(6)
    v_mfma_f32_16x16x32_bf16 v[88:91], v[152:155], v[220:223], v[88:91]
    ds_read_b128 v[216:219], v7 offset:20480
    v_mfma_f32_16x16x32_bf16 v[92:95], v[156:159], v[220:223], v[92:95]
    v_mov_b32 v22, 18
    ds_write_b32 v10, v22
    s_bfe_u32 s18, s101, 12 + (4 << 16)
    s_lshl_b32 s18, s18, 7
    buffer_load_dwordx4 v[96:99], v16, s[80:83], s18 offen offset:0
    buffer_load_dwordx4 v[100:103], v17, s[80:83], s18 offen offset:1024
    buffer_load_dwordx4 v[104:107], v16, s[80:83], s18 offen offset:2048
    buffer_load_dwordx4 v[108:111], v17, s[80:83], s18 offen offset:3072
    s_bfe_u32 s18, s101, 16 + (4 << 16)
    s_lshl_b32 s18, s18, 7
    buffer_load_dwordx4 v[112:115], v16, s[80:83], s18 offen offset:0
    buffer_load_dwordx4 v[116:119], v17, s[80:83], s18 offen offset:1024
    buffer_load_dwordx4 v[120:123], v16, s[80:83], s18 offen offset:2048
    buffer_load_dwordx4 v[124:127], v17, s[80:83], s18 offen offset:3072
    s_mov_b32 s15, 0
G_all18_w:
    ds_read_b128 v[12:15], v11 offset:0
    s_waitcnt lgkmcnt(0)
    v_min3_u32 v12, v12, v13, v14
    v_min_u32 v12, v12, v15
    v_cmp_gt_u32 vcc, 18, v12
    s_cbranch_vccz G_all18_ok
    s_add_u32 s15, s15, 1
    s_cmp_lt_u32 s15, 160000
    s_cbranch_scc1 G_all18_w
G_all18_ok:
    s_cmp_eq_u32 s14, 3
    s_cbranch_scc0 G_pl
    buffer_load_dwordx2 v[28:29], v5, s[72:75], 0 offen sc1
G_pl:
    s_bfe_u32 s18, s100, 16 + (4 << 16)
    s_lshl_b32 s18, s18, 7
    s_add_u32 m0, s22, 65536
    s_nop 0
    buffer_load_dwordx4 v16, s[80:83], s18 offen offset:0 lds
    buffer_load_dwordx4 v17, s[80:83], s18 offen offset:1024 lds
    buffer_load_dwordx4 v16, s[80:83], s18 offen offset:2048 lds
    buffer_load_dwordx4 v17, s[80:83], s18 offen offset:3072 lds
    s_bfe_u32 s18, s100, 20 + (4 << 16)
    s_lshl_b32 s18, s18, 7
    s_add_u32 m0, s22, 81920
    s_nop 0
    buffer_load_dwordx4 v16, s[80:83], s18 offen offset:0 lds
    buffer_load_dwordx4 v17, s[80:83], s18 offen offset:1024 lds
    buffer_load_dwordx4 v16, s[80:83], s18 offen offset:2048 lds
    buffer_load_dwordx4 v17, s[80:83], s18 offen offset:3072 lds
    s_bfe_u32 s18, s100, 24 + (4 << 16)
    s_lshl_b32 s18, s18, 7
    s_add_u32 m0, s22, 0
    s_nop 0
    buffer_load_dwordx4 v16, s[80:83], s18 offen offset:0 lds
    buffer_load_dwordx4 v17, s[80:83], s18 offen offset:1024 lds
    buffer_load_dwordx4 v16, s[80:83], s18 offen offset:2048 lds
    buffer_load_dwordx4 v17, s[80:83], s18 offen offset:3072 lds
    s_mov_b32 s15, 0
    s_cmp_eq_u32 s14, 3
    s_cbranch_scc0 G_np
    s_waitcnt vmcnt(12)
GH_chk:
    v_cmp_ne_u64 vcc, v[28:29], v[30:31]
    s_and_b64 vcc, vcc, s[20:21]
    s_cbranch_scc0 GH_ok
    buffer_load_dwordx2 v[28:29], v5, s[72:75], 0 offen sc1
    s_add_u32 s15, s15, 1
    s_cmp_lt_u32 s15, 20000
    s_waitcnt vmcnt(0)
    s_cbranch_scc1 GH_chk
GH_ok:
    ds_write_b32 v11, v22 offset:56
    s_branch G_go
G_np:
    s_mov_b32 s15, 0
G_fho_w:
    ds_read_b32 v18, v11 offset:56
    s_waitcnt lgkmcnt(0)
    v_cmp_gt_u32 vcc, 1, v18
    s_cbranch_vccz G_fho_ok
    s_sleep 1
    s_add_u32 s15, s15, 1
    s_cmp_lt_u32 s15, 160000
    s_cbranch_scc1 G_fho_w
G_fho_ok:
G_go:
    s_bfe_u32 s19, s100, 4 + (4 << 16)
    s_lshl_b32 s19, s19, 13
    buffer_load_dwordx4 v[160:163], v26, s[68:71], s19 offen offset:0 sc1
    buffer_load_dwordx4 v[164:167], v26, s[68:71], s19 offen offset:1024 sc1
    buffer_load_dwordx4 v[168:171], v26, s[68:71], s19 offen offset:2048 sc1
    buffer_load_dwordx4 v[172:175], v26, s[68:71], s19 offen offset:3072 sc1
    buffer_load_dwordx4 v[176:179], v27, s[68:71], s19 offen offset:0 sc1
    buffer_load_dwordx4 v[180:183], v27, s[68:71], s19 offen offset:1024 sc1
    buffer_load_dwordx4 v[184:187], v27, s[68:71], s19 offen offset:2048 sc1
    buffer_load_dwordx4 v[188:191], v27, s[68:71], s19 offen offset:3072 sc1
    s_bfe_u32 s19, s100, 8 + (4 << 16)
    s_lshl_b32 s19, s19, 13
    buffer_load_dwordx4 v[128:131], v26, s[68:71], s19 offen offset:0 sc1
    buffer_load_dwordx4 v[132:135], v26, s[68:71], s19 offen offset:1024 sc1
    buffer_load_dwordx4 v[136:139], v26, s[68:71], s19 offen offset:2048 sc1
    buffer_load_dwordx4 v[140:143], v26, s[68:71], s19 offen offset:3072 sc1
    buffer_load_dwordx4 v[144:147], v27, s[68:71], s19 offen offset:0 sc1
    buffer_load_dwordx4 v[148:151], v27, s[68:71], s19 offen offset:1024 sc1
    buffer_load_dwordx4 v[152:155], v27, s[68:71], s19 offen offset:2048 sc1
    buffer_load_dwordx4 v[156:159], v27, s[68:71], s19 offen offset:3072 sc1
    s_setprio 1
    s_waitcnt vmcnt(14)
    v_mfma_f32_16x16x32_bf16 v[64:67], v[160:163], v[192:195], v[64:67]
    ds_read_b128 v[220:223], v7 offset:22528
    v_mfma_f32_16x16x32_bf16 v[68:71], v[164:167], v[192:195], v[68:71]
    v_mfma_f32_16x16x32_bf16 v[72:75], v[160:163], v[196:199], v[72:75]
    ds_read_b128 v[192:195], v6 offset:24576
    v_mfma_f32_16x16x32_bf16 v[76:79], v[164:167], v[196:199], v[76:79]
    v_mfma_f32_16x16x32_bf16 v[80:83], v[160:163], v[200:203], v[80:83]
    ds_read_b128 v[196:199], v6 offset:26624
    v_mfma_f32_16x16x32_bf16 v[84:87], v[164:167], v[200:203], v[84:87]
    v_mfma_f32_16x16x32_bf16 v[88:91], v[160:163], v[204:207], v[88:91]
    ds_read_b128 v[200:203], v6 offset:28672
    s_bfe_u32 s19, s100, 12 + (4 << 16)
    v_mfma_f32_16x16x32_bf16 v[92:95], v[164:167], v[204:207], v[92:95]
    s_lshl_b32 s19, s19, 13
    s_waitcnt vmcnt(12)
    v_mfma_f32_16x16x32_bf16 v[64:67], v[168:171], v[208:211], v[64:67]
    ds_read_b128 v[204:207], v6 offset:30720
    v_mfma_f32_16x16x32_bf16 v[68:71], v[172:175], v[208:211], v[68:71]
    buffer_load_dwordx4 v[160:163], v26, s[68:71], s19 offen offset:0 sc1
    v_mfma_f32_16x16x32_bf16 v[72:75], v[168:171], v[212:215], v[72:75]
    ds_read_b128 v[208:211], v7 offset:24576
    v_mfma_f32_16x16x32_bf16 v[76:79], v[172:175], v[212:215], v[76:79]
    v_mfma_f32_16x16x32_bf16 v[80:83], v[168:171], v[216:219], v[80:83]
    ds_read_b128 v[212:215], v7 offset:26624
    v_mfma_f32_16x16x32_bf16 v[84:87], v[172:175], v[216:219], v[84:87]
    buffer_load_dwordx4 v[164:167], v26, s[68:71], s19 offen offset:1024 sc1
    s_waitcnt lgkmcnt(6)
    v_mfma_f32_16x16x32_bf16 v[88:91], v[168:171], v[220:223], v[88:91]
    ds_read_b128 v[216:219], v7 offset:28672
    v_mfma_f32_16x16x32_bf16 v[92:95], v[172:175], v[220:223], v[92:95]
    s_waitcnt vmcnt(12) lgkmcnt(6)
    v_mfma_f32_16x16x32_bf16 v[64:67], v[176:179], v[192:195], v[64:67]
    ds_read_b128 v[220:223], v7 offset:30720
    v_mfma_f32_16x16x32_bf16 v[68:71], v[180:183], v[192:195], v[68:71]
    buffer_load_dwordx4 v[168:171], v26, s[68:71], s19 offen offset:2048 sc1
    s_waitcnt lgkmcnt(6)
    v_mfma_f32_16x16x32_bf16 v[72:75], v[176:179], v[196:199], v[72:75]
    ds_read_b128 v[192:195], v6 offset:32768
    v_mfma_f32_16x16x32_bf16 v[76:79], v[180:183], v[196:199], v[76:79]
    s_waitcnt lgkmcnt(6)
    v_mfma_f32_16x16x32_bf16 v[80:83], v[176:179], v[200:203], v[80:83]
    ds_read_b128 v[196:199], v6 offset:34816
    v_mfma_f32_16x16x32_bf16 v[84:87], v[180:183], v[200:203], v[84:87]
    buffer_load_dwordx4 v[172:175], v26, s[68:71], s19 offen offset:3072 sc1
    s_waitcnt lgkmcnt(6)
    v_mfma_f32_16x16x32_bf16 v[88:91], v[176:179], v[204:207], v[88:91]
    ds_read_b128 v[200:203], v6 offset:36864
    v_mfma_f32_16x16x32_bf16 v[92:95], v[180:183], v[204:207], v[92:95]
    s_waitcnt vmcnt(12) lgkmcnt(6)
    v_mfma_f32_16x16x32_bf16 v[64:67], v[184:187], v[208:211], v[64:67]
    ds_read_b128 v[204:207], v6 offset:38912
    v_mfma_f32_16x16x32_bf16 v[68:71], v[188:191], v[208:211], v[68:71]
    buffer_load_dwordx4 v[176:179], v27, s[68:71], s19 offen offset:0 sc1
    s_waitcnt lgkmcnt(6)
    v_mfma_f32_16x16x32_bf16 v[72:75], v[184:187], v[212:215], v[72:75]
    ds_read_b128 v[208:211], v7 offset:32768
    v_mfma_f32_16x16x32_bf16 v[76:79], v[188:191], v[212:215], v[76:79]
    s_waitcnt lgkmcnt(6)
    v_mfma_f32_16x16x32_bf16 v[80:83], v[184:187], v[216:219], v[80:83]
    ds_read_b128 v[212:215], v7 offset:34816
    v_mfma_f32_16x16x32_bf16 v[84:87], v[188:191], v[216:219], v[84:87]
    buffer_load_dwordx4 v[180:183], v27, s[68:71], s19 offen offset:1024 sc1
    s_waitcnt lgkmcnt(6)
    v_mfma_f32_16x16x32_bf16 v[88:91], v[184:187], v[220:223], v[88:91]
    ds_read_b128 v[216:219], v7 offset:36864
    v_mfma_f32_16x16x32_bf16 v[92:95], v[188:191], v[220:223], v[92:95]
    s_waitcnt vmcnt(12) lgkmcnt(6)
    v_mfma_f32_16x16x32_bf16 v[64:67], v[128:131], v[192:195], v[64:67]
    ds_read_b128 v[220:223], v7 offset:38912
    v_mov_b32 v22, 20
    v_mfma_f32_16x16x32_bf16 v[68:71], v[132:135], v[192:195], v[68:71]
    buffer_load_dwordx4 v[184:187], v27, s[68:71], s19 offen offset:2048 sc1
    s_waitcnt lgkmcnt(6)
    v_mfma_f32_16x16x32_bf16 v[72:75], v[128:131], v[196:199], v[72:75]
    ds_read_b128 v[192:195], v6 offset:40960
    v_mfma_f32_16x16x32_bf16 v[76:79], v[132:135], v[196:199], v[76:79]
    ds_write_b32 v10, v22
    s_waitcnt lgkmcnt(7)
    v_mfma_f32_16x16x32_bf16 v[80:83], v[128:131], v[200:203], v[80:83]
    ds_read_b128 v[196:199], v6 offset:43008
    v_mfma_f32_16x16x32_bf16 v[84:87], v[132:135], v[200:203], v[84:87]
    buffer_load_dwordx4 v[188:191], v27, s[68:71], s19 offen offset:3072 sc1
    s_waitcnt lgkmcnt(7)
    v_mfma_f32_16x16x32_bf16 v[88:91], v[128:131], v[204:207], v[88:91]
    ds_read_b128 v[200:203], v6 offset:45056
    s_bfe_u32 s19, s100, 16 + (4 << 16)
    v_mfma_f32_16x16x32_bf16 v[92:95], v[132:135], v[204:207], v[92:95]
    s_lshl_b32 s19, s19, 13
    s_waitcnt vmcnt(12) lgkmcnt(7)
    v_mfma_f32_16x16x32_bf16 v[64:67], v[136:139], v[208:211], v[64:67]
    ds_read_b128 v[204:207], v6 offset:47104
    v_mfma_f32_16x16x32_bf16 v[68:71], v[140:143], v[208:211], v[68:71]
    buffer_load_dwordx4 v[128:131], v26, s[68:71], s19 offen offset:0 sc1
    s_waitcnt lgkmcnt(7)
    v_mfma_f32_16x16x32_bf16 v[72:75], v[136:139], v[212:215], v[72:75]
    ds_read_b128 v[208:211], v7 offset:40960
    v_mfma_f32_16x16x32_bf16 v[76:79], v[140:143], v[212:215], v[76:79]
    s_waitcnt lgkmcnt(7)
    v_mfma_f32_16x16x32_bf16 v[80:83], v[136:139], v[216:219], v[80:83]
    ds_read_b128 v[212:215], v7 offset:43008
    v_mfma_f32_16x16x32_bf16 v[84:87], v[140:143], v[216:219], v[84:87]
    buffer_load_dwordx4 v[132:135], v26, s[68:71], s19 offen offset:1024 sc1
    s_waitcnt lgkmcnt(7)
    v_mfma_f32_16x16x32_bf16 v[88:91], v[136:139], v[220:223], v[88:91]
    ds_read_b128 v[216:219], v7 offset:45056
    v_mfma_f32_16x16x32_bf16 v[92:95], v[140:143], v[220:223], v[92:95]
    s_waitcnt vmcnt(12) lgkmcnt(7)
    v_mfma_f32_16x16x32_bf16 v[64:67], v[144:147], v[192:195], v[64:67]
    ds_read_b128 v[220:223], v7 offset:47104
    v_mfma_f32_16x16x32_bf16 v[68:71], v[148:151], v[192:195], v[68:71]
    buffer_load_dwordx4 v[136:139], v26, s[68:71], s19 offen offset:2048 sc1
    s_waitcnt lgkmcnt(6)
    v_mfma_f32_16x16x32_bf16 v[72:75], v[144:147], v[196:199], v[72:75]
    ds_read_b128 v[192:195], v6 offset:49152
    v_mfma_f32_16x16x32_bf16 v[76:79], v[148:151], v[196:199], v[76:79]
    s_waitcnt lgkmcnt(6)
    v_mfma_f32_16x16x32_bf16 v[80:83], v[144:147], v[200:203], v[80:83]
    ds_read_b128 v[196:199], v6 offset:51200
    ds_read_b128 v[12:15], v11
    v_mfma_f32_16x16x32_bf16 v[84:87], v[148:151], v[200:203], v[84:87]
    buffer_load_dwordx4 v[140:143], v26, s[68:71], s19 offen offset:3072 sc1
    s_waitcnt lgkmcnt(7)
    v_mfma_f32_16x16x32_bf16 v[88:91], v[144:147], v[204:207], v[88:91]
    ds_read_b128 v[200:203], v6 offset:53248
    v_mfma_f32_16x16x32_bf16 v[92:95], v[148:151], v[204:207], v[92:95]
    s_waitcnt vmcnt(12) lgkmcnt(7)
    v_mfma_f32_16x16x32_bf16 v[64:67], v[152:155], v[208:211], v[64:67]
    ds_read_b128 v[204:207], v6 offset:55296
    v_mfma_f32_16x16x32_bf16 v[68:71], v[156:159], v[208:211], v[68:71]
    buffer_load_dwordx4 v[144:147], v27, s[68:71], s19 offen offset:0 sc1
    s_waitcnt lgkmcnt(7)
    v_mfma_f32_16x16x32_bf16 v[72:75], v[152:155], v[212:215], v[72:75]
    ds_read_b128 v[208:211], v7 offset:49152
    v_mfma_f32_16x16x32_bf16 v[76:79], v[156:159], v[212:215], v[76:79]
    s_waitcnt lgkmcnt(7)
    v_mfma_f32_16x16x32_bf16 v[80:83], v[152:155], v[216:219], v[80:83]
    ds_read_b128 v[212:215], v7 offset:51200
    v_mfma_f32_16x16x32_bf16 v[84:87], v[156:159], v[216:219], v[84:87]
    buffer_load_dwordx4 v[148:151], v27, s[68:71], s19 offen offset:1024 sc1
    s_waitcnt lgkmcnt(7)
    v_mfma_f32_16x16x32_bf16 v[88:91], v[152:155], v[220:223], v[88:91]
    ds_read_b128 v[216:219], v7 offset:53248
    v_mfma_f32_16x16x32_bf16 v[92:95], v[156:159], v[220:223], v[92:95]
    s_waitcnt vmcnt(12) lgkmcnt(7)
    v_mfma_f32_16x16x32_bf16 v[64:67], v[160:163], v[192:195], v[64:67]
    ds_read_b128 v[220:223], v7 offset:55296
    v_mov_b32 v22, 21
    v_mfma_f32_16x16x32_bf16 v[68:71], v[164:167], v[192:195], v[68:71]
    buffer_load_dwordx4 v[152:155], v27, s[68:71], s19 offen offset:2048 sc1
    s_waitcnt lgkmcnt(7)
    v_mfma_f32_16x16x32_bf16 v[72:75], v[160:163], v[196:199], v[72:75]
    ds_read_b128 v[192:195], v6 offset:57344
    s_waitcnt lgkmcnt(7)
    v_min3_u32 v12, v12, v13, v14
    v_mfma_f32_16x16x32_bf16 v[76:79], v[164:167], v[196:199], v[76:79]
    ds_write_b32 v10, v22
    s_waitcnt lgkmcnt(7)
    v_mfma_f32_16x16x32_bf16 v[80:83], v[160:163], v[200:203], v[80:83]
    ds_read_b128 v[196:199], v6 offset:59392
    v_min_u32 v12, v12, v15
    v_mfma_f32_16x16x32_bf16 v[84:87], v[164:167], v[200:203], v[84:87]
    buffer_load_dwordx4 v[156:159], v27, s[68:71], s19 offen offset:3072 sc1
    s_waitcnt lgkmcnt(7)
    v_mfma_f32_16x16x32_bf16 v[88:91], v[160:163], v[204:207], v[88:91]
    ds_read_b128 v[200:203], v6 offset:61440
    s_bfe_u32 s19, s100, 20 + (4 << 16)
    v_mfma_f32_16x16x32_bf16 v[92:95], v[164:167], v[204:207], v[92:95]
    s_lshl_b32 s19, s19, 13
    s_waitcnt vmcnt(12) lgkmcnt(7)
    v_mfma_f32_16x16x32_bf16 v[64:67], v[168:171], v[208:211], v[64:67]
    ds_read_b128 v[204:207], v6 offset:63488
    v_cmp_gt_u32 vcc, 20, v12
    v_mfma_f32_16x16x32_bf16 v[68:71], v[172:175], v[208:211], v[68:71]
    buffer_load_dwordx4 v[160:163], v26, s[68:71], s19 offen offset:0 sc1
    s_waitcnt lgkmcnt(7)
    v_mfma_f32_16x16x32_bf16 v[72:75], v[168:171], v[212:215], v[72:75]
    ds_read_b128 v[208:211], v7 offset:57344
    s_cbranch_vccnz G2_slow3
G2_back3:
    v_mfma_f32_16x16x32_bf16 v[76:79], v[172:175], v[212:215], v[76:79]
    ds_write_b64 v0, v[224:225] offset:16384
    s_waitcnt lgkmcnt(8)
    v_mfma_f32_16x16x32_bf16 v[80:83], v[168:171], v[216:219], v[80:83]
    ds_read_b128 v[212:215], v7 offset:59392
    v_mfma_f32_16x16x32_bf16 v[84:87], v[172:175], v[216:219], v[84:87]
    buffer_load_dwordx4 v[164:167], v26, s[68:71], s19 offen offset:1024 sc1
    s_waitcnt lgkmcnt(8)
    v_mfma_f32_16x16x32_bf16 v[88:91], v[168:171], v[220:223], v[88:91]
    ds_read_b128 v[216:219], v7 offset:61440
    v_mfma_f32_16x16x32_bf16 v[92:95], v[172:175], v[220:223], v[92:95]
    ds_write_b64 v0, v[226:227] offset:16392
    s_waitcnt vmcnt(12) lgkmcnt(9)
    v_mfma_f32_16x16x32_bf16 v[64:67], v[176:179], v[192:195], v[64:67]
    ds_read_b128 v[220:223], v7 offset:63488
    ds_write_b64 v0, v[228:229] offset:17408
    v_mfma_f32_16x16x32_bf16 v[68:71], v[180:183], v[192:195], v[68:71]
    buffer_load_dwordx4 v[168:171], v26, s[68:71], s19 offen offset:2048 sc1
    s_waitcnt lgkmcnt(9)
    v_mfma_f32_16x16x32_bf16 v[72:75], v[176:179], v[196:199], v[72:75]
    ds_read_b128 v[192:195], v8 offset:0
    v_mfma_f32_16x16x32_bf16 v[76:79], v[180:183], v[196:199], v[76:79]
    ds_write_b64 v0, v[230:231] offset:17416
    s_waitcnt lgkmcnt(10)
    v_mfma_f32_16x16x32_bf16 v[80:83], v[176:179], v[200:203], v[80:83]
    ds_read_b128 v[196:199], v8 offset:2048
    ds_read_b128 v[12:15], v11
    v_mfma_f32_16x16x32_bf16 v[84:87], v[180:183], v[200:203], v[84:87]
    buffer_load_dwordx4 v[172:175], v26, s[68:71], s19 offen offset:3072 sc1
    s_waitcnt lgkmcnt(11)
    v_mfma_f32_16x16x32_bf16 v[88:91], v[176:179], v[204:207], v[88:91]
    ds_read_b128 v[200:203], v8 offset:4096
    v_mfma_f32_16x16x32_bf16 v[92:95], v[180:183], v[204:207], v[92:95]
    ds_write_b64 v0, v[232:233] offset:18432
    s_waitcnt vmcnt(12) lgkmcnt(12)
    v_mfma_f32_16x16x32_bf16 v[64:67], v[184:187], v[208:211], v[64:67]
    ds_read_b128 v[204:207], v8 offset:6144
    ds_write_b64 v0, v[234:235] offset:18440
    v_mfma_f32_16x16x32_bf16 v[68:71], v[188:191], v[208:211], v[68:71]
    buffer_load_dwordx4 v[176:179], v27, s[68:71], s19 offen offset:0 sc1
    s_waitcnt lgkmcnt(12)
    v_mfma_f32_16x16x32_bf16 v[72:75], v[184:187], v[212:215], v[72:75]
    ds_read_b128 v[208:211], v9 offset:0
    v_mfma_f32_16x16x32_bf16 v[76:79], v[188:191], v[212:215], v[76:79]
    ds_write_b64 v0, v[236:237] offset:19456
    s_waitcnt lgkmcnt(13)
    v_mfma_f32_16x16x32_bf16 v[80:83], v[184:187], v[216:219], v[80:83]
    ds_read_b128 v[212:215], v9 offset:2048
    v_mfma_f32_16x16x32_bf16 v[84:87], v[188:191], v[216:219], v[84:87]
    buffer_load_dwordx4 v[180:183], v27, s[68:71], s19 offen offset:1024 sc1
    s_waitcnt lgkmcnt(12)
    v_mfma_f32_16x16x32_bf16 v[88:91], v[184:187], v[220:223], v[88:91]
    ds_read_b128 v[216:219], v9 offset:4096
    v_mfma_f32_16x16x32_bf16 v[92:95], v[188:191], v[220:223], v[92:95]
    ds_write_b64 v0, v[238:239] offset:19464
    s_waitcnt vmcnt(12) lgkmcnt(12)
    v_mfma_f32_16x16x32_bf16 v[64:67], v[128:131], v[192:195], v[64:67]
    ds_read_b128 v[220:223], v9 offset:6144
    v_mov_b32 v22, 22
    v_mfma_f32_16x16x32_bf16 v[68:71], v[132:135], v[192:195], v[68:71]
    buffer_load_dwordx4 v[184:187], v27, s[68:71], s19 offen offset:2048 sc1
    s_waitcnt lgkmcnt(11)
    v_mfma_f32_16x16x32_bf16 v[72:75], v[128:131], v[196:199], v[72:75]
    ds_read_b128 v[192:195], v8 offset:8192
    s_waitcnt lgkmcnt(11)
    v_min3_u32 v12, v12, v13, v14
    v_mfma_f32_16x16x32_bf16 v[76:79], v[132:135], v[196:199], v[76:79]
    ds_write_b32 v10, v22
    s_waitcnt lgkmcnt(11)
    v_mfma_f32_16x16x32_bf16 v[80:83], v[128:131], v[200:203], v[80:83]
    ds_read_b128 v[196:199], v8 offset:10240
    v_min_u32 v12, v12, v15
    v_mfma_f32_16x16x32_bf16 v[84:87], v[132:135], v[200:203], v[84:87]
    buffer_load_dwordx4 v[188:191], v27, s[68:71], s19 offen offset:3072 sc1
    s_waitcnt lgkmcnt(10)
    v_mfma_f32_16x16x32_bf16 v[88:91], v[128:131], v[204:207], v[88:91]
    ds_read_b128 v[200:203], v8 offset:12288
    s_bfe_u32 s19, s100, 24 + (4 << 16)
    v_mfma_f32_16x16x32_bf16 v[92:95], v[132:135], v[204:207], v[92:95]
    s_lshl_b32 s19, s19, 13
    s_waitcnt vmcnt(12) lgkmcnt(9)
    v_mfma_f32_16x16x32_bf16 v[64:67], v[136:139], v[208:211], v[64:67]
    ds_read_b128 v[204:207], v8 offset:14336
    v_cmp_gt_u32 vcc, 21, v12
    v_mfma_f32_16x16x32_bf16 v[68:71], v[140:143], v[208:211], v[68:71]
    buffer_load_dwordx4 v[128:131], v26, s[68:71], s19 offen offset:0 sc1
    s_waitcnt lgkmcnt(8)
    v_mfma_f32_16x16x32_bf16 v[72:75], v[136:139], v[212:215], v[72:75]
    ds_read_b128 v[208:211], v9 offset:8192
    s_cbranch_vccnz G2_slow4
G2_back4:
    v_mfma_f32_16x16x32_bf16 v[76:79], v[140:143], v[212:215], v[76:79]
    ds_write_b64 v0, v[240:241] offset:32768
    s_waitcnt lgkmcnt(9)
    v_mfma_f32_16x16x32_bf16 v[80:83], v[136:139], v[216:219], v[80:83]
    ds_read_b128 v[212:215], v9 offset:10240
    v_mfma_f32_16x16x32_bf16 v[84:87], v[140:143], v[216:219], v[84:87]
    buffer_load_dwordx4 v[132:135], v26, s[68:71], s19 offen offset:1024 sc1
    s_waitcnt lgkmcnt(8)
    v_mfma_f32_16x16x32_bf16 v[88:91], v[136:139], v[220:223], v[88:91]
    ds_read_b128 v[216:219], v9 offset:12288
    v_mfma_f32_16x16x32_bf16 v[92:95], v[140:143], v[220:223], v[92:95]
    ds_write_b64 v0, v[242:243] offset:32776
    s_waitcnt vmcnt(12) lgkmcnt(9)
    v_mfma_f32_16x16x32_bf16 v[64:67], v[144:147], v[192:195], v[64:67]
    ds_read_b128 v[220:223], v9 offset:14336
    ds_write_b64 v0, v[244:245] offset:33792
    v_mfma_f32_16x16x32_bf16 v[68:71], v[148:151], v[192:195], v[68:71]
    buffer_load_dwordx4 v[136:139], v26, s[68:71], s19 offen offset:2048 sc1
    s_waitcnt lgkmcnt(9)
    v_mfma_f32_16x16x32_bf16 v[72:75], v[144:147], v[196:199], v[72:75]
    ds_read_b128 v[192:195], v8 offset:16384
    v_mfma_f32_16x16x32_bf16 v[76:79], v[148:151], v[196:199], v[76:79]
    ds_write_b64 v0, v[246:247] offset:33800
    s_waitcnt lgkmcnt(10)
    v_mfma_f32_16x16x32_bf16 v[80:83], v[144:147], v[200:203], v[80:83]
    ds_read_b128 v[196:199], v8 offset:18432
    ds_read_b128 v[12:15], v11
    v_mfma_f32_16x16x32_bf16 v[84:87], v[148:151], v[200:203], v[84:87]
    buffer_load_dwordx4 v[140:143], v26, s[68:71], s19 offen offset:3072 sc1
    s_waitcnt lgkmcnt(11)
    v_mfma_f32_16x16x32_bf16 v[88:91], v[144:147], v[204:207], v[88:91]
    ds_read_b128 v[200:203], v8 offset:20480
    v_mfma_f32_16x16x32_bf16 v[92:95], v[148:151], v[204:207], v[92:95]
    ds_write_b64 v0, v[248:249] offset:34816
    s_waitcnt vmcnt(12) lgkmcnt(12)
    v_mfma_f32_16x16x32_bf16 v[64:67], v[152:155], v[208:211], v[64:67]
    ds_read_b128 v[204:207], v8 offset:22528
    ds_write_b64 v0, v[250:251] offset:34824
    v_mfma_f32_16x16x32_bf16 v[68:71], v[156:159], v[208:211], v[68:71]
    buffer_load_dwordx4 v[144:147], v27, s[68:71], s19 offen offset:0 sc1
    s_waitcnt lgkmcnt(12)
    v_mfma_f32_16x16x32_bf16 v[72:75], v[152:155], v[212:215], v[72:75]
    ds_read_b128 v[208:211], v9 offset:16384
    v_mfma_f32_16x16x32_bf16 v[76:79], v[156:159], v[212:215], v[76:79]
    ds_write_b64 v0, v[252:253] offset:35840
    s_waitcnt lgkmcnt(13)
    v_mfma_f32_16x16x32_bf16 v[80:83], v[152:155], v[216:219], v[80:83]
    ds_read_b128 v[212:215], v9 offset:18432
    v_mfma_f32_16x16x32_bf16 v[84:87], v[156:159], v[216:219], v[84:87]
    buffer_load_dwordx4 v[148:151], v27, s[68:71], s19 offen offset:1024 sc1
    s_waitcnt lgkmcnt(12)
    v_mfma_f32_16x16x32_bf16 v[88:91], v[152:155], v[220:223], v[88:91]
    ds_read_b128 v[216:219], v9 offset:20480
    v_mfma_f32_16x16x32_bf16 v[92:95], v[156:159], v[220:223], v[92:95]
    ds_write_b64 v0, v[254:255] offset:35848
    s_waitcnt vmcnt(12) lgkmcnt(12)
    v_mfma_f32_16x16x32_bf16 v[64:67], v[160:163], v[192:195], v[64:67]
    ds_read_b128 v[220:223], v9 offset:22528
    v_mov_b32 v22, 23
    v_mfma_f32_16x16x32_bf16 v[68:71], v[164:167], v[192:195], v[68:71]
    buffer_load_dwordx4 v[152:155], v27, s[68:71], s19 offen offset:2048 sc1
    s_waitcnt lgkmcnt(11)
    v_mfma_f32_16x16x32_bf16 v[72:75], v[160:163], v[196:199], v[72:75]
    ds_read_b128 v[192:195], v8 offset:24576
    s_waitcnt lgkmcnt(11)
    v_min3_u32 v12, v12, v13, v14
    v_mfma_f32_16x16x32_bf16 v[76:79], v[164:167], v[196:199], v[76:79]
    ds_write_b32 v10, v22
    s_waitcnt lgkmcnt(11)
    v_mfma_f32_16x16x32_bf16 v[80:83], v[160:163], v[200:203], v[80:83]
    ds_read_b128 v[196:199], v8 offset:26624
    v_min_u32 v12, v12, v15
    v_mfma_f32_16x16x32_bf16 v[84:87], v[164:167], v[200:203], v[84:87]
    buffer_load_dwordx4 v[156:159], v27, s[68:71], s19 offen offset:3072 sc1
    s_waitcnt lgkmcnt(10)
    v_mfma_f32_16x16x32_bf16 v[88:91], v[160:163], v[204:207], v[88:91]
    ds_read_b128 v[200:203], v8 offset:28672
    s_bfe_u32 s19, s100, 28 + (4 << 16)
    v_mfma_f32_16x16x32_bf16 v[92:95], v[164:167], v[204:207], v[92:95]
    s_lshl_b32 s19, s19, 13
    s_waitcnt vmcnt(12) lgkmcnt(9)
    v_mfma_f32_16x16x32_bf16 v[64:67], v[168:171], v[208:211], v[64:67]
    ds_read_b128 v[204:207], v8 offset:30720
    v_cmp_gt_u32 vcc, 22, v12
    v_mfma_f32_16x16x32_bf16 v[68:71], v[172:175], v[208:211], v[68:71]
    buffer_load_dwordx4 v[160:163], v26, s[68:71], s19 offen offset:0 sc1
    s_waitcnt lgkmcnt(8)
    v_mfma_f32_16x16x32_bf16 v[72:75], v[168:171], v[212:215], v[72:75]
    ds_read_b128 v[208:211], v9 offset:24576
    s_cbranch_vccnz G2_slow5
G2_back5:
    v_mfma_f32_16x16x32_bf16 v[76:79], v[172:175], v[212:215], v[76:79]
    ds_write_b64 v0, v[48:49] offset:49152
    s_waitcnt lgkmcnt(9)
    v_mfma_f32_16x16x32_bf16 v[80:83], v[168:171], v[216:219], v[80:83]
    ds_read_b128 v[212:215], v9 offset:26624
    v_mfma_f32_16x16x32_bf16 v[84:87], v[172:175], v[216:219], v[84:87]
    buffer_load_dwordx4 v[164:167], v26, s[68:71], s19 offen offset:1024 sc1
    s_waitcnt lgkmcnt(8)
    v_mfma_f32_16x16x32_bf16 v[88:91], v[168:171], v[220:223], v[88:91]
    ds_read_b128 v[216:219], v9 offset:28672
    v_mfma_f32_16x16x32_bf16 v[92:95], v[172:175], v[220:223], v[92:95]
    ds_write_b64 v0, v[50:51] offset:49160
    s_waitcnt vmcnt(12) lgkmcnt(9)
    v_mfma_f32_16x16x32_bf16 v[64:67], v[176:179], v[192:195], v[64:67]
    ds_read_b128 v[220:223], v9 offset:30720
    ds_write_b64 v0, v[52:53] offset:50176
    v_mfma_f32_16x16x32_bf16 v[68:71], v[180:183], v[192:195], v[68:71]
    buffer_load_dwordx4 v[168:171], v26, s[68:71], s19 offen offset:2048 sc1
    s_waitcnt lgkmcnt(9)
    v_mfma_f32_16x16x32_bf16 v[72:75], v[176:179], v[196:199], v[72:75]
    ds_read_b128 v[192:195], v6 offset:0
    v_mfma_f32_16x16x32_bf16 v[76:79], v[180:183], v[196:199], v[76:79]
    ds_write_b64 v0, v[54:55] offset:50184
    s_waitcnt lgkmcnt(10)
    v_mfma_f32_16x16x32_bf16 v[80:83], v[176:179], v[200:203], v[80:83]
    ds_read_b128 v[196:199], v6 offset:2048
    ds_read_b128 v[12:15], v11
    v_mfma_f32_16x16x32_bf16 v[84:87], v[180:183], v[200:203], v[84:87]
    buffer_load_dwordx4 v[172:175], v26, s[68:71], s19 offen offset:3072 sc1
    s_waitcnt lgkmcnt(11)
    v_mfma_f32_16x16x32_bf16 v[88:91], v[176:179], v[204:207], v[88:91]
    ds_read_b128 v[200:203], v6 offset:4096
    v_mfma_f32_16x16x32_bf16 v[92:95], v[180:183], v[204:207], v[92:95]
    ds_write_b64 v0, v[56:57] offset:51200
    s_waitcnt vmcnt(12) lgkmcnt(12)
    v_mfma_f32_16x16x32_bf16 v[64:67], v[184:187], v[208:211], v[64:67]
    ds_read_b128 v[204:207], v6 offset:6144
    ds_write_b64 v0, v[58:59] offset:51208
    v_mfma_f32_16x16x32_bf16 v[68:71], v[188:191], v[208:211], v[68:71]
    buffer_load_dwordx4 v[176:179], v27, s[68:71], s19 offen offset:0 sc1
    s_waitcnt lgkmcnt(12)
    v_mfma_f32_16x16x32_bf16 v[72:75], v[184:187], v[212:215], v[72:75]
    ds_read_b128 v[208:211], v7 offset:0
    v_mfma_f32_16x16x32_bf16 v[76:79], v[188:191], v[212:215], v[76:79]
    ds_write_b64 v0, v[60:61] offset:52224
    s_waitcnt lgkmcnt(13)
    v_mfma_f32_16x16x32_bf16 v[80:83], v[184:187], v[216:219], v[80:83]
    ds_read_b128 v[212:215], v7 offset:2048
    v_mfma_f32_16x16x32_bf16 v[84:87], v[188:191], v[216:219], v[84:87]
    buffer_load_dwordx4 v[180:183], v27, s[68:71], s19 offen offset:1024 sc1
    s_waitcnt lgkmcnt(12)
    v_mfma_f32_16x16x32_bf16 v[88:91], v[184:187], v[220:223], v[88:91]
    ds_read_b128 v[216:219], v7 offset:4096
    v_mfma_f32_16x16x32_bf16 v[92:95], v[188:191], v[220:223], v[92:95]
    ds_write_b64 v0, v[62:63] offset:52232
    s_waitcnt vmcnt(12) lgkmcnt(12)
    v_mfma_f32_16x16x32_bf16 v[64:67], v[128:131], v[192:195], v[64:67]
    ds_read_b128 v[220:223], v7 offset:6144
    v_mov_b32 v22, 24
    v_mfma_f32_16x16x32_bf16 v[68:71], v[132:135], v[192:195], v[68:71]
    buffer_load_dwordx4 v[184:187], v27, s[68:71], s19 offen offset:2048 sc1
    s_waitcnt lgkmcnt(11)
    v_mfma_f32_16x16x32_bf16 v[72:75], v[128:131], v[196:199], v[72:75]
    ds_read_b128 v[192:195], v6 offset:8192
    s_waitcnt lgkmcnt(11)
    v_min3_u32 v12, v12, v13, v14
    v_mfma_f32_16x16x32_bf16 v[76:79], v[132:135], v[196:199], v[76:79]
    ds_write_b32 v10, v22
    s_waitcnt lgkmcnt(11)
    v_mfma_f32_16x16x32_bf16 v[80:83], v[128:131], v[200:203], v[80:83]
    ds_read_b128 v[196:199], v6 offset:10240
    v_min_u32 v12, v12, v15
    v_mfma_f32_16x16x32_bf16 v[84:87], v[132:135], v[200:203], v[84:87]
    buffer_load_dwordx4 v[188:191], v27, s[68:71], s19 offen offset:3072 sc1
    s_waitcnt lgkmcnt(10)
    v_mfma_f32_16x16x32_bf16 v[88:91], v[128:131], v[204:207], v[88:91]
    ds_read_b128 v[200:203], v6 offset:12288
    s_bfe_u32 s19, s101, 0 + (4 << 16)
    v_mfma_f32_16x16x32_bf16 v[92:95], v[132:135], v[204:207], v[92:95]
    s_lshl_b32 s19, s19, 13
    s_waitcnt vmcnt(12) lgkmcnt(9)
    v_mfma_f32_16x16x32_bf16 v[64:67], v[136:139], v[208:211], v[64:67]
    ds_read_b128 v[204:207], v6 offset:14336
    v_cmp_gt_u32 vcc, 23, v12
    v_mfma_f32_16x16x32_bf16 v[68:71], v[140:143], v[208:211], v[68:71]
    buffer_load_dwordx4 v[128:131], v26, s[68:71], s19 offen offset:0 sc1
    s_waitcnt lgkmcnt(8)
    v_mfma_f32_16x16x32_bf16 v[72:75], v[136:139], v[212:215], v[72:75]
    ds_read_b128 v[208:211], v7 offset:8192
    s_cbranch_vccnz G2_slow6
G2_back6:
    v_mfma_f32_16x16x32_bf16 v[76:79], v[140:143], v[212:215], v[76:79]
    ds_write_b64 v1, v[32:33] offset:0
    s_waitcnt lgkmcnt(9)
    v_mfma_f32_16x16x32_bf16 v[80:83], v[136:139], v[216:219], v[80:83]
    ds_read_b128 v[212:215], v7 offset:10240
    v_mfma_f32_16x16x32_bf16 v[84:87], v[140:143], v[216:219], v[84:87]
    buffer_load_dwordx4 v[132:135], v26, s[68:71], s19 offen offset:1024 sc1
    s_waitcnt lgkmcnt(8)
    v_mfma_f32_16x16x32_bf16 v[88:91], v[136:139], v[220:223], v[88:91]
    ds_read_b128 v[216:219], v7 offset:12288
    v_mfma_f32_16x16x32_bf16 v[92:95], v[140:143], v[220:223], v[92:95]
    ds_write_b64 v1, v[34:35] offset:8
    s_waitcnt vmcnt(12) lgkmcnt(9)
    v_mfma_f32_16x16x32_bf16 v[64:67], v[144:147], v[192:195], v[64:67]
    ds_read_b128 v[220:223], v7 offset:14336
    ds_write_b64 v1, v[36:37] offset:1024
    v_mfma_f32_16x16x32_bf16 v[68:71], v[148:151], v[192:195], v[68:71]
    buffer_load_dwordx4 v[136:139], v26, s[68:71], s19 offen offset:2048 sc1
    s_waitcnt lgkmcnt(9)
    v_mfma_f32_16x16x32_bf16 v[72:75], v[144:147], v[196:199], v[72:75]
    ds_read_b128 v[192:195], v6 offset:16384
    v_mfma_f32_16x16x32_bf16 v[76:79], v[148:151], v[196:199], v[76:79]
    ds_write_b64 v1, v[38:39] offset:1032
    s_waitcnt lgkmcnt(10)
    v_mfma_f32_16x16x32_bf16 v[80:83], v[144:147], v[200:203], v[80:83]
    ds_read_b128 v[196:199], v6 offset:18432
    ds_read_b128 v[12:15], v11
    v_mfma_f32_16x16x32_bf16 v[84:87], v[148:151], v[200:203], v[84:87]
    buffer_load_dwordx4 v[140:143], v26, s[68:71], s19 offen offset:3072 sc1
    s_waitcnt lgkmcnt(11)
    v_mfma_f32_16x16x32_bf16 v[88:91], v[144:147], v[204:207], v[88:91]
    ds_read_b128 v[200:203], v6 offset:20480
    v_mfma_f32_16x16x32_bf16 v[92:95], v[148:151], v[204:207], v[92:95]
    ds_write_b64 v1, v[40:41] offset:2048
    s_waitcnt vmcnt(12) lgkmcnt(12)
    v_mfma_f32_16x16x32_bf16 v[64:67], v[152:155], v[208:211], v[64:67]
    ds_read_b128 v[204:207], v6 offset:22528
    ds_write_b64 v1, v[42:43] offset:2056
    v_mfma_f32_16x16x32_bf16 v[68:71], v[156:159], v[208:211], v[68:71]
    buffer_load_dwordx4 v[144:147], v27, s[68:71], s19 offen offset:0 sc1
    s_waitcnt lgkmcnt(12)
    v_mfma_f32_16x16x32_bf16 v[72:75], v[152:155], v[212:215], v[72:75]
    ds_read_b128 v[208:211], v7 offset:16384
    v_mfma_f32_16x16x32_bf16 v[76:79], v[156:159], v[212:215], v[76:79]
    ds_write_b64 v1, v[44:45] offset:3072
    s_waitcnt lgkmcnt(13)
    v_mfma_f32_16x16x32_bf16 v[80:83], v[152:155], v[216:219], v[80:83]
    ds_read_b128 v[212:215], v7 offset:18432
    v_mfma_f32_16x16x32_bf16 v[84:87], v[156:159], v[216:219], v[84:87]
    buffer_load_dwordx4 v[148:151], v27, s[68:71], s19 offen offset:1024 sc1
    s_waitcnt lgkmcnt(12)
    v_mfma_f32_16x16x32_bf16 v[88:91], v[152:155], v[220:223], v[88:91]
    ds_read_b128 v[216:219], v7 offset:20480
    v_mfma_f32_16x16x32_bf16 v[92:95], v[156:159], v[220:223], v[92:95]
    ds_write_b64 v1, v[46:47] offset:3080
    s_waitcnt vmcnt(12) lgkmcnt(12)
    v_mfma_f32_16x16x32_bf16 v[64:67], v[160:163], v[192:195], v[64:67]
    ds_read_b128 v[220:223], v7 offset:22528
    v_mov_b32 v22, 25
    v_mfma_f32_16x16x32_bf16 v[68:71], v[164:167], v[192:195], v[68:71]
    buffer_load_dwordx4 v[152:155], v27, s[68:71], s19 offen offset:2048 sc1
    s_waitcnt lgkmcnt(11)
    v_mfma_f32_16x16x32_bf16 v[72:75], v[160:163], v[196:199], v[72:75]
    ds_read_b128 v[192:195], v6 offset:24576
    s_waitcnt lgkmcnt(11)
    v_min3_u32 v12, v12, v13, v14
    v_mfma_f32_16x16x32_bf16 v[76:79], v[164:167], v[196:199], v[76:79]
    ds_write_b32 v10, v22
    s_waitcnt lgkmcnt(11)
    v_mfma_f32_16x16x32_bf16 v[80:83], v[160:163], v[200:203], v[80:83]
    ds_read_b128 v[196:199], v6 offset:26624
    v_min_u32 v12, v12, v15
    v_mfma_f32_16x16x32_bf16 v[84:87], v[164:167], v[200:203], v[84:87]
    buffer_load_dwordx4 v[156:159], v27, s[68:71], s19 offen offset:3072 sc1
    s_waitcnt lgkmcnt(10)
    v_mfma_f32_16x16x32_bf16 v[88:91], v[160:163], v[204:207], v[88:91]
    ds_read_b128 v[200:203], v6 offset:28672
    s_bfe_u32 s19, s101, 4 + (4 << 16)
    v_mfma_f32_16x16x32_bf16 v[92:95], v[164:167], v[204:207], v[92:95]
    s_lshl_b32 s19, s19, 13
    s_waitcnt vmcnt(12) lgkmcnt(9)
    v_mfma_f32_16x16x32_bf16 v[64:67], v[168:171], v[208:211], v[64:67]
    ds_read_b128 v[204:207], v6 offset:30720
    v_cmp_gt_u32 vcc, 24, v12
    v_mfma_f32_16x16x32_bf16 v[68:71], v[172:175], v[208:211], v[68:71]
    buffer_load_dwordx4 v[160:163], v26, s[68:71], s19 offen offset:0 sc1
    s_waitcnt lgkmcnt(8)
    v_mfma_f32_16x16x32_bf16 v[72:75], v[168:171], v[212:215], v[72:75]
    ds_read_b128 v[208:211], v7 offset:24576
    s_cbranch_vccnz G2_slow7
G2_back7:
    v_mfma_f32_16x16x32_bf16 v[76:79], v[172:175], v[212:215], v[76:79]
    ds_write_b64 v1, v[96:97] offset:16384
    s_waitcnt lgkmcnt(9)
    v_mfma_f32_16x16x32_bf16 v[80:83], v[168:171], v[216:219], v[80:83]
    ds_read_b128 v[212:215], v7 offset:26624
    v_mfma_f32_16x16x32_bf16 v[84:87], v[172:175], v[216:219], v[84:87]
    buffer_load_dwordx4 v[164:167], v26, s[68:71], s19 offen offset:1024 sc1
    s_waitcnt lgkmcnt(8)
    v_mfma_f32_16x16x32_bf16 v[88:91], v[168:171], v[220:223], v[88:91]
    ds_read_b128 v[216:219], v7 offset:28672
    v_mfma_f32_16x16x32_bf16 v[92:95], v[172:175], v[220:223], v[92:95]
    ds_write_b64 v1, v[98:99] offset:16392
    s_waitcnt vmcnt(12) lgkmcnt(9)
    v_mfma_f32_16x16x32_bf16 v[64:67], v[176:179], v[192:195], v[64:67]
    ds_read_b128 v[220:223], v7 offset:30720
    ds_write_b64 v1, v[100:101] offset:17408
    v_mfma_f32_16x16x32_bf16 v[68:71], v[180:183], v[192:195], v[68:71]
    buffer_load_dwordx4 v[168:171], v26, s[68:71], s19 offen offset:2048 sc1
    s_waitcnt lgkmcnt(9)
    v_mfma_f32_16x16x32_bf16 v[72:75], v[176:179], v[196:199], v[72:75]
    ds_read_b128 v[192:195], v6 offset:32768
    v_mfma_f32_16x16x32_bf16 v[76:79], v[180:183], v[196:199], v[76:79]
    ds_write_b64 v1, v[102:103] offset:17416
    s_waitcnt lgkmcnt(10)
    v_mfma_f32_16x16x32_bf16 v[80:83], v[176:179], v[200:203], v[80:83]
    ds_read_b128 v[196:199], v6 offset:34816
    ds_read_b128 v[12:15], v11
    v_mfma_f32_16x16x32_bf16 v[84:87], v[180:183], v[200:203], v[84:87]
    buffer_load_dwordx4 v[172:175], v26, s[68:71], s19 offen offset:3072 sc1
    s_waitcnt lgkmcnt(11)
    v_mfma_f32_16x16x32_bf16 v[88:91], v[176:179], v[204:207], v[88:91]
    ds_read_b128 v[200:203], v6 offset:36864
    v_mfma_f32_16x16x32_bf16 v[92:95], v[180:183], v[204:207], v[92:95]
    ds_write_b64 v1, v[104:105] offset:18432
    s_waitcnt vmcnt(12) lgkmcnt(12)
    v_mfma_f32_16x16x32_bf16 v[64:67], v[184:187], v[208:211], v[64:67]
    ds_read_b128 v[204:207], v6 offset:38912
    ds_write_b64 v1, v[106:107] offset:18440
    v_mfma_f32_16x16x32_bf16 v[68:71], v[188:191], v[208:211], v[68:71]
    buffer_load_dwordx4 v[176:179], v27, s[68:71], s19 offen offset:0 sc1
    s_waitcnt lgkmcnt(12)
    v_mfma_f32_16x16x32_bf16 v[72:75], v[184:187], v[212:215], v[72:75]
    ds_read_b128 v[208:211], v7 offset:32768
    v_mfma_f32_16x16x32_bf16 v[76:79], v[188:191], v[212:215], v[76:79]
    ds_write_b64 v1, v[108:109] offset:19456
    s_waitcnt lgkmcnt(13)
    v_mfma_f32_16x16x32_bf16 v[80:83], v[184:187], v[216:219], v[80:83]
    ds_read_b128 v[212:215], v7 offset:34816
    v_mfma_f32_16x16x32_bf16 v[84:87], v[188:191], v[216:219], v[84:87]
    buffer_load_dwordx4 v[180:183], v27, s[68:71], s19 offen offset:1024 sc1
    s_waitcnt lgkmcnt(12)
    v_mfma_f32_16x16x32_bf16 v[88:91], v[184:187], v[220:223], v[88:91]
    ds_read_b128 v[216:219], v7 offset:36864
    v_mfma_f32_16x16x32_bf16 v[92:95], v[188:191], v[220:223], v[92:95]
    ds_write_b64 v1, v[110:111] offset:19464
    s_waitcnt vmcnt(12) lgkmcnt(12)
    v_mfma_f32_16x16x32_bf16 v[64:67], v[128:131], v[192:195], v[64:67]
    ds_read_b128 v[220:223], v7 offset:38912
    v_mfma_f32_16x16x32_bf16 v[68:71], v[132:135], v[192:195], v[68:71]
    buffer_load_dwordx4 v[184:187], v27, s[68:71], s19 offen offset:2048 sc1
    s_waitcnt lgkmcnt(11)
    v_mfma_f32_16x16x32_bf16 v[72:75], v[128:131], v[196:199], v[72:75]
    ds_read_b128 v[192:195], v6 offset:40960
    s_waitcnt lgkmcnt(11)
    v_min3_u32 v12, v12, v13, v14
    v_mfma_f32_16x16x32_bf16 v[76:79], v[132:135], v[196:199], v[76:79]
    s_waitcnt lgkmcnt(10)
    v_mfma_f32_16x16x32_bf16 v[80:83], v[128:131], v[200:203], v[80:83]
    ds_read_b128 v[196:199], v6 offset:43008
    v_min_u32 v12, v12, v15
    v_mfma_f32_16x16x32_bf16 v[84:87], v[132:135], v[200:203], v[84:87]
    buffer_load_dwordx4 v[188:191], v27, s[68:71], s19 offen offset:3072 sc1
    s_waitcnt lgkmcnt(9)
    v_mfma_f32_16x16x32_bf16 v[88:91], v[128:131], v[204:207], v[88:91]
    ds_read_b128 v[200:203], v6 offset:45056
    s_bfe_u32 s19, s101, 8 + (4 << 16)
    v_mfma_f32_16x16x32_bf16 v[92:95], v[132:135], v[204:207], v[92:95]
    s_lshl_b32 s19, s19, 13
    s_waitcnt vmcnt(12) lgkmcnt(8)
    v_mfma_f32_16x16x32_bf16 v[64:67], v[136:139], v[208:211], v[64:67]
    ds_read_b128 v[204:207], v6 offset:47104
    v_cmp_gt_u32 vcc, 25, v12
    v_mfma_f32_16x16x32_bf16 v[68:71], v[140:143], v[208:211], v[68:71]
    buffer_load_dwordx4 v[128:131], v26, s[68:71], s19 offen offset:0 sc1
    s_waitcnt lgkmcnt(7)
    v_mfma_f32_16x16x32_bf16 v[72:75], v[136:139], v[212:215], v[72:75]
    ds_read_b128 v[208:211], v7 offset:40960
    s_cbranch_vccnz G2_slow8
G2_back8:
    v_mfma_f32_16x16x32_bf16 v[76:79], v[140:143], v[212:215], v[76:79]
    ds_write_b64 v0, v[112:113] offset:0
    s_waitcnt lgkmcnt(8)
    v_mfma_f32_16x16x32_bf16 v[80:83], v[136:139], v[216:219], v[80:83]
    ds_read_b128 v[212:215], v7 offset:43008
    v_mfma_f32_16x16x32_bf16 v[84:87], v[140:143], v[216:219], v[84:87]
    buffer_load_dwordx4 v[132:135], v26, s[68:71], s19 offen offset:1024 sc1
    s_waitcnt lgkmcnt(7)
    v_mfma_f32_16x16x32_bf16 v[88:91], v[136:139], v[220:223], v[88:91]
    ds_read_b128 v[216:219], v7 offset:45056
    v_mfma_f32_16x16x32_bf16 v[92:95], v[140:143], v[220:223], v[92:95]
    ds_write_b64 v0, v[114:115] offset:8
    s_waitcnt vmcnt(12) lgkmcnt(8)
    v_mfma_f32_16x16x32_bf16 v[64:67], v[144:147], v[192:195], v[64:67]
    ds_read_b128 v[220:223], v7 offset:47104
    ds_write_b64 v0, v[116:117] offset:1024
    v_mfma_f32_16x16x32_bf16 v[68:71], v[148:151], v[192:195], v[68:71]
    buffer_load_dwordx4 v[136:139], v26, s[68:71], s19 offen offset:2048 sc1
    s_waitcnt lgkmcnt(9)
    v_mfma_f32_16x16x32_bf16 v[72:75], v[144:147], v[196:199], v[72:75]
    ds_read_b128 v[192:195], v6 offset:49152
    v_mfma_f32_16x16x32_bf16 v[76:79], v[148:151], v[196:199], v[76:79]
    ds_write_b64 v0, v[118:119] offset:1032
    s_waitcnt lgkmcnt(10)
    v_mfma_f32_16x16x32_bf16 v[80:83], v[144:147], v[200:203], v[80:83]
    ds_read_b128 v[196:199], v6 offset:51200
    v_mfma_f32_16x16x32_bf16 v[84:87], v[148:151], v[200:203], v[84:87]
    buffer_load_dwordx4 v[140:143], v26, s[68:71], s19 offen offset:3072 sc1
    s_waitcnt lgkmcnt(10)
    v_mfma_f32_16x16x32_bf16 v[88:91], v[144:147], v[204:207], v[88:91]
    ds_read_b128 v[200:203], v6 offset:53248
    v_mfma_f32_16x16x32_bf16 v[92:95], v[148:151], v[204:207], v[92:95]
    ds_write_b64 v0, v[120:121] offset:2048
    s_waitcnt vmcnt(12) lgkmcnt(11)
    v_mfma_f32_16x16x32_bf16 v[64:67], v[152:155], v[208:211], v[64:67]
    ds_read_b128 v[204:207], v6 offset:55296
    ds_write_b64 v0, v[122:123] offset:2056
    v_mfma_f32_16x16x32_bf16 v[68:71], v[156:159], v[208:211], v[68:71]
    buffer_load_dwordx4 v[144:147], v27, s[68:71], s19 offen offset:0 sc1
    s_waitcnt lgkmcnt(11)
    v_mfma_f32_16x16x32_bf16 v[72:75], v[152:155], v[212:215], v[72:75]
    ds_read_b128 v[208:211], v7 offset:49152
    v_mfma_f32_16x16x32_bf16 v[76:79], v[156:159], v[212:215], v[76:79]
    ds_write_b64 v0, v[124:125] offset:3072
    s_waitcnt lgkmcnt(12)
    v_mfma_f32_16x16x32_bf16 v[80:83], v[152:155], v[216:219], v[80:83]
    ds_read_b128 v[212:215], v7 offset:51200
    v_mfma_f32_16x16x32_bf16 v[84:87], v[156:159], v[216:219], v[84:87]
    buffer_load_dwordx4 v[148:151], v27, s[68:71], s19 offen offset:1024 sc1
    s_waitcnt lgkmcnt(11)
    v_mfma_f32_16x16x32_bf16 v[88:91], v[152:155], v[220:223], v[88:91]
    ds_read_b128 v[216:219], v7 offset:53248
    v_mfma_f32_16x16x32_bf16 v[92:95], v[156:159], v[220:223], v[92:95]
    ds_write_b64 v0, v[126:127] offset:3080
    s_waitcnt vmcnt(12) lgkmcnt(11)
    v_mfma_f32_16x16x32_bf16 v[64:67], v[160:163], v[192:195], v[64:67]
    ds_read_b128 v[220:223], v7 offset:55296
    v_mov_b32 v22, 27
    v_mfma_f32_16x16x32_bf16 v[68:71], v[164:167], v[192:195], v[68:71]
    buffer_load_dwordx4 v[152:155], v27, s[68:71], s19 offen offset:2048 sc1
    s_waitcnt lgkmcnt(10)
    v_mfma_f32_16x16x32_bf16 v[72:75], v[160:163], v[196:199], v[72:75]
    ds_read_b128 v[192:195], v6 offset:57344
    v_mfma_f32_16x16x32_bf16 v[76:79], v[164:167], v[196:199], v[76:79]
    ds_write_b32 v10, v22
    s_waitcnt lgkmcnt(11)
    v_mfma_f32_16x16x32_bf16 v[80:83], v[160:163], v[200:203], v[80:83]
    ds_read_b128 v[196:199], v6 offset:59392
    v_mfma_f32_16x16x32_bf16 v[84:87], v[164:167], v[200:203], v[84:87]
    buffer_load_dwordx4 v[156:159], v27, s[68:71], s19 offen offset:3072 sc1
    s_waitcnt lgkmcnt(10)
    v_mfma_f32_16x16x32_bf16 v[88:91], v[160:163], v[204:207], v[88:91]
    ds_read_b128 v[200:203], v6 offset:61440
    s_bfe_u32 s19, s101, 12 + (4 << 16)
    v_mfma_f32_16x16x32_bf16 v[92:95], v[164:167], v[204:207], v[92:95]
    s_lshl_b32 s19, s19, 13
    s_waitcnt vmcnt(12) lgkmcnt(9)
    v_mfma_f32_16x16x32_bf16 v[64:67], v[168:171], v[208:211], v[64:67]
    ds_read_b128 v[204:207], v6 offset:63488
    v_mfma_f32_16x16x32_bf16 v[68:71], v[172:175], v[208:211], v[68:71]
    buffer_load_dwordx4 v[160:163], v26, s[68:71], s19 offen offset:0 sc1
    s_waitcnt lgkmcnt(8)
    v_mfma_f32_16x16x32_bf16 v[72:75], v[168:171], v[212:215], v[72:75]
    ds_read_b128 v[208:211], v7 offset:57344
    v_mfma_f32_16x16x32_bf16 v[76:79], v[172:175], v[212:215], v[76:79]
    s_waitcnt lgkmcnt(8)
    v_mfma_f32_16x16x32_bf16 v[80:83], v[168:171], v[216:219], v[80:83]
    ds_read_b128 v[212:215], v7 offset:59392
    v_mfma_f32_16x16x32_bf16 v[84:87], v[172:175], v[216:219], v[84:87]
    buffer_load_dwordx4 v[164:167], v26, s[68:71], s19 offen offset:1024 sc1
    s_waitcnt lgkmcnt(7)
    v_mfma_f32_16x16x32_bf16 v[88:91], v[168:171], v[220:223], v[88:91]
    ds_read_b128 v[216:219], v7 offset:61440
    v_mfma_f32_16x16x32_bf16 v[92:95], v[172:175], v[220:223], v[92:95]
    s_waitcnt vmcnt(12) lgkmcnt(7)
    v_mfma_f32_16x16x32_bf16 v[64:67], v[176:179], v[192:195], v[64:67]
    ds_read_b128 v[220:223], v7 offset:63488
    v_mfma_f32_16x16x32_bf16 v[68:71], v[180:183], v[192:195], v[68:71]
    buffer_load_dwordx4 v[168:171], v26, s[68:71], s19 offen offset:2048 sc1
    s_waitcnt lgkmcnt(6)
    v_mfma_f32_16x16x32_bf16 v[72:75], v[176:179], v[196:199], v[72:75]
    ds_read_b128 v[192:195], v8 offset:0
    v_mfma_f32_16x16x32_bf16 v[76:79], v[180:183], v[196:199], v[76:79]
    s_waitcnt lgkmcnt(6)
    v_mfma_f32_16x16x32_bf16 v[80:83], v[176:179], v[200:203], v[80:83]
    ds_read_b128 v[196:199], v8 offset:2048
    ds_read_b128 v[12:15], v11
    v_mfma_f32_16x16x32_bf16 v[84:87], v[180:183], v[200:203], v[84:87]
    buffer_load_dwordx4 v[172:175], v26, s[68:71], s19 offen offset:3072 sc1
    s_waitcnt lgkmcnt(7)
    v_mfma_f32_16x16x32_bf16 v[88:91], v[176:179], v[204:207], v[88:91]
    ds_read_b128 v[200:203], v8 offset:4096
    v_mfma_f32_16x16x32_bf16 v[92:95], v[180:183], v[204:207], v[92:95]
    s_waitcnt vmcnt(12) lgkmcnt(7)
    v_mfma_f32_16x16x32_bf16 v[64:67], v[184:187], v[208:211], v[64:67]
    ds_read_b128 v[204:207], v8 offset:6144
    v_mfma_f32_16x16x32_bf16 v[68:71], v[188:191], v[208:211], v[68:71]
    buffer_load_dwordx4 v[176:179], v27, s[68:71], s19 offen offset:0 sc1
    s_waitcnt lgkmcnt(7)
    v_mfma_f32_16x16x32_bf16 v[72:75], v[184:187], v[212:215], v[72:75]
    ds_read_b128 v[208:211], v9 offset:0
    v_mfma_f32_16x16x32_bf16 v[76:79], v[188:191], v[212:215], v[76:79]
    s_waitcnt lgkmcnt(7)
    v_mfma_f32_16x16x32_bf16 v[80:83], v[184:187], v[216:219], v[80:83]
    ds_read_b128 v[212:215], v9 offset:2048
    v_mfma_f32_16x16x32_bf16 v[84:87], v[188:191], v[216:219], v[84:87]
    buffer_load_dwordx4 v[180:183], v27, s[68:71], s19 offen offset:1024 sc1
    s_waitcnt lgkmcnt(7)
    v_mfma_f32_16x16x32_bf16 v[88:91], v[184:187], v[220:223], v[88:91]
    ds_read_b128 v[216:219], v9 offset:4096
    v_mfma_f32_16x16x32_bf16 v[92:95], v[188:191], v[220:223], v[92:95]
    s_waitcnt vmcnt(12) lgkmcnt(7)
    v_mfma_f32_16x16x32_bf16 v[64:67], v[128:131], v[192:195], v[64:67]
    ds_read_b128 v[220:223], v9 offset:6144
    v_mfma_f32_16x16x32_bf16 v[68:71], v[132:135], v[192:195], v[68:71]
    buffer_load_dwordx4 v[184:187], v27, s[68:71], s19 offen offset:2048 sc1
    s_waitcnt lgkmcnt(7)
    v_mfma_f32_16x16x32_bf16 v[72:75], v[128:131], v[196:199], v[72:75]
    ds_read_b128 v[192:195], v8 offset:8192
    s_waitcnt lgkmcnt(7)
    v_min3_u32 v12, v12, v13, v14
    v_mfma_f32_16x16x32_bf16 v[76:79], v[132:135], v[196:199], v[76:79]
    s_waitcnt lgkmcnt(6)
    v_mfma_f32_16x16x32_bf16 v[80:83], v[128:131], v[200:203], v[80:83]
    ds_read_b128 v[196:199], v8 offset:10240
    v_min_u32 v12, v12, v15
    v_mfma_f32_16x16x32_bf16 v[84:87], v[132:135], v[200:203], v[84:87]
    buffer_load_dwordx4 v[188:191], v27, s[68:71], s19 offen offset:3072 sc1
    s_waitcnt lgkmcnt(6)
    v_mfma_f32_16x16x32_bf16 v[88:91], v[128:131], v[204:207], v[88:91]
    ds_read_b128 v[200:203], v8 offset:12288
    s_bfe_u32 s19, s101, 16 + (4 << 16)
    v_mfma_f32_16x16x32_bf16 v[92:95], v[132:135], v[204:207], v[92:95]
    s_lshl_b32 s19, s19, 13
    s_waitcnt vmcnt(12) lgkmcnt(6)
    v_mfma_f32_16x16x32_bf16 v[64:67], v[136:139], v[208:211], v[64:67]
    ds_read_b128 v[204:207], v8 offset:14336
    v_cmp_gt_u32 vcc, 27, v12
    v_mfma_f32_16x16x32_bf16 v[68:71], v[140:143], v[208:211], v[68:71]
    buffer_load_dwordx4 v[128:131], v26, s[68:71], s19 offen offset:0 sc1
    s_waitcnt lgkmcnt(6)
    v_mfma_f32_16x16x32_bf16 v[72:75], v[136:139], v[212:215], v[72:75]
    ds_read_b128 v[208:211], v9 offset:8192
    s_cbranch_vccnz G2_slow10
G2_back10:
    v_mfma_f32_16x16x32_bf16 v[76:79], v[140:143], v[212:215], v[76:79]
    s_waitcnt lgkmcnt(6)
    v_mfma_f32_16x16x32_bf16 v[80:83], v[136:139], v[216:219], v[80:83]
    ds_read_b128 v[212:215], v9 offset:10240
    v_mfma_f32_16x16x32_bf16 v[84:87], v[140:143], v[216:219], v[84:87]
    buffer_load_dwordx4 v[132:135], v26, s[68:71], s19 offen offset:1024 sc1
    s_waitcnt lgkmcnt(6)
    v_mfma_f32_16x16x32_bf16 v[88:91], v[136:139], v[220:223], v[88:91]
    ds_read_b128 v[216:219], v9 offset:12288
    v_mfma_f32_16x16x32_bf16 v[92:95], v[140:143], v[220:223], v[92:95]
    s_waitcnt vmcnt(12) lgkmcnt(6)
    v_mfma_f32_16x16x32_bf16 v[64:67], v[144:147], v[192:195], v[64:67]
    ds_read_b128 v[220:223], v9 offset:14336
    v_mfma_f32_16x16x32_bf16 v[68:71], v[148:151], v[192:195], v[68:71]
    buffer_load_dwordx4 v[136:139], v26, s[68:71], s19 offen offset:2048 sc1
    s_waitcnt lgkmcnt(6)
    v_mfma_f32_16x16x32_bf16 v[72:75], v[144:147], v[196:199], v[72:75]
    ds_read_b128 v[192:195], v8 offset:16384
    v_mfma_f32_16x16x32_bf16 v[76:79], v[148:151], v[196:199], v[76:79]
    s_waitcnt lgkmcnt(6)
    v_mfma_f32_16x16x32_bf16 v[80:83], v[144:147], v[200:203], v[80:83]
    ds_read_b128 v[196:199], v8 offset:18432
    v_mfma_f32_16x16x32_bf16 v[84:87], v[148:151], v[200:203], v[84:87]
    buffer_load_dwordx4 v[140:143], v26, s[68:71], s19 offen offset:3072 sc1
    s_waitcnt lgkmcnt(6)
    v_mfma_f32_16x16x32_bf16 v[88:91], v[144:147], v[204:207], v[88:91]
    ds_read_b128 v[200:203], v8 offset:20480
    v_mfma_f32_16x16x32_bf16 v[92:95], v[148:151], v[204:207], v[92:95]
    s_waitcnt vmcnt(12) lgkmcnt(6)
    v_mfma_f32_16x16x32_bf16 v[64:67], v[152:155], v[208:211], v[64:67]
    ds_read_b128 v[204:207], v8 offset:22528
    v_mfma_f32_16x16x32_bf16 v[68:71], v[156:159], v[208:211], v[68:71]
    buffer_load_dwordx4 v[144:147], v27, s[68:71], s19 offen offset:0 sc1
    s_waitcnt lgkmcnt(6)
    v_mfma_f32_16x16x32_bf16 v[72:75], v[152:155], v[212:215], v[72:75]
    ds_read_b128 v[208:211], v9 offset:16384
    v_mfma_f32_16x16x32_bf16 v[76:79], v[156:159], v[212:215], v[76:79]
    s_waitcnt lgkmcnt(6)
    v_mfma_f32_16x16x32_bf16 v[80:83], v[152:155], v[216:219], v[80:83]
    ds_read_b128 v[212:215], v9 offset:18432
    v_mfma_f32_16x16x32_bf16 v[84:87], v[156:159], v[216:219], v[84:87]
    buffer_load_dwordx4 v[148:151], v27, s[68:71], s19 offen offset:1024 sc1
    s_waitcnt lgkmcnt(6)
    v_mfma_f32_16x16x32_bf16 v[88:91], v[152:155], v[220:223], v[88:91]
    ds_read_b128 v[216:219], v9 offset:20480
    v_mfma_f32_16x16x32_bf16 v[92:95], v[156:159], v[220:223], v[92:95]
    s_waitcnt vmcnt(12) lgkmcnt(6)
    v_mfma_f32_16x16x32_bf16 v[64:67], v[160:163], v[192:195], v[64:67]
    ds_read_b128 v[220:223], v9 offset:22528
    v_mfma_f32_16x16x32_bf16 v[68:71], v[164:167], v[192:195], v[68:71]
    buffer_load_dwordx4 v[152:155], v27, s[68:71], s19 offen offset:2048 sc1
    s_waitcnt lgkmcnt(6)
    v_mfma_f32_16x16x32_bf16 v[72:75], v[160:163], v[196:199], v[72:75]
    ds_read_b128 v[192:195], v8 offset:24576
    v_mfma_f32_16x16x32_bf16 v[76:79], v[164:167], v[196:199], v[76:79]
    s_waitcnt lgkmcnt(6)
    v_mfma_f32_16x16x32_bf16 v[80:83], v[160:163], v[200:203], v[80:83]
    ds_read_b128 v[196:199], v8 offset:26624
    v_mfma_f32_16x16x32_bf16 v[84:87], v[164:167], v[200:203], v[84:87]
    buffer_load_dwordx4 v[156:159], v27, s[68:71], s19 offen offset:3072 sc1
    s_waitcnt lgkmcnt(6)
    v_mfma_f32_16x16x32_bf16 v[88:91], v[160:163], v[204:207], v[88:91]
    ds_read_b128 v[200:203], v8 offset:28672
    s_bfe_u32 s19, s101, 20 + (4 << 16)
    v_mfma_f32_16x16x32_bf16 v[92:95], v[164:167], v[204:207], v[92:95]
    s_lshl_b32 s19, s19, 13
    s_waitcnt vmcnt(12) lgkmcnt(6)
    v_mfma_f32_16x16x32_bf16 v[64:67], v[168:171], v[208:211], v[64:67]
    ds_read_b128 v[204:207], v8 offset:30720
    v_mfma_f32_16x16x32_bf16 v[68:71], v[172:175], v[208:211], v[68:71]
    buffer_load_dwordx4 v[160:163], v26, s[68:71], s19 offen offset:0 sc1
    s_waitcnt lgkmcnt(6)
    v_mfma_f32_16x16x32_bf16 v[72:75], v[168:171], v[212:215], v[72:75]
    ds_read_b128 v[208:211], v9 offset:24576
    v_mfma_f32_16x16x32_bf16 v[76:79], v[172:175], v[212:215], v[76:79]
    s_waitcnt lgkmcnt(6)
    v_mfma_f32_16x16x32_bf16 v[80:83], v[168:171], v[216:219], v[80:83]
    ds_read_b128 v[212:215], v9 offset:26624
    v_mfma_f32_16x16x32_bf16 v[84:87], v[172:175], v[216:219], v[84:87]
    buffer_load_dwordx4 v[164:167], v26, s[68:71], s19 offen offset:1024 sc1
    s_waitcnt lgkmcnt(6)
    v_mfma_f32_16x16x32_bf16 v[88:91], v[168:171], v[220:223], v[88:91]
    ds_read_b128 v[216:219], v9 offset:28672
    v_mfma_f32_16x16x32_bf16 v[92:95], v[172:175], v[220:223], v[92:95]
    s_waitcnt vmcnt(12) lgkmcnt(6)
    v_mfma_f32_16x16x32_bf16 v[64:67], v[176:179], v[192:195], v[64:67]
    ds_read_b128 v[220:223], v9 offset:30720
    v_mfma_f32_16x16x32_bf16 v[68:71], v[180:183], v[192:195], v[68:71]
    buffer_load_dwordx4 v[168:171], v26, s[68:71], s19 offen offset:2048 sc1
    s_waitcnt lgkmcnt(6)
    v_mfma_f32_16x16x32_bf16 v[72:75], v[176:179], v[196:199], v[72:75]
    ds_read_b128 v[192:195], v6 offset:0
    v_mfma_f32_16x16x32_bf16 v[76:79], v[180:183], v[196:199], v[76:79]
    s_waitcnt lgkmcnt(6)
    v_mfma_f32_16x16x32_bf16 v[80:83], v[176:179], v[200:203], v[80:83]
    ds_read_b128 v[196:199], v6 offset:2048
    v_mfma_f32_16x16x32_bf16 v[84:87], v[180:183], v[200:203], v[84:87]
    buffer_load_dwordx4 v[172:175], v26, s[68:71], s19 offen offset:3072 sc1
    s_waitcnt lgkmcnt(6)
    v_mfma_f32_16x16x32_bf16 v[88:91], v[176:179], v[204:207], v[88:91]
    ds_read_b128 v[200:203], v6 offset:4096
    v_mfma_f32_16x16x32_bf16 v[92:95], v[180:183], v[204:207], v[92:95]
    s_waitcnt vmcnt(12) lgkmcnt(6)
    v_mfma_f32_16x16x32_bf16 v[64:67], v[184:187], v[208:211], v[64:67]
    ds_read_b128 v[204:207], v6 offset:6144
    v_mfma_f32_16x16x32_bf16 v[68:71], v[188:191], v[208:211], v[68:71]
    buffer_load_dwordx4 v[176:179], v27, s[68:71], s19 offen offset:0 sc1
    s_waitcnt lgkmcnt(6)
    v_mfma_f32_16x16x32_bf16 v[72:75], v[184:187], v[212:215], v[72:75]
    ds_read_b128 v[208:211], v7 offset:0
    ds_read_b32 v18, v11 offset:68
    v_mfma_f32_16x16x32_bf16 v[76:79], v[188:191], v[212:215], v[76:79]
    s_waitcnt lgkmcnt(7)
    v_mfma_f32_16x16x32_bf16 v[80:83], v[184:187], v[216:219], v[80:83]
    ds_read_b128 v[212:215], v7 offset:2048
    v_mfma_f32_16x16x32_bf16 v[84:87], v[188:191], v[216:219], v[84:87]
    buffer_load_dwordx4 v[180:183], v27, s[68:71], s19 offen offset:1024 sc1
    s_waitcnt lgkmcnt(7)
    v_mfma_f32_16x16x32_bf16 v[88:91], v[184:187], v[220:223], v[88:91]
    ds_read_b128 v[216:219], v7 offset:4096
    v_mfma_f32_16x16x32_bf16 v[92:95], v[188:191], v[220:223], v[92:95]
    s_waitcnt vmcnt(12) lgkmcnt(7)
    v_mfma_f32_16x16x32_bf16 v[64:67], v[128:131], v[192:195], v[64:67]
    ds_read_b128 v[220:223], v7 offset:6144
    v_mfma_f32_16x16x32_bf16 v[68:71], v[132:135], v[192:195], v[68:71]
    buffer_load_dwordx4 v[184:187], v27, s[68:71], s19 offen offset:2048 sc1
    s_waitcnt lgkmcnt(7)
    v_mfma_f32_16x16x32_bf16 v[72:75], v[128:131], v[196:199], v[72:75]
    ds_read_b128 v[192:195], v6 offset:8192
    v_mfma_f32_16x16x32_bf16 v[76:79], v[132:135], v[196:199], v[76:79]
    s_waitcnt lgkmcnt(7)
    v_mfma_f32_16x16x32_bf16 v[80:83], v[128:131], v[200:203], v[80:83]
    ds_read_b128 v[196:199], v6 offset:10240
    v_add_u32 v8, 32768, v8
    v_mfma_f32_16x16x32_bf16 v[84:87], v[132:135], v[200:203], v[84:87]
    buffer_load_dwordx4 v[188:191], v27, s[68:71], s19 offen offset:3072 sc1
    s_waitcnt lgkmcnt(7)
    v_mfma_f32_16x16x32_bf16 v[88:91], v[128:131], v[204:207], v[88:91]
    ds_read_b128 v[200:203], v6 offset:12288
    s_bfe_u32 s19, s101, 24 + (4 << 16)
    v_mfma_f32_16x16x32_bf16 v[92:95], v[132:135], v[204:207], v[92:95]
    s_lshl_b32 s19, s19, 13
    s_waitcnt vmcnt(12) lgkmcnt(7)
    v_mfma_f32_16x16x32_bf16 v[64:67], v[136:139], v[208:211], v[64:67]
    ds_read_b128 v[204:207], v6 offset:14336
    v_add_u32 v9, 32768, v9
    v_mfma_f32_16x16x32_bf16 v[68:71], v[140:143], v[208:211], v[68:71]
    buffer_load_dwordx4 v[128:131], v26, s[68:71], s19 offen offset:0 sc1
    s_waitcnt lgkmcnt(6)
    v_mfma_f32_16x16x32_bf16 v[72:75], v[136:139], v[212:215], v[72:75]
    ds_read_b128 v[208:211], v7 offset:8192
    v_cmp_gt_u32 vcc, 4, v18
    v_mfma_f32_16x16x32_bf16 v[76:79], v[140:143], v[212:215], v[76:79]
    s_waitcnt lgkmcnt(6)
    v_mfma_f32_16x16x32_bf16 v[80:83], v[136:139], v[216:219], v[80:83]
    ds_read_b128 v[212:215], v7 offset:10240
    v_mfma_f32_16x16x32_bf16 v[84:87], v[140:143], v[216:219], v[84:87]
    buffer_load_dwordx4 v[132:135], v26, s[68:71], s19 offen offset:1024 sc1
    s_waitcnt lgkmcnt(6)
    v_mfma_f32_16x16x32_bf16 v[88:91], v[136:139], v[220:223], v[88:91]
    ds_read_b128 v[216:219], v7 offset:12288
    s_cbranch_vccnz G2_slowc
G2_backc:
    v_mfma_f32_16x16x32_bf16 v[92:95], v[140:143], v[220:223], v[92:95]
    s_waitcnt vmcnt(12) lgkmcnt(6)
    v_mfma_f32_16x16x32_bf16 v[64:67], v[144:147], v[192:195], v[64:67]
    ds_read_b128 v[220:223], v7 offset:14336
    v_mfma_f32_16x16x32_bf16 v[68:71], v[148:151], v[192:195], v[68:71]
    buffer_load_dwordx4 v[136:139], v26, s[68:71], s19 offen offset:2048 sc1
    s_waitcnt lgkmcnt(6)
    v_mfma_f32_16x16x32_bf16 v[72:75], v[144:147], v[196:199], v[72:75]
    ds_read_b128 v[192:195], v8 offset:0
    v_mfma_f32_16x16x32_bf16 v[76:79], v[148:151], v[196:199], v[76:79]
    s_waitcnt lgkmcnt(6)
    v_mfma_f32_16x16x32_bf16 v[80:83], v[144:147], v[200:203], v[80:83]
    ds_read_b128 v[196:199], v8 offset:2048
    v_mfma_f32_16x16x32_bf16 v[84:87], v[148:151], v[200:203], v[84:87]
    buffer_load_dwordx4 v[140:143], v26, s[68:71], s19 offen offset:3072 sc1
    s_waitcnt lgkmcnt(6)
    v_mfma_f32_16x16x32_bf16 v[88:91], v[144:147], v[204:207], v[88:91]
    ds_read_b128 v[200:203], v8 offset:25856
    v_mfma_f32_16x16x32_bf16 v[92:95], v[148:151], v[204:207], v[92:95]
    s_waitcnt vmcnt(12) lgkmcnt(6)
    v_mfma_f32_16x16x32_bf16 v[64:67], v[152:155], v[208:211], v[64:67]
    ds_read_b128 v[204:207], v8 offset:27904
    v_mfma_f32_16x16x32_bf16 v[68:71], v[156:159], v[208:211], v[68:71]
    buffer_load_dwordx4 v[144:147], v27, s[68:71], s19 offen offset:0 sc1
    s_waitcnt lgkmcnt(6)
    v_mfma_f32_16x16x32_bf16 v[72:75], v[152:155], v[212:215], v[72:75]
    ds_read_b128 v[208:211], v9 offset:0
    v_mfma_f32_16x16x32_bf16 v[76:79], v[156:159], v[212:215], v[76:79]
    s_waitcnt lgkmcnt(6)
    v_mfma_f32_16x16x32_bf16 v[80:83], v[152:155], v[216:219], v[80:83]
    ds_read_b128 v[212:215], v9 offset:2048
    v_mfma_f32_16x16x32_bf16 v[84:87], v[156:159], v[216:219], v[84:87]
    buffer_load_dwordx4 v[148:151], v27, s[68:71], s19 offen offset:1024 sc1
    s_waitcnt lgkmcnt(6)
    v_mfma_f32_16x16x32_bf16 v[88:91], v[152:155], v[220:223], v[88:91]
    ds_read_b128 v[216:219], v9 offset:25856
    v_mfma_f32_16x16x32_bf16 v[92:95], v[156:159], v[220:223], v[92:95]
    s_waitcnt vmcnt(12) lgkmcnt(6)
    v_mfma_f32_16x16x32_bf16 v[64:67], v[160:163], v[192:195], v[64:67]
    ds_read_b128 v[220:223], v9 offset:27904
    v_mfma_f32_16x16x32_bf16 v[68:71], v[164:167], v[192:195], v[68:71]
    buffer_load_dwordx4 v[152:155], v27, s[68:71], s19 offen offset:2048 sc1
    s_waitcnt lgkmcnt(6)
    v_mfma_f32_16x16x32_bf16 v[72:75], v[160:163], v[196:199], v[72:75]
    ds_read_b128 v[192:195], v8 offset:12928
    v_mfma_f32_16x16x32_bf16 v[76:79], v[164:167], v[196:199], v[76:79]
    s_waitcnt lgkmcnt(6)
    v_mfma_f32_16x16x32_bf16 v[80:83], v[160:163], v[200:203], v[80:83]
    ds_read_b128 v[196:199], v8 offset:14976
    v_mfma_f32_16x16x32_bf16 v[84:87], v[164:167], v[200:203], v[84:87]
    buffer_load_dwordx4 v[156:159], v27, s[68:71], s19 offen offset:3072 sc1
    s_waitcnt lgkmcnt(6)
    v_mfma_f32_16x16x32_bf16 v[88:91], v[160:163], v[204:207], v[88:91]
    ds_read_b128 v[200:203], v8 offset:38784
    s_bfe_u32 s19, s101, 28 + (4 << 16)
    v_mfma_f32_16x16x32_bf16 v[92:95], v[164:167], v[204:207], v[92:95]
    s_lshl_b32 s19, s19, 13
    s_waitcnt vmcnt(12) lgkmcnt(6)
    v_mfma_f32_16x16x32_bf16 v[64:67], v[168:171], v[208:211], v[64:67]
    ds_read_b128 v[204:207], v8 offset:40832
    v_mfma_f32_16x16x32_bf16 v[68:71], v[172:175], v[208:211], v[68:71]
    buffer_load_dwordx4 v[160:163], v26, s[68:71], s19 offen offset:0 sc1
    s_waitcnt lgkmcnt(6)
    v_mfma_f32_16x16x32_bf16 v[72:75], v[168:171], v[212:215], v[72:75]
    ds_read_b128 v[208:211], v9 offset:12928
    v_mfma_f32_16x16x32_bf16 v[76:79], v[172:175], v[212:215], v[76:79]
    s_waitcnt lgkmcnt(6)
    v_mfma_f32_16x16x32_bf16 v[80:83], v[168:171], v[216:219], v[80:83]
    ds_read_b128 v[212:215], v9 offset:14976
    v_mfma_f32_16x16x32_bf16 v[84:87], v[172:175], v[216:219], v[84:87]
    buffer_load_dwordx4 v[164:167], v26, s[68:71], s19 offen offset:1024 sc1
    s_waitcnt lgkmcnt(6)
    v_mfma_f32_16x16x32_bf16 v[88:91], v[168:171], v[220:223], v[88:91]
    ds_read_b128 v[216:219], v9 offset:38784
    v_mfma_f32_16x16x32_bf16 v[92:95], v[172:175], v[220:223], v[92:95]
    s_waitcnt vmcnt(12) lgkmcnt(6)
    v_mfma_f32_16x16x32_bf16 v[64:67], v[176:179], v[192:195], v[64:67]
    ds_read_b128 v[220:223], v9 offset:40832
    v_mfma_f32_16x16x32_bf16 v[68:71], v[180:183], v[192:195], v[68:71]
    buffer_load_dwordx4 v[168:171], v26, s[68:71], s19 offen offset:2048 sc1
    s_waitcnt lgkmcnt(6)
    v_mfma_f32_16x16x32_bf16 v[72:75], v[176:179], v[196:199], v[72:75]
    ds_read_b128 v[192:195], v8 offset:4096
    v_mfma_f32_16x16x32_bf16 v[76:79], v[180:183], v[196:199], v[76:79]
    s_waitcnt lgkmcnt(6)
    v_mfma_f32_16x16x32_bf16 v[80:83], v[176:179], v[200:203], v[80:83]
    ds_read_b128 v[196:199], v8 offset:6144
    v_mfma_f32_16x16x32_bf16 v[84:87], v[180:183], v[200:203], v[84:87]
    buffer_load_dwordx4 v[172:175], v26, s[68:71], s19 offen offset:3072 sc1
    s_waitcnt lgkmcnt(6)
    v_mfma_f32_16x16x32_bf16 v[88:91], v[176:179], v[204:207], v[88:91]
    ds_read_b128 v[200:203], v8 offset:29952
    v_mfma_f32_16x16x32_bf16 v[92:95], v[180:183], v[204:207], v[92:95]
    s_waitcnt vmcnt(12) lgkmcnt(6)
    v_mfma_f32_16x16x32_bf16 v[64:67], v[184:187], v[208:211], v[64:67]
    ds_read_b128 v[204:207], v8 offset:32000
    v_mfma_f32_16x16x32_bf16 v[68:71], v[188:191], v[208:211], v[68:71]
    buffer_load_dwordx4 v[176:179], v27, s[68:71], s19 offen offset:0 sc1
    s_waitcnt lgkmcnt(6)
    v_mfma_f32_16x16x32_bf16 v[72:75], v[184:187], v[212:215], v[72:75]
    ds_read_b128 v[208:211], v9 offset:4096
    v_mfma_f32_16x16x32_bf16 v[76:79], v[188:191], v[212:215], v[76:79]
    s_waitcnt lgkmcnt(6)
    v_mfma_f32_16x16x32_bf16 v[80:83], v[184:187], v[216:219], v[80:83]
    ds_read_b128 v[212:215], v9 offset:6144
    v_mfma_f32_16x16x32_bf16 v[84:87], v[188:191], v[216:219], v[84:87]
    buffer_load_dwordx4 v[180:183], v27, s[68:71], s19 offen offset:1024 sc1
    s_waitcnt lgkmcnt(6)
    v_mfma_f32_16x16x32_bf16 v[88:91], v[184:187], v[220:223], v[88:91]
    ds_read_b128 v[216:219], v9 offset:29952
    v_mfma_f32_16x16x32_bf16 v[92:95], v[188:191], v[220:223], v[92:95]
    s_waitcnt vmcnt(12) lgkmcnt(6)
    v_mfma_f32_16x16x32_bf16 v[64:67], v[128:131], v[192:195], v[64:67]
    ds_read_b128 v[220:223], v9 offset:32000
    v_mfma_f32_16x16x32_bf16 v[68:71], v[132:135], v[192:195], v[68:71]
    buffer_load_dwordx4 v[184:187], v27, s[68:71], s19 offen offset:2048 sc1
    s_waitcnt lgkmcnt(6)
    v_mfma_f32_16x16x32_bf16 v[72:75], v[128:131], v[196:199], v[72:75]
    ds_read_b128 v[192:195], v8 offset:17024
    v_mfma_f32_16x16x32_bf16 v[76:79], v[132:135], v[196:199], v[76:79]
    s_waitcnt lgkmcnt(6)
    v_mfma_f32_16x16x32_bf16 v[80:83], v[128:131], v[200:203], v[80:83]
    ds_read_b128 v[196:199], v8 offset:19072
    v_mfma_f32_16x16x32_bf16 v[84:87], v[132:135], v[200:203], v[84:87]
    buffer_load_dwordx4 v[188:191], v27, s[68:71], s19 offen offset:3072 sc1
    s_waitcnt lgkmcnt(6)
    v_mfma_f32_16x16x32_bf16 v[88:91], v[128:131], v[204:207], v[88:91]
    ds_read_b128 v[200:203], v8 offset:42880
    v_mfma_f32_16x16x32_bf16 v[92:95], v[132:135], v[204:207], v[92:95]
    s_waitcnt vmcnt(12) lgkmcnt(6)
    v_mfma_f32_16x16x32_bf16 v[64:67], v[136:139], v[208:211], v[64:67]
    ds_read_b128 v[204:207], v8 offset:44928
    v_mfma_f32_16x16x32_bf16 v[68:71], v[140:143], v[208:211], v[68:71]
    s_waitcnt lgkmcnt(6)
    v_mfma_f32_16x16x32_bf16 v[72:75], v[136:139], v[212:215], v[72:75]
    ds_read_b128 v[208:211], v9 offset:17024
    v_mfma_f32_16x16x32_bf16 v[76:79], v[140:143], v[212:215], v[76:79]
    s_waitcnt lgkmcnt(6)
    v_mfma_f32_16x16x32_bf16 v[80:83], v[136:139], v[216:219], v[80:83]
    ds_read_b128 v[212:215], v9 offset:19072
    v_mfma_f32_16x16x32_bf16 v[84:87], v[140:143], v[216:219], v[84:87]
    s_waitcnt lgkmcnt(6)
    v_mfma_f32_16x16x32_bf16 v[88:91], v[136:139], v[220:223], v[88:91]
    ds_read_b128 v[216:219], v9 offset:42880
    v_mfma_f32_16x16x32_bf16 v[92:95], v[140:143], v[220:223], v[92:95]
    s_waitcnt vmcnt(10) lgkmcnt(6)
    v_mfma_f32_16x16x32_bf16 v[64:67], v[144:147], v[192:195], v[64:67]
    ds_read_b128 v[220:223], v9 offset:44928
    v_mfma_f32_16x16x32_bf16 v[68:71], v[148:151], v[192:195], v[68:71]
    s_waitcnt lgkmcnt(6)
    v_mfma_f32_16x16x32_bf16 v[72:75], v[144:147], v[196:199], v[72:75]
    ds_read_b128 v[192:195], v8 offset:8192
    v_mfma_f32_16x16x32_bf16 v[76:79], v[148:151], v[196:199], v[76:79]
    s_waitcnt lgkmcnt(6)
    v_mfma_f32_16x16x32_bf16 v[80:83], v[144:147], v[200:203], v[80:83]
    ds_read_b128 v[196:199], v8 offset:10240
    v_mfma_f32_16x16x32_bf16 v[84:87], v[148:151], v[200:203], v[84:87]
    s_waitcnt lgkmcnt(6)
    v_mfma_f32_16x16x32_bf16 v[88:91], v[144:147], v[204:207], v[88:91]
    ds_read_b128 v[200:203], v8 offset:34048
    v_mfma_f32_16x16x32_bf16 v[92:95], v[148:151], v[204:207], v[92:95]
    s_waitcnt vmcnt(8) lgkmcnt(6)
    v_mfma_f32_16x16x32_bf16 v[64:67], v[152:155], v[208:211], v[64:67]
    ds_read_b128 v[204:207], v8 offset:36096
    v_mfma_f32_16x16x32_bf16 v[68:71], v[156:159], v[208:211], v[68:71]
    s_waitcnt lgkmcnt(6)
    v_mfma_f32_16x16x32_bf16 v[72:75], v[152:155], v[212:215], v[72:75]
    ds_read_b128 v[208:211], v9 offset:8192
    v_mfma_f32_16x16x32_bf16 v[76:79], v[156:159], v[212:215], v[76:79]
    s_waitcnt lgkmcnt(6)
    v_mfma_f32_16x16x32_bf16 v[80:83], v[152:155], v[216:219], v[80:83]
    ds_read_b128 v[212:215], v9 offset:10240
    v_mfma_f32_16x16x32_bf16 v[84:87], v[156:159], v[216:219], v[84:87]
    s_waitcnt lgkmcnt(6)
    v_mfma_f32_16x16x32_bf16 v[88:91], v[152:155], v[220:223], v[88:91]
    ds_read_b128 v[216:219], v9 offset:34048
    v_mfma_f32_16x16x32_bf16 v[92:95], v[156:159], v[220:223], v[92:95]
    s_waitcnt vmcnt(6) lgkmcnt(6)
    v_mfma_f32_16x16x32_bf16 v[64:67], v[160:163], v[192:195], v[64:67]
    ds_read_b128 v[220:223], v9 offset:36096
    v_mfma_f32_16x16x32_bf16 v[68:71], v[164:167], v[192:195], v[68:71]
    s_waitcnt lgkmcnt(6)
    v_mfma_f32_16x16x32_bf16 v[72:75], v[160:163], v[196:199], v[72:75]
    ds_read_b128 v[192:195], v8 offset:21120
    v_mfma_f32_16x16x32_bf16 v[76:79], v[164:167], v[196:199], v[76:79]
    s_waitcnt lgkmcnt(6)
    v_mfma_f32_16x16x32_bf16 v[80:83], v[160:163], v[200:203], v[80:83]
    ds_read_b128 v[196:199], v8 offset:23168
    v_mfma_f32_16x16x32_bf16 v[84:87], v[164:167], v[200:203], v[84:87]
    s_waitcnt lgkmcnt(6)
    v_mfma_f32_16x16x32_bf16 v[88:91], v[160:163], v[204:207], v[88:91]
    ds_read_b128 v[200:203], v8 offset:46976
    v_mfma_f32_16x16x32_bf16 v[92:95], v[164:167], v[204:207], v[92:95]
    s_waitcnt vmcnt(4) lgkmcnt(6)
    v_mfma_f32_16x16x32_bf16 v[64:67], v[168:171], v[208:211], v[64:67]
    ds_read_b128 v[204:207], v8 offset:49024
    v_mfma_f32_16x16x32_bf16 v[68:71], v[172:175], v[208:211], v[68:71]
    s_waitcnt lgkmcnt(6)
    v_mfma_f32_16x16x32_bf16 v[72:75], v[168:171], v[212:215], v[72:75]
    ds_read_b128 v[208:211], v9 offset:21120
    v_mfma_f32_16x16x32_bf16 v[76:79], v[172:175], v[212:215], v[76:79]
    s_waitcnt lgkmcnt(6)
    v_mfma_f32_16x16x32_bf16 v[80:83], v[168:171], v[216:219], v[80:83]
    ds_read_b128 v[212:215], v9 offset:23168
    v_mfma_f32_16x16x32_bf16 v[84:87], v[172:175], v[216:219], v[84:87]
    s_waitcnt lgkmcnt(6)
    v_mfma_f32_16x16x32_bf16 v[88:91], v[168:171], v[220:223], v[88:91]
    ds_read_b128 v[216:219], v9 offset:46976
    v_mfma_f32_16x16x32_bf16 v[92:95], v[172:175], v[220:223], v[92:95]
    s_waitcnt vmcnt(2) lgkmcnt(6)
    v_mfma_f32_16x16x32_bf16 v[64:67], v[176:179], v[192:195], v[64:67]
    ds_read_b128 v[220:223], v9 offset:49024
    v_mfma_f32_16x16x32_bf16 v[68:71], v[180:183], v[192:195], v[68:71]
    s_waitcnt lgkmcnt(6)
    v_mfma_f32_16x16x32_bf16 v[72:75], v[176:179], v[196:199], v[72:75]
    v_mfma_f32_16x16x32_bf16 v[76:79], v[180:183], v[196:199], v[76:79]
    s_waitcnt lgkmcnt(5)
    v_mfma_f32_16x16x32_bf16 v[80:83], v[176:179], v[200:203], v[80:83]
    v_mfma_f32_16x16x32_bf16 v[84:87], v[180:183], v[200:203], v[84:87]
    s_waitcnt lgkmcnt(4)
    v_mfma_f32_16x16x32_bf16 v[88:91], v[176:179], v[204:207], v[88:91]
    v_mfma_f32_16x16x32_bf16 v[92:95], v[180:183], v[204:207], v[92:95]
    s_waitcnt vmcnt(0) lgkmcnt(3)
    v_mfma_f32_16x16x32_bf16 v[64:67], v[184:187], v[208:211], v[64:67]
    v_mfma_f32_16x16x32_bf16 v[68:71], v[188:191], v[208:211], v[68:71]
    s_waitcnt lgkmcnt(2)
    v_mfma_f32_16x16x32_bf16 v[72:75], v[184:187], v[212:215], v[72:75]
    v_mfma_f32_16x16x32_bf16 v[76:79], v[188:191], v[212:215], v[76:79]
    s_waitcnt lgkmcnt(1)
    v_mfma_f32_16x16x32_bf16 v[80:83], v[184:187], v[216:219], v[80:83]
    v_mfma_f32_16x16x32_bf16 v[84:87], v[188:191], v[216:219], v[84:87]
    s_waitcnt lgkmcnt(0)
    v_mfma_f32_16x16x32_bf16 v[88:91], v[184:187], v[220:223], v[88:91]
    v_mfma_f32_16x16x32_bf16 v[92:95], v[188:191], v[220:223], v[92:95]
    s_lshl_b32 s10, s6, 7
    s_lshl_b32 s11, s3, 5
    s_add_u32 s10, s10, s11
    v_lshrrev_b32 v32, 4, v2
    v_lshl_add_u32 v32, v32, 2, s10
    s_lshl_b32 s10, s7, 8
    s_add_u32 s10, s10, 4096
    v_and_b32 v33, 15, v2
    v_lshl_add_u32 v33, v33, 4, s10
    v_lshl_add_u32 v32, v32, 13, v33
    v_mov_b32 v224, v64
    v_mov_b32 v225, v72
    v_mov_b32 v226, v80
    v_mov_b32 v227, v88
    s_mov_b32 s10, 0
    buffer_store_dwordx4 v[224:227], v32, s[60:63], s10 offen sc1
    v_mov_b32 v228, v65
    v_mov_b32 v229, v73
    v_mov_b32 v230, v81
    v_mov_b32 v231, v89
    s_mov_b32 s10, 8192
    buffer_store_dwordx4 v[228:231], v32, s[60:63], s10 offen sc1
    v_mov_b32 v232, v66
    v_mov_b32 v233, v74
    v_mov_b32 v234, v82
    v_mov_b32 v235, v90
    s_mov_b32 s10, 16384
    buffer_store_dwordx4 v[232:235], v32, s[60:63], s10 offen sc1
    v_mov_b32 v236, v67
    v_mov_b32 v237, v75
    v_mov_b32 v238, v83
    v_mov_b32 v239, v91
    s_mov_b32 s10, 24576
    buffer_store_dwordx4 v[236:239], v32, s[60:63], s10 offen sc1
    v_mov_b32 v240, v68
    v_mov_b32 v241, v76
    v_mov_b32 v242, v84
    v_mov_b32 v243, v92
    s_mov_b32 s10, 131072
    buffer_store_dwordx4 v[240:243], v32, s[60:63], s10 offen sc1
    v_mov_b32 v244, v69
    v_mov_b32 v245, v77
    v_mov_b32 v246, v85
    v_mov_b32 v247, v93
    s_mov_b32 s10, 139264
    buffer_store_dwordx4 v[244:247], v32, s[60:63], s10 offen sc1
    v_mov_b32 v248, v70
    v_mov_b32 v249, v78
    v_mov_b32 v250, v86
    v_mov_b32 v251, v94
    s_mov_b32 s10, 147456
    buffer_store_dwordx4 v[248:251], v32, s[60:63], s10 offen sc1
    v_mov_b32 v252, v71
    v_mov_b32 v253, v79
    v_mov_b32 v254, v87
    v_mov_b32 v255, v95
    s_mov_b32 s10, 155648
    buffer_store_dwordx4 v[252:255], v32, s[60:63], s10 offen sc1
    s_waitcnt vmcnt(0) lgkmcnt(0)
    s_endpgm
G2_slow3:
    s_mov_b32 s15, 0
G2_sl3_w:
    ds_read_b128 v[12:15], v11 offset:0
    s_waitcnt lgkmcnt(0)
    v_min3_u32 v12, v12, v13, v14
    v_min_u32 v12, v12, v15
    v_cmp_gt_u32 vcc, 20, v12
    s_cbranch_vccz G2_sl3_ok
    s_add_u32 s15, s15, 1
    s_cmp_lt_u32 s15, 160000
    s_cbranch_scc1 G2_sl3_w
G2_sl3_ok:
    s_branch G2_back3
G2_slow4:
    s_mov_b32 s15, 0
G2_sl4_w:
    ds_read_b128 v[12:15], v11 offset:0
    s_waitcnt lgkmcnt(0)
    v_min3_u32 v12, v12, v13, v14
    v_min_u32 v12, v12, v15
    v_cmp_gt_u32 vcc, 21, v12
    s_cbranch_vccz G2_sl4_ok
    s_add_u32 s15, s15, 1
    s_cmp_lt_u32 s15, 160000
    s_cbranch_scc1 G2_sl4_w
G2_sl4_ok:
    s_branch G2_back4
G2_slow5:
    s_mov_b32 s15, 0
G2_sl5_w:
    ds_read_b128 v[12:15], v11 offset:0
    s_waitcnt lgkmcnt(0)
    v_min3_u32 v12, v12, v13, v14
    v_min_u32 v12, v12, v15
    v_cmp_gt_u32 vcc, 22, v12
    s_cbranch_vccz G2_sl5_ok
    s_add_u32 s15, s15, 1
    s_cmp_lt_u32 s15, 160000
    s_cbranch_scc1 G2_sl5_w
G2_sl5_ok:
    s_branch G2_back5
G2_slow6:
    s_mov_b32 s15, 0
G2_sl6_w:
    ds_read_b128 v[12:15], v11 offset:0
    s_waitcnt lgkmcnt(0)
    v_min3_u32 v12, v12, v13, v14
    v_min_u32 v12, v12, v15
    v_cmp_gt_u32 vcc, 23, v12
    s_cbranch_vccz G2_sl6_ok
    s_add_u32 s15, s15, 1
    s_cmp_lt_u32 s15, 160000
    s_cbranch_scc1 G2_sl6_w
G2_sl6_ok:
    s_branch G2_back6
G2_slow7:
    s_mov_b32 s15, 0
G2_sl7_w:
    ds_read_b128 v[12:15], v11 offset:0
    s_waitcnt lgkmcnt(0)
    v_min3_u32 v12, v12, v13, v14
    v_min_u32 v12, v12, v15
    v_cmp_gt_u32 vcc, 24, v12
    s_cbranch_vccz G2_sl7_ok
    s_add_u32 s15, s15, 1
    s_cmp_lt_u32 s15, 160000
    s_cbranch_scc1 G2_sl7_w
G2_sl7_ok:
    s_branch G2_back7
G2_slow8:
    s_mov_b32 s15, 0
G2_sl8_w:
    ds_read_b128 v[12:15], v11 offset:0
    s_waitcnt lgkmcnt(0)
    v_min3_u32 v12, v12, v13, v14
    v_min_u32 v12, v12, v15
    v_cmp_gt_u32 vcc, 25, v12
    s_cbranch_vccz G2_sl8_ok
    s_add_u32 s15, s15, 1
    s_cmp_lt_u32 s15, 160000
    s_cbranch_scc1 G2_sl8_w
G2_sl8_ok:
    s_branch G2_back8
G2_slow10:
    s_mov_b32 s15, 0
G2_sl10_w:
    ds_read_b128 v[12:15], v11 offset:0
    s_waitcnt lgkmcnt(0)
    v_min3_u32 v12, v12, v13, v14
    v_min_u32 v12, v12, v15
    v_cmp_gt_u32 vcc, 27, v12
    s_cbranch_vccz G2_sl10_ok
    s_add_u32 s15, s15, 1
    s_cmp_lt_u32 s15, 160000
    s_cbranch_scc1 G2_sl10_w
G2_sl10_ok:
    s_branch G2_back10
G2_slowc:
    s_mov_b32 s15, 0
G2_slc_w:
    ds_read_b32 v18, v11 offset:68
    s_waitcnt lgkmcnt(0)
    v_cmp_gt_u32 vcc, 4, v18
    s_cbranch_vccz G2_slc_ok
    s_add_u32 s15, s15, 1
    s_cmp_lt_u32 s15, 160000
    s_cbranch_scc1 G2_slc_w
G2_slc_ok:
    s_branch G2_backc
Y_done:
    s_endpgm
Y_end:
.section .rodata,"a"
.p2align 6
.amdhsa_kernel concat_heads__ssm_conv_h3__ssm_conv_s5__prompt_kernel
  .amdhsa_next_free_vgpr 256
  .amdhsa_next_free_sgpr 102
  .amdhsa_accum_offset 256
  .amdhsa_group_segment_fixed_size 0
  .amdhsa_kernarg_size 144
  .amdhsa_user_sgpr_count 2
  .amdhsa_user_sgpr_kernarg_segment_ptr 1
  .amdhsa_system_sgpr_workgroup_id_x 1
.end_amdhsa_kernel
```

```asm
; @launch grid=(256,1,1) block=(512,1,1) lds=163840
.amdgcn_target "amdgcn-amd-amdhsa--gfx950"
.text
.globl concat_heads__ssm_conv_h3__ssm_conv_s5__prompt_kernel
.p2align 8
.type concat_heads__ssm_conv_h3__ssm_conv_s5__prompt_kernel,@function
concat_heads__ssm_conv_h3__ssm_conv_s5__prompt_kernel:
    s_cmp_ge_u32 s2, 256
    s_cbranch_scc1 Y_done
    s_load_dwordx16 s[16:31], s[0:1], 0
    s_load_dwordx16 s[32:47], s[0:1], 64
    s_load_dwordx4 s[48:51], s[0:1], 128
    s_getpc_b64 s[52:53]
Y_pc:
    v_lshrrev_b32 v1, 6, v0
    v_and_b32 v2, 63, v0
    s_and_b32 s4, s2, 7
    v_readfirstlane_b32 s3, v1
    s_lshr_b32 s5, s2, 3
    s_and_b32 s6, s4, 3
    s_lshl_b32 s6, s6, 2
    s_and_b32 s7, s5, 3
    s_add_u32 s6, s6, s7
    s_and_b32 s7, s4, 4
    s_lshl_b32 s7, s7, 1
    s_lshr_b32 s8, s5, 2
    s_add_u32 s7, s7, s8
    s_and_b32 s6, s4, 1
    s_lshl_b32 s6, s6, 3
    s_and_b32 s7, s5, 7
    s_add_u32 s6, s6, s7
    s_and_b32 s7, s4, 6
    s_lshl_b32 s7, s7, 1
    s_lshr_b32 s8, s5, 3
    s_add_u32 s7, s7, s8
    s_lshl_b32 s54, s5, 3
    s_add_u32 s54, s54, s3
    s_lshl_b32 s54, s54, 6
    s_load_dword s56, s[52:53], s54
    s_add_u32 s54, s54, 16384
    s_min_u32 s54, s54, Y_end-Y_pc-4
    s_load_dword s57, s[52:53], s54
    s_add_u32 s13, s5, s8
    s_lshl_b32 s13, s13, 3
    s_and_b32 s9, s4, 6
    s_add_u32 s13, s13, s9
    s_and_b32 s9, s4, 1
    s_lshl_b32 s9, s9, 2
    s_add_u32 s13, s13, s9
    s_and_b32 s13, s13, 15
    s_and_b32 s9, s4, 6
    s_add_u32 s12, s5, s9
    s_lshl_b32 s12, s12, 1
    s_and_b32 s9, s4, 1
    s_add_u32 s12, s12, s9
    s_and_b32 s12, s12, 15
    s_lshl_b32 s13, s13, 7
    s_mov_b32 s100, 0x76543210
    s_mov_b32 s101, 0xfedcba98
    s_lshl_b32 s9, s12, 2
    s_lshr_b64 s[10:11], s[100:101], s9
    s_sub_u32 s9, 64, s9
    s_lshl_b64 s[100:101], s[100:101], s9
    s_or_b64 s[100:101], s[100:101], s[10:11]
    s_sub_u32 s9, s7, s12
    s_and_b32 s9, s9, 15
    s_lshl_b32 s9, s9, 2
    s_bfm_b64 s[10:11], s9, 0
    s_and_b64 s[14:15], s[100:101], s[10:11]
    s_lshl_b64 s[14:15], s[14:15], 4
    s_lshl_b64 s[10:11], s[10:11], 4
    s_or_b32 s10, s10, 15
    s_andn2_b64 s[100:101], s[100:101], s[10:11]
    s_or_b64 s[100:101], s[100:101], s[14:15]
    s_or_b32 s100, s100, s7
    s_cmp_lt_u32 s3, 4
    s_cbranch_scc0 Y_L
    v_and_b32 v3, 31, v2
    v_mov_b32 v23, 0
    v_mov_b32 v11, 163712
    v_lshl_add_u32 v48, v3, 2, v11
    ds_write_b32 v48, v23
    s_waitcnt lgkmcnt(0)
    s_barrier
    s_branch Y_G
Y_L:
    s_setprio 2
    s_sub_u32 s8, s3, 4
    s_lshr_b32 s11, s8, 1
    s_and_b32 s9, s8, 1
    s_cmp_eq_u32 s11, 1
    s_cbranch_scc1 L_ns0
    s_lshl_b32 s10, s6, 7
    s_lshl_b32 s12, s9, 6
    s_add_u32 s10, s10, s12
    v_and_b32 v24, 32, v2
    v_bfe_u32 v25, v2, 3, 1
    v_lshl_add_u32 v24, v25, 4, v24
    v_bfe_u32 v25, v2, 4, 1
    v_add_u32 v24, v24, v25
    v_add_u32 v24, s10, v24
    v_lshlrev_b32 v24, 11, v24
    v_lshrrev_b32 v25, 4, v2
    v_xor_b32 v25, v25, v2
    v_and_b32 v25, 7, v25
    v_lshl_add_u32 v4, v25, 4, v24
    v_xor_b32 v5, 64, v4
    v_add_u32 v5, 3072, v5
    v_add_u32 v6, 6144, v4
    v_add_u32 v7, 6144, v5
    s_lshl_b32 s10, s7, 6
    v_lshrrev_b32 v24, 3, v2
    s_lshl_b32 s12, s9, 5
    s_add_u32 s10, s10, s12
    v_add_u32 v24, s10, v24
    v_lshlrev_b32 v24, 11, v24
    v_lshrrev_b32 v25, 4, v2
    v_xor_b32 v25, v25, v2
    v_and_b32 v25, 7, v25
    v_lshl_add_u32 v8, v25, 4, v24
    v_xor_b32 v9, 64, v8
    v_add_u32 v9, 15360, v9
    v_add_u32 v10, 30720, v8
    v_add_u32 v11, 30720, v9
    s_lshl_b32 s14, s8, 13
    s_waitcnt lgkmcnt(0)
    s_mov_b32 s52, s28
    s_mov_b32 s53, s29
    s_mov_b32 s54, 4194304
    s_mov_b32 s55, 0x00020000
    s_mov_b32 s56, s34
    s_mov_b32 s57, s35
    s_mov_b32 s58, 2097152
    s_mov_b32 s59, 0x00020000
    s_mov_b32 s60, s36
    s_mov_b32 s61, s37
    s_mov_b32 s62, 2097152
    s_mov_b32 s63, 0x00020000
    s_add_u32 m0, s14, 0
    s_nop 0
    buffer_load_dwordx4 v4, s[52:55], s13 offen offset:0 lds
    buffer_load_dwordx4 v5, s[52:55], s13 offen offset:1024 lds
    buffer_load_dwordx4 v6, s[52:55], s13 offen offset:2048 lds
    buffer_load_dwordx4 v7, s[52:55], s13 offen offset:3072 lds
    s_add_u32 m0, s14, 16384
    s_nop 0
    buffer_load_dwordx4 v8, s[56:59], s13 offen offset:0 lds
    buffer_load_dwordx4 v9, s[56:59], s13 offen offset:1024 lds
    buffer_load_dwordx4 v10, s[56:59], s13 offen offset:2048 lds
    buffer_load_dwordx4 v11, s[56:59], s13 offen offset:3072 lds
    s_add_u32 m0, s14, 4096
    s_add_u32 s12, s13, 16384
    buffer_load_dwordx4 v4, s[52:55], s12 offen offset:0 lds
    buffer_load_dwordx4 v5, s[52:55], s12 offen offset:1024 lds
    buffer_load_dwordx4 v6, s[52:55], s12 offen offset:2048 lds
    buffer_load_dwordx4 v7, s[52:55], s12 offen offset:3072 lds
    s_add_u32 m0, s14, 20480
    s_nop 0
    buffer_load_dwordx4 v8, s[60:63], s13 offen offset:0 lds
    buffer_load_dwordx4 v9, s[60:63], s13 offen offset:1024 lds
    buffer_load_dwordx4 v10, s[60:63], s13 offen offset:2048 lds
    buffer_load_dwordx4 v11, s[60:63], s13 offen offset:3072 lds
    s_add_u32 s13, s13, 128
    s_and_b32 s13, s13, 2047
    s_add_u32 s14, s14, 32768
    s_and_b32 s14, s14, 131071
L_ns0:
    s_waitcnt lgkmcnt(0)
    s_barrier
    v_mov_b32 v19, 0
    s_lshl_b32 s10, s3, 2
    s_add_u32 s10, s10, 163712
    v_mov_b32 v22, s10
    v_mov_b32 v21, 163712
    s_add_u32 s72, s50, 17825792
    s_addc_u32 s73, s51, 0
    s_mov_b32 s74, 24576
    s_mov_b32 s75, 0x00020000
    s_mov_b32 s76, s48
    s_mov_b32 s77, s49
    s_mov_b32 s78, 256
    s_mov_b32 s79, 0x00020000
    s_mov_b32 s37, s100
    s_mov_b32 s30, s101
    s_lshl_b32 s100, s4, 7
    s_lshl_b32 s10, s5, 2
    s_add_u32 s100, s100, s10
    s_add_u32 s100, s100, s8
    s_lshr_b32 s10, s100, 1
    s_lshl_b32 s10, s10, 2
    s_load_dword s31, s[26:27], s10
    s_mul_i32 s101, s8, 12928
    s_add_u32 s101, s101, 98304
    s_lshl_b32 s10, s7, 5
    s_add_u32 s10, s10, s11
    s_lshl_b32 s10, s10, 12
    v_lshrrev_b32 v24, 3, v2
    v_lshl_add_u32 v24, v24, 13, s10
    v_lshrrev_b32 v25, 4, v2
    v_xor_b32 v25, v25, v2
    v_and_b32 v25, 7, v25
    v_lshl_add_u32 v12, v25, 4, v24
    v_xor_b32 v13, 64, v12
    v_add_u32 v13, 64512, v13
    s_cmp_eq_u32 s9, 1
    s_cselect_b32 s80, s40, s38
    s_cselect_b32 s81, s41, s39
    s_mov_b32 s82, 2097152
    s_mov_b32 s83, 0x00020000
    s_mov_b32 s68, s24
    s_mov_b32 s69, s25
    s_mov_b32 s70, 4194304
    s_mov_b32 s71, 0x00020000
    s_movk_i32 s32, 4096
    s_movk_i32 s33, 8192
    s_movk_i32 s34, 12288
    s_lshl_b32 s10, s5, 6
    v_and_b32 v23, 56, v2
    v_add_u32 v23, s10, v23
    v_lshlrev_b32 v26, 4, v2
    s_lshl_b32 s36, s100, 12
    s_lshl_b32 s10, s4, 1
    s_lshr_b32 s12, s5, 4
    s_add_u32 s10, s10, s12
    s_lshl_b32 s10, s10, 8
    v_and_b32 v60, 31, v2
    v_lshl_add_u32 v20, v60, 3, s10
    s_lshl_b32 s10, s4, 7
    s_lshl_b32 s12, s8, 5
    s_add_u32 s35, s10, s12
    v_and_b32 v25, 7, v2
    v_lshl_add_u32 v24, v25, 2, s35
    v_lshlrev_b32 v25, 1, v24
    v_lshl_add_u32 v16, v23, 11, v25
    v_add_u32 v60, 12416, v26
    v_and_b32 v61, 16, v26
    v_and_b32 v62, 32, v26
    v_mul_u32_u24 v62, 130, v62
    v_add_u32 v61, v61, v62
    v_cmp_gt_u32 vcc, 32, v2
    s_nop 1
    v_cndmask_b32 v60, v61, v60, vcc
    v_add_u32 v18, s101, v60
    s_lshl_b32 s10, s4, 10
    s_add_u32 s10, s10, 8192
    v_add_u32 v3, s10, v26
    v_and_b32 v17, 15, v2
    v_lshrrev_b32 v27, 4, v2
    v_lshlrev_b32 v60, 1, v17
    v_lshlrev_b32 v61, 4, v27
    v_sub_u32 v60, v60, v61
    v_and_b32 v62, 1, v17
    v_mov_b32 v63, 4212
    v_cmp_eq_u32 vcc, 1, v62
    s_nop 1
    v_cndmask_b32 v63, v63, 50, vcc
    v_add3_u32 v28, v60, v63, s101
    v_add_u32 v29, 1024, v28
    v_add_u32 v30, 2048, v28
    v_add_u32 v31, 3072, v28
    v_lshl_add_u32 v60, v17, 5, v61
    s_add_u32 s10, s101, 8848
    v_sub_u32 v32, s10, v60
    s_add_u32 s10, s101, 8320
    v_add_u32 v33, s10, v26
    s_cmp_eq_u32 s11, 1
    s_cbranch_scc1 L_idle
    s_mov_b32 s29, 1
    v_mov_b32 v25, 1
    s_branch L_free
L_loop:
    s_sub_i32 s28, s29, 3
    s_max_i32 s28, s28, 0
    s_waitcnt lgkmcnt(0)
    v_min3_u32 v60, v60, v61, v62
    v_min_u32 v60, v60, v63
    v_mov_b32 v25, s29
    v_cmp_gt_u32 vcc, s28, v60
    s_cbranch_vccz L_free
    s_mov_b32 s15, 0
L_slot_w:
    ds_read_b128 v[60:63], v21 offset:0
    s_waitcnt lgkmcnt(0)
    v_min3_u32 v60, v60, v61, v62
    v_min_u32 v60, v60, v63
    v_cmp_gt_u32 vcc, s28, v60
    s_cbranch_vccz L_slot_ok
    s_sleep 1
    s_add_u32 s15, s15, 1
    s_cmp_lt_u32 s15, 160000
    s_cbranch_scc1 L_slot_w
L_slot_ok:
L_free:
    s_cmp_ge_u32 s29, 8
    s_cbranch_scc1 L_sh
    s_add_u32 m0, s14, 0
    s_waitcnt vmcnt(15)
    buffer_load_dwordx4 v4, s[52:55], s13 offen offset:0 lds
    s_waitcnt vmcnt(15)
    buffer_load_dwordx4 v5, s[52:55], s13 offen offset:1024 lds
    s_waitcnt vmcnt(15)
    buffer_load_dwordx4 v6, s[52:55], s13 offen offset:2048 lds
    s_waitcnt vmcnt(15)
    buffer_load_dwordx4 v7, s[52:55], s13 offen offset:3072 lds
    s_add_u32 m0, s14, 16384
    s_waitcnt vmcnt(15)
    buffer_load_dwordx4 v8, s[56:59], s13 offen offset:0 lds
    s_waitcnt vmcnt(15)
    buffer_load_dwordx4 v9, s[56:59], s13 offen offset:1024 lds
    s_waitcnt vmcnt(15)
    buffer_load_dwordx4 v10, s[56:59], s13 offen offset:2048 lds
    s_waitcnt vmcnt(15)
    buffer_load_dwordx4 v11, s[56:59], s13 offen offset:3072 lds
    s_add_u32 m0, s14, 4096
    s_add_u32 s12, s13, 16384
    s_waitcnt vmcnt(15)
    buffer_load_dwordx4 v4, s[52:55], s12 offen offset:0 lds
    s_waitcnt vmcnt(15)
    buffer_load_dwordx4 v5, s[52:55], s12 offen offset:1024 lds
    s_waitcnt vmcnt(15)
    buffer_load_dwordx4 v6, s[52:55], s12 offen offset:2048 lds
    s_waitcnt vmcnt(15)
    buffer_load_dwordx4 v7, s[52:55], s12 offen offset:3072 lds
    ds_read_b128 v[60:63], v21
    s_add_u32 m0, s14, 20480
    s_waitcnt vmcnt(15)
    buffer_load_dwordx4 v8, s[60:63], s13 offen offset:0 lds
    s_waitcnt vmcnt(15)
    buffer_load_dwordx4 v9, s[60:63], s13 offen offset:1024 lds
    s_waitcnt vmcnt(15)
    buffer_load_dwordx4 v10, s[60:63], s13 offen offset:2048 lds
    s_waitcnt vmcnt(15)
    ds_write_b32 v22, v25
    buffer_load_dwordx4 v11, s[60:63], s13 offen offset:3072 lds
    s_add_u32 s13, s13, 128
    s_and_b32 s13, s13, 2047
    s_add_u32 s14, s14, 32768
    s_and_b32 s14, s14, 131071
    s_add_u32 s29, s29, 1
    s_branch L_loop
L_sh:
    s_add_u32 m0, s14, 0
    s_waitcnt vmcnt(7)
    buffer_load_dwordx4 v4, s[52:55], s13 offen offset:0 lds
    s_waitcnt vmcnt(7)
    buffer_load_dwordx4 v5, s[52:55], s13 offen offset:1024 lds
    s_waitcnt vmcnt(7)
    buffer_load_dwordx4 v6, s[52:55], s13 offen offset:2048 lds
    s_waitcnt vmcnt(7)
    buffer_load_dwordx4 v7, s[52:55], s13 offen offset:3072 lds
    s_add_u32 m0, s14, 16384
    s_waitcnt vmcnt(7)
    buffer_load_dwordx4 v8, s[56:59], s13 offen offset:0 lds
    s_waitcnt vmcnt(7)
    buffer_load_dwordx4 v9, s[56:59], s13 offen offset:1024 lds
    s_waitcnt vmcnt(7)
    buffer_load_dwordx4 v10, s[56:59], s13 offen offset:2048 lds
    s_waitcnt vmcnt(7)
    ds_write_b32 v22, v25
    buffer_load_dwordx4 v11, s[56:59], s13 offen offset:3072 lds
    s_add_u32 m0, s14, 4096
    s_add_u32 s12, s13, 16384
    s_waitcnt vmcnt(7)
    buffer_load_dwordx4 v4, s[52:55], s12 offen offset:0 lds
    s_waitcnt vmcnt(7)
    buffer_load_dwordx4 v5, s[52:55], s12 offen offset:1024 lds
    s_waitcnt vmcnt(7)
    buffer_load_dwordx4 v6, s[52:55], s12 offen offset:2048 lds
    s_waitcnt vmcnt(7)
    buffer_load_dwordx4 v7, s[52:55], s12 offen offset:3072 lds
    ds_read_b128 v[60:63], v21
    s_add_u32 m0, s14, 20480
    s_waitcnt vmcnt(7)
    buffer_load_dwordx4 v8, s[60:63], s13 offen offset:0 lds
    s_waitcnt vmcnt(7)
    buffer_load_dwordx4 v9, s[60:63], s13 offen offset:1024 lds
    s_waitcnt vmcnt(7)
    buffer_load_dwordx4 v10, s[60:63], s13 offen offset:2048 lds
    s_waitcnt vmcnt(7)
    buffer_load_dwordx4 v11, s[60:63], s13 offen offset:3072 lds
    s_add_u32 s13, s13, 128
    s_and_b32 s13, s13, 2047
    s_add_u32 s14, s14, 32768
    s_and_b32 s14, s14, 131071
    s_add_u32 s29, s29, 1
    s_cmp_lt_u32 s29, 16
    s_cbranch_scc1 L_loop
    v_mov_b32 v25, 16
    v_mov_b32 v60, 1
    s_mov_b64 exec, 1
    ds_add_u32 v21, v60 offset:40
    s_mov_b64 exec, -1
    s_waitcnt vmcnt(0)
    ds_write_b32 v22, v25
    s_mov_b32 s15, 0
L_is0_w:
    ds_read_b32 v60, v21 offset:40
    s_waitcnt lgkmcnt(0)
    v_cmp_gt_u32 vcc, 2, v60
    s_cbranch_vccz L_is0_ok
    s_add_u32 s15, s15, 1
    s_cmp_lt_u32 s15, 160000
    s_cbranch_scc1 L_is0_w
L_is0_ok:
    buffer_load_dwordx4 v[192:195], v26, s[68:71], s36 offen offset:0 nt
    buffer_load_dwordx4 v[196:199], v26, s[68:71], s36 offen offset:1024 nt
    buffer_load_dwordx4 v[200:203], v26, s[68:71], s36 offen offset:2048 nt
    buffer_load_dwordx4 v[204:207], v26, s[68:71], s36 offen offset:3072 nt
    s_branch L_t2
L_idle:
    s_setprio 0
    s_mov_b32 s52, s18
    s_mov_b32 s53, s19
    s_mov_b32 s54, 4194304
    s_mov_b32 s55, 0x00020000
    s_mov_b32 s56, s20
    s_mov_b32 s57, s21
    s_mov_b32 s58, 4194304
    s_mov_b32 s59, 0x00020000
    s_mov_b32 s60, s22
    s_mov_b32 s61, s23
    s_mov_b32 s62, 8192
    s_mov_b32 s63, 0x00020000
    s_mov_b32 s64, s50
    s_mov_b32 s65, s51
    s_mov_b32 s66, 4194304
    s_mov_b32 s67, 0x00020000
    s_lshl_b32 s10, s4, 7
    s_lshl_b32 s12, s9, 6
    s_add_u32 s10, s10, s12
    v_and_b32 v60, 7, v2
    v_lshl_add_u32 v4, v60, 3, s10
    v_lshlrev_b32 v60, 1, v4
    v_lshl_add_u32 v5, v23, 11, v60
    v_subrev_u32 v6, 6144, v5
    v_bfrev_b32 v60, 1
    v_cmp_eq_u32 vcc, 0, v23
    s_nop 1
    v_cndmask_b32 v6, v6, v60, vcc
    v_lshlrev_b32 v7, 3, v4
    v_sub_u32 v8, 2040, v23
    v_lshlrev_b32 v8, 1, v8
    v_lshl_add_u32 v8, v4, 12, v8
    v_add_u32 v9, 16384, v8
    s_lshl_b32 s13, s4, 1
    s_add_u32 s13, s13, s9
    s_lshl_b32 s13, s13, 5
    s_add_u32 s13, s13, s5
    s_lshl_b32 s13, s13, 3
    v_mov_b32 v25, 16
    s_getreg_b32 s14, hwreg(HW_REG_XCC_ID, 0, 8)
    s_add_u32 s14, s14, 1
    s_lshl_b32 s14, s14, 20
    s_lshl_b32 s10, s4, 8
    s_add_u32 s10, s10, 4096
    v_and_b32 v14, 31, v2
    v_lshl_add_u32 v14, v14, 3, s10
    s_lshl_b32 s28, s5, 3
    s_add_u32 s28, s28, s10
    s_cmp_eq_u32 s9, 0
    s_cbranch_scc0 L_x1
    s_mov_b32 s15, 0
L_x0_w:
    ds_read_b64 v[60:61], v21 offset:16
    s_waitcnt lgkmcnt(0)
    v_min_u32 v60, v60, v61
    v_cmp_gt_u32 vcc, 1, v60
    s_cbranch_vccz L_x0_ok
    s_sleep 2
    s_add_u32 s15, s15, 1
    s_cmp_lt_u32 s15, 160000
    s_cbranch_scc1 L_x0_w
L_x0_ok:
    buffer_load_dwordx2 v[10:11], v19, s[76:79], 0 offen sc1
    s_waitcnt vmcnt(0)
    s_mov_b32 s12, 0
LX_np:
    v_cmp_eq_u32 vcc, 0, v10
    s_cbranch_vccz LX_nok
    buffer_load_dwordx2 v[10:11], v19, s[76:79], 0 offen sc1
    s_add_u32 s12, s12, 1
    s_waitcnt vmcnt(0)
    s_cmp_lt_u32 s12, 20000
    s_cbranch_scc1 LX_np
LX_nok:
    v_xor_b32 v11, s14, v11
    s_mov_b64 exec, 1
    buffer_store_dwordx2 v[10:11], v19, s[72:75], s28 offen sc1
    s_mov_b64 exec, -1
L_x1:
    s_mov_b32 s15, 0
L_i1_w:
    ds_read_b64 v[60:61], v21 offset:16
    s_waitcnt lgkmcnt(0)
    v_min_u32 v60, v60, v61
    v_cmp_gt_u32 vcc, 4, v60
    s_cbranch_vccz L_i1_ok
    s_sleep 2
    s_add_u32 s15, s15, 1
    s_cmp_lt_u32 s15, 160000
    s_cbranch_scc1 L_i1_w
L_i1_ok:
    buffer_load_dwordx4 v[64:67], v7, s[60:63], 0 offen offset:0
    buffer_load_dwordx4 v[68:71], v7, s[60:63], 0 offen offset:16
    buffer_load_dwordx4 v[72:75], v7, s[60:63], 0 offen offset:32
    buffer_load_dwordx4 v[76:79], v7, s[60:63], 0 offen offset:48
    buffer_load_dwordx4 v[92:95], v5, s[52:55], 0 offen offset:0 nt
    buffer_load_dwordx4 v[96:99], v5, s[52:55], 0 offen offset:2048 nt
    buffer_load_dwordx4 v[100:103], v5, s[52:55], s32 offen offset:0 nt
    buffer_load_dwordx4 v[104:107], v5, s[52:55], s32 offen offset:2048 nt
    buffer_load_dwordx4 v[108:111], v5, s[52:55], s33 offen offset:0 nt
    buffer_load_dwordx4 v[112:115], v5, s[52:55], s33 offen offset:2048 nt
    buffer_load_dwordx4 v[116:119], v5, s[52:55], s34 offen offset:0 nt
    buffer_load_dwordx4 v[120:123], v5, s[52:55], s34 offen offset:2048 nt
    buffer_load_dwordx4 v[80:83], v6, s[52:55], 0 offen offset:0 nt
    buffer_load_dwordx4 v[84:87], v6, s[52:55], 0 offen offset:2048 nt
    buffer_load_dwordx4 v[88:91], v6, s[52:55], s32 offen offset:0 nt
    buffer_load_dwordx4 v[124:127], v5, s[56:59], 0 offen offset:0 nt
    buffer_load_dwordx4 v[128:131], v5, s[56:59], 0 offen offset:2048 nt
    buffer_load_dwordx4 v[132:135], v5, s[56:59], s32 offen offset:0 nt
    buffer_load_dwordx4 v[136:139], v5, s[56:59], s32 offen offset:2048 nt
    buffer_load_dwordx4 v[140:143], v5, s[56:59], s33 offen offset:0 nt
    buffer_load_dwordx4 v[144:147], v5, s[56:59], s33 offen offset:2048 nt
    buffer_load_dwordx4 v[148:151], v5, s[56:59], s34 offen offset:0 nt
    buffer_load_dwordx4 v[152:155], v5, s[56:59], s34 offen offset:2048 nt
    buffer_load_dwordx2 v[58:59], v14, s[72:75], 0 offen sc1
    buffer_load_dwordx2 v[0:1], v19, s[76:79], 0 offen sc1
    s_waitcnt vmcnt(21)
    v_lshlrev_b32 v156, 16, v64
    v_and_b32 v160, 0xffff0000, v64
    v_lshlrev_b32 v164, 16, v65
    v_and_b32 v168, 0xffff0000, v65
    v_lshlrev_b32 v157, 16, v66
    v_and_b32 v161, 0xffff0000, v66
    v_lshlrev_b32 v165, 16, v67
    v_and_b32 v169, 0xffff0000, v67
    v_lshlrev_b32 v158, 16, v68
    v_and_b32 v162, 0xffff0000, v68
    v_lshlrev_b32 v166, 16, v69
    v_and_b32 v170, 0xffff0000, v69
    v_lshlrev_b32 v159, 16, v70
    v_and_b32 v163, 0xffff0000, v70
    v_lshlrev_b32 v167, 16, v71
    v_and_b32 v171, 0xffff0000, v71
    s_waitcnt vmcnt(10)
    v_lshlrev_b32 v172, 16, v80
    v_and_b32 v173, 0xffff0000, v80
    v_lshlrev_b32 v174, 16, v81
    v_and_b32 v175, 0xffff0000, v81
    v_lshlrev_b32 v176, 16, v84
    v_and_b32 v177, 0xffff0000, v84
    v_lshlrev_b32 v178, 16, v85
    v_and_b32 v179, 0xffff0000, v85
    v_lshlrev_b32 v180, 16, v88
    v_and_b32 v181, 0xffff0000, v88
    v_lshlrev_b32 v182, 16, v89
    v_and_b32 v183, 0xffff0000, v89
    v_lshlrev_b32 v184, 16, v92
    v_and_b32 v185, 0xffff0000, v92
    v_lshlrev_b32 v186, 16, v93
    v_and_b32 v187, 0xffff0000, v93
    v_lshlrev_b32 v188, 16, v96
    v_and_b32 v189, 0xffff0000, v96
    v_lshlrev_b32 v190, 16, v97
    v_and_b32 v191, 0xffff0000, v97
    v_lshlrev_b32 v192, 16, v100
    v_and_b32 v193, 0xffff0000, v100
    v_lshlrev_b32 v194, 16, v101
    v_and_b32 v195, 0xffff0000, v101
    v_lshlrev_b32 v196, 16, v104
    v_and_b32 v197, 0xffff0000, v104
    v_lshlrev_b32 v198, 16, v105
    v_and_b32 v199, 0xffff0000, v105
    v_lshlrev_b32 v200, 16, v108
    v_and_b32 v201, 0xffff0000, v108
    v_lshlrev_b32 v202, 16, v109
    v_and_b32 v203, 0xffff0000, v109
    v_lshlrev_b32 v204, 16, v112
    v_and_b32 v205, 0xffff0000, v112
    v_lshlrev_b32 v206, 16, v113
    v_and_b32 v207, 0xffff0000, v113
    v_lshlrev_b32 v208, 16, v116
    v_and_b32 v209, 0xffff0000, v116
    v_lshlrev_b32 v210, 16, v117
    v_and_b32 v211, 0xffff0000, v117
    v_lshlrev_b32 v212, 16, v120
    v_and_b32 v213, 0xffff0000, v120
    v_lshlrev_b32 v214, 16, v121
    v_and_b32 v215, 0xffff0000, v121
    v_mul_f32 v216, v184, v156
    v_mul_f32 v217, v185, v157
    v_mul_f32 v218, v186, v158
    v_mul_f32 v219, v187, v159
    v_mul_f32 v220, v188, v156
    v_mul_f32 v221, v189, v157
    v_mul_f32 v222, v190, v158
    v_mul_f32 v223, v191, v159
    v_mul_f32 v224, v192, v156
    v_mul_f32 v225, v193, v157
    v_mul_f32 v226, v194, v158
    v_mul_f32 v227, v195, v159
    v_mul_f32 v228, v196, v156
    v_mul_f32 v229, v197, v157
    v_mul_f32 v230, v198, v158
    v_mul_f32 v231, v199, v159
    v_mul_f32 v232, v200, v156
    v_mul_f32 v233, v201, v157
    v_mul_f32 v234, v202, v158
    v_mul_f32 v235, v203, v159
    v_mul_f32 v236, v204, v156
    v_mul_f32 v237, v205, v157
    v_mul_f32 v238, v206, v158
    v_mul_f32 v239, v207, v159
    v_mul_f32 v240, v208, v156
    v_mul_f32 v241, v209, v157
    v_mul_f32 v242, v210, v158
    v_mul_f32 v243, v211, v159
    v_mul_f32 v244, v212, v156
    v_mul_f32 v245, v213, v157
    v_mul_f32 v246, v214, v158
    v_mul_f32 v247, v215, v159
    v_fmac_f32 v216, v180, v160
    v_fmac_f32 v217, v181, v161
    v_fmac_f32 v218, v182, v162
    v_fmac_f32 v219, v183, v163
    v_fmac_f32 v220, v184, v160
    v_fmac_f32 v221, v185, v161
    v_fmac_f32 v222, v186, v162
    v_fmac_f32 v223, v187, v163
    v_fmac_f32 v224, v188, v160
    v_fmac_f32 v225, v189, v161
    v_fmac_f32 v226, v190, v162
    v_fmac_f32 v227, v191, v163
    v_fmac_f32 v228, v192, v160
    v_fmac_f32 v229, v193, v161
    v_fmac_f32 v230, v194, v162
    v_fmac_f32 v231, v195, v163
    v_fmac_f32 v232, v196, v160
    v_fmac_f32 v233, v197, v161
    v_fmac_f32 v234, v198, v162
    v_fmac_f32 v235, v199, v163
    v_fmac_f32 v236, v200, v160
    v_fmac_f32 v237, v201, v161
    v_fmac_f32 v238, v202, v162
    v_fmac_f32 v239, v203, v163
    v_fmac_f32 v240, v204, v160
    v_fmac_f32 v241, v205, v161
    v_fmac_f32 v242, v206, v162
    v_fmac_f32 v243, v207, v163
    v_fmac_f32 v244, v208, v160
    v_fmac_f32 v245, v209, v161
    v_fmac_f32 v246, v210, v162
    v_fmac_f32 v247, v211, v163
    v_fmac_f32 v216, v176, v164
    v_fmac_f32 v217, v177, v165
    v_fmac_f32 v218, v178, v166
    v_fmac_f32 v219, v179, v167
    v_fmac_f32 v220, v180, v164
    v_fmac_f32 v221, v181, v165
    v_fmac_f32 v222, v182, v166
    v_fmac_f32 v223, v183, v167
    v_fmac_f32 v224, v184, v164
    v_fmac_f32 v225, v185, v165
    v_fmac_f32 v226, v186, v166
    v_fmac_f32 v227, v187, v167
    v_fmac_f32 v228, v188, v164
    v_fmac_f32 v229, v189, v165
    v_fmac_f32 v230, v190, v166
    v_fmac_f32 v231, v191, v167
    v_fmac_f32 v232, v192, v164
    v_fmac_f32 v233, v193, v165
    v_fmac_f32 v234, v194, v166
    v_fmac_f32 v235, v195, v167
    v_fmac_f32 v236, v196, v164
    v_fmac_f32 v237, v197, v165
    v_fmac_f32 v238, v198, v166
    v_fmac_f32 v239, v199, v167
    v_fmac_f32 v240, v200, v164
    v_fmac_f32 v241, v201, v165
    v_fmac_f32 v242, v202, v166
    v_fmac_f32 v243, v203, v167
    v_fmac_f32 v244, v204, v164
    v_fmac_f32 v245, v205, v165
    v_fmac_f32 v246, v206, v166
    v_fmac_f32 v247, v207, v167
    v_fmac_f32 v216, v172, v168
    v_fmac_f32 v217, v173, v169
    v_fmac_f32 v218, v174, v170
    v_fmac_f32 v219, v175, v171
    v_fmac_f32 v220, v176, v168
    v_fmac_f32 v221, v177, v169
    v_fmac_f32 v222, v178, v170
    v_fmac_f32 v223, v179, v171
    v_fmac_f32 v224, v180, v168
    v_fmac_f32 v225, v181, v169
    v_fmac_f32 v226, v182, v170
    v_fmac_f32 v227, v183, v171
    v_fmac_f32 v228, v184, v168
    v_fmac_f32 v229, v185, v169
    v_fmac_f32 v230, v186, v170
    v_fmac_f32 v231, v187, v171
    v_fmac_f32 v232, v188, v168
    v_fmac_f32 v233, v189, v169
    v_fmac_f32 v234, v190, v170
    v_fmac_f32 v235, v191, v171
    v_fmac_f32 v236, v192, v168
    v_fmac_f32 v237, v193, v169
    v_fmac_f32 v238, v194, v170
    v_fmac_f32 v239, v195, v171
    v_fmac_f32 v240, v196, v168
    v_fmac_f32 v241, v197, v169
    v_fmac_f32 v242, v198, v170
    v_fmac_f32 v243, v199, v171
    v_fmac_f32 v244, v200, v168
    v_fmac_f32 v245, v201, v169
    v_fmac_f32 v246, v202, v170
    v_fmac_f32 v247, v203, v171
    s_waitcnt vmcnt(0)
    s_mov_b32 s12, 0
L_np:
    v_cmp_eq_u32 vcc, 0, v0
    s_cbranch_vccz L_nok
    buffer_load_dwordx2 v[0:1], v19, s[76:79], 0 offen sc1
    s_add_u32 s12, s12, 1
    s_waitcnt vmcnt(0)
    s_cmp_lt_u32 s12, 20000
    s_cbranch_scc1 L_np
L_nok:
    ds_write_b64 v21, v[0:1] offset:32
    v_xor_b32 v59, s14, v59
    v_cmp_ne_u64 vcc, v[58:59], v[0:1]
    s_cmp_eq_u64 vcc, 0
    s_cselect_b32 s14, 1, 0
    v_mov_b32 v58, s14
    ds_or_b32 v21, v58 offset:72
    v_lshlrev_b32 v172, 16, v124
    v_and_b32 v173, 0xffff0000, v124
    v_lshlrev_b32 v174, 16, v125
    v_and_b32 v175, 0xffff0000, v125
    v_lshlrev_b32 v176, 16, v128
    v_and_b32 v177, 0xffff0000, v128
    v_lshlrev_b32 v178, 16, v129
    v_and_b32 v179, 0xffff0000, v129
    v_lshlrev_b32 v180, 16, v132
    v_and_b32 v181, 0xffff0000, v132
    v_lshlrev_b32 v182, 16, v133
    v_and_b32 v183, 0xffff0000, v133
    v_lshlrev_b32 v184, 16, v136
    v_and_b32 v185, 0xffff0000, v136
    v_lshlrev_b32 v186, 16, v137
    v_and_b32 v187, 0xffff0000, v137
    v_lshlrev_b32 v188, 16, v140
    v_and_b32 v189, 0xffff0000, v140
    v_lshlrev_b32 v190, 16, v141
    v_and_b32 v191, 0xffff0000, v141
    v_lshlrev_b32 v192, 16, v144
    v_and_b32 v193, 0xffff0000, v144
    v_lshlrev_b32 v194, 16, v145
    v_and_b32 v195, 0xffff0000, v145
    v_lshlrev_b32 v196, 16, v148
    v_and_b32 v197, 0xffff0000, v148
    v_lshlrev_b32 v198, 16, v149
    v_and_b32 v199, 0xffff0000, v149
    v_lshlrev_b32 v200, 16, v152
    v_and_b32 v201, 0xffff0000, v152
    v_lshlrev_b32 v202, 16, v153
    v_and_b32 v203, 0xffff0000, v153
    v_mul_f32 v216, v216, v172
    v_mul_f32 v217, v217, v173
    v_mul_f32 v218, v218, v174
    v_mul_f32 v219, v219, v175
    v_mul_f32 v220, v220, v176
    v_mul_f32 v221, v221, v177
    v_mul_f32 v222, v222, v178
    v_mul_f32 v223, v223, v179
    v_mul_f32 v224, v224, v180
    v_mul_f32 v225, v225, v181
    v_mul_f32 v226, v226, v182
    v_mul_f32 v227, v227, v183
    v_mul_f32 v228, v228, v184
    v_mul_f32 v229, v229, v185
    v_mul_f32 v230, v230, v186
    v_mul_f32 v231, v231, v187
    v_mul_f32 v232, v232, v188
    v_mul_f32 v233, v233, v189
    v_mul_f32 v234, v234, v190
    v_mul_f32 v235, v235, v191
    v_mul_f32 v236, v236, v192
    v_mul_f32 v237, v237, v193
    v_mul_f32 v238, v238, v194
    v_mul_f32 v239, v239, v195
    v_mul_f32 v240, v240, v196
    v_mul_f32 v241, v241, v197
    v_mul_f32 v242, v242, v198
    v_mul_f32 v243, v243, v199
    v_mul_f32 v244, v244, v200
    v_mul_f32 v245, v245, v201
    v_mul_f32 v246, v246, v202
    v_mul_f32 v247, v247, v203
    v_cvt_pk_bf16_f32 v40, v244, v240
    v_cvt_pk_bf16_f32 v41, v236, v232
    v_cvt_pk_bf16_f32 v42, v228, v224
    v_cvt_pk_bf16_f32 v43, v220, v216
    v_cvt_pk_bf16_f32 v44, v245, v241
    v_cvt_pk_bf16_f32 v45, v237, v233
    v_cvt_pk_bf16_f32 v46, v229, v225
    v_cvt_pk_bf16_f32 v47, v221, v217
    v_cvt_pk_bf16_f32 v48, v246, v242
    v_cvt_pk_bf16_f32 v49, v238, v234
    v_cvt_pk_bf16_f32 v50, v230, v226
    v_cvt_pk_bf16_f32 v51, v222, v218
    v_cvt_pk_bf16_f32 v52, v247, v243
    v_cvt_pk_bf16_f32 v53, v239, v235
    v_cvt_pk_bf16_f32 v54, v231, v227
    v_cvt_pk_bf16_f32 v55, v223, v219
    s_cmp_eq_u32 s14, 1
    s_cbranch_scc1 L_xp0
    buffer_store_dwordx4 v[40:43], v8, s[64:67], 0 offen sc1
    buffer_store_dwordx4 v[44:47], v8, s[64:67], s32 offen sc1
    buffer_store_dwordx4 v[48:51], v8, s[64:67], s33 offen sc1
    buffer_store_dwordx4 v[52:55], v8, s[64:67], s34 offen sc1
    s_branch L_xq0
L_xp0:
    buffer_store_dwordx4 v[40:43], v8, s[64:67], 0 offen
    buffer_store_dwordx4 v[44:47], v8, s[64:67], s32 offen
    buffer_store_dwordx4 v[48:51], v8, s[64:67], s33 offen
    buffer_store_dwordx4 v[52:55], v8, s[64:67], s34 offen
L_xq0:
    v_lshlrev_b32 v156, 16, v72
    v_and_b32 v160, 0xffff0000, v72
    v_lshlrev_b32 v164, 16, v73
    v_and_b32 v168, 0xffff0000, v73
    v_lshlrev_b32 v157, 16, v74
    v_and_b32 v161, 0xffff0000, v74
    v_lshlrev_b32 v165, 16, v75
    v_and_b32 v169, 0xffff0000, v75
    v_lshlrev_b32 v158, 16, v76
    v_and_b32 v162, 0xffff0000, v76
    v_lshlrev_b32 v166, 16, v77
    v_and_b32 v170, 0xffff0000, v77
    v_lshlrev_b32 v159, 16, v78
    v_and_b32 v163, 0xffff0000, v78
    v_lshlrev_b32 v167, 16, v79
    v_and_b32 v171, 0xffff0000, v79
    v_lshlrev_b32 v172, 16, v82
    v_and_b32 v173, 0xffff0000, v82
    v_lshlrev_b32 v174, 16, v83
    v_and_b32 v175, 0xffff0000, v83
    v_lshlrev_b32 v176, 16, v86
    v_and_b32 v177, 0xffff0000, v86
    v_lshlrev_b32 v178, 16, v87
    v_and_b32 v179, 0xffff0000, v87
    v_lshlrev_b32 v180, 16, v90
    v_and_b32 v181, 0xffff0000, v90
    v_lshlrev_b32 v182, 16, v91
    v_and_b32 v183, 0xffff0000, v91
    v_lshlrev_b32 v184, 16, v94
    v_and_b32 v185, 0xffff0000, v94
    v_lshlrev_b32 v186, 16, v95
    v_and_b32 v187, 0xffff0000, v95
    v_lshlrev_b32 v188, 16, v98
    v_and_b32 v189, 0xffff0000, v98
    v_lshlrev_b32 v190, 16, v99
    v_and_b32 v191, 0xffff0000, v99
    v_lshlrev_b32 v192, 16, v102
    v_and_b32 v193, 0xffff0000, v102
    v_lshlrev_b32 v194, 16, v103
    v_and_b32 v195, 0xffff0000, v103
    v_lshlrev_b32 v196, 16, v106
    v_and_b32 v197, 0xffff0000, v106
    v_lshlrev_b32 v198, 16, v107
    v_and_b32 v199, 0xffff0000, v107
    v_lshlrev_b32 v200, 16, v110
    v_and_b32 v201, 0xffff0000, v110
    v_lshlrev_b32 v202, 16, v111
    v_and_b32 v203, 0xffff0000, v111
    v_lshlrev_b32 v204, 16, v114
    v_and_b32 v205, 0xffff0000, v114
    v_lshlrev_b32 v206, 16, v115
    v_and_b32 v207, 0xffff0000, v115
    v_lshlrev_b32 v208, 16, v118
    v_and_b32 v209, 0xffff0000, v118
    v_lshlrev_b32 v210, 16, v119
    v_and_b32 v211, 0xffff0000, v119
    v_lshlrev_b32 v212, 16, v122
    v_and_b32 v213, 0xffff0000, v122
    v_lshlrev_b32 v214, 16, v123
    v_and_b32 v215, 0xffff0000, v123
    v_mul_f32 v216, v184, v156
    v_mul_f32 v217, v185, v157
    v_mul_f32 v218, v186, v158
    v_mul_f32 v219, v187, v159
    v_mul_f32 v220, v188, v156
    v_mul_f32 v221, v189, v157
    v_mul_f32 v222, v190, v158
    v_mul_f32 v223, v191, v159
    v_mul_f32 v224, v192, v156
    v_mul_f32 v225, v193, v157
    v_mul_f32 v226, v194, v158
    v_mul_f32 v227, v195, v159
    v_mul_f32 v228, v196, v156
    v_mul_f32 v229, v197, v157
    v_mul_f32 v230, v198, v158
    v_mul_f32 v231, v199, v159
    v_mul_f32 v232, v200, v156
    v_mul_f32 v233, v201, v157
    v_mul_f32 v234, v202, v158
    v_mul_f32 v235, v203, v159
    v_mul_f32 v236, v204, v156
    v_mul_f32 v237, v205, v157
    v_mul_f32 v238, v206, v158
    v_mul_f32 v239, v207, v159
    v_mul_f32 v240, v208, v156
    v_mul_f32 v241, v209, v157
    v_mul_f32 v242, v210, v158
    v_mul_f32 v243, v211, v159
    v_mul_f32 v244, v212, v156
    v_mul_f32 v245, v213, v157
    v_mul_f32 v246, v214, v158
    v_mul_f32 v247, v215, v159
    v_fmac_f32 v216, v180, v160
    v_fmac_f32 v217, v181, v161
    v_fmac_f32 v218, v182, v162
    v_fmac_f32 v219, v183, v163
    v_fmac_f32 v220, v184, v160
    v_fmac_f32 v221, v185, v161
    v_fmac_f32 v222, v186, v162
    v_fmac_f32 v223, v187, v163
    v_fmac_f32 v224, v188, v160
    v_fmac_f32 v225, v189, v161
    v_fmac_f32 v226, v190, v162
    v_fmac_f32 v227, v191, v163
    v_fmac_f32 v228, v192, v160
    v_fmac_f32 v229, v193, v161
    v_fmac_f32 v230, v194, v162
    v_fmac_f32 v231, v195, v163
    v_fmac_f32 v232, v196, v160
    v_fmac_f32 v233, v197, v161
    v_fmac_f32 v234, v198, v162
    v_fmac_f32 v235, v199, v163
    v_fmac_f32 v236, v200, v160
    v_fmac_f32 v237, v201, v161
    v_fmac_f32 v238, v202, v162
    v_fmac_f32 v239, v203, v163
    v_fmac_f32 v240, v204, v160
    v_fmac_f32 v241, v205, v161
    v_fmac_f32 v242, v206, v162
    v_fmac_f32 v243, v207, v163
    v_fmac_f32 v244, v208, v160
    v_fmac_f32 v245, v209, v161
    v_fmac_f32 v246, v210, v162
    v_fmac_f32 v247, v211, v163
    v_fmac_f32 v216, v176, v164
    v_fmac_f32 v217, v177, v165
    v_fmac_f32 v218, v178, v166
    v_fmac_f32 v219, v179, v167
    v_fmac_f32 v220, v180, v164
    v_fmac_f32 v221, v181, v165
    v_fmac_f32 v222, v182, v166
    v_fmac_f32 v223, v183, v167
    v_fmac_f32 v224, v184, v164
    v_fmac_f32 v225, v185, v165
    v_fmac_f32 v226, v186, v166
    v_fmac_f32 v227, v187, v167
    v_fmac_f32 v228, v188, v164
    v_fmac_f32 v229, v189, v165
    v_fmac_f32 v230, v190, v166
    v_fmac_f32 v231, v191, v167
    v_fmac_f32 v232, v192, v164
    v_fmac_f32 v233, v193, v165
    v_fmac_f32 v234, v194, v166
    v_fmac_f32 v235, v195, v167
    v_fmac_f32 v236, v196, v164
    v_fmac_f32 v237, v197, v165
    v_fmac_f32 v238, v198, v166
    v_fmac_f32 v239, v199, v167
    v_fmac_f32 v240, v200, v164
    v_fmac_f32 v241, v201, v165
    v_fmac_f32 v242, v202, v166
    v_fmac_f32 v243, v203, v167
    v_fmac_f32 v244, v204, v164
    v_fmac_f32 v245, v205, v165
    v_fmac_f32 v246, v206, v166
    v_fmac_f32 v247, v207, v167
    v_fmac_f32 v216, v172, v168
    v_fmac_f32 v217, v173, v169
    v_fmac_f32 v218, v174, v170
    v_fmac_f32 v219, v175, v171
    v_fmac_f32 v220, v176, v168
    v_fmac_f32 v221, v177, v169
    v_fmac_f32 v222, v178, v170
    v_fmac_f32 v223, v179, v171
    v_fmac_f32 v224, v180, v168
    v_fmac_f32 v225, v181, v169
    v_fmac_f32 v226, v182, v170
    v_fmac_f32 v227, v183, v171
    v_fmac_f32 v228, v184, v168
    v_fmac_f32 v229, v185, v169
    v_fmac_f32 v230, v186, v170
    v_fmac_f32 v231, v187, v171
    v_fmac_f32 v232, v188, v168
    v_fmac_f32 v233, v189, v169
    v_fmac_f32 v234, v190, v170
    v_fmac_f32 v235, v191, v171
    v_fmac_f32 v236, v192, v168
    v_fmac_f32 v237, v193, v169
    v_fmac_f32 v238, v194, v170
    v_fmac_f32 v239, v195, v171
    v_fmac_f32 v240, v196, v168
    v_fmac_f32 v241, v197, v169
    v_fmac_f32 v242, v198, v170
    v_fmac_f32 v243, v199, v171
    v_fmac_f32 v244, v200, v168
    v_fmac_f32 v245, v201, v169
    v_fmac_f32 v246, v202, v170
    v_fmac_f32 v247, v203, v171
    v_lshlrev_b32 v172, 16, v126
    v_and_b32 v173, 0xffff0000, v126
    v_lshlrev_b32 v174, 16, v127
    v_and_b32 v175, 0xffff0000, v127
    v_lshlrev_b32 v176, 16, v130
    v_and_b32 v177, 0xffff0000, v130
    v_lshlrev_b32 v178, 16, v131
    v_and_b32 v179, 0xffff0000, v131
    v_lshlrev_b32 v180, 16, v134
    v_and_b32 v181, 0xffff0000, v134
    v_lshlrev_b32 v182, 16, v135
    v_and_b32 v183, 0xffff0000, v135
    v_lshlrev_b32 v184, 16, v138
    v_and_b32 v185, 0xffff0000, v138
    v_lshlrev_b32 v186, 16, v139
    v_and_b32 v187, 0xffff0000, v139
    v_lshlrev_b32 v188, 16, v142
    v_and_b32 v189, 0xffff0000, v142
    v_lshlrev_b32 v190, 16, v143
    v_and_b32 v191, 0xffff0000, v143
    v_lshlrev_b32 v192, 16, v146
    v_and_b32 v193, 0xffff0000, v146
    v_lshlrev_b32 v194, 16, v147
    v_and_b32 v195, 0xffff0000, v147
    v_lshlrev_b32 v196, 16, v150
    v_and_b32 v197, 0xffff0000, v150
    v_lshlrev_b32 v198, 16, v151
    v_and_b32 v199, 0xffff0000, v151
    v_lshlrev_b32 v200, 16, v154
    v_and_b32 v201, 0xffff0000, v154
    v_lshlrev_b32 v202, 16, v155
    v_and_b32 v203, 0xffff0000, v155
    v_mul_f32 v216, v216, v172
    v_mul_f32 v217, v217, v173
    v_mul_f32 v218, v218, v174
    v_mul_f32 v219, v219, v175
    v_mul_f32 v220, v220, v176
    v_mul_f32 v221, v221, v177
    v_mul_f32 v222, v222, v178
    v_mul_f32 v223, v223, v179
    v_mul_f32 v224, v224, v180
    v_mul_f32 v225, v225, v181
    v_mul_f32 v226, v226, v182
    v_mul_f32 v227, v227, v183
    v_mul_f32 v228, v228, v184
    v_mul_f32 v229, v229, v185
    v_mul_f32 v230, v230, v186
    v_mul_f32 v231, v231, v187
    v_mul_f32 v232, v232, v188
    v_mul_f32 v233, v233, v189
    v_mul_f32 v234, v234, v190
    v_mul_f32 v235, v235, v191
    v_mul_f32 v236, v236, v192
    v_mul_f32 v237, v237, v193
    v_mul_f32 v238, v238, v194
    v_mul_f32 v239, v239, v195
    v_mul_f32 v240, v240, v196
    v_mul_f32 v241, v241, v197
    v_mul_f32 v242, v242, v198
    v_mul_f32 v243, v243, v199
    v_mul_f32 v244, v244, v200
    v_mul_f32 v245, v245, v201
    v_mul_f32 v246, v246, v202
    v_mul_f32 v247, v247, v203
    v_cvt_pk_bf16_f32 v40, v244, v240
    v_cvt_pk_bf16_f32 v41, v236, v232
    v_cvt_pk_bf16_f32 v42, v228, v224
    v_cvt_pk_bf16_f32 v43, v220, v216
    v_cvt_pk_bf16_f32 v44, v245, v241
    v_cvt_pk_bf16_f32 v45, v237, v233
    v_cvt_pk_bf16_f32 v46, v229, v225
    v_cvt_pk_bf16_f32 v47, v221, v217
    v_cvt_pk_bf16_f32 v48, v246, v242
    v_cvt_pk_bf16_f32 v49, v238, v234
    v_cvt_pk_bf16_f32 v50, v230, v226
    v_cvt_pk_bf16_f32 v51, v222, v218
    v_cvt_pk_bf16_f32 v52, v247, v243
    v_cvt_pk_bf16_f32 v53, v239, v235
    v_cvt_pk_bf16_f32 v54, v231, v227
    v_cvt_pk_bf16_f32 v55, v223, v219
    s_cmp_eq_u32 s14, 1
    s_cbranch_scc1 L_xp1
    buffer_store_dwordx4 v[40:43], v9, s[64:67], 0 offen sc1
    buffer_store_dwordx4 v[44:47], v9, s[64:67], s32 offen sc1
    buffer_store_dwordx4 v[48:51], v9, s[64:67], s33 offen sc1
    buffer_store_dwordx4 v[52:55], v9, s[64:67], s34 offen sc1
    s_branch L_xq1
L_xp1:
    buffer_store_dwordx4 v[40:43], v9, s[64:67], 0 offen
    buffer_store_dwordx4 v[44:47], v9, s[64:67], s32 offen
    buffer_store_dwordx4 v[48:51], v9, s[64:67], s33 offen
    buffer_store_dwordx4 v[52:55], v9, s[64:67], s34 offen
L_xq1:
    s_waitcnt vmcnt(0)
    s_mov_b64 exec, 1
    s_cmp_eq_u32 s14, 1
    s_cbranch_scc0 L_xf0
    buffer_store_dwordx2 v[0:1], v19, s[72:75], s13 offen
    s_branch L_xf1
L_xf0:
    buffer_store_dwordx2 v[0:1], v19, s[72:75], s13 offen sc1
L_xf1:
    s_mov_b64 exec, -1
    s_cmp_eq_u32 s8, 3
    s_cbranch_scc0 L_id2
    s_mov_b32 s15, 0
L_i2_w:
    ds_read_b64 v[60:61], v21 offset:16
    s_waitcnt lgkmcnt(0)
    v_min_u32 v60, v60, v61
    v_cmp_gt_u32 vcc, 14, v60
    s_cbranch_vccz L_i2_ok
    s_sleep 2
    s_add_u32 s15, s15, 1
    s_cmp_lt_u32 s15, 160000
    s_cbranch_scc1 L_i2_w
L_i2_ok:
    s_mov_b32 s15, 0
LK_poll:
    buffer_load_dwordx2 v[60:61], v20, s[72:75], 0 offen sc1
    s_waitcnt vmcnt(0)
    v_cmp_ne_u64 vcc, v[60:61], v[0:1]
    s_cbranch_vccz LK_ok
    s_add_u32 s15, s15, 1
    s_cmp_lt_u32 s15, 20000
    s_cbranch_scc1 LK_poll
LK_ok:
    ds_write_b32 v21, v25 offset:44
L_id2:
    s_mov_b32 s15, 0
L_is1_w:
    ds_read_b32 v60, v21 offset:40
    s_waitcnt lgkmcnt(0)
    v_cmp_gt_u32 vcc, 2, v60
    s_cbranch_vccz L_is1_ok
    s_sleep 2
    s_add_u32 s15, s15, 1
    s_cmp_lt_u32 s15, 160000
    s_cbranch_scc1 L_is1_w
L_is1_ok:
    buffer_load_dwordx4 v[192:195], v26, s[68:71], s36 offen offset:0 nt
    buffer_load_dwordx4 v[196:199], v26, s[68:71], s36 offen offset:1024 nt
    buffer_load_dwordx4 v[200:203], v26, s[68:71], s36 offen offset:2048 nt
    buffer_load_dwordx4 v[204:207], v26, s[68:71], s36 offen offset:3072 nt
L_t2:
    s_mov_b32 s52, s50
    s_mov_b32 s53, s51
    s_mov_b32 s54, 4194304
    s_mov_b32 s55, 0x00020000
    s_mov_b32 s56, s50
    s_mov_b32 s57, s51
    s_mov_b32 s58, 4194304
    s_mov_b32 s59, 0x00020000
    s_mov_b32 s60, s16
    s_mov_b32 s61, s17
    s_mov_b32 s62, 4194304
    s_mov_b32 s63, 0x00020000
    s_mov_b32 s64, s46
    s_mov_b32 s65, s47
    s_mov_b32 s66, 16777216
    s_mov_b32 s67, 0x00020000
    s_mov_b32 s15, 0
L_fk_w:
    ds_read_b32 v60, v21 offset:44
    s_waitcnt lgkmcnt(0)
    v_cmp_gt_u32 vcc, 1, v60
    s_cbranch_vccz L_fk_ok
    s_sleep 1
    s_add_u32 s15, s15, 1
    s_cmp_lt_u32 s15, 160000
    s_cbranch_scc1 L_fk_w
L_fk_ok:
    ds_read_b64 v[0:1], v21 offset:32
    buffer_load_dwordx4 v[224:227], v26, s[52:55], s36 offen offset:0 sc1
    buffer_load_dwordx4 v[228:231], v26, s[52:55], s36 offen offset:1024 sc1
    buffer_load_dwordx4 v[232:235], v26, s[52:55], s36 offen offset:2048 sc1
    buffer_load_dwordx4 v[236:239], v26, s[52:55], s36 offen offset:3072 sc1
    buffer_load_dwordx2 v[4:5], v16, s[60:63], 0 offen offset:0 nt
    buffer_load_dwordx2 v[6:7], v16, s[60:63], 0 offen offset:2048 nt
    s_waitcnt vmcnt(9)
    buffer_load_dwordx2 v[8:9], v16, s[60:63], s32 offen offset:0 nt
    s_waitcnt vmcnt(9)
    buffer_load_dwordx2 v[10:11], v16, s[60:63], s32 offen offset:2048 nt
    s_waitcnt vmcnt(9)
    buffer_load_dwordx2 v[14:15], v16, s[60:63], s33 offen offset:0 nt
    s_waitcnt vmcnt(9)
    buffer_load_dwordx2 v[56:57], v16, s[60:63], s33 offen offset:2048 nt
    s_waitcnt vmcnt(9)
    buffer_load_dwordx2 v[58:59], v16, s[60:63], s34 offen offset:0 nt
    s_waitcnt vmcnt(9)
    buffer_load_dwordx2 v[34:35], v16, s[60:63], s34 offen offset:2048 nt
    s_lshl_b32 s14, s9, 13
    s_lshl_b32 s10, s11, 12
    s_add_u32 s14, s14, s10
    s_mov_b32 s15, 0
L_c1_w:
    ds_read_b128 v[60:63], v21 offset:0
    s_waitcnt lgkmcnt(0)
    v_min3_u32 v60, v60, v61, v62
    v_min_u32 v60, v60, v63
    v_cmp_gt_u32 vcc, 14, v60
    s_cbranch_vccz L_c1_ok
    s_sleep 1
    s_add_u32 s15, s15, 1
    s_cmp_lt_u32 s15, 160000
    s_cbranch_scc1 L_c1_w
L_c1_ok:
    s_waitcnt vmcnt(9)
    s_bfe_u32 s13, s37, 0 + (4 << 16)
    s_lshl_b32 s13, s13, 7
    s_add_u32 m0, s14, 0
    s_nop 0
    buffer_load_dwordx4 v12, s[80:83], s13 offen offset:0 lds
    s_waitcnt vmcnt(9)
    buffer_load_dwordx4 v13, s[80:83], s13 offen offset:1024 lds
    s_waitcnt vmcnt(9)
    buffer_load_dwordx4 v12, s[80:83], s13 offen offset:2048 lds
    s_waitcnt vmcnt(9)
    buffer_load_dwordx4 v13, s[80:83], s13 offen offset:3072 lds
    s_waitcnt vmcnt(9)
    s_bfe_u32 s13, s37, 4 + (4 << 16)
    s_lshl_b32 s13, s13, 7
    s_add_u32 m0, s14, 16384
    s_nop 0
    buffer_load_dwordx4 v12, s[80:83], s13 offen offset:0 lds
    s_waitcnt vmcnt(9)
    buffer_load_dwordx4 v13, s[80:83], s13 offen offset:1024 lds
    s_waitcnt vmcnt(9)
    buffer_load_dwordx4 v12, s[80:83], s13 offen offset:2048 lds
    s_waitcnt vmcnt(9)
    buffer_load_dwordx4 v13, s[80:83], s13 offen offset:3072 lds
    s_waitcnt vmcnt(9)
    s_bfe_u32 s13, s37, 8 + (4 << 16)
    s_lshl_b32 s13, s13, 7
    s_add_u32 m0, s14, 32768
    s_nop 0
    buffer_load_dwordx4 v12, s[80:83], s13 offen offset:0 lds
    s_waitcnt vmcnt(9)
    buffer_load_dwordx4 v13, s[80:83], s13 offen offset:1024 lds
    s_waitcnt vmcnt(9)
    buffer_load_dwordx4 v12, s[80:83], s13 offen offset:2048 lds
    s_waitcnt vmcnt(9)
    buffer_load_dwordx4 v13, s[80:83], s13 offen offset:3072 lds
    s_bitcmp1_b32 s100, 0
    s_cselect_b32 s10, 16, 0
    s_lshr_b32 s31, s31, s10
    s_and_b32 s31, s31, 0xffff
    v_lshlrev_b32 v60, 3, v27
    v_sub_u32 v60, v60, v17
    v_add_u32 v60, -9, v60
    v_and_b32 v61, 1, v60
    v_lshlrev_b32 v61, 4, v61
    v_lshlrev_b32 v61, v61, s31
    v_ashrrev_i32 v60, 1, v60
    v_cmp_eq_u32 vcc, 0, v60
    s_nop 1
    v_cndmask_b32 v36, 0, v61, vcc
    v_cmp_eq_u32 vcc, 1, v60
    s_nop 1
    v_cndmask_b32 v37, 0, v61, vcc
    v_cmp_eq_u32 vcc, 2, v60
    s_nop 1
    v_cndmask_b32 v38, 0, v61, vcc
    v_cmp_eq_u32 vcc, 3, v60
    s_nop 1
    v_cndmask_b32 v39, 0, v61, vcc
    v_mov_b32 v128, 0
    v_mov_b32 v129, 0
    v_mov_b32 v130, 0
    v_mov_b32 v131, 0
    v_and_b32 v60, 1, v27
    v_lshlrev_b32 v60, 9, v60
    v_lshl_add_u32 v60, v17, 5, v60
    v_lshrrev_b32 v61, 1, v27
    v_lshl_add_u32 v17, v61, 4, v60
    v_and_b32 v60, 1, v2
    v_lshrrev_b32 v61, 5, v2
    v_lshl_add_u32 v60, v60, 1, v61
    v_bfe_u32 v61, v2, 1, 4
    v_lshl_add_u32 v60, v60, 4, v61
    v_lshlrev_b32 v17, 2, v60
    s_waitcnt vmcnt(24)
    v_mov_b32 v208, 0
    v_alignbit_b32 v209, v193, v192, 16
    v_alignbit_b32 v210, v194, v193, 16
    v_alignbit_b32 v211, v195, v194, 16
    s_nop 0
    v_mov_b32_dpp v208, v195 wave_shr:1 row_mask:0xf bank_mask:0xf
    v_alignbit_b32 v208, v192, v208, 16
    v_readlane_b32 s10, v195, 63
    v_alignbit_b32 v213, v197, v196, 16
    v_alignbit_b32 v214, v198, v197, 16
    v_mov_b32 v212, s10
    v_alignbit_b32 v215, v199, v198, 16
    s_nop 0
    v_mov_b32_dpp v212, v199 wave_shr:1 row_mask:0xf bank_mask:0xf
    v_alignbit_b32 v212, v196, v212, 16
    v_readlane_b32 s10, v199, 63
    v_alignbit_b32 v217, v201, v200, 16
    v_alignbit_b32 v218, v202, v201, 16
    v_mov_b32 v216, s10
    v_alignbit_b32 v219, v203, v202, 16
    s_nop 0
    v_mov_b32_dpp v216, v203 wave_shr:1 row_mask:0xf bank_mask:0xf
    v_alignbit_b32 v216, v200, v216, 16
    v_readlane_b32 s10, v203, 63
    v_alignbit_b32 v221, v205, v204, 16
    v_alignbit_b32 v222, v206, v205, 16
    v_mov_b32 v220, s10
    v_alignbit_b32 v223, v207, v206, 16
    s_nop 0
    v_mov_b32_dpp v220, v207 wave_shr:1 row_mask:0xf bank_mask:0xf
    v_alignbit_b32 v220, v204, v220, 16
    s_mov_b32 s15, 0
L_c2_w:
    ds_read_b128 v[60:63], v21 offset:0
    s_waitcnt lgkmcnt(0)
    v_min3_u32 v60, v60, v61, v62
    v_min_u32 v60, v60, v63
    v_cmp_gt_u32 vcc, 16, v60
    s_cbranch_vccz L_c2_ok
    s_sleep 1
    s_add_u32 s15, s15, 1
    s_cmp_lt_u32 s15, 160000
    s_cbranch_scc1 L_c2_w
L_c2_ok:
    s_setprio 0
    ds_write_b128 v18, v[128:131]
    v_add_u32 v62, -8288, v33
    ds_write_b128 v62, v[192:195] offset:0
    ds_write_b128 v62, v[196:199] offset:1024
    ds_write_b128 v62, v[200:203] offset:2048
    ds_write_b128 v62, v[204:207] offset:3072
    ds_write_b128 v62, v[208:211] offset:4160
    ds_write_b128 v62, v[212:215] offset:5184
    ds_write_b128 v62, v[216:219] offset:6208
    ds_write_b128 v62, v[220:223] offset:7232
    ds_read2_b32 v[128:129], v28 offset0:0 offset1:1
    ds_read2_b32 v[130:131], v28 offset0:2 offset1:3
    ds_read2_b32 v[132:133], v28 offset0:128 offset1:129
    ds_read2_b32 v[134:135], v28 offset0:130 offset1:131
    ds_read2_b32 v[136:137], v29 offset0:0 offset1:1
    ds_read2_b32 v[138:139], v29 offset0:2 offset1:3
    ds_read2_b32 v[140:141], v29 offset0:128 offset1:129
    ds_read2_b32 v[142:143], v29 offset0:130 offset1:131
    ds_read2_b32 v[144:145], v30 offset0:0 offset1:1
    ds_read2_b32 v[146:147], v30 offset0:2 offset1:3
    ds_read2_b32 v[148:149], v30 offset0:128 offset1:129
    ds_read2_b32 v[150:151], v30 offset0:130 offset1:131
    ds_read2_b32 v[152:153], v31 offset0:0 offset1:1
    ds_read2_b32 v[154:155], v31 offset0:2 offset1:3
    ds_read2_b32 v[156:157], v31 offset0:128 offset1:129
    ds_read2_b32 v[158:159], v31 offset0:130 offset1:131
    s_waitcnt vmcnt(23)
    ds_write_b128 v33, v[224:227] offset:0
    s_waitcnt vmcnt(22)
    ds_write_b128 v33, v[228:231] offset:1024
    s_waitcnt vmcnt(21)
    ds_write_b128 v33, v[232:235] offset:2048
    s_waitcnt vmcnt(20)
    ds_write_b128 v33, v[236:239] offset:3072
    ds_read_b128 v[160:163], v32 offset:3584
    ds_read_b128 v[164:167], v32 offset:3072
    ds_read_b128 v[168:171], v32 offset:2560
    ds_read_b128 v[172:175], v32 offset:2048
    ds_read_b128 v[176:179], v32 offset:1536
    ds_read_b128 v[180:183], v32 offset:1024
    ds_read_b128 v[184:187], v32 offset:512
    ds_read_b128 v[188:191], v32 offset:0
    s_setprio 2
    s_waitcnt lgkmcnt(0)
    v_mfma_f32_16x16x32_bf16 v[96:99], v[36:39], v[160:163], 0
    v_mfma_f32_16x16x32_bf16 v[100:103], v[36:39], v[164:167], 0
    v_mfma_f32_16x16x32_bf16 v[104:107], v[36:39], v[168:171], 0
    v_mfma_f32_16x16x32_bf16 v[108:111], v[36:39], v[172:175], 0
    v_mfma_f32_16x16x32_bf16 v[112:115], v[36:39], v[176:179], 0
    v_mfma_f32_16x16x32_bf16 v[116:119], v[36:39], v[180:183], 0
    v_mfma_f32_16x16x32_bf16 v[120:123], v[36:39], v[184:187], 0
    v_mfma_f32_16x16x32_bf16 v[124:127], v[36:39], v[188:191], 0
    v_mfma_f32_16x16x32_bf16 v[96:99], v[128:131], v[160:163], v[96:99]
    ds_read2_b32 v[192:193], v28 offset0:16 offset1:17
    s_bfe_u32 s13, s37, 12 + (4 << 16)
    s_lshl_b32 s13, s13, 7
    s_add_u32 m0, s14, 49152
    s_nop 0
    buffer_load_dwordx4 v12, s[80:83], s13 offen offset:0 lds
    v_mfma_f32_16x16x32_bf16 v[100:103], v[128:131], v[164:167], v[100:103]
    ds_read2_b32 v[194:195], v28 offset0:18 offset1:19
    v_mfma_f32_16x16x32_bf16 v[104:107], v[128:131], v[168:171], v[104:107]
    ds_read_b128 v[224:227], v32 offset:3648
    v_mfma_f32_16x16x32_bf16 v[108:111], v[128:131], v[172:175], v[108:111]
    ds_read2_b32 v[196:197], v28 offset0:144 offset1:145
    v_mfma_f32_16x16x32_bf16 v[112:115], v[128:131], v[176:179], v[112:115]
    ds_read2_b32 v[198:199], v28 offset0:146 offset1:147
    v_mfma_f32_16x16x32_bf16 v[116:119], v[128:131], v[180:183], v[116:119]
    ds_read_b128 v[228:231], v32 offset:3136
    v_mfma_f32_16x16x32_bf16 v[120:123], v[128:131], v[184:187], v[120:123]
    ds_read2_b32 v[200:201], v29 offset0:16 offset1:17
    v_mfma_f32_16x16x32_bf16 v[124:127], v[128:131], v[188:191], v[124:127]
    ds_read2_b32 v[202:203], v29 offset0:18 offset1:19
    v_mfma_f32_16x16x32_bf16 v[100:103], v[132:135], v[160:163], v[100:103]
    ds_read_b128 v[232:235], v32 offset:2624
    buffer_load_dwordx4 v13, s[80:83], s13 offen offset:1024 lds
    v_mfma_f32_16x16x32_bf16 v[104:107], v[132:135], v[164:167], v[104:107]
    ds_read2_b32 v[204:205], v29 offset0:144 offset1:145
    v_mfma_f32_16x16x32_bf16 v[108:111], v[132:135], v[168:171], v[108:111]
    ds_read2_b32 v[206:207], v29 offset0:146 offset1:147
    v_mfma_f32_16x16x32_bf16 v[112:115], v[132:135], v[172:175], v[112:115]
    ds_read_b128 v[236:239], v32 offset:2112
    v_mfma_f32_16x16x32_bf16 v[116:119], v[132:135], v[176:179], v[116:119]
    ds_read2_b32 v[208:209], v30 offset0:16 offset1:17
    v_mfma_f32_16x16x32_bf16 v[120:123], v[132:135], v[180:183], v[120:123]
    ds_read2_b32 v[210:211], v30 offset0:18 offset1:19
    v_mfma_f32_16x16x32_bf16 v[124:127], v[132:135], v[184:187], v[124:127]
    ds_read_b128 v[240:243], v32 offset:1600
    v_mfma_f32_16x16x32_bf16 v[104:107], v[136:139], v[160:163], v[104:107]
    ds_read2_b32 v[212:213], v30 offset0:144 offset1:145
    v_mfma_f32_16x16x32_bf16 v[108:111], v[136:139], v[164:167], v[108:111]
    ds_read2_b32 v[214:215], v30 offset0:146 offset1:147
    buffer_load_dwordx4 v12, s[80:83], s13 offen offset:2048 lds
    v_mfma_f32_16x16x32_bf16 v[112:115], v[136:139], v[168:171], v[112:115]
    ds_read_b128 v[244:247], v32 offset:1088
    v_mfma_f32_16x16x32_bf16 v[116:119], v[136:139], v[172:175], v[116:119]
    ds_read2_b32 v[216:217], v31 offset0:16 offset1:17
    v_mfma_f32_16x16x32_bf16 v[120:123], v[136:139], v[176:179], v[120:123]
    ds_read2_b32 v[218:219], v31 offset0:18 offset1:19
    v_mfma_f32_16x16x32_bf16 v[124:127], v[136:139], v[180:183], v[124:127]
    ds_read_b128 v[248:251], v32 offset:576
    v_mfma_f32_16x16x32_bf16 v[108:111], v[140:143], v[160:163], v[108:111]
    ds_read2_b32 v[220:221], v31 offset0:144 offset1:145
    v_mfma_f32_16x16x32_bf16 v[112:115], v[140:143], v[164:167], v[112:115]
    ds_read2_b32 v[222:223], v31 offset0:146 offset1:147
    v_mfma_f32_16x16x32_bf16 v[116:119], v[140:143], v[168:171], v[116:119]
    ds_read_b128 v[252:255], v32 offset:64
    v_mfma_f32_16x16x32_bf16 v[120:123], v[140:143], v[172:175], v[120:123]
    buffer_load_dwordx4 v13, s[80:83], s13 offen offset:3072 lds
    v_mfma_f32_16x16x32_bf16 v[124:127], v[140:143], v[176:179], v[124:127]
    v_mfma_f32_16x16x32_bf16 v[112:115], v[144:147], v[160:163], v[112:115]
    v_mfma_f32_16x16x32_bf16 v[116:119], v[144:147], v[164:167], v[116:119]
    v_mfma_f32_16x16x32_bf16 v[120:123], v[144:147], v[168:171], v[120:123]
    v_mfma_f32_16x16x32_bf16 v[124:127], v[144:147], v[172:175], v[124:127]
    v_mfma_f32_16x16x32_bf16 v[116:119], v[148:151], v[160:163], v[116:119]
    v_mfma_f32_16x16x32_bf16 v[120:123], v[148:151], v[164:167], v[120:123]
    v_mfma_f32_16x16x32_bf16 v[124:127], v[148:151], v[168:171], v[124:127]
    s_bfe_u32 s13, s30, 28 + (4 << 16)
    s_lshl_b32 s13, s13, 7
    buffer_load_dwordx4 v[40:43], v12, s[80:83], s13 offen offset:0
    v_mfma_f32_16x16x32_bf16 v[120:123], v[152:155], v[160:163], v[120:123]
    v_mfma_f32_16x16x32_bf16 v[124:127], v[152:155], v[164:167], v[124:127]
    v_mfma_f32_16x16x32_bf16 v[124:127], v[156:159], v[160:163], v[124:127]
    s_waitcnt lgkmcnt(0)
    v_mfma_f32_16x16x32_bf16 v[96:99], v[192:195], v[224:227], v[96:99]
    ds_read2_b32 v[128:129], v28 offset0:32 offset1:33
    v_mfma_f32_16x16x32_bf16 v[100:103], v[192:195], v[228:231], v[100:103]
    ds_read2_b32 v[130:131], v28 offset0:34 offset1:35
    v_mfma_f32_16x16x32_bf16 v[104:107], v[192:195], v[232:235], v[104:107]
    ds_read_b128 v[160:163], v32 offset:3712
    v_mfma_f32_16x16x32_bf16 v[108:111], v[192:195], v[236:239], v[108:111]
    ds_read2_b32 v[132:133], v28 offset0:160 offset1:161
    v_mfma_f32_16x16x32_bf16 v[112:115], v[192:195], v[240:243], v[112:115]
    ds_read2_b32 v[134:135], v28 offset0:162 offset1:163
    buffer_load_dwordx4 v[44:47], v13, s[80:83], s13 offen offset:1024
    v_mfma_f32_16x16x32_bf16 v[116:119], v[192:195], v[244:247], v[116:119]
    ds_read_b128 v[164:167], v32 offset:3200
    v_mfma_f32_16x16x32_bf16 v[120:123], v[192:195], v[248:251], v[120:123]
    ds_read2_b32 v[136:137], v29 offset0:32 offset1:33
    v_mfma_f32_16x16x32_bf16 v[124:127], v[192:195], v[252:255], v[124:127]
    ds_read2_b32 v[138:139], v29 offset0:34 offset1:35
    v_mfma_f32_16x16x32_bf16 v[100:103], v[196:199], v[224:227], v[100:103]
    ds_read_b128 v[168:171], v32 offset:2688
    v_mfma_f32_16x16x32_bf16 v[104:107], v[196:199], v[228:231], v[104:107]
    ds_read2_b32 v[140:141], v29 offset0:160 offset1:161
    v_mfma_f32_16x16x32_bf16 v[108:111], v[196:199], v[232:235], v[108:111]
    ds_read2_b32 v[142:143], v29 offset0:162 offset1:163
    v_mfma_f32_16x16x32_bf16 v[112:115], v[196:199], v[236:239], v[112:115]
    ds_read_b128 v[172:175], v32 offset:2176
    v_mfma_f32_16x16x32_bf16 v[116:119], v[196:199], v[240:243], v[116:119]
    ds_read2_b32 v[144:145], v30 offset0:32 offset1:33
    buffer_load_dwordx4 v[48:51], v12, s[80:83], s13 offen offset:2048
    v_mfma_f32_16x16x32_bf16 v[120:123], v[196:199], v[244:247], v[120:123]
    ds_read2_b32 v[146:147], v30 offset0:34 offset1:35
    v_mfma_f32_16x16x32_bf16 v[124:127], v[196:199], v[248:251], v[124:127]
    ds_read_b128 v[176:179], v32 offset:1664
    v_mfma_f32_16x16x32_bf16 v[104:107], v[200:203], v[224:227], v[104:107]
    ds_read2_b32 v[148:149], v30 offset0:160 offset1:161
    v_mfma_f32_16x16x32_bf16 v[108:111], v[200:203], v[228:231], v[108:111]
    ds_read2_b32 v[150:151], v30 offset0:162 offset1:163
    v_mfma_f32_16x16x32_bf16 v[112:115], v[200:203], v[232:235], v[112:115]
    ds_read_b128 v[180:183], v32 offset:1152
    v_mfma_f32_16x16x32_bf16 v[116:119], v[200:203], v[236:239], v[116:119]
    ds_read2_b32 v[152:153], v31 offset0:32 offset1:33
    v_mfma_f32_16x16x32_bf16 v[120:123], v[200:203], v[240:243], v[120:123]
    ds_read2_b32 v[154:155], v31 offset0:34 offset1:35
    v_mfma_f32_16x16x32_bf16 v[124:127], v[200:203], v[244:247], v[124:127]
    ds_read_b128 v[184:187], v32 offset:640
    buffer_load_dwordx4 v[52:55], v13, s[80:83], s13 offen offset:3072
    v_mfma_f32_16x16x32_bf16 v[108:111], v[204:207], v[224:227], v[108:111]
    ds_read2_b32 v[156:157], v31 offset0:160 offset1:161
    v_mfma_f32_16x16x32_bf16 v[112:115], v[204:207], v[228:231], v[112:115]
    ds_read2_b32 v[158:159], v31 offset0:162 offset1:163
    v_mfma_f32_16x16x32_bf16 v[116:119], v[204:207], v[232:235], v[116:119]
    ds_read_b128 v[188:191], v32 offset:128
    v_mfma_f32_16x16x32_bf16 v[120:123], v[204:207], v[236:239], v[120:123]
    v_mfma_f32_16x16x32_bf16 v[124:127], v[204:207], v[240:243], v[124:127]
    v_mfma_f32_16x16x32_bf16 v[112:115], v[208:211], v[224:227], v[112:115]
    v_mfma_f32_16x16x32_bf16 v[116:119], v[208:211], v[228:231], v[116:119]
    v_mfma_f32_16x16x32_bf16 v[120:123], v[208:211], v[232:235], v[120:123]
    s_bfe_u32 s13, s30, 24 + (4 << 16)
    s_lshl_b32 s13, s13, 7
    buffer_load_dwordx4 v[80:83], v12, s[80:83], s13 offen offset:0
    v_mfma_f32_16x16x32_bf16 v[124:127], v[208:211], v[236:239], v[124:127]
    v_mfma_f32_16x16x32_bf16 v[116:119], v[212:215], v[224:227], v[116:119]
    v_mfma_f32_16x16x32_bf16 v[120:123], v[212:215], v[228:231], v[120:123]
    v_mfma_f32_16x16x32_bf16 v[124:127], v[212:215], v[232:235], v[124:127]
    v_mfma_f32_16x16x32_bf16 v[120:123], v[216:219], v[224:227], v[120:123]
    v_mfma_f32_16x16x32_bf16 v[124:127], v[216:219], v[228:231], v[124:127]
    v_mfma_f32_16x16x32_bf16 v[124:127], v[220:223], v[224:227], v[124:127]
    s_waitcnt lgkmcnt(0)
    v_mfma_f32_16x16x32_bf16 v[96:99], v[128:131], v[160:163], v[96:99]
    ds_read2_b32 v[192:193], v28 offset0:48 offset1:49
    buffer_load_dwordx4 v[84:87], v13, s[80:83], s13 offen offset:1024
    v_mfma_f32_16x16x32_bf16 v[100:103], v[128:131], v[164:167], v[100:103]
    ds_read2_b32 v[194:195], v28 offset0:50 offset1:51
    v_mfma_f32_16x16x32_bf16 v[104:107], v[128:131], v[168:171], v[104:107]
    ds_read_b128 v[224:227], v32 offset:3776
    v_mfma_f32_16x16x32_bf16 v[108:111], v[128:131], v[172:175], v[108:111]
    ds_read2_b32 v[196:197], v28 offset0:176 offset1:177
    v_mfma_f32_16x16x32_bf16 v[112:115], v[128:131], v[176:179], v[112:115]
    ds_read2_b32 v[198:199], v28 offset0:178 offset1:179
    v_mfma_f32_16x16x32_bf16 v[116:119], v[128:131], v[180:183], v[116:119]
    ds_read_b128 v[228:231], v32 offset:3264
    v_mfma_f32_16x16x32_bf16 v[120:123], v[128:131], v[184:187], v[120:123]
    ds_read2_b32 v[200:201], v29 offset0:48 offset1:49
    v_mfma_f32_16x16x32_bf16 v[124:127], v[128:131], v[188:191], v[124:127]
    ds_read2_b32 v[202:203], v29 offset0:50 offset1:51
    v_mfma_f32_16x16x32_bf16 v[100:103], v[132:135], v[160:163], v[100:103]
    ds_read_b128 v[232:235], v32 offset:2752
    buffer_load_dwordx4 v[88:91], v12, s[80:83], s13 offen offset:2048
    v_mfma_f32_16x16x32_bf16 v[104:107], v[132:135], v[164:167], v[104:107]
    ds_read2_b32 v[204:205], v29 offset0:176 offset1:177
    v_mfma_f32_16x16x32_bf16 v[108:111], v[132:135], v[168:171], v[108:111]
    ds_read2_b32 v[206:207], v29 offset0:178 offset1:179
    v_mfma_f32_16x16x32_bf16 v[112:115], v[132:135], v[172:175], v[112:115]
    ds_read_b128 v[236:239], v32 offset:2240
    v_mfma_f32_16x16x32_bf16 v[116:119], v[132:135], v[176:179], v[116:119]
    ds_read2_b32 v[208:209], v30 offset0:48 offset1:49
    v_mfma_f32_16x16x32_bf16 v[120:123], v[132:135], v[180:183], v[120:123]
    ds_read2_b32 v[210:211], v30 offset0:50 offset1:51
    v_mfma_f32_16x16x32_bf16 v[124:127], v[132:135], v[184:187], v[124:127]
    ds_read_b128 v[240:243], v32 offset:1728
    v_mfma_f32_16x16x32_bf16 v[104:107], v[136:139], v[160:163], v[104:107]
    ds_read2_b32 v[212:213], v30 offset0:176 offset1:177
    v_mfma_f32_16x16x32_bf16 v[108:111], v[136:139], v[164:167], v[108:111]
    ds_read2_b32 v[214:215], v30 offset0:178 offset1:179
    buffer_load_dwordx4 v[92:95], v13, s[80:83], s13 offen offset:3072
    v_mfma_f32_16x16x32_bf16 v[112:115], v[136:139], v[168:171], v[112:115]
    ds_read_b128 v[244:247], v32 offset:1216
    v_mfma_f32_16x16x32_bf16 v[116:119], v[136:139], v[172:175], v[116:119]
    ds_read2_b32 v[216:217], v31 offset0:48 offset1:49
    v_mfma_f32_16x16x32_bf16 v[120:123], v[136:139], v[176:179], v[120:123]
    ds_read2_b32 v[218:219], v31 offset0:50 offset1:51
    v_mfma_f32_16x16x32_bf16 v[124:127], v[136:139], v[180:183], v[124:127]
    ds_read_b128 v[248:251], v32 offset:704
    v_mfma_f32_16x16x32_bf16 v[108:111], v[140:143], v[160:163], v[108:111]
    ds_read2_b32 v[220:221], v31 offset0:176 offset1:177
    v_mfma_f32_16x16x32_bf16 v[112:115], v[140:143], v[164:167], v[112:115]
    ds_read2_b32 v[222:223], v31 offset0:178 offset1:179
    v_mfma_f32_16x16x32_bf16 v[116:119], v[140:143], v[168:171], v[116:119]
    ds_read_b128 v[252:255], v32 offset:192
    v_mfma_f32_16x16x32_bf16 v[120:123], v[140:143], v[172:175], v[120:123]
    s_bfe_u32 s13, s30, 20 + (4 << 16)
    s_lshl_b32 s13, s13, 7
    buffer_load_dwordx4 v[64:67], v12, s[80:83], s13 offen offset:0
    v_mfma_f32_16x16x32_bf16 v[124:127], v[140:143], v[176:179], v[124:127]
    v_mfma_f32_16x16x32_bf16 v[112:115], v[144:147], v[160:163], v[112:115]
    v_mfma_f32_16x16x32_bf16 v[116:119], v[144:147], v[164:167], v[116:119]
    v_mfma_f32_16x16x32_bf16 v[120:123], v[144:147], v[168:171], v[120:123]
    v_mfma_f32_16x16x32_bf16 v[124:127], v[144:147], v[172:175], v[124:127]
    v_mfma_f32_16x16x32_bf16 v[116:119], v[148:151], v[160:163], v[116:119]
    s_waitcnt vmcnt(9)
    v_mov_b32 v60, 1
    s_mov_b64 exec, 1
    ds_add_u32 v21, v60 offset:60
    s_mov_b64 exec, -1
    v_mfma_f32_16x16x32_bf16 v[120:123], v[148:151], v[164:167], v[120:123]
    v_mfma_f32_16x16x32_bf16 v[124:127], v[148:151], v[168:171], v[124:127]
    buffer_load_dwordx4 v[68:71], v13, s[80:83], s13 offen offset:1024
    v_mfma_f32_16x16x32_bf16 v[120:123], v[152:155], v[160:163], v[120:123]
    v_mfma_f32_16x16x32_bf16 v[124:127], v[152:155], v[164:167], v[124:127]
    v_mfma_f32_16x16x32_bf16 v[124:127], v[156:159], v[160:163], v[124:127]
    s_waitcnt lgkmcnt(0)
    v_mfma_f32_16x16x32_bf16 v[96:99], v[192:195], v[224:227], v[96:99]
    ds_read2_b32 v[128:129], v28 offset0:64 offset1:65
    v_mfma_f32_16x16x32_bf16 v[100:103], v[192:195], v[228:231], v[100:103]
    ds_read2_b32 v[130:131], v28 offset0:66 offset1:67
    v_mfma_f32_16x16x32_bf16 v[104:107], v[192:195], v[232:235], v[104:107]
    ds_read_b128 v[160:163], v32 offset:3840
    v_mfma_f32_16x16x32_bf16 v[108:111], v[192:195], v[236:239], v[108:111]
    ds_read2_b32 v[132:133], v28 offset0:192 offset1:193
    v_mfma_f32_16x16x32_bf16 v[112:115], v[192:195], v[240:243], v[112:115]
    ds_read2_b32 v[134:135], v28 offset0:194 offset1:195
    buffer_load_dwordx4 v[72:75], v12, s[80:83], s13 offen offset:2048
    v_mfma_f32_16x16x32_bf16 v[116:119], v[192:195], v[244:247], v[116:119]
    ds_read_b128 v[164:167], v32 offset:3328
    v_mfma_f32_16x16x32_bf16 v[120:123], v[192:195], v[248:251], v[120:123]
    ds_read2_b32 v[136:137], v29 offset0:64 offset1:65
    v_mfma_f32_16x16x32_bf16 v[124:127], v[192:195], v[252:255], v[124:127]
    ds_read2_b32 v[138:139], v29 offset0:66 offset1:67
    v_mfma_f32_16x16x32_bf16 v[100:103], v[196:199], v[224:227], v[100:103]
    ds_read_b128 v[168:171], v32 offset:2816
    v_mfma_f32_16x16x32_bf16 v[104:107], v[196:199], v[228:231], v[104:107]
    ds_read2_b32 v[140:141], v29 offset0:192 offset1:193
    v_mfma_f32_16x16x32_bf16 v[108:111], v[196:199], v[232:235], v[108:111]
    ds_read2_b32 v[142:143], v29 offset0:194 offset1:195
    v_mfma_f32_16x16x32_bf16 v[112:115], v[196:199], v[236:239], v[112:115]
    ds_read_b128 v[172:175], v32 offset:2304
    v_mfma_f32_16x16x32_bf16 v[116:119], v[196:199], v[240:243], v[116:119]
    ds_read2_b32 v[144:145], v30 offset0:64 offset1:65
    buffer_load_dwordx4 v[76:79], v13, s[80:83], s13 offen offset:3072
    v_mfma_f32_16x16x32_bf16 v[120:123], v[196:199], v[244:247], v[120:123]
    ds_read2_b32 v[146:147], v30 offset0:66 offset1:67
    v_mfma_f32_16x16x32_bf16 v[124:127], v[196:199], v[248:251], v[124:127]
    ds_read_b128 v[176:179], v32 offset:1792
    v_mfma_f32_16x16x32_bf16 v[104:107], v[200:203], v[224:227], v[104:107]
    ds_read2_b32 v[148:149], v30 offset0:192 offset1:193
    v_mfma_f32_16x16x32_bf16 v[108:111], v[200:203], v[228:231], v[108:111]
    ds_read2_b32 v[150:151], v30 offset0:194 offset1:195
    v_mfma_f32_16x16x32_bf16 v[112:115], v[200:203], v[232:235], v[112:115]
    ds_read_b128 v[180:183], v32 offset:1280
    v_mfma_f32_16x16x32_bf16 v[116:119], v[200:203], v[236:239], v[116:119]
    ds_read2_b32 v[152:153], v31 offset0:64 offset1:65
    v_mfma_f32_16x16x32_bf16 v[120:123], v[200:203], v[240:243], v[120:123]
    ds_read2_b32 v[154:155], v31 offset0:66 offset1:67
    v_mfma_f32_16x16x32_bf16 v[124:127], v[200:203], v[244:247], v[124:127]
    ds_read_b128 v[184:187], v32 offset:768
    v_mfma_f32_16x16x32_bf16 v[108:111], v[204:207], v[224:227], v[108:111]
    ds_read2_b32 v[156:157], v31 offset0:192 offset1:193
    v_mfma_f32_16x16x32_bf16 v[112:115], v[204:207], v[228:231], v[112:115]
    ds_read2_b32 v[158:159], v31 offset0:194 offset1:195
    v_mfma_f32_16x16x32_bf16 v[116:119], v[204:207], v[232:235], v[116:119]
    ds_read_b128 v[188:191], v32 offset:256
    v_mfma_f32_16x16x32_bf16 v[120:123], v[204:207], v[236:239], v[120:123]
    v_mfma_f32_16x16x32_bf16 v[124:127], v[204:207], v[240:243], v[124:127]
    v_mfma_f32_16x16x32_bf16 v[112:115], v[208:211], v[224:227], v[112:115]
    v_mfma_f32_16x16x32_bf16 v[116:119], v[208:211], v[228:231], v[116:119]
    v_mfma_f32_16x16x32_bf16 v[120:123], v[208:211], v[232:235], v[120:123]
    v_mfma_f32_16x16x32_bf16 v[124:127], v[208:211], v[236:239], v[124:127]
    v_mfma_f32_16x16x32_bf16 v[116:119], v[212:215], v[224:227], v[116:119]
    v_mfma_f32_16x16x32_bf16 v[120:123], v[212:215], v[228:231], v[120:123]
    v_mfma_f32_16x16x32_bf16 v[124:127], v[212:215], v[232:235], v[124:127]
    v_mfma_f32_16x16x32_bf16 v[120:123], v[216:219], v[224:227], v[120:123]
    v_mfma_f32_16x16x32_bf16 v[124:127], v[216:219], v[228:231], v[124:127]
    v_mfma_f32_16x16x32_bf16 v[124:127], v[220:223], v[224:227], v[124:127]
    s_waitcnt lgkmcnt(0)
    v_mfma_f32_16x16x32_bf16 v[96:99], v[128:131], v[160:163], v[96:99]
    ds_read2_b32 v[192:193], v28 offset0:80 offset1:81
    v_mfma_f32_16x16x32_bf16 v[100:103], v[128:131], v[164:167], v[100:103]
    ds_read2_b32 v[194:195], v28 offset0:82 offset1:83
    v_mfma_f32_16x16x32_bf16 v[104:107], v[128:131], v[168:171], v[104:107]
    ds_read_b128 v[224:227], v32 offset:3904
    v_mfma_f32_16x16x32_bf16 v[108:111], v[128:131], v[172:175], v[108:111]
    ds_read2_b32 v[196:197], v28 offset0:208 offset1:209
    v_mfma_f32_16x16x32_bf16 v[112:115], v[128:131], v[176:179], v[112:115]
    ds_read2_b32 v[198:199], v28 offset0:210 offset1:211
    v_mfma_f32_16x16x32_bf16 v[116:119], v[128:131], v[180:183], v[116:119]
    ds_read_b128 v[228:231], v32 offset:3392
    v_mfma_f32_16x16x32_bf16 v[120:123], v[128:131], v[184:187], v[120:123]
    ds_read2_b32 v[200:201], v29 offset0:80 offset1:81
    v_mfma_f32_16x16x32_bf16 v[124:127], v[128:131], v[188:191], v[124:127]
    ds_read2_b32 v[202:203], v29 offset0:82 offset1:83
    v_mfma_f32_16x16x32_bf16 v[100:103], v[132:135], v[160:163], v[100:103]
    ds_read_b128 v[232:235], v32 offset:2880
    v_mfma_f32_16x16x32_bf16 v[104:107], v[132:135], v[164:167], v[104:107]
    ds_read2_b32 v[204:205], v29 offset0:208 offset1:209
    v_mfma_f32_16x16x32_bf16 v[108:111], v[132:135], v[168:171], v[108:111]
    ds_read2_b32 v[206:207], v29 offset0:210 offset1:211
    v_mfma_f32_16x16x32_bf16 v[112:115], v[132:135], v[172:175], v[112:115]
    ds_read_b128 v[236:239], v32 offset:2368
    v_mfma_f32_16x16x32_bf16 v[116:119], v[132:135], v[176:179], v[116:119]
    ds_read2_b32 v[208:209], v30 offset0:80 offset1:81
    v_mfma_f32_16x16x32_bf16 v[120:123], v[132:135], v[180:183], v[120:123]
    ds_read2_b32 v[210:211], v30 offset0:82 offset1:83
    v_mfma_f32_16x16x32_bf16 v[124:127], v[132:135], v[184:187], v[124:127]
    ds_read_b128 v[240:243], v32 offset:1856
    v_mfma_f32_16x16x32_bf16 v[104:107], v[136:139], v[160:163], v[104:107]
    ds_read2_b32 v[212:213], v30 offset0:208 offset1:209
    v_mfma_f32_16x16x32_bf16 v[108:111], v[136:139], v[164:167], v[108:111]
    ds_read2_b32 v[214:215], v30 offset0:210 offset1:211
    v_mfma_f32_16x16x32_bf16 v[112:115], v[136:139], v[168:171], v[112:115]
    ds_read_b128 v[244:247], v32 offset:1344
    v_mfma_f32_16x16x32_bf16 v[116:119], v[136:139], v[172:175], v[116:119]
    ds_read2_b32 v[216:217], v31 offset0:80 offset1:81
    v_mfma_f32_16x16x32_bf16 v[120:123], v[136:139], v[176:179], v[120:123]
    ds_read2_b32 v[218:219], v31 offset0:82 offset1:83
    v_mfma_f32_16x16x32_bf16 v[124:127], v[136:139], v[180:183], v[124:127]
    ds_read_b128 v[248:251], v32 offset:832
    v_mfma_f32_16x16x32_bf16 v[108:111], v[140:143], v[160:163], v[108:111]
    ds_read2_b32 v[220:221], v31 offset0:208 offset1:209
    v_mfma_f32_16x16x32_bf16 v[112:115], v[140:143], v[164:167], v[112:115]
    ds_read2_b32 v[222:223], v31 offset0:210 offset1:211
    v_mfma_f32_16x16x32_bf16 v[116:119], v[140:143], v[168:171], v[116:119]
    ds_read_b128 v[252:255], v32 offset:320
    v_mfma_f32_16x16x32_bf16 v[120:123], v[140:143], v[172:175], v[120:123]
    v_mfma_f32_16x16x32_bf16 v[124:127], v[140:143], v[176:179], v[124:127]
    v_mfma_f32_16x16x32_bf16 v[112:115], v[144:147], v[160:163], v[112:115]
    v_mfma_f32_16x16x32_bf16 v[116:119], v[144:147], v[164:167], v[116:119]
    v_mfma_f32_16x16x32_bf16 v[120:123], v[144:147], v[168:171], v[120:123]
    v_mfma_f32_16x16x32_bf16 v[124:127], v[144:147], v[172:175], v[124:127]
    v_mfma_f32_16x16x32_bf16 v[116:119], v[148:151], v[160:163], v[116:119]
    v_mfma_f32_16x16x32_bf16 v[120:123], v[148:151], v[164:167], v[120:123]
    v_mfma_f32_16x16x32_bf16 v[124:127], v[148:151], v[168:171], v[124:127]
    v_mfma_f32_16x16x32_bf16 v[120:123], v[152:155], v[160:163], v[120:123]
    v_mfma_f32_16x16x32_bf16 v[124:127], v[152:155], v[164:167], v[124:127]
    v_mfma_f32_16x16x32_bf16 v[124:127], v[156:159], v[160:163], v[124:127]
    s_waitcnt lgkmcnt(0)
    v_mfma_f32_16x16x32_bf16 v[96:99], v[192:195], v[224:227], v[96:99]
    ds_read2_b32 v[128:129], v28 offset0:96 offset1:97
    v_mfma_f32_16x16x32_bf16 v[100:103], v[192:195], v[228:231], v[100:103]
    ds_read2_b32 v[130:131], v28 offset0:98 offset1:99
    v_mfma_f32_16x16x32_bf16 v[104:107], v[192:195], v[232:235], v[104:107]
    ds_read_b128 v[160:163], v32 offset:3968
    v_mfma_f32_16x16x32_bf16 v[108:111], v[192:195], v[236:239], v[108:111]
    ds_read2_b32 v[132:133], v28 offset0:224 offset1:225
    v_mfma_f32_16x16x32_bf16 v[112:115], v[192:195], v[240:243], v[112:115]
    ds_read2_b32 v[134:135], v28 offset0:226 offset1:227
    v_mfma_f32_16x16x32_bf16 v[116:119], v[192:195], v[244:247], v[116:119]
    ds_read_b128 v[164:167], v32 offset:3456
    v_mfma_f32_16x16x32_bf16 v[120:123], v[192:195], v[248:251], v[120:123]
    ds_read2_b32 v[136:137], v29 offset0:96 offset1:97
    v_mfma_f32_16x16x32_bf16 v[124:127], v[192:195], v[252:255], v[124:127]
    ds_read2_b32 v[138:139], v29 offset0:98 offset1:99
    v_mfma_f32_16x16x32_bf16 v[100:103], v[196:199], v[224:227], v[100:103]
    ds_read_b128 v[168:171], v32 offset:2944
    v_mfma_f32_16x16x32_bf16 v[104:107], v[196:199], v[228:231], v[104:107]
    ds_read2_b32 v[140:141], v29 offset0:224 offset1:225
    v_mfma_f32_16x16x32_bf16 v[108:111], v[196:199], v[232:235], v[108:111]
    ds_read2_b32 v[142:143], v29 offset0:226 offset1:227
    v_mfma_f32_16x16x32_bf16 v[112:115], v[196:199], v[236:239], v[112:115]
    ds_read_b128 v[172:175], v32 offset:2432
    v_mfma_f32_16x16x32_bf16 v[116:119], v[196:199], v[240:243], v[116:119]
    ds_read2_b32 v[144:145], v30 offset0:96 offset1:97
    v_mfma_f32_16x16x32_bf16 v[120:123], v[196:199], v[244:247], v[120:123]
    ds_read2_b32 v[146:147], v30 offset0:98 offset1:99
    v_mfma_f32_16x16x32_bf16 v[124:127], v[196:199], v[248:251], v[124:127]
    ds_read_b128 v[176:179], v32 offset:1920
    v_mfma_f32_16x16x32_bf16 v[104:107], v[200:203], v[224:227], v[104:107]
    ds_read2_b32 v[148:149], v30 offset0:224 offset1:225
    v_mfma_f32_16x16x32_bf16 v[108:111], v[200:203], v[228:231], v[108:111]
    ds_read2_b32 v[150:151], v30 offset0:226 offset1:227
    v_mfma_f32_16x16x32_bf16 v[112:115], v[200:203], v[232:235], v[112:115]
    ds_read_b128 v[180:183], v32 offset:1408
    v_mfma_f32_16x16x32_bf16 v[116:119], v[200:203], v[236:239], v[116:119]
    ds_read2_b32 v[152:153], v31 offset0:96 offset1:97
    v_mfma_f32_16x16x32_bf16 v[120:123], v[200:203], v[240:243], v[120:123]
    ds_read2_b32 v[154:155], v31 offset0:98 offset1:99
    v_mfma_f32_16x16x32_bf16 v[124:127], v[200:203], v[244:247], v[124:127]
    ds_read_b128 v[184:187], v32 offset:896
    v_mfma_f32_16x16x32_bf16 v[108:111], v[204:207], v[224:227], v[108:111]
    ds_read2_b32 v[156:157], v31 offset0:224 offset1:225
    v_mfma_f32_16x16x32_bf16 v[112:115], v[204:207], v[228:231], v[112:115]
    ds_read2_b32 v[158:159], v31 offset0:226 offset1:227
    v_mfma_f32_16x16x32_bf16 v[116:119], v[204:207], v[232:235], v[116:119]
    ds_read_b128 v[188:191], v32 offset:384
    v_mfma_f32_16x16x32_bf16 v[120:123], v[204:207], v[236:239], v[120:123]
    v_mfma_f32_16x16x32_bf16 v[124:127], v[204:207], v[240:243], v[124:127]
    v_mfma_f32_16x16x32_bf16 v[112:115], v[208:211], v[224:227], v[112:115]
    v_mfma_f32_16x16x32_bf16 v[116:119], v[208:211], v[228:231], v[116:119]
    v_mfma_f32_16x16x32_bf16 v[120:123], v[208:211], v[232:235], v[120:123]
    v_mfma_f32_16x16x32_bf16 v[124:127], v[208:211], v[236:239], v[124:127]
    v_mfma_f32_16x16x32_bf16 v[116:119], v[212:215], v[224:227], v[116:119]
    v_mfma_f32_16x16x32_bf16 v[120:123], v[212:215], v[228:231], v[120:123]
    v_mfma_f32_16x16x32_bf16 v[124:127], v[212:215], v[232:235], v[124:127]
    v_mfma_f32_16x16x32_bf16 v[120:123], v[216:219], v[224:227], v[120:123]
    v_mfma_f32_16x16x32_bf16 v[124:127], v[216:219], v[228:231], v[124:127]
    v_mfma_f32_16x16x32_bf16 v[124:127], v[220:223], v[224:227], v[124:127]
    s_waitcnt lgkmcnt(0)
    v_mfma_f32_16x16x32_bf16 v[96:99], v[128:131], v[160:163], v[96:99]
    ds_read2_b32 v[192:193], v28 offset0:112 offset1:113
    v_mfma_f32_16x16x32_bf16 v[100:103], v[128:131], v[164:167], v[100:103]
    ds_read2_b32 v[194:195], v28 offset0:114 offset1:115
    v_mfma_f32_16x16x32_bf16 v[104:107], v[128:131], v[168:171], v[104:107]
    ds_read_b128 v[224:227], v32 offset:4032
    v_mfma_f32_16x16x32_bf16 v[108:111], v[128:131], v[172:175], v[108:111]
    ds_read2_b32 v[196:197], v28 offset0:240 offset1:241
    v_mfma_f32_16x16x32_bf16 v[112:115], v[128:131], v[176:179], v[112:115]
    ds_read2_b32 v[198:199], v28 offset0:242 offset1:243
    v_mfma_f32_16x16x32_bf16 v[116:119], v[128:131], v[180:183], v[116:119]
    ds_read_b128 v[228:231], v32 offset:3520
    v_mfma_f32_16x16x32_bf16 v[120:123], v[128:131], v[184:187], v[120:123]
    ds_read2_b32 v[200:201], v29 offset0:112 offset1:113
    v_mfma_f32_16x16x32_bf16 v[124:127], v[128:131], v[188:191], v[124:127]
    ds_read2_b32 v[202:203], v29 offset0:114 offset1:115
    v_mfma_f32_16x16x32_bf16 v[100:103], v[132:135], v[160:163], v[100:103]
    ds_read_b128 v[232:235], v32 offset:3008
    v_mfma_f32_16x16x32_bf16 v[104:107], v[132:135], v[164:167], v[104:107]
    ds_read2_b32 v[204:205], v29 offset0:240 offset1:241
    v_mfma_f32_16x16x32_bf16 v[108:111], v[132:135], v[168:171], v[108:111]
    ds_read2_b32 v[206:207], v29 offset0:242 offset1:243
    v_mfma_f32_16x16x32_bf16 v[112:115], v[132:135], v[172:175], v[112:115]
    ds_read_b128 v[236:239], v32 offset:2496
    v_mfma_f32_16x16x32_bf16 v[116:119], v[132:135], v[176:179], v[116:119]
    ds_read2_b32 v[208:209], v30 offset0:112 offset1:113
    v_mfma_f32_16x16x32_bf16 v[120:123], v[132:135], v[180:183], v[120:123]
    ds_read2_b32 v[210:211], v30 offset0:114 offset1:115
    v_mfma_f32_16x16x32_bf16 v[124:127], v[132:135], v[184:187], v[124:127]
    ds_read_b128 v[240:243], v32 offset:1984
    v_mfma_f32_16x16x32_bf16 v[104:107], v[136:139], v[160:163], v[104:107]
    ds_read2_b32 v[212:213], v30 offset0:240 offset1:241
    v_mfma_f32_16x16x32_bf16 v[108:111], v[136:139], v[164:167], v[108:111]
    ds_read2_b32 v[214:215], v30 offset0:242 offset1:243
    v_mfma_f32_16x16x32_bf16 v[112:115], v[136:139], v[168:171], v[112:115]
    ds_read_b128 v[244:247], v32 offset:1472
    v_mfma_f32_16x16x32_bf16 v[116:119], v[136:139], v[172:175], v[116:119]
    ds_read2_b32 v[216:217], v31 offset0:112 offset1:113
    v_mfma_f32_16x16x32_bf16 v[120:123], v[136:139], v[176:179], v[120:123]
    ds_read2_b32 v[218:219], v31 offset0:114 offset1:115
    v_mfma_f32_16x16x32_bf16 v[124:127], v[136:139], v[180:183], v[124:127]
    ds_read_b128 v[248:251], v32 offset:960
    v_mfma_f32_16x16x32_bf16 v[108:111], v[140:143], v[160:163], v[108:111]
    ds_read2_b32 v[220:221], v31 offset0:240 offset1:241
    v_mfma_f32_16x16x32_bf16 v[112:115], v[140:143], v[164:167], v[112:115]
    ds_read2_b32 v[222:223], v31 offset0:242 offset1:243
    v_mfma_f32_16x16x32_bf16 v[116:119], v[140:143], v[168:171], v[116:119]
    ds_read_b128 v[252:255], v32 offset:448
    v_mfma_f32_16x16x32_bf16 v[120:123], v[140:143], v[172:175], v[120:123]
    v_mfma_f32_16x16x32_bf16 v[124:127], v[140:143], v[176:179], v[124:127]
    v_mfma_f32_16x16x32_bf16 v[112:115], v[144:147], v[160:163], v[112:115]
    v_mfma_f32_16x16x32_bf16 v[116:119], v[144:147], v[164:167], v[116:119]
    v_mfma_f32_16x16x32_bf16 v[120:123], v[144:147], v[168:171], v[120:123]
    v_mfma_f32_16x16x32_bf16 v[124:127], v[144:147], v[172:175], v[124:127]
    v_mfma_f32_16x16x32_bf16 v[116:119], v[148:151], v[160:163], v[116:119]
    v_mfma_f32_16x16x32_bf16 v[120:123], v[148:151], v[164:167], v[120:123]
    v_mfma_f32_16x16x32_bf16 v[124:127], v[148:151], v[168:171], v[124:127]
    v_mfma_f32_16x16x32_bf16 v[120:123], v[152:155], v[160:163], v[120:123]
    v_mfma_f32_16x16x32_bf16 v[124:127], v[152:155], v[164:167], v[124:127]
    v_mfma_f32_16x16x32_bf16 v[124:127], v[156:159], v[160:163], v[124:127]
    s_waitcnt lgkmcnt(0)
    v_mfma_f32_16x16x32_bf16 v[96:99], v[192:195], v[224:227], v[96:99]
    v_mfma_f32_16x16x32_bf16 v[100:103], v[192:195], v[228:231], v[100:103]
    v_mfma_f32_16x16x32_bf16 v[104:107], v[192:195], v[232:235], v[104:107]
    v_mfma_f32_16x16x32_bf16 v[108:111], v[192:195], v[236:239], v[108:111]
    v_mfma_f32_16x16x32_bf16 v[112:115], v[192:195], v[240:243], v[112:115]
    v_mfma_f32_16x16x32_bf16 v[116:119], v[192:195], v[244:247], v[116:119]
    v_mfma_f32_16x16x32_bf16 v[120:123], v[192:195], v[248:251], v[120:123]
    v_mfma_f32_16x16x32_bf16 v[124:127], v[192:195], v[252:255], v[124:127]
    v_mfma_f32_16x16x32_bf16 v[100:103], v[196:199], v[224:227], v[100:103]
    v_mfma_f32_16x16x32_bf16 v[104:107], v[196:199], v[228:231], v[104:107]
    v_mfma_f32_16x16x32_bf16 v[108:111], v[196:199], v[232:235], v[108:111]
    v_mfma_f32_16x16x32_bf16 v[112:115], v[196:199], v[236:239], v[112:115]
    v_mfma_f32_16x16x32_bf16 v[116:119], v[196:199], v[240:243], v[116:119]
    v_mfma_f32_16x16x32_bf16 v[120:123], v[196:199], v[244:247], v[120:123]
    v_mfma_f32_16x16x32_bf16 v[124:127], v[196:199], v[248:251], v[124:127]
    v_mfma_f32_16x16x32_bf16 v[104:107], v[200:203], v[224:227], v[104:107]
    v_mfma_f32_16x16x32_bf16 v[108:111], v[200:203], v[228:231], v[108:111]
    v_mfma_f32_16x16x32_bf16 v[112:115], v[200:203], v[232:235], v[112:115]
    v_mfma_f32_16x16x32_bf16 v[116:119], v[200:203], v[236:239], v[116:119]
    v_mfma_f32_16x16x32_bf16 v[120:123], v[200:203], v[240:243], v[120:123]
    v_mfma_f32_16x16x32_bf16 v[124:127], v[200:203], v[244:247], v[124:127]
    v_mfma_f32_16x16x32_bf16 v[108:111], v[204:207], v[224:227], v[108:111]
    v_mfma_f32_16x16x32_bf16 v[112:115], v[204:207], v[228:231], v[112:115]
    v_mfma_f32_16x16x32_bf16 v[116:119], v[204:207], v[232:235], v[116:119]
    v_mfma_f32_16x16x32_bf16 v[120:123], v[204:207], v[236:239], v[120:123]
    v_mfma_f32_16x16x32_bf16 v[124:127], v[204:207], v[240:243], v[124:127]
    v_mfma_f32_16x16x32_bf16 v[112:115], v[208:211], v[224:227], v[112:115]
    v_mfma_f32_16x16x32_bf16 v[116:119], v[208:211], v[228:231], v[116:119]
    v_mfma_f32_16x16x32_bf16 v[120:123], v[208:211], v[232:235], v[120:123]
    v_mfma_f32_16x16x32_bf16 v[124:127], v[208:211], v[236:239], v[124:127]
    v_mfma_f32_16x16x32_bf16 v[116:119], v[212:215], v[224:227], v[116:119]
    v_mfma_f32_16x16x32_bf16 v[120:123], v[212:215], v[228:231], v[120:123]
    v_mfma_f32_16x16x32_bf16 v[124:127], v[212:215], v[232:235], v[124:127]
    v_mfma_f32_16x16x32_bf16 v[120:123], v[216:219], v[224:227], v[120:123]
    v_mfma_f32_16x16x32_bf16 v[124:127], v[216:219], v[228:231], v[124:127]
    v_mfma_f32_16x16x32_bf16 v[124:127], v[220:223], v[224:227], v[124:127]
    s_setprio 0
    v_cvt_pk_bf16_f32 v192, v96, v97
    v_cvt_pk_bf16_f32 v193, v98, v99
    v_cvt_pk_bf16_f32 v194, v100, v101
    v_cvt_pk_bf16_f32 v195, v102, v103
    v_cvt_pk_bf16_f32 v196, v104, v105
    v_cvt_pk_bf16_f32 v197, v106, v107
    v_cvt_pk_bf16_f32 v198, v108, v109
    v_cvt_pk_bf16_f32 v199, v110, v111
    v_cvt_pk_bf16_f32 v200, v112, v113
    v_cvt_pk_bf16_f32 v201, v114, v115
    v_cvt_pk_bf16_f32 v202, v116, v117
    v_cvt_pk_bf16_f32 v203, v118, v119
    v_cvt_pk_bf16_f32 v204, v120, v121
    v_cvt_pk_bf16_f32 v205, v122, v123
    v_cvt_pk_bf16_f32 v206, v124, v125
    v_cvt_pk_bf16_f32 v207, v126, v127
    v_permlane16_swap_b32 v192, v194
    v_permlane16_swap_b32 v193, v195
    v_permlane16_swap_b32 v196, v198
    v_permlane16_swap_b32 v197, v199
    v_permlane16_swap_b32 v200, v202
    v_permlane16_swap_b32 v201, v203
    v_permlane16_swap_b32 v204, v206
    v_permlane16_swap_b32 v205, v207
    ds_bpermute_b32 v192, v17, v192
    ds_bpermute_b32 v193, v17, v193
    ds_bpermute_b32 v194, v17, v194
    ds_bpermute_b32 v195, v17, v195
    ds_bpermute_b32 v196, v17, v196
    ds_bpermute_b32 v197, v17, v197
    ds_bpermute_b32 v198, v17, v198
    ds_bpermute_b32 v199, v17, v199
    ds_bpermute_b32 v200, v17, v200
    ds_bpermute_b32 v201, v17, v201
    ds_bpermute_b32 v202, v17, v202
    ds_bpermute_b32 v203, v17, v203
    ds_bpermute_b32 v204, v17, v204
    ds_bpermute_b32 v205, v17, v205
    ds_bpermute_b32 v206, v17, v206
    ds_bpermute_b32 v207, v17, v207
    ds_read_b32 v60, v21 offset:72
    s_waitcnt lgkmcnt(0)
    v_cmp_eq_u32 vcc, 1, v60
    s_cbranch_vccnz L_zp
    s_mov_b32 s13, 0
    buffer_store_dwordx4 v[192:195], v26, s[56:59], s36 offen offset:0 sc1
    buffer_store_dwordx4 v[196:199], v26, s[56:59], s36 offen offset:1024 sc1
    buffer_store_dwordx4 v[200:203], v26, s[56:59], s36 offen offset:2048 sc1
    buffer_store_dwordx4 v[204:207], v26, s[56:59], s36 offen offset:3072 sc1
    s_branch L_zq
L_zp:
    s_mov_b32 s13, 1
    buffer_store_dwordx4 v[192:195], v26, s[56:59], s36 offen offset:0
    buffer_store_dwordx4 v[196:199], v26, s[56:59], s36 offen offset:1024
    buffer_store_dwordx4 v[200:203], v26, s[56:59], s36 offen offset:2048
    buffer_store_dwordx4 v[204:207], v26, s[56:59], s36 offen offset:3072
L_zq:
    v_add_u32 v33, s101, v26
    s_waitcnt vmcnt(4)
    ds_write_b128 v33, v[64:67] offset:0
    ds_write_b128 v33, v[68:71] offset:1024
    ds_write_b128 v33, v[72:75] offset:2048
    ds_write_b128 v33, v[76:79] offset:3072
    ds_write_b128 v33, v[80:83] offset:4096
    ds_write_b128 v33, v[84:87] offset:5120
    ds_write_b128 v33, v[88:91] offset:6144
    ds_write_b128 v33, v[92:95] offset:7168
    ds_write_b128 v33, v[40:43] offset:8192
    ds_write_b128 v33, v[44:47] offset:9216
    ds_write_b128 v33, v[48:51] offset:10240
    ds_write_b128 v33, v[52:55] offset:11264
    v_mov_b32 v60, 1
    s_mov_b64 exec, 1
    ds_add_u32 v21, v60 offset:68
    s_mov_b64 exec, -1
    s_lshl_b32 s12, s100, 3
    s_add_u32 s12, s12, 8192
    v_lshlrev_b32 v28, 1, v23
    v_lshl_add_u32 v28, v24, 12, v28
    v_lshlrev_b32 v29, 2, v24
    v_lshl_add_u32 v29, v23, 13, v29
    v_lshrrev_b32 v60, 3, v2
    v_and_b32 v61, 7, v2
    v_lshl_add_u32 v28, v60, 2, s35
    v_lshlrev_b32 v28, 12, v28
    v_lshl_add_u32 v28, v61, 4, v28
    s_lshl_b32 s10, s5, 7
    v_add_u32 v28, s10, v28
    v_lshl_add_u32 v30, v61, 3, v60
    v_lshlrev_b32 v30, 2, v30
    s_waitcnt vmcnt(0)
    s_mov_b64 exec, 1
    s_cmp_eq_u32 s13, 1
    s_cbranch_scc0 L_xf2
    buffer_store_dwordx2 v[0:1], v19, s[72:75], s12 offen
    s_branch L_xf3
L_xf2:
    buffer_store_dwordx2 v[0:1], v19, s[72:75], s12 offen sc1
L_xf3:
    s_mov_b64 exec, -1
    s_mov_b32 s15, 0
L_zw_w:
    ds_read_b128 v[60:63], v21 offset:0
    s_waitcnt lgkmcnt(0)
    v_min3_u32 v60, v60, v61, v62
    v_min_u32 v60, v60, v63
    v_cmp_gt_u32 vcc, 24, v60
    s_cbranch_vccz L_zw_ok
    s_sleep 4
    s_add_u32 s15, s15, 1
    s_cmp_lt_u32 s15, 160000
    s_cbranch_scc1 L_zw_w
L_zw_ok:
    s_cmp_eq_u32 s8, 0
    s_cbranch_scc0 L_z1
    s_mov_b32 s15, 0
LZ_poll:
    buffer_load_dwordx4 v[60:63], v3, s[72:75], 0 offen sc1
    s_waitcnt vmcnt(0)
LZ_chk:
    v_cmp_ne_u64 vcc, v[60:61], v[0:1]
    v_cmp_ne_u64 s[10:11], v[62:63], v[0:1]
    s_or_b64 vcc, vcc, s[10:11]
    s_cbranch_scc0 LZ_ok
    s_sleep 4
    s_add_u32 s15, s15, 1
    s_cmp_lt_u32 s15, 20000
    s_cbranch_scc1 LZ_poll
LZ_ok:
    ds_write_b32 v21, v25 offset:48
L_z1:
    s_waitcnt vmcnt(0)
    v_lshlrev_b32 v128, 16, v4
    v_and_b32 v129, 0xffff0000, v4
    v_lshlrev_b32 v130, 16, v5
    v_and_b32 v131, 0xffff0000, v5
    v_lshlrev_b32 v132, 16, v6
    v_and_b32 v133, 0xffff0000, v6
    v_lshlrev_b32 v134, 16, v7
    v_and_b32 v135, 0xffff0000, v7
    v_lshlrev_b32 v136, 16, v8
    v_and_b32 v137, 0xffff0000, v8
    v_lshlrev_b32 v138, 16, v9
    v_and_b32 v139, 0xffff0000, v9
    v_lshlrev_b32 v140, 16, v10
    v_and_b32 v141, 0xffff0000, v10
    v_lshlrev_b32 v142, 16, v11
    v_and_b32 v143, 0xffff0000, v11
    v_lshlrev_b32 v144, 16, v14
    v_and_b32 v145, 0xffff0000, v14
    v_lshlrev_b32 v146, 16, v15
    v_and_b32 v147, 0xffff0000, v15
    v_lshlrev_b32 v148, 16, v56
    v_and_b32 v149, 0xffff0000, v56
    v_lshlrev_b32 v150, 16, v57
    v_and_b32 v151, 0xffff0000, v57
    v_lshlrev_b32 v152, 16, v58
    v_and_b32 v153, 0xffff0000, v58
    v_lshlrev_b32 v154, 16, v59
    v_and_b32 v155, 0xffff0000, v59
    v_lshlrev_b32 v156, 16, v34
    v_and_b32 v157, 0xffff0000, v34
    v_lshlrev_b32 v158, 16, v35
    v_and_b32 v159, 0xffff0000, v35
    s_mov_b32 s15, 0
L_fz_w:
    ds_read_b32 v60, v21 offset:48
    s_waitcnt lgkmcnt(0)
    v_cmp_gt_u32 vcc, 1, v60
    s_cbranch_vccz L_fz_ok
    s_sleep 1
    s_add_u32 s15, s15, 1
    s_cmp_lt_u32 s15, 160000
    s_cbranch_scc1 L_fz_w
L_fz_ok:
    buffer_load_dwordx4 v[64:67], v28, s[56:59], 0 offen sc1
    buffer_load_dwordx4 v[68:71], v28, s[56:59], s32 offen sc1
    buffer_load_dwordx4 v[72:75], v28, s[56:59], s33 offen sc1
    buffer_load_dwordx4 v[76:79], v28, s[56:59], s34 offen sc1
    s_waitcnt vmcnt(3)
    ds_bpermute_b32 v64, v30, v64
    ds_bpermute_b32 v65, v30, v65
    ds_bpermute_b32 v66, v30, v66
    ds_bpermute_b32 v67, v30, v67
    s_waitcnt vmcnt(2)
    ds_bpermute_b32 v68, v30, v68
    ds_bpermute_b32 v69, v30, v69
    ds_bpermute_b32 v70, v30, v70
    ds_bpermute_b32 v71, v30, v71
    s_waitcnt vmcnt(1)
    ds_bpermute_b32 v72, v30, v72
    ds_bpermute_b32 v73, v30, v73
    ds_bpermute_b32 v74, v30, v74
    ds_bpermute_b32 v75, v30, v75
    s_waitcnt vmcnt(0)
    ds_bpermute_b32 v76, v30, v76
    ds_bpermute_b32 v77, v30, v77
    ds_bpermute_b32 v78, v30, v78
    ds_bpermute_b32 v79, v30, v79
    s_waitcnt lgkmcnt(0)
    s_waitcnt vmcnt(0)
    v_lshlrev_b32 v160, 16, v64
    v_lshlrev_b32 v161, 16, v68
    v_lshlrev_b32 v162, 16, v72
    v_lshlrev_b32 v163, 16, v76
    v_mul_f32 v160, v160, v128
    v_mul_f32 v161, v161, v129
    v_mul_f32 v162, v162, v130
    v_mul_f32 v163, v163, v131
    s_mov_b32 s10, 0
    buffer_store_dwordx4 v[160:163], v29, s[64:67], s10 offen nt
    v_and_b32 v164, 0xffff0000, v64
    v_and_b32 v165, 0xffff0000, v68
    v_and_b32 v166, 0xffff0000, v72
    v_and_b32 v167, 0xffff0000, v76
    v_mul_f32 v164, v164, v132
    v_mul_f32 v165, v165, v133
    v_mul_f32 v166, v166, v134
    v_mul_f32 v167, v167, v135
    s_mov_b32 s10, 8192
    buffer_store_dwordx4 v[164:167], v29, s[64:67], s10 offen nt
    v_lshlrev_b32 v168, 16, v65
    v_lshlrev_b32 v169, 16, v69
    v_lshlrev_b32 v170, 16, v73
    v_lshlrev_b32 v171, 16, v77
    v_mul_f32 v168, v168, v136
    v_mul_f32 v169, v169, v137
    v_mul_f32 v170, v170, v138
    v_mul_f32 v171, v171, v139
    s_mov_b32 s10, 16384
    buffer_store_dwordx4 v[168:171], v29, s[64:67], s10 offen nt
    v_and_b32 v172, 0xffff0000, v65
    v_and_b32 v173, 0xffff0000, v69
    v_and_b32 v174, 0xffff0000, v73
    v_and_b32 v175, 0xffff0000, v77
    v_mul_f32 v172, v172, v140
    v_mul_f32 v173, v173, v141
    v_mul_f32 v174, v174, v142
    v_mul_f32 v175, v175, v143
    s_mov_b32 s10, 24576
    buffer_store_dwordx4 v[172:175], v29, s[64:67], s10 offen nt
    v_lshlrev_b32 v176, 16, v66
    v_lshlrev_b32 v177, 16, v70
    v_lshlrev_b32 v178, 16, v74
    v_lshlrev_b32 v179, 16, v78
    v_mul_f32 v176, v176, v144
    v_mul_f32 v177, v177, v145
    v_mul_f32 v178, v178, v146
    v_mul_f32 v179, v179, v147
    s_mov_b32 s10, 32768
    buffer_store_dwordx4 v[176:179], v29, s[64:67], s10 offen nt
    v_and_b32 v180, 0xffff0000, v66
    v_and_b32 v181, 0xffff0000, v70
    v_and_b32 v182, 0xffff0000, v74
    v_and_b32 v183, 0xffff0000, v78
    v_mul_f32 v180, v180, v148
    v_mul_f32 v181, v181, v149
    v_mul_f32 v182, v182, v150
    v_mul_f32 v183, v183, v151
    s_mov_b32 s10, 40960
    buffer_store_dwordx4 v[180:183], v29, s[64:67], s10 offen nt
    v_lshlrev_b32 v184, 16, v67
    v_lshlrev_b32 v185, 16, v71
    v_lshlrev_b32 v186, 16, v75
    v_lshlrev_b32 v187, 16, v79
    v_mul_f32 v184, v184, v152
    v_mul_f32 v185, v185, v153
    v_mul_f32 v186, v186, v154
    v_mul_f32 v187, v187, v155
    s_mov_b32 s10, 49152
    buffer_store_dwordx4 v[184:187], v29, s[64:67], s10 offen nt
    v_and_b32 v188, 0xffff0000, v67
    v_and_b32 v189, 0xffff0000, v71
    v_and_b32 v190, 0xffff0000, v75
    v_and_b32 v191, 0xffff0000, v79
    v_mul_f32 v188, v188, v156
    v_mul_f32 v189, v189, v157
    v_mul_f32 v190, v190, v158
    v_mul_f32 v191, v191, v159
    s_mov_b32 s10, 57344
    buffer_store_dwordx4 v[188:191], v29, s[64:67], s10 offen nt
    s_waitcnt vmcnt(0)
    s_endpgm
Y_G:
    s_setprio 0
    v_and_b32 v3, 31, v2
    v_mov_b32 v23, 0
    v_mov_b32 v11, 163712
    v_lshrrev_b32 v4, 5, v2
    s_lshr_b32 s8, s3, 1
    s_and_b32 s9, s3, 1
    s_lshl_b32 s10, s7, 6
    s_lshl_b32 s11, s9, 5
    s_add_u32 s10, s10, s11
    v_add_u32 v5, s10, v3
    v_lshlrev_b32 v48, 1, v5
    s_lshl_b32 s10, s7, 7
    v_and_b32 v49, 15, v2
    v_lshl_add_u32 v49, v49, 3, s10
    s_lshl_b32 s10, s3, 2
    s_add_u32 s10, s10, 163712
    v_mov_b32 v10, s10
    s_waitcnt lgkmcnt(0)
    s_mov_b32 s76, s48
    s_mov_b32 s77, s49
    s_mov_b32 s78, 256
    s_mov_b32 s79, 0x00020000
    s_or_b32 s10, s2, s3
    s_cmp_eq_u32 s10, 0
    s_cbranch_scc0 G_nononce
    s_memrealtime s[10:11]
    s_waitcnt lgkmcnt(0)
    s_or_b32 s10, s10, 1
    v_mov_b32 v54, s10
    v_mov_b32 v55, s11
    s_mov_b64 exec, 1
    buffer_store_dwordx2 v[54:55], v23, s[76:79], 0 offen sc1
    s_mov_b64 exec, -1
G_nononce:
    s_mov_b32 s52, s42
    s_mov_b32 s53, s43
    s_mov_b32 s54, 2048
    s_mov_b32 s55, 0x00020000
    buffer_load_ushort v12, v48, s[52:55], 0 offen
    s_mov_b32 s52, s30
    s_mov_b32 s53, s31
    buffer_load_ushort v13, v48, s[52:55], 0 offen
    s_mov_b32 s52, s32
    s_mov_b32 s53, s33
    buffer_load_ushort v14, v48, s[52:55], 0 offen
    s_mov_b32 s52, s44
    s_mov_b32 s53, s45
    buffer_load_dwordx2 v[24:25], v49, s[52:55], 0 offen
    s_mov_b32 s52, s28
    s_mov_b32 s53, s29
    s_mov_b32 s54, 4194304
    s_mov_b32 s55, 0x00020000
    s_mov_b32 s60, s46
    s_mov_b32 s61, s47
    s_mov_b32 s62, 16777216
    s_mov_b32 s63, 0x00020000
    s_add_u32 s64, s50, 16777216
    s_addc_u32 s65, s51, 0
    s_mov_b32 s66, 278528
    s_mov_b32 s67, 0x00020000
    s_add_u32 s68, s50, 8388608
    s_addc_u32 s69, s51, 0
    s_mov_b32 s70, 8388608
    s_mov_b32 s71, 0x00020000
    s_add_u32 s72, s50, 17825792
    s_addc_u32 s73, s51, 0
    s_mov_b32 s74, 65536
    s_mov_b32 s75, 0x00020000
    s_cmp_eq_u32 s9, 1
    s_cselect_b32 s80, s40, s38
    s_cselect_b32 s81, s41, s39
    s_mov_b32 s82, 2097152
    s_mov_b32 s83, 0x00020000
    s_lshl_b32 s10, s6, 7
    s_lshl_b32 s11, s3, 5
    s_add_u32 s10, s10, s11
    v_lshrrev_b32 v50, 4, v2
    v_lshl_add_u32 v50, v50, 2, s10
    v_lshl_add_u32 v22, v50, 11, v49
    v_xor_b32 v50, 1, v4
    v_lshlrev_b32 v50, 14, v50
    v_lshl_add_u32 v53, v5, 4, v50
    v_lshlrev_b32 v26, 4, v2
    v_add_u32 v27, 4096, v26
    v_lshrrev_b32 v50, 1, v3
    v_and_b32 v50, 7, v50
    v_xor_b32 v50, v50, v4
    v_lshlrev_b32 v50, 4, v50
    v_lshl_add_u32 v50, v3, 7, v50
    s_lshl_b32 s10, s8, 13
    s_lshl_b32 s11, s9, 13
    s_add_u32 s11, s11, 16384
    v_add_u32 v32, s10, v50
    v_add_u32 v36, s11, v50
    v_xor_b32 v33, 32, v32
    v_xor_b32 v37, 32, v36
    v_xor_b32 v34, 64, v32
    v_xor_b32 v38, 64, v36
    v_xor_b32 v35, 96, v32
    v_xor_b32 v39, 96, v36
    v_add_u32 v40, 65536, v32
    v_add_u32 v41, 65536, v33
    v_add_u32 v42, 65536, v34
    v_add_u32 v43, 65536, v35
    v_add_u32 v44, 65536, v36
    v_add_u32 v45, 65536, v37
    v_add_u32 v46, 65536, v38
    v_add_u32 v47, 65536, v39
    v_mov_b32 v64, 0
    v_mov_b32 v65, 0
    v_mov_b32 v66, 0
    v_mov_b32 v67, 0
    v_mov_b32 v68, 0
    v_mov_b32 v69, 0
    v_mov_b32 v70, 0
    v_mov_b32 v71, 0
    v_mov_b32 v72, 0
    v_mov_b32 v73, 0
    v_mov_b32 v74, 0
    v_mov_b32 v75, 0
    v_mov_b32 v76, 0
    v_mov_b32 v77, 0
    v_mov_b32 v78, 0
    v_mov_b32 v79, 0
    v_mov_b32 v80, 0
    v_mov_b32 v81, 0
    v_mov_b32 v82, 0
    v_mov_b32 v83, 0
    v_mov_b32 v84, 0
    v_mov_b32 v85, 0
    v_mov_b32 v86, 0
    v_mov_b32 v87, 0
    v_mov_b32 v88, 0
    v_mov_b32 v89, 0
    v_mov_b32 v90, 0
    v_mov_b32 v91, 0
    v_mov_b32 v92, 0
    v_mov_b32 v93, 0
    v_mov_b32 v94, 0
    v_mov_b32 v95, 0
    v_mov_b32 v96, 0
    v_mov_b32 v97, 0
    v_mov_b32 v98, 0
    v_mov_b32 v99, 0
    v_mov_b32 v100, 0
    v_mov_b32 v101, 0
    v_mov_b32 v102, 0
    v_mov_b32 v103, 0
    v_mov_b32 v104, 0
    v_mov_b32 v105, 0
    v_mov_b32 v106, 0
    v_mov_b32 v107, 0
    v_mov_b32 v108, 0
    v_mov_b32 v109, 0
    v_mov_b32 v110, 0
    v_mov_b32 v111, 0
    v_mov_b32 v112, 0
    v_mov_b32 v113, 0
    v_mov_b32 v114, 0
    v_mov_b32 v115, 0
    v_mov_b32 v116, 0
    v_mov_b32 v117, 0
    v_mov_b32 v118, 0
    v_mov_b32 v119, 0
    v_mov_b32 v120, 0
    v_mov_b32 v121, 0
    v_mov_b32 v122, 0
    v_mov_b32 v123, 0
    v_mov_b32 v124, 0
    v_mov_b32 v125, 0
    v_mov_b32 v126, 0
    v_mov_b32 v127, 0
    s_lshl_b32 s10, s8, 10
    s_lshl_b32 s11, s9, 9
    s_add_u32 s10, s10, s11
    s_add_u32 s10, s10, 151552
    v_lshl_add_u32 v0, v3, 4, s10
    v_xor_b32 v1, 1024, v0
    s_lshl_b32 s10, s8, 1
    s_sub_i32 s10, s6, s10
    v_sub_u32 v56, s10, v4
    v_add_u32 v57, 0, v56
    v_max_i32 v57, 0, v57
    v_lshlrev_b32 v57, 14, v57
    v_lshl_add_u32 v60, v5, 4, v57
    v_add_u32 v57, -4, v56
    v_max_i32 v57, 0, v57
    v_lshlrev_b32 v57, 14, v57
    v_lshl_add_u32 v61, v5, 4, v57
    v_add_u32 v57, -8, v56
    v_max_i32 v57, 0, v57
    v_lshlrev_b32 v57, 14, v57
    v_lshl_add_u32 v62, v5, 4, v57
    v_add_u32 v57, -12, v56
    v_max_i32 v57, 0, v57
    v_lshlrev_b32 v57, 14, v57
    v_lshl_add_u32 v63, v5, 4, v57
    s_mov_b32 s15, 0
G_s0_w:
    ds_read_b64 v[48:49], v11 offset:16
    s_waitcnt lgkmcnt(0)
    v_min_u32 v48, v48, v49
    v_cmp_gt_u32 vcc, 1, v48
    s_cbranch_vccz G_s0_ok
    s_add_u32 s15, s15, 1
    s_cmp_lt_u32 s15, 160000
    s_cbranch_scc1 G_s0_w
G_s0_ok:
    ds_read_b128 v[128:131], v32 offset:0
    ds_read_b128 v[136:139], v36 offset:0
    ds_read_b128 v[140:143], v36 offset:4096
    ds_read_b128 v[132:135], v32 offset:4096
    ds_read_b128 v[144:147], v33 offset:0
    ds_read_b128 v[152:155], v37 offset:0
    ds_read_b128 v[156:159], v37 offset:4096
    ds_read_b128 v[148:151], v33 offset:4096
    ds_read_b128 v[160:163], v34 offset:0
    ds_read_b128 v[168:171], v38 offset:0
    ds_read_b128 v[172:175], v38 offset:4096
    ds_read_b128 v[164:167], v34 offset:4096
    ds_read_b128 v[176:179], v35 offset:0
    ds_read_b128 v[184:187], v39 offset:0
    ds_read_b128 v[188:191], v39 offset:4096
    ds_read_b128 v[180:183], v35 offset:4096
    ds_read_b64 v[48:49], v11 offset:16
    v_mov_b32 v52, 1
    s_mov_b32 s12, 2
    s_waitcnt lgkmcnt(0)
    ds_write_b32 v10, v52
G1_loop:
    v_mfma_f32_32x32x16_bf16 v[64:79], v[128:131], v[136:139], v[64:79]
    s_waitcnt lgkmcnt(0)
    v_min_u32 v48, v48, v49
    v_cmp_gt_u32 vcc, s12, v48
    s_cbranch_vccnz G1_slow0
G1_back0:
    ds_read_b128 v[192:195], v32 offset:32768
    ds_read_b128 v[200:203], v36 offset:32768
    v_mfma_f32_32x32x16_bf16 v[80:95], v[128:131], v[140:143], v[80:95]
    ds_read_b128 v[204:207], v36 offset:36864
    ds_read_b128 v[196:199], v32 offset:36864
    v_mfma_f32_32x32x16_bf16 v[96:111], v[132:135], v[136:139], v[96:111]
    ds_read_b128 v[208:211], v33 offset:32768
    ds_read_b128 v[216:219], v37 offset:32768
    v_mfma_f32_32x32x16_bf16 v[112:127], v[132:135], v[140:143], v[112:127]
    ds_read_b128 v[220:223], v37 offset:36864
    ds_read_b128 v[212:215], v33 offset:36864
    v_mfma_f32_32x32x16_bf16 v[64:79], v[144:147], v[152:155], v[64:79]
    ds_read_b128 v[224:227], v34 offset:32768
    ds_read_b128 v[232:235], v38 offset:32768
    v_mfma_f32_32x32x16_bf16 v[80:95], v[144:147], v[156:159], v[80:95]
    ds_read_b128 v[236:239], v38 offset:36864
    ds_read_b128 v[228:231], v34 offset:36864
    v_mfma_f32_32x32x16_bf16 v[96:111], v[148:151], v[152:155], v[96:111]
    ds_read_b128 v[240:243], v35 offset:32768
    ds_read_b128 v[248:251], v39 offset:32768
    v_mfma_f32_32x32x16_bf16 v[112:127], v[148:151], v[156:159], v[112:127]
    ds_read_b128 v[252:255], v39 offset:36864
    ds_read_b128 v[244:247], v35 offset:36864
    v_mfma_f32_32x32x16_bf16 v[64:79], v[160:163], v[168:171], v[64:79]
    v_mfma_f32_32x32x16_bf16 v[80:95], v[160:163], v[172:175], v[80:95]
    v_mfma_f32_32x32x16_bf16 v[96:111], v[164:167], v[168:171], v[96:111]
    v_mfma_f32_32x32x16_bf16 v[112:127], v[164:167], v[172:175], v[112:127]
    v_mfma_f32_32x32x16_bf16 v[64:79], v[176:179], v[184:187], v[64:79]
    v_mov_b32 v52, s12
    s_waitcnt lgkmcnt(0)
    ds_write_b32 v10, v52
    s_add_u32 s12, s12, 1
    v_mfma_f32_32x32x16_bf16 v[80:95], v[176:179], v[188:191], v[80:95]
    ds_read_b64 v[48:49], v11 offset:16
    v_mfma_f32_32x32x16_bf16 v[96:111], v[180:183], v[184:187], v[96:111]
    v_mfma_f32_32x32x16_bf16 v[112:127], v[180:183], v[188:191], v[112:127]
    v_mfma_f32_32x32x16_bf16 v[64:79], v[192:195], v[200:203], v[64:79]
    s_waitcnt lgkmcnt(0)
    v_min_u32 v48, v48, v49
    v_cmp_gt_u32 vcc, s12, v48
    s_cbranch_vccnz G1_slow1
G1_back1:
    ds_read_b128 v[128:131], v40 offset:0
    ds_read_b128 v[136:139], v44 offset:0
    v_mfma_f32_32x32x16_bf16 v[80:95], v[192:195], v[204:207], v[80:95]
    ds_read_b128 v[140:143], v44 offset:4096
    ds_read_b128 v[132:135], v40 offset:4096
    v_mfma_f32_32x32x16_bf16 v[96:111], v[196:199], v[200:203], v[96:111]
    ds_read_b128 v[144:147], v41 offset:0
    ds_read_b128 v[152:155], v45 offset:0
    v_mfma_f32_32x32x16_bf16 v[112:127], v[196:199], v[204:207], v[112:127]
    ds_read_b128 v[156:159], v45 offset:4096
    ds_read_b128 v[148:151], v41 offset:4096
    v_mfma_f32_32x32x16_bf16 v[64:79], v[208:211], v[216:219], v[64:79]
    ds_read_b128 v[160:163], v42 offset:0
    ds_read_b128 v[168:171], v46 offset:0
    v_mfma_f32_32x32x16_bf16 v[80:95], v[208:211], v[220:223], v[80:95]
    ds_read_b128 v[172:175], v46 offset:4096
    ds_read_b128 v[164:167], v42 offset:4096
    v_mfma_f32_32x32x16_bf16 v[96:111], v[212:215], v[216:219], v[96:111]
    ds_read_b128 v[176:179], v43 offset:0
    ds_read_b128 v[184:187], v47 offset:0
    v_mfma_f32_32x32x16_bf16 v[112:127], v[212:215], v[220:223], v[112:127]
    ds_read_b128 v[188:191], v47 offset:4096
    ds_read_b128 v[180:183], v43 offset:4096
    v_mfma_f32_32x32x16_bf16 v[64:79], v[224:227], v[232:235], v[64:79]
    v_mfma_f32_32x32x16_bf16 v[80:95], v[224:227], v[236:239], v[80:95]
    v_mfma_f32_32x32x16_bf16 v[96:111], v[228:231], v[232:235], v[96:111]
    v_mfma_f32_32x32x16_bf16 v[112:127], v[228:231], v[236:239], v[112:127]
    v_mfma_f32_32x32x16_bf16 v[64:79], v[240:243], v[248:251], v[64:79]
    v_mov_b32 v52, s12
    s_waitcnt lgkmcnt(0)
    ds_write_b32 v10, v52
    s_add_u32 s12, s12, 1
    v_mfma_f32_32x32x16_bf16 v[80:95], v[240:243], v[252:255], v[80:95]
    ds_read_b64 v[48:49], v11 offset:16
    v_mfma_f32_32x32x16_bf16 v[96:111], v[244:247], v[248:251], v[96:111]
    v_mfma_f32_32x32x16_bf16 v[112:127], v[244:247], v[252:255], v[112:127]
    v_mfma_f32_32x32x16_bf16 v[64:79], v[128:131], v[136:139], v[64:79]
    s_waitcnt lgkmcnt(0)
    v_min_u32 v48, v48, v49
    v_cmp_gt_u32 vcc, s12, v48
    s_cbranch_vccnz G1_slow2
G1_back2:
    ds_read_b128 v[192:195], v40 offset:32768
    ds_read_b128 v[200:203], v44 offset:32768
    v_mfma_f32_32x32x16_bf16 v[80:95], v[128:131], v[140:143], v[80:95]
    ds_read_b128 v[204:207], v44 offset:36864
    ds_read_b128 v[196:199], v40 offset:36864
    v_mfma_f32_32x32x16_bf16 v[96:111], v[132:135], v[136:139], v[96:111]
    ds_read_b128 v[208:211], v41 offset:32768
    ds_read_b128 v[216:219], v45 offset:32768
    v_mfma_f32_32x32x16_bf16 v[112:127], v[132:135], v[140:143], v[112:127]
    ds_read_b128 v[220:223], v45 offset:36864
    ds_read_b128 v[212:215], v41 offset:36864
    v_mfma_f32_32x32x16_bf16 v[64:79], v[144:147], v[152:155], v[64:79]
    ds_read_b128 v[224:227], v42 offset:32768
    ds_read_b128 v[232:235], v46 offset:32768
    v_mfma_f32_32x32x16_bf16 v[80:95], v[144:147], v[156:159], v[80:95]
    ds_read_b128 v[236:239], v46 offset:36864
    ds_read_b128 v[228:231], v42 offset:36864
    v_mfma_f32_32x32x16_bf16 v[96:111], v[148:151], v[152:155], v[96:111]
    ds_read_b128 v[240:243], v43 offset:32768
    ds_read_b128 v[248:251], v47 offset:32768
    v_mfma_f32_32x32x16_bf16 v[112:127], v[148:151], v[156:159], v[112:127]
    ds_read_b128 v[252:255], v47 offset:36864
    ds_read_b128 v[244:247], v43 offset:36864
    v_mfma_f32_32x32x16_bf16 v[64:79], v[160:163], v[168:171], v[64:79]
    v_mfma_f32_32x32x16_bf16 v[80:95], v[160:163], v[172:175], v[80:95]
    v_mfma_f32_32x32x16_bf16 v[96:111], v[164:167], v[168:171], v[96:111]
    v_mfma_f32_32x32x16_bf16 v[112:127], v[164:167], v[172:175], v[112:127]
    v_mfma_f32_32x32x16_bf16 v[64:79], v[176:179], v[184:187], v[64:79]
    v_mov_b32 v52, s12
    s_waitcnt lgkmcnt(0)
    ds_write_b32 v10, v52
    s_add_u32 s12, s12, 1
    v_mfma_f32_32x32x16_bf16 v[80:95], v[176:179], v[188:191], v[80:95]
    ds_read_b64 v[48:49], v11 offset:16
    v_mfma_f32_32x32x16_bf16 v[96:111], v[180:183], v[184:187], v[96:111]
    v_mfma_f32_32x32x16_bf16 v[112:127], v[180:183], v[188:191], v[112:127]
    s_cmp_eq_u32 s12, 17
    s_cbranch_scc1 G1_last
    v_mfma_f32_32x32x16_bf16 v[64:79], v[192:195], v[200:203], v[64:79]
    s_waitcnt lgkmcnt(0)
    v_min_u32 v48, v48, v49
    v_cmp_gt_u32 vcc, s12, v48
    s_cbranch_vccnz G1_slow3
G1_back3:
    ds_read_b128 v[128:131], v32 offset:0
    ds_read_b128 v[136:139], v36 offset:0
    v_mfma_f32_32x32x16_bf16 v[80:95], v[192:195], v[204:207], v[80:95]
    ds_read_b128 v[140:143], v36 offset:4096
    ds_read_b128 v[132:135], v32 offset:4096
    v_mfma_f32_32x32x16_bf16 v[96:111], v[196:199], v[200:203], v[96:111]
    ds_read_b128 v[144:147], v33 offset:0
    ds_read_b128 v[152:155], v37 offset:0
    v_mfma_f32_32x32x16_bf16 v[112:127], v[196:199], v[204:207], v[112:127]
    ds_read_b128 v[156:159], v37 offset:4096
    ds_read_b128 v[148:151], v33 offset:4096
    v_mfma_f32_32x32x16_bf16 v[64:79], v[208:211], v[216:219], v[64:79]
    ds_read_b128 v[160:163], v34 offset:0
    ds_read_b128 v[168:171], v38 offset:0
    v_mfma_f32_32x32x16_bf16 v[80:95], v[208:211], v[220:223], v[80:95]
    ds_read_b128 v[172:175], v38 offset:4096
    ds_read_b128 v[164:167], v34 offset:4096
    v_mfma_f32_32x32x16_bf16 v[96:111], v[212:215], v[216:219], v[96:111]
    ds_read_b128 v[176:179], v35 offset:0
    ds_read_b128 v[184:187], v39 offset:0
    v_mfma_f32_32x32x16_bf16 v[112:127], v[212:215], v[220:223], v[112:127]
    ds_read_b128 v[188:191], v39 offset:4096
    ds_read_b128 v[180:183], v35 offset:4096
    v_mfma_f32_32x32x16_bf16 v[64:79], v[224:227], v[232:235], v[64:79]
    v_mfma_f32_32x32x16_bf16 v[80:95], v[224:227], v[236:239], v[80:95]
    v_mfma_f32_32x32x16_bf16 v[96:111], v[228:231], v[232:235], v[96:111]
    v_mfma_f32_32x32x16_bf16 v[112:127], v[228:231], v[236:239], v[112:127]
    v_mfma_f32_32x32x16_bf16 v[64:79], v[240:243], v[248:251], v[64:79]
    v_mov_b32 v52, s12
    s_waitcnt lgkmcnt(0)
    ds_write_b32 v10, v52
    s_add_u32 s12, s12, 1
    v_mfma_f32_32x32x16_bf16 v[80:95], v[240:243], v[252:255], v[80:95]
    ds_read_b64 v[48:49], v11 offset:16
    v_mfma_f32_32x32x16_bf16 v[96:111], v[244:247], v[248:251], v[96:111]
    v_mfma_f32_32x32x16_bf16 v[112:127], v[244:247], v[252:255], v[112:127]
    s_branch G1_loop
G1_slow0:
    s_mov_b32 s15, 0
G1_sl0_w:
    ds_read_b64 v[48:49], v11 offset:16
    s_waitcnt lgkmcnt(0)
    v_min_u32 v48, v48, v49
    v_cmp_gt_u32 vcc, s12, v48
    s_cbranch_vccz G1_sl0_ok
    s_add_u32 s15, s15, 1
    s_cmp_lt_u32 s15, 160000
    s_cbranch_scc1 G1_sl0_w
G1_sl0_ok:
    s_branch G1_back0
G1_slow1:
    s_mov_b32 s15, 0
G1_sl1_w:
    ds_read_b64 v[48:49], v11 offset:16
    s_waitcnt lgkmcnt(0)
    v_min_u32 v48, v48, v49
    v_cmp_gt_u32 vcc, s12, v48
    s_cbranch_vccz G1_sl1_ok
    s_add_u32 s15, s15, 1
    s_cmp_lt_u32 s15, 160000
    s_cbranch_scc1 G1_sl1_w
G1_sl1_ok:
    s_branch G1_back1
G1_slow2:
    s_mov_b32 s15, 0
G1_sl2_w:
    ds_read_b64 v[48:49], v11 offset:16
    s_waitcnt lgkmcnt(0)
    v_min_u32 v48, v48, v49
    v_cmp_gt_u32 vcc, s12, v48
    s_cbranch_vccz G1_sl2_ok
    s_add_u32 s15, s15, 1
    s_cmp_lt_u32 s15, 160000
    s_cbranch_scc1 G1_sl2_w
G1_sl2_ok:
    s_branch G1_back2
G1_slow3:
    s_mov_b32 s15, 0
G1_sl3_w:
    ds_read_b64 v[48:49], v11 offset:16
    s_waitcnt lgkmcnt(0)
    v_min_u32 v48, v48, v49
    v_cmp_gt_u32 vcc, s12, v48
    s_cbranch_vccz G1_sl3_ok
    s_add_u32 s15, s15, 1
    s_cmp_lt_u32 s15, 160000
    s_cbranch_scc1 G1_sl3_w
G1_sl3_ok:
    s_branch G1_back3
G1_last:
    v_mfma_f32_32x32x16_bf16 v[64:79], v[192:195], v[200:203], v[64:79]
    s_setprio 3
    s_waitcnt vmcnt(0)
    ds_read_b64 v[30:31], v11 offset:32
    v_lshlrev_b32 v133, 16, v12
    v_lshlrev_b32 v134, 16, v13
    v_lshlrev_b32 v135, 16, v14
    v_mul_f32 v133, 0x3fb8aa3b, v133
    v_mfma_f32_32x32x16_bf16 v[80:95], v[192:195], v[204:207], v[80:95]
    v_exp_f32 v133, v133
    v_mul_f32 v140, v134, v134
    v_cvt_pk_bf16_f32 v133, v133, v133
    v_fmac_f32 v140, v135, v135
    v_mfma_f32_32x32x16_bf16 v[96:111], v[196:199], v[200:203], v[96:111]
    v_lshlrev_b32 v133, 16, v133
    v_rcp_f32 v140, v140
    v_mul_f32 v136, v133, v134
    v_mul_f32 v137, v133, v135
    v_mfma_f32_32x32x16_bf16 v[112:127], v[196:199], v[204:207], v[112:127]
    v_mul_f32 v136, 0x3fb8aa3b, v136
    v_exp_f32 v136, v136
    v_mul_f32 v137, 0.15915494, v137
    v_cos_f32 v138, v137
    v_mfma_f32_32x32x16_bf16 v[64:79], v[208:211], v[216:219], v[64:79]
    v_sin_f32 v139, v137
    v_add_f32 v140, v140, v140
    v_mul_f32 v6, v136, v138
    v_mul_f32 v7, v136, v139
    v_mfma_f32_32x32x16_bf16 v[80:95], v[208:211], v[220:223], v[80:95]
    v_mul_f32 v128, v6, v6
    v_mul_f32 v129, v6, v7
    v_fma_f32 v128, -v7, v7, v128
    v_fmac_f32 v129, v7, v6
    v_mfma_f32_32x32x16_bf16 v[96:111], v[212:215], v[216:219], v[96:111]
    v_mul_f32 v130, v128, v128
    v_mul_f32 v131, v128, v129
    v_fma_f32 v130, -v129, v129, v130
    v_fmac_f32 v131, v129, v128
    v_mfma_f32_32x32x16_bf16 v[112:127], v[212:215], v[220:223], v[112:127]
    v_mul_f32 v12, v130, v130
    v_mul_f32 v13, v130, v131
    v_fma_f32 v12, -v131, v131, v12
    v_fmac_f32 v13, v131, v130
    v_mfma_f32_32x32x16_bf16 v[64:79], v[224:227], v[232:235], v[64:79]
    v_mul_f32 v14, v12, v12
    v_mul_f32 v15, v12, v13
    v_fma_f32 v14, -v13, v13, v14
    v_fmac_f32 v15, v13, v12
    v_mfma_f32_32x32x16_bf16 v[80:95], v[224:227], v[236:239], v[80:95]
    v_mul_f32 v16, v14, v14
    v_mul_f32 v17, v14, v15
    v_fma_f32 v16, -v15, v15, v16
    v_fmac_f32 v17, v15, v14
    v_mfma_f32_32x32x16_bf16 v[96:111], v[228:231], v[232:235], v[96:111]
    v_add_f32 v136, -1.0, v6
    v_mul_f32 v138, v136, v134
    v_fmac_f32 v138, v7, v135
    v_mul_f32 v139, v7, v134
    v_mfma_f32_32x32x16_bf16 v[112:127], v[228:231], v[236:239], v[112:127]
    v_fma_f32 v139, -v136, v135, v139
    v_mul_f32 v8, v138, v140
    v_mul_f32 v9, v139, v140
    v_mul_f32 v18, v16, v16
    v_mfma_f32_32x32x16_bf16 v[64:79], v[240:243], v[248:251], v[64:79]
    v_mul_f32 v19, v16, v17
    v_fma_f32 v18, -v17, v17, v18
    v_fmac_f32 v19, v17, v16
    v_mul_f32 v20, v18, v18
    v_mfma_f32_32x32x16_bf16 v[80:95], v[240:243], v[252:255], v[80:95]
    v_mul_f32 v21, v18, v19
    v_fma_f32 v20, -v19, v19, v20
    v_fmac_f32 v21, v19, v18
    v_mfma_f32_32x32x16_bf16 v[96:111], v[244:247], v[248:251], v[96:111]
    v_mfma_f32_32x32x16_bf16 v[112:127], v[244:247], v[252:255], v[112:127]
    s_nop 1
    v_fma_f32 v40, v6, v64, v66
    v_fma_f32 v41, v6, v65, v67
    s_nop 2
    v_fma_f32 v42, v6, v80, v82
    v_fma_f32 v43, v6, v81, v83
    s_nop 1
    v_fma_f32 v44, v6, v96, v98
    v_fma_f32 v45, v6, v97, v99
    v_fma_f32 v46, v6, v112, v114
    v_fma_f32 v47, v6, v113, v115
    v_fma_f32 v40, -v7, v80, v40
    v_fma_f32 v41, -v7, v81, v41
    v_fmac_f32 v42, v7, v64
    v_fmac_f32 v43, v7, v65
    v_fma_f32 v44, -v7, v112, v44
    v_fma_f32 v45, -v7, v113, v45
    v_fmac_f32 v46, v7, v96
    v_fmac_f32 v47, v7, v97
    v_fma_f32 v32, v6, v40, v68
    v_fma_f32 v33, v6, v41, v69
    v_fma_f32 v34, v6, v42, v84
    v_fma_f32 v35, v6, v43, v85
    v_fma_f32 v36, v6, v44, v100
    v_fma_f32 v37, v6, v45, v101
    v_fma_f32 v38, v6, v46, v116
    v_fma_f32 v39, v6, v47, v117
    v_fma_f32 v32, -v7, v42, v32
    v_fma_f32 v33, -v7, v43, v33
    v_fmac_f32 v34, v7, v40
    v_fmac_f32 v35, v7, v41
    v_fma_f32 v36, -v7, v46, v36
    v_fma_f32 v37, -v7, v47, v37
    v_fmac_f32 v38, v7, v44
    v_fmac_f32 v39, v7, v45
    v_fma_f32 v40, v6, v32, v70
    v_fma_f32 v41, v6, v33, v71
    v_fma_f32 v42, v6, v34, v86
    v_fma_f32 v43, v6, v35, v87
    v_fma_f32 v44, v6, v36, v102
    v_fma_f32 v45, v6, v37, v103
    v_fma_f32 v46, v6, v38, v118
    v_fma_f32 v47, v6, v39, v119
    v_fma_f32 v40, -v7, v34, v40
    v_fma_f32 v41, -v7, v35, v41
    v_fmac_f32 v42, v7, v32
    v_fmac_f32 v43, v7, v33
    v_fma_f32 v44, -v7, v38, v44
    v_fma_f32 v45, -v7, v39, v45
    v_fmac_f32 v46, v7, v36
    v_fmac_f32 v47, v7, v37
    v_fma_f32 v32, v6, v40, v72
    v_fma_f32 v33, v6, v41, v73
    v_fma_f32 v34, v6, v42, v88
    v_fma_f32 v35, v6, v43, v89
    v_fma_f32 v36, v6, v44, v104
    v_fma_f32 v37, v6, v45, v105
    v_fma_f32 v38, v6, v46, v120
    v_fma_f32 v39, v6, v47, v121
    v_fma_f32 v32, -v7, v42, v32
    v_fma_f32 v33, -v7, v43, v33
    v_fmac_f32 v34, v7, v40
    v_fmac_f32 v35, v7, v41
    v_fma_f32 v36, -v7, v46, v36
    v_fma_f32 v37, -v7, v47, v37
    v_fmac_f32 v38, v7, v44
    v_fmac_f32 v39, v7, v45
    v_fma_f32 v40, v6, v32, v74
    v_fma_f32 v41, v6, v33, v75
    v_fma_f32 v42, v6, v34, v90
    v_fma_f32 v43, v6, v35, v91
    v_fma_f32 v44, v6, v36, v106
    v_fma_f32 v45, v6, v37, v107
    v_fma_f32 v46, v6, v38, v122
    v_fma_f32 v47, v6, v39, v123
    v_fma_f32 v40, -v7, v34, v40
    v_fma_f32 v41, -v7, v35, v41
    v_fmac_f32 v42, v7, v32
    v_fmac_f32 v43, v7, v33
    v_fma_f32 v44, -v7, v38, v44
    v_fma_f32 v45, -v7, v39, v45
    v_fmac_f32 v46, v7, v36
    v_fmac_f32 v47, v7, v37
    v_fma_f32 v32, v6, v40, v76
    v_fma_f32 v33, v6, v41, v77
    v_fma_f32 v34, v6, v42, v92
    v_fma_f32 v35, v6, v43, v93
    v_fma_f32 v36, v6, v44, v108
    v_fma_f32 v37, v6, v45, v109
    v_fma_f32 v38, v6, v46, v124
    v_fma_f32 v39, v6, v47, v125
    v_fma_f32 v32, -v7, v42, v32
    v_fma_f32 v33, -v7, v43, v33
    v_fmac_f32 v34, v7, v40
    v_fmac_f32 v35, v7, v41
    v_fma_f32 v36, -v7, v46, v36
    v_fma_f32 v37, -v7, v47, v37
    v_fmac_f32 v38, v7, v44
    v_fmac_f32 v39, v7, v45
    v_fma_f32 v40, v6, v32, v78
    v_fma_f32 v41, v6, v33, v79
    v_fma_f32 v42, v6, v34, v94
    v_fma_f32 v43, v6, v35, v95
    v_fma_f32 v44, v6, v36, v110
    v_fma_f32 v45, v6, v37, v111
    v_fma_f32 v46, v6, v38, v126
    v_fma_f32 v47, v6, v39, v127
    v_fma_f32 v40, -v7, v34, v40
    v_fma_f32 v41, -v7, v35, v41
    v_fmac_f32 v42, v7, v32
    v_fmac_f32 v43, v7, v33
    v_fma_f32 v44, -v7, v38, v44
    v_fma_f32 v45, -v7, v39, v45
    v_fmac_f32 v46, v7, v36
    v_fmac_f32 v47, v7, v37
    v_fmac_f32 v44, v12, v40
    v_fmac_f32 v45, v12, v41
    v_fmac_f32 v46, v12, v42
    v_fmac_f32 v47, v12, v43
    v_fma_f32 v44, -v13, v42, v44
    v_fma_f32 v45, -v13, v43, v45
    v_fmac_f32 v46, v13, v40
    v_fmac_f32 v47, v13, v41
    v_fma_f32 v32, v14, v44, v45
    v_fma_f32 v34, v14, v46, v47
    v_fma_f32 v32, -v15, v46, v32
    v_fmac_f32 v34, v15, v44
    v_mov_b32 v33, v32
    v_mov_b32 v35, v34
    s_lshl_b32 s12, s6, 1
    s_add_u32 s12, s12, s8
    v_permlane32_swap_b32 v32, v33
    v_permlane32_swap_b32 v34, v35
    v_fma_f32 v28, v16, v32, v33
    v_fma_f32 v29, v16, v34, v35
    v_fma_f32 v28, -v17, v34, v28
    v_fmac_f32 v29, v17, v32
    s_waitcnt lgkmcnt(0)
    s_mov_b32 s15, 0
G_nw:
    v_cmp_eq_u32 vcc, 0, v30
    s_cbranch_vccz G_nok
    ds_read_b64 v[30:31], v11 offset:32
    s_add_u32 s15, s15, 1
    s_waitcnt lgkmcnt(0)
    s_cmp_lt_u32 s15, 160000
    s_cbranch_scc1 G_nw
G_nok:
    s_cmp_eq_u32 s8, 0
    s_cbranch_scc0 G_pw1
    ds_write_b128 v0, v[28:31] offset:2048
    s_branch G_pub1
G_pw1:
    s_mov_b32 s15, 0
G_x1:
    ds_read_b128 v[56:59], v1 offset:2048
    s_add_u32 s15, s15, 1
    s_waitcnt lgkmcnt(0)
    v_cmp_ne_u64 vcc, v[58:59], v[30:31]
    s_cbranch_vccz G_x1_ok
    s_cmp_lt_u32 s15, 160000
    s_cbranch_scc1 G_x1
G_x1_ok:
    v_fmac_f32 v28, v18, v56
    v_fmac_f32 v29, v18, v57
    s_lshl_b32 s13, s6, 14
    v_fma_f32 v28, -v19, v57, v28
    v_fmac_f32 v29, v19, v56
    s_mov_b32 exec_hi, 0
    buffer_store_dwordx4 v[28:31], v53, s[64:67], s13 offen sc1
    s_cmp_eq_u32 s6, 0
    s_cbranch_scc0 G_pub1
    s_not_b64 exec, exec
    v_mov_b32 v28, 0
    v_mov_b32 v29, 0
    buffer_store_dwordx4 v[28:31], v53, s[64:67], 0 offen sc1
G_pub1:
    s_mov_b64 exec, -1
    v_mul_f32 v128, v8, v64
    v_mul_f32 v129, v8, v65
    v_mul_f32 v144, -v8, v80
    v_mul_f32 v145, -v8, v81
    v_mul_f32 v160, v8, v96
    v_mul_f32 v161, v8, v97
    v_mul_f32 v176, -v8, v112
    v_mul_f32 v177, -v8, v113
    v_fma_f32 v128, -v9, v80, v128
    v_fma_f32 v129, -v9, v81, v129
    v_fma_f32 v144, -v9, v64, v144
    v_fma_f32 v145, -v9, v65, v145
    v_fma_f32 v160, -v9, v112, v160
    v_fma_f32 v161, -v9, v113, v161
    v_fma_f32 v176, -v9, v96, v176
    v_fma_f32 v177, -v9, v97, v177
    v_mul_f32 v130, v8, v66
    v_mul_f32 v131, v8, v67
    v_mul_f32 v146, -v8, v82
    v_mul_f32 v147, -v8, v83
    v_mul_f32 v162, v8, v98
    v_mul_f32 v163, v8, v99
    v_mul_f32 v178, -v8, v114
    v_mul_f32 v179, -v8, v115
    v_fma_f32 v130, -v9, v82, v130
    v_fma_f32 v131, -v9, v83, v131
    v_fma_f32 v146, -v9, v66, v146
    v_fma_f32 v147, -v9, v67, v147
    v_fma_f32 v162, -v9, v114, v162
    v_fma_f32 v163, -v9, v115, v163
    v_fma_f32 v178, -v9, v98, v178
    v_fma_f32 v179, -v9, v99, v179
    v_mul_f32 v132, v8, v68
    v_mul_f32 v133, v8, v69
    v_mul_f32 v148, -v8, v84
    v_mul_f32 v149, -v8, v85
    v_mul_f32 v164, v8, v100
    v_mul_f32 v165, v8, v101
    v_mul_f32 v180, -v8, v116
    v_mul_f32 v181, -v8, v117
    v_fma_f32 v132, -v9, v84, v132
    v_fma_f32 v133, -v9, v85, v133
    v_fma_f32 v148, -v9, v68, v148
    v_fma_f32 v149, -v9, v69, v149
    v_fma_f32 v164, -v9, v116, v164
    v_fma_f32 v165, -v9, v117, v165
    v_fma_f32 v180, -v9, v100, v180
    v_fma_f32 v181, -v9, v101, v181
    v_mul_f32 v134, v8, v70
    v_mul_f32 v135, v8, v71
    v_mul_f32 v150, -v8, v86
    v_mul_f32 v151, -v8, v87
    v_mul_f32 v166, v8, v102
    v_mul_f32 v167, v8, v103
    v_mul_f32 v182, -v8, v118
    v_mul_f32 v183, -v8, v119
    v_fma_f32 v134, -v9, v86, v134
    v_fma_f32 v135, -v9, v87, v135
    v_fma_f32 v150, -v9, v70, v150
    v_fma_f32 v151, -v9, v71, v151
    v_fma_f32 v166, -v9, v118, v166
    v_fma_f32 v167, -v9, v119, v167
    v_fma_f32 v182, -v9, v102, v182
    v_fma_f32 v183, -v9, v103, v183
    v_mul_f32 v136, v8, v72
    v_mul_f32 v137, v8, v73
    v_mul_f32 v152, -v8, v88
    v_mul_f32 v153, -v8, v89
    v_mul_f32 v168, v8, v104
    v_mul_f32 v169, v8, v105
    v_mul_f32 v184, -v8, v120
    v_mul_f32 v185, -v8, v121
    v_fma_f32 v136, -v9, v88, v136
    v_fma_f32 v137, -v9, v89, v137
    v_fma_f32 v152, -v9, v72, v152
    v_fma_f32 v153, -v9, v73, v153
    v_fma_f32 v168, -v9, v120, v168
    v_fma_f32 v169, -v9, v121, v169
    v_fma_f32 v184, -v9, v104, v184
    v_fma_f32 v185, -v9, v105, v185
    v_mul_f32 v138, v8, v74
    v_mul_f32 v139, v8, v75
    v_mul_f32 v154, -v8, v90
    v_mul_f32 v155, -v8, v91
    v_mul_f32 v170, v8, v106
    v_mul_f32 v171, v8, v107
    v_mul_f32 v186, -v8, v122
    v_mul_f32 v187, -v8, v123
    v_fma_f32 v138, -v9, v90, v138
    v_fma_f32 v139, -v9, v91, v139
    v_fma_f32 v154, -v9, v74, v154
    v_fma_f32 v155, -v9, v75, v155
    v_fma_f32 v170, -v9, v122, v170
    v_fma_f32 v171, -v9, v123, v171
    v_fma_f32 v186, -v9, v106, v186
    v_fma_f32 v187, -v9, v107, v187
    v_mul_f32 v140, v8, v76
    v_mul_f32 v141, v8, v77
    v_mul_f32 v156, -v8, v92
    v_mul_f32 v157, -v8, v93
    v_mul_f32 v172, v8, v108
    v_mul_f32 v173, v8, v109
    v_mul_f32 v188, -v8, v124
    v_mul_f32 v189, -v8, v125
    v_fma_f32 v140, -v9, v92, v140
    v_fma_f32 v141, -v9, v93, v141
    v_fma_f32 v156, -v9, v76, v156
    v_fma_f32 v157, -v9, v77, v157
    v_fma_f32 v172, -v9, v124, v172
    v_fma_f32 v173, -v9, v125, v173
    v_fma_f32 v188, -v9, v108, v188
    v_fma_f32 v189, -v9, v109, v189
    v_mul_f32 v142, v8, v78
    v_mul_f32 v143, v8, v79
    v_mul_f32 v158, -v8, v94
    v_mul_f32 v159, -v8, v95
    v_mul_f32 v174, v8, v110
    v_mul_f32 v175, v8, v111
    v_mul_f32 v190, -v8, v126
    v_mul_f32 v191, -v8, v127
    v_fma_f32 v142, -v9, v94, v142
    v_fma_f32 v143, -v9, v95, v143
    v_fma_f32 v158, -v9, v78, v158
    v_fma_f32 v159, -v9, v79, v159
    v_fma_f32 v174, -v9, v126, v174
    v_fma_f32 v175, -v9, v127, v175
    v_fma_f32 v190, -v9, v110, v190
    v_fma_f32 v191, -v9, v111, v191
    s_mov_b32 s13, 0
    buffer_load_dwordx2 v[80:81], v22, s[52:55], s13 offen offset:0
    buffer_load_dwordx2 v[82:83], v22, s[52:55], s13 offen offset:2048
    s_mov_b32 s13, 4096
    buffer_load_dwordx2 v[84:85], v22, s[52:55], s13 offen offset:0
    buffer_load_dwordx2 v[86:87], v22, s[52:55], s13 offen offset:2048
    s_mov_b32 s13, 32768
    buffer_load_dwordx2 v[88:89], v22, s[52:55], s13 offen offset:0
    buffer_load_dwordx2 v[90:91], v22, s[52:55], s13 offen offset:2048
    s_mov_b32 s13, 36864
    buffer_load_dwordx2 v[92:93], v22, s[52:55], s13 offen offset:0
    buffer_load_dwordx2 v[94:95], v22, s[52:55], s13 offen offset:2048
    v_cmp_eq_u32 vcc, 1, v4
    v_mov_b32 v36, 1.0
    s_nop 0
    v_cndmask_b32 v72, v36, v20, vcc
    v_cndmask_b32 v73, 0, v21, vcc
    v_cndmask_b32 v96, 0, v32, vcc
    v_cndmask_b32 v98, 0, v34, vcc
    v_cndmask_b32 v36, v36, v16, vcc
    v_cndmask_b32 v37, 0, v17, vcc
    s_cmp_eq_u32 s8, 1
    s_cselect_b64 s[14:15], -1, 0
    v_mul_f32 v74, v20, v20
    v_fma_f32 v97, v14, v96, v44
    v_mul_f32 v75, v20, v21
    v_fma_f32 v99, v14, v98, v46
    v_fma_f32 v74, -v21, v21, v74
    v_fma_f32 v97, -v15, v98, v97
    v_fmac_f32 v75, v21, v20
    v_fmac_f32 v99, v15, v96
    v_mul_f32 v76, v74, v74
    v_fma_f32 v100, v12, v96, v40
    v_mul_f32 v77, v74, v75
    v_fma_f32 v101, v12, v97, v41
    v_fma_f32 v76, -v75, v75, v76
    v_fma_f32 v102, v12, v98, v42
    v_fmac_f32 v77, v75, v74
    v_fma_f32 v103, v12, v99, v43
    v_cndmask_b32 v74, 1.0, v74, s[14:15]
    v_fma_f32 v100, -v13, v98, v100
    v_cndmask_b32 v75, 0, v75, s[14:15]
    v_fma_f32 v101, -v13, v99, v101
    v_mul_f32 v64, v72, v74
    v_fmac_f32 v102, v13, v96
    v_mul_f32 v65, v72, v75
    v_fmac_f32 v103, v13, v97
    v_fma_f32 v64, -v73, v75, v64
    v_mul_f32 v104, v8, v36
    v_fmac_f32 v65, v73, v74
    v_mul_f32 v106, v8, v37
    v_mul_f32 v66, v64, v76
    v_fma_f32 v104, -v9, v37, v104
    v_mul_f32 v67, v64, v77
    v_fmac_f32 v106, v9, v36
    v_fma_f32 v66, -v65, v77, v66
    v_mul_f32 v105, v14, v104
    v_fmac_f32 v67, v65, v76
    v_mul_f32 v107, v14, v106
    v_mul_f32 v68, v66, v76
    v_fma_f32 v105, -v15, v106, v105
    v_mul_f32 v69, v66, v77
    v_fmac_f32 v107, v15, v104
    v_fma_f32 v68, -v67, v77, v68
    v_mul_f32 v108, v12, v104
    v_fmac_f32 v69, v67, v76
    v_mul_f32 v109, v12, v105
    v_mul_f32 v70, v68, v76
    v_mul_f32 v110, v12, v106
    v_mul_f32 v71, v68, v77
    v_mul_f32 v111, v12, v107
    v_fma_f32 v70, -v69, v77, v70
    v_fma_f32 v108, -v13, v106, v108
    v_fmac_f32 v71, v69, v76
    v_fma_f32 v109, -v13, v107, v109
    v_fmac_f32 v110, v13, v104
    v_fmac_f32 v111, v13, v105
    v_mul_f32 v112, v8, v96
    v_mul_f32 v113, v8, v97
    v_mul_f32 v114, -v8, v98
    v_mul_f32 v115, -v8, v99
    v_fma_f32 v112, -v9, v98, v112
    v_fma_f32 v113, -v9, v99, v113
    v_fma_f32 v114, -v9, v96, v114
    v_fma_f32 v115, -v9, v97, v115
    v_mul_f32 v116, v8, v100
    v_mul_f32 v117, v8, v101
    v_mul_f32 v118, -v8, v102
    v_mul_f32 v119, -v8, v103
    v_fma_f32 v116, -v9, v102, v116
    v_fma_f32 v117, -v9, v103, v117
    v_fma_f32 v118, -v9, v100, v118
    v_fma_f32 v119, -v9, v101, v119
    s_lshl_b32 s13, s3, 13
    s_add_u32 s13, s13, 65536
    v_and_b32 v32, 1, v2
    v_and_b32 v33, 2, v2
    v_lshl_or_b32 v32, v33, 1, v32
    v_lshrrev_b32 v33, 1, v2
    v_xor_b32 v33, v33, v2
    v_bfe_u32 v33, v33, 2, 1
    v_lshl_or_b32 v32, v33, 1, v32
    v_lshlrev_b32 v33, 2, v4
    v_xor_b32 v32, v32, v33
    v_lshlrev_b32 v32, 4, v32
    v_lshl_add_u32 v32, v3, 7, v32
    v_add_u32 v120, s13, v32
    v_xor_b32 v121, 16, v120
    v_xor_b32 v122, 32, v120
    v_xor_b32 v123, 48, v120
    v_bfe_u32 v32, v2, 2, 2
    v_lshrrev_b32 v33, 4, v2
    v_lshl_add_u32 v33, v33, 3, v32
    v_lshlrev_b32 v33, 7, v33
    v_and_b32 v34, 1, v32
    v_and_b32 v32, 2, v32
    v_lshl_or_b32 v32, v32, 1, v34
    v_bfe_u32 v34, v2, 4, 1
    v_bfe_u32 v35, v2, 1, 1
    v_lshl_or_b32 v34, v34, 1, v35
    v_xor_b32 v32, v32, v34
    v_lshl_add_u32 v33, v32, 4, v33
    v_and_b32 v32, 1, v2
    v_lshl_add_u32 v33, v32, 3, v33
    v_add_u32 v124, s13, v33
    v_xor_b32 v125, 64, v124
    v_xor_b32 v126, 32, v124
    v_xor_b32 v127, 64, v126
    s_lshl_b32 s10, s7, 5
    s_add_u32 s10, s10, s8
    s_lshl_b32 s10, s10, 12
    v_lshrrev_b32 v40, 3, v2
    v_lshl_add_u32 v40, v40, 13, s10
    v_lshrrev_b32 v41, 4, v2
    v_xor_b32 v41, v41, v2
    v_and_b32 v41, 7, v41
    v_lshl_add_u32 v16, v41, 4, v40
    v_xor_b32 v17, 64, v16
    v_add_u32 v17, 64512, v17
    s_lshl_b32 s16, s6, 2
    s_add_u32 s16, s16, s3
    s_lshl_b32 s16, s16, 17
    s_lshl_b32 s22, s9, 13
    s_lshl_b32 s10, s8, 12
    s_add_u32 s22, s22, s10
    s_lshl_b32 s10, s9, 6
    s_lshl_b32 s11, s9, 13
    v_xor_b32 v20, s10, v124
    v_xor_b32 v21, s10, v126
    v_subrev_u32 v20, s11, v20
    v_subrev_u32 v21, s11, v21
    s_mov_b32 s15, 0
G_all16_w:
    ds_read_b128 v[48:51], v11 offset:0
    s_waitcnt lgkmcnt(0)
    v_min3_u32 v48, v48, v49, v50
    v_min_u32 v48, v48, v51
    v_cmp_gt_u32 vcc, 16, v48
    s_cbranch_vccz G_all16_ok
    s_add_u32 s15, s15, 1
    s_cmp_lt_u32 s15, 160000
    s_cbranch_scc1 G_all16_w
G_all16_ok:
    v_mov_b32 v36, 0
    v_mov_b32 v37, 0
    s_mov_b32 s15, 0
    s_cmp_eq_u32 s6, 0
    s_cbranch_scc1 G_lb4
    s_lshl_b32 s14, s8, 1
    s_sub_i32 s14, s6, s14
    s_cmp_le_i32 s14, 0
    s_cbranch_scc1 G_lb3
G_lb:
    buffer_load_dwordx4 v[192:195], v60, s[64:67], 0 offen sc1
    s_cmp_le_i32 s14, 4
    s_cbranch_scc1 G_lb1
    buffer_load_dwordx4 v[196:199], v61, s[64:67], 0 offen sc1
    s_cmp_le_i32 s14, 8
    s_cbranch_scc1 G_lb1
    buffer_load_dwordx4 v[200:203], v62, s[64:67], 0 offen sc1
    s_cmp_le_i32 s14, 12
    s_cbranch_scc1 G_lb1
    buffer_load_dwordx4 v[204:207], v63, s[64:67], 0 offen sc1
G_lb1:
    v_mov_b32 v36, 0
    v_mov_b32 v37, 0
    s_mov_b64 s[10:11], 0
    s_waitcnt vmcnt(0)
    v_cmp_ne_u64 vcc, v[194:195], v[30:31]
    v_fmac_f32 v36, v64, v192
    v_fmac_f32 v37, v64, v193
    s_or_b64 s[10:11], s[10:11], vcc
    v_fma_f32 v36, -v65, v193, v36
    v_fmac_f32 v37, v65, v192
    s_cmp_le_i32 s14, 4
    s_cbranch_scc1 G_lb2
    v_cmp_ne_u64 vcc, v[198:199], v[30:31]
    v_fmac_f32 v36, v66, v196
    v_fmac_f32 v37, v66, v197
    s_or_b64 s[10:11], s[10:11], vcc
    v_fma_f32 v36, -v67, v197, v36
    v_fmac_f32 v37, v67, v196
    s_cmp_le_i32 s14, 8
    s_cbranch_scc1 G_lb2
    v_cmp_ne_u64 vcc, v[202:203], v[30:31]
    v_fmac_f32 v36, v68, v200
    v_fmac_f32 v37, v68, v201
    s_or_b64 s[10:11], s[10:11], vcc
    v_fma_f32 v36, -v69, v201, v36
    v_fmac_f32 v37, v69, v200
    s_cmp_le_i32 s14, 12
    s_cbranch_scc1 G_lb2
    v_cmp_ne_u64 vcc, v[206:207], v[30:31]
    v_fmac_f32 v36, v70, v204
    v_fmac_f32 v37, v70, v205
    s_or_b64 s[10:11], s[10:11], vcc
    v_fma_f32 v36, -v71, v205, v36
    v_fmac_f32 v37, v71, v204
G_lb2:
    s_cmp_eq_u64 s[10:11], 0
    s_cbranch_scc1 G_lb2b
    s_add_u32 s15, s15, 1
    s_cmp_lt_u32 s15, 20000
    s_cbranch_scc1 G_lb
G_lb2b:
    v_mov_b32 v38, v36
    v_mov_b32 v39, v37
    s_nop 0
    v_permlane32_swap_b32 v36, v38
    v_permlane32_swap_b32 v37, v39
    v_add_f32 v36, v36, v38
    v_add_f32 v37, v37, v39
G_lb3:
    v_mov_b32 v28, v36
    v_mov_b32 v29, v37
    ds_write_b128 v0, v[28:31]
    s_mov_b32 s15, 0
G_x2:
    ds_read_b128 v[192:195], v1 offset:0
    s_add_u32 s15, s15, 1
    s_waitcnt lgkmcnt(0)
    v_cmp_ne_u64 vcc, v[194:195], v[30:31]
    s_cbranch_vccz G_x2_ok
    s_cmp_lt_u32 s15, 160000
    s_cbranch_scc1 G_x2
G_x2_ok:
    v_add_f32 v36, v36, v192
    v_add_f32 v37, v37, v193
G_lb4:
    s_cmp_eq_u32 s8, 0
    s_cbranch_scc1 G_lbdone
    v_fma_f32 v56, v18, v36, v56
    v_fma_f32 v57, v18, v37, v57
    v_fma_f32 v56, -v19, v37, v56
    v_fma_f32 v37, v19, v36, v57
    v_mov_b32 v36, v56
G_lbdone:
    v_fmac_f32 v112, v36, v104
    v_fmac_f32 v113, v36, v105
    v_fma_f32 v114, -v37, v104, v114
    v_fma_f32 v115, -v37, v105, v115
    v_fmac_f32 v116, v36, v108
    v_fmac_f32 v117, v36, v109
    v_fma_f32 v118, -v37, v108, v118
    v_fma_f32 v119, -v37, v109, v119
    v_fma_f32 v112, -v37, v106, v112
    v_fma_f32 v113, -v37, v107, v113
    v_fma_f32 v114, -v36, v106, v114
    v_fma_f32 v115, -v36, v107, v115
    v_fma_f32 v116, -v37, v110, v116
    v_fma_f32 v117, -v37, v111, v117
    v_fma_f32 v118, -v36, v110, v118
    v_fma_f32 v119, -v36, v111, v119
    s_bfe_u32 s18, s100, 28 + (4 << 16)
    s_lshl_b32 s18, s18, 7
    buffer_load_dwordx4 v[224:227], v16, s[80:83], s18 offen offset:0
    v_fmac_f32 v128, v6, v112
    v_fmac_f32 v129, v6, v113
    v_fmac_f32 v144, v6, v114
    v_fmac_f32 v145, v6, v115
    v_fmac_f32 v160, v6, v116
    v_fmac_f32 v161, v6, v117
    v_fmac_f32 v176, v6, v118
    v_fmac_f32 v177, v6, v119
    v_fmac_f32 v128, v7, v114
    v_fmac_f32 v129, v7, v115
    v_fma_f32 v144, -v7, v112, v144
    v_fma_f32 v145, -v7, v113, v145
    v_fmac_f32 v160, v7, v118
    v_fmac_f32 v161, v7, v119
    v_fma_f32 v176, -v7, v116, v176
    v_fma_f32 v177, -v7, v117, v177
    buffer_load_dwordx4 v[228:231], v17, s[80:83], s18 offen offset:1024
    v_fmac_f32 v130, v6, v128
    v_fmac_f32 v131, v6, v129
    v_fmac_f32 v146, v6, v144
    v_fmac_f32 v147, v6, v145
    v_fmac_f32 v162, v6, v160
    v_fmac_f32 v163, v6, v161
    v_fmac_f32 v178, v6, v176
    v_fmac_f32 v179, v6, v177
    v_fmac_f32 v130, v7, v144
    v_fmac_f32 v131, v7, v145
    v_fma_f32 v146, -v7, v128, v146
    v_fma_f32 v147, -v7, v129, v147
    v_fmac_f32 v162, v7, v176
    v_fmac_f32 v163, v7, v177
    v_fma_f32 v178, -v7, v160, v178
    v_fma_f32 v179, -v7, v161, v179
    buffer_load_dwordx4 v[232:235], v16, s[80:83], s18 offen offset:2048
    v_fmac_f32 v132, v6, v130
    v_fmac_f32 v133, v6, v131
    v_fmac_f32 v148, v6, v146
    v_fmac_f32 v149, v6, v147
    v_fmac_f32 v164, v6, v162
    v_fmac_f32 v165, v6, v163
    v_fmac_f32 v180, v6, v178
    v_fmac_f32 v181, v6, v179
    v_fmac_f32 v132, v7, v146
    v_fmac_f32 v133, v7, v147
    v_fma_f32 v148, -v7, v130, v148
    v_fma_f32 v149, -v7, v131, v149
    v_fmac_f32 v164, v7, v178
    v_fmac_f32 v165, v7, v179
    v_fma_f32 v180, -v7, v162, v180
    v_fma_f32 v181, -v7, v163, v181
    buffer_load_dwordx4 v[236:239], v17, s[80:83], s18 offen offset:3072
    v_fmac_f32 v134, v6, v132
    v_fmac_f32 v135, v6, v133
    v_fmac_f32 v150, v6, v148
    v_fmac_f32 v151, v6, v149
    v_fmac_f32 v166, v6, v164
    v_fmac_f32 v167, v6, v165
    v_fmac_f32 v182, v6, v180
    v_fmac_f32 v183, v6, v181
    v_fmac_f32 v134, v7, v148
    v_fmac_f32 v135, v7, v149
    v_fma_f32 v150, -v7, v132, v150
    v_fma_f32 v151, -v7, v133, v151
    v_fmac_f32 v166, v7, v180
    v_fmac_f32 v167, v7, v181
    v_fma_f32 v182, -v7, v164, v182
    v_fma_f32 v183, -v7, v165, v183
    s_bfe_u32 s18, s101, 0 + (4 << 16)
    s_lshl_b32 s18, s18, 7
    buffer_load_dwordx4 v[240:243], v16, s[80:83], s18 offen offset:0
    v_fmac_f32 v136, v6, v134
    v_fmac_f32 v137, v6, v135
    v_fmac_f32 v152, v6, v150
    v_fmac_f32 v153, v6, v151
    v_fmac_f32 v168, v6, v166
    v_fmac_f32 v169, v6, v167
    v_fmac_f32 v184, v6, v182
    v_fmac_f32 v185, v6, v183
    v_fmac_f32 v136, v7, v150
    v_fmac_f32 v137, v7, v151
    v_fma_f32 v152, -v7, v134, v152
    v_fma_f32 v153, -v7, v135, v153
    v_fmac_f32 v168, v7, v182
    v_fmac_f32 v169, v7, v183
    v_fma_f32 v184, -v7, v166, v184
    v_fma_f32 v185, -v7, v167, v185
    buffer_load_dwordx4 v[244:247], v17, s[80:83], s18 offen offset:1024
    v_fmac_f32 v138, v6, v136
    v_fmac_f32 v139, v6, v137
    v_fmac_f32 v154, v6, v152
    v_fmac_f32 v155, v6, v153
    v_fmac_f32 v170, v6, v168
    v_fmac_f32 v171, v6, v169
    v_fmac_f32 v186, v6, v184
    v_fmac_f32 v187, v6, v185
    v_fmac_f32 v138, v7, v152
    v_fmac_f32 v139, v7, v153
    v_fma_f32 v154, -v7, v136, v154
    v_fma_f32 v155, -v7, v137, v155
    v_fmac_f32 v170, v7, v184
    v_fmac_f32 v171, v7, v185
    v_fma_f32 v186, -v7, v168, v186
    v_fma_f32 v187, -v7, v169, v187
    buffer_load_dwordx4 v[248:251], v16, s[80:83], s18 offen offset:2048
    v_fmac_f32 v140, v6, v138
    v_fmac_f32 v141, v6, v139
    v_fmac_f32 v156, v6, v154
    v_fmac_f32 v157, v6, v155
    v_fmac_f32 v172, v6, v170
    v_fmac_f32 v173, v6, v171
    v_fmac_f32 v188, v6, v186
    v_fmac_f32 v189, v6, v187
    v_fmac_f32 v140, v7, v154
    v_fmac_f32 v141, v7, v155
    v_fma_f32 v156, -v7, v138, v156
    v_fma_f32 v157, -v7, v139, v157
    v_fmac_f32 v172, v7, v186
    v_fmac_f32 v173, v7, v187
    v_fma_f32 v188, -v7, v170, v188
    v_fma_f32 v189, -v7, v171, v189
    buffer_load_dwordx4 v[252:255], v17, s[80:83], s18 offen offset:3072
    v_fmac_f32 v142, v6, v140
    v_fmac_f32 v143, v6, v141
    v_fmac_f32 v158, v6, v156
    v_fmac_f32 v159, v6, v157
    v_fmac_f32 v174, v6, v172
    v_fmac_f32 v175, v6, v173
    v_fmac_f32 v190, v6, v188
    v_fmac_f32 v191, v6, v189
    v_fmac_f32 v142, v7, v156
    v_fmac_f32 v143, v7, v157
    v_fma_f32 v158, -v7, v140, v158
    v_fma_f32 v159, -v7, v141, v159
    v_fmac_f32 v174, v7, v188
    v_fmac_f32 v175, v7, v189
    v_fma_f32 v190, -v7, v172, v190
    v_fma_f32 v191, -v7, v173, v191
    v_cvt_pk_bf16_f32 v192, v128, v130
    v_cvt_pk_bf16_f32 v193, v132, v134
    v_cvt_pk_bf16_f32 v194, v136, v138
    v_cvt_pk_bf16_f32 v195, v140, v142
    ds_write_b128 v120, v[192:195] offset:0
    v_cvt_pk_bf16_f32 v196, v160, v162
    v_cvt_pk_bf16_f32 v197, v164, v166
    v_cvt_pk_bf16_f32 v198, v168, v170
    v_cvt_pk_bf16_f32 v199, v172, v174
    ds_write_b128 v121, v[196:199] offset:0
    v_cvt_pk_bf16_f32 v200, v129, v131
    v_cvt_pk_bf16_f32 v201, v133, v135
    v_cvt_pk_bf16_f32 v202, v137, v139
    v_cvt_pk_bf16_f32 v203, v141, v143
    ds_write_b128 v122, v[200:203] offset:0
    v_cvt_pk_bf16_f32 v204, v161, v163
    v_cvt_pk_bf16_f32 v205, v165, v167
    v_cvt_pk_bf16_f32 v206, v169, v171
    v_cvt_pk_bf16_f32 v207, v173, v175
    ds_write_b128 v123, v[204:207] offset:0
    v_cvt_pk_bf16_f32 v208, v144, v146
    v_cvt_pk_bf16_f32 v209, v148, v150
    v_cvt_pk_bf16_f32 v210, v152, v154
    v_cvt_pk_bf16_f32 v211, v156, v158
    ds_write_b128 v120, v[208:211] offset:4096
    v_cvt_pk_bf16_f32 v212, v176, v178
    v_cvt_pk_bf16_f32 v213, v180, v182
    v_cvt_pk_bf16_f32 v214, v184, v186
    v_cvt_pk_bf16_f32 v215, v188, v190
    ds_write_b128 v121, v[212:215] offset:4096
    v_cvt_pk_bf16_f32 v216, v145, v147
    v_cvt_pk_bf16_f32 v217, v149, v151
    v_cvt_pk_bf16_f32 v218, v153, v155
    v_cvt_pk_bf16_f32 v219, v157, v159
    ds_write_b128 v122, v[216:219] offset:4096
    v_cvt_pk_bf16_f32 v220, v177, v179
    v_cvt_pk_bf16_f32 v221, v181, v183
    v_cvt_pk_bf16_f32 v222, v185, v187
    v_cvt_pk_bf16_f32 v223, v189, v191
    ds_write_b128 v123, v[220:223] offset:4096
    s_lshl_b32 s10, s12, 18
    s_lshl_b32 s11, s7, 13
    s_add_u32 s10, s10, s11
    s_lshl_b32 s11, s9, 11
    s_add_u32 s10, s10, s11
    s_add_u32 s11, s10, 131072
    v_mov_b32 v22, 17
    s_waitcnt lgkmcnt(0)
    ds_read_b64_tr_b16 v[160:161], v124 offset:0
    ds_read_b64_tr_b16 v[162:163], v126 offset:512
    ds_read_b64_tr_b16 v[164:165], v126 offset:0
    ds_read_b64_tr_b16 v[166:167], v124 offset:512
    ds_read_b64_tr_b16 v[168:169], v125 offset:0
    ds_read_b64_tr_b16 v[170:171], v127 offset:512
    ds_read_b64_tr_b16 v[172:173], v127 offset:0
    ds_read_b64_tr_b16 v[174:175], v125 offset:512
    ds_read_b64_tr_b16 v[176:177], v124 offset:4096
    ds_read_b64_tr_b16 v[178:179], v126 offset:4608
    ds_read_b64_tr_b16 v[180:181], v126 offset:4096
    ds_read_b64_tr_b16 v[182:183], v124 offset:4608
    ds_read_b64_tr_b16 v[184:185], v125 offset:4096
    ds_read_b64_tr_b16 v[186:187], v127 offset:4608
    ds_read_b64_tr_b16 v[188:189], v127 offset:4096
    ds_read_b64_tr_b16 v[190:191], v125 offset:4608
    s_waitcnt lgkmcnt(14)
    buffer_store_dwordx4 v[160:163], v26, s[68:71], s10 offen offset:0 sc1
    s_waitcnt lgkmcnt(12)
    buffer_store_dwordx4 v[164:167], v26, s[68:71], s10 offen offset:1024 sc1
    s_waitcnt lgkmcnt(10)
    buffer_store_dwordx4 v[168:171], v26, s[68:71], s11 offen offset:0 sc1
    s_waitcnt lgkmcnt(8)
    buffer_store_dwordx4 v[172:175], v26, s[68:71], s11 offen offset:1024 sc1
    s_waitcnt lgkmcnt(6)
    buffer_store_dwordx4 v[176:179], v27, s[68:71], s10 offen offset:0 sc1
    s_waitcnt lgkmcnt(4)
    buffer_store_dwordx4 v[180:183], v27, s[68:71], s10 offen offset:1024 sc1
    s_waitcnt lgkmcnt(2)
    buffer_store_dwordx4 v[184:187], v27, s[68:71], s11 offen offset:0 sc1
    s_waitcnt lgkmcnt(0)
    buffer_store_dwordx4 v[188:191], v27, s[68:71], s11 offen offset:1024 sc1
    ds_write_b32 v10, v22
    v_and_b32 v112, 15, v2
    v_lshrrev_b32 v113, 1, v112
    v_lshrrev_b32 v114, 4, v2
    v_xor_b32 v113, v113, v114
    v_lshlrev_b32 v113, 4, v113
    v_lshl_add_u32 v6, v112, 7, v113
    v_xor_b32 v7, 64, v6
    v_add_u32 v8, 65536, v6
    v_add_u32 v9, 65536, v7
    v_add_u32 v0, s22, v26
    v_add_u32 v1, 65536, v0
    s_lshl_b32 s10, s6, 11
    s_add_u32 s10, s10, 32768
    s_lshl_b32 s11, s7, 7
    s_add_u32 s11, s11, s10
    v_lshl_add_u32 v5, v112, 7, s10
    v_cmp_ne_u32 s[20:21], s7, v112
    v_lshlrev_b32 v116, 16, v24
    v_and_b32 v117, 0xffff0000, v24
    v_lshlrev_b32 v118, 16, v25
    v_and_b32 v119, 0xffff0000, v25
    v_add_u32 v26, s16, v26
    v_add_u32 v27, s16, v27
    s_waitcnt vmcnt(16)
    v_lshlrev_b32 v192, 16, v80
    v_and_b32 v193, 0xffff0000, v80
    v_lshlrev_b32 v194, 16, v81
    v_and_b32 v195, 0xffff0000, v81
    v_lshlrev_b32 v196, 16, v82
    v_and_b32 v197, 0xffff0000, v82
    v_lshlrev_b32 v198, 16, v83
    v_and_b32 v199, 0xffff0000, v83
    v_lshlrev_b32 v200, 16, v84
    v_and_b32 v201, 0xffff0000, v84
    v_lshlrev_b32 v202, 16, v85
    v_and_b32 v203, 0xffff0000, v85
    v_lshlrev_b32 v204, 16, v86
    v_and_b32 v205, 0xffff0000, v86
    v_lshlrev_b32 v206, 16, v87
    v_and_b32 v207, 0xffff0000, v87
    v_lshlrev_b32 v208, 16, v88
    v_and_b32 v209, 0xffff0000, v88
    v_lshlrev_b32 v210, 16, v89
    v_and_b32 v211, 0xffff0000, v89
    v_lshlrev_b32 v212, 16, v90
    v_and_b32 v213, 0xffff0000, v90
    v_lshlrev_b32 v214, 16, v91
    v_and_b32 v215, 0xffff0000, v91
    v_lshlrev_b32 v216, 16, v92
    v_and_b32 v217, 0xffff0000, v92
    v_lshlrev_b32 v218, 16, v93
    v_and_b32 v219, 0xffff0000, v93
    v_lshlrev_b32 v220, 16, v94
    v_and_b32 v221, 0xffff0000, v94
    v_lshlrev_b32 v222, 16, v95
    v_and_b32 v223, 0xffff0000, v95
    v_mul_f32 v64, v192, v116
    v_mul_f32 v72, v193, v117
    v_mul_f32 v80, v194, v118
    v_mul_f32 v88, v195, v119
    v_mul_f32 v65, v196, v116
    v_mul_f32 v73, v197, v117
    v_mul_f32 v81, v198, v118
    v_mul_f32 v89, v199, v119
    v_mul_f32 v66, v200, v116
    v_mul_f32 v74, v201, v117
    v_mul_f32 v82, v202, v118
    v_mul_f32 v90, v203, v119
    v_mul_f32 v67, v204, v116
    v_mul_f32 v75, v205, v117
    v_mul_f32 v83, v206, v118
    v_mul_f32 v91, v207, v119
    v_mul_f32 v68, v208, v116
    v_mul_f32 v76, v209, v117
    v_mul_f32 v84, v210, v118
    v_mul_f32 v92, v211, v119
    v_mul_f32 v69, v212, v116
    v_mul_f32 v77, v213, v117
    v_mul_f32 v85, v214, v118
    v_mul_f32 v93, v215, v119
    v_mul_f32 v70, v216, v116
    v_mul_f32 v78, v217, v117
    v_mul_f32 v86, v218, v118
    v_mul_f32 v94, v219, v119
    v_mul_f32 v71, v220, v116
    v_mul_f32 v79, v221, v117
    v_mul_f32 v87, v222, v118
    v_mul_f32 v95, v223, v119
    s_mov_b32 s15, 0
G_all17_w:
    ds_read_b128 v[12:15], v11 offset:0
    s_waitcnt lgkmcnt(0)
    v_min3_u32 v12, v12, v13, v14
    v_min_u32 v12, v12, v15
    v_cmp_gt_u32 vcc, 17, v12
    s_cbranch_vccz G_all17_ok
    s_add_u32 s15, s15, 1
    s_cmp_lt_u32 s15, 160000
    s_cbranch_scc1 G_all17_w
G_all17_ok:
    ds_read_b64_tr_b16 v[128:129], v20 offset:0
    ds_read_b64_tr_b16 v[130:131], v21 offset:512
    ds_read_b64_tr_b16 v[132:133], v21 offset:0
    ds_read_b64_tr_b16 v[134:135], v20 offset:512
    ds_read_b64_tr_b16 v[136:137], v20 offset:8192
    ds_read_b64_tr_b16 v[138:139], v21 offset:8704
    ds_read_b64_tr_b16 v[140:141], v21 offset:8192
    ds_read_b64_tr_b16 v[142:143], v20 offset:8704
    ds_read_b64_tr_b16 v[144:145], v20 offset:4096
    ds_read_b64_tr_b16 v[146:147], v21 offset:4608
    ds_read_b64_tr_b16 v[148:149], v21 offset:4096
    ds_read_b64_tr_b16 v[150:151], v20 offset:4608
    ds_read_b64_tr_b16 v[152:153], v20 offset:12288
    ds_read_b64_tr_b16 v[154:155], v21 offset:12800
    ds_read_b64_tr_b16 v[156:157], v21 offset:12288
    ds_read_b64_tr_b16 v[158:159], v20 offset:12800
    v_mov_b32 v18, 1
    s_waitcnt vmcnt(0)
    s_mov_b64 exec, 1
    ds_add_rtn_u32 v18, v11, v18 offset:52
    s_waitcnt lgkmcnt(0)
    v_readfirstlane_b32 s14, v18
    s_cmp_eq_u32 s14, 3
    s_cbranch_scc0 G_nl
    buffer_store_dwordx2 v[30:31], v23, s[72:75], s11 offen sc1
    s_mov_b64 exec, -1
G_nl:
    s_mov_b64 exec, -1
    s_mov_b32 s15, 0
G_f0_w:
    ds_read_b32 v18, v11 offset:60
    s_waitcnt lgkmcnt(0)
    v_cmp_gt_u32 vcc, 4, v18
    s_cbranch_vccz G_f0_ok
    s_sleep 1
    s_add_u32 s15, s15, 1
    s_cmp_lt_u32 s15, 160000
    s_cbranch_scc1 G_f0_w
G_f0_ok:
    ds_read_b128 v[192:195], v6 offset:0
    ds_read_b128 v[196:199], v6 offset:2048
    ds_read_b128 v[200:203], v6 offset:4096
    ds_read_b128 v[204:207], v6 offset:6144
    ds_read_b128 v[208:211], v7 offset:0
    ds_read_b128 v[212:215], v7 offset:2048
    ds_read_b128 v[216:219], v7 offset:4096
    s_waitcnt lgkmcnt(6)
    v_mfma_f32_16x16x32_bf16 v[64:67], v[128:131], v[192:195], v[64:67]
    ds_read_b128 v[220:223], v7 offset:6144
    v_mfma_f32_16x16x32_bf16 v[68:71], v[132:135], v[192:195], v[68:71]
    s_bfe_u32 s18, s101, 4 + (4 << 16)
    s_lshl_b32 s18, s18, 7
    buffer_load_dwordx4 v[48:51], v16, s[80:83], s18 offen offset:0
    s_waitcnt lgkmcnt(6)
    v_mfma_f32_16x16x32_bf16 v[72:75], v[128:131], v[196:199], v[72:75]
    ds_read_b128 v[192:195], v6 offset:8192
    v_mfma_f32_16x16x32_bf16 v[76:79], v[132:135], v[196:199], v[76:79]
    s_waitcnt lgkmcnt(6)
    v_mfma_f32_16x16x32_bf16 v[80:83], v[128:131], v[200:203], v[80:83]
    ds_read_b128 v[196:199], v6 offset:10240
    v_mfma_f32_16x16x32_bf16 v[84:87], v[132:135], v[200:203], v[84:87]
    buffer_load_dwordx4 v[52:55], v17, s[80:83], s18 offen offset:1024
    s_waitcnt lgkmcnt(6)
    v_mfma_f32_16x16x32_bf16 v[88:91], v[128:131], v[204:207], v[88:91]
    ds_read_b128 v[200:203], v6 offset:12288
    v_mfma_f32_16x16x32_bf16 v[92:95], v[132:135], v[204:207], v[92:95]
    s_waitcnt lgkmcnt(6)
    v_mfma_f32_16x16x32_bf16 v[64:67], v[136:139], v[208:211], v[64:67]
    ds_read_b128 v[204:207], v6 offset:14336
    v_mfma_f32_16x16x32_bf16 v[68:71], v[140:143], v[208:211], v[68:71]
    buffer_load_dwordx4 v[56:59], v16, s[80:83], s18 offen offset:2048
    s_waitcnt lgkmcnt(6)
    v_mfma_f32_16x16x32_bf16 v[72:75], v[136:139], v[212:215], v[72:75]
    ds_read_b128 v[208:211], v7 offset:8192
    v_mfma_f32_16x16x32_bf16 v[76:79], v[140:143], v[212:215], v[76:79]
    s_waitcnt lgkmcnt(6)
    v_mfma_f32_16x16x32_bf16 v[80:83], v[136:139], v[216:219], v[80:83]
    ds_read_b128 v[212:215], v7 offset:10240
    v_mfma_f32_16x16x32_bf16 v[84:87], v[140:143], v[216:219], v[84:87]
    buffer_load_dwordx4 v[60:63], v17, s[80:83], s18 offen offset:3072
    s_waitcnt lgkmcnt(6)
    v_mfma_f32_16x16x32_bf16 v[88:91], v[136:139], v[220:223], v[88:91]
    ds_read_b128 v[216:219], v7 offset:12288
    v_mfma_f32_16x16x32_bf16 v[92:95], v[140:143], v[220:223], v[92:95]
    s_waitcnt lgkmcnt(6)
    v_mfma_f32_16x16x32_bf16 v[64:67], v[144:147], v[192:195], v[64:67]
    ds_read_b128 v[220:223], v7 offset:14336
    v_mfma_f32_16x16x32_bf16 v[68:71], v[148:151], v[192:195], v[68:71]
    s_bfe_u32 s18, s101, 8 + (4 << 16)
    s_lshl_b32 s18, s18, 7
    buffer_load_dwordx4 v[32:35], v16, s[80:83], s18 offen offset:0
    s_waitcnt lgkmcnt(6)
    v_mfma_f32_16x16x32_bf16 v[72:75], v[144:147], v[196:199], v[72:75]
    ds_read_b128 v[192:195], v6 offset:16384
    v_mfma_f32_16x16x32_bf16 v[76:79], v[148:151], v[196:199], v[76:79]
    s_waitcnt lgkmcnt(6)
    v_mfma_f32_16x16x32_bf16 v[80:83], v[144:147], v[200:203], v[80:83]
    ds_read_b128 v[196:199], v6 offset:18432
    v_mfma_f32_16x16x32_bf16 v[84:87], v[148:151], v[200:203], v[84:87]
    buffer_load_dwordx4 v[36:39], v17, s[80:83], s18 offen offset:1024
    s_waitcnt lgkmcnt(6)
    v_mfma_f32_16x16x32_bf16 v[88:91], v[144:147], v[204:207], v[88:91]
    ds_read_b128 v[200:203], v6 offset:20480
    v_mfma_f32_16x16x32_bf16 v[92:95], v[148:151], v[204:207], v[92:95]
    s_waitcnt lgkmcnt(6)
    v_mfma_f32_16x16x32_bf16 v[64:67], v[152:155], v[208:211], v[64:67]
    ds_read_b128 v[204:207], v6 offset:22528
    v_mfma_f32_16x16x32_bf16 v[68:71], v[156:159], v[208:211], v[68:71]
    buffer_load_dwordx4 v[40:43], v16, s[80:83], s18 offen offset:2048
    s_waitcnt lgkmcnt(6)
    v_mfma_f32_16x16x32_bf16 v[72:75], v[152:155], v[212:215], v[72:75]
    ds_read_b128 v[208:211], v7 offset:16384
    v_mfma_f32_16x16x32_bf16 v[76:79], v[156:159], v[212:215], v[76:79]
    s_waitcnt lgkmcnt(6)
    v_mfma_f32_16x16x32_bf16 v[80:83], v[152:155], v[216:219], v[80:83]
    ds_read_b128 v[212:215], v7 offset:18432
    v_mfma_f32_16x16x32_bf16 v[84:87], v[156:159], v[216:219], v[84:87]
    buffer_load_dwordx4 v[44:47], v17, s[80:83], s18 offen offset:3072
    s_waitcnt lgkmcnt(6)
    v_mfma_f32_16x16x32_bf16 v[88:91], v[152:155], v[220:223], v[88:91]
    ds_read_b128 v[216:219], v7 offset:20480
    v_mfma_f32_16x16x32_bf16 v[92:95], v[156:159], v[220:223], v[92:95]
    v_mov_b32 v22, 18
    ds_write_b32 v10, v22
    s_bfe_u32 s18, s101, 12 + (4 << 16)
    s_lshl_b32 s18, s18, 7
    buffer_load_dwordx4 v[96:99], v16, s[80:83], s18 offen offset:0
    buffer_load_dwordx4 v[100:103], v17, s[80:83], s18 offen offset:1024
    buffer_load_dwordx4 v[104:107], v16, s[80:83], s18 offen offset:2048
    buffer_load_dwordx4 v[108:111], v17, s[80:83], s18 offen offset:3072
    s_bfe_u32 s18, s101, 16 + (4 << 16)
    s_lshl_b32 s18, s18, 7
    buffer_load_dwordx4 v[112:115], v16, s[80:83], s18 offen offset:0
    buffer_load_dwordx4 v[116:119], v17, s[80:83], s18 offen offset:1024
    buffer_load_dwordx4 v[120:123], v16, s[80:83], s18 offen offset:2048
    buffer_load_dwordx4 v[124:127], v17, s[80:83], s18 offen offset:3072
    s_mov_b32 s15, 0
G_all18_w:
    ds_read_b128 v[12:15], v11 offset:0
    s_waitcnt lgkmcnt(0)
    v_min3_u32 v12, v12, v13, v14
    v_min_u32 v12, v12, v15
    v_cmp_gt_u32 vcc, 18, v12
    s_cbranch_vccz G_all18_ok
    s_add_u32 s15, s15, 1
    s_cmp_lt_u32 s15, 160000
    s_cbranch_scc1 G_all18_w
G_all18_ok:
    s_cmp_eq_u32 s14, 3
    s_cbranch_scc0 G_pl
    buffer_load_dwordx2 v[28:29], v5, s[72:75], 0 offen sc1
G_pl:
    s_bfe_u32 s18, s100, 16 + (4 << 16)
    s_lshl_b32 s18, s18, 7
    s_add_u32 m0, s22, 65536
    s_nop 0
    buffer_load_dwordx4 v16, s[80:83], s18 offen offset:0 lds
    buffer_load_dwordx4 v17, s[80:83], s18 offen offset:1024 lds
    buffer_load_dwordx4 v16, s[80:83], s18 offen offset:2048 lds
    buffer_load_dwordx4 v17, s[80:83], s18 offen offset:3072 lds
    s_bfe_u32 s18, s100, 20 + (4 << 16)
    s_lshl_b32 s18, s18, 7
    s_add_u32 m0, s22, 81920
    s_nop 0
    buffer_load_dwordx4 v16, s[80:83], s18 offen offset:0 lds
    buffer_load_dwordx4 v17, s[80:83], s18 offen offset:1024 lds
    buffer_load_dwordx4 v16, s[80:83], s18 offen offset:2048 lds
    buffer_load_dwordx4 v17, s[80:83], s18 offen offset:3072 lds
    s_bfe_u32 s18, s100, 24 + (4 << 16)
    s_lshl_b32 s18, s18, 7
    s_add_u32 m0, s22, 0
    s_nop 0
    buffer_load_dwordx4 v16, s[80:83], s18 offen offset:0 lds
    buffer_load_dwordx4 v17, s[80:83], s18 offen offset:1024 lds
    buffer_load_dwordx4 v16, s[80:83], s18 offen offset:2048 lds
    buffer_load_dwordx4 v17, s[80:83], s18 offen offset:3072 lds
    s_mov_b32 s15, 0
    s_cmp_eq_u32 s14, 3
    s_cbranch_scc0 G_np
    s_waitcnt vmcnt(12)
GH_chk:
    v_cmp_ne_u64 vcc, v[28:29], v[30:31]
    s_and_b64 vcc, vcc, s[20:21]
    s_cbranch_scc0 GH_ok
    buffer_load_dwordx2 v[28:29], v5, s[72:75], 0 offen sc1
    s_add_u32 s15, s15, 1
    s_cmp_lt_u32 s15, 20000
    s_waitcnt vmcnt(0)
    s_cbranch_scc1 GH_chk
GH_ok:
    ds_write_b32 v11, v22 offset:56
    s_branch G_go
G_np:
    s_mov_b32 s15, 0
G_fho_w:
    ds_read_b32 v18, v11 offset:56
    s_waitcnt lgkmcnt(0)
    v_cmp_gt_u32 vcc, 1, v18
    s_cbranch_vccz G_fho_ok
    s_sleep 1
    s_add_u32 s15, s15, 1
    s_cmp_lt_u32 s15, 160000
    s_cbranch_scc1 G_fho_w
G_fho_ok:
G_go:
    s_bfe_u32 s19, s100, 4 + (4 << 16)
    s_lshl_b32 s19, s19, 13
    buffer_load_dwordx4 v[160:163], v26, s[68:71], s19 offen offset:0 sc1
    buffer_load_dwordx4 v[164:167], v26, s[68:71], s19 offen offset:1024 sc1
    buffer_load_dwordx4 v[168:171], v26, s[68:71], s19 offen offset:2048 sc1
    buffer_load_dwordx4 v[172:175], v26, s[68:71], s19 offen offset:3072 sc1
    buffer_load_dwordx4 v[176:179], v27, s[68:71], s19 offen offset:0 sc1
    buffer_load_dwordx4 v[180:183], v27, s[68:71], s19 offen offset:1024 sc1
    buffer_load_dwordx4 v[184:187], v27, s[68:71], s19 offen offset:2048 sc1
    buffer_load_dwordx4 v[188:191], v27, s[68:71], s19 offen offset:3072 sc1
    s_bfe_u32 s19, s100, 8 + (4 << 16)
    s_lshl_b32 s19, s19, 13
    buffer_load_dwordx4 v[128:131], v26, s[68:71], s19 offen offset:0 sc1
    buffer_load_dwordx4 v[132:135], v26, s[68:71], s19 offen offset:1024 sc1
    buffer_load_dwordx4 v[136:139], v26, s[68:71], s19 offen offset:2048 sc1
    buffer_load_dwordx4 v[140:143], v26, s[68:71], s19 offen offset:3072 sc1
    buffer_load_dwordx4 v[144:147], v27, s[68:71], s19 offen offset:0 sc1
    buffer_load_dwordx4 v[148:151], v27, s[68:71], s19 offen offset:1024 sc1
    buffer_load_dwordx4 v[152:155], v27, s[68:71], s19 offen offset:2048 sc1
    buffer_load_dwordx4 v[156:159], v27, s[68:71], s19 offen offset:3072 sc1
    s_setprio 1
    s_waitcnt vmcnt(14)
    v_mfma_f32_16x16x32_bf16 v[64:67], v[160:163], v[192:195], v[64:67]
    ds_read_b128 v[220:223], v7 offset:22528
    v_mfma_f32_16x16x32_bf16 v[68:71], v[164:167], v[192:195], v[68:71]
    v_mfma_f32_16x16x32_bf16 v[72:75], v[160:163], v[196:199], v[72:75]
    ds_read_b128 v[192:195], v6 offset:24576
    v_mfma_f32_16x16x32_bf16 v[76:79], v[164:167], v[196:199], v[76:79]
    v_mfma_f32_16x16x32_bf16 v[80:83], v[160:163], v[200:203], v[80:83]
    ds_read_b128 v[196:199], v6 offset:26624
    v_mfma_f32_16x16x32_bf16 v[84:87], v[164:167], v[200:203], v[84:87]
    v_mfma_f32_16x16x32_bf16 v[88:91], v[160:163], v[204:207], v[88:91]
    ds_read_b128 v[200:203], v6 offset:28672
    s_bfe_u32 s19, s100, 12 + (4 << 16)
    v_mfma_f32_16x16x32_bf16 v[92:95], v[164:167], v[204:207], v[92:95]
    s_lshl_b32 s19, s19, 13
    s_waitcnt vmcnt(12)
    v_mfma_f32_16x16x32_bf16 v[64:67], v[168:171], v[208:211], v[64:67]
    ds_read_b128 v[204:207], v6 offset:30720
    v_mfma_f32_16x16x32_bf16 v[68:71], v[172:175], v[208:211], v[68:71]
    buffer_load_dwordx4 v[160:163], v26, s[68:71], s19 offen offset:0 sc1
    v_mfma_f32_16x16x32_bf16 v[72:75], v[168:171], v[212:215], v[72:75]
    ds_read_b128 v[208:211], v7 offset:24576
    v_mfma_f32_16x16x32_bf16 v[76:79], v[172:175], v[212:215], v[76:79]
    v_mfma_f32_16x16x32_bf16 v[80:83], v[168:171], v[216:219], v[80:83]
    ds_read_b128 v[212:215], v7 offset:26624
    v_mfma_f32_16x16x32_bf16 v[84:87], v[172:175], v[216:219], v[84:87]
    buffer_load_dwordx4 v[164:167], v26, s[68:71], s19 offen offset:1024 sc1
    s_waitcnt lgkmcnt(6)
    v_mfma_f32_16x16x32_bf16 v[88:91], v[168:171], v[220:223], v[88:91]
    ds_read_b128 v[216:219], v7 offset:28672
    v_mfma_f32_16x16x32_bf16 v[92:95], v[172:175], v[220:223], v[92:95]
    s_waitcnt vmcnt(12) lgkmcnt(6)
    v_mfma_f32_16x16x32_bf16 v[64:67], v[176:179], v[192:195], v[64:67]
    ds_read_b128 v[220:223], v7 offset:30720
    v_mfma_f32_16x16x32_bf16 v[68:71], v[180:183], v[192:195], v[68:71]
    buffer_load_dwordx4 v[168:171], v26, s[68:71], s19 offen offset:2048 sc1
    s_waitcnt lgkmcnt(6)
    v_mfma_f32_16x16x32_bf16 v[72:75], v[176:179], v[196:199], v[72:75]
    ds_read_b128 v[192:195], v6 offset:32768
    v_mfma_f32_16x16x32_bf16 v[76:79], v[180:183], v[196:199], v[76:79]
    s_waitcnt lgkmcnt(6)
    v_mfma_f32_16x16x32_bf16 v[80:83], v[176:179], v[200:203], v[80:83]
    ds_read_b128 v[196:199], v6 offset:34816
    v_mfma_f32_16x16x32_bf16 v[84:87], v[180:183], v[200:203], v[84:87]
    buffer_load_dwordx4 v[172:175], v26, s[68:71], s19 offen offset:3072 sc1
    s_waitcnt lgkmcnt(6)
    v_mfma_f32_16x16x32_bf16 v[88:91], v[176:179], v[204:207], v[88:91]
    ds_read_b128 v[200:203], v6 offset:36864
    v_mfma_f32_16x16x32_bf16 v[92:95], v[180:183], v[204:207], v[92:95]
    s_waitcnt vmcnt(12) lgkmcnt(6)
    v_mfma_f32_16x16x32_bf16 v[64:67], v[184:187], v[208:211], v[64:67]
    ds_read_b128 v[204:207], v6 offset:38912
    v_mfma_f32_16x16x32_bf16 v[68:71], v[188:191], v[208:211], v[68:71]
    buffer_load_dwordx4 v[176:179], v27, s[68:71], s19 offen offset:0 sc1
    s_waitcnt lgkmcnt(6)
    v_mfma_f32_16x16x32_bf16 v[72:75], v[184:187], v[212:215], v[72:75]
    ds_read_b128 v[208:211], v7 offset:32768
    v_mfma_f32_16x16x32_bf16 v[76:79], v[188:191], v[212:215], v[76:79]
    s_waitcnt lgkmcnt(6)
    v_mfma_f32_16x16x32_bf16 v[80:83], v[184:187], v[216:219], v[80:83]
    ds_read_b128 v[212:215], v7 offset:34816
    v_mfma_f32_16x16x32_bf16 v[84:87], v[188:191], v[216:219], v[84:87]
    buffer_load_dwordx4 v[180:183], v27, s[68:71], s19 offen offset:1024 sc1
    s_waitcnt lgkmcnt(6)
    v_mfma_f32_16x16x32_bf16 v[88:91], v[184:187], v[220:223], v[88:91]
    ds_read_b128 v[216:219], v7 offset:36864
    v_mfma_f32_16x16x32_bf16 v[92:95], v[188:191], v[220:223], v[92:95]
    s_waitcnt vmcnt(12) lgkmcnt(6)
    v_mfma_f32_16x16x32_bf16 v[64:67], v[128:131], v[192:195], v[64:67]
    ds_read_b128 v[220:223], v7 offset:38912
    v_mov_b32 v22, 20
    v_mfma_f32_16x16x32_bf16 v[68:71], v[132:135], v[192:195], v[68:71]
    buffer_load_dwordx4 v[184:187], v27, s[68:71], s19 offen offset:2048 sc1
    s_waitcnt lgkmcnt(6)
    v_mfma_f32_16x16x32_bf16 v[72:75], v[128:131], v[196:199], v[72:75]
    ds_read_b128 v[192:195], v6 offset:40960
    v_mfma_f32_16x16x32_bf16 v[76:79], v[132:135], v[196:199], v[76:79]
    ds_write_b32 v10, v22
    s_waitcnt lgkmcnt(7)
    v_mfma_f32_16x16x32_bf16 v[80:83], v[128:131], v[200:203], v[80:83]
    ds_read_b128 v[196:199], v6 offset:43008
    v_mfma_f32_16x16x32_bf16 v[84:87], v[132:135], v[200:203], v[84:87]
    buffer_load_dwordx4 v[188:191], v27, s[68:71], s19 offen offset:3072 sc1
    s_waitcnt lgkmcnt(7)
    v_mfma_f32_16x16x32_bf16 v[88:91], v[128:131], v[204:207], v[88:91]
    ds_read_b128 v[200:203], v6 offset:45056
    s_bfe_u32 s19, s100, 16 + (4 << 16)
    v_mfma_f32_16x16x32_bf16 v[92:95], v[132:135], v[204:207], v[92:95]
    s_lshl_b32 s19, s19, 13
    s_waitcnt vmcnt(12) lgkmcnt(7)
    v_mfma_f32_16x16x32_bf16 v[64:67], v[136:139], v[208:211], v[64:67]
    ds_read_b128 v[204:207], v6 offset:47104
    v_mfma_f32_16x16x32_bf16 v[68:71], v[140:143], v[208:211], v[68:71]
    buffer_load_dwordx4 v[128:131], v26, s[68:71], s19 offen offset:0 sc1
    s_waitcnt lgkmcnt(7)
    v_mfma_f32_16x16x32_bf16 v[72:75], v[136:139], v[212:215], v[72:75]
    ds_read_b128 v[208:211], v7 offset:40960
    v_mfma_f32_16x16x32_bf16 v[76:79], v[140:143], v[212:215], v[76:79]
    s_waitcnt lgkmcnt(7)
    v_mfma_f32_16x16x32_bf16 v[80:83], v[136:139], v[216:219], v[80:83]
    ds_read_b128 v[212:215], v7 offset:43008
    v_mfma_f32_16x16x32_bf16 v[84:87], v[140:143], v[216:219], v[84:87]
    buffer_load_dwordx4 v[132:135], v26, s[68:71], s19 offen offset:1024 sc1
    s_waitcnt lgkmcnt(7)
    v_mfma_f32_16x16x32_bf16 v[88:91], v[136:139], v[220:223], v[88:91]
    ds_read_b128 v[216:219], v7 offset:45056
    v_mfma_f32_16x16x32_bf16 v[92:95], v[140:143], v[220:223], v[92:95]
    s_waitcnt vmcnt(12) lgkmcnt(7)
    v_mfma_f32_16x16x32_bf16 v[64:67], v[144:147], v[192:195], v[64:67]
    ds_read_b128 v[220:223], v7 offset:47104
    v_mfma_f32_16x16x32_bf16 v[68:71], v[148:151], v[192:195], v[68:71]
    buffer_load_dwordx4 v[136:139], v26, s[68:71], s19 offen offset:2048 sc1
    s_waitcnt lgkmcnt(6)
    v_mfma_f32_16x16x32_bf16 v[72:75], v[144:147], v[196:199], v[72:75]
    ds_read_b128 v[192:195], v6 offset:49152
    v_mfma_f32_16x16x32_bf16 v[76:79], v[148:151], v[196:199], v[76:79]
    s_waitcnt lgkmcnt(6)
    v_mfma_f32_16x16x32_bf16 v[80:83], v[144:147], v[200:203], v[80:83]
    ds_read_b128 v[196:199], v6 offset:51200
    ds_read_b128 v[12:15], v11
    v_mfma_f32_16x16x32_bf16 v[84:87], v[148:151], v[200:203], v[84:87]
    buffer_load_dwordx4 v[140:143], v26, s[68:71], s19 offen offset:3072 sc1
    s_waitcnt lgkmcnt(7)
    v_mfma_f32_16x16x32_bf16 v[88:91], v[144:147], v[204:207], v[88:91]
    ds_read_b128 v[200:203], v6 offset:53248
    v_mfma_f32_16x16x32_bf16 v[92:95], v[148:151], v[204:207], v[92:95]
    s_waitcnt vmcnt(12) lgkmcnt(7)
    v_mfma_f32_16x16x32_bf16 v[64:67], v[152:155], v[208:211], v[64:67]
    ds_read_b128 v[204:207], v6 offset:55296
    v_mfma_f32_16x16x32_bf16 v[68:71], v[156:159], v[208:211], v[68:71]
    buffer_load_dwordx4 v[144:147], v27, s[68:71], s19 offen offset:0 sc1
    s_waitcnt lgkmcnt(7)
    v_mfma_f32_16x16x32_bf16 v[72:75], v[152:155], v[212:215], v[72:75]
    ds_read_b128 v[208:211], v7 offset:49152
    v_mfma_f32_16x16x32_bf16 v[76:79], v[156:159], v[212:215], v[76:79]
    s_waitcnt lgkmcnt(7)
    v_mfma_f32_16x16x32_bf16 v[80:83], v[152:155], v[216:219], v[80:83]
    ds_read_b128 v[212:215], v7 offset:51200
    v_mfma_f32_16x16x32_bf16 v[84:87], v[156:159], v[216:219], v[84:87]
    buffer_load_dwordx4 v[148:151], v27, s[68:71], s19 offen offset:1024 sc1
    s_waitcnt lgkmcnt(7)
    v_mfma_f32_16x16x32_bf16 v[88:91], v[152:155], v[220:223], v[88:91]
    ds_read_b128 v[216:219], v7 offset:53248
    v_mfma_f32_16x16x32_bf16 v[92:95], v[156:159], v[220:223], v[92:95]
    s_waitcnt vmcnt(12) lgkmcnt(7)
    v_mfma_f32_16x16x32_bf16 v[64:67], v[160:163], v[192:195], v[64:67]
    ds_read_b128 v[220:223], v7 offset:55296
    v_mov_b32 v22, 21
    v_mfma_f32_16x16x32_bf16 v[68:71], v[164:167], v[192:195], v[68:71]
    buffer_load_dwordx4 v[152:155], v27, s[68:71], s19 offen offset:2048 sc1
    s_waitcnt lgkmcnt(7)
    v_mfma_f32_16x16x32_bf16 v[72:75], v[160:163], v[196:199], v[72:75]
    ds_read_b128 v[192:195], v6 offset:57344
    s_waitcnt lgkmcnt(7)
    v_min3_u32 v12, v12, v13, v14
    v_mfma_f32_16x16x32_bf16 v[76:79], v[164:167], v[196:199], v[76:79]
    ds_write_b32 v10, v22
    s_waitcnt lgkmcnt(7)
    v_mfma_f32_16x16x32_bf16 v[80:83], v[160:163], v[200:203], v[80:83]
    ds_read_b128 v[196:199], v6 offset:59392
    v_min_u32 v12, v12, v15
    v_mfma_f32_16x16x32_bf16 v[84:87], v[164:167], v[200:203], v[84:87]
    buffer_load_dwordx4 v[156:159], v27, s[68:71], s19 offen offset:3072 sc1
    s_waitcnt lgkmcnt(7)
    v_mfma_f32_16x16x32_bf16 v[88:91], v[160:163], v[204:207], v[88:91]
    ds_read_b128 v[200:203], v6 offset:61440
    s_bfe_u32 s19, s100, 20 + (4 << 16)
    v_mfma_f32_16x16x32_bf16 v[92:95], v[164:167], v[204:207], v[92:95]
    s_lshl_b32 s19, s19, 13
    s_waitcnt vmcnt(12) lgkmcnt(7)
    v_mfma_f32_16x16x32_bf16 v[64:67], v[168:171], v[208:211], v[64:67]
    ds_read_b128 v[204:207], v6 offset:63488
    v_cmp_gt_u32 vcc, 20, v12
    v_mfma_f32_16x16x32_bf16 v[68:71], v[172:175], v[208:211], v[68:71]
    buffer_load_dwordx4 v[160:163], v26, s[68:71], s19 offen offset:0 sc1
    s_waitcnt lgkmcnt(7)
    v_mfma_f32_16x16x32_bf16 v[72:75], v[168:171], v[212:215], v[72:75]
    ds_read_b128 v[208:211], v7 offset:57344
    s_cbranch_vccnz G2_slow3
G2_back3:
    v_mfma_f32_16x16x32_bf16 v[76:79], v[172:175], v[212:215], v[76:79]
    ds_write_b64 v0, v[224:225] offset:16384
    s_waitcnt lgkmcnt(8)
    v_mfma_f32_16x16x32_bf16 v[80:83], v[168:171], v[216:219], v[80:83]
    ds_read_b128 v[212:215], v7 offset:59392
    v_mfma_f32_16x16x32_bf16 v[84:87], v[172:175], v[216:219], v[84:87]
    buffer_load_dwordx4 v[164:167], v26, s[68:71], s19 offen offset:1024 sc1
    s_waitcnt lgkmcnt(8)
    v_mfma_f32_16x16x32_bf16 v[88:91], v[168:171], v[220:223], v[88:91]
    ds_read_b128 v[216:219], v7 offset:61440
    v_mfma_f32_16x16x32_bf16 v[92:95], v[172:175], v[220:223], v[92:95]
    ds_write_b64 v0, v[226:227] offset:16392
    s_waitcnt vmcnt(12) lgkmcnt(9)
    v_mfma_f32_16x16x32_bf16 v[64:67], v[176:179], v[192:195], v[64:67]
    ds_read_b128 v[220:223], v7 offset:63488
    ds_write_b64 v0, v[228:229] offset:17408
    v_mfma_f32_16x16x32_bf16 v[68:71], v[180:183], v[192:195], v[68:71]
    buffer_load_dwordx4 v[168:171], v26, s[68:71], s19 offen offset:2048 sc1
    s_waitcnt lgkmcnt(9)
    v_mfma_f32_16x16x32_bf16 v[72:75], v[176:179], v[196:199], v[72:75]
    ds_read_b128 v[192:195], v8 offset:0
    v_mfma_f32_16x16x32_bf16 v[76:79], v[180:183], v[196:199], v[76:79]
    ds_write_b64 v0, v[230:231] offset:17416
    s_waitcnt lgkmcnt(10)
    v_mfma_f32_16x16x32_bf16 v[80:83], v[176:179], v[200:203], v[80:83]
    ds_read_b128 v[196:199], v8 offset:2048
    ds_read_b128 v[12:15], v11
    v_mfma_f32_16x16x32_bf16 v[84:87], v[180:183], v[200:203], v[84:87]
    buffer_load_dwordx4 v[172:175], v26, s[68:71], s19 offen offset:3072 sc1
    s_waitcnt lgkmcnt(11)
    v_mfma_f32_16x16x32_bf16 v[88:91], v[176:179], v[204:207], v[88:91]
    ds_read_b128 v[200:203], v8 offset:4096
    v_mfma_f32_16x16x32_bf16 v[92:95], v[180:183], v[204:207], v[92:95]
    ds_write_b64 v0, v[232:233] offset:18432
    s_waitcnt vmcnt(12) lgkmcnt(12)
    v_mfma_f32_16x16x32_bf16 v[64:67], v[184:187], v[208:211], v[64:67]
    ds_read_b128 v[204:207], v8 offset:6144
    ds_write_b64 v0, v[234:235] offset:18440
    v_mfma_f32_16x16x32_bf16 v[68:71], v[188:191], v[208:211], v[68:71]
    buffer_load_dwordx4 v[176:179], v27, s[68:71], s19 offen offset:0 sc1
    s_waitcnt lgkmcnt(12)
    v_mfma_f32_16x16x32_bf16 v[72:75], v[184:187], v[212:215], v[72:75]
    ds_read_b128 v[208:211], v9 offset:0
    v_mfma_f32_16x16x32_bf16 v[76:79], v[188:191], v[212:215], v[76:79]
    ds_write_b64 v0, v[236:237] offset:19456
    s_waitcnt lgkmcnt(13)
    v_mfma_f32_16x16x32_bf16 v[80:83], v[184:187], v[216:219], v[80:83]
    ds_read_b128 v[212:215], v9 offset:2048
    v_mfma_f32_16x16x32_bf16 v[84:87], v[188:191], v[216:219], v[84:87]
    buffer_load_dwordx4 v[180:183], v27, s[68:71], s19 offen offset:1024 sc1
    s_waitcnt lgkmcnt(12)
    v_mfma_f32_16x16x32_bf16 v[88:91], v[184:187], v[220:223], v[88:91]
    ds_read_b128 v[216:219], v9 offset:4096
    v_mfma_f32_16x16x32_bf16 v[92:95], v[188:191], v[220:223], v[92:95]
    ds_write_b64 v0, v[238:239] offset:19464
    s_waitcnt vmcnt(12) lgkmcnt(12)
    v_mfma_f32_16x16x32_bf16 v[64:67], v[128:131], v[192:195], v[64:67]
    ds_read_b128 v[220:223], v9 offset:6144
    v_mov_b32 v22, 22
    v_mfma_f32_16x16x32_bf16 v[68:71], v[132:135], v[192:195], v[68:71]
    buffer_load_dwordx4 v[184:187], v27, s[68:71], s19 offen offset:2048 sc1
    s_waitcnt lgkmcnt(11)
    v_mfma_f32_16x16x32_bf16 v[72:75], v[128:131], v[196:199], v[72:75]
    ds_read_b128 v[192:195], v8 offset:8192
    s_waitcnt lgkmcnt(11)
    v_min3_u32 v12, v12, v13, v14
    v_mfma_f32_16x16x32_bf16 v[76:79], v[132:135], v[196:199], v[76:79]
    ds_write_b32 v10, v22
    s_waitcnt lgkmcnt(11)
    v_mfma_f32_16x16x32_bf16 v[80:83], v[128:131], v[200:203], v[80:83]
    ds_read_b128 v[196:199], v8 offset:10240
    v_min_u32 v12, v12, v15
    v_mfma_f32_16x16x32_bf16 v[84:87], v[132:135], v[200:203], v[84:87]
    buffer_load_dwordx4 v[188:191], v27, s[68:71], s19 offen offset:3072 sc1
    s_waitcnt lgkmcnt(10)
    v_mfma_f32_16x16x32_bf16 v[88:91], v[128:131], v[204:207], v[88:91]
    ds_read_b128 v[200:203], v8 offset:12288
    s_bfe_u32 s19, s100, 24 + (4 << 16)
    v_mfma_f32_16x16x32_bf16 v[92:95], v[132:135], v[204:207], v[92:95]
    s_lshl_b32 s19, s19, 13
    s_waitcnt vmcnt(12) lgkmcnt(9)
    v_mfma_f32_16x16x32_bf16 v[64:67], v[136:139], v[208:211], v[64:67]
    ds_read_b128 v[204:207], v8 offset:14336
    v_cmp_gt_u32 vcc, 21, v12
    v_mfma_f32_16x16x32_bf16 v[68:71], v[140:143], v[208:211], v[68:71]
    buffer_load_dwordx4 v[128:131], v26, s[68:71], s19 offen offset:0 sc1
    s_waitcnt lgkmcnt(8)
    v_mfma_f32_16x16x32_bf16 v[72:75], v[136:139], v[212:215], v[72:75]
    ds_read_b128 v[208:211], v9 offset:8192
    s_cbranch_vccnz G2_slow4
G2_back4:
    v_mfma_f32_16x16x32_bf16 v[76:79], v[140:143], v[212:215], v[76:79]
    ds_write_b64 v0, v[240:241] offset:32768
    s_waitcnt lgkmcnt(9)
    v_mfma_f32_16x16x32_bf16 v[80:83], v[136:139], v[216:219], v[80:83]
    ds_read_b128 v[212:215], v9 offset:10240
    v_mfma_f32_16x16x32_bf16 v[84:87], v[140:143], v[216:219], v[84:87]
    buffer_load_dwordx4 v[132:135], v26, s[68:71], s19 offen offset:1024 sc1
    s_waitcnt lgkmcnt(8)
    v_mfma_f32_16x16x32_bf16 v[88:91], v[136:139], v[220:223], v[88:91]
    ds_read_b128 v[216:219], v9 offset:12288
    v_mfma_f32_16x16x32_bf16 v[92:95], v[140:143], v[220:223], v[92:95]
    ds_write_b64 v0, v[242:243] offset:32776
    s_waitcnt vmcnt(12) lgkmcnt(9)
    v_mfma_f32_16x16x32_bf16 v[64:67], v[144:147], v[192:195], v[64:67]
    ds_read_b128 v[220:223], v9 offset:14336
    ds_write_b64 v0, v[244:245] offset:33792
    v_mfma_f32_16x16x32_bf16 v[68:71], v[148:151], v[192:195], v[68:71]
    buffer_load_dwordx4 v[136:139], v26, s[68:71], s19 offen offset:2048 sc1
    s_waitcnt lgkmcnt(9)
    v_mfma_f32_16x16x32_bf16 v[72:75], v[144:147], v[196:199], v[72:75]
    ds_read_b128 v[192:195], v8 offset:16384
    v_mfma_f32_16x16x32_bf16 v[76:79], v[148:151], v[196:199], v[76:79]
    ds_write_b64 v0, v[246:247] offset:33800
    s_waitcnt lgkmcnt(10)
    v_mfma_f32_16x16x32_bf16 v[80:83], v[144:147], v[200:203], v[80:83]
    ds_read_b128 v[196:199], v8 offset:18432
    ds_read_b128 v[12:15], v11
    v_mfma_f32_16x16x32_bf16 v[84:87], v[148:151], v[200:203], v[84:87]
    buffer_load_dwordx4 v[140:143], v26, s[68:71], s19 offen offset:3072 sc1
    s_waitcnt lgkmcnt(11)
    v_mfma_f32_16x16x32_bf16 v[88:91], v[144:147], v[204:207], v[88:91]
    ds_read_b128 v[200:203], v8 offset:20480
    v_mfma_f32_16x16x32_bf16 v[92:95], v[148:151], v[204:207], v[92:95]
    ds_write_b64 v0, v[248:249] offset:34816
    s_waitcnt vmcnt(12) lgkmcnt(12)
    v_mfma_f32_16x16x32_bf16 v[64:67], v[152:155], v[208:211], v[64:67]
    ds_read_b128 v[204:207], v8 offset:22528
    ds_write_b64 v0, v[250:251] offset:34824
    v_mfma_f32_16x16x32_bf16 v[68:71], v[156:159], v[208:211], v[68:71]
    buffer_load_dwordx4 v[144:147], v27, s[68:71], s19 offen offset:0 sc1
    s_waitcnt lgkmcnt(12)
    v_mfma_f32_16x16x32_bf16 v[72:75], v[152:155], v[212:215], v[72:75]
    ds_read_b128 v[208:211], v9 offset:16384
    v_mfma_f32_16x16x32_bf16 v[76:79], v[156:159], v[212:215], v[76:79]
    ds_write_b64 v0, v[252:253] offset:35840
    s_waitcnt lgkmcnt(13)
    v_mfma_f32_16x16x32_bf16 v[80:83], v[152:155], v[216:219], v[80:83]
    ds_read_b128 v[212:215], v9 offset:18432
    v_mfma_f32_16x16x32_bf16 v[84:87], v[156:159], v[216:219], v[84:87]
    buffer_load_dwordx4 v[148:151], v27, s[68:71], s19 offen offset:1024 sc1
    s_waitcnt lgkmcnt(12)
    v_mfma_f32_16x16x32_bf16 v[88:91], v[152:155], v[220:223], v[88:91]
    ds_read_b128 v[216:219], v9 offset:20480
    v_mfma_f32_16x16x32_bf16 v[92:95], v[156:159], v[220:223], v[92:95]
    ds_write_b64 v0, v[254:255] offset:35848
    s_waitcnt vmcnt(12) lgkmcnt(12)
    v_mfma_f32_16x16x32_bf16 v[64:67], v[160:163], v[192:195], v[64:67]
    ds_read_b128 v[220:223], v9 offset:22528
    v_mov_b32 v22, 23
    v_mfma_f32_16x16x32_bf16 v[68:71], v[164:167], v[192:195], v[68:71]
    buffer_load_dwordx4 v[152:155], v27, s[68:71], s19 offen offset:2048 sc1
    s_waitcnt lgkmcnt(11)
    v_mfma_f32_16x16x32_bf16 v[72:75], v[160:163], v[196:199], v[72:75]
    ds_read_b128 v[192:195], v8 offset:24576
    s_waitcnt lgkmcnt(11)
    v_min3_u32 v12, v12, v13, v14
    v_mfma_f32_16x16x32_bf16 v[76:79], v[164:167], v[196:199], v[76:79]
    ds_write_b32 v10, v22
    s_waitcnt lgkmcnt(11)
    v_mfma_f32_16x16x32_bf16 v[80:83], v[160:163], v[200:203], v[80:83]
    ds_read_b128 v[196:199], v8 offset:26624
    v_min_u32 v12, v12, v15
    v_mfma_f32_16x16x32_bf16 v[84:87], v[164:167], v[200:203], v[84:87]
    buffer_load_dwordx4 v[156:159], v27, s[68:71], s19 offen offset:3072 sc1
    s_waitcnt lgkmcnt(10)
    v_mfma_f32_16x16x32_bf16 v[88:91], v[160:163], v[204:207], v[88:91]
    ds_read_b128 v[200:203], v8 offset:28672
    s_bfe_u32 s19, s100, 28 + (4 << 16)
    v_mfma_f32_16x16x32_bf16 v[92:95], v[164:167], v[204:207], v[92:95]
    s_lshl_b32 s19, s19, 13
    s_waitcnt vmcnt(12) lgkmcnt(9)
    v_mfma_f32_16x16x32_bf16 v[64:67], v[168:171], v[208:211], v[64:67]
    ds_read_b128 v[204:207], v8 offset:30720
    v_cmp_gt_u32 vcc, 22, v12
    v_mfma_f32_16x16x32_bf16 v[68:71], v[172:175], v[208:211], v[68:71]
    buffer_load_dwordx4 v[160:163], v26, s[68:71], s19 offen offset:0 sc1
    s_waitcnt lgkmcnt(8)
    v_mfma_f32_16x16x32_bf16 v[72:75], v[168:171], v[212:215], v[72:75]
    ds_read_b128 v[208:211], v9 offset:24576
    s_cbranch_vccnz G2_slow5
G2_back5:
    v_mfma_f32_16x16x32_bf16 v[76:79], v[172:175], v[212:215], v[76:79]
    ds_write_b64 v0, v[48:49] offset:49152
    s_waitcnt lgkmcnt(9)
    v_mfma_f32_16x16x32_bf16 v[80:83], v[168:171], v[216:219], v[80:83]
    ds_read_b128 v[212:215], v9 offset:26624
    v_mfma_f32_16x16x32_bf16 v[84:87], v[172:175], v[216:219], v[84:87]
    buffer_load_dwordx4 v[164:167], v26, s[68:71], s19 offen offset:1024 sc1
    s_waitcnt lgkmcnt(8)
    v_mfma_f32_16x16x32_bf16 v[88:91], v[168:171], v[220:223], v[88:91]
    ds_read_b128 v[216:219], v9 offset:28672
    v_mfma_f32_16x16x32_bf16 v[92:95], v[172:175], v[220:223], v[92:95]
    ds_write_b64 v0, v[50:51] offset:49160
    s_waitcnt vmcnt(12) lgkmcnt(9)
    v_mfma_f32_16x16x32_bf16 v[64:67], v[176:179], v[192:195], v[64:67]
    ds_read_b128 v[220:223], v9 offset:30720
    ds_write_b64 v0, v[52:53] offset:50176
    v_mfma_f32_16x16x32_bf16 v[68:71], v[180:183], v[192:195], v[68:71]
    buffer_load_dwordx4 v[168:171], v26, s[68:71], s19 offen offset:2048 sc1
    s_waitcnt lgkmcnt(9)
    v_mfma_f32_16x16x32_bf16 v[72:75], v[176:179], v[196:199], v[72:75]
    ds_read_b128 v[192:195], v6 offset:0
    v_mfma_f32_16x16x32_bf16 v[76:79], v[180:183], v[196:199], v[76:79]
    ds_write_b64 v0, v[54:55] offset:50184
    s_waitcnt lgkmcnt(10)
    v_mfma_f32_16x16x32_bf16 v[80:83], v[176:179], v[200:203], v[80:83]
    ds_read_b128 v[196:199], v6 offset:2048
    ds_read_b128 v[12:15], v11
    v_mfma_f32_16x16x32_bf16 v[84:87], v[180:183], v[200:203], v[84:87]
    buffer_load_dwordx4 v[172:175], v26, s[68:71], s19 offen offset:3072 sc1
    s_waitcnt lgkmcnt(11)
    v_mfma_f32_16x16x32_bf16 v[88:91], v[176:179], v[204:207], v[88:91]
    ds_read_b128 v[200:203], v6 offset:4096
    v_mfma_f32_16x16x32_bf16 v[92:95], v[180:183], v[204:207], v[92:95]
    ds_write_b64 v0, v[56:57] offset:51200
    s_waitcnt vmcnt(12) lgkmcnt(12)
    v_mfma_f32_16x16x32_bf16 v[64:67], v[184:187], v[208:211], v[64:67]
    ds_read_b128 v[204:207], v6 offset:6144
    ds_write_b64 v0, v[58:59] offset:51208
    v_mfma_f32_16x16x32_bf16 v[68:71], v[188:191], v[208:211], v[68:71]
    buffer_load_dwordx4 v[176:179], v27, s[68:71], s19 offen offset:0 sc1
    s_waitcnt lgkmcnt(12)
    v_mfma_f32_16x16x32_bf16 v[72:75], v[184:187], v[212:215], v[72:75]
    ds_read_b128 v[208:211], v7 offset:0
    v_mfma_f32_16x16x32_bf16 v[76:79], v[188:191], v[212:215], v[76:79]
    ds_write_b64 v0, v[60:61] offset:52224
    s_waitcnt lgkmcnt(13)
    v_mfma_f32_16x16x32_bf16 v[80:83], v[184:187], v[216:219], v[80:83]
    ds_read_b128 v[212:215], v7 offset:2048
    v_mfma_f32_16x16x32_bf16 v[84:87], v[188:191], v[216:219], v[84:87]
    buffer_load_dwordx4 v[180:183], v27, s[68:71], s19 offen offset:1024 sc1
    s_waitcnt lgkmcnt(12)
    v_mfma_f32_16x16x32_bf16 v[88:91], v[184:187], v[220:223], v[88:91]
    ds_read_b128 v[216:219], v7 offset:4096
    v_mfma_f32_16x16x32_bf16 v[92:95], v[188:191], v[220:223], v[92:95]
    ds_write_b64 v0, v[62:63] offset:52232
    s_waitcnt vmcnt(12) lgkmcnt(12)
    v_mfma_f32_16x16x32_bf16 v[64:67], v[128:131], v[192:195], v[64:67]
    ds_read_b128 v[220:223], v7 offset:6144
    v_mov_b32 v22, 24
    v_mfma_f32_16x16x32_bf16 v[68:71], v[132:135], v[192:195], v[68:71]
    buffer_load_dwordx4 v[184:187], v27, s[68:71], s19 offen offset:2048 sc1
    s_waitcnt lgkmcnt(11)
    v_mfma_f32_16x16x32_bf16 v[72:75], v[128:131], v[196:199], v[72:75]
    ds_read_b128 v[192:195], v6 offset:8192
    s_waitcnt lgkmcnt(11)
    v_min3_u32 v12, v12, v13, v14
    v_mfma_f32_16x16x32_bf16 v[76:79], v[132:135], v[196:199], v[76:79]
    ds_write_b32 v10, v22
    s_waitcnt lgkmcnt(11)
    v_mfma_f32_16x16x32_bf16 v[80:83], v[128:131], v[200:203], v[80:83]
    ds_read_b128 v[196:199], v6 offset:10240
    v_min_u32 v12, v12, v15
    v_mfma_f32_16x16x32_bf16 v[84:87], v[132:135], v[200:203], v[84:87]
    buffer_load_dwordx4 v[188:191], v27, s[68:71], s19 offen offset:3072 sc1
    s_waitcnt lgkmcnt(10)
    v_mfma_f32_16x16x32_bf16 v[88:91], v[128:131], v[204:207], v[88:91]
    ds_read_b128 v[200:203], v6 offset:12288
    s_bfe_u32 s19, s101, 0 + (4 << 16)
    v_mfma_f32_16x16x32_bf16 v[92:95], v[132:135], v[204:207], v[92:95]
    s_lshl_b32 s19, s19, 13
    s_waitcnt vmcnt(12) lgkmcnt(9)
    v_mfma_f32_16x16x32_bf16 v[64:67], v[136:139], v[208:211], v[64:67]
    ds_read_b128 v[204:207], v6 offset:14336
    v_cmp_gt_u32 vcc, 23, v12
    v_mfma_f32_16x16x32_bf16 v[68:71], v[140:143], v[208:211], v[68:71]
    buffer_load_dwordx4 v[128:131], v26, s[68:71], s19 offen offset:0 sc1
    s_waitcnt lgkmcnt(8)
    v_mfma_f32_16x16x32_bf16 v[72:75], v[136:139], v[212:215], v[72:75]
    ds_read_b128 v[208:211], v7 offset:8192
    s_cbranch_vccnz G2_slow6
G2_back6:
    v_mfma_f32_16x16x32_bf16 v[76:79], v[140:143], v[212:215], v[76:79]
    ds_write_b64 v1, v[32:33] offset:0
    s_waitcnt lgkmcnt(9)
    v_mfma_f32_16x16x32_bf16 v[80:83], v[136:139], v[216:219], v[80:83]
    ds_read_b128 v[212:215], v7 offset:10240
    v_mfma_f32_16x16x32_bf16 v[84:87], v[140:143], v[216:219], v[84:87]
    buffer_load_dwordx4 v[132:135], v26, s[68:71], s19 offen offset:1024 sc1
    s_waitcnt lgkmcnt(8)
    v_mfma_f32_16x16x32_bf16 v[88:91], v[136:139], v[220:223], v[88:91]
    ds_read_b128 v[216:219], v7 offset:12288
    v_mfma_f32_16x16x32_bf16 v[92:95], v[140:143], v[220:223], v[92:95]
    ds_write_b64 v1, v[34:35] offset:8
    s_waitcnt vmcnt(12) lgkmcnt(9)
    v_mfma_f32_16x16x32_bf16 v[64:67], v[144:147], v[192:195], v[64:67]
    ds_read_b128 v[220:223], v7 offset:14336
    ds_write_b64 v1, v[36:37] offset:1024
    v_mfma_f32_16x16x32_bf16 v[68:71], v[148:151], v[192:195], v[68:71]
    buffer_load_dwordx4 v[136:139], v26, s[68:71], s19 offen offset:2048 sc1
    s_waitcnt lgkmcnt(9)
    v_mfma_f32_16x16x32_bf16 v[72:75], v[144:147], v[196:199], v[72:75]
    ds_read_b128 v[192:195], v6 offset:16384
    v_mfma_f32_16x16x32_bf16 v[76:79], v[148:151], v[196:199], v[76:79]
    ds_write_b64 v1, v[38:39] offset:1032
    s_waitcnt lgkmcnt(10)
    v_mfma_f32_16x16x32_bf16 v[80:83], v[144:147], v[200:203], v[80:83]
    ds_read_b128 v[196:199], v6 offset:18432
    ds_read_b128 v[12:15], v11
    v_mfma_f32_16x16x32_bf16 v[84:87], v[148:151], v[200:203], v[84:87]
    buffer_load_dwordx4 v[140:143], v26, s[68:71], s19 offen offset:3072 sc1
    s_waitcnt lgkmcnt(11)
    v_mfma_f32_16x16x32_bf16 v[88:91], v[144:147], v[204:207], v[88:91]
    ds_read_b128 v[200:203], v6 offset:20480
    v_mfma_f32_16x16x32_bf16 v[92:95], v[148:151], v[204:207], v[92:95]
    ds_write_b64 v1, v[40:41] offset:2048
    s_waitcnt vmcnt(12) lgkmcnt(12)
    v_mfma_f32_16x16x32_bf16 v[64:67], v[152:155], v[208:211], v[64:67]
    ds_read_b128 v[204:207], v6 offset:22528
    ds_write_b64 v1, v[42:43] offset:2056
    v_mfma_f32_16x16x32_bf16 v[68:71], v[156:159], v[208:211], v[68:71]
    buffer_load_dwordx4 v[144:147], v27, s[68:71], s19 offen offset:0 sc1
    s_waitcnt lgkmcnt(12)
    v_mfma_f32_16x16x32_bf16 v[72:75], v[152:155], v[212:215], v[72:75]
    ds_read_b128 v[208:211], v7 offset:16384
    v_mfma_f32_16x16x32_bf16 v[76:79], v[156:159], v[212:215], v[76:79]
    ds_write_b64 v1, v[44:45] offset:3072
    s_waitcnt lgkmcnt(13)
    v_mfma_f32_16x16x32_bf16 v[80:83], v[152:155], v[216:219], v[80:83]
    ds_read_b128 v[212:215], v7 offset:18432
    v_mfma_f32_16x16x32_bf16 v[84:87], v[156:159], v[216:219], v[84:87]
    buffer_load_dwordx4 v[148:151], v27, s[68:71], s19 offen offset:1024 sc1
    s_waitcnt lgkmcnt(12)
    v_mfma_f32_16x16x32_bf16 v[88:91], v[152:155], v[220:223], v[88:91]
    ds_read_b128 v[216:219], v7 offset:20480
    v_mfma_f32_16x16x32_bf16 v[92:95], v[156:159], v[220:223], v[92:95]
    ds_write_b64 v1, v[46:47] offset:3080
    s_waitcnt vmcnt(12) lgkmcnt(12)
    v_mfma_f32_16x16x32_bf16 v[64:67], v[160:163], v[192:195], v[64:67]
    ds_read_b128 v[220:223], v7 offset:22528
    v_mov_b32 v22, 25
    v_mfma_f32_16x16x32_bf16 v[68:71], v[164:167], v[192:195], v[68:71]
    buffer_load_dwordx4 v[152:155], v27, s[68:71], s19 offen offset:2048 sc1
    s_waitcnt lgkmcnt(11)
    v_mfma_f32_16x16x32_bf16 v[72:75], v[160:163], v[196:199], v[72:75]
    ds_read_b128 v[192:195], v6 offset:24576
    s_waitcnt lgkmcnt(11)
    v_min3_u32 v12, v12, v13, v14
    v_mfma_f32_16x16x32_bf16 v[76:79], v[164:167], v[196:199], v[76:79]
    ds_write_b32 v10, v22
    s_waitcnt lgkmcnt(11)
    v_mfma_f32_16x16x32_bf16 v[80:83], v[160:163], v[200:203], v[80:83]
    ds_read_b128 v[196:199], v6 offset:26624
    v_min_u32 v12, v12, v15
    v_mfma_f32_16x16x32_bf16 v[84:87], v[164:167], v[200:203], v[84:87]
    buffer_load_dwordx4 v[156:159], v27, s[68:71], s19 offen offset:3072 sc1
    s_waitcnt lgkmcnt(10)
    v_mfma_f32_16x16x32_bf16 v[88:91], v[160:163], v[204:207], v[88:91]
    ds_read_b128 v[200:203], v6 offset:28672
    s_bfe_u32 s19, s101, 4 + (4 << 16)
    v_mfma_f32_16x16x32_bf16 v[92:95], v[164:167], v[204:207], v[92:95]
    s_lshl_b32 s19, s19, 13
    s_waitcnt vmcnt(12) lgkmcnt(9)
    v_mfma_f32_16x16x32_bf16 v[64:67], v[168:171], v[208:211], v[64:67]
    ds_read_b128 v[204:207], v6 offset:30720
    v_cmp_gt_u32 vcc, 24, v12
    v_mfma_f32_16x16x32_bf16 v[68:71], v[172:175], v[208:211], v[68:71]
    buffer_load_dwordx4 v[160:163], v26, s[68:71], s19 offen offset:0 sc1
    s_waitcnt lgkmcnt(8)
    v_mfma_f32_16x16x32_bf16 v[72:75], v[168:171], v[212:215], v[72:75]
    ds_read_b128 v[208:211], v7 offset:24576
    s_cbranch_vccnz G2_slow7
G2_back7:
    v_mfma_f32_16x16x32_bf16 v[76:79], v[172:175], v[212:215], v[76:79]
    ds_write_b64 v1, v[96:97] offset:16384
    s_waitcnt lgkmcnt(9)
    v_mfma_f32_16x16x32_bf16 v[80:83], v[168:171], v[216:219], v[80:83]
    ds_read_b128 v[212:215], v7 offset:26624
    v_mfma_f32_16x16x32_bf16 v[84:87], v[172:175], v[216:219], v[84:87]
    buffer_load_dwordx4 v[164:167], v26, s[68:71], s19 offen offset:1024 sc1
    s_waitcnt lgkmcnt(8)
    v_mfma_f32_16x16x32_bf16 v[88:91], v[168:171], v[220:223], v[88:91]
    ds_read_b128 v[216:219], v7 offset:28672
    v_mfma_f32_16x16x32_bf16 v[92:95], v[172:175], v[220:223], v[92:95]
    ds_write_b64 v1, v[98:99] offset:16392
    s_waitcnt vmcnt(12) lgkmcnt(9)
    v_mfma_f32_16x16x32_bf16 v[64:67], v[176:179], v[192:195], v[64:67]
    ds_read_b128 v[220:223], v7 offset:30720
    ds_write_b64 v1, v[100:101] offset:17408
    v_mfma_f32_16x16x32_bf16 v[68:71], v[180:183], v[192:195], v[68:71]
    buffer_load_dwordx4 v[168:171], v26, s[68:71], s19 offen offset:2048 sc1
    s_waitcnt lgkmcnt(9)
    v_mfma_f32_16x16x32_bf16 v[72:75], v[176:179], v[196:199], v[72:75]
    ds_read_b128 v[192:195], v6 offset:32768
    v_mfma_f32_16x16x32_bf16 v[76:79], v[180:183], v[196:199], v[76:79]
    ds_write_b64 v1, v[102:103] offset:17416
    s_waitcnt lgkmcnt(10)
    v_mfma_f32_16x16x32_bf16 v[80:83], v[176:179], v[200:203], v[80:83]
    ds_read_b128 v[196:199], v6 offset:34816
    ds_read_b128 v[12:15], v11
    v_mfma_f32_16x16x32_bf16 v[84:87], v[180:183], v[200:203], v[84:87]
    buffer_load_dwordx4 v[172:175], v26, s[68:71], s19 offen offset:3072 sc1
    s_waitcnt lgkmcnt(11)
    v_mfma_f32_16x16x32_bf16 v[88:91], v[176:179], v[204:207], v[88:91]
    ds_read_b128 v[200:203], v6 offset:36864
    v_mfma_f32_16x16x32_bf16 v[92:95], v[180:183], v[204:207], v[92:95]
    ds_write_b64 v1, v[104:105] offset:18432
    s_waitcnt vmcnt(12) lgkmcnt(12)
    v_mfma_f32_16x16x32_bf16 v[64:67], v[184:187], v[208:211], v[64:67]
    ds_read_b128 v[204:207], v6 offset:38912
    ds_write_b64 v1, v[106:107] offset:18440
    v_mfma_f32_16x16x32_bf16 v[68:71], v[188:191], v[208:211], v[68:71]
    buffer_load_dwordx4 v[176:179], v27, s[68:71], s19 offen offset:0 sc1
    s_waitcnt lgkmcnt(12)
    v_mfma_f32_16x16x32_bf16 v[72:75], v[184:187], v[212:215], v[72:75]
    ds_read_b128 v[208:211], v7 offset:32768
    v_mfma_f32_16x16x32_bf16 v[76:79], v[188:191], v[212:215], v[76:79]
    ds_write_b64 v1, v[108:109] offset:19456
    s_waitcnt lgkmcnt(13)
    v_mfma_f32_16x16x32_bf16 v[80:83], v[184:187], v[216:219], v[80:83]
    ds_read_b128 v[212:215], v7 offset:34816
    v_mfma_f32_16x16x32_bf16 v[84:87], v[188:191], v[216:219], v[84:87]
    buffer_load_dwordx4 v[180:183], v27, s[68:71], s19 offen offset:1024 sc1
    s_waitcnt lgkmcnt(12)
    v_mfma_f32_16x16x32_bf16 v[88:91], v[184:187], v[220:223], v[88:91]
    ds_read_b128 v[216:219], v7 offset:36864
    v_mfma_f32_16x16x32_bf16 v[92:95], v[188:191], v[220:223], v[92:95]
    ds_write_b64 v1, v[110:111] offset:19464
    s_waitcnt vmcnt(12) lgkmcnt(12)
    v_mfma_f32_16x16x32_bf16 v[64:67], v[128:131], v[192:195], v[64:67]
    ds_read_b128 v[220:223], v7 offset:38912
    v_mfma_f32_16x16x32_bf16 v[68:71], v[132:135], v[192:195], v[68:71]
    buffer_load_dwordx4 v[184:187], v27, s[68:71], s19 offen offset:2048 sc1
    s_waitcnt lgkmcnt(11)
    v_mfma_f32_16x16x32_bf16 v[72:75], v[128:131], v[196:199], v[72:75]
    ds_read_b128 v[192:195], v6 offset:40960
    s_waitcnt lgkmcnt(11)
    v_min3_u32 v12, v12, v13, v14
    v_mfma_f32_16x16x32_bf16 v[76:79], v[132:135], v[196:199], v[76:79]
    s_waitcnt lgkmcnt(10)
    v_mfma_f32_16x16x32_bf16 v[80:83], v[128:131], v[200:203], v[80:83]
    ds_read_b128 v[196:199], v6 offset:43008
    v_min_u32 v12, v12, v15
    v_mfma_f32_16x16x32_bf16 v[84:87], v[132:135], v[200:203], v[84:87]
    buffer_load_dwordx4 v[188:191], v27, s[68:71], s19 offen offset:3072 sc1
    s_waitcnt lgkmcnt(9)
    v_mfma_f32_16x16x32_bf16 v[88:91], v[128:131], v[204:207], v[88:91]
    ds_read_b128 v[200:203], v6 offset:45056
    s_bfe_u32 s19, s101, 8 + (4 << 16)
    v_mfma_f32_16x16x32_bf16 v[92:95], v[132:135], v[204:207], v[92:95]
    s_lshl_b32 s19, s19, 13
    s_waitcnt vmcnt(12) lgkmcnt(8)
    v_mfma_f32_16x16x32_bf16 v[64:67], v[136:139], v[208:211], v[64:67]
    ds_read_b128 v[204:207], v6 offset:47104
    v_cmp_gt_u32 vcc, 25, v12
    v_mfma_f32_16x16x32_bf16 v[68:71], v[140:143], v[208:211], v[68:71]
    buffer_load_dwordx4 v[128:131], v26, s[68:71], s19 offen offset:0 sc1
    s_waitcnt lgkmcnt(7)
    v_mfma_f32_16x16x32_bf16 v[72:75], v[136:139], v[212:215], v[72:75]
    ds_read_b128 v[208:211], v7 offset:40960
    s_cbranch_vccnz G2_slow8
G2_back8:
    v_mfma_f32_16x16x32_bf16 v[76:79], v[140:143], v[212:215], v[76:79]
    ds_write_b64 v0, v[112:113] offset:0
    s_waitcnt lgkmcnt(8)
    v_mfma_f32_16x16x32_bf16 v[80:83], v[136:139], v[216:219], v[80:83]
    ds_read_b128 v[212:215], v7 offset:43008
    v_mfma_f32_16x16x32_bf16 v[84:87], v[140:143], v[216:219], v[84:87]
    buffer_load_dwordx4 v[132:135], v26, s[68:71], s19 offen offset:1024 sc1
    s_waitcnt lgkmcnt(7)
    v_mfma_f32_16x16x32_bf16 v[88:91], v[136:139], v[220:223], v[88:91]
    ds_read_b128 v[216:219], v7 offset:45056
    v_mfma_f32_16x16x32_bf16 v[92:95], v[140:143], v[220:223], v[92:95]
    ds_write_b64 v0, v[114:115] offset:8
    s_waitcnt vmcnt(12) lgkmcnt(8)
    v_mfma_f32_16x16x32_bf16 v[64:67], v[144:147], v[192:195], v[64:67]
    ds_read_b128 v[220:223], v7 offset:47104
    ds_write_b64 v0, v[116:117] offset:1024
    v_mfma_f32_16x16x32_bf16 v[68:71], v[148:151], v[192:195], v[68:71]
    buffer_load_dwordx4 v[136:139], v26, s[68:71], s19 offen offset:2048 sc1
    s_waitcnt lgkmcnt(9)
    v_mfma_f32_16x16x32_bf16 v[72:75], v[144:147], v[196:199], v[72:75]
    ds_read_b128 v[192:195], v6 offset:49152
    v_mfma_f32_16x16x32_bf16 v[76:79], v[148:151], v[196:199], v[76:79]
    ds_write_b64 v0, v[118:119] offset:1032
    s_waitcnt lgkmcnt(10)
    v_mfma_f32_16x16x32_bf16 v[80:83], v[144:147], v[200:203], v[80:83]
    ds_read_b128 v[196:199], v6 offset:51200
    v_mfma_f32_16x16x32_bf16 v[84:87], v[148:151], v[200:203], v[84:87]
    buffer_load_dwordx4 v[140:143], v26, s[68:71], s19 offen offset:3072 sc1
    s_waitcnt lgkmcnt(10)
    v_mfma_f32_16x16x32_bf16 v[88:91], v[144:147], v[204:207], v[88:91]
    ds_read_b128 v[200:203], v6 offset:53248
    v_mfma_f32_16x16x32_bf16 v[92:95], v[148:151], v[204:207], v[92:95]
    ds_write_b64 v0, v[120:121] offset:2048
    s_waitcnt vmcnt(12) lgkmcnt(11)
    v_mfma_f32_16x16x32_bf16 v[64:67], v[152:155], v[208:211], v[64:67]
    ds_read_b128 v[204:207], v6 offset:55296
    ds_write_b64 v0, v[122:123] offset:2056
    v_mfma_f32_16x16x32_bf16 v[68:71], v[156:159], v[208:211], v[68:71]
    buffer_load_dwordx4 v[144:147], v27, s[68:71], s19 offen offset:0 sc1
    s_waitcnt lgkmcnt(11)
    v_mfma_f32_16x16x32_bf16 v[72:75], v[152:155], v[212:215], v[72:75]
    ds_read_b128 v[208:211], v7 offset:49152
    v_mfma_f32_16x16x32_bf16 v[76:79], v[156:159], v[212:215], v[76:79]
    ds_write_b64 v0, v[124:125] offset:3072
    s_waitcnt lgkmcnt(12)
    v_mfma_f32_16x16x32_bf16 v[80:83], v[152:155], v[216:219], v[80:83]
    ds_read_b128 v[212:215], v7 offset:51200
    v_mfma_f32_16x16x32_bf16 v[84:87], v[156:159], v[216:219], v[84:87]
    buffer_load_dwordx4 v[148:151], v27, s[68:71], s19 offen offset:1024 sc1
    s_waitcnt lgkmcnt(11)
    v_mfma_f32_16x16x32_bf16 v[88:91], v[152:155], v[220:223], v[88:91]
    ds_read_b128 v[216:219], v7 offset:53248
    v_mfma_f32_16x16x32_bf16 v[92:95], v[156:159], v[220:223], v[92:95]
    ds_write_b64 v0, v[126:127] offset:3080
    s_waitcnt vmcnt(12) lgkmcnt(11)
    v_mfma_f32_16x16x32_bf16 v[64:67], v[160:163], v[192:195], v[64:67]
    ds_read_b128 v[220:223], v7 offset:55296
    v_mov_b32 v22, 27
    v_mfma_f32_16x16x32_bf16 v[68:71], v[164:167], v[192:195], v[68:71]
    buffer_load_dwordx4 v[152:155], v27, s[68:71], s19 offen offset:2048 sc1
    s_waitcnt lgkmcnt(10)
    v_mfma_f32_16x16x32_bf16 v[72:75], v[160:163], v[196:199], v[72:75]
    ds_read_b128 v[192:195], v6 offset:57344
    v_mfma_f32_16x16x32_bf16 v[76:79], v[164:167], v[196:199], v[76:79]
    ds_write_b32 v10, v22
    s_waitcnt lgkmcnt(11)
    v_mfma_f32_16x16x32_bf16 v[80:83], v[160:163], v[200:203], v[80:83]
    ds_read_b128 v[196:199], v6 offset:59392
    v_mfma_f32_16x16x32_bf16 v[84:87], v[164:167], v[200:203], v[84:87]
    buffer_load_dwordx4 v[156:159], v27, s[68:71], s19 offen offset:3072 sc1
    s_waitcnt lgkmcnt(10)
    v_mfma_f32_16x16x32_bf16 v[88:91], v[160:163], v[204:207], v[88:91]
    ds_read_b128 v[200:203], v6 offset:61440
    s_bfe_u32 s19, s101, 12 + (4 << 16)
    v_mfma_f32_16x16x32_bf16 v[92:95], v[164:167], v[204:207], v[92:95]
    s_lshl_b32 s19, s19, 13
    s_waitcnt vmcnt(12) lgkmcnt(9)
    v_mfma_f32_16x16x32_bf16 v[64:67], v[168:171], v[208:211], v[64:67]
    ds_read_b128 v[204:207], v6 offset:63488
    v_mfma_f32_16x16x32_bf16 v[68:71], v[172:175], v[208:211], v[68:71]
    buffer_load_dwordx4 v[160:163], v26, s[68:71], s19 offen offset:0 sc1
    s_waitcnt lgkmcnt(8)
    v_mfma_f32_16x16x32_bf16 v[72:75], v[168:171], v[212:215], v[72:75]
    ds_read_b128 v[208:211], v7 offset:57344
    v_mfma_f32_16x16x32_bf16 v[76:79], v[172:175], v[212:215], v[76:79]
    s_waitcnt lgkmcnt(8)
    v_mfma_f32_16x16x32_bf16 v[80:83], v[168:171], v[216:219], v[80:83]
    ds_read_b128 v[212:215], v7 offset:59392
    v_mfma_f32_16x16x32_bf16 v[84:87], v[172:175], v[216:219], v[84:87]
    buffer_load_dwordx4 v[164:167], v26, s[68:71], s19 offen offset:1024 sc1
    s_waitcnt lgkmcnt(7)
    v_mfma_f32_16x16x32_bf16 v[88:91], v[168:171], v[220:223], v[88:91]
    ds_read_b128 v[216:219], v7 offset:61440
    v_mfma_f32_16x16x32_bf16 v[92:95], v[172:175], v[220:223], v[92:95]
    s_waitcnt vmcnt(12) lgkmcnt(7)
    v_mfma_f32_16x16x32_bf16 v[64:67], v[176:179], v[192:195], v[64:67]
    ds_read_b128 v[220:223], v7 offset:63488
    v_mfma_f32_16x16x32_bf16 v[68:71], v[180:183], v[192:195], v[68:71]
    buffer_load_dwordx4 v[168:171], v26, s[68:71], s19 offen offset:2048 sc1
    s_waitcnt lgkmcnt(6)
    v_mfma_f32_16x16x32_bf16 v[72:75], v[176:179], v[196:199], v[72:75]
    ds_read_b128 v[192:195], v8 offset:0
    v_mfma_f32_16x16x32_bf16 v[76:79], v[180:183], v[196:199], v[76:79]
    s_waitcnt lgkmcnt(6)
    v_mfma_f32_16x16x32_bf16 v[80:83], v[176:179], v[200:203], v[80:83]
    ds_read_b128 v[196:199], v8 offset:2048
    ds_read_b128 v[12:15], v11
    v_mfma_f32_16x16x32_bf16 v[84:87], v[180:183], v[200:203], v[84:87]
    buffer_load_dwordx4 v[172:175], v26, s[68:71], s19 offen offset:3072 sc1
    s_waitcnt lgkmcnt(7)
    v_mfma_f32_16x16x32_bf16 v[88:91], v[176:179], v[204:207], v[88:91]
    ds_read_b128 v[200:203], v8 offset:4096
    v_mfma_f32_16x16x32_bf16 v[92:95], v[180:183], v[204:207], v[92:95]
    s_waitcnt vmcnt(12) lgkmcnt(7)
    v_mfma_f32_16x16x32_bf16 v[64:67], v[184:187], v[208:211], v[64:67]
    ds_read_b128 v[204:207], v8 offset:6144
    v_mfma_f32_16x16x32_bf16 v[68:71], v[188:191], v[208:211], v[68:71]
    buffer_load_dwordx4 v[176:179], v27, s[68:71], s19 offen offset:0 sc1
    s_waitcnt lgkmcnt(7)
    v_mfma_f32_16x16x32_bf16 v[72:75], v[184:187], v[212:215], v[72:75]
    ds_read_b128 v[208:211], v9 offset:0
    v_mfma_f32_16x16x32_bf16 v[76:79], v[188:191], v[212:215], v[76:79]
    s_waitcnt lgkmcnt(7)
    v_mfma_f32_16x16x32_bf16 v[80:83], v[184:187], v[216:219], v[80:83]
    ds_read_b128 v[212:215], v9 offset:2048
    v_mfma_f32_16x16x32_bf16 v[84:87], v[188:191], v[216:219], v[84:87]
    buffer_load_dwordx4 v[180:183], v27, s[68:71], s19 offen offset:1024 sc1
    s_waitcnt lgkmcnt(7)
    v_mfma_f32_16x16x32_bf16 v[88:91], v[184:187], v[220:223], v[88:91]
    ds_read_b128 v[216:219], v9 offset:4096
    v_mfma_f32_16x16x32_bf16 v[92:95], v[188:191], v[220:223], v[92:95]
    s_waitcnt vmcnt(12) lgkmcnt(7)
    v_mfma_f32_16x16x32_bf16 v[64:67], v[128:131], v[192:195], v[64:67]
    ds_read_b128 v[220:223], v9 offset:6144
    v_mfma_f32_16x16x32_bf16 v[68:71], v[132:135], v[192:195], v[68:71]
    buffer_load_dwordx4 v[184:187], v27, s[68:71], s19 offen offset:2048 sc1
    s_waitcnt lgkmcnt(7)
    v_mfma_f32_16x16x32_bf16 v[72:75], v[128:131], v[196:199], v[72:75]
    ds_read_b128 v[192:195], v8 offset:8192
    s_waitcnt lgkmcnt(7)
    v_min3_u32 v12, v12, v13, v14
    v_mfma_f32_16x16x32_bf16 v[76:79], v[132:135], v[196:199], v[76:79]
    s_waitcnt lgkmcnt(6)
    v_mfma_f32_16x16x32_bf16 v[80:83], v[128:131], v[200:203], v[80:83]
    ds_read_b128 v[196:199], v8 offset:10240
    v_min_u32 v12, v12, v15
    v_mfma_f32_16x16x32_bf16 v[84:87], v[132:135], v[200:203], v[84:87]
    buffer_load_dwordx4 v[188:191], v27, s[68:71], s19 offen offset:3072 sc1
    s_waitcnt lgkmcnt(6)
    v_mfma_f32_16x16x32_bf16 v[88:91], v[128:131], v[204:207], v[88:91]
    ds_read_b128 v[200:203], v8 offset:12288
    s_bfe_u32 s19, s101, 16 + (4 << 16)
    v_mfma_f32_16x16x32_bf16 v[92:95], v[132:135], v[204:207], v[92:95]
    s_lshl_b32 s19, s19, 13
    s_waitcnt vmcnt(12) lgkmcnt(6)
    v_mfma_f32_16x16x32_bf16 v[64:67], v[136:139], v[208:211], v[64:67]
    ds_read_b128 v[204:207], v8 offset:14336
    v_cmp_gt_u32 vcc, 27, v12
    v_mfma_f32_16x16x32_bf16 v[68:71], v[140:143], v[208:211], v[68:71]
    buffer_load_dwordx4 v[128:131], v26, s[68:71], s19 offen offset:0 sc1
    s_waitcnt lgkmcnt(6)
    v_mfma_f32_16x16x32_bf16 v[72:75], v[136:139], v[212:215], v[72:75]
    ds_read_b128 v[208:211], v9 offset:8192
    s_cbranch_vccnz G2_slow10
G2_back10:
    v_mfma_f32_16x16x32_bf16 v[76:79], v[140:143], v[212:215], v[76:79]
    s_waitcnt lgkmcnt(6)
    v_mfma_f32_16x16x32_bf16 v[80:83], v[136:139], v[216:219], v[80:83]
    ds_read_b128 v[212:215], v9 offset:10240
    v_mfma_f32_16x16x32_bf16 v[84:87], v[140:143], v[216:219], v[84:87]
    buffer_load_dwordx4 v[132:135], v26, s[68:71], s19 offen offset:1024 sc1
    s_waitcnt lgkmcnt(6)
    v_mfma_f32_16x16x32_bf16 v[88:91], v[136:139], v[220:223], v[88:91]
    ds_read_b128 v[216:219], v9 offset:12288
    v_mfma_f32_16x16x32_bf16 v[92:95], v[140:143], v[220:223], v[92:95]
    s_waitcnt vmcnt(12) lgkmcnt(6)
    v_mfma_f32_16x16x32_bf16 v[64:67], v[144:147], v[192:195], v[64:67]
    ds_read_b128 v[220:223], v9 offset:14336
    v_mfma_f32_16x16x32_bf16 v[68:71], v[148:151], v[192:195], v[68:71]
    buffer_load_dwordx4 v[136:139], v26, s[68:71], s19 offen offset:2048 sc1
    s_waitcnt lgkmcnt(6)
    v_mfma_f32_16x16x32_bf16 v[72:75], v[144:147], v[196:199], v[72:75]
    ds_read_b128 v[192:195], v8 offset:16384
    v_mfma_f32_16x16x32_bf16 v[76:79], v[148:151], v[196:199], v[76:79]
    s_waitcnt lgkmcnt(6)
    v_mfma_f32_16x16x32_bf16 v[80:83], v[144:147], v[200:203], v[80:83]
    ds_read_b128 v[196:199], v8 offset:18432
    v_mfma_f32_16x16x32_bf16 v[84:87], v[148:151], v[200:203], v[84:87]
    buffer_load_dwordx4 v[140:143], v26, s[68:71], s19 offen offset:3072 sc1
    s_waitcnt lgkmcnt(6)
    v_mfma_f32_16x16x32_bf16 v[88:91], v[144:147], v[204:207], v[88:91]
    ds_read_b128 v[200:203], v8 offset:20480
    v_mfma_f32_16x16x32_bf16 v[92:95], v[148:151], v[204:207], v[92:95]
    s_waitcnt vmcnt(12) lgkmcnt(6)
    v_mfma_f32_16x16x32_bf16 v[64:67], v[152:155], v[208:211], v[64:67]
    ds_read_b128 v[204:207], v8 offset:22528
    v_mfma_f32_16x16x32_bf16 v[68:71], v[156:159], v[208:211], v[68:71]
    buffer_load_dwordx4 v[144:147], v27, s[68:71], s19 offen offset:0 sc1
    s_waitcnt lgkmcnt(6)
    v_mfma_f32_16x16x32_bf16 v[72:75], v[152:155], v[212:215], v[72:75]
    ds_read_b128 v[208:211], v9 offset:16384
    v_mfma_f32_16x16x32_bf16 v[76:79], v[156:159], v[212:215], v[76:79]
    s_waitcnt lgkmcnt(6)
    v_mfma_f32_16x16x32_bf16 v[80:83], v[152:155], v[216:219], v[80:83]
    ds_read_b128 v[212:215], v9 offset:18432
    v_mfma_f32_16x16x32_bf16 v[84:87], v[156:159], v[216:219], v[84:87]
    buffer_load_dwordx4 v[148:151], v27, s[68:71], s19 offen offset:1024 sc1
    s_waitcnt lgkmcnt(6)
    v_mfma_f32_16x16x32_bf16 v[88:91], v[152:155], v[220:223], v[88:91]
    ds_read_b128 v[216:219], v9 offset:20480
    v_mfma_f32_16x16x32_bf16 v[92:95], v[156:159], v[220:223], v[92:95]
    s_waitcnt vmcnt(12) lgkmcnt(6)
    v_mfma_f32_16x16x32_bf16 v[64:67], v[160:163], v[192:195], v[64:67]
    ds_read_b128 v[220:223], v9 offset:22528
    v_mfma_f32_16x16x32_bf16 v[68:71], v[164:167], v[192:195], v[68:71]
    buffer_load_dwordx4 v[152:155], v27, s[68:71], s19 offen offset:2048 sc1
    s_waitcnt lgkmcnt(6)
    v_mfma_f32_16x16x32_bf16 v[72:75], v[160:163], v[196:199], v[72:75]
    ds_read_b128 v[192:195], v8 offset:24576
    v_mfma_f32_16x16x32_bf16 v[76:79], v[164:167], v[196:199], v[76:79]
    s_waitcnt lgkmcnt(6)
    v_mfma_f32_16x16x32_bf16 v[80:83], v[160:163], v[200:203], v[80:83]
    ds_read_b128 v[196:199], v8 offset:26624
    v_mfma_f32_16x16x32_bf16 v[84:87], v[164:167], v[200:203], v[84:87]
    buffer_load_dwordx4 v[156:159], v27, s[68:71], s19 offen offset:3072 sc1
    s_waitcnt lgkmcnt(6)
    v_mfma_f32_16x16x32_bf16 v[88:91], v[160:163], v[204:207], v[88:91]
    ds_read_b128 v[200:203], v8 offset:28672
    s_bfe_u32 s19, s101, 20 + (4 << 16)
    v_mfma_f32_16x16x32_bf16 v[92:95], v[164:167], v[204:207], v[92:95]
    s_lshl_b32 s19, s19, 13
    s_waitcnt vmcnt(12) lgkmcnt(6)
    v_mfma_f32_16x16x32_bf16 v[64:67], v[168:171], v[208:211], v[64:67]
    ds_read_b128 v[204:207], v8 offset:30720
    v_mfma_f32_16x16x32_bf16 v[68:71], v[172:175], v[208:211], v[68:71]
    buffer_load_dwordx4 v[160:163], v26, s[68:71], s19 offen offset:0 sc1
    s_waitcnt lgkmcnt(6)
    v_mfma_f32_16x16x32_bf16 v[72:75], v[168:171], v[212:215], v[72:75]
    ds_read_b128 v[208:211], v9 offset:24576
    v_mfma_f32_16x16x32_bf16 v[76:79], v[172:175], v[212:215], v[76:79]
    s_waitcnt lgkmcnt(6)
    v_mfma_f32_16x16x32_bf16 v[80:83], v[168:171], v[216:219], v[80:83]
    ds_read_b128 v[212:215], v9 offset:26624
    v_mfma_f32_16x16x32_bf16 v[84:87], v[172:175], v[216:219], v[84:87]
    buffer_load_dwordx4 v[164:167], v26, s[68:71], s19 offen offset:1024 sc1
    s_waitcnt lgkmcnt(6)
    v_mfma_f32_16x16x32_bf16 v[88:91], v[168:171], v[220:223], v[88:91]
    ds_read_b128 v[216:219], v9 offset:28672
    v_mfma_f32_16x16x32_bf16 v[92:95], v[172:175], v[220:223], v[92:95]
    s_waitcnt vmcnt(12) lgkmcnt(6)
    v_mfma_f32_16x16x32_bf16 v[64:67], v[176:179], v[192:195], v[64:67]
    ds_read_b128 v[220:223], v9 offset:30720
    v_mfma_f32_16x16x32_bf16 v[68:71], v[180:183], v[192:195], v[68:71]
    buffer_load_dwordx4 v[168:171], v26, s[68:71], s19 offen offset:2048 sc1
    s_waitcnt lgkmcnt(6)
    v_mfma_f32_16x16x32_bf16 v[72:75], v[176:179], v[196:199], v[72:75]
    ds_read_b128 v[192:195], v6 offset:0
    v_mfma_f32_16x16x32_bf16 v[76:79], v[180:183], v[196:199], v[76:79]
    s_waitcnt lgkmcnt(6)
    v_mfma_f32_16x16x32_bf16 v[80:83], v[176:179], v[200:203], v[80:83]
    ds_read_b128 v[196:199], v6 offset:2048
    v_mfma_f32_16x16x32_bf16 v[84:87], v[180:183], v[200:203], v[84:87]
    buffer_load_dwordx4 v[172:175], v26, s[68:71], s19 offen offset:3072 sc1
    s_waitcnt lgkmcnt(6)
    v_mfma_f32_16x16x32_bf16 v[88:91], v[176:179], v[204:207], v[88:91]
    ds_read_b128 v[200:203], v6 offset:4096
    v_mfma_f32_16x16x32_bf16 v[92:95], v[180:183], v[204:207], v[92:95]
    s_waitcnt vmcnt(12) lgkmcnt(6)
    v_mfma_f32_16x16x32_bf16 v[64:67], v[184:187], v[208:211], v[64:67]
    ds_read_b128 v[204:207], v6 offset:6144
    v_mfma_f32_16x16x32_bf16 v[68:71], v[188:191], v[208:211], v[68:71]
    buffer_load_dwordx4 v[176:179], v27, s[68:71], s19 offen offset:0 sc1
    s_waitcnt lgkmcnt(6)
    v_mfma_f32_16x16x32_bf16 v[72:75], v[184:187], v[212:215], v[72:75]
    ds_read_b128 v[208:211], v7 offset:0
    ds_read_b32 v18, v11 offset:68
    v_mfma_f32_16x16x32_bf16 v[76:79], v[188:191], v[212:215], v[76:79]
    s_waitcnt lgkmcnt(7)
    v_mfma_f32_16x16x32_bf16 v[80:83], v[184:187], v[216:219], v[80:83]
    ds_read_b128 v[212:215], v7 offset:2048
    v_mfma_f32_16x16x32_bf16 v[84:87], v[188:191], v[216:219], v[84:87]
    buffer_load_dwordx4 v[180:183], v27, s[68:71], s19 offen offset:1024 sc1
    s_waitcnt lgkmcnt(7)
    v_mfma_f32_16x16x32_bf16 v[88:91], v[184:187], v[220:223], v[88:91]
    ds_read_b128 v[216:219], v7 offset:4096
    v_mfma_f32_16x16x32_bf16 v[92:95], v[188:191], v[220:223], v[92:95]
    s_waitcnt vmcnt(12) lgkmcnt(7)
    v_mfma_f32_16x16x32_bf16 v[64:67], v[128:131], v[192:195], v[64:67]
    ds_read_b128 v[220:223], v7 offset:6144
    v_mfma_f32_16x16x32_bf16 v[68:71], v[132:135], v[192:195], v[68:71]
    buffer_load_dwordx4 v[184:187], v27, s[68:71], s19 offen offset:2048 sc1
    s_waitcnt lgkmcnt(7)
    v_mfma_f32_16x16x32_bf16 v[72:75], v[128:131], v[196:199], v[72:75]
    ds_read_b128 v[192:195], v6 offset:8192
    v_mfma_f32_16x16x32_bf16 v[76:79], v[132:135], v[196:199], v[76:79]
    s_waitcnt lgkmcnt(7)
    v_mfma_f32_16x16x32_bf16 v[80:83], v[128:131], v[200:203], v[80:83]
    ds_read_b128 v[196:199], v6 offset:10240
    v_add_u32 v8, 32768, v8
    v_mfma_f32_16x16x32_bf16 v[84:87], v[132:135], v[200:203], v[84:87]
    buffer_load_dwordx4 v[188:191], v27, s[68:71], s19 offen offset:3072 sc1
    s_waitcnt lgkmcnt(7)
    v_mfma_f32_16x16x32_bf16 v[88:91], v[128:131], v[204:207], v[88:91]
    ds_read_b128 v[200:203], v6 offset:12288
    s_bfe_u32 s19, s101, 24 + (4 << 16)
    v_mfma_f32_16x16x32_bf16 v[92:95], v[132:135], v[204:207], v[92:95]
    s_lshl_b32 s19, s19, 13
    s_waitcnt vmcnt(12) lgkmcnt(7)
    v_mfma_f32_16x16x32_bf16 v[64:67], v[136:139], v[208:211], v[64:67]
    ds_read_b128 v[204:207], v6 offset:14336
    v_add_u32 v9, 32768, v9
    v_mfma_f32_16x16x32_bf16 v[68:71], v[140:143], v[208:211], v[68:71]
    buffer_load_dwordx4 v[128:131], v26, s[68:71], s19 offen offset:0 sc1
    s_waitcnt lgkmcnt(6)
    v_mfma_f32_16x16x32_bf16 v[72:75], v[136:139], v[212:215], v[72:75]
    ds_read_b128 v[208:211], v7 offset:8192
    v_cmp_gt_u32 vcc, 4, v18
    v_mfma_f32_16x16x32_bf16 v[76:79], v[140:143], v[212:215], v[76:79]
    s_waitcnt lgkmcnt(6)
    v_mfma_f32_16x16x32_bf16 v[80:83], v[136:139], v[216:219], v[80:83]
    ds_read_b128 v[212:215], v7 offset:10240
    v_mfma_f32_16x16x32_bf16 v[84:87], v[140:143], v[216:219], v[84:87]
    buffer_load_dwordx4 v[132:135], v26, s[68:71], s19 offen offset:1024 sc1
    s_waitcnt lgkmcnt(6)
    v_mfma_f32_16x16x32_bf16 v[88:91], v[136:139], v[220:223], v[88:91]
    ds_read_b128 v[216:219], v7 offset:12288
    s_cbranch_vccnz G2_slowc
G2_backc:
    v_mfma_f32_16x16x32_bf16 v[92:95], v[140:143], v[220:223], v[92:95]
    s_waitcnt vmcnt(12) lgkmcnt(6)
    v_mfma_f32_16x16x32_bf16 v[64:67], v[144:147], v[192:195], v[64:67]
    ds_read_b128 v[220:223], v7 offset:14336
    v_mfma_f32_16x16x32_bf16 v[68:71], v[148:151], v[192:195], v[68:71]
    buffer_load_dwordx4 v[136:139], v26, s[68:71], s19 offen offset:2048 sc1
    s_waitcnt lgkmcnt(6)
    v_mfma_f32_16x16x32_bf16 v[72:75], v[144:147], v[196:199], v[72:75]
    ds_read_b128 v[192:195], v8 offset:0
    v_mfma_f32_16x16x32_bf16 v[76:79], v[148:151], v[196:199], v[76:79]
    s_waitcnt lgkmcnt(6)
    v_mfma_f32_16x16x32_bf16 v[80:83], v[144:147], v[200:203], v[80:83]
    ds_read_b128 v[196:199], v8 offset:2048
    v_mfma_f32_16x16x32_bf16 v[84:87], v[148:151], v[200:203], v[84:87]
    buffer_load_dwordx4 v[140:143], v26, s[68:71], s19 offen offset:3072 sc1
    s_waitcnt lgkmcnt(6)
    v_mfma_f32_16x16x32_bf16 v[88:91], v[144:147], v[204:207], v[88:91]
    ds_read_b128 v[200:203], v8 offset:25856
    v_mfma_f32_16x16x32_bf16 v[92:95], v[148:151], v[204:207], v[92:95]
    s_waitcnt vmcnt(12) lgkmcnt(6)
    v_mfma_f32_16x16x32_bf16 v[64:67], v[152:155], v[208:211], v[64:67]
    ds_read_b128 v[204:207], v8 offset:27904
    v_mfma_f32_16x16x32_bf16 v[68:71], v[156:159], v[208:211], v[68:71]
    buffer_load_dwordx4 v[144:147], v27, s[68:71], s19 offen offset:0 sc1
    s_waitcnt lgkmcnt(6)
    v_mfma_f32_16x16x32_bf16 v[72:75], v[152:155], v[212:215], v[72:75]
    ds_read_b128 v[208:211], v9 offset:0
    v_mfma_f32_16x16x32_bf16 v[76:79], v[156:159], v[212:215], v[76:79]
    s_waitcnt lgkmcnt(6)
    v_mfma_f32_16x16x32_bf16 v[80:83], v[152:155], v[216:219], v[80:83]
    ds_read_b128 v[212:215], v9 offset:2048
    v_mfma_f32_16x16x32_bf16 v[84:87], v[156:159], v[216:219], v[84:87]
    buffer_load_dwordx4 v[148:151], v27, s[68:71], s19 offen offset:1024 sc1
    s_waitcnt lgkmcnt(6)
    v_mfma_f32_16x16x32_bf16 v[88:91], v[152:155], v[220:223], v[88:91]
    ds_read_b128 v[216:219], v9 offset:25856
    v_mfma_f32_16x16x32_bf16 v[92:95], v[156:159], v[220:223], v[92:95]
    s_waitcnt vmcnt(12) lgkmcnt(6)
    v_mfma_f32_16x16x32_bf16 v[64:67], v[160:163], v[192:195], v[64:67]
    ds_read_b128 v[220:223], v9 offset:27904
    v_mfma_f32_16x16x32_bf16 v[68:71], v[164:167], v[192:195], v[68:71]
    buffer_load_dwordx4 v[152:155], v27, s[68:71], s19 offen offset:2048 sc1
    s_waitcnt lgkmcnt(6)
    v_mfma_f32_16x16x32_bf16 v[72:75], v[160:163], v[196:199], v[72:75]
    ds_read_b128 v[192:195], v8 offset:12928
    v_mfma_f32_16x16x32_bf16 v[76:79], v[164:167], v[196:199], v[76:79]
    s_waitcnt lgkmcnt(6)
    v_mfma_f32_16x16x32_bf16 v[80:83], v[160:163], v[200:203], v[80:83]
    ds_read_b128 v[196:199], v8 offset:14976
    v_mfma_f32_16x16x32_bf16 v[84:87], v[164:167], v[200:203], v[84:87]
    buffer_load_dwordx4 v[156:159], v27, s[68:71], s19 offen offset:3072 sc1
    s_waitcnt lgkmcnt(6)
    v_mfma_f32_16x16x32_bf16 v[88:91], v[160:163], v[204:207], v[88:91]
    ds_read_b128 v[200:203], v8 offset:38784
    s_bfe_u32 s19, s101, 28 + (4 << 16)
    v_mfma_f32_16x16x32_bf16 v[92:95], v[164:167], v[204:207], v[92:95]
    s_lshl_b32 s19, s19, 13
    s_waitcnt vmcnt(12) lgkmcnt(6)
    v_mfma_f32_16x16x32_bf16 v[64:67], v[168:171], v[208:211], v[64:67]
    ds_read_b128 v[204:207], v8 offset:40832
    v_mfma_f32_16x16x32_bf16 v[68:71], v[172:175], v[208:211], v[68:71]
    buffer_load_dwordx4 v[160:163], v26, s[68:71], s19 offen offset:0 sc1
    s_waitcnt lgkmcnt(6)
    v_mfma_f32_16x16x32_bf16 v[72:75], v[168:171], v[212:215], v[72:75]
    ds_read_b128 v[208:211], v9 offset:12928
    v_mfma_f32_16x16x32_bf16 v[76:79], v[172:175], v[212:215], v[76:79]
    s_waitcnt lgkmcnt(6)
    v_mfma_f32_16x16x32_bf16 v[80:83], v[168:171], v[216:219], v[80:83]
    ds_read_b128 v[212:215], v9 offset:14976
    v_mfma_f32_16x16x32_bf16 v[84:87], v[172:175], v[216:219], v[84:87]
    buffer_load_dwordx4 v[164:167], v26, s[68:71], s19 offen offset:1024 sc1
    s_waitcnt lgkmcnt(6)
    v_mfma_f32_16x16x32_bf16 v[88:91], v[168:171], v[220:223], v[88:91]
    ds_read_b128 v[216:219], v9 offset:38784
    v_mfma_f32_16x16x32_bf16 v[92:95], v[172:175], v[220:223], v[92:95]
    s_waitcnt vmcnt(12) lgkmcnt(6)
    v_mfma_f32_16x16x32_bf16 v[64:67], v[176:179], v[192:195], v[64:67]
    ds_read_b128 v[220:223], v9 offset:40832
    v_mfma_f32_16x16x32_bf16 v[68:71], v[180:183], v[192:195], v[68:71]
    buffer_load_dwordx4 v[168:171], v26, s[68:71], s19 offen offset:2048 sc1
    s_waitcnt lgkmcnt(6)
    v_mfma_f32_16x16x32_bf16 v[72:75], v[176:179], v[196:199], v[72:75]
    ds_read_b128 v[192:195], v8 offset:4096
    v_mfma_f32_16x16x32_bf16 v[76:79], v[180:183], v[196:199], v[76:79]
    s_waitcnt lgkmcnt(6)
    v_mfma_f32_16x16x32_bf16 v[80:83], v[176:179], v[200:203], v[80:83]
    ds_read_b128 v[196:199], v8 offset:6144
    v_mfma_f32_16x16x32_bf16 v[84:87], v[180:183], v[200:203], v[84:87]
    buffer_load_dwordx4 v[172:175], v26, s[68:71], s19 offen offset:3072 sc1
    s_waitcnt lgkmcnt(6)
    v_mfma_f32_16x16x32_bf16 v[88:91], v[176:179], v[204:207], v[88:91]
    ds_read_b128 v[200:203], v8 offset:29952
    v_mfma_f32_16x16x32_bf16 v[92:95], v[180:183], v[204:207], v[92:95]
    s_waitcnt vmcnt(12) lgkmcnt(6)
    v_mfma_f32_16x16x32_bf16 v[64:67], v[184:187], v[208:211], v[64:67]
    ds_read_b128 v[204:207], v8 offset:32000
    v_mfma_f32_16x16x32_bf16 v[68:71], v[188:191], v[208:211], v[68:71]
    buffer_load_dwordx4 v[176:179], v27, s[68:71], s19 offen offset:0 sc1
    s_waitcnt lgkmcnt(6)
    v_mfma_f32_16x16x32_bf16 v[72:75], v[184:187], v[212:215], v[72:75]
    ds_read_b128 v[208:211], v9 offset:4096
    v_mfma_f32_16x16x32_bf16 v[76:79], v[188:191], v[212:215], v[76:79]
    s_waitcnt lgkmcnt(6)
    v_mfma_f32_16x16x32_bf16 v[80:83], v[184:187], v[216:219], v[80:83]
    ds_read_b128 v[212:215], v9 offset:6144
    v_mfma_f32_16x16x32_bf16 v[84:87], v[188:191], v[216:219], v[84:87]
    buffer_load_dwordx4 v[180:183], v27, s[68:71], s19 offen offset:1024 sc1
    s_waitcnt lgkmcnt(6)
    v_mfma_f32_16x16x32_bf16 v[88:91], v[184:187], v[220:223], v[88:91]
    ds_read_b128 v[216:219], v9 offset:29952
    v_mfma_f32_16x16x32_bf16 v[92:95], v[188:191], v[220:223], v[92:95]
    s_waitcnt vmcnt(12) lgkmcnt(6)
    v_mfma_f32_16x16x32_bf16 v[64:67], v[128:131], v[192:195], v[64:67]
    ds_read_b128 v[220:223], v9 offset:32000
    v_mfma_f32_16x16x32_bf16 v[68:71], v[132:135], v[192:195], v[68:71]
    buffer_load_dwordx4 v[184:187], v27, s[68:71], s19 offen offset:2048 sc1
    s_waitcnt lgkmcnt(6)
    v_mfma_f32_16x16x32_bf16 v[72:75], v[128:131], v[196:199], v[72:75]
    ds_read_b128 v[192:195], v8 offset:17024
    v_mfma_f32_16x16x32_bf16 v[76:79], v[132:135], v[196:199], v[76:79]
    s_waitcnt lgkmcnt(6)
    v_mfma_f32_16x16x32_bf16 v[80:83], v[128:131], v[200:203], v[80:83]
    ds_read_b128 v[196:199], v8 offset:19072
    v_mfma_f32_16x16x32_bf16 v[84:87], v[132:135], v[200:203], v[84:87]
    buffer_load_dwordx4 v[188:191], v27, s[68:71], s19 offen offset:3072 sc1
    s_waitcnt lgkmcnt(6)
    v_mfma_f32_16x16x32_bf16 v[88:91], v[128:131], v[204:207], v[88:91]
    ds_read_b128 v[200:203], v8 offset:42880
    v_mfma_f32_16x16x32_bf16 v[92:95], v[132:135], v[204:207], v[92:95]
    s_waitcnt vmcnt(12) lgkmcnt(6)
    v_mfma_f32_16x16x32_bf16 v[64:67], v[136:139], v[208:211], v[64:67]
    ds_read_b128 v[204:207], v8 offset:44928
    v_mfma_f32_16x16x32_bf16 v[68:71], v[140:143], v[208:211], v[68:71]
    s_waitcnt lgkmcnt(6)
    v_mfma_f32_16x16x32_bf16 v[72:75], v[136:139], v[212:215], v[72:75]
    ds_read_b128 v[208:211], v9 offset:17024
    v_mfma_f32_16x16x32_bf16 v[76:79], v[140:143], v[212:215], v[76:79]
    s_waitcnt lgkmcnt(6)
    v_mfma_f32_16x16x32_bf16 v[80:83], v[136:139], v[216:219], v[80:83]
    ds_read_b128 v[212:215], v9 offset:19072
    v_mfma_f32_16x16x32_bf16 v[84:87], v[140:143], v[216:219], v[84:87]
    s_waitcnt lgkmcnt(6)
    v_mfma_f32_16x16x32_bf16 v[88:91], v[136:139], v[220:223], v[88:91]
    ds_read_b128 v[216:219], v9 offset:42880
    v_mfma_f32_16x16x32_bf16 v[92:95], v[140:143], v[220:223], v[92:95]
    s_waitcnt vmcnt(10) lgkmcnt(6)
    v_mfma_f32_16x16x32_bf16 v[64:67], v[144:147], v[192:195], v[64:67]
    ds_read_b128 v[220:223], v9 offset:44928
    v_mfma_f32_16x16x32_bf16 v[68:71], v[148:151], v[192:195], v[68:71]
    s_waitcnt lgkmcnt(6)
    v_mfma_f32_16x16x32_bf16 v[72:75], v[144:147], v[196:199], v[72:75]
    ds_read_b128 v[192:195], v8 offset:8192
    v_mfma_f32_16x16x32_bf16 v[76:79], v[148:151], v[196:199], v[76:79]
    s_waitcnt lgkmcnt(6)
    v_mfma_f32_16x16x32_bf16 v[80:83], v[144:147], v[200:203], v[80:83]
    ds_read_b128 v[196:199], v8 offset:10240
    v_mfma_f32_16x16x32_bf16 v[84:87], v[148:151], v[200:203], v[84:87]
    s_waitcnt lgkmcnt(6)
    v_mfma_f32_16x16x32_bf16 v[88:91], v[144:147], v[204:207], v[88:91]
    ds_read_b128 v[200:203], v8 offset:34048
    v_mfma_f32_16x16x32_bf16 v[92:95], v[148:151], v[204:207], v[92:95]
    s_waitcnt vmcnt(8) lgkmcnt(6)
    v_mfma_f32_16x16x32_bf16 v[64:67], v[152:155], v[208:211], v[64:67]
    ds_read_b128 v[204:207], v8 offset:36096
    v_mfma_f32_16x16x32_bf16 v[68:71], v[156:159], v[208:211], v[68:71]
    s_waitcnt lgkmcnt(6)
    v_mfma_f32_16x16x32_bf16 v[72:75], v[152:155], v[212:215], v[72:75]
    ds_read_b128 v[208:211], v9 offset:8192
    v_mfma_f32_16x16x32_bf16 v[76:79], v[156:159], v[212:215], v[76:79]
    s_waitcnt lgkmcnt(6)
    v_mfma_f32_16x16x32_bf16 v[80:83], v[152:155], v[216:219], v[80:83]
    ds_read_b128 v[212:215], v9 offset:10240
    v_mfma_f32_16x16x32_bf16 v[84:87], v[156:159], v[216:219], v[84:87]
    s_waitcnt lgkmcnt(6)
    v_mfma_f32_16x16x32_bf16 v[88:91], v[152:155], v[220:223], v[88:91]
    ds_read_b128 v[216:219], v9 offset:34048
    v_mfma_f32_16x16x32_bf16 v[92:95], v[156:159], v[220:223], v[92:95]
    s_waitcnt vmcnt(6) lgkmcnt(6)
    v_mfma_f32_16x16x32_bf16 v[64:67], v[160:163], v[192:195], v[64:67]
    ds_read_b128 v[220:223], v9 offset:36096
    v_mfma_f32_16x16x32_bf16 v[68:71], v[164:167], v[192:195], v[68:71]
    s_waitcnt lgkmcnt(6)
    v_mfma_f32_16x16x32_bf16 v[72:75], v[160:163], v[196:199], v[72:75]
    ds_read_b128 v[192:195], v8 offset:21120
    v_mfma_f32_16x16x32_bf16 v[76:79], v[164:167], v[196:199], v[76:79]
    s_waitcnt lgkmcnt(6)
    v_mfma_f32_16x16x32_bf16 v[80:83], v[160:163], v[200:203], v[80:83]
    ds_read_b128 v[196:199], v8 offset:23168
    v_mfma_f32_16x16x32_bf16 v[84:87], v[164:167], v[200:203], v[84:87]
    s_waitcnt lgkmcnt(6)
    v_mfma_f32_16x16x32_bf16 v[88:91], v[160:163], v[204:207], v[88:91]
    ds_read_b128 v[200:203], v8 offset:46976
    v_mfma_f32_16x16x32_bf16 v[92:95], v[164:167], v[204:207], v[92:95]
    s_waitcnt vmcnt(4) lgkmcnt(6)
    v_mfma_f32_16x16x32_bf16 v[64:67], v[168:171], v[208:211], v[64:67]
    ds_read_b128 v[204:207], v8 offset:49024
    v_mfma_f32_16x16x32_bf16 v[68:71], v[172:175], v[208:211], v[68:71]
    s_waitcnt lgkmcnt(6)
    v_mfma_f32_16x16x32_bf16 v[72:75], v[168:171], v[212:215], v[72:75]
    ds_read_b128 v[208:211], v9 offset:21120
    v_mfma_f32_16x16x32_bf16 v[76:79], v[172:175], v[212:215], v[76:79]
    s_waitcnt lgkmcnt(6)
    v_mfma_f32_16x16x32_bf16 v[80:83], v[168:171], v[216:219], v[80:83]
    ds_read_b128 v[212:215], v9 offset:23168
    v_mfma_f32_16x16x32_bf16 v[84:87], v[172:175], v[216:219], v[84:87]
    s_waitcnt lgkmcnt(6)
    v_mfma_f32_16x16x32_bf16 v[88:91], v[168:171], v[220:223], v[88:91]
    ds_read_b128 v[216:219], v9 offset:46976
    v_mfma_f32_16x16x32_bf16 v[92:95], v[172:175], v[220:223], v[92:95]
    s_waitcnt vmcnt(2) lgkmcnt(6)
    v_mfma_f32_16x16x32_bf16 v[64:67], v[176:179], v[192:195], v[64:67]
    ds_read_b128 v[220:223], v9 offset:49024
    v_mfma_f32_16x16x32_bf16 v[68:71], v[180:183], v[192:195], v[68:71]
    s_waitcnt lgkmcnt(6)
    v_mfma_f32_16x16x32_bf16 v[72:75], v[176:179], v[196:199], v[72:75]
    v_mfma_f32_16x16x32_bf16 v[76:79], v[180:183], v[196:199], v[76:79]
    s_waitcnt lgkmcnt(5)
    v_mfma_f32_16x16x32_bf16 v[80:83], v[176:179], v[200:203], v[80:83]
    v_mfma_f32_16x16x32_bf16 v[84:87], v[180:183], v[200:203], v[84:87]
    s_waitcnt lgkmcnt(4)
    v_mfma_f32_16x16x32_bf16 v[88:91], v[176:179], v[204:207], v[88:91]
    v_mfma_f32_16x16x32_bf16 v[92:95], v[180:183], v[204:207], v[92:95]
    s_waitcnt vmcnt(0) lgkmcnt(3)
    v_mfma_f32_16x16x32_bf16 v[64:67], v[184:187], v[208:211], v[64:67]
    v_mfma_f32_16x16x32_bf16 v[68:71], v[188:191], v[208:211], v[68:71]
    s_waitcnt lgkmcnt(2)
    v_mfma_f32_16x16x32_bf16 v[72:75], v[184:187], v[212:215], v[72:75]
    v_mfma_f32_16x16x32_bf16 v[76:79], v[188:191], v[212:215], v[76:79]
    s_waitcnt lgkmcnt(1)
    v_mfma_f32_16x16x32_bf16 v[80:83], v[184:187], v[216:219], v[80:83]
    v_mfma_f32_16x16x32_bf16 v[84:87], v[188:191], v[216:219], v[84:87]
    s_waitcnt lgkmcnt(0)
    v_mfma_f32_16x16x32_bf16 v[88:91], v[184:187], v[220:223], v[88:91]
    v_mfma_f32_16x16x32_bf16 v[92:95], v[188:191], v[220:223], v[92:95]
    s_lshl_b32 s10, s6, 7
    s_lshl_b32 s11, s3, 5
    s_add_u32 s10, s10, s11
    v_lshrrev_b32 v32, 4, v2
    v_lshl_add_u32 v32, v32, 2, s10
    s_lshl_b32 s10, s7, 8
    s_add_u32 s10, s10, 4096
    v_and_b32 v33, 15, v2
    v_lshl_add_u32 v33, v33, 4, s10
    v_lshl_add_u32 v32, v32, 13, v33
    v_mov_b32 v224, v64
    v_mov_b32 v225, v72
    v_mov_b32 v226, v80
    v_mov_b32 v227, v88
    s_mov_b32 s10, 0
    buffer_store_dwordx4 v[224:227], v32, s[60:63], s10 offen nt
    v_mov_b32 v228, v65
    v_mov_b32 v229, v73
    v_mov_b32 v230, v81
    v_mov_b32 v231, v89
    s_mov_b32 s10, 8192
    buffer_store_dwordx4 v[228:231], v32, s[60:63], s10 offen nt
    v_mov_b32 v232, v66
    v_mov_b32 v233, v74
    v_mov_b32 v234, v82
    v_mov_b32 v235, v90
    s_mov_b32 s10, 16384
    buffer_store_dwordx4 v[232:235], v32, s[60:63], s10 offen nt
    v_mov_b32 v236, v67
    v_mov_b32 v237, v75
    v_mov_b32 v238, v83
    v_mov_b32 v239, v91
    s_mov_b32 s10, 24576
    buffer_store_dwordx4 v[236:239], v32, s[60:63], s10 offen nt
    v_mov_b32 v240, v68
    v_mov_b32 v241, v76
    v_mov_b32 v242, v84
    v_mov_b32 v243, v92
    s_mov_b32 s10, 131072
    buffer_store_dwordx4 v[240:243], v32, s[60:63], s10 offen nt
    v_mov_b32 v244, v69
    v_mov_b32 v245, v77
    v_mov_b32 v246, v85
    v_mov_b32 v247, v93
    s_mov_b32 s10, 139264
    buffer_store_dwordx4 v[244:247], v32, s[60:63], s10 offen nt
    v_mov_b32 v248, v70
    v_mov_b32 v249, v78
    v_mov_b32 v250, v86
    v_mov_b32 v251, v94
    s_mov_b32 s10, 147456
    buffer_store_dwordx4 v[248:251], v32, s[60:63], s10 offen nt
    v_mov_b32 v252, v71
    v_mov_b32 v253, v79
    v_mov_b32 v254, v87
    v_mov_b32 v255, v95
    s_mov_b32 s10, 155648
    buffer_store_dwordx4 v[252:255], v32, s[60:63], s10 offen nt
    s_waitcnt vmcnt(0) lgkmcnt(0)
    s_endpgm
G2_slow3:
    s_mov_b32 s15, 0
G2_sl3_w:
    ds_read_b128 v[12:15], v11 offset:0
    s_waitcnt lgkmcnt(0)
    v_min3_u32 v12, v12, v13, v14
    v_min_u32 v12, v12, v15
    v_cmp_gt_u32 vcc, 20, v12
    s_cbranch_vccz G2_sl3_ok
    s_add_u32 s15, s15, 1
    s_cmp_lt_u32 s15, 160000
    s_cbranch_scc1 G2_sl3_w
G2_sl3_ok:
    s_branch G2_back3
G2_slow4:
    s_mov_b32 s15, 0
G2_sl4_w:
    ds_read_b128 v[12:15], v11 offset:0
    s_waitcnt lgkmcnt(0)
    v_min3_u32 v12, v12, v13, v14
    v_min_u32 v12, v12, v15
    v_cmp_gt_u32 vcc, 21, v12
    s_cbranch_vccz G2_sl4_ok
    s_add_u32 s15, s15, 1
    s_cmp_lt_u32 s15, 160000
    s_cbranch_scc1 G2_sl4_w
G2_sl4_ok:
    s_branch G2_back4
G2_slow5:
    s_mov_b32 s15, 0
G2_sl5_w:
    ds_read_b128 v[12:15], v11 offset:0
    s_waitcnt lgkmcnt(0)
    v_min3_u32 v12, v12, v13, v14
    v_min_u32 v12, v12, v15
    v_cmp_gt_u32 vcc, 22, v12
    s_cbranch_vccz G2_sl5_ok
    s_add_u32 s15, s15, 1
    s_cmp_lt_u32 s15, 160000
    s_cbranch_scc1 G2_sl5_w
G2_sl5_ok:
    s_branch G2_back5
G2_slow6:
    s_mov_b32 s15, 0
G2_sl6_w:
    ds_read_b128 v[12:15], v11 offset:0
    s_waitcnt lgkmcnt(0)
    v_min3_u32 v12, v12, v13, v14
    v_min_u32 v12, v12, v15
    v_cmp_gt_u32 vcc, 23, v12
    s_cbranch_vccz G2_sl6_ok
    s_add_u32 s15, s15, 1
    s_cmp_lt_u32 s15, 160000
    s_cbranch_scc1 G2_sl6_w
G2_sl6_ok:
    s_branch G2_back6
G2_slow7:
    s_mov_b32 s15, 0
G2_sl7_w:
    ds_read_b128 v[12:15], v11 offset:0
    s_waitcnt lgkmcnt(0)
    v_min3_u32 v12, v12, v13, v14
    v_min_u32 v12, v12, v15
    v_cmp_gt_u32 vcc, 24, v12
    s_cbranch_vccz G2_sl7_ok
    s_add_u32 s15, s15, 1
    s_cmp_lt_u32 s15, 160000
    s_cbranch_scc1 G2_sl7_w
G2_sl7_ok:
    s_branch G2_back7
G2_slow8:
    s_mov_b32 s15, 0
G2_sl8_w:
    ds_read_b128 v[12:15], v11 offset:0
    s_waitcnt lgkmcnt(0)
    v_min3_u32 v12, v12, v13, v14
    v_min_u32 v12, v12, v15
    v_cmp_gt_u32 vcc, 25, v12
    s_cbranch_vccz G2_sl8_ok
    s_add_u32 s15, s15, 1
    s_cmp_lt_u32 s15, 160000
    s_cbranch_scc1 G2_sl8_w
G2_sl8_ok:
    s_branch G2_back8
G2_slow10:
    s_mov_b32 s15, 0
G2_sl10_w:
    ds_read_b128 v[12:15], v11 offset:0
    s_waitcnt lgkmcnt(0)
    v_min3_u32 v12, v12, v13, v14
    v_min_u32 v12, v12, v15
    v_cmp_gt_u32 vcc, 27, v12
    s_cbranch_vccz G2_sl10_ok
    s_add_u32 s15, s15, 1
    s_cmp_lt_u32 s15, 160000
    s_cbranch_scc1 G2_sl10_w
G2_sl10_ok:
    s_branch G2_back10
G2_slowc:
    s_mov_b32 s15, 0
G2_slc_w:
    ds_read_b32 v18, v11 offset:68
    s_waitcnt lgkmcnt(0)
    v_cmp_gt_u32 vcc, 4, v18
    s_cbranch_vccz G2_slc_ok
    s_add_u32 s15, s15, 1
    s_cmp_lt_u32 s15, 160000
    s_cbranch_scc1 G2_slc_w
G2_slc_ok:
    s_branch G2_backc
Y_done:
    s_endpgm
Y_end:
.section .rodata,"a"
.p2align 6
.amdhsa_kernel concat_heads__ssm_conv_h3__ssm_conv_s5__prompt_kernel
  .amdhsa_next_free_vgpr 256
  .amdhsa_next_free_sgpr 102
  .amdhsa_accum_offset 256
  .amdhsa_group_segment_fixed_size 0
  .amdhsa_kernarg_size 144
  .amdhsa_user_sgpr_count 2
  .amdhsa_user_sgpr_kernarg_segment_ptr 1
  .amdhsa_system_sgpr_workgroup_id_x 1
.end_amdhsa_kernel
```

```asm
; @launch grid=(256,1,1) block=(512,1,1) lds=163840
.amdgcn_target "amdgcn-amd-amdhsa--gfx950"
.text
.globl concat_heads__ssm_conv_h3__ssm_conv_s5__prompt_kernel
.p2align 8
.type concat_heads__ssm_conv_h3__ssm_conv_s5__prompt_kernel,@function
concat_heads__ssm_conv_h3__ssm_conv_s5__prompt_kernel:
    s_cmp_ge_u32 s2, 256
    s_cbranch_scc1 Y_done
    s_load_dwordx16 s[16:31], s[0:1], 0
    s_load_dwordx16 s[32:47], s[0:1], 64
    s_load_dwordx4 s[48:51], s[0:1], 128
    s_getpc_b64 s[52:53]
Y_pc:
    v_lshrrev_b32 v1, 6, v0
    v_and_b32 v2, 63, v0
    s_and_b32 s4, s2, 7
    v_readfirstlane_b32 s3, v1
    s_lshr_b32 s5, s2, 3
    s_and_b32 s6, s4, 1
    s_lshl_b32 s6, s6, 3
    s_and_b32 s7, s5, 7
    s_add_u32 s6, s6, s7
    s_and_b32 s7, s4, 6
    s_lshl_b32 s7, s7, 1
    s_lshr_b32 s8, s5, 3
    s_add_u32 s7, s7, s8
    s_cmp_lt_u32 s3, 4
    s_cbranch_scc0 Y_L
    s_lshl_b32 s54, s5, 2
    s_add_u32 s54, s54, s3
    s_lshl_b32 s54, s54, 7
    s_load_dword s56, s[52:53], s54
    s_add_u32 s54, s54, 64
    s_load_dword s57, s[52:53], s54
    s_add_u32 s54, s54, 16320
    s_min_u32 s54, s54, Y_end-Y_pc-4
    s_load_dword s58, s[52:53], s54
    s_add_u32 s54, s54, 64
    s_min_u32 s54, s54, Y_end-Y_pc-4
    s_load_dword s59, s[52:53], s54
    s_barrier
    s_branch Y_G
Y_L:
    s_add_u32 s13, s5, s8
    s_lshl_b32 s13, s13, 3
    s_and_b32 s9, s4, 6
    s_add_u32 s13, s13, s9
    s_and_b32 s9, s4, 1
    s_lshl_b32 s9, s9, 2
    s_add_u32 s13, s13, s9
    s_and_b32 s13, s13, 15
    s_lshl_b32 s13, s13, 7
    s_setprio 2
    s_sub_u32 s8, s3, 4
    s_lshr_b32 s11, s8, 1
    s_and_b32 s9, s8, 1
    s_cmp_eq_u32 s11, 1
    s_cbranch_scc1 L_ns0
    s_lshl_b32 s10, s6, 7
    s_lshl_b32 s12, s9, 6
    s_add_u32 s10, s10, s12
    v_and_b32 v24, 32, v2
    v_bfe_u32 v25, v2, 3, 1
    v_lshl_add_u32 v24, v25, 4, v24
    v_bfe_u32 v25, v2, 4, 1
    v_add_u32 v24, v24, v25
    v_add_u32 v24, s10, v24
    v_lshlrev_b32 v24, 11, v24
    v_lshrrev_b32 v25, 4, v2
    v_xor_b32 v25, v25, v2
    v_and_b32 v25, 7, v25
    v_lshl_add_u32 v4, v25, 4, v24
    v_xor_b32 v5, 64, v4
    v_add_u32 v5, 3072, v5
    v_add_u32 v6, 6144, v4
    v_add_u32 v7, 6144, v5
    s_lshl_b32 s10, s7, 6
    v_lshrrev_b32 v24, 3, v2
    s_lshl_b32 s12, s9, 5
    s_add_u32 s10, s10, s12
    v_add_u32 v24, s10, v24
    v_lshlrev_b32 v24, 11, v24
    v_lshrrev_b32 v25, 4, v2
    v_xor_b32 v25, v25, v2
    v_and_b32 v25, 7, v25
    v_lshl_add_u32 v8, v25, 4, v24
    v_xor_b32 v9, 64, v8
    v_add_u32 v9, 15360, v9
    v_add_u32 v10, 30720, v8
    v_add_u32 v11, 30720, v9
    s_lshl_b32 s14, s8, 13
    s_mov_b32 s54, 4194304
    s_mov_b32 s55, 0x00020000
    s_mov_b32 s58, 2097152
    s_mov_b32 s59, 0x00020000
    s_mov_b32 s62, 2097152
    s_mov_b32 s63, 0x00020000
    s_waitcnt lgkmcnt(0)
    s_mov_b32 s52, s28
    s_mov_b32 s53, s29
    s_mov_b32 s56, s34
    s_mov_b32 s57, s35
    s_mov_b32 s60, s36
    s_mov_b32 s61, s37
    s_mov_b32 s22, 1043403025
    s_mov_b32 s23, 17895742
    s_add_u32 m0, s14, 0
    s_nop 0
    buffer_load_dwordx4 v4, s[52:55], s13 offen offset:0 lds
    buffer_load_dwordx4 v5, s[52:55], s13 offen offset:1024 lds
    buffer_load_dwordx4 v6, s[52:55], s13 offen offset:2048 lds
    buffer_load_dwordx4 v7, s[52:55], s13 offen offset:3072 lds
    s_add_u32 m0, s14, 16384
    s_nop 0
    buffer_load_dwordx4 v8, s[56:59], s13 offen offset:0 lds
    buffer_load_dwordx4 v9, s[56:59], s13 offen offset:1024 lds
    buffer_load_dwordx4 v10, s[56:59], s13 offen offset:2048 lds
    buffer_load_dwordx4 v11, s[56:59], s13 offen offset:3072 lds
    s_add_u32 m0, s14, 4096
    s_add_u32 s12, s13, 16384
    buffer_load_dwordx4 v4, s[52:55], s12 offen offset:0 lds
    buffer_load_dwordx4 v5, s[52:55], s12 offen offset:1024 lds
    buffer_load_dwordx4 v6, s[52:55], s12 offen offset:2048 lds
    buffer_load_dwordx4 v7, s[52:55], s12 offen offset:3072 lds
    s_add_u32 m0, s14, 20480
    s_nop 0
    buffer_load_dwordx4 v8, s[60:63], s13 offen offset:0 lds
    buffer_load_dwordx4 v9, s[60:63], s13 offen offset:1024 lds
    buffer_load_dwordx4 v10, s[60:63], s13 offen offset:2048 lds
    buffer_load_dwordx4 v11, s[60:63], s13 offen offset:3072 lds
    s_and_b32 s12, s22, 15
    s_lshl_b32 s12, s12, 7
    s_add_u32 s13, s13, s12
    s_lshr_b64 s[22:23], s[22:23], 4
    s_and_b32 s13, s13, 2047
    s_add_u32 s14, s14, 32768
    s_and_b32 s14, s14, 131071
L_ns0:
    v_and_b32 v60, 31, v2
    v_mov_b32 v61, 0
    v_mov_b32 v62, 163712
    v_lshl_add_u32 v60, v60, 2, v62
    ds_write_b32 v60, v61
    s_and_b32 s68, s4, 6
    s_add_u32 s69, s5, s68
    s_lshl_b32 s69, s69, 1
    s_and_b32 s68, s4, 1
    s_add_u32 s69, s69, s68
    s_and_b32 s69, s69, 15
    s_mov_b32 s100, 0x76543210
    s_mov_b32 s101, 0xfedcba98
    s_lshl_b32 s68, s69, 2
    s_lshr_b64 s[64:65], s[100:101], s68
    s_sub_u32 s68, 64, s68
    s_lshl_b64 s[100:101], s[100:101], s68
    s_or_b64 s[100:101], s[100:101], s[64:65]
    s_sub_u32 s68, s7, s69
    s_and_b32 s68, s68, 15
    s_lshl_b32 s68, s68, 2
    s_bfm_b64 s[64:65], s68, 0
    s_and_b64 s[66:67], s[100:101], s[64:65]
    s_lshl_b64 s[66:67], s[66:67], 4
    s_lshl_b64 s[64:65], s[64:65], 4
    s_or_b32 s64, s64, 15
    s_andn2_b64 s[100:101], s[100:101], s[64:65]
    s_or_b64 s[100:101], s[100:101], s[66:67]
    s_or_b32 s100, s100, s7
    s_waitcnt lgkmcnt(0)
    s_barrier
    v_mov_b32 v19, 0
    s_lshl_b32 s10, s3, 2
    s_add_u32 s10, s10, 163712
    v_mov_b32 v22, s10
    v_mov_b32 v21, 163712
    s_add_u32 s72, s50, 17825792
    s_addc_u32 s73, s51, 0
    s_mov_b32 s74, 24576
    s_mov_b32 s75, 0x00020000
    s_mov_b32 s76, s48
    s_mov_b32 s77, s49
    s_mov_b32 s78, 256
    s_mov_b32 s79, 0x00020000
    s_mov_b32 s37, s100
    s_mov_b32 s30, s101
    s_lshl_b32 s100, s4, 7
    s_lshl_b32 s10, s5, 2
    s_add_u32 s100, s100, s10
    s_add_u32 s100, s100, s8
    s_lshr_b32 s10, s100, 1
    s_lshl_b32 s10, s10, 2
    s_load_dword s31, s[26:27], s10
    s_mul_i32 s101, s8, 12928
    s_add_u32 s101, s101, 98304
    s_lshl_b32 s10, s7, 5
    s_add_u32 s10, s10, s11
    s_lshl_b32 s10, s10, 12
    v_lshrrev_b32 v24, 3, v2
    v_lshl_add_u32 v24, v24, 13, s10
    v_lshrrev_b32 v25, 4, v2
    v_xor_b32 v25, v25, v2
    v_and_b32 v25, 7, v25
    v_lshl_add_u32 v12, v25, 4, v24
    v_xor_b32 v13, 64, v12
    v_add_u32 v13, 64512, v13
    s_cmp_eq_u32 s9, 1
    s_cselect_b32 s80, s40, s38
    s_cselect_b32 s81, s41, s39
    s_mov_b32 s82, 2097152
    s_mov_b32 s83, 0x00020000
    s_mov_b32 s68, s24
    s_mov_b32 s69, s25
    s_mov_b32 s70, 4194304
    s_mov_b32 s71, 0x00020000
    s_movk_i32 s32, 4096
    s_movk_i32 s33, 8192
    s_movk_i32 s34, 12288
    s_lshl_b32 s10, s5, 6
    v_and_b32 v23, 56, v2
    v_add_u32 v23, s10, v23
    v_lshlrev_b32 v26, 4, v2
    s_lshl_b32 s36, s100, 12
    s_lshl_b32 s10, s4, 1
    s_lshr_b32 s12, s5, 4
    s_add_u32 s10, s10, s12
    s_lshl_b32 s10, s10, 8
    v_and_b32 v60, 31, v2
    v_lshl_add_u32 v20, v60, 3, s10
    s_lshl_b32 s10, s4, 7
    s_lshl_b32 s12, s8, 5
    s_add_u32 s35, s10, s12
    v_and_b32 v25, 7, v2
    v_lshl_add_u32 v24, v25, 2, s35
    v_lshlrev_b32 v25, 1, v24
    v_lshl_add_u32 v16, v23, 11, v25
    v_add_u32 v60, 12416, v26
    v_and_b32 v61, 16, v26
    v_and_b32 v62, 32, v26
    v_mul_u32_u24 v62, 130, v62
    v_add_u32 v61, v61, v62
    v_cmp_gt_u32 vcc, 32, v2
    s_nop 1
    v_cndmask_b32 v60, v61, v60, vcc
    v_add_u32 v18, s101, v60
    s_lshl_b32 s10, s4, 10
    s_add_u32 s10, s10, 8192
    v_add_u32 v3, s10, v26
    v_and_b32 v17, 15, v2
    v_lshrrev_b32 v27, 4, v2
    v_lshlrev_b32 v60, 1, v17
    v_lshlrev_b32 v61, 4, v27
    v_sub_u32 v60, v60, v61
    v_and_b32 v62, 1, v17
    v_mov_b32 v63, 4212
    v_cmp_eq_u32 vcc, 1, v62
    s_nop 1
    v_cndmask_b32 v63, v63, 50, vcc
    v_add3_u32 v28, v60, v63, s101
    v_add_u32 v29, 1024, v28
    v_add_u32 v30, 2048, v28
    v_add_u32 v31, 3072, v28
    v_lshl_add_u32 v60, v17, 5, v61
    s_add_u32 s10, s101, 8848
    v_sub_u32 v32, s10, v60
    s_add_u32 s10, s101, 8320
    v_add_u32 v33, s10, v26
    s_cmp_eq_u32 s11, 1
    s_cbranch_scc1 L_idle
    s_mov_b32 s29, 1
    v_mov_b32 v25, 1
    s_branch L_free
L_loop:
    s_sub_i32 s28, s29, 3
    s_max_i32 s28, s28, 0
    s_waitcnt lgkmcnt(0)
    v_min3_u32 v60, v60, v61, v62
    v_min_u32 v60, v60, v63
    v_mov_b32 v25, s29
    v_cmp_gt_u32 vcc, s28, v60
    s_cbranch_vccz L_free
    s_mov_b32 s15, 0
L_slot_w:
    ds_read_b128 v[60:63], v21 offset:0
    s_waitcnt lgkmcnt(0)
    v_min3_u32 v60, v60, v61, v62
    v_min_u32 v60, v60, v63
    v_cmp_gt_u32 vcc, s28, v60
    s_cbranch_vccz L_slot_ok
    s_sleep 1
    s_add_u32 s15, s15, 1
    s_cmp_lt_u32 s15, 160000
    s_cbranch_scc1 L_slot_w
L_slot_ok:
L_free:
    s_cmp_ge_u32 s29, 10
    s_cbranch_scc1 L_sh
    s_add_u32 m0, s14, 0
    s_waitcnt vmcnt(15)
    buffer_load_dwordx4 v4, s[52:55], s13 offen offset:0 lds
    s_waitcnt vmcnt(15)
    buffer_load_dwordx4 v5, s[52:55], s13 offen offset:1024 lds
    s_waitcnt vmcnt(15)
    buffer_load_dwordx4 v6, s[52:55], s13 offen offset:2048 lds
    s_waitcnt vmcnt(15)
    buffer_load_dwordx4 v7, s[52:55], s13 offen offset:3072 lds
    s_add_u32 m0, s14, 16384
    s_waitcnt vmcnt(15)
    buffer_load_dwordx4 v8, s[56:59], s13 offen offset:0 lds
    s_waitcnt vmcnt(15)
    buffer_load_dwordx4 v9, s[56:59], s13 offen offset:1024 lds
    s_waitcnt vmcnt(15)
    buffer_load_dwordx4 v10, s[56:59], s13 offen offset:2048 lds
    s_waitcnt vmcnt(15)
    buffer_load_dwordx4 v11, s[56:59], s13 offen offset:3072 lds
    s_add_u32 m0, s14, 4096
    s_add_u32 s12, s13, 16384
    s_waitcnt vmcnt(15)
    buffer_load_dwordx4 v4, s[52:55], s12 offen offset:0 lds
    s_waitcnt vmcnt(15)
    buffer_load_dwordx4 v5, s[52:55], s12 offen offset:1024 lds
    s_waitcnt vmcnt(15)
    buffer_load_dwordx4 v6, s[52:55], s12 offen offset:2048 lds
    s_waitcnt vmcnt(15)
    buffer_load_dwordx4 v7, s[52:55], s12 offen offset:3072 lds
    ds_read_b128 v[60:63], v21
    s_add_u32 m0, s14, 20480
    s_waitcnt vmcnt(15)
    buffer_load_dwordx4 v8, s[60:63], s13 offen offset:0 lds
    s_waitcnt vmcnt(15)
    buffer_load_dwordx4 v9, s[60:63], s13 offen offset:1024 lds
    s_waitcnt vmcnt(15)
    buffer_load_dwordx4 v10, s[60:63], s13 offen offset:2048 lds
    s_waitcnt vmcnt(15)
    ds_write_b32 v22, v25
    buffer_load_dwordx4 v11, s[60:63], s13 offen offset:3072 lds
    s_and_b32 s12, s22, 15
    s_lshl_b32 s12, s12, 7
    s_add_u32 s13, s13, s12
    s_lshr_b64 s[22:23], s[22:23], 4
    s_and_b32 s13, s13, 2047
    s_add_u32 s14, s14, 32768
    s_and_b32 s14, s14, 131071
    s_add_u32 s29, s29, 1
    s_branch L_loop
L_sh:
    s_add_u32 m0, s14, 0
    s_waitcnt vmcnt(7)
    buffer_load_dwordx4 v4, s[52:55], s13 offen offset:0 lds
    s_waitcnt vmcnt(7)
    buffer_load_dwordx4 v5, s[52:55], s13 offen offset:1024 lds
    s_waitcnt vmcnt(7)
    buffer_load_dwordx4 v6, s[52:55], s13 offen offset:2048 lds
    s_waitcnt vmcnt(7)
    buffer_load_dwordx4 v7, s[52:55], s13 offen offset:3072 lds
    s_add_u32 m0, s14, 16384
    s_waitcnt vmcnt(7)
    buffer_load_dwordx4 v8, s[56:59], s13 offen offset:0 lds
    s_waitcnt vmcnt(7)
    buffer_load_dwordx4 v9, s[56:59], s13 offen offset:1024 lds
    s_waitcnt vmcnt(7)
    buffer_load_dwordx4 v10, s[56:59], s13 offen offset:2048 lds
    s_waitcnt vmcnt(7)
    ds_write_b32 v22, v25
    buffer_load_dwordx4 v11, s[56:59], s13 offen offset:3072 lds
    s_add_u32 m0, s14, 4096
    s_add_u32 s12, s13, 16384
    s_waitcnt vmcnt(7)
    buffer_load_dwordx4 v4, s[52:55], s12 offen offset:0 lds
    s_waitcnt vmcnt(7)
    buffer_load_dwordx4 v5, s[52:55], s12 offen offset:1024 lds
    s_waitcnt vmcnt(7)
    buffer_load_dwordx4 v6, s[52:55], s12 offen offset:2048 lds
    s_waitcnt vmcnt(7)
    buffer_load_dwordx4 v7, s[52:55], s12 offen offset:3072 lds
    ds_read_b128 v[60:63], v21
    s_add_u32 m0, s14, 20480
    s_waitcnt vmcnt(7)
    buffer_load_dwordx4 v8, s[60:63], s13 offen offset:0 lds
    s_waitcnt vmcnt(7)
    buffer_load_dwordx4 v9, s[60:63], s13 offen offset:1024 lds
    s_waitcnt vmcnt(7)
    buffer_load_dwordx4 v10, s[60:63], s13 offen offset:2048 lds
    s_waitcnt vmcnt(7)
    buffer_load_dwordx4 v11, s[60:63], s13 offen offset:3072 lds
    s_and_b32 s12, s22, 15
    s_lshl_b32 s12, s12, 7
    s_add_u32 s13, s13, s12
    s_lshr_b64 s[22:23], s[22:23], 4
    s_and_b32 s13, s13, 2047
    s_add_u32 s14, s14, 32768
    s_and_b32 s14, s14, 131071
    s_add_u32 s29, s29, 1
    s_cmp_lt_u32 s29, 16
    s_cbranch_scc1 L_loop
    v_mov_b32 v25, 16
    v_mov_b32 v60, 1
    s_mov_b64 exec, 1
    ds_add_u32 v21, v60 offset:40
    s_mov_b64 exec, -1
    s_waitcnt vmcnt(0)
    ds_write_b32 v22, v25
    s_mov_b32 s15, 0
L_is0_w:
    ds_read_b32 v60, v21 offset:40
    s_waitcnt lgkmcnt(0)
    v_cmp_gt_u32 vcc, 2, v60
    s_cbranch_vccz L_is0_ok
    s_add_u32 s15, s15, 1
    s_cmp_lt_u32 s15, 160000
    s_cbranch_scc1 L_is0_w
L_is0_ok:
    buffer_load_dwordx4 v[192:195], v26, s[68:71], s36 offen offset:0 nt
    buffer_load_dwordx4 v[196:199], v26, s[68:71], s36 offen offset:1024 nt
    buffer_load_dwordx4 v[200:203], v26, s[68:71], s36 offen offset:2048 nt
    buffer_load_dwordx4 v[204:207], v26, s[68:71], s36 offen offset:3072 nt
    s_branch L_t2
L_idle:
    s_setprio 0
    s_cmp_eq_u32 s8, 3
    s_cbranch_scc0 L_ntls
    s_lshl_b32 s10, s5, 16
    s_load_dword s29, s[22:23], 0
    s_load_dword s29, s[44:45], 0
    s_load_dword s29, s[18:19], s10
    s_load_dword s29, s[20:21], s10
    s_load_dword s29, s[50:51], s10
    s_add_u32 s10, s10, 2097152
    s_load_dword s29, s[18:19], s10
    s_load_dword s29, s[20:21], s10
    s_load_dword s29, s[50:51], s10
    s_add_u32 s10, s10, 2097152
    s_add_u32 s10, s10, 2097152
    s_add_u32 s10, s10, 2097152
    s_load_dword s29, s[50:51], s10
    s_add_u32 s10, s10, 2097152
    s_load_dword s29, s[50:51], s10
    s_add_u32 s10, s10, 2097152
    s_load_dword s29, s[50:51], s10
    s_add_u32 s10, s10, 2097152
    s_load_dword s29, s[50:51], s10
    s_add_u32 s10, s10, 2097152
    s_load_dword s29, s[50:51], s10
L_ntls:
    s_mov_b32 s52, s18
    s_mov_b32 s53, s19
    s_mov_b32 s54, 4194304
    s_mov_b32 s55, 0x00020000
    s_mov_b32 s56, s20
    s_mov_b32 s57, s21
    s_mov_b32 s58, 4194304
    s_mov_b32 s59, 0x00020000
    s_mov_b32 s60, s22
    s_mov_b32 s61, s23
    s_mov_b32 s62, 8192
    s_mov_b32 s63, 0x00020000
    s_mov_b32 s64, s50
    s_mov_b32 s65, s51
    s_mov_b32 s66, 4194304
    s_mov_b32 s67, 0x00020000
    s_lshl_b32 s10, s4, 7
    s_lshl_b32 s12, s9, 6
    s_add_u32 s10, s10, s12
    v_and_b32 v60, 7, v2
    v_lshl_add_u32 v4, v60, 3, s10
    v_lshlrev_b32 v60, 1, v4
    v_lshl_add_u32 v5, v23, 11, v60
    v_subrev_u32 v6, 6144, v5
    v_bfrev_b32 v60, 1
    v_cmp_eq_u32 vcc, 0, v23
    s_nop 1
    v_cndmask_b32 v6, v6, v60, vcc
    v_lshlrev_b32 v7, 3, v4
    v_sub_u32 v8, 2040, v23
    v_lshlrev_b32 v8, 1, v8
    v_lshl_add_u32 v8, v4, 12, v8
    v_add_u32 v9, 16384, v8
    s_lshl_b32 s13, s4, 1
    s_add_u32 s13, s13, s9
    s_lshl_b32 s13, s13, 5
    s_add_u32 s13, s13, s5
    s_lshl_b32 s13, s13, 3
    v_mov_b32 v25, 16
    s_getreg_b32 s14, hwreg(HW_REG_XCC_ID, 0, 8)
    s_add_u32 s14, s14, 1
    s_lshl_b32 s14, s14, 20
    s_lshl_b32 s10, s4, 8
    s_add_u32 s10, s10, 4096
    v_and_b32 v14, 31, v2
    v_lshl_add_u32 v14, v14, 3, s10
    s_lshl_b32 s28, s5, 3
    s_add_u32 s28, s28, s10
    s_cmp_eq_u32 s9, 0
    s_cbranch_scc0 L_x1
    s_mov_b32 s15, 0
L_x0_w:
    ds_read_b64 v[60:61], v21 offset:16
    s_waitcnt lgkmcnt(0)
    v_min_u32 v60, v60, v61
    v_cmp_gt_u32 vcc, 1, v60
    s_cbranch_vccz L_x0_ok
    s_sleep 2
    s_add_u32 s15, s15, 1
    s_cmp_lt_u32 s15, 160000
    s_cbranch_scc1 L_x0_w
L_x0_ok:
    buffer_load_dwordx2 v[10:11], v19, s[76:79], 0 offen sc1
    s_waitcnt vmcnt(0)
    s_mov_b32 s12, 0
LX_np:
    v_cmp_eq_u32 vcc, 0, v10
    s_cbranch_vccz LX_nok
    buffer_load_dwordx2 v[10:11], v19, s[76:79], 0 offen sc1
    s_add_u32 s12, s12, 1
    s_waitcnt vmcnt(0)
    s_cmp_lt_u32 s12, 20000
    s_cbranch_scc1 LX_np
LX_nok:
    v_xor_b32 v11, s14, v11
    s_mov_b64 exec, 1
    buffer_store_dwordx2 v[10:11], v19, s[72:75], s28 offen sc1
    s_mov_b64 exec, -1
L_x1:
    s_mov_b32 s15, 0
L_i1_w:
    ds_read_b64 v[60:61], v21 offset:16
    s_waitcnt lgkmcnt(0)
    v_min_u32 v60, v60, v61
    v_cmp_gt_u32 vcc, 4, v60
    s_cbranch_vccz L_i1_ok
    s_sleep 2
    s_add_u32 s15, s15, 1
    s_cmp_lt_u32 s15, 160000
    s_cbranch_scc1 L_i1_w
L_i1_ok:
    buffer_load_dwordx4 v[64:67], v7, s[60:63], 0 offen offset:0
    buffer_load_dwordx4 v[68:71], v7, s[60:63], 0 offen offset:16
    buffer_load_dwordx4 v[72:75], v7, s[60:63], 0 offen offset:32
    buffer_load_dwordx4 v[76:79], v7, s[60:63], 0 offen offset:48
    buffer_load_dwordx4 v[92:95], v5, s[52:55], 0 offen offset:0 nt
    buffer_load_dwordx4 v[96:99], v5, s[52:55], 0 offen offset:2048 nt
    buffer_load_dwordx4 v[100:103], v5, s[52:55], s32 offen offset:0 nt
    buffer_load_dwordx4 v[104:107], v5, s[52:55], s32 offen offset:2048 nt
    buffer_load_dwordx4 v[108:111], v5, s[52:55], s33 offen offset:0 nt
    buffer_load_dwordx4 v[112:115], v5, s[52:55], s33 offen offset:2048 nt
    buffer_load_dwordx4 v[116:119], v5, s[52:55], s34 offen offset:0 nt
    buffer_load_dwordx4 v[120:123], v5, s[52:55], s34 offen offset:2048 nt
    buffer_load_dwordx4 v[80:83], v6, s[52:55], 0 offen offset:0 nt
    buffer_load_dwordx4 v[84:87], v6, s[52:55], 0 offen offset:2048 nt
    buffer_load_dwordx4 v[88:91], v6, s[52:55], s32 offen offset:0 nt
    buffer_load_dwordx4 v[124:127], v5, s[56:59], 0 offen offset:0 nt
    buffer_load_dwordx4 v[128:131], v5, s[56:59], 0 offen offset:2048 nt
    buffer_load_dwordx4 v[132:135], v5, s[56:59], s32 offen offset:0 nt
    buffer_load_dwordx4 v[136:139], v5, s[56:59], s32 offen offset:2048 nt
    buffer_load_dwordx4 v[140:143], v5, s[56:59], s33 offen offset:0 nt
    buffer_load_dwordx4 v[144:147], v5, s[56:59], s33 offen offset:2048 nt
    buffer_load_dwordx4 v[148:151], v5, s[56:59], s34 offen offset:0 nt
    buffer_load_dwordx4 v[152:155], v5, s[56:59], s34 offen offset:2048 nt
    buffer_load_dwordx2 v[58:59], v14, s[72:75], 0 offen sc1
    buffer_load_dwordx2 v[0:1], v19, s[76:79], 0 offen sc1
    s_waitcnt vmcnt(21)
    v_lshlrev_b32 v156, 16, v64
    v_and_b32 v160, 0xffff0000, v64
    v_lshlrev_b32 v164, 16, v65
    v_and_b32 v168, 0xffff0000, v65
    v_lshlrev_b32 v157, 16, v66
    v_and_b32 v161, 0xffff0000, v66
    v_lshlrev_b32 v165, 16, v67
    v_and_b32 v169, 0xffff0000, v67
    v_lshlrev_b32 v158, 16, v68
    v_and_b32 v162, 0xffff0000, v68
    v_lshlrev_b32 v166, 16, v69
    v_and_b32 v170, 0xffff0000, v69
    v_lshlrev_b32 v159, 16, v70
    v_and_b32 v163, 0xffff0000, v70
    v_lshlrev_b32 v167, 16, v71
    v_and_b32 v171, 0xffff0000, v71
    s_waitcnt vmcnt(10)
    v_lshlrev_b32 v172, 16, v80
    v_and_b32 v173, 0xffff0000, v80
    v_lshlrev_b32 v174, 16, v81
    v_and_b32 v175, 0xffff0000, v81
    v_lshlrev_b32 v176, 16, v84
    v_and_b32 v177, 0xffff0000, v84
    v_lshlrev_b32 v178, 16, v85
    v_and_b32 v179, 0xffff0000, v85
    v_lshlrev_b32 v180, 16, v88
    v_and_b32 v181, 0xffff0000, v88
    v_lshlrev_b32 v182, 16, v89
    v_and_b32 v183, 0xffff0000, v89
    v_lshlrev_b32 v184, 16, v92
    v_and_b32 v185, 0xffff0000, v92
    v_lshlrev_b32 v186, 16, v93
    v_and_b32 v187, 0xffff0000, v93
    v_lshlrev_b32 v188, 16, v96
    v_and_b32 v189, 0xffff0000, v96
    v_lshlrev_b32 v190, 16, v97
    v_and_b32 v191, 0xffff0000, v97
    v_lshlrev_b32 v192, 16, v100
    v_and_b32 v193, 0xffff0000, v100
    v_lshlrev_b32 v194, 16, v101
    v_and_b32 v195, 0xffff0000, v101
    v_lshlrev_b32 v196, 16, v104
    v_and_b32 v197, 0xffff0000, v104
    v_lshlrev_b32 v198, 16, v105
    v_and_b32 v199, 0xffff0000, v105
    v_lshlrev_b32 v200, 16, v108
    v_and_b32 v201, 0xffff0000, v108
    v_lshlrev_b32 v202, 16, v109
    v_and_b32 v203, 0xffff0000, v109
    v_lshlrev_b32 v204, 16, v112
    v_and_b32 v205, 0xffff0000, v112
    v_lshlrev_b32 v206, 16, v113
    v_and_b32 v207, 0xffff0000, v113
    v_lshlrev_b32 v208, 16, v116
    v_and_b32 v209, 0xffff0000, v116
    v_lshlrev_b32 v210, 16, v117
    v_and_b32 v211, 0xffff0000, v117
    v_lshlrev_b32 v212, 16, v120
    v_and_b32 v213, 0xffff0000, v120
    v_lshlrev_b32 v214, 16, v121
    v_and_b32 v215, 0xffff0000, v121
    v_mul_f32 v216, v184, v156
    v_mul_f32 v217, v185, v157
    v_mul_f32 v218, v186, v158
    v_mul_f32 v219, v187, v159
    v_mul_f32 v220, v188, v156
    v_mul_f32 v221, v189, v157
    v_mul_f32 v222, v190, v158
    v_mul_f32 v223, v191, v159
    v_mul_f32 v224, v192, v156
    v_mul_f32 v225, v193, v157
    v_mul_f32 v226, v194, v158
    v_mul_f32 v227, v195, v159
    v_mul_f32 v228, v196, v156
    v_mul_f32 v229, v197, v157
    v_mul_f32 v230, v198, v158
    v_mul_f32 v231, v199, v159
    v_mul_f32 v232, v200, v156
    v_mul_f32 v233, v201, v157
    v_mul_f32 v234, v202, v158
    v_mul_f32 v235, v203, v159
    v_mul_f32 v236, v204, v156
    v_mul_f32 v237, v205, v157
    v_mul_f32 v238, v206, v158
    v_mul_f32 v239, v207, v159
    v_mul_f32 v240, v208, v156
    v_mul_f32 v241, v209, v157
    v_mul_f32 v242, v210, v158
    v_mul_f32 v243, v211, v159
    v_mul_f32 v244, v212, v156
    v_mul_f32 v245, v213, v157
    v_mul_f32 v246, v214, v158
    v_mul_f32 v247, v215, v159
    v_fmac_f32 v216, v180, v160
    v_fmac_f32 v217, v181, v161
    v_fmac_f32 v218, v182, v162
    v_fmac_f32 v219, v183, v163
    v_fmac_f32 v220, v184, v160
    v_fmac_f32 v221, v185, v161
    v_fmac_f32 v222, v186, v162
    v_fmac_f32 v223, v187, v163
    v_fmac_f32 v224, v188, v160
    v_fmac_f32 v225, v189, v161
    v_fmac_f32 v226, v190, v162
    v_fmac_f32 v227, v191, v163
    v_fmac_f32 v228, v192, v160
    v_fmac_f32 v229, v193, v161
    v_fmac_f32 v230, v194, v162
    v_fmac_f32 v231, v195, v163
    v_fmac_f32 v232, v196, v160
    v_fmac_f32 v233, v197, v161
    v_fmac_f32 v234, v198, v162
    v_fmac_f32 v235, v199, v163
    v_fmac_f32 v236, v200, v160
    v_fmac_f32 v237, v201, v161
    v_fmac_f32 v238, v202, v162
    v_fmac_f32 v239, v203, v163
    v_fmac_f32 v240, v204, v160
    v_fmac_f32 v241, v205, v161
    v_fmac_f32 v242, v206, v162
    v_fmac_f32 v243, v207, v163
    v_fmac_f32 v244, v208, v160
    v_fmac_f32 v245, v209, v161
    v_fmac_f32 v246, v210, v162
    v_fmac_f32 v247, v211, v163
    v_fmac_f32 v216, v176, v164
    v_fmac_f32 v217, v177, v165
    v_fmac_f32 v218, v178, v166
    v_fmac_f32 v219, v179, v167
    v_fmac_f32 v220, v180, v164
    v_fmac_f32 v221, v181, v165
    v_fmac_f32 v222, v182, v166
    v_fmac_f32 v223, v183, v167
    v_fmac_f32 v224, v184, v164
    v_fmac_f32 v225, v185, v165
    v_fmac_f32 v226, v186, v166
    v_fmac_f32 v227, v187, v167
    v_fmac_f32 v228, v188, v164
    v_fmac_f32 v229, v189, v165
    v_fmac_f32 v230, v190, v166
    v_fmac_f32 v231, v191, v167
    v_fmac_f32 v232, v192, v164
    v_fmac_f32 v233, v193, v165
    v_fmac_f32 v234, v194, v166
    v_fmac_f32 v235, v195, v167
    v_fmac_f32 v236, v196, v164
    v_fmac_f32 v237, v197, v165
    v_fmac_f32 v238, v198, v166
    v_fmac_f32 v239, v199, v167
    v_fmac_f32 v240, v200, v164
    v_fmac_f32 v241, v201, v165
    v_fmac_f32 v242, v202, v166
    v_fmac_f32 v243, v203, v167
    v_fmac_f32 v244, v204, v164
    v_fmac_f32 v245, v205, v165
    v_fmac_f32 v246, v206, v166
    v_fmac_f32 v247, v207, v167
    v_fmac_f32 v216, v172, v168
    v_fmac_f32 v217, v173, v169
    v_fmac_f32 v218, v174, v170
    v_fmac_f32 v219, v175, v171
    v_fmac_f32 v220, v176, v168
    v_fmac_f32 v221, v177, v169
    v_fmac_f32 v222, v178, v170
    v_fmac_f32 v223, v179, v171
    v_fmac_f32 v224, v180, v168
    v_fmac_f32 v225, v181, v169
    v_fmac_f32 v226, v182, v170
    v_fmac_f32 v227, v183, v171
    v_fmac_f32 v228, v184, v168
    v_fmac_f32 v229, v185, v169
    v_fmac_f32 v230, v186, v170
    v_fmac_f32 v231, v187, v171
    v_fmac_f32 v232, v188, v168
    v_fmac_f32 v233, v189, v169
    v_fmac_f32 v234, v190, v170
    v_fmac_f32 v235, v191, v171
    v_fmac_f32 v236, v192, v168
    v_fmac_f32 v237, v193, v169
    v_fmac_f32 v238, v194, v170
    v_fmac_f32 v239, v195, v171
    v_fmac_f32 v240, v196, v168
    v_fmac_f32 v241, v197, v169
    v_fmac_f32 v242, v198, v170
    v_fmac_f32 v243, v199, v171
    v_fmac_f32 v244, v200, v168
    v_fmac_f32 v245, v201, v169
    v_fmac_f32 v246, v202, v170
    v_fmac_f32 v247, v203, v171
    s_waitcnt vmcnt(0)
    s_mov_b32 s12, 0
L_np:
    v_cmp_eq_u32 vcc, 0, v0
    s_cbranch_vccz L_nok
    buffer_load_dwordx2 v[0:1], v19, s[76:79], 0 offen sc1
    s_add_u32 s12, s12, 1
    s_waitcnt vmcnt(0)
    s_cmp_lt_u32 s12, 20000
    s_cbranch_scc1 L_np
L_nok:
    ds_write_b64 v21, v[0:1] offset:32
    v_xor_b32 v59, s14, v59
    v_cmp_ne_u64 vcc, v[58:59], v[0:1]
    s_cmp_eq_u64 vcc, 0
    s_cselect_b32 s14, 1, 0
    v_mov_b32 v58, s14
    ds_or_b32 v21, v58 offset:72
    v_lshlrev_b32 v172, 16, v124
    v_and_b32 v173, 0xffff0000, v124
    v_lshlrev_b32 v174, 16, v125
    v_and_b32 v175, 0xffff0000, v125
    v_lshlrev_b32 v176, 16, v128
    v_and_b32 v177, 0xffff0000, v128
    v_lshlrev_b32 v178, 16, v129
    v_and_b32 v179, 0xffff0000, v129
    v_lshlrev_b32 v180, 16, v132
    v_and_b32 v181, 0xffff0000, v132
    v_lshlrev_b32 v182, 16, v133
    v_and_b32 v183, 0xffff0000, v133
    v_lshlrev_b32 v184, 16, v136
    v_and_b32 v185, 0xffff0000, v136
    v_lshlrev_b32 v186, 16, v137
    v_and_b32 v187, 0xffff0000, v137
    v_lshlrev_b32 v188, 16, v140
    v_and_b32 v189, 0xffff0000, v140
    v_lshlrev_b32 v190, 16, v141
    v_and_b32 v191, 0xffff0000, v141
    v_lshlrev_b32 v192, 16, v144
    v_and_b32 v193, 0xffff0000, v144
    v_lshlrev_b32 v194, 16, v145
    v_and_b32 v195, 0xffff0000, v145
    v_lshlrev_b32 v196, 16, v148
    v_and_b32 v197, 0xffff0000, v148
    v_lshlrev_b32 v198, 16, v149
    v_and_b32 v199, 0xffff0000, v149
    v_lshlrev_b32 v200, 16, v152
    v_and_b32 v201, 0xffff0000, v152
    v_lshlrev_b32 v202, 16, v153
    v_and_b32 v203, 0xffff0000, v153
    v_mul_f32 v216, v216, v172
    v_mul_f32 v217, v217, v173
    v_mul_f32 v218, v218, v174
    v_mul_f32 v219, v219, v175
    v_mul_f32 v220, v220, v176
    v_mul_f32 v221, v221, v177
    v_mul_f32 v222, v222, v178
    v_mul_f32 v223, v223, v179
    v_mul_f32 v224, v224, v180
    v_mul_f32 v225, v225, v181
    v_mul_f32 v226, v226, v182
    v_mul_f32 v227, v227, v183
    v_mul_f32 v228, v228, v184
    v_mul_f32 v229, v229, v185
    v_mul_f32 v230, v230, v186
    v_mul_f32 v231, v231, v187
    v_mul_f32 v232, v232, v188
    v_mul_f32 v233, v233, v189
    v_mul_f32 v234, v234, v190
    v_mul_f32 v235, v235, v191
    v_mul_f32 v236, v236, v192
    v_mul_f32 v237, v237, v193
    v_mul_f32 v238, v238, v194
    v_mul_f32 v239, v239, v195
    v_mul_f32 v240, v240, v196
    v_mul_f32 v241, v241, v197
    v_mul_f32 v242, v242, v198
    v_mul_f32 v243, v243, v199
    v_mul_f32 v244, v244, v200
    v_mul_f32 v245, v245, v201
    v_mul_f32 v246, v246, v202
    v_mul_f32 v247, v247, v203
    v_cvt_pk_bf16_f32 v40, v244, v240
    v_cvt_pk_bf16_f32 v41, v236, v232
    v_cvt_pk_bf16_f32 v42, v228, v224
    v_cvt_pk_bf16_f32 v43, v220, v216
    v_cvt_pk_bf16_f32 v44, v245, v241
    v_cvt_pk_bf16_f32 v45, v237, v233
    v_cvt_pk_bf16_f32 v46, v229, v225
    v_cvt_pk_bf16_f32 v47, v221, v217
    v_cvt_pk_bf16_f32 v48, v246, v242
    v_cvt_pk_bf16_f32 v49, v238, v234
    v_cvt_pk_bf16_f32 v50, v230, v226
    v_cvt_pk_bf16_f32 v51, v222, v218
    v_cvt_pk_bf16_f32 v52, v247, v243
    v_cvt_pk_bf16_f32 v53, v239, v235
    v_cvt_pk_bf16_f32 v54, v231, v227
    v_cvt_pk_bf16_f32 v55, v223, v219
    s_cmp_eq_u32 s14, 1
    s_cbranch_scc1 L_xp0
    buffer_store_dwordx4 v[40:43], v8, s[64:67], 0 offen sc1
    buffer_store_dwordx4 v[44:47], v8, s[64:67], s32 offen sc1
    buffer_store_dwordx4 v[48:51], v8, s[64:67], s33 offen sc1
    buffer_store_dwordx4 v[52:55], v8, s[64:67], s34 offen sc1
    s_branch L_xq0
L_xp0:
    buffer_store_dwordx4 v[40:43], v8, s[64:67], 0 offen
    buffer_store_dwordx4 v[44:47], v8, s[64:67], s32 offen
    buffer_store_dwordx4 v[48:51], v8, s[64:67], s33 offen
    buffer_store_dwordx4 v[52:55], v8, s[64:67], s34 offen
L_xq0:
    v_lshlrev_b32 v156, 16, v72
    v_and_b32 v160, 0xffff0000, v72
    v_lshlrev_b32 v164, 16, v73
    v_and_b32 v168, 0xffff0000, v73
    v_lshlrev_b32 v157, 16, v74
    v_and_b32 v161, 0xffff0000, v74
    v_lshlrev_b32 v165, 16, v75
    v_and_b32 v169, 0xffff0000, v75
    v_lshlrev_b32 v158, 16, v76
    v_and_b32 v162, 0xffff0000, v76
    v_lshlrev_b32 v166, 16, v77
    v_and_b32 v170, 0xffff0000, v77
    v_lshlrev_b32 v159, 16, v78
    v_and_b32 v163, 0xffff0000, v78
    v_lshlrev_b32 v167, 16, v79
    v_and_b32 v171, 0xffff0000, v79
    v_lshlrev_b32 v172, 16, v82
    v_and_b32 v173, 0xffff0000, v82
    v_lshlrev_b32 v174, 16, v83
    v_and_b32 v175, 0xffff0000, v83
    v_lshlrev_b32 v176, 16, v86
    v_and_b32 v177, 0xffff0000, v86
    v_lshlrev_b32 v178, 16, v87
    v_and_b32 v179, 0xffff0000, v87
    v_lshlrev_b32 v180, 16, v90
    v_and_b32 v181, 0xffff0000, v90
    v_lshlrev_b32 v182, 16, v91
    v_and_b32 v183, 0xffff0000, v91
    v_lshlrev_b32 v184, 16, v94
    v_and_b32 v185, 0xffff0000, v94
    v_lshlrev_b32 v186, 16, v95
    v_and_b32 v187, 0xffff0000, v95
    v_lshlrev_b32 v188, 16, v98
    v_and_b32 v189, 0xffff0000, v98
    v_lshlrev_b32 v190, 16, v99
    v_and_b32 v191, 0xffff0000, v99
    v_lshlrev_b32 v192, 16, v102
    v_and_b32 v193, 0xffff0000, v102
    v_lshlrev_b32 v194, 16, v103
    v_and_b32 v195, 0xffff0000, v103
    v_lshlrev_b32 v196, 16, v106
    v_and_b32 v197, 0xffff0000, v106
    v_lshlrev_b32 v198, 16, v107
    v_and_b32 v199, 0xffff0000, v107
    v_lshlrev_b32 v200, 16, v110
    v_and_b32 v201, 0xffff0000, v110
    v_lshlrev_b32 v202, 16, v111
    v_and_b32 v203, 0xffff0000, v111
    v_lshlrev_b32 v204, 16, v114
    v_and_b32 v205, 0xffff0000, v114
    v_lshlrev_b32 v206, 16, v115
    v_and_b32 v207, 0xffff0000, v115
    v_lshlrev_b32 v208, 16, v118
    v_and_b32 v209, 0xffff0000, v118
    v_lshlrev_b32 v210, 16, v119
    v_and_b32 v211, 0xffff0000, v119
    v_lshlrev_b32 v212, 16, v122
    v_and_b32 v213, 0xffff0000, v122
    v_lshlrev_b32 v214, 16, v123
    v_and_b32 v215, 0xffff0000, v123
    v_mul_f32 v216, v184, v156
    v_mul_f32 v217, v185, v157
    v_mul_f32 v218, v186, v158
    v_mul_f32 v219, v187, v159
    v_mul_f32 v220, v188, v156
    v_mul_f32 v221, v189, v157
    v_mul_f32 v222, v190, v158
    v_mul_f32 v223, v191, v159
    v_mul_f32 v224, v192, v156
    v_mul_f32 v225, v193, v157
    v_mul_f32 v226, v194, v158
    v_mul_f32 v227, v195, v159
    v_mul_f32 v228, v196, v156
    v_mul_f32 v229, v197, v157
    v_mul_f32 v230, v198, v158
    v_mul_f32 v231, v199, v159
    v_mul_f32 v232, v200, v156
    v_mul_f32 v233, v201, v157
    v_mul_f32 v234, v202, v158
    v_mul_f32 v235, v203, v159
    v_mul_f32 v236, v204, v156
    v_mul_f32 v237, v205, v157
    v_mul_f32 v238, v206, v158
    v_mul_f32 v239, v207, v159
    v_mul_f32 v240, v208, v156
    v_mul_f32 v241, v209, v157
    v_mul_f32 v242, v210, v158
    v_mul_f32 v243, v211, v159
    v_mul_f32 v244, v212, v156
    v_mul_f32 v245, v213, v157
    v_mul_f32 v246, v214, v158
    v_mul_f32 v247, v215, v159
    v_fmac_f32 v216, v180, v160
    v_fmac_f32 v217, v181, v161
    v_fmac_f32 v218, v182, v162
    v_fmac_f32 v219, v183, v163
    v_fmac_f32 v220, v184, v160
    v_fmac_f32 v221, v185, v161
    v_fmac_f32 v222, v186, v162
    v_fmac_f32 v223, v187, v163
    v_fmac_f32 v224, v188, v160
    v_fmac_f32 v225, v189, v161
    v_fmac_f32 v226, v190, v162
    v_fmac_f32 v227, v191, v163
    v_fmac_f32 v228, v192, v160
    v_fmac_f32 v229, v193, v161
    v_fmac_f32 v230, v194, v162
    v_fmac_f32 v231, v195, v163
    v_fmac_f32 v232, v196, v160
    v_fmac_f32 v233, v197, v161
    v_fmac_f32 v234, v198, v162
    v_fmac_f32 v235, v199, v163
    v_fmac_f32 v236, v200, v160
    v_fmac_f32 v237, v201, v161
    v_fmac_f32 v238, v202, v162
    v_fmac_f32 v239, v203, v163
    v_fmac_f32 v240, v204, v160
    v_fmac_f32 v241, v205, v161
    v_fmac_f32 v242, v206, v162
    v_fmac_f32 v243, v207, v163
    v_fmac_f32 v244, v208, v160
    v_fmac_f32 v245, v209, v161
    v_fmac_f32 v246, v210, v162
    v_fmac_f32 v247, v211, v163
    v_fmac_f32 v216, v176, v164
    v_fmac_f32 v217, v177, v165
    v_fmac_f32 v218, v178, v166
    v_fmac_f32 v219, v179, v167
    v_fmac_f32 v220, v180, v164
    v_fmac_f32 v221, v181, v165
    v_fmac_f32 v222, v182, v166
    v_fmac_f32 v223, v183, v167
    v_fmac_f32 v224, v184, v164
    v_fmac_f32 v225, v185, v165
    v_fmac_f32 v226, v186, v166
    v_fmac_f32 v227, v187, v167
    v_fmac_f32 v228, v188, v164
    v_fmac_f32 v229, v189, v165
    v_fmac_f32 v230, v190, v166
    v_fmac_f32 v231, v191, v167
    v_fmac_f32 v232, v192, v164
    v_fmac_f32 v233, v193, v165
    v_fmac_f32 v234, v194, v166
    v_fmac_f32 v235, v195, v167
    v_fmac_f32 v236, v196, v164
    v_fmac_f32 v237, v197, v165
    v_fmac_f32 v238, v198, v166
    v_fmac_f32 v239, v199, v167
    v_fmac_f32 v240, v200, v164
    v_fmac_f32 v241, v201, v165
    v_fmac_f32 v242, v202, v166
    v_fmac_f32 v243, v203, v167
    v_fmac_f32 v244, v204, v164
    v_fmac_f32 v245, v205, v165
    v_fmac_f32 v246, v206, v166
    v_fmac_f32 v247, v207, v167
    v_fmac_f32 v216, v172, v168
    v_fmac_f32 v217, v173, v169
    v_fmac_f32 v218, v174, v170
    v_fmac_f32 v219, v175, v171
    v_fmac_f32 v220, v176, v168
    v_fmac_f32 v221, v177, v169
    v_fmac_f32 v222, v178, v170
    v_fmac_f32 v223, v179, v171
    v_fmac_f32 v224, v180, v168
    v_fmac_f32 v225, v181, v169
    v_fmac_f32 v226, v182, v170
    v_fmac_f32 v227, v183, v171
    v_fmac_f32 v228, v184, v168
    v_fmac_f32 v229, v185, v169
    v_fmac_f32 v230, v186, v170
    v_fmac_f32 v231, v187, v171
    v_fmac_f32 v232, v188, v168
    v_fmac_f32 v233, v189, v169
    v_fmac_f32 v234, v190, v170
    v_fmac_f32 v235, v191, v171
    v_fmac_f32 v236, v192, v168
    v_fmac_f32 v237, v193, v169
    v_fmac_f32 v238, v194, v170
    v_fmac_f32 v239, v195, v171
    v_fmac_f32 v240, v196, v168
    v_fmac_f32 v241, v197, v169
    v_fmac_f32 v242, v198, v170
    v_fmac_f32 v243, v199, v171
    v_fmac_f32 v244, v200, v168
    v_fmac_f32 v245, v201, v169
    v_fmac_f32 v246, v202, v170
    v_fmac_f32 v247, v203, v171
    v_lshlrev_b32 v172, 16, v126
    v_and_b32 v173, 0xffff0000, v126
    v_lshlrev_b32 v174, 16, v127
    v_and_b32 v175, 0xffff0000, v127
    v_lshlrev_b32 v176, 16, v130
    v_and_b32 v177, 0xffff0000, v130
    v_lshlrev_b32 v178, 16, v131
    v_and_b32 v179, 0xffff0000, v131
    v_lshlrev_b32 v180, 16, v134
    v_and_b32 v181, 0xffff0000, v134
    v_lshlrev_b32 v182, 16, v135
    v_and_b32 v183, 0xffff0000, v135
    v_lshlrev_b32 v184, 16, v138
    v_and_b32 v185, 0xffff0000, v138
    v_lshlrev_b32 v186, 16, v139
    v_and_b32 v187, 0xffff0000, v139
    v_lshlrev_b32 v188, 16, v142
    v_and_b32 v189, 0xffff0000, v142
    v_lshlrev_b32 v190, 16, v143
    v_and_b32 v191, 0xffff0000, v143
    v_lshlrev_b32 v192, 16, v146
    v_and_b32 v193, 0xffff0000, v146
    v_lshlrev_b32 v194, 16, v147
    v_and_b32 v195, 0xffff0000, v147
    v_lshlrev_b32 v196, 16, v150
    v_and_b32 v197, 0xffff0000, v150
    v_lshlrev_b32 v198, 16, v151
    v_and_b32 v199, 0xffff0000, v151
    v_lshlrev_b32 v200, 16, v154
    v_and_b32 v201, 0xffff0000, v154
    v_lshlrev_b32 v202, 16, v155
    v_and_b32 v203, 0xffff0000, v155
    v_mul_f32 v216, v216, v172
    v_mul_f32 v217, v217, v173
    v_mul_f32 v218, v218, v174
    v_mul_f32 v219, v219, v175
    v_mul_f32 v220, v220, v176
    v_mul_f32 v221, v221, v177
    v_mul_f32 v222, v222, v178
    v_mul_f32 v223, v223, v179
    v_mul_f32 v224, v224, v180
    v_mul_f32 v225, v225, v181
    v_mul_f32 v226, v226, v182
    v_mul_f32 v227, v227, v183
    v_mul_f32 v228, v228, v184
    v_mul_f32 v229, v229, v185
    v_mul_f32 v230, v230, v186
    v_mul_f32 v231, v231, v187
    v_mul_f32 v232, v232, v188
    v_mul_f32 v233, v233, v189
    v_mul_f32 v234, v234, v190
    v_mul_f32 v235, v235, v191
    v_mul_f32 v236, v236, v192
    v_mul_f32 v237, v237, v193
    v_mul_f32 v238, v238, v194
    v_mul_f32 v239, v239, v195
    v_mul_f32 v240, v240, v196
    v_mul_f32 v241, v241, v197
    v_mul_f32 v242, v242, v198
    v_mul_f32 v243, v243, v199
    v_mul_f32 v244, v244, v200
    v_mul_f32 v245, v245, v201
    v_mul_f32 v246, v246, v202
    v_mul_f32 v247, v247, v203
    v_cvt_pk_bf16_f32 v40, v244, v240
    v_cvt_pk_bf16_f32 v41, v236, v232
    v_cvt_pk_bf16_f32 v42, v228, v224
    v_cvt_pk_bf16_f32 v43, v220, v216
    v_cvt_pk_bf16_f32 v44, v245, v241
    v_cvt_pk_bf16_f32 v45, v237, v233
    v_cvt_pk_bf16_f32 v46, v229, v225
    v_cvt_pk_bf16_f32 v47, v221, v217
    v_cvt_pk_bf16_f32 v48, v246, v242
    v_cvt_pk_bf16_f32 v49, v238, v234
    v_cvt_pk_bf16_f32 v50, v230, v226
    v_cvt_pk_bf16_f32 v51, v222, v218
    v_cvt_pk_bf16_f32 v52, v247, v243
    v_cvt_pk_bf16_f32 v53, v239, v235
    v_cvt_pk_bf16_f32 v54, v231, v227
    v_cvt_pk_bf16_f32 v55, v223, v219
    s_cmp_eq_u32 s14, 1
    s_cbranch_scc1 L_xp1
    buffer_store_dwordx4 v[40:43], v9, s[64:67], 0 offen sc1
    buffer_store_dwordx4 v[44:47], v9, s[64:67], s32 offen sc1
    buffer_store_dwordx4 v[48:51], v9, s[64:67], s33 offen sc1
    buffer_store_dwordx4 v[52:55], v9, s[64:67], s34 offen sc1
    s_branch L_xq1
L_xp1:
    buffer_store_dwordx4 v[40:43], v9, s[64:67], 0 offen
    buffer_store_dwordx4 v[44:47], v9, s[64:67], s32 offen
    buffer_store_dwordx4 v[48:51], v9, s[64:67], s33 offen
    buffer_store_dwordx4 v[52:55], v9, s[64:67], s34 offen
L_xq1:
    s_waitcnt vmcnt(0)
    s_mov_b64 exec, 1
    s_cmp_eq_u32 s14, 1
    s_cbranch_scc0 L_xf0
    buffer_store_dwordx2 v[0:1], v19, s[72:75], s13 offen
    s_branch L_xf1
L_xf0:
    buffer_store_dwordx2 v[0:1], v19, s[72:75], s13 offen sc1
L_xf1:
    s_mov_b64 exec, -1
    s_cmp_eq_u32 s8, 3
    s_cbranch_scc0 L_id2
    s_mov_b32 s15, 0
L_i2_w:
    ds_read_b64 v[60:61], v21 offset:16
    s_waitcnt lgkmcnt(0)
    v_min_u32 v60, v60, v61
    v_cmp_gt_u32 vcc, 14, v60
    s_cbranch_vccz L_i2_ok
    s_sleep 2
    s_add_u32 s15, s15, 1
    s_cmp_lt_u32 s15, 160000
    s_cbranch_scc1 L_i2_w
L_i2_ok:
    s_mov_b32 s15, 0
LK_poll:
    buffer_load_dwordx2 v[60:61], v20, s[72:75], 0 offen sc1
    s_waitcnt vmcnt(0)
    v_cmp_ne_u64 vcc, v[60:61], v[0:1]
    s_cbranch_vccz LK_ok
    s_add_u32 s15, s15, 1
    s_cmp_lt_u32 s15, 20000
    s_cbranch_scc1 LK_poll
LK_ok:
    ds_write_b32 v21, v25 offset:44
L_id2:
    s_mov_b32 s15, 0
L_is1_w:
    ds_read_b32 v60, v21 offset:40
    s_waitcnt lgkmcnt(0)
    v_cmp_gt_u32 vcc, 2, v60
    s_cbranch_vccz L_is1_ok
    s_sleep 2
    s_add_u32 s15, s15, 1
    s_cmp_lt_u32 s15, 160000
    s_cbranch_scc1 L_is1_w
L_is1_ok:
    buffer_load_dwordx4 v[192:195], v26, s[68:71], s36 offen offset:0 nt
    buffer_load_dwordx4 v[196:199], v26, s[68:71], s36 offen offset:1024 nt
    buffer_load_dwordx4 v[200:203], v26, s[68:71], s36 offen offset:2048 nt
    buffer_load_dwordx4 v[204:207], v26, s[68:71], s36 offen offset:3072 nt
L_t2:
    s_mov_b32 s52, s50
    s_mov_b32 s53, s51
    s_mov_b32 s54, 4194304
    s_mov_b32 s55, 0x00020000
    s_mov_b32 s56, s50
    s_mov_b32 s57, s51
    s_mov_b32 s58, 4194304
    s_mov_b32 s59, 0x00020000
    s_mov_b32 s60, s16
    s_mov_b32 s61, s17
    s_mov_b32 s62, 4194304
    s_mov_b32 s63, 0x00020000
    s_mov_b32 s64, s46
    s_mov_b32 s65, s47
    s_mov_b32 s66, 16777216
    s_mov_b32 s67, 0x00020000
    s_mov_b32 s15, 0
L_fk_w:
    ds_read_b32 v60, v21 offset:44
    s_waitcnt lgkmcnt(0)
    v_cmp_gt_u32 vcc, 1, v60
    s_cbranch_vccz L_fk_ok
    s_sleep 1
    s_add_u32 s15, s15, 1
    s_cmp_lt_u32 s15, 160000
    s_cbranch_scc1 L_fk_w
L_fk_ok:
    ds_read_b64 v[0:1], v21 offset:32
    buffer_load_dwordx4 v[224:227], v26, s[52:55], s36 offen offset:0 sc1
    buffer_load_dwordx4 v[228:231], v26, s[52:55], s36 offen offset:1024 sc1
    buffer_load_dwordx4 v[232:235], v26, s[52:55], s36 offen offset:2048 sc1
    buffer_load_dwordx4 v[236:239], v26, s[52:55], s36 offen offset:3072 sc1
    buffer_load_dwordx2 v[4:5], v16, s[60:63], 0 offen offset:0 nt
    buffer_load_dwordx2 v[6:7], v16, s[60:63], 0 offen offset:2048 nt
    s_waitcnt vmcnt(9)
    buffer_load_dwordx2 v[8:9], v16, s[60:63], s32 offen offset:0 nt
    s_waitcnt vmcnt(9)
    buffer_load_dwordx2 v[10:11], v16, s[60:63], s32 offen offset:2048 nt
    s_waitcnt vmcnt(9)
    buffer_load_dwordx2 v[14:15], v16, s[60:63], s33 offen offset:0 nt
    s_waitcnt vmcnt(9)
    buffer_load_dwordx2 v[56:57], v16, s[60:63], s33 offen offset:2048 nt
    s_waitcnt vmcnt(9)
    buffer_load_dwordx2 v[58:59], v16, s[60:63], s34 offen offset:0 nt
    s_waitcnt vmcnt(9)
    buffer_load_dwordx2 v[34:35], v16, s[60:63], s34 offen offset:2048 nt
    s_lshl_b32 s14, s9, 13
    s_lshl_b32 s10, s11, 12
    s_add_u32 s14, s14, s10
    s_mov_b32 s15, 0
L_c1_w:
    ds_read_b128 v[60:63], v21 offset:0
    s_waitcnt lgkmcnt(0)
    v_min3_u32 v60, v60, v61, v62
    v_min_u32 v60, v60, v63
    v_cmp_gt_u32 vcc, 14, v60
    s_cbranch_vccz L_c1_ok
    s_sleep 1
    s_add_u32 s15, s15, 1
    s_cmp_lt_u32 s15, 160000
    s_cbranch_scc1 L_c1_w
L_c1_ok:
    s_waitcnt vmcnt(9)
    s_bfe_u32 s13, s37, 0 + (4 << 16)
    s_lshl_b32 s13, s13, 7
    s_add_u32 m0, s14, 0
    s_nop 0
    buffer_load_dwordx4 v12, s[80:83], s13 offen offset:0 lds
    s_waitcnt vmcnt(9)
    buffer_load_dwordx4 v13, s[80:83], s13 offen offset:1024 lds
    s_waitcnt vmcnt(9)
    buffer_load_dwordx4 v12, s[80:83], s13 offen offset:2048 lds
    s_waitcnt vmcnt(9)
    buffer_load_dwordx4 v13, s[80:83], s13 offen offset:3072 lds
    s_waitcnt vmcnt(9)
    s_bfe_u32 s13, s37, 4 + (4 << 16)
    s_lshl_b32 s13, s13, 7
    s_add_u32 m0, s14, 16384
    s_nop 0
    buffer_load_dwordx4 v12, s[80:83], s13 offen offset:0 lds
    s_waitcnt vmcnt(9)
    buffer_load_dwordx4 v13, s[80:83], s13 offen offset:1024 lds
    s_waitcnt vmcnt(9)
    buffer_load_dwordx4 v12, s[80:83], s13 offen offset:2048 lds
    s_waitcnt vmcnt(9)
    buffer_load_dwordx4 v13, s[80:83], s13 offen offset:3072 lds
    s_waitcnt vmcnt(9)
    s_bfe_u32 s13, s37, 8 + (4 << 16)
    s_lshl_b32 s13, s13, 7
    s_add_u32 m0, s14, 32768
    s_nop 0
    buffer_load_dwordx4 v12, s[80:83], s13 offen offset:0 lds
    s_waitcnt vmcnt(9)
    buffer_load_dwordx4 v13, s[80:83], s13 offen offset:1024 lds
    s_waitcnt vmcnt(9)
    buffer_load_dwordx4 v12, s[80:83], s13 offen offset:2048 lds
    s_waitcnt vmcnt(9)
    buffer_load_dwordx4 v13, s[80:83], s13 offen offset:3072 lds
    s_bitcmp1_b32 s100, 0
    s_cselect_b32 s10, 16, 0
    s_lshr_b32 s31, s31, s10
    s_and_b32 s31, s31, 0xffff
    v_lshlrev_b32 v60, 3, v27
    v_sub_u32 v60, v60, v17
    v_add_u32 v60, -9, v60
    v_and_b32 v61, 1, v60
    v_lshlrev_b32 v61, 4, v61
    v_lshlrev_b32 v61, v61, s31
    v_ashrrev_i32 v60, 1, v60
    v_cmp_eq_u32 vcc, 0, v60
    s_nop 1
    v_cndmask_b32 v36, 0, v61, vcc
    v_cmp_eq_u32 vcc, 1, v60
    s_nop 1
    v_cndmask_b32 v37, 0, v61, vcc
    v_cmp_eq_u32 vcc, 2, v60
    s_nop 1
    v_cndmask_b32 v38, 0, v61, vcc
    v_cmp_eq_u32 vcc, 3, v60
    s_nop 1
    v_cndmask_b32 v39, 0, v61, vcc
    v_mov_b32 v128, 0
    v_mov_b32 v129, 0
    v_mov_b32 v130, 0
    v_mov_b32 v131, 0
    v_and_b32 v60, 1, v27
    v_lshlrev_b32 v60, 9, v60
    v_lshl_add_u32 v60, v17, 5, v60
    v_lshrrev_b32 v61, 1, v27
    v_lshl_add_u32 v17, v61, 4, v60
    v_and_b32 v60, 1, v2
    v_lshrrev_b32 v61, 5, v2
    v_lshl_add_u32 v60, v60, 1, v61
    v_bfe_u32 v61, v2, 1, 4
    v_lshl_add_u32 v60, v60, 4, v61
    v_lshlrev_b32 v17, 2, v60
    s_waitcnt vmcnt(24)
    v_mov_b32 v208, 0
    v_alignbit_b32 v209, v193, v192, 16
    v_alignbit_b32 v210, v194, v193, 16
    v_alignbit_b32 v211, v195, v194, 16
    s_nop 0
    v_mov_b32_dpp v208, v195 wave_shr:1 row_mask:0xf bank_mask:0xf
    v_alignbit_b32 v208, v192, v208, 16
    v_readlane_b32 s10, v195, 63
    v_alignbit_b32 v213, v197, v196, 16
    v_alignbit_b32 v214, v198, v197, 16
    v_mov_b32 v212, s10
    v_alignbit_b32 v215, v199, v198, 16
    s_nop 0
    v_mov_b32_dpp v212, v199 wave_shr:1 row_mask:0xf bank_mask:0xf
    v_alignbit_b32 v212, v196, v212, 16
    v_readlane_b32 s10, v199, 63
    v_alignbit_b32 v217, v201, v200, 16
    v_alignbit_b32 v218, v202, v201, 16
    v_mov_b32 v216, s10
    v_alignbit_b32 v219, v203, v202, 16
    s_nop 0
    v_mov_b32_dpp v216, v203 wave_shr:1 row_mask:0xf bank_mask:0xf
    v_alignbit_b32 v216, v200, v216, 16
    v_readlane_b32 s10, v203, 63
    v_alignbit_b32 v221, v205, v204, 16
    v_alignbit_b32 v222, v206, v205, 16
    v_mov_b32 v220, s10
    v_alignbit_b32 v223, v207, v206, 16
    s_nop 0
    v_mov_b32_dpp v220, v207 wave_shr:1 row_mask:0xf bank_mask:0xf
    v_alignbit_b32 v220, v204, v220, 16
    s_mov_b32 s15, 0
L_c2_w:
    ds_read_b128 v[60:63], v21 offset:0
    s_waitcnt lgkmcnt(0)
    v_min3_u32 v60, v60, v61, v62
    v_min_u32 v60, v60, v63
    v_cmp_gt_u32 vcc, 16, v60
    s_cbranch_vccz L_c2_ok
    s_sleep 1
    s_add_u32 s15, s15, 1
    s_cmp_lt_u32 s15, 160000
    s_cbranch_scc1 L_c2_w
L_c2_ok:
    s_setprio 0
    ds_write_b128 v18, v[128:131]
    v_add_u32 v62, -8288, v33
    ds_write_b128 v62, v[192:195] offset:0
    ds_write_b128 v62, v[196:199] offset:1024
    ds_write_b128 v62, v[200:203] offset:2048
    ds_write_b128 v62, v[204:207] offset:3072
    ds_write_b128 v62, v[208:211] offset:4160
    ds_write_b128 v62, v[212:215] offset:5184
    ds_write_b128 v62, v[216:219] offset:6208
    ds_write_b128 v62, v[220:223] offset:7232
    ds_read2_b32 v[128:129], v28 offset0:0 offset1:1
    ds_read2_b32 v[130:131], v28 offset0:2 offset1:3
    ds_read2_b32 v[132:133], v28 offset0:128 offset1:129
    ds_read2_b32 v[134:135], v28 offset0:130 offset1:131
    ds_read2_b32 v[136:137], v29 offset0:0 offset1:1
    ds_read2_b32 v[138:139], v29 offset0:2 offset1:3
    ds_read2_b32 v[140:141], v29 offset0:128 offset1:129
    ds_read2_b32 v[142:143], v29 offset0:130 offset1:131
    ds_read2_b32 v[144:145], v30 offset0:0 offset1:1
    ds_read2_b32 v[146:147], v30 offset0:2 offset1:3
    ds_read2_b32 v[148:149], v30 offset0:128 offset1:129
    ds_read2_b32 v[150:151], v30 offset0:130 offset1:131
    ds_read2_b32 v[152:153], v31 offset0:0 offset1:1
    ds_read2_b32 v[154:155], v31 offset0:2 offset1:3
    ds_read2_b32 v[156:157], v31 offset0:128 offset1:129
    ds_read2_b32 v[158:159], v31 offset0:130 offset1:131
    s_waitcnt vmcnt(23)
    ds_write_b128 v33, v[224:227] offset:0
    s_waitcnt vmcnt(22)
    ds_write_b128 v33, v[228:231] offset:1024
    s_waitcnt vmcnt(21)
    ds_write_b128 v33, v[232:235] offset:2048
    s_waitcnt vmcnt(20)
    ds_write_b128 v33, v[236:239] offset:3072
    ds_read_b128 v[160:163], v32 offset:3584
    ds_read_b128 v[164:167], v32 offset:3072
    ds_read_b128 v[168:171], v32 offset:2560
    ds_read_b128 v[172:175], v32 offset:2048
    ds_read_b128 v[176:179], v32 offset:1536
    ds_read_b128 v[180:183], v32 offset:1024
    ds_read_b128 v[184:187], v32 offset:512
    ds_read_b128 v[188:191], v32 offset:0
    s_setprio 2
    s_waitcnt lgkmcnt(0)
    v_mfma_f32_16x16x32_bf16 v[96:99], v[36:39], v[160:163], 0
    v_mfma_f32_16x16x32_bf16 v[100:103], v[36:39], v[164:167], 0
    v_mfma_f32_16x16x32_bf16 v[104:107], v[36:39], v[168:171], 0
    v_mfma_f32_16x16x32_bf16 v[108:111], v[36:39], v[172:175], 0
    v_mfma_f32_16x16x32_bf16 v[112:115], v[36:39], v[176:179], 0
    v_mfma_f32_16x16x32_bf16 v[116:119], v[36:39], v[180:183], 0
    v_mfma_f32_16x16x32_bf16 v[120:123], v[36:39], v[184:187], 0
    v_mfma_f32_16x16x32_bf16 v[124:127], v[36:39], v[188:191], 0
    v_mfma_f32_16x16x32_bf16 v[96:99], v[128:131], v[160:163], v[96:99]
    ds_read2_b32 v[192:193], v28 offset0:16 offset1:17
    s_bfe_u32 s13, s37, 12 + (4 << 16)
    s_lshl_b32 s13, s13, 7
    s_add_u32 m0, s14, 49152
    s_nop 0
    buffer_load_dwordx4 v12, s[80:83], s13 offen offset:0 lds
    v_mfma_f32_16x16x32_bf16 v[100:103], v[128:131], v[164:167], v[100:103]
    ds_read2_b32 v[194:195], v28 offset0:18 offset1:19
    v_mfma_f32_16x16x32_bf16 v[104:107], v[128:131], v[168:171], v[104:107]
    ds_read_b128 v[224:227], v32 offset:3648
    v_mfma_f32_16x16x32_bf16 v[108:111], v[128:131], v[172:175], v[108:111]
    ds_read2_b32 v[196:197], v28 offset0:144 offset1:145
    v_mfma_f32_16x16x32_bf16 v[112:115], v[128:131], v[176:179], v[112:115]
    ds_read2_b32 v[198:199], v28 offset0:146 offset1:147
    v_mfma_f32_16x16x32_bf16 v[116:119], v[128:131], v[180:183], v[116:119]
    ds_read_b128 v[228:231], v32 offset:3136
    v_mfma_f32_16x16x32_bf16 v[120:123], v[128:131], v[184:187], v[120:123]
    ds_read2_b32 v[200:201], v29 offset0:16 offset1:17
    v_mfma_f32_16x16x32_bf16 v[124:127], v[128:131], v[188:191], v[124:127]
    ds_read2_b32 v[202:203], v29 offset0:18 offset1:19
    v_mfma_f32_16x16x32_bf16 v[100:103], v[132:135], v[160:163], v[100:103]
    ds_read_b128 v[232:235], v32 offset:2624
    buffer_load_dwordx4 v13, s[80:83], s13 offen offset:1024 lds
    v_mfma_f32_16x16x32_bf16 v[104:107], v[132:135], v[164:167], v[104:107]
    ds_read2_b32 v[204:205], v29 offset0:144 offset1:145
    v_mfma_f32_16x16x32_bf16 v[108:111], v[132:135], v[168:171], v[108:111]
    ds_read2_b32 v[206:207], v29 offset0:146 offset1:147
    v_mfma_f32_16x16x32_bf16 v[112:115], v[132:135], v[172:175], v[112:115]
    ds_read_b128 v[236:239], v32 offset:2112
    v_mfma_f32_16x16x32_bf16 v[116:119], v[132:135], v[176:179], v[116:119]
    ds_read2_b32 v[208:209], v30 offset0:16 offset1:17
    v_mfma_f32_16x16x32_bf16 v[120:123], v[132:135], v[180:183], v[120:123]
    ds_read2_b32 v[210:211], v30 offset0:18 offset1:19
    v_mfma_f32_16x16x32_bf16 v[124:127], v[132:135], v[184:187], v[124:127]
    ds_read_b128 v[240:243], v32 offset:1600
    v_mfma_f32_16x16x32_bf16 v[104:107], v[136:139], v[160:163], v[104:107]
    ds_read2_b32 v[212:213], v30 offset0:144 offset1:145
    v_mfma_f32_16x16x32_bf16 v[108:111], v[136:139], v[164:167], v[108:111]
    ds_read2_b32 v[214:215], v30 offset0:146 offset1:147
    buffer_load_dwordx4 v12, s[80:83], s13 offen offset:2048 lds
    v_mfma_f32_16x16x32_bf16 v[112:115], v[136:139], v[168:171], v[112:115]
    ds_read_b128 v[244:247], v32 offset:1088
    v_mfma_f32_16x16x32_bf16 v[116:119], v[136:139], v[172:175], v[116:119]
    ds_read2_b32 v[216:217], v31 offset0:16 offset1:17
    v_mfma_f32_16x16x32_bf16 v[120:123], v[136:139], v[176:179], v[120:123]
    ds_read2_b32 v[218:219], v31 offset0:18 offset1:19
    v_mfma_f32_16x16x32_bf16 v[124:127], v[136:139], v[180:183], v[124:127]
    ds_read_b128 v[248:251], v32 offset:576
    v_mfma_f32_16x16x32_bf16 v[108:111], v[140:143], v[160:163], v[108:111]
    ds_read2_b32 v[220:221], v31 offset0:144 offset1:145
    v_mfma_f32_16x16x32_bf16 v[112:115], v[140:143], v[164:167], v[112:115]
    ds_read2_b32 v[222:223], v31 offset0:146 offset1:147
    v_mfma_f32_16x16x32_bf16 v[116:119], v[140:143], v[168:171], v[116:119]
    ds_read_b128 v[252:255], v32 offset:64
    v_mfma_f32_16x16x32_bf16 v[120:123], v[140:143], v[172:175], v[120:123]
    buffer_load_dwordx4 v13, s[80:83], s13 offen offset:3072 lds
    v_mfma_f32_16x16x32_bf16 v[124:127], v[140:143], v[176:179], v[124:127]
    v_mfma_f32_16x16x32_bf16 v[112:115], v[144:147], v[160:163], v[112:115]
    v_mfma_f32_16x16x32_bf16 v[116:119], v[144:147], v[164:167], v[116:119]
    v_mfma_f32_16x16x32_bf16 v[120:123], v[144:147], v[168:171], v[120:123]
    v_mfma_f32_16x16x32_bf16 v[124:127], v[144:147], v[172:175], v[124:127]
    v_mfma_f32_16x16x32_bf16 v[116:119], v[148:151], v[160:163], v[116:119]
    v_mfma_f32_16x16x32_bf16 v[120:123], v[148:151], v[164:167], v[120:123]
    v_mfma_f32_16x16x32_bf16 v[124:127], v[148:151], v[168:171], v[124:127]
    s_bfe_u32 s13, s30, 28 + (4 << 16)
    s_lshl_b32 s13, s13, 7
    buffer_load_dwordx4 v[40:43], v12, s[80:83], s13 offen offset:0
    v_mfma_f32_16x16x32_bf16 v[120:123], v[152:155], v[160:163], v[120:123]
    v_mfma_f32_16x16x32_bf16 v[124:127], v[152:155], v[164:167], v[124:127]
    v_mfma_f32_16x16x32_bf16 v[124:127], v[156:159], v[160:163], v[124:127]
    s_waitcnt lgkmcnt(0)
    v_mfma_f32_16x16x32_bf16 v[96:99], v[192:195], v[224:227], v[96:99]
    ds_read2_b32 v[128:129], v28 offset0:32 offset1:33
    v_mfma_f32_16x16x32_bf16 v[100:103], v[192:195], v[228:231], v[100:103]
    ds_read2_b32 v[130:131], v28 offset0:34 offset1:35
    v_mfma_f32_16x16x32_bf16 v[104:107], v[192:195], v[232:235], v[104:107]
    ds_read_b128 v[160:163], v32 offset:3712
    v_mfma_f32_16x16x32_bf16 v[108:111], v[192:195], v[236:239], v[108:111]
    ds_read2_b32 v[132:133], v28 offset0:160 offset1:161
    v_mfma_f32_16x16x32_bf16 v[112:115], v[192:195], v[240:243], v[112:115]
    ds_read2_b32 v[134:135], v28 offset0:162 offset1:163
    buffer_load_dwordx4 v[44:47], v13, s[80:83], s13 offen offset:1024
    v_mfma_f32_16x16x32_bf16 v[116:119], v[192:195], v[244:247], v[116:119]
    ds_read_b128 v[164:167], v32 offset:3200
    v_mfma_f32_16x16x32_bf16 v[120:123], v[192:195], v[248:251], v[120:123]
    ds_read2_b32 v[136:137], v29 offset0:32 offset1:33
    v_mfma_f32_16x16x32_bf16 v[124:127], v[192:195], v[252:255], v[124:127]
    ds_read2_b32 v[138:139], v29 offset0:34 offset1:35
    v_mfma_f32_16x16x32_bf16 v[100:103], v[196:199], v[224:227], v[100:103]
    ds_read_b128 v[168:171], v32 offset:2688
    v_mfma_f32_16x16x32_bf16 v[104:107], v[196:199], v[228:231], v[104:107]
    ds_read2_b32 v[140:141], v29 offset0:160 offset1:161
    v_mfma_f32_16x16x32_bf16 v[108:111], v[196:199], v[232:235], v[108:111]
    ds_read2_b32 v[142:143], v29 offset0:162 offset1:163
    v_mfma_f32_16x16x32_bf16 v[112:115], v[196:199], v[236:239], v[112:115]
    ds_read_b128 v[172:175], v32 offset:2176
    v_mfma_f32_16x16x32_bf16 v[116:119], v[196:199], v[240:243], v[116:119]
    ds_read2_b32 v[144:145], v30 offset0:32 offset1:33
    buffer_load_dwordx4 v[48:51], v12, s[80:83], s13 offen offset:2048
    v_mfma_f32_16x16x32_bf16 v[120:123], v[196:199], v[244:247], v[120:123]
    ds_read2_b32 v[146:147], v30 offset0:34 offset1:35
    v_mfma_f32_16x16x32_bf16 v[124:127], v[196:199], v[248:251], v[124:127]
    ds_read_b128 v[176:179], v32 offset:1664
    v_mfma_f32_16x16x32_bf16 v[104:107], v[200:203], v[224:227], v[104:107]
    ds_read2_b32 v[148:149], v30 offset0:160 offset1:161
    v_mfma_f32_16x16x32_bf16 v[108:111], v[200:203], v[228:231], v[108:111]
    ds_read2_b32 v[150:151], v30 offset0:162 offset1:163
    v_mfma_f32_16x16x32_bf16 v[112:115], v[200:203], v[232:235], v[112:115]
    ds_read_b128 v[180:183], v32 offset:1152
    v_mfma_f32_16x16x32_bf16 v[116:119], v[200:203], v[236:239], v[116:119]
    ds_read2_b32 v[152:153], v31 offset0:32 offset1:33
    v_mfma_f32_16x16x32_bf16 v[120:123], v[200:203], v[240:243], v[120:123]
    ds_read2_b32 v[154:155], v31 offset0:34 offset1:35
    v_mfma_f32_16x16x32_bf16 v[124:127], v[200:203], v[244:247], v[124:127]
    ds_read_b128 v[184:187], v32 offset:640
    buffer_load_dwordx4 v[52:55], v13, s[80:83], s13 offen offset:3072
    v_mfma_f32_16x16x32_bf16 v[108:111], v[204:207], v[224:227], v[108:111]
    ds_read2_b32 v[156:157], v31 offset0:160 offset1:161
    v_mfma_f32_16x16x32_bf16 v[112:115], v[204:207], v[228:231], v[112:115]
    ds_read2_b32 v[158:159], v31 offset0:162 offset1:163
    v_mfma_f32_16x16x32_bf16 v[116:119], v[204:207], v[232:235], v[116:119]
    ds_read_b128 v[188:191], v32 offset:128
    v_mfma_f32_16x16x32_bf16 v[120:123], v[204:207], v[236:239], v[120:123]
    v_mfma_f32_16x16x32_bf16 v[124:127], v[204:207], v[240:243], v[124:127]
    v_mfma_f32_16x16x32_bf16 v[112:115], v[208:211], v[224:227], v[112:115]
    v_mfma_f32_16x16x32_bf16 v[116:119], v[208:211], v[228:231], v[116:119]
    v_mfma_f32_16x16x32_bf16 v[120:123], v[208:211], v[232:235], v[120:123]
    s_bfe_u32 s13, s30, 24 + (4 << 16)
    s_lshl_b32 s13, s13, 7
    buffer_load_dwordx4 v[80:83], v12, s[80:83], s13 offen offset:0
    v_mfma_f32_16x16x32_bf16 v[124:127], v[208:211], v[236:239], v[124:127]
    v_mfma_f32_16x16x32_bf16 v[116:119], v[212:215], v[224:227], v[116:119]
    v_mfma_f32_16x16x32_bf16 v[120:123], v[212:215], v[228:231], v[120:123]
    v_mfma_f32_16x16x32_bf16 v[124:127], v[212:215], v[232:235], v[124:127]
    v_mfma_f32_16x16x32_bf16 v[120:123], v[216:219], v[224:227], v[120:123]
    v_mfma_f32_16x16x32_bf16 v[124:127], v[216:219], v[228:231], v[124:127]
    v_mfma_f32_16x16x32_bf16 v[124:127], v[220:223], v[224:227], v[124:127]
    s_waitcnt lgkmcnt(0)
    v_mfma_f32_16x16x32_bf16 v[96:99], v[128:131], v[160:163], v[96:99]
    ds_read2_b32 v[192:193], v28 offset0:48 offset1:49
    buffer_load_dwordx4 v[84:87], v13, s[80:83], s13 offen offset:1024
    v_mfma_f32_16x16x32_bf16 v[100:103], v[128:131], v[164:167], v[100:103]
    ds_read2_b32 v[194:195], v28 offset0:50 offset1:51
    v_mfma_f32_16x16x32_bf16 v[104:107], v[128:131], v[168:171], v[104:107]
    ds_read_b128 v[224:227], v32 offset:3776
    v_mfma_f32_16x16x32_bf16 v[108:111], v[128:131], v[172:175], v[108:111]
    ds_read2_b32 v[196:197], v28 offset0:176 offset1:177
    v_mfma_f32_16x16x32_bf16 v[112:115], v[128:131], v[176:179], v[112:115]
    ds_read2_b32 v[198:199], v28 offset0:178 offset1:179
    v_mfma_f32_16x16x32_bf16 v[116:119], v[128:131], v[180:183], v[116:119]
    ds_read_b128 v[228:231], v32 offset:3264
    v_mfma_f32_16x16x32_bf16 v[120:123], v[128:131], v[184:187], v[120:123]
    ds_read2_b32 v[200:201], v29 offset0:48 offset1:49
    v_mfma_f32_16x16x32_bf16 v[124:127], v[128:131], v[188:191], v[124:127]
    ds_read2_b32 v[202:203], v29 offset0:50 offset1:51
    v_mfma_f32_16x16x32_bf16 v[100:103], v[132:135], v[160:163], v[100:103]
    ds_read_b128 v[232:235], v32 offset:2752
    buffer_load_dwordx4 v[88:91], v12, s[80:83], s13 offen offset:2048
    v_mfma_f32_16x16x32_bf16 v[104:107], v[132:135], v[164:167], v[104:107]
    ds_read2_b32 v[204:205], v29 offset0:176 offset1:177
    v_mfma_f32_16x16x32_bf16 v[108:111], v[132:135], v[168:171], v[108:111]
    ds_read2_b32 v[206:207], v29 offset0:178 offset1:179
    v_mfma_f32_16x16x32_bf16 v[112:115], v[132:135], v[172:175], v[112:115]
    ds_read_b128 v[236:239], v32 offset:2240
    v_mfma_f32_16x16x32_bf16 v[116:119], v[132:135], v[176:179], v[116:119]
    ds_read2_b32 v[208:209], v30 offset0:48 offset1:49
    v_mfma_f32_16x16x32_bf16 v[120:123], v[132:135], v[180:183], v[120:123]
    ds_read2_b32 v[210:211], v30 offset0:50 offset1:51
    v_mfma_f32_16x16x32_bf16 v[124:127], v[132:135], v[184:187], v[124:127]
    ds_read_b128 v[240:243], v32 offset:1728
    v_mfma_f32_16x16x32_bf16 v[104:107], v[136:139], v[160:163], v[104:107]
    ds_read2_b32 v[212:213], v30 offset0:176 offset1:177
    v_mfma_f32_16x16x32_bf16 v[108:111], v[136:139], v[164:167], v[108:111]
    ds_read2_b32 v[214:215], v30 offset0:178 offset1:179
    buffer_load_dwordx4 v[92:95], v13, s[80:83], s13 offen offset:3072
    v_mfma_f32_16x16x32_bf16 v[112:115], v[136:139], v[168:171], v[112:115]
    ds_read_b128 v[244:247], v32 offset:1216
    v_mfma_f32_16x16x32_bf16 v[116:119], v[136:139], v[172:175], v[116:119]
    ds_read2_b32 v[216:217], v31 offset0:48 offset1:49
    v_mfma_f32_16x16x32_bf16 v[120:123], v[136:139], v[176:179], v[120:123]
    ds_read2_b32 v[218:219], v31 offset0:50 offset1:51
    v_mfma_f32_16x16x32_bf16 v[124:127], v[136:139], v[180:183], v[124:127]
    ds_read_b128 v[248:251], v32 offset:704
    v_mfma_f32_16x16x32_bf16 v[108:111], v[140:143], v[160:163], v[108:111]
    ds_read2_b32 v[220:221], v31 offset0:176 offset1:177
    v_mfma_f32_16x16x32_bf16 v[112:115], v[140:143], v[164:167], v[112:115]
    ds_read2_b32 v[222:223], v31 offset0:178 offset1:179
    v_mfma_f32_16x16x32_bf16 v[116:119], v[140:143], v[168:171], v[116:119]
    ds_read_b128 v[252:255], v32 offset:192
    v_mfma_f32_16x16x32_bf16 v[120:123], v[140:143], v[172:175], v[120:123]
    s_bfe_u32 s13, s30, 20 + (4 << 16)
    s_lshl_b32 s13, s13, 7
    buffer_load_dwordx4 v[64:67], v12, s[80:83], s13 offen offset:0
    v_mfma_f32_16x16x32_bf16 v[124:127], v[140:143], v[176:179], v[124:127]
    v_mfma_f32_16x16x32_bf16 v[112:115], v[144:147], v[160:163], v[112:115]
    v_mfma_f32_16x16x32_bf16 v[116:119], v[144:147], v[164:167], v[116:119]
    v_mfma_f32_16x16x32_bf16 v[120:123], v[144:147], v[168:171], v[120:123]
    v_mfma_f32_16x16x32_bf16 v[124:127], v[144:147], v[172:175], v[124:127]
    v_mfma_f32_16x16x32_bf16 v[116:119], v[148:151], v[160:163], v[116:119]
    s_waitcnt vmcnt(9)
    v_mov_b32 v60, 1
    s_mov_b64 exec, 1
    ds_add_u32 v21, v60 offset:60
    s_mov_b64 exec, -1
    v_mfma_f32_16x16x32_bf16 v[120:123], v[148:151], v[164:167], v[120:123]
    v_mfma_f32_16x16x32_bf16 v[124:127], v[148:151], v[168:171], v[124:127]
    buffer_load_dwordx4 v[68:71], v13, s[80:83], s13 offen offset:1024
    v_mfma_f32_16x16x32_bf16 v[120:123], v[152:155], v[160:163], v[120:123]
    v_mfma_f32_16x16x32_bf16 v[124:127], v[152:155], v[164:167], v[124:127]
    v_mfma_f32_16x16x32_bf16 v[124:127], v[156:159], v[160:163], v[124:127]
    s_waitcnt lgkmcnt(0)
    v_mfma_f32_16x16x32_bf16 v[96:99], v[192:195], v[224:227], v[96:99]
    ds_read2_b32 v[128:129], v28 offset0:64 offset1:65
    v_mfma_f32_16x16x32_bf16 v[100:103], v[192:195], v[228:231], v[100:103]
    ds_read2_b32 v[130:131], v28 offset0:66 offset1:67
    v_mfma_f32_16x16x32_bf16 v[104:107], v[192:195], v[232:235], v[104:107]
    ds_read_b128 v[160:163], v32 offset:3840
    v_mfma_f32_16x16x32_bf16 v[108:111], v[192:195], v[236:239], v[108:111]
    ds_read2_b32 v[132:133], v28 offset0:192 offset1:193
    v_mfma_f32_16x16x32_bf16 v[112:115], v[192:195], v[240:243], v[112:115]
    ds_read2_b32 v[134:135], v28 offset0:194 offset1:195
    buffer_load_dwordx4 v[72:75], v12, s[80:83], s13 offen offset:2048
    v_mfma_f32_16x16x32_bf16 v[116:119], v[192:195], v[244:247], v[116:119]
    ds_read_b128 v[164:167], v32 offset:3328
    v_mfma_f32_16x16x32_bf16 v[120:123], v[192:195], v[248:251], v[120:123]
    ds_read2_b32 v[136:137], v29 offset0:64 offset1:65
    v_mfma_f32_16x16x32_bf16 v[124:127], v[192:195], v[252:255], v[124:127]
    ds_read2_b32 v[138:139], v29 offset0:66 offset1:67
    v_mfma_f32_16x16x32_bf16 v[100:103], v[196:199], v[224:227], v[100:103]
    ds_read_b128 v[168:171], v32 offset:2816
    v_mfma_f32_16x16x32_bf16 v[104:107], v[196:199], v[228:231], v[104:107]
    ds_read2_b32 v[140:141], v29 offset0:192 offset1:193
    v_mfma_f32_16x16x32_bf16 v[108:111], v[196:199], v[232:235], v[108:111]
    ds_read2_b32 v[142:143], v29 offset0:194 offset1:195
    v_mfma_f32_16x16x32_bf16 v[112:115], v[196:199], v[236:239], v[112:115]
    ds_read_b128 v[172:175], v32 offset:2304
    v_mfma_f32_16x16x32_bf16 v[116:119], v[196:199], v[240:243], v[116:119]
    ds_read2_b32 v[144:145], v30 offset0:64 offset1:65
    buffer_load_dwordx4 v[76:79], v13, s[80:83], s13 offen offset:3072
    v_mfma_f32_16x16x32_bf16 v[120:123], v[196:199], v[244:247], v[120:123]
    ds_read2_b32 v[146:147], v30 offset0:66 offset1:67
    v_mfma_f32_16x16x32_bf16 v[124:127], v[196:199], v[248:251], v[124:127]
    ds_read_b128 v[176:179], v32 offset:1792
    v_mfma_f32_16x16x32_bf16 v[104:107], v[200:203], v[224:227], v[104:107]
    ds_read2_b32 v[148:149], v30 offset0:192 offset1:193
    v_mfma_f32_16x16x32_bf16 v[108:111], v[200:203], v[228:231], v[108:111]
    ds_read2_b32 v[150:151], v30 offset0:194 offset1:195
    v_mfma_f32_16x16x32_bf16 v[112:115], v[200:203], v[232:235], v[112:115]
    ds_read_b128 v[180:183], v32 offset:1280
    v_mfma_f32_16x16x32_bf16 v[116:119], v[200:203], v[236:239], v[116:119]
    ds_read2_b32 v[152:153], v31 offset0:64 offset1:65
    v_mfma_f32_16x16x32_bf16 v[120:123], v[200:203], v[240:243], v[120:123]
    ds_read2_b32 v[154:155], v31 offset0:66 offset1:67
    v_mfma_f32_16x16x32_bf16 v[124:127], v[200:203], v[244:247], v[124:127]
    ds_read_b128 v[184:187], v32 offset:768
    v_mfma_f32_16x16x32_bf16 v[108:111], v[204:207], v[224:227], v[108:111]
    ds_read2_b32 v[156:157], v31 offset0:192 offset1:193
    v_mfma_f32_16x16x32_bf16 v[112:115], v[204:207], v[228:231], v[112:115]
    ds_read2_b32 v[158:159], v31 offset0:194 offset1:195
    v_mfma_f32_16x16x32_bf16 v[116:119], v[204:207], v[232:235], v[116:119]
    ds_read_b128 v[188:191], v32 offset:256
    v_mfma_f32_16x16x32_bf16 v[120:123], v[204:207], v[236:239], v[120:123]
    v_mfma_f32_16x16x32_bf16 v[124:127], v[204:207], v[240:243], v[124:127]
    v_mfma_f32_16x16x32_bf16 v[112:115], v[208:211], v[224:227], v[112:115]
    v_mfma_f32_16x16x32_bf16 v[116:119], v[208:211], v[228:231], v[116:119]
    v_mfma_f32_16x16x32_bf16 v[120:123], v[208:211], v[232:235], v[120:123]
    v_mfma_f32_16x16x32_bf16 v[124:127], v[208:211], v[236:239], v[124:127]
    v_mfma_f32_16x16x32_bf16 v[116:119], v[212:215], v[224:227], v[116:119]
    v_mfma_f32_16x16x32_bf16 v[120:123], v[212:215], v[228:231], v[120:123]
    v_mfma_f32_16x16x32_bf16 v[124:127], v[212:215], v[232:235], v[124:127]
    v_mfma_f32_16x16x32_bf16 v[120:123], v[216:219], v[224:227], v[120:123]
    v_mfma_f32_16x16x32_bf16 v[124:127], v[216:219], v[228:231], v[124:127]
    v_mfma_f32_16x16x32_bf16 v[124:127], v[220:223], v[224:227], v[124:127]
    s_waitcnt lgkmcnt(0)
    v_mfma_f32_16x16x32_bf16 v[96:99], v[128:131], v[160:163], v[96:99]
    ds_read2_b32 v[192:193], v28 offset0:80 offset1:81
    v_mfma_f32_16x16x32_bf16 v[100:103], v[128:131], v[164:167], v[100:103]
    ds_read2_b32 v[194:195], v28 offset0:82 offset1:83
    v_mfma_f32_16x16x32_bf16 v[104:107], v[128:131], v[168:171], v[104:107]
    ds_read_b128 v[224:227], v32 offset:3904
    v_mfma_f32_16x16x32_bf16 v[108:111], v[128:131], v[172:175], v[108:111]
    ds_read2_b32 v[196:197], v28 offset0:208 offset1:209
    v_mfma_f32_16x16x32_bf16 v[112:115], v[128:131], v[176:179], v[112:115]
    ds_read2_b32 v[198:199], v28 offset0:210 offset1:211
    v_mfma_f32_16x16x32_bf16 v[116:119], v[128:131], v[180:183], v[116:119]
    ds_read_b128 v[228:231], v32 offset:3392
    v_mfma_f32_16x16x32_bf16 v[120:123], v[128:131], v[184:187], v[120:123]
    ds_read2_b32 v[200:201], v29 offset0:80 offset1:81
    v_mfma_f32_16x16x32_bf16 v[124:127], v[128:131], v[188:191], v[124:127]
    ds_read2_b32 v[202:203], v29 offset0:82 offset1:83
    v_mfma_f32_16x16x32_bf16 v[100:103], v[132:135], v[160:163], v[100:103]
    ds_read_b128 v[232:235], v32 offset:2880
    v_mfma_f32_16x16x32_bf16 v[104:107], v[132:135], v[164:167], v[104:107]
    ds_read2_b32 v[204:205], v29 offset0:208 offset1:209
    v_mfma_f32_16x16x32_bf16 v[108:111], v[132:135], v[168:171], v[108:111]
    ds_read2_b32 v[206:207], v29 offset0:210 offset1:211
    v_mfma_f32_16x16x32_bf16 v[112:115], v[132:135], v[172:175], v[112:115]
    ds_read_b128 v[236:239], v32 offset:2368
    v_mfma_f32_16x16x32_bf16 v[116:119], v[132:135], v[176:179], v[116:119]
    ds_read2_b32 v[208:209], v30 offset0:80 offset1:81
    v_mfma_f32_16x16x32_bf16 v[120:123], v[132:135], v[180:183], v[120:123]
    ds_read2_b32 v[210:211], v30 offset0:82 offset1:83
    v_mfma_f32_16x16x32_bf16 v[124:127], v[132:135], v[184:187], v[124:127]
    ds_read_b128 v[240:243], v32 offset:1856
    v_mfma_f32_16x16x32_bf16 v[104:107], v[136:139], v[160:163], v[104:107]
    ds_read2_b32 v[212:213], v30 offset0:208 offset1:209
    v_mfma_f32_16x16x32_bf16 v[108:111], v[136:139], v[164:167], v[108:111]
    ds_read2_b32 v[214:215], v30 offset0:210 offset1:211
    v_mfma_f32_16x16x32_bf16 v[112:115], v[136:139], v[168:171], v[112:115]
    ds_read_b128 v[244:247], v32 offset:1344
    v_mfma_f32_16x16x32_bf16 v[116:119], v[136:139], v[172:175], v[116:119]
    ds_read2_b32 v[216:217], v31 offset0:80 offset1:81
    v_mfma_f32_16x16x32_bf16 v[120:123], v[136:139], v[176:179], v[120:123]
    ds_read2_b32 v[218:219], v31 offset0:82 offset1:83
    v_mfma_f32_16x16x32_bf16 v[124:127], v[136:139], v[180:183], v[124:127]
    ds_read_b128 v[248:251], v32 offset:832
    v_mfma_f32_16x16x32_bf16 v[108:111], v[140:143], v[160:163], v[108:111]
    ds_read2_b32 v[220:221], v31 offset0:208 offset1:209
    v_mfma_f32_16x16x32_bf16 v[112:115], v[140:143], v[164:167], v[112:115]
    ds_read2_b32 v[222:223], v31 offset0:210 offset1:211
    v_mfma_f32_16x16x32_bf16 v[116:119], v[140:143], v[168:171], v[116:119]
    ds_read_b128 v[252:255], v32 offset:320
    v_mfma_f32_16x16x32_bf16 v[120:123], v[140:143], v[172:175], v[120:123]
    v_mfma_f32_16x16x32_bf16 v[124:127], v[140:143], v[176:179], v[124:127]
    v_mfma_f32_16x16x32_bf16 v[112:115], v[144:147], v[160:163], v[112:115]
    v_mfma_f32_16x16x32_bf16 v[116:119], v[144:147], v[164:167], v[116:119]
    v_mfma_f32_16x16x32_bf16 v[120:123], v[144:147], v[168:171], v[120:123]
    v_mfma_f32_16x16x32_bf16 v[124:127], v[144:147], v[172:175], v[124:127]
    v_mfma_f32_16x16x32_bf16 v[116:119], v[148:151], v[160:163], v[116:119]
    v_mfma_f32_16x16x32_bf16 v[120:123], v[148:151], v[164:167], v[120:123]
    v_mfma_f32_16x16x32_bf16 v[124:127], v[148:151], v[168:171], v[124:127]
    v_mfma_f32_16x16x32_bf16 v[120:123], v[152:155], v[160:163], v[120:123]
    v_mfma_f32_16x16x32_bf16 v[124:127], v[152:155], v[164:167], v[124:127]
    v_mfma_f32_16x16x32_bf16 v[124:127], v[156:159], v[160:163], v[124:127]
    s_waitcnt lgkmcnt(0)
    v_mfma_f32_16x16x32_bf16 v[96:99], v[192:195], v[224:227], v[96:99]
    ds_read2_b32 v[128:129], v28 offset0:96 offset1:97
    v_mfma_f32_16x16x32_bf16 v[100:103], v[192:195], v[228:231], v[100:103]
    ds_read2_b32 v[130:131], v28 offset0:98 offset1:99
    v_mfma_f32_16x16x32_bf16 v[104:107], v[192:195], v[232:235], v[104:107]
    ds_read_b128 v[160:163], v32 offset:3968
    v_mfma_f32_16x16x32_bf16 v[108:111], v[192:195], v[236:239], v[108:111]
    ds_read2_b32 v[132:133], v28 offset0:224 offset1:225
    v_mfma_f32_16x16x32_bf16 v[112:115], v[192:195], v[240:243], v[112:115]
    ds_read2_b32 v[134:135], v28 offset0:226 offset1:227
    v_mfma_f32_16x16x32_bf16 v[116:119], v[192:195], v[244:247], v[116:119]
    ds_read_b128 v[164:167], v32 offset:3456
    v_mfma_f32_16x16x32_bf16 v[120:123], v[192:195], v[248:251], v[120:123]
    ds_read2_b32 v[136:137], v29 offset0:96 offset1:97
    v_mfma_f32_16x16x32_bf16 v[124:127], v[192:195], v[252:255], v[124:127]
    ds_read2_b32 v[138:139], v29 offset0:98 offset1:99
    v_mfma_f32_16x16x32_bf16 v[100:103], v[196:199], v[224:227], v[100:103]
    ds_read_b128 v[168:171], v32 offset:2944
    v_mfma_f32_16x16x32_bf16 v[104:107], v[196:199], v[228:231], v[104:107]
    ds_read2_b32 v[140:141], v29 offset0:224 offset1:225
    v_mfma_f32_16x16x32_bf16 v[108:111], v[196:199], v[232:235], v[108:111]
    ds_read2_b32 v[142:143], v29 offset0:226 offset1:227
    v_mfma_f32_16x16x32_bf16 v[112:115], v[196:199], v[236:239], v[112:115]
    ds_read_b128 v[172:175], v32 offset:2432
    v_mfma_f32_16x16x32_bf16 v[116:119], v[196:199], v[240:243], v[116:119]
    ds_read2_b32 v[144:145], v30 offset0:96 offset1:97
    v_mfma_f32_16x16x32_bf16 v[120:123], v[196:199], v[244:247], v[120:123]
    ds_read2_b32 v[146:147], v30 offset0:98 offset1:99
    v_mfma_f32_16x16x32_bf16 v[124:127], v[196:199], v[248:251], v[124:127]
    ds_read_b128 v[176:179], v32 offset:1920
    v_mfma_f32_16x16x32_bf16 v[104:107], v[200:203], v[224:227], v[104:107]
    ds_read2_b32 v[148:149], v30 offset0:224 offset1:225
    v_mfma_f32_16x16x32_bf16 v[108:111], v[200:203], v[228:231], v[108:111]
    ds_read2_b32 v[150:151], v30 offset0:226 offset1:227
    v_mfma_f32_16x16x32_bf16 v[112:115], v[200:203], v[232:235], v[112:115]
    ds_read_b128 v[180:183], v32 offset:1408
    v_mfma_f32_16x16x32_bf16 v[116:119], v[200:203], v[236:239], v[116:119]
    ds_read2_b32 v[152:153], v31 offset0:96 offset1:97
    v_mfma_f32_16x16x32_bf16 v[120:123], v[200:203], v[240:243], v[120:123]
    ds_read2_b32 v[154:155], v31 offset0:98 offset1:99
    v_mfma_f32_16x16x32_bf16 v[124:127], v[200:203], v[244:247], v[124:127]
    ds_read_b128 v[184:187], v32 offset:896
    v_mfma_f32_16x16x32_bf16 v[108:111], v[204:207], v[224:227], v[108:111]
    ds_read2_b32 v[156:157], v31 offset0:224 offset1:225
    v_mfma_f32_16x16x32_bf16 v[112:115], v[204:207], v[228:231], v[112:115]
    ds_read2_b32 v[158:159], v31 offset0:226 offset1:227
    v_mfma_f32_16x16x32_bf16 v[116:119], v[204:207], v[232:235], v[116:119]
    ds_read_b128 v[188:191], v32 offset:384
    v_mfma_f32_16x16x32_bf16 v[120:123], v[204:207], v[236:239], v[120:123]
    v_mfma_f32_16x16x32_bf16 v[124:127], v[204:207], v[240:243], v[124:127]
    v_mfma_f32_16x16x32_bf16 v[112:115], v[208:211], v[224:227], v[112:115]
    v_mfma_f32_16x16x32_bf16 v[116:119], v[208:211], v[228:231], v[116:119]
    v_mfma_f32_16x16x32_bf16 v[120:123], v[208:211], v[232:235], v[120:123]
    v_mfma_f32_16x16x32_bf16 v[124:127], v[208:211], v[236:239], v[124:127]
    v_mfma_f32_16x16x32_bf16 v[116:119], v[212:215], v[224:227], v[116:119]
    v_mfma_f32_16x16x32_bf16 v[120:123], v[212:215], v[228:231], v[120:123]
    v_mfma_f32_16x16x32_bf16 v[124:127], v[212:215], v[232:235], v[124:127]
    v_mfma_f32_16x16x32_bf16 v[120:123], v[216:219], v[224:227], v[120:123]
    v_mfma_f32_16x16x32_bf16 v[124:127], v[216:219], v[228:231], v[124:127]
    v_mfma_f32_16x16x32_bf16 v[124:127], v[220:223], v[224:227], v[124:127]
    s_waitcnt lgkmcnt(0)
    v_mfma_f32_16x16x32_bf16 v[96:99], v[128:131], v[160:163], v[96:99]
    ds_read2_b32 v[192:193], v28 offset0:112 offset1:113
    v_mfma_f32_16x16x32_bf16 v[100:103], v[128:131], v[164:167], v[100:103]
    ds_read2_b32 v[194:195], v28 offset0:114 offset1:115
    v_mfma_f32_16x16x32_bf16 v[104:107], v[128:131], v[168:171], v[104:107]
    ds_read_b128 v[224:227], v32 offset:4032
    v_mfma_f32_16x16x32_bf16 v[108:111], v[128:131], v[172:175], v[108:111]
    ds_read2_b32 v[196:197], v28 offset0:240 offset1:241
    v_mfma_f32_16x16x32_bf16 v[112:115], v[128:131], v[176:179], v[112:115]
    ds_read2_b32 v[198:199], v28 offset0:242 offset1:243
    v_mfma_f32_16x16x32_bf16 v[116:119], v[128:131], v[180:183], v[116:119]
    ds_read_b128 v[228:231], v32 offset:3520
    v_mfma_f32_16x16x32_bf16 v[120:123], v[128:131], v[184:187], v[120:123]
    ds_read2_b32 v[200:201], v29 offset0:112 offset1:113
    v_mfma_f32_16x16x32_bf16 v[124:127], v[128:131], v[188:191], v[124:127]
    ds_read2_b32 v[202:203], v29 offset0:114 offset1:115
    v_mfma_f32_16x16x32_bf16 v[100:103], v[132:135], v[160:163], v[100:103]
    ds_read_b128 v[232:235], v32 offset:3008
    v_mfma_f32_16x16x32_bf16 v[104:107], v[132:135], v[164:167], v[104:107]
    ds_read2_b32 v[204:205], v29 offset0:240 offset1:241
    v_mfma_f32_16x16x32_bf16 v[108:111], v[132:135], v[168:171], v[108:111]
    ds_read2_b32 v[206:207], v29 offset0:242 offset1:243
    v_mfma_f32_16x16x32_bf16 v[112:115], v[132:135], v[172:175], v[112:115]
    ds_read_b128 v[236:239], v32 offset:2496
    v_mfma_f32_16x16x32_bf16 v[116:119], v[132:135], v[176:179], v[116:119]
    ds_read2_b32 v[208:209], v30 offset0:112 offset1:113
    v_mfma_f32_16x16x32_bf16 v[120:123], v[132:135], v[180:183], v[120:123]
    ds_read2_b32 v[210:211], v30 offset0:114 offset1:115
    v_mfma_f32_16x16x32_bf16 v[124:127], v[132:135], v[184:187], v[124:127]
    ds_read_b128 v[240:243], v32 offset:1984
    v_mfma_f32_16x16x32_bf16 v[104:107], v[136:139], v[160:163], v[104:107]
    ds_read2_b32 v[212:213], v30 offset0:240 offset1:241
    v_mfma_f32_16x16x32_bf16 v[108:111], v[136:139], v[164:167], v[108:111]
    ds_read2_b32 v[214:215], v30 offset0:242 offset1:243
    v_mfma_f32_16x16x32_bf16 v[112:115], v[136:139], v[168:171], v[112:115]
    ds_read_b128 v[244:247], v32 offset:1472
    v_mfma_f32_16x16x32_bf16 v[116:119], v[136:139], v[172:175], v[116:119]
    ds_read2_b32 v[216:217], v31 offset0:112 offset1:113
    v_mfma_f32_16x16x32_bf16 v[120:123], v[136:139], v[176:179], v[120:123]
    ds_read2_b32 v[218:219], v31 offset0:114 offset1:115
    v_mfma_f32_16x16x32_bf16 v[124:127], v[136:139], v[180:183], v[124:127]
    ds_read_b128 v[248:251], v32 offset:960
    v_mfma_f32_16x16x32_bf16 v[108:111], v[140:143], v[160:163], v[108:111]
    ds_read2_b32 v[220:221], v31 offset0:240 offset1:241
    v_mfma_f32_16x16x32_bf16 v[112:115], v[140:143], v[164:167], v[112:115]
    ds_read2_b32 v[222:223], v31 offset0:242 offset1:243
    v_mfma_f32_16x16x32_bf16 v[116:119], v[140:143], v[168:171], v[116:119]
    ds_read_b128 v[252:255], v32 offset:448
    v_mfma_f32_16x16x32_bf16 v[120:123], v[140:143], v[172:175], v[120:123]
    v_mfma_f32_16x16x32_bf16 v[124:127], v[140:143], v[176:179], v[124:127]
    v_mfma_f32_16x16x32_bf16 v[112:115], v[144:147], v[160:163], v[112:115]
    v_mfma_f32_16x16x32_bf16 v[116:119], v[144:147], v[164:167], v[116:119]
    v_mfma_f32_16x16x32_bf16 v[120:123], v[144:147], v[168:171], v[120:123]
    v_mfma_f32_16x16x32_bf16 v[124:127], v[144:147], v[172:175], v[124:127]
    v_mfma_f32_16x16x32_bf16 v[116:119], v[148:151], v[160:163], v[116:119]
    v_mfma_f32_16x16x32_bf16 v[120:123], v[148:151], v[164:167], v[120:123]
    v_mfma_f32_16x16x32_bf16 v[124:127], v[148:151], v[168:171], v[124:127]
    v_mfma_f32_16x16x32_bf16 v[120:123], v[152:155], v[160:163], v[120:123]
    v_mfma_f32_16x16x32_bf16 v[124:127], v[152:155], v[164:167], v[124:127]
    v_mfma_f32_16x16x32_bf16 v[124:127], v[156:159], v[160:163], v[124:127]
    s_waitcnt lgkmcnt(0)
    v_mfma_f32_16x16x32_bf16 v[96:99], v[192:195], v[224:227], v[96:99]
    v_mfma_f32_16x16x32_bf16 v[100:103], v[192:195], v[228:231], v[100:103]
    v_mfma_f32_16x16x32_bf16 v[104:107], v[192:195], v[232:235], v[104:107]
    v_mfma_f32_16x16x32_bf16 v[108:111], v[192:195], v[236:239], v[108:111]
    v_mfma_f32_16x16x32_bf16 v[112:115], v[192:195], v[240:243], v[112:115]
    v_mfma_f32_16x16x32_bf16 v[116:119], v[192:195], v[244:247], v[116:119]
    v_mfma_f32_16x16x32_bf16 v[120:123], v[192:195], v[248:251], v[120:123]
    v_mfma_f32_16x16x32_bf16 v[124:127], v[192:195], v[252:255], v[124:127]
    v_mfma_f32_16x16x32_bf16 v[100:103], v[196:199], v[224:227], v[100:103]
    v_mfma_f32_16x16x32_bf16 v[104:107], v[196:199], v[228:231], v[104:107]
    v_mfma_f32_16x16x32_bf16 v[108:111], v[196:199], v[232:235], v[108:111]
    v_mfma_f32_16x16x32_bf16 v[112:115], v[196:199], v[236:239], v[112:115]
    v_mfma_f32_16x16x32_bf16 v[116:119], v[196:199], v[240:243], v[116:119]
    v_mfma_f32_16x16x32_bf16 v[120:123], v[196:199], v[244:247], v[120:123]
    v_mfma_f32_16x16x32_bf16 v[124:127], v[196:199], v[248:251], v[124:127]
    v_mfma_f32_16x16x32_bf16 v[104:107], v[200:203], v[224:227], v[104:107]
    v_mfma_f32_16x16x32_bf16 v[108:111], v[200:203], v[228:231], v[108:111]
    v_mfma_f32_16x16x32_bf16 v[112:115], v[200:203], v[232:235], v[112:115]
    v_mfma_f32_16x16x32_bf16 v[116:119], v[200:203], v[236:239], v[116:119]
    v_mfma_f32_16x16x32_bf16 v[120:123], v[200:203], v[240:243], v[120:123]
    v_mfma_f32_16x16x32_bf16 v[124:127], v[200:203], v[244:247], v[124:127]
    v_mfma_f32_16x16x32_bf16 v[108:111], v[204:207], v[224:227], v[108:111]
    v_mfma_f32_16x16x32_bf16 v[112:115], v[204:207], v[228:231], v[112:115]
    v_mfma_f32_16x16x32_bf16 v[116:119], v[204:207], v[232:235], v[116:119]
    v_mfma_f32_16x16x32_bf16 v[120:123], v[204:207], v[236:239], v[120:123]
    v_mfma_f32_16x16x32_bf16 v[124:127], v[204:207], v[240:243], v[124:127]
    v_mfma_f32_16x16x32_bf16 v[112:115], v[208:211], v[224:227], v[112:115]
    v_mfma_f32_16x16x32_bf16 v[116:119], v[208:211], v[228:231], v[116:119]
    v_mfma_f32_16x16x32_bf16 v[120:123], v[208:211], v[232:235], v[120:123]
    v_mfma_f32_16x16x32_bf16 v[124:127], v[208:211], v[236:239], v[124:127]
    v_mfma_f32_16x16x32_bf16 v[116:119], v[212:215], v[224:227], v[116:119]
    v_mfma_f32_16x16x32_bf16 v[120:123], v[212:215], v[228:231], v[120:123]
    v_mfma_f32_16x16x32_bf16 v[124:127], v[212:215], v[232:235], v[124:127]
    v_mfma_f32_16x16x32_bf16 v[120:123], v[216:219], v[224:227], v[120:123]
    v_mfma_f32_16x16x32_bf16 v[124:127], v[216:219], v[228:231], v[124:127]
    v_mfma_f32_16x16x32_bf16 v[124:127], v[220:223], v[224:227], v[124:127]
    s_setprio 0
    v_cvt_pk_bf16_f32 v192, v96, v97
    v_cvt_pk_bf16_f32 v193, v98, v99
    v_cvt_pk_bf16_f32 v194, v100, v101
    v_cvt_pk_bf16_f32 v195, v102, v103
    v_cvt_pk_bf16_f32 v196, v104, v105
    v_cvt_pk_bf16_f32 v197, v106, v107
    v_cvt_pk_bf16_f32 v198, v108, v109
    v_cvt_pk_bf16_f32 v199, v110, v111
    v_cvt_pk_bf16_f32 v200, v112, v113
    v_cvt_pk_bf16_f32 v201, v114, v115
    v_cvt_pk_bf16_f32 v202, v116, v117
    v_cvt_pk_bf16_f32 v203, v118, v119
    v_cvt_pk_bf16_f32 v204, v120, v121
    v_cvt_pk_bf16_f32 v205, v122, v123
    v_cvt_pk_bf16_f32 v206, v124, v125
    v_cvt_pk_bf16_f32 v207, v126, v127
    v_permlane16_swap_b32 v192, v194
    v_permlane16_swap_b32 v193, v195
    v_permlane16_swap_b32 v196, v198
    v_permlane16_swap_b32 v197, v199
    v_permlane16_swap_b32 v200, v202
    v_permlane16_swap_b32 v201, v203
    v_permlane16_swap_b32 v204, v206
    v_permlane16_swap_b32 v205, v207
    ds_bpermute_b32 v192, v17, v192
    ds_bpermute_b32 v193, v17, v193
    ds_bpermute_b32 v194, v17, v194
    ds_bpermute_b32 v195, v17, v195
    ds_bpermute_b32 v196, v17, v196
    ds_bpermute_b32 v197, v17, v197
    ds_bpermute_b32 v198, v17, v198
    ds_bpermute_b32 v199, v17, v199
    ds_bpermute_b32 v200, v17, v200
    ds_bpermute_b32 v201, v17, v201
    ds_bpermute_b32 v202, v17, v202
    ds_bpermute_b32 v203, v17, v203
    ds_bpermute_b32 v204, v17, v204
    ds_bpermute_b32 v205, v17, v205
    ds_bpermute_b32 v206, v17, v206
    ds_bpermute_b32 v207, v17, v207
    ds_read_b32 v60, v21 offset:72
    s_waitcnt lgkmcnt(0)
    v_cmp_eq_u32 vcc, 1, v60
    s_cbranch_vccnz L_zp
    s_mov_b32 s13, 0
    buffer_store_dwordx4 v[192:195], v26, s[56:59], s36 offen offset:0 sc1
    buffer_store_dwordx4 v[196:199], v26, s[56:59], s36 offen offset:1024 sc1
    buffer_store_dwordx4 v[200:203], v26, s[56:59], s36 offen offset:2048 sc1
    buffer_store_dwordx4 v[204:207], v26, s[56:59], s36 offen offset:3072 sc1
    s_branch L_zq
L_zp:
    s_mov_b32 s13, 1
    buffer_store_dwordx4 v[192:195], v26, s[56:59], s36 offen offset:0
    buffer_store_dwordx4 v[196:199], v26, s[56:59], s36 offen offset:1024
    buffer_store_dwordx4 v[200:203], v26, s[56:59], s36 offen offset:2048
    buffer_store_dwordx4 v[204:207], v26, s[56:59], s36 offen offset:3072
L_zq:
    v_add_u32 v33, s101, v26
    s_waitcnt vmcnt(4)
    ds_write_b128 v33, v[64:67] offset:0
    ds_write_b128 v33, v[68:71] offset:1024
    ds_write_b128 v33, v[72:75] offset:2048
    ds_write_b128 v33, v[76:79] offset:3072
    ds_write_b128 v33, v[80:83] offset:4096
    ds_write_b128 v33, v[84:87] offset:5120
    ds_write_b128 v33, v[88:91] offset:6144
    ds_write_b128 v33, v[92:95] offset:7168
    ds_write_b128 v33, v[40:43] offset:8192
    ds_write_b128 v33, v[44:47] offset:9216
    ds_write_b128 v33, v[48:51] offset:10240
    ds_write_b128 v33, v[52:55] offset:11264
    v_mov_b32 v60, 1
    s_mov_b64 exec, 1
    ds_add_u32 v21, v60 offset:68
    s_mov_b64 exec, -1
    s_lshl_b32 s12, s100, 3
    s_add_u32 s12, s12, 8192
    v_lshlrev_b32 v28, 1, v23
    v_lshl_add_u32 v28, v24, 12, v28
    v_lshlrev_b32 v29, 2, v24
    v_lshl_add_u32 v29, v23, 13, v29
    v_lshrrev_b32 v60, 3, v2
    v_and_b32 v61, 7, v2
    v_lshl_add_u32 v28, v60, 2, s35
    v_lshlrev_b32 v28, 12, v28
    v_lshl_add_u32 v28, v61, 4, v28
    s_lshl_b32 s10, s5, 7
    v_add_u32 v28, s10, v28
    v_lshl_add_u32 v30, v61, 3, v60
    v_lshlrev_b32 v30, 2, v30
    s_waitcnt vmcnt(0)
    s_mov_b64 exec, 1
    s_cmp_eq_u32 s13, 1
    s_cbranch_scc0 L_xf2
    buffer_store_dwordx2 v[0:1], v19, s[72:75], s12 offen
    s_branch L_xf3
L_xf2:
    buffer_store_dwordx2 v[0:1], v19, s[72:75], s12 offen sc1
L_xf3:
    s_mov_b64 exec, -1
    s_mov_b32 s15, 0
L_zw_w:
    ds_read_b128 v[60:63], v21 offset:0
    s_waitcnt lgkmcnt(0)
    v_min3_u32 v60, v60, v61, v62
    v_min_u32 v60, v60, v63
    v_cmp_gt_u32 vcc, 24, v60
    s_cbranch_vccz L_zw_ok
    s_sleep 4
    s_add_u32 s15, s15, 1
    s_cmp_lt_u32 s15, 160000
    s_cbranch_scc1 L_zw_w
L_zw_ok:
    s_cmp_eq_u32 s8, 0
    s_cbranch_scc0 L_z1
    s_mov_b32 s15, 0
LZ_poll:
    buffer_load_dwordx4 v[60:63], v3, s[72:75], 0 offen sc1
    s_waitcnt vmcnt(0)
LZ_chk:
    v_cmp_ne_u64 vcc, v[60:61], v[0:1]
    v_cmp_ne_u64 s[10:11], v[62:63], v[0:1]
    s_or_b64 vcc, vcc, s[10:11]
    s_cbranch_scc0 LZ_ok
    s_sleep 4
    s_add_u32 s15, s15, 1
    s_cmp_lt_u32 s15, 20000
    s_cbranch_scc1 LZ_poll
LZ_ok:
    ds_write_b32 v21, v25 offset:48
L_z1:
    s_waitcnt vmcnt(0)
    v_lshlrev_b32 v128, 16, v4
    v_and_b32 v129, 0xffff0000, v4
    v_lshlrev_b32 v130, 16, v5
    v_and_b32 v131, 0xffff0000, v5
    v_lshlrev_b32 v132, 16, v6
    v_and_b32 v133, 0xffff0000, v6
    v_lshlrev_b32 v134, 16, v7
    v_and_b32 v135, 0xffff0000, v7
    v_lshlrev_b32 v136, 16, v8
    v_and_b32 v137, 0xffff0000, v8
    v_lshlrev_b32 v138, 16, v9
    v_and_b32 v139, 0xffff0000, v9
    v_lshlrev_b32 v140, 16, v10
    v_and_b32 v141, 0xffff0000, v10
    v_lshlrev_b32 v142, 16, v11
    v_and_b32 v143, 0xffff0000, v11
    v_lshlrev_b32 v144, 16, v14
    v_and_b32 v145, 0xffff0000, v14
    v_lshlrev_b32 v146, 16, v15
    v_and_b32 v147, 0xffff0000, v15
    v_lshlrev_b32 v148, 16, v56
    v_and_b32 v149, 0xffff0000, v56
    v_lshlrev_b32 v150, 16, v57
    v_and_b32 v151, 0xffff0000, v57
    v_lshlrev_b32 v152, 16, v58
    v_and_b32 v153, 0xffff0000, v58
    v_lshlrev_b32 v154, 16, v59
    v_and_b32 v155, 0xffff0000, v59
    v_lshlrev_b32 v156, 16, v34
    v_and_b32 v157, 0xffff0000, v34
    v_lshlrev_b32 v158, 16, v35
    v_and_b32 v159, 0xffff0000, v35
    s_mov_b32 s15, 0
L_fz_w:
    ds_read_b32 v60, v21 offset:48
    s_waitcnt lgkmcnt(0)
    v_cmp_gt_u32 vcc, 1, v60
    s_cbranch_vccz L_fz_ok
    s_sleep 1
    s_add_u32 s15, s15, 1
    s_cmp_lt_u32 s15, 160000
    s_cbranch_scc1 L_fz_w
L_fz_ok:
    buffer_load_dwordx4 v[64:67], v28, s[56:59], 0 offen sc1
    buffer_load_dwordx4 v[68:71], v28, s[56:59], s32 offen sc1
    buffer_load_dwordx4 v[72:75], v28, s[56:59], s33 offen sc1
    buffer_load_dwordx4 v[76:79], v28, s[56:59], s34 offen sc1
    s_waitcnt vmcnt(3)
    ds_bpermute_b32 v64, v30, v64
    ds_bpermute_b32 v65, v30, v65
    ds_bpermute_b32 v66, v30, v66
    ds_bpermute_b32 v67, v30, v67
    s_waitcnt vmcnt(2)
    ds_bpermute_b32 v68, v30, v68
    ds_bpermute_b32 v69, v30, v69
    ds_bpermute_b32 v70, v30, v70
    ds_bpermute_b32 v71, v30, v71
    s_waitcnt vmcnt(1)
    ds_bpermute_b32 v72, v30, v72
    ds_bpermute_b32 v73, v30, v73
    ds_bpermute_b32 v74, v30, v74
    ds_bpermute_b32 v75, v30, v75
    s_waitcnt vmcnt(0)
    ds_bpermute_b32 v76, v30, v76
    ds_bpermute_b32 v77, v30, v77
    ds_bpermute_b32 v78, v30, v78
    ds_bpermute_b32 v79, v30, v79
    s_waitcnt lgkmcnt(0)
    s_waitcnt vmcnt(0)
    v_lshlrev_b32 v160, 16, v64
    v_lshlrev_b32 v161, 16, v68
    v_lshlrev_b32 v162, 16, v72
    v_lshlrev_b32 v163, 16, v76
    v_mul_f32 v160, v160, v128
    v_mul_f32 v161, v161, v129
    v_mul_f32 v162, v162, v130
    v_mul_f32 v163, v163, v131
    s_mov_b32 s10, 0
    buffer_store_dwordx4 v[160:163], v29, s[64:67], s10 offen nt
    v_and_b32 v164, 0xffff0000, v64
    v_and_b32 v165, 0xffff0000, v68
    v_and_b32 v166, 0xffff0000, v72
    v_and_b32 v167, 0xffff0000, v76
    v_mul_f32 v164, v164, v132
    v_mul_f32 v165, v165, v133
    v_mul_f32 v166, v166, v134
    v_mul_f32 v167, v167, v135
    s_mov_b32 s10, 8192
    buffer_store_dwordx4 v[164:167], v29, s[64:67], s10 offen nt
    v_lshlrev_b32 v168, 16, v65
    v_lshlrev_b32 v169, 16, v69
    v_lshlrev_b32 v170, 16, v73
    v_lshlrev_b32 v171, 16, v77
    v_mul_f32 v168, v168, v136
    v_mul_f32 v169, v169, v137
    v_mul_f32 v170, v170, v138
    v_mul_f32 v171, v171, v139
    s_mov_b32 s10, 16384
    buffer_store_dwordx4 v[168:171], v29, s[64:67], s10 offen nt
    v_and_b32 v172, 0xffff0000, v65
    v_and_b32 v173, 0xffff0000, v69
    v_and_b32 v174, 0xffff0000, v73
    v_and_b32 v175, 0xffff0000, v77
    v_mul_f32 v172, v172, v140
    v_mul_f32 v173, v173, v141
    v_mul_f32 v174, v174, v142
    v_mul_f32 v175, v175, v143
    s_mov_b32 s10, 24576
    buffer_store_dwordx4 v[172:175], v29, s[64:67], s10 offen nt
    v_lshlrev_b32 v176, 16, v66
    v_lshlrev_b32 v177, 16, v70
    v_lshlrev_b32 v178, 16, v74
    v_lshlrev_b32 v179, 16, v78
    v_mul_f32 v176, v176, v144
    v_mul_f32 v177, v177, v145
    v_mul_f32 v178, v178, v146
    v_mul_f32 v179, v179, v147
    s_mov_b32 s10, 32768
    buffer_store_dwordx4 v[176:179], v29, s[64:67], s10 offen nt
    v_and_b32 v180, 0xffff0000, v66
    v_and_b32 v181, 0xffff0000, v70
    v_and_b32 v182, 0xffff0000, v74
    v_and_b32 v183, 0xffff0000, v78
    v_mul_f32 v180, v180, v148
    v_mul_f32 v181, v181, v149
    v_mul_f32 v182, v182, v150
    v_mul_f32 v183, v183, v151
    s_mov_b32 s10, 40960
    buffer_store_dwordx4 v[180:183], v29, s[64:67], s10 offen nt
    v_lshlrev_b32 v184, 16, v67
    v_lshlrev_b32 v185, 16, v71
    v_lshlrev_b32 v186, 16, v75
    v_lshlrev_b32 v187, 16, v79
    v_mul_f32 v184, v184, v152
    v_mul_f32 v185, v185, v153
    v_mul_f32 v186, v186, v154
    v_mul_f32 v187, v187, v155
    s_mov_b32 s10, 49152
    buffer_store_dwordx4 v[184:187], v29, s[64:67], s10 offen nt
    v_and_b32 v188, 0xffff0000, v67
    v_and_b32 v189, 0xffff0000, v71
    v_and_b32 v190, 0xffff0000, v75
    v_and_b32 v191, 0xffff0000, v79
    v_mul_f32 v188, v188, v156
    v_mul_f32 v189, v189, v157
    v_mul_f32 v190, v190, v158
    v_mul_f32 v191, v191, v159
    s_mov_b32 s10, 57344
    buffer_store_dwordx4 v[188:191], v29, s[64:67], s10 offen nt
    s_endpgm
Y_G:
    s_and_b32 s68, s4, 6
    s_add_u32 s69, s5, s68
    s_lshl_b32 s69, s69, 1
    s_and_b32 s68, s4, 1
    s_add_u32 s69, s69, s68
    s_and_b32 s69, s69, 15
    s_mov_b32 s100, 0x76543210
    s_mov_b32 s101, 0xfedcba98
    s_lshl_b32 s68, s69, 2
    s_lshr_b64 s[64:65], s[100:101], s68
    s_sub_u32 s68, 64, s68
    s_lshl_b64 s[100:101], s[100:101], s68
    s_or_b64 s[100:101], s[100:101], s[64:65]
    s_sub_u32 s68, s7, s69
    s_and_b32 s68, s68, 15
    s_lshl_b32 s68, s68, 2
    s_bfm_b64 s[64:65], s68, 0
    s_and_b64 s[66:67], s[100:101], s[64:65]
    s_lshl_b64 s[66:67], s[66:67], 4
    s_lshl_b64 s[64:65], s[64:65], 4
    s_or_b32 s64, s64, 15
    s_andn2_b64 s[100:101], s[100:101], s[64:65]
    s_or_b64 s[100:101], s[100:101], s[66:67]
    s_or_b32 s100, s100, s7
    s_setprio 0
    v_and_b32 v3, 31, v2
    v_mov_b32 v23, 0
    v_mov_b32 v11, 163712
    v_lshrrev_b32 v4, 5, v2
    s_lshr_b32 s8, s3, 1
    s_and_b32 s9, s3, 1
    s_lshl_b32 s10, s7, 6
    s_lshl_b32 s11, s9, 5
    s_add_u32 s10, s10, s11
    v_add_u32 v5, s10, v3
    v_lshlrev_b32 v48, 1, v5
    s_lshl_b32 s10, s7, 7
    v_and_b32 v49, 15, v2
    v_lshl_add_u32 v49, v49, 3, s10
    s_lshl_b32 s10, s3, 2
    s_add_u32 s10, s10, 163712
    v_mov_b32 v10, s10
    s_waitcnt lgkmcnt(0)
    s_mov_b32 s76, s48
    s_mov_b32 s77, s49
    s_mov_b32 s78, 256
    s_mov_b32 s79, 0x00020000
    s_or_b32 s10, s2, s3
    s_cmp_eq_u32 s10, 0
    s_cbranch_scc0 G_nononce
    s_memrealtime s[10:11]
    s_waitcnt lgkmcnt(0)
    s_or_b32 s10, s10, 1
    v_mov_b32 v54, s10
    v_mov_b32 v55, s11
    s_mov_b64 exec, 1
    buffer_store_dwordx2 v[54:55], v23, s[76:79], 0 offen sc1
    s_mov_b64 exec, -1
G_nononce:
    s_mov_b32 s52, s42
    s_mov_b32 s53, s43
    s_mov_b32 s54, 2048
    s_mov_b32 s55, 0x00020000
    buffer_load_ushort v12, v48, s[52:55], 0 offen
    s_mov_b32 s52, s30
    s_mov_b32 s53, s31
    buffer_load_ushort v13, v48, s[52:55], 0 offen
    s_mov_b32 s52, s32
    s_mov_b32 s53, s33
    buffer_load_ushort v14, v48, s[52:55], 0 offen
    s_mov_b32 s52, s44
    s_mov_b32 s53, s45
    buffer_load_dwordx2 v[24:25], v49, s[52:55], 0 offen
    s_mov_b32 s52, s28
    s_mov_b32 s53, s29
    s_mov_b32 s54, 4194304
    s_mov_b32 s55, 0x00020000
    s_mov_b32 s60, s46
    s_mov_b32 s61, s47
    s_mov_b32 s62, 16777216
    s_mov_b32 s63, 0x00020000
    s_add_u32 s64, s50, 16777216
    s_addc_u32 s65, s51, 0
    s_mov_b32 s66, 278528
    s_mov_b32 s67, 0x00020000
    s_add_u32 s68, s50, 8388608
    s_addc_u32 s69, s51, 0
    s_mov_b32 s70, 8388608
    s_mov_b32 s71, 0x00020000
    s_add_u32 s72, s50, 17825792
    s_addc_u32 s73, s51, 0
    s_mov_b32 s74, 65536
    s_mov_b32 s75, 0x00020000
    s_cmp_eq_u32 s9, 1
    s_cselect_b32 s80, s40, s38
    s_cselect_b32 s81, s41, s39
    s_mov_b32 s82, 2097152
    s_mov_b32 s83, 0x00020000
    s_lshl_b32 s10, s6, 7
    s_lshl_b32 s11, s3, 5
    s_add_u32 s10, s10, s11
    v_lshrrev_b32 v50, 4, v2
    v_lshl_add_u32 v50, v50, 2, s10
    v_lshl_add_u32 v22, v50, 11, v49
    v_xor_b32 v50, 1, v4
    v_lshlrev_b32 v50, 14, v50
    v_lshl_add_u32 v53, v5, 4, v50
    v_lshlrev_b32 v26, 4, v2
    v_add_u32 v27, 4096, v26
    v_lshrrev_b32 v50, 1, v3
    v_and_b32 v50, 7, v50
    v_xor_b32 v50, v50, v4
    v_lshlrev_b32 v50, 4, v50
    v_lshl_add_u32 v50, v3, 7, v50
    s_lshl_b32 s10, s8, 13
    s_lshl_b32 s11, s9, 13
    s_add_u32 s11, s11, 16384
    v_add_u32 v32, s10, v50
    v_add_u32 v36, s11, v50
    v_xor_b32 v33, 32, v32
    v_xor_b32 v37, 32, v36
    v_xor_b32 v34, 64, v32
    v_xor_b32 v38, 64, v36
    v_xor_b32 v35, 96, v32
    v_xor_b32 v39, 96, v36
    v_add_u32 v40, 65536, v32
    v_add_u32 v41, 65536, v33
    v_add_u32 v42, 65536, v34
    v_add_u32 v43, 65536, v35
    v_add_u32 v44, 65536, v36
    v_add_u32 v45, 65536, v37
    v_add_u32 v46, 65536, v38
    v_add_u32 v47, 65536, v39
    v_mov_b32 v64, 0
    v_mov_b32 v65, 0
    v_mov_b32 v66, 0
    v_mov_b32 v67, 0
    v_mov_b32 v68, 0
    v_mov_b32 v69, 0
    v_mov_b32 v70, 0
    v_mov_b32 v71, 0
    v_mov_b32 v72, 0
    v_mov_b32 v73, 0
    v_mov_b32 v74, 0
    v_mov_b32 v75, 0
    v_mov_b32 v76, 0
    v_mov_b32 v77, 0
    v_mov_b32 v78, 0
    v_mov_b32 v79, 0
    v_mov_b32 v80, 0
    v_mov_b32 v81, 0
    v_mov_b32 v82, 0
    v_mov_b32 v83, 0
    v_mov_b32 v84, 0
    v_mov_b32 v85, 0
    v_mov_b32 v86, 0
    v_mov_b32 v87, 0
    v_mov_b32 v88, 0
    v_mov_b32 v89, 0
    v_mov_b32 v90, 0
    v_mov_b32 v91, 0
    v_mov_b32 v92, 0
    v_mov_b32 v93, 0
    v_mov_b32 v94, 0
    v_mov_b32 v95, 0
    v_mov_b32 v96, 0
    v_mov_b32 v97, 0
    v_mov_b32 v98, 0
    v_mov_b32 v99, 0
    v_mov_b32 v100, 0
    v_mov_b32 v101, 0
    v_mov_b32 v102, 0
    v_mov_b32 v103, 0
    v_mov_b32 v104, 0
    v_mov_b32 v105, 0
    v_mov_b32 v106, 0
    v_mov_b32 v107, 0
    v_mov_b32 v108, 0
    v_mov_b32 v109, 0
    v_mov_b32 v110, 0
    v_mov_b32 v111, 0
    v_mov_b32 v112, 0
    v_mov_b32 v113, 0
    v_mov_b32 v114, 0
    v_mov_b32 v115, 0
    v_mov_b32 v116, 0
    v_mov_b32 v117, 0
    v_mov_b32 v118, 0
    v_mov_b32 v119, 0
    v_mov_b32 v120, 0
    v_mov_b32 v121, 0
    v_mov_b32 v122, 0
    v_mov_b32 v123, 0
    v_mov_b32 v124, 0
    v_mov_b32 v125, 0
    v_mov_b32 v126, 0
    v_mov_b32 v127, 0
    s_lshl_b32 s10, s8, 10
    s_lshl_b32 s11, s9, 9
    s_add_u32 s10, s10, s11
    s_add_u32 s10, s10, 151552
    v_lshl_add_u32 v0, v3, 4, s10
    v_xor_b32 v1, 1024, v0
    s_lshl_b32 s10, s8, 1
    s_sub_i32 s10, s6, s10
    v_sub_u32 v56, s10, v4
    v_add_u32 v57, 0, v56
    v_max_i32 v57, 0, v57
    v_lshlrev_b32 v57, 14, v57
    v_lshl_add_u32 v60, v5, 4, v57
    v_add_u32 v57, -4, v56
    v_max_i32 v57, 0, v57
    v_lshlrev_b32 v57, 14, v57
    v_lshl_add_u32 v61, v5, 4, v57
    v_add_u32 v57, -8, v56
    v_max_i32 v57, 0, v57
    v_lshlrev_b32 v57, 14, v57
    v_lshl_add_u32 v62, v5, 4, v57
    v_add_u32 v57, -12, v56
    v_max_i32 v57, 0, v57
    v_lshlrev_b32 v57, 14, v57
    v_lshl_add_u32 v63, v5, 4, v57
    s_mov_b32 s15, 0
G_s0_w:
    ds_read_b64 v[48:49], v11 offset:16
    s_waitcnt lgkmcnt(0)
    v_min_u32 v48, v48, v49
    v_cmp_gt_u32 vcc, 1, v48
    s_cbranch_vccz G_s0_ok
    s_add_u32 s15, s15, 1
    s_cmp_lt_u32 s15, 160000
    s_cbranch_scc1 G_s0_w
G_s0_ok:
    ds_read_b128 v[128:131], v32 offset:0
    ds_read_b128 v[136:139], v36 offset:0
    ds_read_b128 v[140:143], v36 offset:4096
    ds_read_b128 v[132:135], v32 offset:4096
    ds_read_b128 v[144:147], v33 offset:0
    ds_read_b128 v[152:155], v37 offset:0
    ds_read_b128 v[156:159], v37 offset:4096
    ds_read_b128 v[148:151], v33 offset:4096
    ds_read_b128 v[160:163], v34 offset:0
    ds_read_b128 v[168:171], v38 offset:0
    ds_read_b128 v[172:175], v38 offset:4096
    ds_read_b128 v[164:167], v34 offset:4096
    ds_read_b128 v[176:179], v35 offset:0
    ds_read_b128 v[184:187], v39 offset:0
    ds_read_b128 v[188:191], v39 offset:4096
    ds_read_b128 v[180:183], v35 offset:4096
    ds_read_b64 v[48:49], v11 offset:16
    v_mov_b32 v52, 1
    s_mov_b32 s12, 2
    s_waitcnt lgkmcnt(0)
    ds_write_b32 v10, v52
G1_loop:
    v_mfma_f32_32x32x16_bf16 v[64:79], v[128:131], v[136:139], v[64:79]
    s_waitcnt lgkmcnt(0)
    v_min_u32 v48, v48, v49
    v_cmp_gt_u32 vcc, s12, v48
    s_cbranch_vccnz G1_slow0
G1_back0:
    ds_read_b128 v[192:195], v32 offset:32768
    ds_read_b128 v[200:203], v36 offset:32768
    v_mfma_f32_32x32x16_bf16 v[80:95], v[128:131], v[140:143], v[80:95]
    ds_read_b128 v[204:207], v36 offset:36864
    ds_read_b128 v[196:199], v32 offset:36864
    v_mfma_f32_32x32x16_bf16 v[96:111], v[132:135], v[136:139], v[96:111]
    ds_read_b128 v[208:211], v33 offset:32768
    ds_read_b128 v[216:219], v37 offset:32768
    v_mfma_f32_32x32x16_bf16 v[112:127], v[132:135], v[140:143], v[112:127]
    ds_read_b128 v[220:223], v37 offset:36864
    ds_read_b128 v[212:215], v33 offset:36864
    v_mfma_f32_32x32x16_bf16 v[64:79], v[144:147], v[152:155], v[64:79]
    ds_read_b128 v[224:227], v34 offset:32768
    ds_read_b128 v[232:235], v38 offset:32768
    v_mfma_f32_32x32x16_bf16 v[80:95], v[144:147], v[156:159], v[80:95]
    ds_read_b128 v[236:239], v38 offset:36864
    ds_read_b128 v[228:231], v34 offset:36864
    v_mfma_f32_32x32x16_bf16 v[96:111], v[148:151], v[152:155], v[96:111]
    ds_read_b128 v[240:243], v35 offset:32768
    ds_read_b128 v[248:251], v39 offset:32768
    v_mfma_f32_32x32x16_bf16 v[112:127], v[148:151], v[156:159], v[112:127]
    ds_read_b128 v[252:255], v39 offset:36864
    ds_read_b128 v[244:247], v35 offset:36864
    v_mfma_f32_32x32x16_bf16 v[64:79], v[160:163], v[168:171], v[64:79]
    v_mfma_f32_32x32x16_bf16 v[80:95], v[160:163], v[172:175], v[80:95]
    v_mfma_f32_32x32x16_bf16 v[96:111], v[164:167], v[168:171], v[96:111]
    v_mfma_f32_32x32x16_bf16 v[112:127], v[164:167], v[172:175], v[112:127]
    v_mfma_f32_32x32x16_bf16 v[64:79], v[176:179], v[184:187], v[64:79]
    v_mov_b32 v52, s12
    s_waitcnt lgkmcnt(0)
    ds_write_b32 v10, v52
    s_add_u32 s12, s12, 1
    v_mfma_f32_32x32x16_bf16 v[80:95], v[176:179], v[188:191], v[80:95]
    ds_read_b64 v[48:49], v11 offset:16
    v_mfma_f32_32x32x16_bf16 v[96:111], v[180:183], v[184:187], v[96:111]
    v_mfma_f32_32x32x16_bf16 v[112:127], v[180:183], v[188:191], v[112:127]
    v_mfma_f32_32x32x16_bf16 v[64:79], v[192:195], v[200:203], v[64:79]
    s_waitcnt lgkmcnt(0)
    v_min_u32 v48, v48, v49
    v_cmp_gt_u32 vcc, s12, v48
    s_cbranch_vccnz G1_slow1
G1_back1:
    ds_read_b128 v[128:131], v40 offset:0
    ds_read_b128 v[136:139], v44 offset:0
    v_mfma_f32_32x32x16_bf16 v[80:95], v[192:195], v[204:207], v[80:95]
    ds_read_b128 v[140:143], v44 offset:4096
    ds_read_b128 v[132:135], v40 offset:4096
    v_mfma_f32_32x32x16_bf16 v[96:111], v[196:199], v[200:203], v[96:111]
    ds_read_b128 v[144:147], v41 offset:0
    ds_read_b128 v[152:155], v45 offset:0
    v_mfma_f32_32x32x16_bf16 v[112:127], v[196:199], v[204:207], v[112:127]
    ds_read_b128 v[156:159], v45 offset:4096
    ds_read_b128 v[148:151], v41 offset:4096
    v_mfma_f32_32x32x16_bf16 v[64:79], v[208:211], v[216:219], v[64:79]
    ds_read_b128 v[160:163], v42 offset:0
    ds_read_b128 v[168:171], v46 offset:0
    v_mfma_f32_32x32x16_bf16 v[80:95], v[208:211], v[220:223], v[80:95]
    ds_read_b128 v[172:175], v46 offset:4096
    ds_read_b128 v[164:167], v42 offset:4096
    v_mfma_f32_32x32x16_bf16 v[96:111], v[212:215], v[216:219], v[96:111]
    ds_read_b128 v[176:179], v43 offset:0
    ds_read_b128 v[184:187], v47 offset:0
    v_mfma_f32_32x32x16_bf16 v[112:127], v[212:215], v[220:223], v[112:127]
    ds_read_b128 v[188:191], v47 offset:4096
    ds_read_b128 v[180:183], v43 offset:4096
    v_mfma_f32_32x32x16_bf16 v[64:79], v[224:227], v[232:235], v[64:79]
    v_mfma_f32_32x32x16_bf16 v[80:95], v[224:227], v[236:239], v[80:95]
    v_mfma_f32_32x32x16_bf16 v[96:111], v[228:231], v[232:235], v[96:111]
    v_mfma_f32_32x32x16_bf16 v[112:127], v[228:231], v[236:239], v[112:127]
    v_mfma_f32_32x32x16_bf16 v[64:79], v[240:243], v[248:251], v[64:79]
    v_mov_b32 v52, s12
    s_waitcnt lgkmcnt(0)
    ds_write_b32 v10, v52
    s_add_u32 s12, s12, 1
    v_mfma_f32_32x32x16_bf16 v[80:95], v[240:243], v[252:255], v[80:95]
    ds_read_b64 v[48:49], v11 offset:16
    v_mfma_f32_32x32x16_bf16 v[96:111], v[244:247], v[248:251], v[96:111]
    v_mfma_f32_32x32x16_bf16 v[112:127], v[244:247], v[252:255], v[112:127]
    v_mfma_f32_32x32x16_bf16 v[64:79], v[128:131], v[136:139], v[64:79]
    s_waitcnt lgkmcnt(0)
    v_min_u32 v48, v48, v49
    v_cmp_gt_u32 vcc, s12, v48
    s_cbranch_vccnz G1_slow2
G1_back2:
    ds_read_b128 v[192:195], v40 offset:32768
    ds_read_b128 v[200:203], v44 offset:32768
    v_mfma_f32_32x32x16_bf16 v[80:95], v[128:131], v[140:143], v[80:95]
    ds_read_b128 v[204:207], v44 offset:36864
    ds_read_b128 v[196:199], v40 offset:36864
    v_mfma_f32_32x32x16_bf16 v[96:111], v[132:135], v[136:139], v[96:111]
    ds_read_b128 v[208:211], v41 offset:32768
    ds_read_b128 v[216:219], v45 offset:32768
    v_mfma_f32_32x32x16_bf16 v[112:127], v[132:135], v[140:143], v[112:127]
    ds_read_b128 v[220:223], v45 offset:36864
    ds_read_b128 v[212:215], v41 offset:36864
    v_mfma_f32_32x32x16_bf16 v[64:79], v[144:147], v[152:155], v[64:79]
    ds_read_b128 v[224:227], v42 offset:32768
    ds_read_b128 v[232:235], v46 offset:32768
    v_mfma_f32_32x32x16_bf16 v[80:95], v[144:147], v[156:159], v[80:95]
    ds_read_b128 v[236:239], v46 offset:36864
    ds_read_b128 v[228:231], v42 offset:36864
    v_mfma_f32_32x32x16_bf16 v[96:111], v[148:151], v[152:155], v[96:111]
    ds_read_b128 v[240:243], v43 offset:32768
    ds_read_b128 v[248:251], v47 offset:32768
    v_mfma_f32_32x32x16_bf16 v[112:127], v[148:151], v[156:159], v[112:127]
    ds_read_b128 v[252:255], v47 offset:36864
    ds_read_b128 v[244:247], v43 offset:36864
    v_mfma_f32_32x32x16_bf16 v[64:79], v[160:163], v[168:171], v[64:79]
    v_mfma_f32_32x32x16_bf16 v[80:95], v[160:163], v[172:175], v[80:95]
    v_mfma_f32_32x32x16_bf16 v[96:111], v[164:167], v[168:171], v[96:111]
    v_mfma_f32_32x32x16_bf16 v[112:127], v[164:167], v[172:175], v[112:127]
    v_mfma_f32_32x32x16_bf16 v[64:79], v[176:179], v[184:187], v[64:79]
    v_mov_b32 v52, s12
    s_waitcnt lgkmcnt(0)
    ds_write_b32 v10, v52
    s_add_u32 s12, s12, 1
    v_mfma_f32_32x32x16_bf16 v[80:95], v[176:179], v[188:191], v[80:95]
    ds_read_b64 v[48:49], v11 offset:16
    v_mfma_f32_32x32x16_bf16 v[96:111], v[180:183], v[184:187], v[96:111]
    v_mfma_f32_32x32x16_bf16 v[112:127], v[180:183], v[188:191], v[112:127]
    s_cmp_eq_u32 s12, 17
    s_cbranch_scc1 G1_last
    v_mfma_f32_32x32x16_bf16 v[64:79], v[192:195], v[200:203], v[64:79]
    s_waitcnt lgkmcnt(0)
    v_min_u32 v48, v48, v49
    v_cmp_gt_u32 vcc, s12, v48
    s_cbranch_vccnz G1_slow3
G1_back3:
    ds_read_b128 v[128:131], v32 offset:0
    ds_read_b128 v[136:139], v36 offset:0
    v_mfma_f32_32x32x16_bf16 v[80:95], v[192:195], v[204:207], v[80:95]
    ds_read_b128 v[140:143], v36 offset:4096
    ds_read_b128 v[132:135], v32 offset:4096
    v_mfma_f32_32x32x16_bf16 v[96:111], v[196:199], v[200:203], v[96:111]
    ds_read_b128 v[144:147], v33 offset:0
    ds_read_b128 v[152:155], v37 offset:0
    v_mfma_f32_32x32x16_bf16 v[112:127], v[196:199], v[204:207], v[112:127]
    ds_read_b128 v[156:159], v37 offset:4096
    ds_read_b128 v[148:151], v33 offset:4096
    v_mfma_f32_32x32x16_bf16 v[64:79], v[208:211], v[216:219], v[64:79]
    ds_read_b128 v[160:163], v34 offset:0
    ds_read_b128 v[168:171], v38 offset:0
    v_mfma_f32_32x32x16_bf16 v[80:95], v[208:211], v[220:223], v[80:95]
    ds_read_b128 v[172:175], v38 offset:4096
    ds_read_b128 v[164:167], v34 offset:4096
    v_mfma_f32_32x32x16_bf16 v[96:111], v[212:215], v[216:219], v[96:111]
    ds_read_b128 v[176:179], v35 offset:0
    ds_read_b128 v[184:187], v39 offset:0
    v_mfma_f32_32x32x16_bf16 v[112:127], v[212:215], v[220:223], v[112:127]
    ds_read_b128 v[188:191], v39 offset:4096
    ds_read_b128 v[180:183], v35 offset:4096
    v_mfma_f32_32x32x16_bf16 v[64:79], v[224:227], v[232:235], v[64:79]
    v_mfma_f32_32x32x16_bf16 v[80:95], v[224:227], v[236:239], v[80:95]
    v_mfma_f32_32x32x16_bf16 v[96:111], v[228:231], v[232:235], v[96:111]
    v_mfma_f32_32x32x16_bf16 v[112:127], v[228:231], v[236:239], v[112:127]
    v_mfma_f32_32x32x16_bf16 v[64:79], v[240:243], v[248:251], v[64:79]
    v_mov_b32 v52, s12
    s_waitcnt lgkmcnt(0)
    ds_write_b32 v10, v52
    s_add_u32 s12, s12, 1
    v_mfma_f32_32x32x16_bf16 v[80:95], v[240:243], v[252:255], v[80:95]
    ds_read_b64 v[48:49], v11 offset:16
    v_mfma_f32_32x32x16_bf16 v[96:111], v[244:247], v[248:251], v[96:111]
    v_mfma_f32_32x32x16_bf16 v[112:127], v[244:247], v[252:255], v[112:127]
    s_branch G1_loop
G1_slow0:
    s_mov_b32 s15, 0
G1_sl0_w:
    ds_read_b64 v[48:49], v11 offset:16
    s_waitcnt lgkmcnt(0)
    v_min_u32 v48, v48, v49
    v_cmp_gt_u32 vcc, s12, v48
    s_cbranch_vccz G1_sl0_ok
    s_add_u32 s15, s15, 1
    s_cmp_lt_u32 s15, 160000
    s_cbranch_scc1 G1_sl0_w
G1_sl0_ok:
    s_branch G1_back0
G1_slow1:
    s_mov_b32 s15, 0
G1_sl1_w:
    ds_read_b64 v[48:49], v11 offset:16
    s_waitcnt lgkmcnt(0)
    v_min_u32 v48, v48, v49
    v_cmp_gt_u32 vcc, s12, v48
    s_cbranch_vccz G1_sl1_ok
    s_add_u32 s15, s15, 1
    s_cmp_lt_u32 s15, 160000
    s_cbranch_scc1 G1_sl1_w
G1_sl1_ok:
    s_branch G1_back1
G1_slow2:
    s_mov_b32 s15, 0
G1_sl2_w:
    ds_read_b64 v[48:49], v11 offset:16
    s_waitcnt lgkmcnt(0)
    v_min_u32 v48, v48, v49
    v_cmp_gt_u32 vcc, s12, v48
    s_cbranch_vccz G1_sl2_ok
    s_add_u32 s15, s15, 1
    s_cmp_lt_u32 s15, 160000
    s_cbranch_scc1 G1_sl2_w
G1_sl2_ok:
    s_branch G1_back2
G1_slow3:
    s_mov_b32 s15, 0
G1_sl3_w:
    ds_read_b64 v[48:49], v11 offset:16
    s_waitcnt lgkmcnt(0)
    v_min_u32 v48, v48, v49
    v_cmp_gt_u32 vcc, s12, v48
    s_cbranch_vccz G1_sl3_ok
    s_add_u32 s15, s15, 1
    s_cmp_lt_u32 s15, 160000
    s_cbranch_scc1 G1_sl3_w
G1_sl3_ok:
    s_branch G1_back3
G1_last:
    v_mfma_f32_32x32x16_bf16 v[64:79], v[192:195], v[200:203], v[64:79]
    s_setprio 3
    s_waitcnt vmcnt(0)
    ds_read_b64 v[30:31], v11 offset:32
    v_lshlrev_b32 v133, 16, v12
    v_lshlrev_b32 v134, 16, v13
    v_lshlrev_b32 v135, 16, v14
    v_mul_f32 v133, 0x3fb8aa3b, v133
    v_mfma_f32_32x32x16_bf16 v[80:95], v[192:195], v[204:207], v[80:95]
    v_exp_f32 v133, v133
    v_mul_f32 v140, v134, v134
    v_cvt_pk_bf16_f32 v133, v133, v133
    v_fmac_f32 v140, v135, v135
    v_mfma_f32_32x32x16_bf16 v[96:111], v[196:199], v[200:203], v[96:111]
    v_lshlrev_b32 v133, 16, v133
    v_rcp_f32 v140, v140
    v_mul_f32 v136, v133, v134
    v_mul_f32 v137, v133, v135
    v_mfma_f32_32x32x16_bf16 v[112:127], v[196:199], v[204:207], v[112:127]
    v_mul_f32 v136, 0x3fb8aa3b, v136
    v_exp_f32 v136, v136
    v_mul_f32 v137, 0.15915494, v137
    v_cos_f32 v138, v137
    v_mfma_f32_32x32x16_bf16 v[64:79], v[208:211], v[216:219], v[64:79]
    v_sin_f32 v139, v137
    v_add_f32 v140, v140, v140
    v_mul_f32 v6, v136, v138
    v_mul_f32 v7, v136, v139
    v_mfma_f32_32x32x16_bf16 v[80:95], v[208:211], v[220:223], v[80:95]
    v_mul_f32 v128, v6, v6
    v_mul_f32 v129, v6, v7
    v_fma_f32 v128, -v7, v7, v128
    v_fmac_f32 v129, v7, v6
    v_mfma_f32_32x32x16_bf16 v[96:111], v[212:215], v[216:219], v[96:111]
    v_mul_f32 v130, v128, v128
    v_mul_f32 v131, v128, v129
    v_fma_f32 v130, -v129, v129, v130
    v_fmac_f32 v131, v129, v128
    v_mfma_f32_32x32x16_bf16 v[112:127], v[212:215], v[220:223], v[112:127]
    v_mul_f32 v12, v130, v130
    v_mul_f32 v13, v130, v131
    v_fma_f32 v12, -v131, v131, v12
    v_fmac_f32 v13, v131, v130
    v_mfma_f32_32x32x16_bf16 v[64:79], v[224:227], v[232:235], v[64:79]
    v_mul_f32 v14, v12, v12
    v_mul_f32 v15, v12, v13
    v_fma_f32 v14, -v13, v13, v14
    v_fmac_f32 v15, v13, v12
    v_mfma_f32_32x32x16_bf16 v[80:95], v[224:227], v[236:239], v[80:95]
    v_mul_f32 v16, v14, v14
    v_mul_f32 v17, v14, v15
    v_fma_f32 v16, -v15, v15, v16
    v_fmac_f32 v17, v15, v14
    v_mfma_f32_32x32x16_bf16 v[96:111], v[228:231], v[232:235], v[96:111]
    v_add_f32 v136, -1.0, v6
    v_mul_f32 v138, v136, v134
    v_fmac_f32 v138, v7, v135
    v_mul_f32 v139, v7, v134
    v_mfma_f32_32x32x16_bf16 v[112:127], v[228:231], v[236:239], v[112:127]
    v_fma_f32 v139, -v136, v135, v139
    v_mul_f32 v8, v138, v140
    v_mul_f32 v9, v139, v140
    v_mul_f32 v18, v16, v16
    v_mfma_f32_32x32x16_bf16 v[64:79], v[240:243], v[248:251], v[64:79]
    v_mul_f32 v19, v16, v17
    v_fma_f32 v18, -v17, v17, v18
    v_fmac_f32 v19, v17, v16
    v_mul_f32 v20, v18, v18
    v_mfma_f32_32x32x16_bf16 v[80:95], v[240:243], v[252:255], v[80:95]
    v_mul_f32 v21, v18, v19
    v_fma_f32 v20, -v19, v19, v20
    v_fmac_f32 v21, v19, v18
    v_mfma_f32_32x32x16_bf16 v[96:111], v[244:247], v[248:251], v[96:111]
    v_mfma_f32_32x32x16_bf16 v[112:127], v[244:247], v[252:255], v[112:127]
    s_nop 1
    v_fma_f32 v40, v6, v64, v66
    v_fma_f32 v41, v6, v65, v67
    s_nop 2
    v_fma_f32 v42, v6, v80, v82
    v_fma_f32 v43, v6, v81, v83
    s_nop 1
    v_fma_f32 v44, v6, v96, v98
    v_fma_f32 v45, v6, v97, v99
    v_fma_f32 v46, v6, v112, v114
    v_fma_f32 v47, v6, v113, v115
    v_fma_f32 v40, -v7, v80, v40
    v_fma_f32 v41, -v7, v81, v41
    v_fmac_f32 v42, v7, v64
    v_fmac_f32 v43, v7, v65
    v_fma_f32 v44, -v7, v112, v44
    v_fma_f32 v45, -v7, v113, v45
    v_fmac_f32 v46, v7, v96
    v_fmac_f32 v47, v7, v97
    v_fma_f32 v32, v6, v40, v68
    v_fma_f32 v33, v6, v41, v69
    v_fma_f32 v34, v6, v42, v84
    v_fma_f32 v35, v6, v43, v85
    v_fma_f32 v36, v6, v44, v100
    v_fma_f32 v37, v6, v45, v101
    v_fma_f32 v38, v6, v46, v116
    v_fma_f32 v39, v6, v47, v117
    v_fma_f32 v32, -v7, v42, v32
    v_fma_f32 v33, -v7, v43, v33
    v_fmac_f32 v34, v7, v40
    v_fmac_f32 v35, v7, v41
    v_fma_f32 v36, -v7, v46, v36
    v_fma_f32 v37, -v7, v47, v37
    v_fmac_f32 v38, v7, v44
    v_fmac_f32 v39, v7, v45
    v_fma_f32 v40, v6, v32, v70
    v_fma_f32 v41, v6, v33, v71
    v_fma_f32 v42, v6, v34, v86
    v_fma_f32 v43, v6, v35, v87
    v_fma_f32 v44, v6, v36, v102
    v_fma_f32 v45, v6, v37, v103
    v_fma_f32 v46, v6, v38, v118
    v_fma_f32 v47, v6, v39, v119
    v_fma_f32 v40, -v7, v34, v40
    v_fma_f32 v41, -v7, v35, v41
    v_fmac_f32 v42, v7, v32
    v_fmac_f32 v43, v7, v33
    v_fma_f32 v44, -v7, v38, v44
    v_fma_f32 v45, -v7, v39, v45
    v_fmac_f32 v46, v7, v36
    v_fmac_f32 v47, v7, v37
    v_fma_f32 v32, v6, v40, v72
    v_fma_f32 v33, v6, v41, v73
    v_fma_f32 v34, v6, v42, v88
    v_fma_f32 v35, v6, v43, v89
    v_fma_f32 v36, v6, v44, v104
    v_fma_f32 v37, v6, v45, v105
    v_fma_f32 v38, v6, v46, v120
    v_fma_f32 v39, v6, v47, v121
    v_fma_f32 v32, -v7, v42, v32
    v_fma_f32 v33, -v7, v43, v33
    v_fmac_f32 v34, v7, v40
    v_fmac_f32 v35, v7, v41
    v_fma_f32 v36, -v7, v46, v36
    v_fma_f32 v37, -v7, v47, v37
    v_fmac_f32 v38, v7, v44
    v_fmac_f32 v39, v7, v45
    v_fma_f32 v40, v6, v32, v74
    v_fma_f32 v41, v6, v33, v75
    v_fma_f32 v42, v6, v34, v90
    v_fma_f32 v43, v6, v35, v91
    v_fma_f32 v44, v6, v36, v106
    v_fma_f32 v45, v6, v37, v107
    v_fma_f32 v46, v6, v38, v122
    v_fma_f32 v47, v6, v39, v123
    v_fma_f32 v40, -v7, v34, v40
    v_fma_f32 v41, -v7, v35, v41
    v_fmac_f32 v42, v7, v32
    v_fmac_f32 v43, v7, v33
    v_fma_f32 v44, -v7, v38, v44
    v_fma_f32 v45, -v7, v39, v45
    v_fmac_f32 v46, v7, v36
    v_fmac_f32 v47, v7, v37
    v_fma_f32 v32, v6, v40, v76
    v_fma_f32 v33, v6, v41, v77
    v_fma_f32 v34, v6, v42, v92
    v_fma_f32 v35, v6, v43, v93
    v_fma_f32 v36, v6, v44, v108
    v_fma_f32 v37, v6, v45, v109
    v_fma_f32 v38, v6, v46, v124
    v_fma_f32 v39, v6, v47, v125
    v_fma_f32 v32, -v7, v42, v32
    v_fma_f32 v33, -v7, v43, v33
    v_fmac_f32 v34, v7, v40
    v_fmac_f32 v35, v7, v41
    v_fma_f32 v36, -v7, v46, v36
    v_fma_f32 v37, -v7, v47, v37
    v_fmac_f32 v38, v7, v44
    v_fmac_f32 v39, v7, v45
    v_fma_f32 v40, v6, v32, v78
    v_fma_f32 v41, v6, v33, v79
    v_fma_f32 v42, v6, v34, v94
    v_fma_f32 v43, v6, v35, v95
    v_fma_f32 v44, v6, v36, v110
    v_fma_f32 v45, v6, v37, v111
    v_fma_f32 v46, v6, v38, v126
    v_fma_f32 v47, v6, v39, v127
    v_fma_f32 v40, -v7, v34, v40
    v_fma_f32 v41, -v7, v35, v41
    v_fmac_f32 v42, v7, v32
    v_fmac_f32 v43, v7, v33
    v_fma_f32 v44, -v7, v38, v44
    v_fma_f32 v45, -v7, v39, v45
    v_fmac_f32 v46, v7, v36
    v_fmac_f32 v47, v7, v37
    v_fmac_f32 v44, v12, v40
    v_fmac_f32 v45, v12, v41
    v_fmac_f32 v46, v12, v42
    v_fmac_f32 v47, v12, v43
    v_fma_f32 v44, -v13, v42, v44
    v_fma_f32 v45, -v13, v43, v45
    v_fmac_f32 v46, v13, v40
    v_fmac_f32 v47, v13, v41
    v_fma_f32 v32, v14, v44, v45
    v_fma_f32 v34, v14, v46, v47
    v_fma_f32 v32, -v15, v46, v32
    v_fmac_f32 v34, v15, v44
    v_mov_b32 v33, v32
    v_mov_b32 v35, v34
    s_lshl_b32 s12, s6, 1
    s_add_u32 s12, s12, s8
    v_permlane32_swap_b32 v32, v33
    v_permlane32_swap_b32 v34, v35
    v_fma_f32 v28, v16, v32, v33
    v_fma_f32 v29, v16, v34, v35
    v_fma_f32 v28, -v17, v34, v28
    v_fmac_f32 v29, v17, v32
    s_waitcnt lgkmcnt(0)
    s_mov_b32 s15, 0
G_nw:
    v_cmp_eq_u32 vcc, 0, v30
    s_cbranch_vccz G_nok
    ds_read_b64 v[30:31], v11 offset:32
    s_add_u32 s15, s15, 1
    s_waitcnt lgkmcnt(0)
    s_cmp_lt_u32 s15, 160000
    s_cbranch_scc1 G_nw
G_nok:
    s_cmp_eq_u32 s8, 0
    s_cbranch_scc0 G_pw1
    ds_write_b128 v0, v[28:31] offset:2048
    s_branch G_pub1
G_pw1:
    s_mov_b32 s15, 0
G_x1:
    ds_read_b128 v[56:59], v1 offset:2048
    s_add_u32 s15, s15, 1
    s_waitcnt lgkmcnt(0)
    v_cmp_ne_u64 vcc, v[58:59], v[30:31]
    s_cbranch_vccz G_x1_ok
    s_cmp_lt_u32 s15, 160000
    s_cbranch_scc1 G_x1
G_x1_ok:
    v_fmac_f32 v28, v18, v56
    v_fmac_f32 v29, v18, v57
    s_lshl_b32 s13, s6, 14
    v_fma_f32 v28, -v19, v57, v28
    v_fmac_f32 v29, v19, v56
    s_mov_b32 exec_hi, 0
    buffer_store_dwordx4 v[28:31], v53, s[64:67], s13 offen sc1
    s_cmp_eq_u32 s6, 0
    s_cbranch_scc0 G_pub1
    s_not_b64 exec, exec
    v_mov_b32 v28, 0
    v_mov_b32 v29, 0
    buffer_store_dwordx4 v[28:31], v53, s[64:67], 0 offen sc1
G_pub1:
    s_mov_b64 exec, -1
    v_mul_f32 v128, v8, v64
    v_mul_f32 v129, v8, v65
    v_mul_f32 v144, -v8, v80
    v_mul_f32 v145, -v8, v81
    v_mul_f32 v160, v8, v96
    v_mul_f32 v161, v8, v97
    v_mul_f32 v176, -v8, v112
    v_mul_f32 v177, -v8, v113
    v_fma_f32 v128, -v9, v80, v128
    v_fma_f32 v129, -v9, v81, v129
    v_fma_f32 v144, -v9, v64, v144
    v_fma_f32 v145, -v9, v65, v145
    v_fma_f32 v160, -v9, v112, v160
    v_fma_f32 v161, -v9, v113, v161
    v_fma_f32 v176, -v9, v96, v176
    v_fma_f32 v177, -v9, v97, v177
    v_mul_f32 v130, v8, v66
    v_mul_f32 v131, v8, v67
    v_mul_f32 v146, -v8, v82
    v_mul_f32 v147, -v8, v83
    v_mul_f32 v162, v8, v98
    v_mul_f32 v163, v8, v99
    v_mul_f32 v178, -v8, v114
    v_mul_f32 v179, -v8, v115
    v_fma_f32 v130, -v9, v82, v130
    v_fma_f32 v131, -v9, v83, v131
    v_fma_f32 v146, -v9, v66, v146
    v_fma_f32 v147, -v9, v67, v147
    v_fma_f32 v162, -v9, v114, v162
    v_fma_f32 v163, -v9, v115, v163
    v_fma_f32 v178, -v9, v98, v178
    v_fma_f32 v179, -v9, v99, v179
    v_mul_f32 v132, v8, v68
    v_mul_f32 v133, v8, v69
    v_mul_f32 v148, -v8, v84
    v_mul_f32 v149, -v8, v85
    v_mul_f32 v164, v8, v100
    v_mul_f32 v165, v8, v101
    v_mul_f32 v180, -v8, v116
    v_mul_f32 v181, -v8, v117
    v_fma_f32 v132, -v9, v84, v132
    v_fma_f32 v133, -v9, v85, v133
    v_fma_f32 v148, -v9, v68, v148
    v_fma_f32 v149, -v9, v69, v149
    v_fma_f32 v164, -v9, v116, v164
    v_fma_f32 v165, -v9, v117, v165
    v_fma_f32 v180, -v9, v100, v180
    v_fma_f32 v181, -v9, v101, v181
    v_mul_f32 v134, v8, v70
    v_mul_f32 v135, v8, v71
    v_mul_f32 v150, -v8, v86
    v_mul_f32 v151, -v8, v87
    v_mul_f32 v166, v8, v102
    v_mul_f32 v167, v8, v103
    v_mul_f32 v182, -v8, v118
    v_mul_f32 v183, -v8, v119
    v_fma_f32 v134, -v9, v86, v134
    v_fma_f32 v135, -v9, v87, v135
    v_fma_f32 v150, -v9, v70, v150
    v_fma_f32 v151, -v9, v71, v151
    v_fma_f32 v166, -v9, v118, v166
    v_fma_f32 v167, -v9, v119, v167
    v_fma_f32 v182, -v9, v102, v182
    v_fma_f32 v183, -v9, v103, v183
    v_mul_f32 v136, v8, v72
    v_mul_f32 v137, v8, v73
    v_mul_f32 v152, -v8, v88
    v_mul_f32 v153, -v8, v89
    v_mul_f32 v168, v8, v104
    v_mul_f32 v169, v8, v105
    v_mul_f32 v184, -v8, v120
    v_mul_f32 v185, -v8, v121
    v_fma_f32 v136, -v9, v88, v136
    v_fma_f32 v137, -v9, v89, v137
    v_fma_f32 v152, -v9, v72, v152
    v_fma_f32 v153, -v9, v73, v153
    v_fma_f32 v168, -v9, v120, v168
    v_fma_f32 v169, -v9, v121, v169
    v_fma_f32 v184, -v9, v104, v184
    v_fma_f32 v185, -v9, v105, v185
    v_mul_f32 v138, v8, v74
    v_mul_f32 v139, v8, v75
    v_mul_f32 v154, -v8, v90
    v_mul_f32 v155, -v8, v91
    v_mul_f32 v170, v8, v106
    v_mul_f32 v171, v8, v107
    v_mul_f32 v186, -v8, v122
    v_mul_f32 v187, -v8, v123
    v_fma_f32 v138, -v9, v90, v138
    v_fma_f32 v139, -v9, v91, v139
    v_fma_f32 v154, -v9, v74, v154
    v_fma_f32 v155, -v9, v75, v155
    v_fma_f32 v170, -v9, v122, v170
    v_fma_f32 v171, -v9, v123, v171
    v_fma_f32 v186, -v9, v106, v186
    v_fma_f32 v187, -v9, v107, v187
    v_mul_f32 v140, v8, v76
    v_mul_f32 v141, v8, v77
    v_mul_f32 v156, -v8, v92
    v_mul_f32 v157, -v8, v93
    v_mul_f32 v172, v8, v108
    v_mul_f32 v173, v8, v109
    v_mul_f32 v188, -v8, v124
    v_mul_f32 v189, -v8, v125
    v_fma_f32 v140, -v9, v92, v140
    v_fma_f32 v141, -v9, v93, v141
    v_fma_f32 v156, -v9, v76, v156
    v_fma_f32 v157, -v9, v77, v157
    v_fma_f32 v172, -v9, v124, v172
    v_fma_f32 v173, -v9, v125, v173
    v_fma_f32 v188, -v9, v108, v188
    v_fma_f32 v189, -v9, v109, v189
    v_mul_f32 v142, v8, v78
    v_mul_f32 v143, v8, v79
    v_mul_f32 v158, -v8, v94
    v_mul_f32 v159, -v8, v95
    v_mul_f32 v174, v8, v110
    v_mul_f32 v175, v8, v111
    v_mul_f32 v190, -v8, v126
    v_mul_f32 v191, -v8, v127
    v_fma_f32 v142, -v9, v94, v142
    v_fma_f32 v143, -v9, v95, v143
    v_fma_f32 v158, -v9, v78, v158
    v_fma_f32 v159, -v9, v79, v159
    v_fma_f32 v174, -v9, v126, v174
    v_fma_f32 v175, -v9, v127, v175
    v_fma_f32 v190, -v9, v110, v190
    v_fma_f32 v191, -v9, v111, v191
    s_mov_b32 s13, 0
    buffer_load_dwordx2 v[80:81], v22, s[52:55], s13 offen offset:0
    buffer_load_dwordx2 v[82:83], v22, s[52:55], s13 offen offset:2048
    s_mov_b32 s13, 4096
    buffer_load_dwordx2 v[84:85], v22, s[52:55], s13 offen offset:0
    buffer_load_dwordx2 v[86:87], v22, s[52:55], s13 offen offset:2048
    s_mov_b32 s13, 32768
    buffer_load_dwordx2 v[88:89], v22, s[52:55], s13 offen offset:0
    buffer_load_dwordx2 v[90:91], v22, s[52:55], s13 offen offset:2048
    s_mov_b32 s13, 36864
    buffer_load_dwordx2 v[92:93], v22, s[52:55], s13 offen offset:0
    buffer_load_dwordx2 v[94:95], v22, s[52:55], s13 offen offset:2048
    v_cmp_eq_u32 vcc, 1, v4
    v_mov_b32 v36, 1.0
    s_nop 0
    v_cndmask_b32 v72, v36, v20, vcc
    v_cndmask_b32 v73, 0, v21, vcc
    v_cndmask_b32 v96, 0, v32, vcc
    v_cndmask_b32 v98, 0, v34, vcc
    v_cndmask_b32 v36, v36, v16, vcc
    v_cndmask_b32 v37, 0, v17, vcc
    s_cmp_eq_u32 s8, 1
    s_cselect_b64 s[14:15], -1, 0
    v_mul_f32 v74, v20, v20
    v_fma_f32 v97, v14, v96, v44
    v_mul_f32 v75, v20, v21
    v_fma_f32 v99, v14, v98, v46
    v_fma_f32 v74, -v21, v21, v74
    v_fma_f32 v97, -v15, v98, v97
    v_fmac_f32 v75, v21, v20
    v_fmac_f32 v99, v15, v96
    v_mul_f32 v76, v74, v74
    v_fma_f32 v100, v12, v96, v40
    v_mul_f32 v77, v74, v75
    v_fma_f32 v101, v12, v97, v41
    v_fma_f32 v76, -v75, v75, v76
    v_fma_f32 v102, v12, v98, v42
    v_fmac_f32 v77, v75, v74
    v_fma_f32 v103, v12, v99, v43
    v_cndmask_b32 v74, 1.0, v74, s[14:15]
    v_fma_f32 v100, -v13, v98, v100
    v_cndmask_b32 v75, 0, v75, s[14:15]
    v_fma_f32 v101, -v13, v99, v101
    v_mul_f32 v64, v72, v74
    v_fmac_f32 v102, v13, v96
    v_mul_f32 v65, v72, v75
    v_fmac_f32 v103, v13, v97
    v_fma_f32 v64, -v73, v75, v64
    v_mul_f32 v104, v8, v36
    v_fmac_f32 v65, v73, v74
    v_mul_f32 v106, v8, v37
    v_mul_f32 v66, v64, v76
    v_fma_f32 v104, -v9, v37, v104
    v_mul_f32 v67, v64, v77
    v_fmac_f32 v106, v9, v36
    v_fma_f32 v66, -v65, v77, v66
    v_mul_f32 v105, v14, v104
    v_fmac_f32 v67, v65, v76
    v_mul_f32 v107, v14, v106
    v_mul_f32 v68, v66, v76
    v_fma_f32 v105, -v15, v106, v105
    v_mul_f32 v69, v66, v77
    v_fmac_f32 v107, v15, v104
    v_fma_f32 v68, -v67, v77, v68
    v_mul_f32 v108, v12, v104
    v_fmac_f32 v69, v67, v76
    v_mul_f32 v109, v12, v105
    v_mul_f32 v70, v68, v76
    v_mul_f32 v110, v12, v106
    v_mul_f32 v71, v68, v77
    v_mul_f32 v111, v12, v107
    v_fma_f32 v70, -v69, v77, v70
    v_fma_f32 v108, -v13, v106, v108
    v_fmac_f32 v71, v69, v76
    v_fma_f32 v109, -v13, v107, v109
    v_fmac_f32 v110, v13, v104
    v_fmac_f32 v111, v13, v105
    v_mul_f32 v112, v8, v96
    v_mul_f32 v113, v8, v97
    v_mul_f32 v114, -v8, v98
    v_mul_f32 v115, -v8, v99
    v_fma_f32 v112, -v9, v98, v112
    v_fma_f32 v113, -v9, v99, v113
    v_fma_f32 v114, -v9, v96, v114
    v_fma_f32 v115, -v9, v97, v115
    v_mul_f32 v116, v8, v100
    v_mul_f32 v117, v8, v101
    v_mul_f32 v118, -v8, v102
    v_mul_f32 v119, -v8, v103
    v_fma_f32 v116, -v9, v102, v116
    v_fma_f32 v117, -v9, v103, v117
    v_fma_f32 v118, -v9, v100, v118
    v_fma_f32 v119, -v9, v101, v119
    s_lshl_b32 s13, s3, 13
    s_add_u32 s13, s13, 65536
    v_and_b32 v32, 1, v2
    v_and_b32 v33, 2, v2
    v_lshl_or_b32 v32, v33, 1, v32
    v_lshrrev_b32 v33, 1, v2
    v_xor_b32 v33, v33, v2
    v_bfe_u32 v33, v33, 2, 1
    v_lshl_or_b32 v32, v33, 1, v32
    v_lshlrev_b32 v33, 2, v4
    v_xor_b32 v32, v32, v33
    v_lshlrev_b32 v32, 4, v32
    v_lshl_add_u32 v32, v3, 7, v32
    v_add_u32 v120, s13, v32
    v_xor_b32 v121, 16, v120
    v_xor_b32 v122, 32, v120
    v_xor_b32 v123, 48, v120
    v_bfe_u32 v32, v2, 2, 2
    v_lshrrev_b32 v33, 4, v2
    v_lshl_add_u32 v33, v33, 3, v32
    v_lshlrev_b32 v33, 7, v33
    v_and_b32 v34, 1, v32
    v_and_b32 v32, 2, v32
    v_lshl_or_b32 v32, v32, 1, v34
    v_bfe_u32 v34, v2, 4, 1
    v_bfe_u32 v35, v2, 1, 1
    v_lshl_or_b32 v34, v34, 1, v35
    v_xor_b32 v32, v32, v34
    v_lshl_add_u32 v33, v32, 4, v33
    v_and_b32 v32, 1, v2
    v_lshl_add_u32 v33, v32, 3, v33
    v_add_u32 v124, s13, v33
    v_xor_b32 v125, 64, v124
    v_xor_b32 v126, 32, v124
    v_xor_b32 v127, 64, v126
    s_lshl_b32 s10, s7, 5
    s_add_u32 s10, s10, s8
    s_lshl_b32 s10, s10, 12
    v_lshrrev_b32 v40, 3, v2
    v_lshl_add_u32 v40, v40, 13, s10
    v_lshrrev_b32 v41, 4, v2
    v_xor_b32 v41, v41, v2
    v_and_b32 v41, 7, v41
    v_lshl_add_u32 v16, v41, 4, v40
    v_xor_b32 v17, 64, v16
    v_add_u32 v17, 64512, v17
    s_lshl_b32 s16, s6, 2
    s_add_u32 s16, s16, s3
    s_lshl_b32 s16, s16, 17
    s_lshl_b32 s22, s9, 13
    s_lshl_b32 s10, s8, 12
    s_add_u32 s22, s22, s10
    s_lshl_b32 s10, s9, 6
    s_lshl_b32 s11, s9, 13
    v_xor_b32 v20, s10, v124
    v_xor_b32 v21, s10, v126
    v_subrev_u32 v20, s11, v20
    v_subrev_u32 v21, s11, v21
    s_mov_b32 s15, 0
G_all16_w:
    ds_read_b128 v[48:51], v11 offset:0
    s_waitcnt lgkmcnt(0)
    v_min3_u32 v48, v48, v49, v50
    v_min_u32 v48, v48, v51
    v_cmp_gt_u32 vcc, 16, v48
    s_cbranch_vccz G_all16_ok
    s_add_u32 s15, s15, 1
    s_cmp_lt_u32 s15, 160000
    s_cbranch_scc1 G_all16_w
G_all16_ok:
    v_mov_b32 v36, 0
    v_mov_b32 v37, 0
    s_mov_b32 s15, 0
    s_cmp_eq_u32 s6, 0
    s_cbranch_scc1 G_lb4
    s_lshl_b32 s14, s8, 1
    s_sub_i32 s14, s6, s14
    s_cmp_le_i32 s14, 0
    s_cbranch_scc1 G_lb3
G_lb:
    buffer_load_dwordx4 v[192:195], v60, s[64:67], 0 offen sc1
    s_cmp_le_i32 s14, 4
    s_cbranch_scc1 G_lb1
    buffer_load_dwordx4 v[196:199], v61, s[64:67], 0 offen sc1
    s_cmp_le_i32 s14, 8
    s_cbranch_scc1 G_lb1
    buffer_load_dwordx4 v[200:203], v62, s[64:67], 0 offen sc1
    s_cmp_le_i32 s14, 12
    s_cbranch_scc1 G_lb1
    buffer_load_dwordx4 v[204:207], v63, s[64:67], 0 offen sc1
G_lb1:
    v_mov_b32 v36, 0
    v_mov_b32 v37, 0
    s_mov_b64 s[10:11], 0
    s_waitcnt vmcnt(0)
    v_cmp_ne_u64 vcc, v[194:195], v[30:31]
    v_fmac_f32 v36, v64, v192
    v_fmac_f32 v37, v64, v193
    s_or_b64 s[10:11], s[10:11], vcc
    v_fma_f32 v36, -v65, v193, v36
    v_fmac_f32 v37, v65, v192
    s_cmp_le_i32 s14, 4
    s_cbranch_scc1 G_lb2
    v_cmp_ne_u64 vcc, v[198:199], v[30:31]
    v_fmac_f32 v36, v66, v196
    v_fmac_f32 v37, v66, v197
    s_or_b64 s[10:11], s[10:11], vcc
    v_fma_f32 v36, -v67, v197, v36
    v_fmac_f32 v37, v67, v196
    s_cmp_le_i32 s14, 8
    s_cbranch_scc1 G_lb2
    v_cmp_ne_u64 vcc, v[202:203], v[30:31]
    v_fmac_f32 v36, v68, v200
    v_fmac_f32 v37, v68, v201
    s_or_b64 s[10:11], s[10:11], vcc
    v_fma_f32 v36, -v69, v201, v36
    v_fmac_f32 v37, v69, v200
    s_cmp_le_i32 s14, 12
    s_cbranch_scc1 G_lb2
    v_cmp_ne_u64 vcc, v[206:207], v[30:31]
    v_fmac_f32 v36, v70, v204
    v_fmac_f32 v37, v70, v205
    s_or_b64 s[10:11], s[10:11], vcc
    v_fma_f32 v36, -v71, v205, v36
    v_fmac_f32 v37, v71, v204
G_lb2:
    s_cmp_eq_u64 s[10:11], 0
    s_cbranch_scc1 G_lb2b
    s_add_u32 s15, s15, 1
    s_cmp_lt_u32 s15, 20000
    s_cbranch_scc1 G_lb
G_lb2b:
    v_mov_b32 v38, v36
    v_mov_b32 v39, v37
    s_nop 0
    v_permlane32_swap_b32 v36, v38
    v_permlane32_swap_b32 v37, v39
    v_add_f32 v36, v36, v38
    v_add_f32 v37, v37, v39
G_lb3:
    v_mov_b32 v28, v36
    v_mov_b32 v29, v37
    ds_write_b128 v0, v[28:31]
    s_mov_b32 s15, 0
G_x2:
    ds_read_b128 v[192:195], v1 offset:0
    s_add_u32 s15, s15, 1
    s_waitcnt lgkmcnt(0)
    v_cmp_ne_u64 vcc, v[194:195], v[30:31]
    s_cbranch_vccz G_x2_ok
    s_cmp_lt_u32 s15, 160000
    s_cbranch_scc1 G_x2
G_x2_ok:
    v_add_f32 v36, v36, v192
    v_add_f32 v37, v37, v193
G_lb4:
    s_cmp_eq_u32 s8, 0
    s_cbranch_scc1 G_lbdone
    v_fma_f32 v56, v18, v36, v56
    v_fma_f32 v57, v18, v37, v57
    v_fma_f32 v56, -v19, v37, v56
    v_fma_f32 v37, v19, v36, v57
    v_mov_b32 v36, v56
G_lbdone:
    v_fmac_f32 v112, v36, v104
    v_fmac_f32 v113, v36, v105
    v_fma_f32 v114, -v37, v104, v114
    v_fma_f32 v115, -v37, v105, v115
    v_fmac_f32 v116, v36, v108
    v_fmac_f32 v117, v36, v109
    v_fma_f32 v118, -v37, v108, v118
    v_fma_f32 v119, -v37, v109, v119
    v_fma_f32 v112, -v37, v106, v112
    v_fma_f32 v113, -v37, v107, v113
    v_fma_f32 v114, -v36, v106, v114
    v_fma_f32 v115, -v36, v107, v115
    v_fma_f32 v116, -v37, v110, v116
    v_fma_f32 v117, -v37, v111, v117
    v_fma_f32 v118, -v36, v110, v118
    v_fma_f32 v119, -v36, v111, v119
    s_bfe_u32 s18, s100, 28 + (4 << 16)
    s_lshl_b32 s18, s18, 7
    buffer_load_dwordx4 v[224:227], v16, s[80:83], s18 offen offset:0
    v_fmac_f32 v128, v6, v112
    v_fmac_f32 v129, v6, v113
    v_fmac_f32 v144, v6, v114
    v_fmac_f32 v145, v6, v115
    v_fmac_f32 v160, v6, v116
    v_fmac_f32 v161, v6, v117
    v_fmac_f32 v176, v6, v118
    v_fmac_f32 v177, v6, v119
    v_fmac_f32 v128, v7, v114
    v_fmac_f32 v129, v7, v115
    v_fma_f32 v144, -v7, v112, v144
    v_fma_f32 v145, -v7, v113, v145
    v_fmac_f32 v160, v7, v118
    v_fmac_f32 v161, v7, v119
    v_fma_f32 v176, -v7, v116, v176
    v_fma_f32 v177, -v7, v117, v177
    buffer_load_dwordx4 v[228:231], v17, s[80:83], s18 offen offset:1024
    v_fmac_f32 v130, v6, v128
    v_fmac_f32 v131, v6, v129
    v_fmac_f32 v146, v6, v144
    v_fmac_f32 v147, v6, v145
    v_fmac_f32 v162, v6, v160
    v_fmac_f32 v163, v6, v161
    v_fmac_f32 v178, v6, v176
    v_fmac_f32 v179, v6, v177
    v_fmac_f32 v130, v7, v144
    v_fmac_f32 v131, v7, v145
    v_fma_f32 v146, -v7, v128, v146
    v_fma_f32 v147, -v7, v129, v147
    v_fmac_f32 v162, v7, v176
    v_fmac_f32 v163, v7, v177
    v_fma_f32 v178, -v7, v160, v178
    v_fma_f32 v179, -v7, v161, v179
    buffer_load_dwordx4 v[232:235], v16, s[80:83], s18 offen offset:2048
    v_fmac_f32 v132, v6, v130
    v_fmac_f32 v133, v6, v131
    v_fmac_f32 v148, v6, v146
    v_fmac_f32 v149, v6, v147
    v_fmac_f32 v164, v6, v162
    v_fmac_f32 v165, v6, v163
    v_fmac_f32 v180, v6, v178
    v_fmac_f32 v181, v6, v179
    v_fmac_f32 v132, v7, v146
    v_fmac_f32 v133, v7, v147
    v_fma_f32 v148, -v7, v130, v148
    v_fma_f32 v149, -v7, v131, v149
    v_fmac_f32 v164, v7, v178
    v_fmac_f32 v165, v7, v179
    v_fma_f32 v180, -v7, v162, v180
    v_fma_f32 v181, -v7, v163, v181
    buffer_load_dwordx4 v[236:239], v17, s[80:83], s18 offen offset:3072
    v_fmac_f32 v134, v6, v132
    v_fmac_f32 v135, v6, v133
    v_fmac_f32 v150, v6, v148
    v_fmac_f32 v151, v6, v149
    v_fmac_f32 v166, v6, v164
    v_fmac_f32 v167, v6, v165
    v_fmac_f32 v182, v6, v180
    v_fmac_f32 v183, v6, v181
    v_fmac_f32 v134, v7, v148
    v_fmac_f32 v135, v7, v149
    v_fma_f32 v150, -v7, v132, v150
    v_fma_f32 v151, -v7, v133, v151
    v_fmac_f32 v166, v7, v180
    v_fmac_f32 v167, v7, v181
    v_fma_f32 v182, -v7, v164, v182
    v_fma_f32 v183, -v7, v165, v183
    s_bfe_u32 s18, s101, 0 + (4 << 16)
    s_lshl_b32 s18, s18, 7
    buffer_load_dwordx4 v[240:243], v16, s[80:83], s18 offen offset:0
    v_fmac_f32 v136, v6, v134
    v_fmac_f32 v137, v6, v135
    v_fmac_f32 v152, v6, v150
    v_fmac_f32 v153, v6, v151
    v_fmac_f32 v168, v6, v166
    v_fmac_f32 v169, v6, v167
    v_fmac_f32 v184, v6, v182
    v_fmac_f32 v185, v6, v183
    v_fmac_f32 v136, v7, v150
    v_fmac_f32 v137, v7, v151
    v_fma_f32 v152, -v7, v134, v152
    v_fma_f32 v153, -v7, v135, v153
    v_fmac_f32 v168, v7, v182
    v_fmac_f32 v169, v7, v183
    v_fma_f32 v184, -v7, v166, v184
    v_fma_f32 v185, -v7, v167, v185
    buffer_load_dwordx4 v[244:247], v17, s[80:83], s18 offen offset:1024
    v_fmac_f32 v138, v6, v136
    v_fmac_f32 v139, v6, v137
    v_fmac_f32 v154, v6, v152
    v_fmac_f32 v155, v6, v153
    v_fmac_f32 v170, v6, v168
    v_fmac_f32 v171, v6, v169
    v_fmac_f32 v186, v6, v184
    v_fmac_f32 v187, v6, v185
    v_fmac_f32 v138, v7, v152
    v_fmac_f32 v139, v7, v153
    v_fma_f32 v154, -v7, v136, v154
    v_fma_f32 v155, -v7, v137, v155
    v_fmac_f32 v170, v7, v184
    v_fmac_f32 v171, v7, v185
    v_fma_f32 v186, -v7, v168, v186
    v_fma_f32 v187, -v7, v169, v187
    buffer_load_dwordx4 v[248:251], v16, s[80:83], s18 offen offset:2048
    v_fmac_f32 v140, v6, v138
    v_fmac_f32 v141, v6, v139
    v_fmac_f32 v156, v6, v154
    v_fmac_f32 v157, v6, v155
    v_fmac_f32 v172, v6, v170
    v_fmac_f32 v173, v6, v171
    v_fmac_f32 v188, v6, v186
    v_fmac_f32 v189, v6, v187
    v_fmac_f32 v140, v7, v154
    v_fmac_f32 v141, v7, v155
    v_fma_f32 v156, -v7, v138, v156
    v_fma_f32 v157, -v7, v139, v157
    v_fmac_f32 v172, v7, v186
    v_fmac_f32 v173, v7, v187
    v_fma_f32 v188, -v7, v170, v188
    v_fma_f32 v189, -v7, v171, v189
    buffer_load_dwordx4 v[252:255], v17, s[80:83], s18 offen offset:3072
    v_fmac_f32 v142, v6, v140
    v_fmac_f32 v143, v6, v141
    v_fmac_f32 v158, v6, v156
    v_fmac_f32 v159, v6, v157
    v_fmac_f32 v174, v6, v172
    v_fmac_f32 v175, v6, v173
    v_fmac_f32 v190, v6, v188
    v_fmac_f32 v191, v6, v189
    v_fmac_f32 v142, v7, v156
    v_fmac_f32 v143, v7, v157
    v_fma_f32 v158, -v7, v140, v158
    v_fma_f32 v159, -v7, v141, v159
    v_fmac_f32 v174, v7, v188
    v_fmac_f32 v175, v7, v189
    v_fma_f32 v190, -v7, v172, v190
    v_fma_f32 v191, -v7, v173, v191
    v_cvt_pk_bf16_f32 v192, v128, v130
    v_cvt_pk_bf16_f32 v193, v132, v134
    v_cvt_pk_bf16_f32 v194, v136, v138
    v_cvt_pk_bf16_f32 v195, v140, v142
    ds_write_b128 v120, v[192:195] offset:0
    v_cvt_pk_bf16_f32 v196, v160, v162
    v_cvt_pk_bf16_f32 v197, v164, v166
    v_cvt_pk_bf16_f32 v198, v168, v170
    v_cvt_pk_bf16_f32 v199, v172, v174
    ds_write_b128 v121, v[196:199] offset:0
    v_cvt_pk_bf16_f32 v200, v129, v131
    v_cvt_pk_bf16_f32 v201, v133, v135
    v_cvt_pk_bf16_f32 v202, v137, v139
    v_cvt_pk_bf16_f32 v203, v141, v143
    ds_write_b128 v122, v[200:203] offset:0
    v_cvt_pk_bf16_f32 v204, v161, v163
    v_cvt_pk_bf16_f32 v205, v165, v167
    v_cvt_pk_bf16_f32 v206, v169, v171
    v_cvt_pk_bf16_f32 v207, v173, v175
    ds_write_b128 v123, v[204:207] offset:0
    v_cvt_pk_bf16_f32 v208, v144, v146
    v_cvt_pk_bf16_f32 v209, v148, v150
    v_cvt_pk_bf16_f32 v210, v152, v154
    v_cvt_pk_bf16_f32 v211, v156, v158
    ds_write_b128 v120, v[208:211] offset:4096
    v_cvt_pk_bf16_f32 v212, v176, v178
    v_cvt_pk_bf16_f32 v213, v180, v182
    v_cvt_pk_bf16_f32 v214, v184, v186
    v_cvt_pk_bf16_f32 v215, v188, v190
    ds_write_b128 v121, v[212:215] offset:4096
    v_cvt_pk_bf16_f32 v216, v145, v147
    v_cvt_pk_bf16_f32 v217, v149, v151
    v_cvt_pk_bf16_f32 v218, v153, v155
    v_cvt_pk_bf16_f32 v219, v157, v159
    ds_write_b128 v122, v[216:219] offset:4096
    v_cvt_pk_bf16_f32 v220, v177, v179
    v_cvt_pk_bf16_f32 v221, v181, v183
    v_cvt_pk_bf16_f32 v222, v185, v187
    v_cvt_pk_bf16_f32 v223, v189, v191
    ds_write_b128 v123, v[220:223] offset:4096
    s_lshl_b32 s10, s12, 18
    s_lshl_b32 s11, s7, 13
    s_add_u32 s10, s10, s11
    s_lshl_b32 s11, s9, 11
    s_add_u32 s10, s10, s11
    s_add_u32 s11, s10, 131072
    v_mov_b32 v22, 17
    s_waitcnt lgkmcnt(0)
    ds_read_b64_tr_b16 v[160:161], v124 offset:0
    ds_read_b64_tr_b16 v[162:163], v126 offset:512
    ds_read_b64_tr_b16 v[164:165], v126 offset:0
    ds_read_b64_tr_b16 v[166:167], v124 offset:512
    ds_read_b64_tr_b16 v[168:169], v125 offset:0
    ds_read_b64_tr_b16 v[170:171], v127 offset:512
    ds_read_b64_tr_b16 v[172:173], v127 offset:0
    ds_read_b64_tr_b16 v[174:175], v125 offset:512
    ds_read_b64_tr_b16 v[176:177], v124 offset:4096
    ds_read_b64_tr_b16 v[178:179], v126 offset:4608
    ds_read_b64_tr_b16 v[180:181], v126 offset:4096
    ds_read_b64_tr_b16 v[182:183], v124 offset:4608
    ds_read_b64_tr_b16 v[184:185], v125 offset:4096
    ds_read_b64_tr_b16 v[186:187], v127 offset:4608
    ds_read_b64_tr_b16 v[188:189], v127 offset:4096
    ds_read_b64_tr_b16 v[190:191], v125 offset:4608
    s_waitcnt lgkmcnt(14)
    buffer_store_dwordx4 v[160:163], v26, s[68:71], s10 offen offset:0 sc1
    s_waitcnt lgkmcnt(12)
    buffer_store_dwordx4 v[164:167], v26, s[68:71], s10 offen offset:1024 sc1
    s_waitcnt lgkmcnt(10)
    buffer_store_dwordx4 v[168:171], v26, s[68:71], s11 offen offset:0 sc1
    s_waitcnt lgkmcnt(8)
    buffer_store_dwordx4 v[172:175], v26, s[68:71], s11 offen offset:1024 sc1
    s_waitcnt lgkmcnt(6)
    buffer_store_dwordx4 v[176:179], v27, s[68:71], s10 offen offset:0 sc1
    s_waitcnt lgkmcnt(4)
    buffer_store_dwordx4 v[180:183], v27, s[68:71], s10 offen offset:1024 sc1
    s_waitcnt lgkmcnt(2)
    buffer_store_dwordx4 v[184:187], v27, s[68:71], s11 offen offset:0 sc1
    s_waitcnt lgkmcnt(0)
    buffer_store_dwordx4 v[188:191], v27, s[68:71], s11 offen offset:1024 sc1
    ds_write_b32 v10, v22
    v_and_b32 v112, 15, v2
    v_lshrrev_b32 v113, 1, v112
    v_lshrrev_b32 v114, 4, v2
    v_xor_b32 v113, v113, v114
    v_lshlrev_b32 v113, 4, v113
    v_lshl_add_u32 v6, v112, 7, v113
    v_xor_b32 v7, 64, v6
    v_add_u32 v8, 65536, v6
    v_add_u32 v9, 65536, v7
    v_add_u32 v0, s22, v26
    v_add_u32 v1, 65536, v0
    s_lshl_b32 s10, s6, 11
    s_add_u32 s10, s10, 32768
    s_lshl_b32 s11, s7, 7
    s_add_u32 s11, s11, s10
    v_lshl_add_u32 v5, v112, 7, s10
    v_cmp_ne_u32 s[20:21], s7, v112
    v_lshlrev_b32 v116, 16, v24
    v_and_b32 v117, 0xffff0000, v24
    v_lshlrev_b32 v118, 16, v25
    v_and_b32 v119, 0xffff0000, v25
    v_add_u32 v26, s16, v26
    v_add_u32 v27, s16, v27
    s_waitcnt vmcnt(16)
    v_lshlrev_b32 v192, 16, v80
    v_and_b32 v193, 0xffff0000, v80
    v_lshlrev_b32 v194, 16, v81
    v_and_b32 v195, 0xffff0000, v81
    v_lshlrev_b32 v196, 16, v82
    v_and_b32 v197, 0xffff0000, v82
    v_lshlrev_b32 v198, 16, v83
    v_and_b32 v199, 0xffff0000, v83
    v_lshlrev_b32 v200, 16, v84
    v_and_b32 v201, 0xffff0000, v84
    v_lshlrev_b32 v202, 16, v85
    v_and_b32 v203, 0xffff0000, v85
    v_lshlrev_b32 v204, 16, v86
    v_and_b32 v205, 0xffff0000, v86
    v_lshlrev_b32 v206, 16, v87
    v_and_b32 v207, 0xffff0000, v87
    v_lshlrev_b32 v208, 16, v88
    v_and_b32 v209, 0xffff0000, v88
    v_lshlrev_b32 v210, 16, v89
    v_and_b32 v211, 0xffff0000, v89
    v_lshlrev_b32 v212, 16, v90
    v_and_b32 v213, 0xffff0000, v90
    v_lshlrev_b32 v214, 16, v91
    v_and_b32 v215, 0xffff0000, v91
    v_lshlrev_b32 v216, 16, v92
    v_and_b32 v217, 0xffff0000, v92
    v_lshlrev_b32 v218, 16, v93
    v_and_b32 v219, 0xffff0000, v93
    v_lshlrev_b32 v220, 16, v94
    v_and_b32 v221, 0xffff0000, v94
    v_lshlrev_b32 v222, 16, v95
    v_and_b32 v223, 0xffff0000, v95
    v_mul_f32 v64, v192, v116
    v_mul_f32 v72, v193, v117
    v_mul_f32 v80, v194, v118
    v_mul_f32 v88, v195, v119
    v_mul_f32 v65, v196, v116
    v_mul_f32 v73, v197, v117
    v_mul_f32 v81, v198, v118
    v_mul_f32 v89, v199, v119
    v_mul_f32 v66, v200, v116
    v_mul_f32 v74, v201, v117
    v_mul_f32 v82, v202, v118
    v_mul_f32 v90, v203, v119
    v_mul_f32 v67, v204, v116
    v_mul_f32 v75, v205, v117
    v_mul_f32 v83, v206, v118
    v_mul_f32 v91, v207, v119
    v_mul_f32 v68, v208, v116
    v_mul_f32 v76, v209, v117
    v_mul_f32 v84, v210, v118
    v_mul_f32 v92, v211, v119
    v_mul_f32 v69, v212, v116
    v_mul_f32 v77, v213, v117
    v_mul_f32 v85, v214, v118
    v_mul_f32 v93, v215, v119
    v_mul_f32 v70, v216, v116
    v_mul_f32 v78, v217, v117
    v_mul_f32 v86, v218, v118
    v_mul_f32 v94, v219, v119
    v_mul_f32 v71, v220, v116
    v_mul_f32 v79, v221, v117
    v_mul_f32 v87, v222, v118
    v_mul_f32 v95, v223, v119
    s_mov_b32 s15, 0
G_all17_w:
    ds_read_b128 v[12:15], v11 offset:0
    s_waitcnt lgkmcnt(0)
    v_min3_u32 v12, v12, v13, v14
    v_min_u32 v12, v12, v15
    v_cmp_gt_u32 vcc, 17, v12
    s_cbranch_vccz G_all17_ok
    s_add_u32 s15, s15, 1
    s_cmp_lt_u32 s15, 160000
    s_cbranch_scc1 G_all17_w
G_all17_ok:
    ds_read_b64_tr_b16 v[128:129], v20 offset:0
    ds_read_b64_tr_b16 v[130:131], v21 offset:512
    ds_read_b64_tr_b16 v[132:133], v21 offset:0
    ds_read_b64_tr_b16 v[134:135], v20 offset:512
    ds_read_b64_tr_b16 v[136:137], v20 offset:8192
    ds_read_b64_tr_b16 v[138:139], v21 offset:8704
    ds_read_b64_tr_b16 v[140:141], v21 offset:8192
    ds_read_b64_tr_b16 v[142:143], v20 offset:8704
    ds_read_b64_tr_b16 v[144:145], v20 offset:4096
    ds_read_b64_tr_b16 v[146:147], v21 offset:4608
    ds_read_b64_tr_b16 v[148:149], v21 offset:4096
    ds_read_b64_tr_b16 v[150:151], v20 offset:4608
    ds_read_b64_tr_b16 v[152:153], v20 offset:12288
    ds_read_b64_tr_b16 v[154:155], v21 offset:12800
    ds_read_b64_tr_b16 v[156:157], v21 offset:12288
    ds_read_b64_tr_b16 v[158:159], v20 offset:12800
    v_mov_b32 v18, 1
    s_waitcnt vmcnt(0)
    s_mov_b64 exec, 1
    ds_add_rtn_u32 v18, v11, v18 offset:52
    s_waitcnt lgkmcnt(0)
    v_readfirstlane_b32 s14, v18
    s_cmp_eq_u32 s14, 3
    s_cbranch_scc0 G_nl
    buffer_store_dwordx2 v[30:31], v23, s[72:75], s11 offen sc1
    s_mov_b64 exec, -1
G_nl:
    s_mov_b64 exec, -1
    s_mov_b32 s15, 0
G_f0_w:
    ds_read_b32 v18, v11 offset:60
    s_waitcnt lgkmcnt(0)
    v_cmp_gt_u32 vcc, 4, v18
    s_cbranch_vccz G_f0_ok
    s_sleep 1
    s_add_u32 s15, s15, 1
    s_cmp_lt_u32 s15, 160000
    s_cbranch_scc1 G_f0_w
G_f0_ok:
    ds_read_b128 v[192:195], v6 offset:0
    ds_read_b128 v[196:199], v6 offset:2048
    ds_read_b128 v[200:203], v6 offset:4096
    ds_read_b128 v[204:207], v6 offset:6144
    ds_read_b128 v[208:211], v7 offset:0
    ds_read_b128 v[212:215], v7 offset:2048
    ds_read_b128 v[216:219], v7 offset:4096
    s_waitcnt lgkmcnt(6)
    v_mfma_f32_16x16x32_bf16 v[64:67], v[128:131], v[192:195], v[64:67]
    ds_read_b128 v[220:223], v7 offset:6144
    v_mfma_f32_16x16x32_bf16 v[68:71], v[132:135], v[192:195], v[68:71]
    s_bfe_u32 s18, s101, 4 + (4 << 16)
    s_lshl_b32 s18, s18, 7
    buffer_load_dwordx4 v[48:51], v16, s[80:83], s18 offen offset:0
    s_waitcnt lgkmcnt(6)
    v_mfma_f32_16x16x32_bf16 v[72:75], v[128:131], v[196:199], v[72:75]
    ds_read_b128 v[192:195], v6 offset:8192
    v_mfma_f32_16x16x32_bf16 v[76:79], v[132:135], v[196:199], v[76:79]
    s_waitcnt lgkmcnt(6)
    v_mfma_f32_16x16x32_bf16 v[80:83], v[128:131], v[200:203], v[80:83]
    ds_read_b128 v[196:199], v6 offset:10240
    v_mfma_f32_16x16x32_bf16 v[84:87], v[132:135], v[200:203], v[84:87]
    buffer_load_dwordx4 v[52:55], v17, s[80:83], s18 offen offset:1024
    s_waitcnt lgkmcnt(6)
    v_mfma_f32_16x16x32_bf16 v[88:91], v[128:131], v[204:207], v[88:91]
    ds_read_b128 v[200:203], v6 offset:12288
    v_mfma_f32_16x16x32_bf16 v[92:95], v[132:135], v[204:207], v[92:95]
    s_waitcnt lgkmcnt(6)
    v_mfma_f32_16x16x32_bf16 v[64:67], v[136:139], v[208:211], v[64:67]
    ds_read_b128 v[204:207], v6 offset:14336
    v_mfma_f32_16x16x32_bf16 v[68:71], v[140:143], v[208:211], v[68:71]
    buffer_load_dwordx4 v[56:59], v16, s[80:83], s18 offen offset:2048
    s_waitcnt lgkmcnt(6)
    v_mfma_f32_16x16x32_bf16 v[72:75], v[136:139], v[212:215], v[72:75]
    ds_read_b128 v[208:211], v7 offset:8192
    v_mfma_f32_16x16x32_bf16 v[76:79], v[140:143], v[212:215], v[76:79]
    s_waitcnt lgkmcnt(6)
    v_mfma_f32_16x16x32_bf16 v[80:83], v[136:139], v[216:219], v[80:83]
    ds_read_b128 v[212:215], v7 offset:10240
    v_mfma_f32_16x16x32_bf16 v[84:87], v[140:143], v[216:219], v[84:87]
    buffer_load_dwordx4 v[60:63], v17, s[80:83], s18 offen offset:3072
    s_waitcnt lgkmcnt(6)
    v_mfma_f32_16x16x32_bf16 v[88:91], v[136:139], v[220:223], v[88:91]
    ds_read_b128 v[216:219], v7 offset:12288
    v_mfma_f32_16x16x32_bf16 v[92:95], v[140:143], v[220:223], v[92:95]
    s_waitcnt lgkmcnt(6)
    v_mfma_f32_16x16x32_bf16 v[64:67], v[144:147], v[192:195], v[64:67]
    ds_read_b128 v[220:223], v7 offset:14336
    v_mfma_f32_16x16x32_bf16 v[68:71], v[148:151], v[192:195], v[68:71]
    s_bfe_u32 s18, s101, 8 + (4 << 16)
    s_lshl_b32 s18, s18, 7
    buffer_load_dwordx4 v[32:35], v16, s[80:83], s18 offen offset:0
    s_waitcnt lgkmcnt(6)
    v_mfma_f32_16x16x32_bf16 v[72:75], v[144:147], v[196:199], v[72:75]
    ds_read_b128 v[192:195], v6 offset:16384
    v_mfma_f32_16x16x32_bf16 v[76:79], v[148:151], v[196:199], v[76:79]
    s_waitcnt lgkmcnt(6)
    v_mfma_f32_16x16x32_bf16 v[80:83], v[144:147], v[200:203], v[80:83]
    ds_read_b128 v[196:199], v6 offset:18432
    v_mfma_f32_16x16x32_bf16 v[84:87], v[148:151], v[200:203], v[84:87]
    buffer_load_dwordx4 v[36:39], v17, s[80:83], s18 offen offset:1024
    s_waitcnt lgkmcnt(6)
    v_mfma_f32_16x16x32_bf16 v[88:91], v[144:147], v[204:207], v[88:91]
    ds_read_b128 v[200:203], v6 offset:20480
    v_mfma_f32_16x16x32_bf16 v[92:95], v[148:151], v[204:207], v[92:95]
    s_waitcnt lgkmcnt(6)
    v_mfma_f32_16x16x32_bf16 v[64:67], v[152:155], v[208:211], v[64:67]
    ds_read_b128 v[204:207], v6 offset:22528
    v_mfma_f32_16x16x32_bf16 v[68:71], v[156:159], v[208:211], v[68:71]
    buffer_load_dwordx4 v[40:43], v16, s[80:83], s18 offen offset:2048
    s_waitcnt lgkmcnt(6)
    v_mfma_f32_16x16x32_bf16 v[72:75], v[152:155], v[212:215], v[72:75]
    ds_read_b128 v[208:211], v7 offset:16384
    v_mfma_f32_16x16x32_bf16 v[76:79], v[156:159], v[212:215], v[76:79]
    s_waitcnt lgkmcnt(6)
    v_mfma_f32_16x16x32_bf16 v[80:83], v[152:155], v[216:219], v[80:83]
    ds_read_b128 v[212:215], v7 offset:18432
    v_mfma_f32_16x16x32_bf16 v[84:87], v[156:159], v[216:219], v[84:87]
    buffer_load_dwordx4 v[44:47], v17, s[80:83], s18 offen offset:3072
    s_waitcnt lgkmcnt(6)
    v_mfma_f32_16x16x32_bf16 v[88:91], v[152:155], v[220:223], v[88:91]
    ds_read_b128 v[216:219], v7 offset:20480
    v_mfma_f32_16x16x32_bf16 v[92:95], v[156:159], v[220:223], v[92:95]
    v_mov_b32 v22, 18
    ds_write_b32 v10, v22
    s_bfe_u32 s18, s101, 12 + (4 << 16)
    s_lshl_b32 s18, s18, 7
    buffer_load_dwordx4 v[96:99], v16, s[80:83], s18 offen offset:0
    buffer_load_dwordx4 v[100:103], v17, s[80:83], s18 offen offset:1024
    buffer_load_dwordx4 v[104:107], v16, s[80:83], s18 offen offset:2048
    buffer_load_dwordx4 v[108:111], v17, s[80:83], s18 offen offset:3072
    s_bfe_u32 s18, s101, 16 + (4 << 16)
    s_lshl_b32 s18, s18, 7
    buffer_load_dwordx4 v[112:115], v16, s[80:83], s18 offen offset:0
    buffer_load_dwordx4 v[116:119], v17, s[80:83], s18 offen offset:1024
    buffer_load_dwordx4 v[120:123], v16, s[80:83], s18 offen offset:2048
    buffer_load_dwordx4 v[124:127], v17, s[80:83], s18 offen offset:3072
    s_mov_b32 s15, 0
G_all18_w:
    ds_read_b128 v[12:15], v11 offset:0
    s_waitcnt lgkmcnt(0)
    v_min3_u32 v12, v12, v13, v14
    v_min_u32 v12, v12, v15
    v_cmp_gt_u32 vcc, 18, v12
    s_cbranch_vccz G_all18_ok
    s_add_u32 s15, s15, 1
    s_cmp_lt_u32 s15, 160000
    s_cbranch_scc1 G_all18_w
G_all18_ok:
    s_cmp_eq_u32 s14, 3
    s_cbranch_scc0 G_pl
    buffer_load_dwordx2 v[28:29], v5, s[72:75], 0 offen sc1
G_pl:
    s_bfe_u32 s18, s100, 16 + (4 << 16)
    s_lshl_b32 s18, s18, 7
    s_add_u32 m0, s22, 65536
    s_nop 0
    buffer_load_dwordx4 v16, s[80:83], s18 offen offset:0 lds
    buffer_load_dwordx4 v17, s[80:83], s18 offen offset:1024 lds
    buffer_load_dwordx4 v16, s[80:83], s18 offen offset:2048 lds
    buffer_load_dwordx4 v17, s[80:83], s18 offen offset:3072 lds
    s_bfe_u32 s18, s100, 20 + (4 << 16)
    s_lshl_b32 s18, s18, 7
    s_add_u32 m0, s22, 81920
    s_nop 0
    buffer_load_dwordx4 v16, s[80:83], s18 offen offset:0 lds
    buffer_load_dwordx4 v17, s[80:83], s18 offen offset:1024 lds
    buffer_load_dwordx4 v16, s[80:83], s18 offen offset:2048 lds
    buffer_load_dwordx4 v17, s[80:83], s18 offen offset:3072 lds
    s_bfe_u32 s18, s100, 24 + (4 << 16)
    s_lshl_b32 s18, s18, 7
    s_add_u32 m0, s22, 0
    s_nop 0
    buffer_load_dwordx4 v16, s[80:83], s18 offen offset:0 lds
    buffer_load_dwordx4 v17, s[80:83], s18 offen offset:1024 lds
    buffer_load_dwordx4 v16, s[80:83], s18 offen offset:2048 lds
    buffer_load_dwordx4 v17, s[80:83], s18 offen offset:3072 lds
    s_mov_b32 s15, 0
    s_cmp_eq_u32 s14, 3
    s_cbranch_scc0 G_np
    s_waitcnt vmcnt(12)
GH_chk:
    v_cmp_ne_u64 vcc, v[28:29], v[30:31]
    s_and_b64 vcc, vcc, s[20:21]
    s_cbranch_scc0 GH_ok
    buffer_load_dwordx2 v[28:29], v5, s[72:75], 0 offen sc1
    s_add_u32 s15, s15, 1
    s_cmp_lt_u32 s15, 20000
    s_waitcnt vmcnt(0)
    s_cbranch_scc1 GH_chk
GH_ok:
    ds_write_b32 v11, v22 offset:56
    s_branch G_go
G_np:
    s_mov_b32 s15, 0
G_fho_w:
    ds_read_b32 v18, v11 offset:56
    s_waitcnt lgkmcnt(0)
    v_cmp_gt_u32 vcc, 1, v18
    s_cbranch_vccz G_fho_ok
    s_sleep 1
    s_add_u32 s15, s15, 1
    s_cmp_lt_u32 s15, 160000
    s_cbranch_scc1 G_fho_w
G_fho_ok:
G_go:
    s_bfe_u32 s19, s100, 4 + (4 << 16)
    s_lshl_b32 s19, s19, 13
    buffer_load_dwordx4 v[160:163], v26, s[68:71], s19 offen offset:0 sc1
    buffer_load_dwordx4 v[164:167], v26, s[68:71], s19 offen offset:1024 sc1
    buffer_load_dwordx4 v[168:171], v26, s[68:71], s19 offen offset:2048 sc1
    buffer_load_dwordx4 v[172:175], v26, s[68:71], s19 offen offset:3072 sc1
    buffer_load_dwordx4 v[176:179], v27, s[68:71], s19 offen offset:0 sc1
    buffer_load_dwordx4 v[180:183], v27, s[68:71], s19 offen offset:1024 sc1
    buffer_load_dwordx4 v[184:187], v27, s[68:71], s19 offen offset:2048 sc1
    buffer_load_dwordx4 v[188:191], v27, s[68:71], s19 offen offset:3072 sc1
    s_bfe_u32 s19, s100, 8 + (4 << 16)
    s_lshl_b32 s19, s19, 13
    buffer_load_dwordx4 v[128:131], v26, s[68:71], s19 offen offset:0 sc1
    buffer_load_dwordx4 v[132:135], v26, s[68:71], s19 offen offset:1024 sc1
    buffer_load_dwordx4 v[136:139], v26, s[68:71], s19 offen offset:2048 sc1
    buffer_load_dwordx4 v[140:143], v26, s[68:71], s19 offen offset:3072 sc1
    buffer_load_dwordx4 v[144:147], v27, s[68:71], s19 offen offset:0 sc1
    buffer_load_dwordx4 v[148:151], v27, s[68:71], s19 offen offset:1024 sc1
    buffer_load_dwordx4 v[152:155], v27, s[68:71], s19 offen offset:2048 sc1
    buffer_load_dwordx4 v[156:159], v27, s[68:71], s19 offen offset:3072 sc1
    s_setprio 1
    s_waitcnt vmcnt(14)
    v_mfma_f32_16x16x32_bf16 v[64:67], v[160:163], v[192:195], v[64:67]
    ds_read_b128 v[220:223], v7 offset:22528
    v_mfma_f32_16x16x32_bf16 v[68:71], v[164:167], v[192:195], v[68:71]
    v_mfma_f32_16x16x32_bf16 v[72:75], v[160:163], v[196:199], v[72:75]
    ds_read_b128 v[192:195], v6 offset:24576
    v_mfma_f32_16x16x32_bf16 v[76:79], v[164:167], v[196:199], v[76:79]
    v_mfma_f32_16x16x32_bf16 v[80:83], v[160:163], v[200:203], v[80:83]
    ds_read_b128 v[196:199], v6 offset:26624
    v_mfma_f32_16x16x32_bf16 v[84:87], v[164:167], v[200:203], v[84:87]
    v_mfma_f32_16x16x32_bf16 v[88:91], v[160:163], v[204:207], v[88:91]
    ds_read_b128 v[200:203], v6 offset:28672
    s_bfe_u32 s19, s100, 12 + (4 << 16)
    v_mfma_f32_16x16x32_bf16 v[92:95], v[164:167], v[204:207], v[92:95]
    s_lshl_b32 s19, s19, 13
    s_waitcnt vmcnt(12)
    v_mfma_f32_16x16x32_bf16 v[64:67], v[168:171], v[208:211], v[64:67]
    ds_read_b128 v[204:207], v6 offset:30720
    v_mfma_f32_16x16x32_bf16 v[68:71], v[172:175], v[208:211], v[68:71]
    buffer_load_dwordx4 v[160:163], v26, s[68:71], s19 offen offset:0 sc1
    v_mfma_f32_16x16x32_bf16 v[72:75], v[168:171], v[212:215], v[72:75]
    ds_read_b128 v[208:211], v7 offset:24576
    v_mfma_f32_16x16x32_bf16 v[76:79], v[172:175], v[212:215], v[76:79]
    v_mfma_f32_16x16x32_bf16 v[80:83], v[168:171], v[216:219], v[80:83]
    ds_read_b128 v[212:215], v7 offset:26624
    v_mfma_f32_16x16x32_bf16 v[84:87], v[172:175], v[216:219], v[84:87]
    buffer_load_dwordx4 v[164:167], v26, s[68:71], s19 offen offset:1024 sc1
    s_waitcnt lgkmcnt(6)
    v_mfma_f32_16x16x32_bf16 v[88:91], v[168:171], v[220:223], v[88:91]
    ds_read_b128 v[216:219], v7 offset:28672
    v_mfma_f32_16x16x32_bf16 v[92:95], v[172:175], v[220:223], v[92:95]
    s_waitcnt vmcnt(12) lgkmcnt(6)
    v_mfma_f32_16x16x32_bf16 v[64:67], v[176:179], v[192:195], v[64:67]
    ds_read_b128 v[220:223], v7 offset:30720
    v_mfma_f32_16x16x32_bf16 v[68:71], v[180:183], v[192:195], v[68:71]
    buffer_load_dwordx4 v[168:171], v26, s[68:71], s19 offen offset:2048 sc1
    s_waitcnt lgkmcnt(6)
    v_mfma_f32_16x16x32_bf16 v[72:75], v[176:179], v[196:199], v[72:75]
    ds_read_b128 v[192:195], v6 offset:32768
    v_mfma_f32_16x16x32_bf16 v[76:79], v[180:183], v[196:199], v[76:79]
    s_waitcnt lgkmcnt(6)
    v_mfma_f32_16x16x32_bf16 v[80:83], v[176:179], v[200:203], v[80:83]
    ds_read_b128 v[196:199], v6 offset:34816
    v_mfma_f32_16x16x32_bf16 v[84:87], v[180:183], v[200:203], v[84:87]
    buffer_load_dwordx4 v[172:175], v26, s[68:71], s19 offen offset:3072 sc1
    s_waitcnt lgkmcnt(6)
    v_mfma_f32_16x16x32_bf16 v[88:91], v[176:179], v[204:207], v[88:91]
    ds_read_b128 v[200:203], v6 offset:36864
    v_mfma_f32_16x16x32_bf16 v[92:95], v[180:183], v[204:207], v[92:95]
    s_waitcnt vmcnt(12) lgkmcnt(6)
    v_mfma_f32_16x16x32_bf16 v[64:67], v[184:187], v[208:211], v[64:67]
    ds_read_b128 v[204:207], v6 offset:38912
    v_mfma_f32_16x16x32_bf16 v[68:71], v[188:191], v[208:211], v[68:71]
    buffer_load_dwordx4 v[176:179], v27, s[68:71], s19 offen offset:0 sc1
    s_waitcnt lgkmcnt(6)
    v_mfma_f32_16x16x32_bf16 v[72:75], v[184:187], v[212:215], v[72:75]
    ds_read_b128 v[208:211], v7 offset:32768
    v_mfma_f32_16x16x32_bf16 v[76:79], v[188:191], v[212:215], v[76:79]
    s_waitcnt lgkmcnt(6)
    v_mfma_f32_16x16x32_bf16 v[80:83], v[184:187], v[216:219], v[80:83]
    ds_read_b128 v[212:215], v7 offset:34816
    v_mfma_f32_16x16x32_bf16 v[84:87], v[188:191], v[216:219], v[84:87]
    buffer_load_dwordx4 v[180:183], v27, s[68:71], s19 offen offset:1024 sc1
    s_waitcnt lgkmcnt(6)
    v_mfma_f32_16x16x32_bf16 v[88:91], v[184:187], v[220:223], v[88:91]
    ds_read_b128 v[216:219], v7 offset:36864
    v_mfma_f32_16x16x32_bf16 v[92:95], v[188:191], v[220:223], v[92:95]
    s_waitcnt vmcnt(12) lgkmcnt(6)
    v_mfma_f32_16x16x32_bf16 v[64:67], v[128:131], v[192:195], v[64:67]
    ds_read_b128 v[220:223], v7 offset:38912
    v_mov_b32 v22, 20
    v_mfma_f32_16x16x32_bf16 v[68:71], v[132:135], v[192:195], v[68:71]
    buffer_load_dwordx4 v[184:187], v27, s[68:71], s19 offen offset:2048 sc1
    s_waitcnt lgkmcnt(6)
    v_mfma_f32_16x16x32_bf16 v[72:75], v[128:131], v[196:199], v[72:75]
    ds_read_b128 v[192:195], v6 offset:40960
    v_mfma_f32_16x16x32_bf16 v[76:79], v[132:135], v[196:199], v[76:79]
    ds_write_b32 v10, v22
    s_waitcnt lgkmcnt(7)
    v_mfma_f32_16x16x32_bf16 v[80:83], v[128:131], v[200:203], v[80:83]
    ds_read_b128 v[196:199], v6 offset:43008
    v_mfma_f32_16x16x32_bf16 v[84:87], v[132:135], v[200:203], v[84:87]
    buffer_load_dwordx4 v[188:191], v27, s[68:71], s19 offen offset:3072 sc1
    s_waitcnt lgkmcnt(7)
    v_mfma_f32_16x16x32_bf16 v[88:91], v[128:131], v[204:207], v[88:91]
    ds_read_b128 v[200:203], v6 offset:45056
    s_bfe_u32 s19, s100, 16 + (4 << 16)
    v_mfma_f32_16x16x32_bf16 v[92:95], v[132:135], v[204:207], v[92:95]
    s_lshl_b32 s19, s19, 13
    s_waitcnt vmcnt(12) lgkmcnt(7)
    v_mfma_f32_16x16x32_bf16 v[64:67], v[136:139], v[208:211], v[64:67]
    ds_read_b128 v[204:207], v6 offset:47104
    v_mfma_f32_16x16x32_bf16 v[68:71], v[140:143], v[208:211], v[68:71]
    buffer_load_dwordx4 v[128:131], v26, s[68:71], s19 offen offset:0 sc1
    s_waitcnt lgkmcnt(7)
    v_mfma_f32_16x16x32_bf16 v[72:75], v[136:139], v[212:215], v[72:75]
    ds_read_b128 v[208:211], v7 offset:40960
    v_mfma_f32_16x16x32_bf16 v[76:79], v[140:143], v[212:215], v[76:79]
    s_waitcnt lgkmcnt(7)
    v_mfma_f32_16x16x32_bf16 v[80:83], v[136:139], v[216:219], v[80:83]
    ds_read_b128 v[212:215], v7 offset:43008
    v_mfma_f32_16x16x32_bf16 v[84:87], v[140:143], v[216:219], v[84:87]
    buffer_load_dwordx4 v[132:135], v26, s[68:71], s19 offen offset:1024 sc1
    s_waitcnt lgkmcnt(7)
    v_mfma_f32_16x16x32_bf16 v[88:91], v[136:139], v[220:223], v[88:91]
    ds_read_b128 v[216:219], v7 offset:45056
    v_mfma_f32_16x16x32_bf16 v[92:95], v[140:143], v[220:223], v[92:95]
    s_waitcnt vmcnt(12) lgkmcnt(7)
    v_mfma_f32_16x16x32_bf16 v[64:67], v[144:147], v[192:195], v[64:67]
    ds_read_b128 v[220:223], v7 offset:47104
    v_mfma_f32_16x16x32_bf16 v[68:71], v[148:151], v[192:195], v[68:71]
    buffer_load_dwordx4 v[136:139], v26, s[68:71], s19 offen offset:2048 sc1
    s_waitcnt lgkmcnt(6)
    v_mfma_f32_16x16x32_bf16 v[72:75], v[144:147], v[196:199], v[72:75]
    ds_read_b128 v[192:195], v6 offset:49152
    v_mfma_f32_16x16x32_bf16 v[76:79], v[148:151], v[196:199], v[76:79]
    s_waitcnt lgkmcnt(6)
    v_mfma_f32_16x16x32_bf16 v[80:83], v[144:147], v[200:203], v[80:83]
    ds_read_b128 v[196:199], v6 offset:51200
    ds_read_b128 v[12:15], v11
    v_mfma_f32_16x16x32_bf16 v[84:87], v[148:151], v[200:203], v[84:87]
    buffer_load_dwordx4 v[140:143], v26, s[68:71], s19 offen offset:3072 sc1
    s_waitcnt lgkmcnt(7)
    v_mfma_f32_16x16x32_bf16 v[88:91], v[144:147], v[204:207], v[88:91]
    ds_read_b128 v[200:203], v6 offset:53248
    v_mfma_f32_16x16x32_bf16 v[92:95], v[148:151], v[204:207], v[92:95]
    s_waitcnt vmcnt(12) lgkmcnt(7)
    v_mfma_f32_16x16x32_bf16 v[64:67], v[152:155], v[208:211], v[64:67]
    ds_read_b128 v[204:207], v6 offset:55296
    v_mfma_f32_16x16x32_bf16 v[68:71], v[156:159], v[208:211], v[68:71]
    buffer_load_dwordx4 v[144:147], v27, s[68:71], s19 offen offset:0 sc1
    s_waitcnt lgkmcnt(7)
    v_mfma_f32_16x16x32_bf16 v[72:75], v[152:155], v[212:215], v[72:75]
    ds_read_b128 v[208:211], v7 offset:49152
    v_mfma_f32_16x16x32_bf16 v[76:79], v[156:159], v[212:215], v[76:79]
    s_waitcnt lgkmcnt(7)
    v_mfma_f32_16x16x32_bf16 v[80:83], v[152:155], v[216:219], v[80:83]
    ds_read_b128 v[212:215], v7 offset:51200
    v_mfma_f32_16x16x32_bf16 v[84:87], v[156:159], v[216:219], v[84:87]
    buffer_load_dwordx4 v[148:151], v27, s[68:71], s19 offen offset:1024 sc1
    s_waitcnt lgkmcnt(7)
    v_mfma_f32_16x16x32_bf16 v[88:91], v[152:155], v[220:223], v[88:91]
    ds_read_b128 v[216:219], v7 offset:53248
    v_mfma_f32_16x16x32_bf16 v[92:95], v[156:159], v[220:223], v[92:95]
    s_waitcnt vmcnt(12) lgkmcnt(7)
    v_mfma_f32_16x16x32_bf16 v[64:67], v[160:163], v[192:195], v[64:67]
    ds_read_b128 v[220:223], v7 offset:55296
    v_mov_b32 v22, 21
    v_mfma_f32_16x16x32_bf16 v[68:71], v[164:167], v[192:195], v[68:71]
    buffer_load_dwordx4 v[152:155], v27, s[68:71], s19 offen offset:2048 sc1
    s_waitcnt lgkmcnt(7)
    v_mfma_f32_16x16x32_bf16 v[72:75], v[160:163], v[196:199], v[72:75]
    ds_read_b128 v[192:195], v6 offset:57344
    s_waitcnt lgkmcnt(7)
    v_min3_u32 v12, v12, v13, v14
    v_mfma_f32_16x16x32_bf16 v[76:79], v[164:167], v[196:199], v[76:79]
    ds_write_b32 v10, v22
    s_waitcnt lgkmcnt(7)
    v_mfma_f32_16x16x32_bf16 v[80:83], v[160:163], v[200:203], v[80:83]
    ds_read_b128 v[196:199], v6 offset:59392
    v_min_u32 v12, v12, v15
    v_mfma_f32_16x16x32_bf16 v[84:87], v[164:167], v[200:203], v[84:87]
    buffer_load_dwordx4 v[156:159], v27, s[68:71], s19 offen offset:3072 sc1
    s_waitcnt lgkmcnt(7)
    v_mfma_f32_16x16x32_bf16 v[88:91], v[160:163], v[204:207], v[88:91]
    ds_read_b128 v[200:203], v6 offset:61440
    s_bfe_u32 s19, s100, 20 + (4 << 16)
    v_mfma_f32_16x16x32_bf16 v[92:95], v[164:167], v[204:207], v[92:95]
    s_lshl_b32 s19, s19, 13
    s_waitcnt vmcnt(12) lgkmcnt(7)
    v_mfma_f32_16x16x32_bf16 v[64:67], v[168:171], v[208:211], v[64:67]
    ds_read_b128 v[204:207], v6 offset:63488
    v_cmp_gt_u32 vcc, 20, v12
    v_mfma_f32_16x16x32_bf16 v[68:71], v[172:175], v[208:211], v[68:71]
    buffer_load_dwordx4 v[160:163], v26, s[68:71], s19 offen offset:0 sc1
    s_waitcnt lgkmcnt(7)
    v_mfma_f32_16x16x32_bf16 v[72:75], v[168:171], v[212:215], v[72:75]
    ds_read_b128 v[208:211], v7 offset:57344
    s_cbranch_vccnz G2_slow3
G2_back3:
    v_mfma_f32_16x16x32_bf16 v[76:79], v[172:175], v[212:215], v[76:79]
    ds_write_b64 v0, v[224:225] offset:16384
    s_waitcnt lgkmcnt(8)
    v_mfma_f32_16x16x32_bf16 v[80:83], v[168:171], v[216:219], v[80:83]
    ds_read_b128 v[212:215], v7 offset:59392
    v_mfma_f32_16x16x32_bf16 v[84:87], v[172:175], v[216:219], v[84:87]
    buffer_load_dwordx4 v[164:167], v26, s[68:71], s19 offen offset:1024 sc1
    s_waitcnt lgkmcnt(8)
    v_mfma_f32_16x16x32_bf16 v[88:91], v[168:171], v[220:223], v[88:91]
    ds_read_b128 v[216:219], v7 offset:61440
    v_mfma_f32_16x16x32_bf16 v[92:95], v[172:175], v[220:223], v[92:95]
    ds_write_b64 v0, v[226:227] offset:16392
    s_waitcnt vmcnt(12) lgkmcnt(9)
    v_mfma_f32_16x16x32_bf16 v[64:67], v[176:179], v[192:195], v[64:67]
    ds_read_b128 v[220:223], v7 offset:63488
    ds_write_b64 v0, v[228:229] offset:17408
    v_mfma_f32_16x16x32_bf16 v[68:71], v[180:183], v[192:195], v[68:71]
    buffer_load_dwordx4 v[168:171], v26, s[68:71], s19 offen offset:2048 sc1
    s_waitcnt lgkmcnt(9)
    v_mfma_f32_16x16x32_bf16 v[72:75], v[176:179], v[196:199], v[72:75]
    ds_read_b128 v[192:195], v8 offset:0
    v_mfma_f32_16x16x32_bf16 v[76:79], v[180:183], v[196:199], v[76:79]
    ds_write_b64 v0, v[230:231] offset:17416
    s_waitcnt lgkmcnt(10)
    v_mfma_f32_16x16x32_bf16 v[80:83], v[176:179], v[200:203], v[80:83]
    ds_read_b128 v[196:199], v8 offset:2048
    ds_read_b128 v[12:15], v11
    v_mfma_f32_16x16x32_bf16 v[84:87], v[180:183], v[200:203], v[84:87]
    buffer_load_dwordx4 v[172:175], v26, s[68:71], s19 offen offset:3072 sc1
    s_waitcnt lgkmcnt(11)
    v_mfma_f32_16x16x32_bf16 v[88:91], v[176:179], v[204:207], v[88:91]
    ds_read_b128 v[200:203], v8 offset:4096
    v_mfma_f32_16x16x32_bf16 v[92:95], v[180:183], v[204:207], v[92:95]
    ds_write_b64 v0, v[232:233] offset:18432
    s_waitcnt vmcnt(12) lgkmcnt(12)
    v_mfma_f32_16x16x32_bf16 v[64:67], v[184:187], v[208:211], v[64:67]
    ds_read_b128 v[204:207], v8 offset:6144
    ds_write_b64 v0, v[234:235] offset:18440
    v_mfma_f32_16x16x32_bf16 v[68:71], v[188:191], v[208:211], v[68:71]
    buffer_load_dwordx4 v[176:179], v27, s[68:71], s19 offen offset:0 sc1
    s_waitcnt lgkmcnt(12)
    v_mfma_f32_16x16x32_bf16 v[72:75], v[184:187], v[212:215], v[72:75]
    ds_read_b128 v[208:211], v9 offset:0
    v_mfma_f32_16x16x32_bf16 v[76:79], v[188:191], v[212:215], v[76:79]
    ds_write_b64 v0, v[236:237] offset:19456
    s_waitcnt lgkmcnt(13)
    v_mfma_f32_16x16x32_bf16 v[80:83], v[184:187], v[216:219], v[80:83]
    ds_read_b128 v[212:215], v9 offset:2048
    v_mfma_f32_16x16x32_bf16 v[84:87], v[188:191], v[216:219], v[84:87]
    buffer_load_dwordx4 v[180:183], v27, s[68:71], s19 offen offset:1024 sc1
    s_waitcnt lgkmcnt(12)
    v_mfma_f32_16x16x32_bf16 v[88:91], v[184:187], v[220:223], v[88:91]
    ds_read_b128 v[216:219], v9 offset:4096
    v_mfma_f32_16x16x32_bf16 v[92:95], v[188:191], v[220:223], v[92:95]
    ds_write_b64 v0, v[238:239] offset:19464
    s_waitcnt vmcnt(12) lgkmcnt(12)
    v_mfma_f32_16x16x32_bf16 v[64:67], v[128:131], v[192:195], v[64:67]
    ds_read_b128 v[220:223], v9 offset:6144
    v_mov_b32 v22, 22
    v_mfma_f32_16x16x32_bf16 v[68:71], v[132:135], v[192:195], v[68:71]
    buffer_load_dwordx4 v[184:187], v27, s[68:71], s19 offen offset:2048 sc1
    s_waitcnt lgkmcnt(11)
    v_mfma_f32_16x16x32_bf16 v[72:75], v[128:131], v[196:199], v[72:75]
    ds_read_b128 v[192:195], v8 offset:8192
    s_waitcnt lgkmcnt(11)
    v_min3_u32 v12, v12, v13, v14
    v_mfma_f32_16x16x32_bf16 v[76:79], v[132:135], v[196:199], v[76:79]
    ds_write_b32 v10, v22
    s_waitcnt lgkmcnt(11)
    v_mfma_f32_16x16x32_bf16 v[80:83], v[128:131], v[200:203], v[80:83]
    ds_read_b128 v[196:199], v8 offset:10240
    v_min_u32 v12, v12, v15
    v_mfma_f32_16x16x32_bf16 v[84:87], v[132:135], v[200:203], v[84:87]
    buffer_load_dwordx4 v[188:191], v27, s[68:71], s19 offen offset:3072 sc1
    s_waitcnt lgkmcnt(10)
    v_mfma_f32_16x16x32_bf16 v[88:91], v[128:131], v[204:207], v[88:91]
    ds_read_b128 v[200:203], v8 offset:12288
    s_bfe_u32 s19, s100, 24 + (4 << 16)
    v_mfma_f32_16x16x32_bf16 v[92:95], v[132:135], v[204:207], v[92:95]
    s_lshl_b32 s19, s19, 13
    s_waitcnt vmcnt(12) lgkmcnt(9)
    v_mfma_f32_16x16x32_bf16 v[64:67], v[136:139], v[208:211], v[64:67]
    ds_read_b128 v[204:207], v8 offset:14336
    v_cmp_gt_u32 vcc, 21, v12
    v_mfma_f32_16x16x32_bf16 v[68:71], v[140:143], v[208:211], v[68:71]
    buffer_load_dwordx4 v[128:131], v26, s[68:71], s19 offen offset:0 sc1
    s_waitcnt lgkmcnt(8)
    v_mfma_f32_16x16x32_bf16 v[72:75], v[136:139], v[212:215], v[72:75]
    ds_read_b128 v[208:211], v9 offset:8192
    s_cbranch_vccnz G2_slow4
G2_back4:
    v_mfma_f32_16x16x32_bf16 v[76:79], v[140:143], v[212:215], v[76:79]
    ds_write_b64 v0, v[240:241] offset:32768
    s_waitcnt lgkmcnt(9)
    v_mfma_f32_16x16x32_bf16 v[80:83], v[136:139], v[216:219], v[80:83]
    ds_read_b128 v[212:215], v9 offset:10240
    v_mfma_f32_16x16x32_bf16 v[84:87], v[140:143], v[216:219], v[84:87]
    buffer_load_dwordx4 v[132:135], v26, s[68:71], s19 offen offset:1024 sc1
    s_waitcnt lgkmcnt(8)
    v_mfma_f32_16x16x32_bf16 v[88:91], v[136:139], v[220:223], v[88:91]
    ds_read_b128 v[216:219], v9 offset:12288
    v_mfma_f32_16x16x32_bf16 v[92:95], v[140:143], v[220:223], v[92:95]
    ds_write_b64 v0, v[242:243] offset:32776
    s_waitcnt vmcnt(12) lgkmcnt(9)
    v_mfma_f32_16x16x32_bf16 v[64:67], v[144:147], v[192:195], v[64:67]
    ds_read_b128 v[220:223], v9 offset:14336
    ds_write_b64 v0, v[244:245] offset:33792
    v_mfma_f32_16x16x32_bf16 v[68:71], v[148:151], v[192:195], v[68:71]
    buffer_load_dwordx4 v[136:139], v26, s[68:71], s19 offen offset:2048 sc1
    s_waitcnt lgkmcnt(9)
    v_mfma_f32_16x16x32_bf16 v[72:75], v[144:147], v[196:199], v[72:75]
    ds_read_b128 v[192:195], v8 offset:16384
    v_mfma_f32_16x16x32_bf16 v[76:79], v[148:151], v[196:199], v[76:79]
    ds_write_b64 v0, v[246:247] offset:33800
    s_waitcnt lgkmcnt(10)
    v_mfma_f32_16x16x32_bf16 v[80:83], v[144:147], v[200:203], v[80:83]
    ds_read_b128 v[196:199], v8 offset:18432
    ds_read_b128 v[12:15], v11
    v_mfma_f32_16x16x32_bf16 v[84:87], v[148:151], v[200:203], v[84:87]
    buffer_load_dwordx4 v[140:143], v26, s[68:71], s19 offen offset:3072 sc1
    s_waitcnt lgkmcnt(11)
    v_mfma_f32_16x16x32_bf16 v[88:91], v[144:147], v[204:207], v[88:91]
    ds_read_b128 v[200:203], v8 offset:20480
    v_mfma_f32_16x16x32_bf16 v[92:95], v[148:151], v[204:207], v[92:95]
    ds_write_b64 v0, v[248:249] offset:34816
    s_waitcnt vmcnt(12) lgkmcnt(12)
    v_mfma_f32_16x16x32_bf16 v[64:67], v[152:155], v[208:211], v[64:67]
    ds_read_b128 v[204:207], v8 offset:22528
    ds_write_b64 v0, v[250:251] offset:34824
    v_mfma_f32_16x16x32_bf16 v[68:71], v[156:159], v[208:211], v[68:71]
    buffer_load_dwordx4 v[144:147], v27, s[68:71], s19 offen offset:0 sc1
    s_waitcnt lgkmcnt(12)
    v_mfma_f32_16x16x32_bf16 v[72:75], v[152:155], v[212:215], v[72:75]
    ds_read_b128 v[208:211], v9 offset:16384
    v_mfma_f32_16x16x32_bf16 v[76:79], v[156:159], v[212:215], v[76:79]
    ds_write_b64 v0, v[252:253] offset:35840
    s_waitcnt lgkmcnt(13)
    v_mfma_f32_16x16x32_bf16 v[80:83], v[152:155], v[216:219], v[80:83]
    ds_read_b128 v[212:215], v9 offset:18432
    v_mfma_f32_16x16x32_bf16 v[84:87], v[156:159], v[216:219], v[84:87]
    buffer_load_dwordx4 v[148:151], v27, s[68:71], s19 offen offset:1024 sc1
    s_waitcnt lgkmcnt(12)
    v_mfma_f32_16x16x32_bf16 v[88:91], v[152:155], v[220:223], v[88:91]
    ds_read_b128 v[216:219], v9 offset:20480
    v_mfma_f32_16x16x32_bf16 v[92:95], v[156:159], v[220:223], v[92:95]
    ds_write_b64 v0, v[254:255] offset:35848
    s_waitcnt vmcnt(12) lgkmcnt(12)
    v_mfma_f32_16x16x32_bf16 v[64:67], v[160:163], v[192:195], v[64:67]
    ds_read_b128 v[220:223], v9 offset:22528
    v_mov_b32 v22, 23
    v_mfma_f32_16x16x32_bf16 v[68:71], v[164:167], v[192:195], v[68:71]
    buffer_load_dwordx4 v[152:155], v27, s[68:71], s19 offen offset:2048 sc1
    s_waitcnt lgkmcnt(11)
    v_mfma_f32_16x16x32_bf16 v[72:75], v[160:163], v[196:199], v[72:75]
    ds_read_b128 v[192:195], v8 offset:24576
    s_waitcnt lgkmcnt(11)
    v_min3_u32 v12, v12, v13, v14
    v_mfma_f32_16x16x32_bf16 v[76:79], v[164:167], v[196:199], v[76:79]
    ds_write_b32 v10, v22
    s_waitcnt lgkmcnt(11)
    v_mfma_f32_16x16x32_bf16 v[80:83], v[160:163], v[200:203], v[80:83]
    ds_read_b128 v[196:199], v8 offset:26624
    v_min_u32 v12, v12, v15
    v_mfma_f32_16x16x32_bf16 v[84:87], v[164:167], v[200:203], v[84:87]
    buffer_load_dwordx4 v[156:159], v27, s[68:71], s19 offen offset:3072 sc1
    s_waitcnt lgkmcnt(10)
    v_mfma_f32_16x16x32_bf16 v[88:91], v[160:163], v[204:207], v[88:91]
    ds_read_b128 v[200:203], v8 offset:28672
    s_bfe_u32 s19, s100, 28 + (4 << 16)
    v_mfma_f32_16x16x32_bf16 v[92:95], v[164:167], v[204:207], v[92:95]
    s_lshl_b32 s19, s19, 13
    s_waitcnt vmcnt(12) lgkmcnt(9)
    v_mfma_f32_16x16x32_bf16 v[64:67], v[168:171], v[208:211], v[64:67]
    ds_read_b128 v[204:207], v8 offset:30720
    v_cmp_gt_u32 vcc, 22, v12
    v_mfma_f32_16x16x32_bf16 v[68:71], v[172:175], v[208:211], v[68:71]
    buffer_load_dwordx4 v[160:163], v26, s[68:71], s19 offen offset:0 sc1
    s_waitcnt lgkmcnt(8)
    v_mfma_f32_16x16x32_bf16 v[72:75], v[168:171], v[212:215], v[72:75]
    ds_read_b128 v[208:211], v9 offset:24576
    s_cbranch_vccnz G2_slow5
G2_back5:
    v_mfma_f32_16x16x32_bf16 v[76:79], v[172:175], v[212:215], v[76:79]
    ds_write_b64 v0, v[48:49] offset:49152
    s_waitcnt lgkmcnt(9)
    v_mfma_f32_16x16x32_bf16 v[80:83], v[168:171], v[216:219], v[80:83]
    ds_read_b128 v[212:215], v9 offset:26624
    v_mfma_f32_16x16x32_bf16 v[84:87], v[172:175], v[216:219], v[84:87]
    buffer_load_dwordx4 v[164:167], v26, s[68:71], s19 offen offset:1024 sc1
    s_waitcnt lgkmcnt(8)
    v_mfma_f32_16x16x32_bf16 v[88:91], v[168:171], v[220:223], v[88:91]
    ds_read_b128 v[216:219], v9 offset:28672
    v_mfma_f32_16x16x32_bf16 v[92:95], v[172:175], v[220:223], v[92:95]
    ds_write_b64 v0, v[50:51] offset:49160
    s_waitcnt vmcnt(12) lgkmcnt(9)
    v_mfma_f32_16x16x32_bf16 v[64:67], v[176:179], v[192:195], v[64:67]
    ds_read_b128 v[220:223], v9 offset:30720
    ds_write_b64 v0, v[52:53] offset:50176
    v_mfma_f32_16x16x32_bf16 v[68:71], v[180:183], v[192:195], v[68:71]
    buffer_load_dwordx4 v[168:171], v26, s[68:71], s19 offen offset:2048 sc1
    s_waitcnt lgkmcnt(9)
    v_mfma_f32_16x16x32_bf16 v[72:75], v[176:179], v[196:199], v[72:75]
    ds_read_b128 v[192:195], v6 offset:0
    v_mfma_f32_16x16x32_bf16 v[76:79], v[180:183], v[196:199], v[76:79]
    ds_write_b64 v0, v[54:55] offset:50184
    s_waitcnt lgkmcnt(10)
    v_mfma_f32_16x16x32_bf16 v[80:83], v[176:179], v[200:203], v[80:83]
    ds_read_b128 v[196:199], v6 offset:2048
    ds_read_b128 v[12:15], v11
    v_mfma_f32_16x16x32_bf16 v[84:87], v[180:183], v[200:203], v[84:87]
    buffer_load_dwordx4 v[172:175], v26, s[68:71], s19 offen offset:3072 sc1
    s_waitcnt lgkmcnt(11)
    v_mfma_f32_16x16x32_bf16 v[88:91], v[176:179], v[204:207], v[88:91]
    ds_read_b128 v[200:203], v6 offset:4096
    v_mfma_f32_16x16x32_bf16 v[92:95], v[180:183], v[204:207], v[92:95]
    ds_write_b64 v0, v[56:57] offset:51200
    s_waitcnt vmcnt(12) lgkmcnt(12)
    v_mfma_f32_16x16x32_bf16 v[64:67], v[184:187], v[208:211], v[64:67]
    ds_read_b128 v[204:207], v6 offset:6144
    ds_write_b64 v0, v[58:59] offset:51208
    v_mfma_f32_16x16x32_bf16 v[68:71], v[188:191], v[208:211], v[68:71]
    buffer_load_dwordx4 v[176:179], v27, s[68:71], s19 offen offset:0 sc1
    s_waitcnt lgkmcnt(12)
    v_mfma_f32_16x16x32_bf16 v[72:75], v[184:187], v[212:215], v[72:75]
    ds_read_b128 v[208:211], v7 offset:0
    v_mfma_f32_16x16x32_bf16 v[76:79], v[188:191], v[212:215], v[76:79]
    ds_write_b64 v0, v[60:61] offset:52224
    s_waitcnt lgkmcnt(13)
    v_mfma_f32_16x16x32_bf16 v[80:83], v[184:187], v[216:219], v[80:83]
    ds_read_b128 v[212:215], v7 offset:2048
    v_mfma_f32_16x16x32_bf16 v[84:87], v[188:191], v[216:219], v[84:87]
    buffer_load_dwordx4 v[180:183], v27, s[68:71], s19 offen offset:1024 sc1
    s_waitcnt lgkmcnt(12)
    v_mfma_f32_16x16x32_bf16 v[88:91], v[184:187], v[220:223], v[88:91]
    ds_read_b128 v[216:219], v7 offset:4096
    v_mfma_f32_16x16x32_bf16 v[92:95], v[188:191], v[220:223], v[92:95]
    ds_write_b64 v0, v[62:63] offset:52232
    s_waitcnt vmcnt(12) lgkmcnt(12)
    v_mfma_f32_16x16x32_bf16 v[64:67], v[128:131], v[192:195], v[64:67]
    ds_read_b128 v[220:223], v7 offset:6144
    v_mov_b32 v22, 24
    v_mfma_f32_16x16x32_bf16 v[68:71], v[132:135], v[192:195], v[68:71]
    buffer_load_dwordx4 v[184:187], v27, s[68:71], s19 offen offset:2048 sc1
    s_waitcnt lgkmcnt(11)
    v_mfma_f32_16x16x32_bf16 v[72:75], v[128:131], v[196:199], v[72:75]
    ds_read_b128 v[192:195], v6 offset:8192
    s_waitcnt lgkmcnt(11)
    v_min3_u32 v12, v12, v13, v14
    v_mfma_f32_16x16x32_bf16 v[76:79], v[132:135], v[196:199], v[76:79]
    ds_write_b32 v10, v22
    s_waitcnt lgkmcnt(11)
    v_mfma_f32_16x16x32_bf16 v[80:83], v[128:131], v[200:203], v[80:83]
    ds_read_b128 v[196:199], v6 offset:10240
    v_min_u32 v12, v12, v15
    v_mfma_f32_16x16x32_bf16 v[84:87], v[132:135], v[200:203], v[84:87]
    buffer_load_dwordx4 v[188:191], v27, s[68:71], s19 offen offset:3072 sc1
    s_waitcnt lgkmcnt(10)
    v_mfma_f32_16x16x32_bf16 v[88:91], v[128:131], v[204:207], v[88:91]
    ds_read_b128 v[200:203], v6 offset:12288
    s_bfe_u32 s19, s101, 0 + (4 << 16)
    v_mfma_f32_16x16x32_bf16 v[92:95], v[132:135], v[204:207], v[92:95]
    s_lshl_b32 s19, s19, 13
    s_waitcnt vmcnt(12) lgkmcnt(9)
    v_mfma_f32_16x16x32_bf16 v[64:67], v[136:139], v[208:211], v[64:67]
    ds_read_b128 v[204:207], v6 offset:14336
    v_cmp_gt_u32 vcc, 23, v12
    v_mfma_f32_16x16x32_bf16 v[68:71], v[140:143], v[208:211], v[68:71]
    buffer_load_dwordx4 v[128:131], v26, s[68:71], s19 offen offset:0 sc1
    s_waitcnt lgkmcnt(8)
    v_mfma_f32_16x16x32_bf16 v[72:75], v[136:139], v[212:215], v[72:75]
    ds_read_b128 v[208:211], v7 offset:8192
    s_cbranch_vccnz G2_slow6
G2_back6:
    v_mfma_f32_16x16x32_bf16 v[76:79], v[140:143], v[212:215], v[76:79]
    ds_write_b64 v1, v[32:33] offset:0
    s_waitcnt lgkmcnt(9)
    v_mfma_f32_16x16x32_bf16 v[80:83], v[136:139], v[216:219], v[80:83]
    ds_read_b128 v[212:215], v7 offset:10240
    v_mfma_f32_16x16x32_bf16 v[84:87], v[140:143], v[216:219], v[84:87]
    buffer_load_dwordx4 v[132:135], v26, s[68:71], s19 offen offset:1024 sc1
    s_waitcnt lgkmcnt(8)
    v_mfma_f32_16x16x32_bf16 v[88:91], v[136:139], v[220:223], v[88:91]
    ds_read_b128 v[216:219], v7 offset:12288
    v_mfma_f32_16x16x32_bf16 v[92:95], v[140:143], v[220:223], v[92:95]
    ds_write_b64 v1, v[34:35] offset:8
    s_waitcnt vmcnt(12) lgkmcnt(9)
    v_mfma_f32_16x16x32_bf16 v[64:67], v[144:147], v[192:195], v[64:67]
    ds_read_b128 v[220:223], v7 offset:14336
    ds_write_b64 v1, v[36:37] offset:1024
    v_mfma_f32_16x16x32_bf16 v[68:71], v[148:151], v[192:195], v[68:71]
    buffer_load_dwordx4 v[136:139], v26, s[68:71], s19 offen offset:2048 sc1
    s_waitcnt lgkmcnt(9)
    v_mfma_f32_16x16x32_bf16 v[72:75], v[144:147], v[196:199], v[72:75]
    ds_read_b128 v[192:195], v6 offset:16384
    v_mfma_f32_16x16x32_bf16 v[76:79], v[148:151], v[196:199], v[76:79]
    ds_write_b64 v1, v[38:39] offset:1032
    s_waitcnt lgkmcnt(10)
    v_mfma_f32_16x16x32_bf16 v[80:83], v[144:147], v[200:203], v[80:83]
    ds_read_b128 v[196:199], v6 offset:18432
    ds_read_b128 v[12:15], v11
    v_mfma_f32_16x16x32_bf16 v[84:87], v[148:151], v[200:203], v[84:87]
    buffer_load_dwordx4 v[140:143], v26, s[68:71], s19 offen offset:3072 sc1
    s_waitcnt lgkmcnt(11)
    v_mfma_f32_16x16x32_bf16 v[88:91], v[144:147], v[204:207], v[88:91]
    ds_read_b128 v[200:203], v6 offset:20480
    v_mfma_f32_16x16x32_bf16 v[92:95], v[148:151], v[204:207], v[92:95]
    ds_write_b64 v1, v[40:41] offset:2048
    s_waitcnt vmcnt(12) lgkmcnt(12)
    v_mfma_f32_16x16x32_bf16 v[64:67], v[152:155], v[208:211], v[64:67]
    ds_read_b128 v[204:207], v6 offset:22528
    ds_write_b64 v1, v[42:43] offset:2056
    v_mfma_f32_16x16x32_bf16 v[68:71], v[156:159], v[208:211], v[68:71]
    buffer_load_dwordx4 v[144:147], v27, s[68:71], s19 offen offset:0 sc1
    s_waitcnt lgkmcnt(12)
    v_mfma_f32_16x16x32_bf16 v[72:75], v[152:155], v[212:215], v[72:75]
    ds_read_b128 v[208:211], v7 offset:16384
    v_mfma_f32_16x16x32_bf16 v[76:79], v[156:159], v[212:215], v[76:79]
    ds_write_b64 v1, v[44:45] offset:3072
    s_waitcnt lgkmcnt(13)
    v_mfma_f32_16x16x32_bf16 v[80:83], v[152:155], v[216:219], v[80:83]
    ds_read_b128 v[212:215], v7 offset:18432
    v_mfma_f32_16x16x32_bf16 v[84:87], v[156:159], v[216:219], v[84:87]
    buffer_load_dwordx4 v[148:151], v27, s[68:71], s19 offen offset:1024 sc1
    s_waitcnt lgkmcnt(12)
    v_mfma_f32_16x16x32_bf16 v[88:91], v[152:155], v[220:223], v[88:91]
    ds_read_b128 v[216:219], v7 offset:20480
    v_mfma_f32_16x16x32_bf16 v[92:95], v[156:159], v[220:223], v[92:95]
    ds_write_b64 v1, v[46:47] offset:3080
    s_waitcnt vmcnt(12) lgkmcnt(12)
    v_mfma_f32_16x16x32_bf16 v[64:67], v[160:163], v[192:195], v[64:67]
    ds_read_b128 v[220:223], v7 offset:22528
    v_mov_b32 v22, 25
    v_mfma_f32_16x16x32_bf16 v[68:71], v[164:167], v[192:195], v[68:71]
    buffer_load_dwordx4 v[152:155], v27, s[68:71], s19 offen offset:2048 sc1
    s_waitcnt lgkmcnt(11)
    v_mfma_f32_16x16x32_bf16 v[72:75], v[160:163], v[196:199], v[72:75]
    ds_read_b128 v[192:195], v6 offset:24576
    s_waitcnt lgkmcnt(11)
    v_min3_u32 v12, v12, v13, v14
    v_mfma_f32_16x16x32_bf16 v[76:79], v[164:167], v[196:199], v[76:79]
    ds_write_b32 v10, v22
    s_waitcnt lgkmcnt(11)
    v_mfma_f32_16x16x32_bf16 v[80:83], v[160:163], v[200:203], v[80:83]
    ds_read_b128 v[196:199], v6 offset:26624
    v_min_u32 v12, v12, v15
    v_mfma_f32_16x16x32_bf16 v[84:87], v[164:167], v[200:203], v[84:87]
    buffer_load_dwordx4 v[156:159], v27, s[68:71], s19 offen offset:3072 sc1
    s_waitcnt lgkmcnt(10)
    v_mfma_f32_16x16x32_bf16 v[88:91], v[160:163], v[204:207], v[88:91]
    ds_read_b128 v[200:203], v6 offset:28672
    s_bfe_u32 s19, s101, 4 + (4 << 16)
    v_mfma_f32_16x16x32_bf16 v[92:95], v[164:167], v[204:207], v[92:95]
    s_lshl_b32 s19, s19, 13
    s_waitcnt vmcnt(12) lgkmcnt(9)
    v_mfma_f32_16x16x32_bf16 v[64:67], v[168:171], v[208:211], v[64:67]
    ds_read_b128 v[204:207], v6 offset:30720
    v_cmp_gt_u32 vcc, 24, v12
    v_mfma_f32_16x16x32_bf16 v[68:71], v[172:175], v[208:211], v[68:71]
    buffer_load_dwordx4 v[160:163], v26, s[68:71], s19 offen offset:0 sc1
    s_waitcnt lgkmcnt(8)
    v_mfma_f32_16x16x32_bf16 v[72:75], v[168:171], v[212:215], v[72:75]
    ds_read_b128 v[208:211], v7 offset:24576
    s_cbranch_vccnz G2_slow7
G2_back7:
    v_mfma_f32_16x16x32_bf16 v[76:79], v[172:175], v[212:215], v[76:79]
    ds_write_b64 v1, v[96:97] offset:16384
    s_waitcnt lgkmcnt(9)
    v_mfma_f32_16x16x32_bf16 v[80:83], v[168:171], v[216:219], v[80:83]
    ds_read_b128 v[212:215], v7 offset:26624
    v_mfma_f32_16x16x32_bf16 v[84:87], v[172:175], v[216:219], v[84:87]
    buffer_load_dwordx4 v[164:167], v26, s[68:71], s19 offen offset:1024 sc1
    s_waitcnt lgkmcnt(8)
    v_mfma_f32_16x16x32_bf16 v[88:91], v[168:171], v[220:223], v[88:91]
    ds_read_b128 v[216:219], v7 offset:28672
    v_mfma_f32_16x16x32_bf16 v[92:95], v[172:175], v[220:223], v[92:95]
    ds_write_b64 v1, v[98:99] offset:16392
    s_waitcnt vmcnt(12) lgkmcnt(9)
    v_mfma_f32_16x16x32_bf16 v[64:67], v[176:179], v[192:195], v[64:67]
    ds_read_b128 v[220:223], v7 offset:30720
    ds_write_b64 v1, v[100:101] offset:17408
    v_mfma_f32_16x16x32_bf16 v[68:71], v[180:183], v[192:195], v[68:71]
    buffer_load_dwordx4 v[168:171], v26, s[68:71], s19 offen offset:2048 sc1
    s_waitcnt lgkmcnt(9)
    v_mfma_f32_16x16x32_bf16 v[72:75], v[176:179], v[196:199], v[72:75]
    ds_read_b128 v[192:195], v6 offset:32768
    v_mfma_f32_16x16x32_bf16 v[76:79], v[180:183], v[196:199], v[76:79]
    ds_write_b64 v1, v[102:103] offset:17416
    s_waitcnt lgkmcnt(10)
    v_mfma_f32_16x16x32_bf16 v[80:83], v[176:179], v[200:203], v[80:83]
    ds_read_b128 v[196:199], v6 offset:34816
    ds_read_b128 v[12:15], v11
    v_mfma_f32_16x16x32_bf16 v[84:87], v[180:183], v[200:203], v[84:87]
    buffer_load_dwordx4 v[172:175], v26, s[68:71], s19 offen offset:3072 sc1
    s_waitcnt lgkmcnt(11)
    v_mfma_f32_16x16x32_bf16 v[88:91], v[176:179], v[204:207], v[88:91]
    ds_read_b128 v[200:203], v6 offset:36864
    v_mfma_f32_16x16x32_bf16 v[92:95], v[180:183], v[204:207], v[92:95]
    ds_write_b64 v1, v[104:105] offset:18432
    s_waitcnt vmcnt(12) lgkmcnt(12)
    v_mfma_f32_16x16x32_bf16 v[64:67], v[184:187], v[208:211], v[64:67]
    ds_read_b128 v[204:207], v6 offset:38912
    ds_write_b64 v1, v[106:107] offset:18440
    v_mfma_f32_16x16x32_bf16 v[68:71], v[188:191], v[208:211], v[68:71]
    buffer_load_dwordx4 v[176:179], v27, s[68:71], s19 offen offset:0 sc1
    s_waitcnt lgkmcnt(12)
    v_mfma_f32_16x16x32_bf16 v[72:75], v[184:187], v[212:215], v[72:75]
    ds_read_b128 v[208:211], v7 offset:32768
    v_mfma_f32_16x16x32_bf16 v[76:79], v[188:191], v[212:215], v[76:79]
    ds_write_b64 v1, v[108:109] offset:19456
    s_waitcnt lgkmcnt(13)
    v_mfma_f32_16x16x32_bf16 v[80:83], v[184:187], v[216:219], v[80:83]
    ds_read_b128 v[212:215], v7 offset:34816
    v_mfma_f32_16x16x32_bf16 v[84:87], v[188:191], v[216:219], v[84:87]
    buffer_load_dwordx4 v[180:183], v27, s[68:71], s19 offen offset:1024 sc1
    s_waitcnt lgkmcnt(12)
    v_mfma_f32_16x16x32_bf16 v[88:91], v[184:187], v[220:223], v[88:91]
    ds_read_b128 v[216:219], v7 offset:36864
    v_mfma_f32_16x16x32_bf16 v[92:95], v[188:191], v[220:223], v[92:95]
    ds_write_b64 v1, v[110:111] offset:19464
    s_waitcnt vmcnt(12) lgkmcnt(12)
    v_mfma_f32_16x16x32_bf16 v[64:67], v[128:131], v[192:195], v[64:67]
    ds_read_b128 v[220:223], v7 offset:38912
    v_mfma_f32_16x16x32_bf16 v[68:71], v[132:135], v[192:195], v[68:71]
    buffer_load_dwordx4 v[184:187], v27, s[68:71], s19 offen offset:2048 sc1
    s_waitcnt lgkmcnt(11)
    v_mfma_f32_16x16x32_bf16 v[72:75], v[128:131], v[196:199], v[72:75]
    ds_read_b128 v[192:195], v6 offset:40960
    s_waitcnt lgkmcnt(11)
    v_min3_u32 v12, v12, v13, v14
    v_mfma_f32_16x16x32_bf16 v[76:79], v[132:135], v[196:199], v[76:79]
    s_waitcnt lgkmcnt(10)
    v_mfma_f32_16x16x32_bf16 v[80:83], v[128:131], v[200:203], v[80:83]
    ds_read_b128 v[196:199], v6 offset:43008
    v_min_u32 v12, v12, v15
    v_mfma_f32_16x16x32_bf16 v[84:87], v[132:135], v[200:203], v[84:87]
    buffer_load_dwordx4 v[188:191], v27, s[68:71], s19 offen offset:3072 sc1
    s_waitcnt lgkmcnt(9)
    v_mfma_f32_16x16x32_bf16 v[88:91], v[128:131], v[204:207], v[88:91]
    ds_read_b128 v[200:203], v6 offset:45056
    s_bfe_u32 s19, s101, 8 + (4 << 16)
    v_mfma_f32_16x16x32_bf16 v[92:95], v[132:135], v[204:207], v[92:95]
    s_lshl_b32 s19, s19, 13
    s_waitcnt vmcnt(12) lgkmcnt(8)
    v_mfma_f32_16x16x32_bf16 v[64:67], v[136:139], v[208:211], v[64:67]
    ds_read_b128 v[204:207], v6 offset:47104
    v_cmp_gt_u32 vcc, 25, v12
    v_mfma_f32_16x16x32_bf16 v[68:71], v[140:143], v[208:211], v[68:71]
    buffer_load_dwordx4 v[128:131], v26, s[68:71], s19 offen offset:0 sc1
    s_waitcnt lgkmcnt(7)
    v_mfma_f32_16x16x32_bf16 v[72:75], v[136:139], v[212:215], v[72:75]
    ds_read_b128 v[208:211], v7 offset:40960
    s_cbranch_vccnz G2_slow8
G2_back8:
    v_mfma_f32_16x16x32_bf16 v[76:79], v[140:143], v[212:215], v[76:79]
    ds_write_b64 v0, v[112:113] offset:0
    s_waitcnt lgkmcnt(8)
    v_mfma_f32_16x16x32_bf16 v[80:83], v[136:139], v[216:219], v[80:83]
    ds_read_b128 v[212:215], v7 offset:43008
    v_mfma_f32_16x16x32_bf16 v[84:87], v[140:143], v[216:219], v[84:87]
    buffer_load_dwordx4 v[132:135], v26, s[68:71], s19 offen offset:1024 sc1
    s_waitcnt lgkmcnt(7)
    v_mfma_f32_16x16x32_bf16 v[88:91], v[136:139], v[220:223], v[88:91]
    ds_read_b128 v[216:219], v7 offset:45056
    v_mfma_f32_16x16x32_bf16 v[92:95], v[140:143], v[220:223], v[92:95]
    ds_write_b64 v0, v[114:115] offset:8
    s_waitcnt vmcnt(12) lgkmcnt(8)
    v_mfma_f32_16x16x32_bf16 v[64:67], v[144:147], v[192:195], v[64:67]
    ds_read_b128 v[220:223], v7 offset:47104
    ds_write_b64 v0, v[116:117] offset:1024
    v_mfma_f32_16x16x32_bf16 v[68:71], v[148:151], v[192:195], v[68:71]
    buffer_load_dwordx4 v[136:139], v26, s[68:71], s19 offen offset:2048 sc1
    s_waitcnt lgkmcnt(9)
    v_mfma_f32_16x16x32_bf16 v[72:75], v[144:147], v[196:199], v[72:75]
    ds_read_b128 v[192:195], v6 offset:49152
    v_mfma_f32_16x16x32_bf16 v[76:79], v[148:151], v[196:199], v[76:79]
    ds_write_b64 v0, v[118:119] offset:1032
    s_waitcnt lgkmcnt(10)
    v_mfma_f32_16x16x32_bf16 v[80:83], v[144:147], v[200:203], v[80:83]
    ds_read_b128 v[196:199], v6 offset:51200
    v_mfma_f32_16x16x32_bf16 v[84:87], v[148:151], v[200:203], v[84:87]
    buffer_load_dwordx4 v[140:143], v26, s[68:71], s19 offen offset:3072 sc1
    s_waitcnt lgkmcnt(10)
    v_mfma_f32_16x16x32_bf16 v[88:91], v[144:147], v[204:207], v[88:91]
    ds_read_b128 v[200:203], v6 offset:53248
    v_mfma_f32_16x16x32_bf16 v[92:95], v[148:151], v[204:207], v[92:95]
    ds_write_b64 v0, v[120:121] offset:2048
    s_waitcnt vmcnt(12) lgkmcnt(11)
    v_mfma_f32_16x16x32_bf16 v[64:67], v[152:155], v[208:211], v[64:67]
    ds_read_b128 v[204:207], v6 offset:55296
    ds_write_b64 v0, v[122:123] offset:2056
    v_mfma_f32_16x16x32_bf16 v[68:71], v[156:159], v[208:211], v[68:71]
    buffer_load_dwordx4 v[144:147], v27, s[68:71], s19 offen offset:0 sc1
    s_waitcnt lgkmcnt(11)
    v_mfma_f32_16x16x32_bf16 v[72:75], v[152:155], v[212:215], v[72:75]
    ds_read_b128 v[208:211], v7 offset:49152
    v_mfma_f32_16x16x32_bf16 v[76:79], v[156:159], v[212:215], v[76:79]
    ds_write_b64 v0, v[124:125] offset:3072
    s_waitcnt lgkmcnt(12)
    v_mfma_f32_16x16x32_bf16 v[80:83], v[152:155], v[216:219], v[80:83]
    ds_read_b128 v[212:215], v7 offset:51200
    v_mfma_f32_16x16x32_bf16 v[84:87], v[156:159], v[216:219], v[84:87]
    buffer_load_dwordx4 v[148:151], v27, s[68:71], s19 offen offset:1024 sc1
    s_waitcnt lgkmcnt(11)
    v_mfma_f32_16x16x32_bf16 v[88:91], v[152:155], v[220:223], v[88:91]
    ds_read_b128 v[216:219], v7 offset:53248
    v_mfma_f32_16x16x32_bf16 v[92:95], v[156:159], v[220:223], v[92:95]
    ds_write_b64 v0, v[126:127] offset:3080
    s_waitcnt vmcnt(12) lgkmcnt(11)
    v_mfma_f32_16x16x32_bf16 v[64:67], v[160:163], v[192:195], v[64:67]
    ds_read_b128 v[220:223], v7 offset:55296
    v_mov_b32 v22, 27
    v_mfma_f32_16x16x32_bf16 v[68:71], v[164:167], v[192:195], v[68:71]
    buffer_load_dwordx4 v[152:155], v27, s[68:71], s19 offen offset:2048 sc1
    s_waitcnt lgkmcnt(10)
    v_mfma_f32_16x16x32_bf16 v[72:75], v[160:163], v[196:199], v[72:75]
    ds_read_b128 v[192:195], v6 offset:57344
    v_mfma_f32_16x16x32_bf16 v[76:79], v[164:167], v[196:199], v[76:79]
    ds_write_b32 v10, v22
    s_waitcnt lgkmcnt(11)
    v_mfma_f32_16x16x32_bf16 v[80:83], v[160:163], v[200:203], v[80:83]
    ds_read_b128 v[196:199], v6 offset:59392
    v_mfma_f32_16x16x32_bf16 v[84:87], v[164:167], v[200:203], v[84:87]
    buffer_load_dwordx4 v[156:159], v27, s[68:71], s19 offen offset:3072 sc1
    s_waitcnt lgkmcnt(10)
    v_mfma_f32_16x16x32_bf16 v[88:91], v[160:163], v[204:207], v[88:91]
    ds_read_b128 v[200:203], v6 offset:61440
    s_bfe_u32 s19, s101, 12 + (4 << 16)
    v_mfma_f32_16x16x32_bf16 v[92:95], v[164:167], v[204:207], v[92:95]
    s_lshl_b32 s19, s19, 13
    s_waitcnt vmcnt(12) lgkmcnt(9)
    v_mfma_f32_16x16x32_bf16 v[64:67], v[168:171], v[208:211], v[64:67]
    ds_read_b128 v[204:207], v6 offset:63488
    v_mfma_f32_16x16x32_bf16 v[68:71], v[172:175], v[208:211], v[68:71]
    buffer_load_dwordx4 v[160:163], v26, s[68:71], s19 offen offset:0 sc1
    s_waitcnt lgkmcnt(8)
    v_mfma_f32_16x16x32_bf16 v[72:75], v[168:171], v[212:215], v[72:75]
    ds_read_b128 v[208:211], v7 offset:57344
    v_mfma_f32_16x16x32_bf16 v[76:79], v[172:175], v[212:215], v[76:79]
    s_waitcnt lgkmcnt(8)
    v_mfma_f32_16x16x32_bf16 v[80:83], v[168:171], v[216:219], v[80:83]
    ds_read_b128 v[212:215], v7 offset:59392
    v_mfma_f32_16x16x32_bf16 v[84:87], v[172:175], v[216:219], v[84:87]
    buffer_load_dwordx4 v[164:167], v26, s[68:71], s19 offen offset:1024 sc1
    s_waitcnt lgkmcnt(7)
    v_mfma_f32_16x16x32_bf16 v[88:91], v[168:171], v[220:223], v[88:91]
    ds_read_b128 v[216:219], v7 offset:61440
    v_mfma_f32_16x16x32_bf16 v[92:95], v[172:175], v[220:223], v[92:95]
    s_waitcnt vmcnt(12) lgkmcnt(7)
    v_mfma_f32_16x16x32_bf16 v[64:67], v[176:179], v[192:195], v[64:67]
    ds_read_b128 v[220:223], v7 offset:63488
    v_mfma_f32_16x16x32_bf16 v[68:71], v[180:183], v[192:195], v[68:71]
    buffer_load_dwordx4 v[168:171], v26, s[68:71], s19 offen offset:2048 sc1
    s_waitcnt lgkmcnt(6)
    v_mfma_f32_16x16x32_bf16 v[72:75], v[176:179], v[196:199], v[72:75]
    ds_read_b128 v[192:195], v8 offset:0
    v_mfma_f32_16x16x32_bf16 v[76:79], v[180:183], v[196:199], v[76:79]
    s_waitcnt lgkmcnt(6)
    v_mfma_f32_16x16x32_bf16 v[80:83], v[176:179], v[200:203], v[80:83]
    ds_read_b128 v[196:199], v8 offset:2048
    ds_read_b128 v[12:15], v11
    v_mfma_f32_16x16x32_bf16 v[84:87], v[180:183], v[200:203], v[84:87]
    buffer_load_dwordx4 v[172:175], v26, s[68:71], s19 offen offset:3072 sc1
    s_waitcnt lgkmcnt(7)
    v_mfma_f32_16x16x32_bf16 v[88:91], v[176:179], v[204:207], v[88:91]
    ds_read_b128 v[200:203], v8 offset:4096
    v_mfma_f32_16x16x32_bf16 v[92:95], v[180:183], v[204:207], v[92:95]
    s_waitcnt vmcnt(12) lgkmcnt(7)
    v_mfma_f32_16x16x32_bf16 v[64:67], v[184:187], v[208:211], v[64:67]
    ds_read_b128 v[204:207], v8 offset:6144
    v_mfma_f32_16x16x32_bf16 v[68:71], v[188:191], v[208:211], v[68:71]
    buffer_load_dwordx4 v[176:179], v27, s[68:71], s19 offen offset:0 sc1
    s_waitcnt lgkmcnt(7)
    v_mfma_f32_16x16x32_bf16 v[72:75], v[184:187], v[212:215], v[72:75]
    ds_read_b128 v[208:211], v9 offset:0
    v_mfma_f32_16x16x32_bf16 v[76:79], v[188:191], v[212:215], v[76:79]
    s_waitcnt lgkmcnt(7)
    v_mfma_f32_16x16x32_bf16 v[80:83], v[184:187], v[216:219], v[80:83]
    ds_read_b128 v[212:215], v9 offset:2048
    v_mfma_f32_16x16x32_bf16 v[84:87], v[188:191], v[216:219], v[84:87]
    buffer_load_dwordx4 v[180:183], v27, s[68:71], s19 offen offset:1024 sc1
    s_waitcnt lgkmcnt(7)
    v_mfma_f32_16x16x32_bf16 v[88:91], v[184:187], v[220:223], v[88:91]
    ds_read_b128 v[216:219], v9 offset:4096
    v_mfma_f32_16x16x32_bf16 v[92:95], v[188:191], v[220:223], v[92:95]
    s_waitcnt vmcnt(12) lgkmcnt(7)
    v_mfma_f32_16x16x32_bf16 v[64:67], v[128:131], v[192:195], v[64:67]
    ds_read_b128 v[220:223], v9 offset:6144
    v_mfma_f32_16x16x32_bf16 v[68:71], v[132:135], v[192:195], v[68:71]
    buffer_load_dwordx4 v[184:187], v27, s[68:71], s19 offen offset:2048 sc1
    s_waitcnt lgkmcnt(7)
    v_mfma_f32_16x16x32_bf16 v[72:75], v[128:131], v[196:199], v[72:75]
    ds_read_b128 v[192:195], v8 offset:8192
    s_waitcnt lgkmcnt(7)
    v_min3_u32 v12, v12, v13, v14
    v_mfma_f32_16x16x32_bf16 v[76:79], v[132:135], v[196:199], v[76:79]
    s_waitcnt lgkmcnt(6)
    v_mfma_f32_16x16x32_bf16 v[80:83], v[128:131], v[200:203], v[80:83]
    ds_read_b128 v[196:199], v8 offset:10240
    v_min_u32 v12, v12, v15
    v_mfma_f32_16x16x32_bf16 v[84:87], v[132:135], v[200:203], v[84:87]
    buffer_load_dwordx4 v[188:191], v27, s[68:71], s19 offen offset:3072 sc1
    s_waitcnt lgkmcnt(6)
    v_mfma_f32_16x16x32_bf16 v[88:91], v[128:131], v[204:207], v[88:91]
    ds_read_b128 v[200:203], v8 offset:12288
    s_bfe_u32 s19, s101, 16 + (4 << 16)
    v_mfma_f32_16x16x32_bf16 v[92:95], v[132:135], v[204:207], v[92:95]
    s_lshl_b32 s19, s19, 13
    s_waitcnt vmcnt(12) lgkmcnt(6)
    v_mfma_f32_16x16x32_bf16 v[64:67], v[136:139], v[208:211], v[64:67]
    ds_read_b128 v[204:207], v8 offset:14336
    v_cmp_gt_u32 vcc, 27, v12
    v_mfma_f32_16x16x32_bf16 v[68:71], v[140:143], v[208:211], v[68:71]
    buffer_load_dwordx4 v[128:131], v26, s[68:71], s19 offen offset:0 sc1
    s_waitcnt lgkmcnt(6)
    v_mfma_f32_16x16x32_bf16 v[72:75], v[136:139], v[212:215], v[72:75]
    ds_read_b128 v[208:211], v9 offset:8192
    s_cbranch_vccnz G2_slow10
G2_back10:
    v_mfma_f32_16x16x32_bf16 v[76:79], v[140:143], v[212:215], v[76:79]
    s_waitcnt lgkmcnt(6)
    v_mfma_f32_16x16x32_bf16 v[80:83], v[136:139], v[216:219], v[80:83]
    ds_read_b128 v[212:215], v9 offset:10240
    v_mfma_f32_16x16x32_bf16 v[84:87], v[140:143], v[216:219], v[84:87]
    buffer_load_dwordx4 v[132:135], v26, s[68:71], s19 offen offset:1024 sc1
    s_waitcnt lgkmcnt(6)
    v_mfma_f32_16x16x32_bf16 v[88:91], v[136:139], v[220:223], v[88:91]
    ds_read_b128 v[216:219], v9 offset:12288
    v_mfma_f32_16x16x32_bf16 v[92:95], v[140:143], v[220:223], v[92:95]
    s_waitcnt vmcnt(12) lgkmcnt(6)
    v_mfma_f32_16x16x32_bf16 v[64:67], v[144:147], v[192:195], v[64:67]
    ds_read_b128 v[220:223], v9 offset:14336
    v_mfma_f32_16x16x32_bf16 v[68:71], v[148:151], v[192:195], v[68:71]
    buffer_load_dwordx4 v[136:139], v26, s[68:71], s19 offen offset:2048 sc1
    s_waitcnt lgkmcnt(6)
    v_mfma_f32_16x16x32_bf16 v[72:75], v[144:147], v[196:199], v[72:75]
    ds_read_b128 v[192:195], v8 offset:16384
    v_mfma_f32_16x16x32_bf16 v[76:79], v[148:151], v[196:199], v[76:79]
    s_waitcnt lgkmcnt(6)
    v_mfma_f32_16x16x32_bf16 v[80:83], v[144:147], v[200:203], v[80:83]
    ds_read_b128 v[196:199], v8 offset:18432
    v_mfma_f32_16x16x32_bf16 v[84:87], v[148:151], v[200:203], v[84:87]
    buffer_load_dwordx4 v[140:143], v26, s[68:71], s19 offen offset:3072 sc1
    s_waitcnt lgkmcnt(6)
    v_mfma_f32_16x16x32_bf16 v[88:91], v[144:147], v[204:207], v[88:91]
    ds_read_b128 v[200:203], v8 offset:20480
    v_mfma_f32_16x16x32_bf16 v[92:95], v[148:151], v[204:207], v[92:95]
    s_waitcnt vmcnt(12) lgkmcnt(6)
    v_mfma_f32_16x16x32_bf16 v[64:67], v[152:155], v[208:211], v[64:67]
    ds_read_b128 v[204:207], v8 offset:22528
    v_mfma_f32_16x16x32_bf16 v[68:71], v[156:159], v[208:211], v[68:71]
    buffer_load_dwordx4 v[144:147], v27, s[68:71], s19 offen offset:0 sc1
    s_waitcnt lgkmcnt(6)
    v_mfma_f32_16x16x32_bf16 v[72:75], v[152:155], v[212:215], v[72:75]
    ds_read_b128 v[208:211], v9 offset:16384
    v_mfma_f32_16x16x32_bf16 v[76:79], v[156:159], v[212:215], v[76:79]
    s_waitcnt lgkmcnt(6)
    v_mfma_f32_16x16x32_bf16 v[80:83], v[152:155], v[216:219], v[80:83]
    ds_read_b128 v[212:215], v9 offset:18432
    v_mfma_f32_16x16x32_bf16 v[84:87], v[156:159], v[216:219], v[84:87]
    buffer_load_dwordx4 v[148:151], v27, s[68:71], s19 offen offset:1024 sc1
    s_waitcnt lgkmcnt(6)
    v_mfma_f32_16x16x32_bf16 v[88:91], v[152:155], v[220:223], v[88:91]
    ds_read_b128 v[216:219], v9 offset:20480
    v_mfma_f32_16x16x32_bf16 v[92:95], v[156:159], v[220:223], v[92:95]
    s_waitcnt vmcnt(12) lgkmcnt(6)
    v_mfma_f32_16x16x32_bf16 v[64:67], v[160:163], v[192:195], v[64:67]
    ds_read_b128 v[220:223], v9 offset:22528
    v_mfma_f32_16x16x32_bf16 v[68:71], v[164:167], v[192:195], v[68:71]
    buffer_load_dwordx4 v[152:155], v27, s[68:71], s19 offen offset:2048 sc1
    s_waitcnt lgkmcnt(6)
    v_mfma_f32_16x16x32_bf16 v[72:75], v[160:163], v[196:199], v[72:75]
    ds_read_b128 v[192:195], v8 offset:24576
    v_mfma_f32_16x16x32_bf16 v[76:79], v[164:167], v[196:199], v[76:79]
    s_waitcnt lgkmcnt(6)
    v_mfma_f32_16x16x32_bf16 v[80:83], v[160:163], v[200:203], v[80:83]
    ds_read_b128 v[196:199], v8 offset:26624
    v_mfma_f32_16x16x32_bf16 v[84:87], v[164:167], v[200:203], v[84:87]
    buffer_load_dwordx4 v[156:159], v27, s[68:71], s19 offen offset:3072 sc1
    s_waitcnt lgkmcnt(6)
    v_mfma_f32_16x16x32_bf16 v[88:91], v[160:163], v[204:207], v[88:91]
    ds_read_b128 v[200:203], v8 offset:28672
    s_bfe_u32 s19, s101, 20 + (4 << 16)
    v_mfma_f32_16x16x32_bf16 v[92:95], v[164:167], v[204:207], v[92:95]
    s_lshl_b32 s19, s19, 13
    s_waitcnt vmcnt(12) lgkmcnt(6)
    v_mfma_f32_16x16x32_bf16 v[64:67], v[168:171], v[208:211], v[64:67]
    ds_read_b128 v[204:207], v8 offset:30720
    v_mfma_f32_16x16x32_bf16 v[68:71], v[172:175], v[208:211], v[68:71]
    buffer_load_dwordx4 v[160:163], v26, s[68:71], s19 offen offset:0 sc1
    s_waitcnt lgkmcnt(6)
    v_mfma_f32_16x16x32_bf16 v[72:75], v[168:171], v[212:215], v[72:75]
    ds_read_b128 v[208:211], v9 offset:24576
    v_mfma_f32_16x16x32_bf16 v[76:79], v[172:175], v[212:215], v[76:79]
    s_waitcnt lgkmcnt(6)
    v_mfma_f32_16x16x32_bf16 v[80:83], v[168:171], v[216:219], v[80:83]
    ds_read_b128 v[212:215], v9 offset:26624
    v_mfma_f32_16x16x32_bf16 v[84:87], v[172:175], v[216:219], v[84:87]
    buffer_load_dwordx4 v[164:167], v26, s[68:71], s19 offen offset:1024 sc1
    s_waitcnt lgkmcnt(6)
    v_mfma_f32_16x16x32_bf16 v[88:91], v[168:171], v[220:223], v[88:91]
    ds_read_b128 v[216:219], v9 offset:28672
    v_mfma_f32_16x16x32_bf16 v[92:95], v[172:175], v[220:223], v[92:95]
    s_waitcnt vmcnt(12) lgkmcnt(6)
    v_mfma_f32_16x16x32_bf16 v[64:67], v[176:179], v[192:195], v[64:67]
    ds_read_b128 v[220:223], v9 offset:30720
    v_mfma_f32_16x16x32_bf16 v[68:71], v[180:183], v[192:195], v[68:71]
    buffer_load_dwordx4 v[168:171], v26, s[68:71], s19 offen offset:2048 sc1
    s_waitcnt lgkmcnt(6)
    v_mfma_f32_16x16x32_bf16 v[72:75], v[176:179], v[196:199], v[72:75]
    ds_read_b128 v[192:195], v6 offset:0
    v_mfma_f32_16x16x32_bf16 v[76:79], v[180:183], v[196:199], v[76:79]
    s_waitcnt lgkmcnt(6)
    v_mfma_f32_16x16x32_bf16 v[80:83], v[176:179], v[200:203], v[80:83]
    ds_read_b128 v[196:199], v6 offset:2048
    v_mfma_f32_16x16x32_bf16 v[84:87], v[180:183], v[200:203], v[84:87]
    buffer_load_dwordx4 v[172:175], v26, s[68:71], s19 offen offset:3072 sc1
    s_waitcnt lgkmcnt(6)
    v_mfma_f32_16x16x32_bf16 v[88:91], v[176:179], v[204:207], v[88:91]
    ds_read_b128 v[200:203], v6 offset:4096
    v_mfma_f32_16x16x32_bf16 v[92:95], v[180:183], v[204:207], v[92:95]
    s_waitcnt vmcnt(12) lgkmcnt(6)
    v_mfma_f32_16x16x32_bf16 v[64:67], v[184:187], v[208:211], v[64:67]
    ds_read_b128 v[204:207], v6 offset:6144
    v_mfma_f32_16x16x32_bf16 v[68:71], v[188:191], v[208:211], v[68:71]
    buffer_load_dwordx4 v[176:179], v27, s[68:71], s19 offen offset:0 sc1
    s_waitcnt lgkmcnt(6)
    v_mfma_f32_16x16x32_bf16 v[72:75], v[184:187], v[212:215], v[72:75]
    ds_read_b128 v[208:211], v7 offset:0
    ds_read_b32 v18, v11 offset:68
    v_mfma_f32_16x16x32_bf16 v[76:79], v[188:191], v[212:215], v[76:79]
    s_waitcnt lgkmcnt(7)
    v_mfma_f32_16x16x32_bf16 v[80:83], v[184:187], v[216:219], v[80:83]
    ds_read_b128 v[212:215], v7 offset:2048
    v_mfma_f32_16x16x32_bf16 v[84:87], v[188:191], v[216:219], v[84:87]
    buffer_load_dwordx4 v[180:183], v27, s[68:71], s19 offen offset:1024 sc1
    s_waitcnt lgkmcnt(7)
    v_mfma_f32_16x16x32_bf16 v[88:91], v[184:187], v[220:223], v[88:91]
    ds_read_b128 v[216:219], v7 offset:4096
    v_mfma_f32_16x16x32_bf16 v[92:95], v[188:191], v[220:223], v[92:95]
    s_waitcnt vmcnt(12) lgkmcnt(7)
    v_mfma_f32_16x16x32_bf16 v[64:67], v[128:131], v[192:195], v[64:67]
    ds_read_b128 v[220:223], v7 offset:6144
    v_mfma_f32_16x16x32_bf16 v[68:71], v[132:135], v[192:195], v[68:71]
    buffer_load_dwordx4 v[184:187], v27, s[68:71], s19 offen offset:2048 sc1
    s_waitcnt lgkmcnt(7)
    v_mfma_f32_16x16x32_bf16 v[72:75], v[128:131], v[196:199], v[72:75]
    ds_read_b128 v[192:195], v6 offset:8192
    v_mfma_f32_16x16x32_bf16 v[76:79], v[132:135], v[196:199], v[76:79]
    s_waitcnt lgkmcnt(7)
    v_mfma_f32_16x16x32_bf16 v[80:83], v[128:131], v[200:203], v[80:83]
    ds_read_b128 v[196:199], v6 offset:10240
    v_add_u32 v8, 32768, v8
    v_mfma_f32_16x16x32_bf16 v[84:87], v[132:135], v[200:203], v[84:87]
    buffer_load_dwordx4 v[188:191], v27, s[68:71], s19 offen offset:3072 sc1
    s_waitcnt lgkmcnt(7)
    v_mfma_f32_16x16x32_bf16 v[88:91], v[128:131], v[204:207], v[88:91]
    ds_read_b128 v[200:203], v6 offset:12288
    s_bfe_u32 s19, s101, 24 + (4 << 16)
    v_mfma_f32_16x16x32_bf16 v[92:95], v[132:135], v[204:207], v[92:95]
    s_lshl_b32 s19, s19, 13
    s_waitcnt vmcnt(12) lgkmcnt(7)
    v_mfma_f32_16x16x32_bf16 v[64:67], v[136:139], v[208:211], v[64:67]
    ds_read_b128 v[204:207], v6 offset:14336
    v_add_u32 v9, 32768, v9
    v_mfma_f32_16x16x32_bf16 v[68:71], v[140:143], v[208:211], v[68:71]
    buffer_load_dwordx4 v[128:131], v26, s[68:71], s19 offen offset:0 sc1
    s_waitcnt lgkmcnt(6)
    v_mfma_f32_16x16x32_bf16 v[72:75], v[136:139], v[212:215], v[72:75]
    ds_read_b128 v[208:211], v7 offset:8192
    v_cmp_gt_u32 vcc, 4, v18
    v_mfma_f32_16x16x32_bf16 v[76:79], v[140:143], v[212:215], v[76:79]
    s_waitcnt lgkmcnt(6)
    v_mfma_f32_16x16x32_bf16 v[80:83], v[136:139], v[216:219], v[80:83]
    ds_read_b128 v[212:215], v7 offset:10240
    v_mfma_f32_16x16x32_bf16 v[84:87], v[140:143], v[216:219], v[84:87]
    buffer_load_dwordx4 v[132:135], v26, s[68:71], s19 offen offset:1024 sc1
    s_waitcnt lgkmcnt(6)
    v_mfma_f32_16x16x32_bf16 v[88:91], v[136:139], v[220:223], v[88:91]
    ds_read_b128 v[216:219], v7 offset:12288
    s_cbranch_vccnz G2_slowc
G2_backc:
    v_mfma_f32_16x16x32_bf16 v[92:95], v[140:143], v[220:223], v[92:95]
    s_waitcnt vmcnt(12) lgkmcnt(6)
    v_mfma_f32_16x16x32_bf16 v[64:67], v[144:147], v[192:195], v[64:67]
    ds_read_b128 v[220:223], v7 offset:14336
    v_mfma_f32_16x16x32_bf16 v[68:71], v[148:151], v[192:195], v[68:71]
    buffer_load_dwordx4 v[136:139], v26, s[68:71], s19 offen offset:2048 sc1
    s_waitcnt lgkmcnt(6)
    v_mfma_f32_16x16x32_bf16 v[72:75], v[144:147], v[196:199], v[72:75]
    ds_read_b128 v[192:195], v8 offset:0
    v_mfma_f32_16x16x32_bf16 v[76:79], v[148:151], v[196:199], v[76:79]
    s_waitcnt lgkmcnt(6)
    v_mfma_f32_16x16x32_bf16 v[80:83], v[144:147], v[200:203], v[80:83]
    ds_read_b128 v[196:199], v8 offset:2048
    v_mfma_f32_16x16x32_bf16 v[84:87], v[148:151], v[200:203], v[84:87]
    buffer_load_dwordx4 v[140:143], v26, s[68:71], s19 offen offset:3072 sc1
    s_waitcnt lgkmcnt(6)
    v_mfma_f32_16x16x32_bf16 v[88:91], v[144:147], v[204:207], v[88:91]
    ds_read_b128 v[200:203], v8 offset:25856
    v_mfma_f32_16x16x32_bf16 v[92:95], v[148:151], v[204:207], v[92:95]
    s_waitcnt vmcnt(12) lgkmcnt(6)
    v_mfma_f32_16x16x32_bf16 v[64:67], v[152:155], v[208:211], v[64:67]
    ds_read_b128 v[204:207], v8 offset:27904
    v_mfma_f32_16x16x32_bf16 v[68:71], v[156:159], v[208:211], v[68:71]
    buffer_load_dwordx4 v[144:147], v27, s[68:71], s19 offen offset:0 sc1
    s_waitcnt lgkmcnt(6)
    v_mfma_f32_16x16x32_bf16 v[72:75], v[152:155], v[212:215], v[72:75]
    ds_read_b128 v[208:211], v9 offset:0
    v_mfma_f32_16x16x32_bf16 v[76:79], v[156:159], v[212:215], v[76:79]
    s_waitcnt lgkmcnt(6)
    v_mfma_f32_16x16x32_bf16 v[80:83], v[152:155], v[216:219], v[80:83]
    ds_read_b128 v[212:215], v9 offset:2048
    v_mfma_f32_16x16x32_bf16 v[84:87], v[156:159], v[216:219], v[84:87]
    buffer_load_dwordx4 v[148:151], v27, s[68:71], s19 offen offset:1024 sc1
    s_waitcnt lgkmcnt(6)
    v_mfma_f32_16x16x32_bf16 v[88:91], v[152:155], v[220:223], v[88:91]
    ds_read_b128 v[216:219], v9 offset:25856
    v_mfma_f32_16x16x32_bf16 v[92:95], v[156:159], v[220:223], v[92:95]
    s_waitcnt vmcnt(12) lgkmcnt(6)
    v_mfma_f32_16x16x32_bf16 v[64:67], v[160:163], v[192:195], v[64:67]
    ds_read_b128 v[220:223], v9 offset:27904
    v_mfma_f32_16x16x32_bf16 v[68:71], v[164:167], v[192:195], v[68:71]
    buffer_load_dwordx4 v[152:155], v27, s[68:71], s19 offen offset:2048 sc1
    s_waitcnt lgkmcnt(6)
    v_mfma_f32_16x16x32_bf16 v[72:75], v[160:163], v[196:199], v[72:75]
    ds_read_b128 v[192:195], v8 offset:12928
    v_mfma_f32_16x16x32_bf16 v[76:79], v[164:167], v[196:199], v[76:79]
    s_waitcnt lgkmcnt(6)
    v_mfma_f32_16x16x32_bf16 v[80:83], v[160:163], v[200:203], v[80:83]
    ds_read_b128 v[196:199], v8 offset:14976
    v_mfma_f32_16x16x32_bf16 v[84:87], v[164:167], v[200:203], v[84:87]
    buffer_load_dwordx4 v[156:159], v27, s[68:71], s19 offen offset:3072 sc1
    s_waitcnt lgkmcnt(6)
    v_mfma_f32_16x16x32_bf16 v[88:91], v[160:163], v[204:207], v[88:91]
    ds_read_b128 v[200:203], v8 offset:38784
    s_bfe_u32 s19, s101, 28 + (4 << 16)
    v_mfma_f32_16x16x32_bf16 v[92:95], v[164:167], v[204:207], v[92:95]
    s_lshl_b32 s19, s19, 13
    s_waitcnt vmcnt(12) lgkmcnt(6)
    v_mfma_f32_16x16x32_bf16 v[64:67], v[168:171], v[208:211], v[64:67]
    ds_read_b128 v[204:207], v8 offset:40832
    v_mfma_f32_16x16x32_bf16 v[68:71], v[172:175], v[208:211], v[68:71]
    buffer_load_dwordx4 v[160:163], v26, s[68:71], s19 offen offset:0 sc1
    s_waitcnt lgkmcnt(6)
    v_mfma_f32_16x16x32_bf16 v[72:75], v[168:171], v[212:215], v[72:75]
    ds_read_b128 v[208:211], v9 offset:12928
    v_mfma_f32_16x16x32_bf16 v[76:79], v[172:175], v[212:215], v[76:79]
    s_waitcnt lgkmcnt(6)
    v_mfma_f32_16x16x32_bf16 v[80:83], v[168:171], v[216:219], v[80:83]
    ds_read_b128 v[212:215], v9 offset:14976
    v_mfma_f32_16x16x32_bf16 v[84:87], v[172:175], v[216:219], v[84:87]
    buffer_load_dwordx4 v[164:167], v26, s[68:71], s19 offen offset:1024 sc1
    s_waitcnt lgkmcnt(6)
    v_mfma_f32_16x16x32_bf16 v[88:91], v[168:171], v[220:223], v[88:91]
    ds_read_b128 v[216:219], v9 offset:38784
    v_mfma_f32_16x16x32_bf16 v[92:95], v[172:175], v[220:223], v[92:95]
    s_waitcnt vmcnt(12) lgkmcnt(6)
    v_mfma_f32_16x16x32_bf16 v[64:67], v[176:179], v[192:195], v[64:67]
    ds_read_b128 v[220:223], v9 offset:40832
    v_mfma_f32_16x16x32_bf16 v[68:71], v[180:183], v[192:195], v[68:71]
    buffer_load_dwordx4 v[168:171], v26, s[68:71], s19 offen offset:2048 sc1
    s_waitcnt lgkmcnt(6)
    v_mfma_f32_16x16x32_bf16 v[72:75], v[176:179], v[196:199], v[72:75]
    ds_read_b128 v[192:195], v8 offset:4096
    v_mfma_f32_16x16x32_bf16 v[76:79], v[180:183], v[196:199], v[76:79]
    s_waitcnt lgkmcnt(6)
    v_mfma_f32_16x16x32_bf16 v[80:83], v[176:179], v[200:203], v[80:83]
    ds_read_b128 v[196:199], v8 offset:6144
    v_mfma_f32_16x16x32_bf16 v[84:87], v[180:183], v[200:203], v[84:87]
    buffer_load_dwordx4 v[172:175], v26, s[68:71], s19 offen offset:3072 sc1
    s_waitcnt lgkmcnt(6)
    v_mfma_f32_16x16x32_bf16 v[88:91], v[176:179], v[204:207], v[88:91]
    ds_read_b128 v[200:203], v8 offset:29952
    v_mfma_f32_16x16x32_bf16 v[92:95], v[180:183], v[204:207], v[92:95]
    s_waitcnt vmcnt(12) lgkmcnt(6)
    v_mfma_f32_16x16x32_bf16 v[64:67], v[184:187], v[208:211], v[64:67]
    ds_read_b128 v[204:207], v8 offset:32000
    v_mfma_f32_16x16x32_bf16 v[68:71], v[188:191], v[208:211], v[68:71]
    buffer_load_dwordx4 v[176:179], v27, s[68:71], s19 offen offset:0 sc1
    s_waitcnt lgkmcnt(6)
    v_mfma_f32_16x16x32_bf16 v[72:75], v[184:187], v[212:215], v[72:75]
    ds_read_b128 v[208:211], v9 offset:4096
    v_mfma_f32_16x16x32_bf16 v[76:79], v[188:191], v[212:215], v[76:79]
    s_waitcnt lgkmcnt(6)
    v_mfma_f32_16x16x32_bf16 v[80:83], v[184:187], v[216:219], v[80:83]
    ds_read_b128 v[212:215], v9 offset:6144
    v_mfma_f32_16x16x32_bf16 v[84:87], v[188:191], v[216:219], v[84:87]
    buffer_load_dwordx4 v[180:183], v27, s[68:71], s19 offen offset:1024 sc1
    s_waitcnt lgkmcnt(6)
    v_mfma_f32_16x16x32_bf16 v[88:91], v[184:187], v[220:223], v[88:91]
    ds_read_b128 v[216:219], v9 offset:29952
    v_mfma_f32_16x16x32_bf16 v[92:95], v[188:191], v[220:223], v[92:95]
    s_waitcnt vmcnt(12) lgkmcnt(6)
    v_mfma_f32_16x16x32_bf16 v[64:67], v[128:131], v[192:195], v[64:67]
    ds_read_b128 v[220:223], v9 offset:32000
    v_mfma_f32_16x16x32_bf16 v[68:71], v[132:135], v[192:195], v[68:71]
    buffer_load_dwordx4 v[184:187], v27, s[68:71], s19 offen offset:2048 sc1
    s_waitcnt lgkmcnt(6)
    v_mfma_f32_16x16x32_bf16 v[72:75], v[128:131], v[196:199], v[72:75]
    ds_read_b128 v[192:195], v8 offset:17024
    v_mfma_f32_16x16x32_bf16 v[76:79], v[132:135], v[196:199], v[76:79]
    s_waitcnt lgkmcnt(6)
    v_mfma_f32_16x16x32_bf16 v[80:83], v[128:131], v[200:203], v[80:83]
    ds_read_b128 v[196:199], v8 offset:19072
    v_mfma_f32_16x16x32_bf16 v[84:87], v[132:135], v[200:203], v[84:87]
    buffer_load_dwordx4 v[188:191], v27, s[68:71], s19 offen offset:3072 sc1
    s_waitcnt lgkmcnt(6)
    v_mfma_f32_16x16x32_bf16 v[88:91], v[128:131], v[204:207], v[88:91]
    ds_read_b128 v[200:203], v8 offset:42880
    v_mfma_f32_16x16x32_bf16 v[92:95], v[132:135], v[204:207], v[92:95]
    s_waitcnt vmcnt(12) lgkmcnt(6)
    v_mfma_f32_16x16x32_bf16 v[64:67], v[136:139], v[208:211], v[64:67]
    ds_read_b128 v[204:207], v8 offset:44928
    v_mfma_f32_16x16x32_bf16 v[68:71], v[140:143], v[208:211], v[68:71]
    s_waitcnt lgkmcnt(6)
    v_mfma_f32_16x16x32_bf16 v[72:75], v[136:139], v[212:215], v[72:75]
    ds_read_b128 v[208:211], v9 offset:17024
    v_mfma_f32_16x16x32_bf16 v[76:79], v[140:143], v[212:215], v[76:79]
    s_waitcnt lgkmcnt(6)
    v_mfma_f32_16x16x32_bf16 v[80:83], v[136:139], v[216:219], v[80:83]
    ds_read_b128 v[212:215], v9 offset:19072
    v_mfma_f32_16x16x32_bf16 v[84:87], v[140:143], v[216:219], v[84:87]
    s_waitcnt lgkmcnt(6)
    v_mfma_f32_16x16x32_bf16 v[88:91], v[136:139], v[220:223], v[88:91]
    ds_read_b128 v[216:219], v9 offset:42880
    v_mfma_f32_16x16x32_bf16 v[92:95], v[140:143], v[220:223], v[92:95]
    s_waitcnt vmcnt(10) lgkmcnt(6)
    v_mfma_f32_16x16x32_bf16 v[64:67], v[144:147], v[192:195], v[64:67]
    ds_read_b128 v[220:223], v9 offset:44928
    v_mfma_f32_16x16x32_bf16 v[68:71], v[148:151], v[192:195], v[68:71]
    s_waitcnt lgkmcnt(6)
    v_mfma_f32_16x16x32_bf16 v[72:75], v[144:147], v[196:199], v[72:75]
    ds_read_b128 v[192:195], v8 offset:8192
    v_mfma_f32_16x16x32_bf16 v[76:79], v[148:151], v[196:199], v[76:79]
    s_waitcnt lgkmcnt(6)
    v_mfma_f32_16x16x32_bf16 v[80:83], v[144:147], v[200:203], v[80:83]
    ds_read_b128 v[196:199], v8 offset:10240
    v_mfma_f32_16x16x32_bf16 v[84:87], v[148:151], v[200:203], v[84:87]
    s_waitcnt lgkmcnt(6)
    v_mfma_f32_16x16x32_bf16 v[88:91], v[144:147], v[204:207], v[88:91]
    ds_read_b128 v[200:203], v8 offset:34048
    v_mfma_f32_16x16x32_bf16 v[92:95], v[148:151], v[204:207], v[92:95]
    s_waitcnt vmcnt(8) lgkmcnt(6)
    v_mfma_f32_16x16x32_bf16 v[64:67], v[152:155], v[208:211], v[64:67]
    ds_read_b128 v[204:207], v8 offset:36096
    v_mfma_f32_16x16x32_bf16 v[68:71], v[156:159], v[208:211], v[68:71]
    s_waitcnt lgkmcnt(6)
    v_mfma_f32_16x16x32_bf16 v[72:75], v[152:155], v[212:215], v[72:75]
    ds_read_b128 v[208:211], v9 offset:8192
    v_mfma_f32_16x16x32_bf16 v[76:79], v[156:159], v[212:215], v[76:79]
    s_waitcnt lgkmcnt(6)
    v_mfma_f32_16x16x32_bf16 v[80:83], v[152:155], v[216:219], v[80:83]
    ds_read_b128 v[212:215], v9 offset:10240
    v_mfma_f32_16x16x32_bf16 v[84:87], v[156:159], v[216:219], v[84:87]
    s_waitcnt lgkmcnt(6)
    v_mfma_f32_16x16x32_bf16 v[88:91], v[152:155], v[220:223], v[88:91]
    ds_read_b128 v[216:219], v9 offset:34048
    v_mfma_f32_16x16x32_bf16 v[92:95], v[156:159], v[220:223], v[92:95]
    s_waitcnt vmcnt(6) lgkmcnt(6)
    v_mfma_f32_16x16x32_bf16 v[64:67], v[160:163], v[192:195], v[64:67]
    ds_read_b128 v[220:223], v9 offset:36096
    v_mfma_f32_16x16x32_bf16 v[68:71], v[164:167], v[192:195], v[68:71]
    s_waitcnt lgkmcnt(6)
    v_mfma_f32_16x16x32_bf16 v[72:75], v[160:163], v[196:199], v[72:75]
    ds_read_b128 v[192:195], v8 offset:21120
    v_mfma_f32_16x16x32_bf16 v[76:79], v[164:167], v[196:199], v[76:79]
    s_waitcnt lgkmcnt(6)
    v_mfma_f32_16x16x32_bf16 v[80:83], v[160:163], v[200:203], v[80:83]
    ds_read_b128 v[196:199], v8 offset:23168
    v_mfma_f32_16x16x32_bf16 v[84:87], v[164:167], v[200:203], v[84:87]
    s_waitcnt lgkmcnt(6)
    v_mfma_f32_16x16x32_bf16 v[88:91], v[160:163], v[204:207], v[88:91]
    ds_read_b128 v[200:203], v8 offset:46976
    v_mfma_f32_16x16x32_bf16 v[92:95], v[164:167], v[204:207], v[92:95]
    s_waitcnt vmcnt(4) lgkmcnt(6)
    v_mfma_f32_16x16x32_bf16 v[64:67], v[168:171], v[208:211], v[64:67]
    ds_read_b128 v[204:207], v8 offset:49024
    v_mfma_f32_16x16x32_bf16 v[68:71], v[172:175], v[208:211], v[68:71]
    s_waitcnt lgkmcnt(6)
    v_mfma_f32_16x16x32_bf16 v[72:75], v[168:171], v[212:215], v[72:75]
    ds_read_b128 v[208:211], v9 offset:21120
    v_mfma_f32_16x16x32_bf16 v[76:79], v[172:175], v[212:215], v[76:79]
    s_waitcnt lgkmcnt(6)
    v_mfma_f32_16x16x32_bf16 v[80:83], v[168:171], v[216:219], v[80:83]
    ds_read_b128 v[212:215], v9 offset:23168
    v_mfma_f32_16x16x32_bf16 v[84:87], v[172:175], v[216:219], v[84:87]
    s_waitcnt lgkmcnt(6)
    v_mfma_f32_16x16x32_bf16 v[88:91], v[168:171], v[220:223], v[88:91]
    ds_read_b128 v[216:219], v9 offset:46976
    v_mfma_f32_16x16x32_bf16 v[92:95], v[172:175], v[220:223], v[92:95]
    s_waitcnt vmcnt(2) lgkmcnt(6)
    v_mfma_f32_16x16x32_bf16 v[64:67], v[176:179], v[192:195], v[64:67]
    ds_read_b128 v[220:223], v9 offset:49024
    v_mfma_f32_16x16x32_bf16 v[68:71], v[180:183], v[192:195], v[68:71]
    s_waitcnt lgkmcnt(6)
    v_mfma_f32_16x16x32_bf16 v[72:75], v[176:179], v[196:199], v[72:75]
    v_mfma_f32_16x16x32_bf16 v[76:79], v[180:183], v[196:199], v[76:79]
    s_waitcnt lgkmcnt(5)
    v_mfma_f32_16x16x32_bf16 v[80:83], v[176:179], v[200:203], v[80:83]
    v_mfma_f32_16x16x32_bf16 v[84:87], v[180:183], v[200:203], v[84:87]
    s_waitcnt lgkmcnt(4)
    v_mfma_f32_16x16x32_bf16 v[88:91], v[176:179], v[204:207], v[88:91]
    v_mfma_f32_16x16x32_bf16 v[92:95], v[180:183], v[204:207], v[92:95]
    s_waitcnt vmcnt(0) lgkmcnt(3)
    v_mfma_f32_16x16x32_bf16 v[64:67], v[184:187], v[208:211], v[64:67]
    v_mfma_f32_16x16x32_bf16 v[68:71], v[188:191], v[208:211], v[68:71]
    s_waitcnt lgkmcnt(2)
    v_mfma_f32_16x16x32_bf16 v[72:75], v[184:187], v[212:215], v[72:75]
    v_mfma_f32_16x16x32_bf16 v[76:79], v[188:191], v[212:215], v[76:79]
    s_waitcnt lgkmcnt(1)
    v_mfma_f32_16x16x32_bf16 v[80:83], v[184:187], v[216:219], v[80:83]
    v_mfma_f32_16x16x32_bf16 v[84:87], v[188:191], v[216:219], v[84:87]
    s_waitcnt lgkmcnt(0)
    v_mfma_f32_16x16x32_bf16 v[88:91], v[184:187], v[220:223], v[88:91]
    v_mfma_f32_16x16x32_bf16 v[92:95], v[188:191], v[220:223], v[92:95]
    s_lshl_b32 s10, s6, 7
    s_lshl_b32 s11, s3, 5
    s_add_u32 s10, s10, s11
    v_lshrrev_b32 v32, 4, v2
    v_lshl_add_u32 v32, v32, 2, s10
    s_lshl_b32 s10, s7, 8
    s_add_u32 s10, s10, 4096
    v_and_b32 v33, 15, v2
    v_lshl_add_u32 v33, v33, 4, s10
    v_lshl_add_u32 v32, v32, 13, v33
    v_mov_b32 v224, v64
    v_mov_b32 v225, v72
    v_mov_b32 v226, v80
    v_mov_b32 v227, v88
    s_mov_b32 s10, 0
    buffer_store_dwordx4 v[224:227], v32, s[60:63], s10 offen nt
    v_mov_b32 v228, v65
    v_mov_b32 v229, v73
    v_mov_b32 v230, v81
    v_mov_b32 v231, v89
    s_mov_b32 s10, 8192
    buffer_store_dwordx4 v[228:231], v32, s[60:63], s10 offen nt
    v_mov_b32 v232, v66
    v_mov_b32 v233, v74
    v_mov_b32 v234, v82
    v_mov_b32 v235, v90
    s_mov_b32 s10, 16384
    buffer_store_dwordx4 v[232:235], v32, s[60:63], s10 offen nt
    v_mov_b32 v236, v67
    v_mov_b32 v237, v75
    v_mov_b32 v238, v83
    v_mov_b32 v239, v91
    s_mov_b32 s10, 24576
    buffer_store_dwordx4 v[236:239], v32, s[60:63], s10 offen nt
    v_mov_b32 v240, v68
    v_mov_b32 v241, v76
    v_mov_b32 v242, v84
    v_mov_b32 v243, v92
    s_mov_b32 s10, 131072
    buffer_store_dwordx4 v[240:243], v32, s[60:63], s10 offen nt
    v_mov_b32 v244, v69
    v_mov_b32 v245, v77
    v_mov_b32 v246, v85
    v_mov_b32 v247, v93
    s_mov_b32 s10, 139264
    buffer_store_dwordx4 v[244:247], v32, s[60:63], s10 offen nt
    v_mov_b32 v248, v70
    v_mov_b32 v249, v78
    v_mov_b32 v250, v86
    v_mov_b32 v251, v94
    s_mov_b32 s10, 147456
    buffer_store_dwordx4 v[248:251], v32, s[60:63], s10 offen nt
    v_mov_b32 v252, v71
    v_mov_b32 v253, v79
    v_mov_b32 v254, v87
    v_mov_b32 v255, v95
    s_mov_b32 s10, 155648
    buffer_store_dwordx4 v[252:255], v32, s[60:63], s10 offen nt
    s_endpgm
G2_slow3:
    s_mov_b32 s15, 0
G2_sl3_w:
    ds_read_b128 v[12:15], v11 offset:0
    s_waitcnt lgkmcnt(0)
    v_min3_u32 v12, v12, v13, v14
    v_min_u32 v12, v12, v15
    v_cmp_gt_u32 vcc, 20, v12
    s_cbranch_vccz G2_sl3_ok
    s_add_u32 s15, s15, 1
    s_cmp_lt_u32 s15, 160000
    s_cbranch_scc1 G2_sl3_w
G2_sl3_ok:
    s_branch G2_back3
G2_slow4:
    s_mov_b32 s15, 0
G2_sl4_w:
    ds_read_b128 v[12:15], v11 offset:0
    s_waitcnt lgkmcnt(0)
    v_min3_u32 v12, v12, v13, v14
    v_min_u32 v12, v12, v15
    v_cmp_gt_u32 vcc, 21, v12
    s_cbranch_vccz G2_sl4_ok
    s_add_u32 s15, s15, 1
    s_cmp_lt_u32 s15, 160000
    s_cbranch_scc1 G2_sl4_w
G2_sl4_ok:
    s_branch G2_back4
G2_slow5:
    s_mov_b32 s15, 0
G2_sl5_w:
    ds_read_b128 v[12:15], v11 offset:0
    s_waitcnt lgkmcnt(0)
    v_min3_u32 v12, v12, v13, v14
    v_min_u32 v12, v12, v15
    v_cmp_gt_u32 vcc, 22, v12
    s_cbranch_vccz G2_sl5_ok
    s_add_u32 s15, s15, 1
    s_cmp_lt_u32 s15, 160000
    s_cbranch_scc1 G2_sl5_w
G2_sl5_ok:
    s_branch G2_back5
G2_slow6:
    s_mov_b32 s15, 0
G2_sl6_w:
    ds_read_b128 v[12:15], v11 offset:0
    s_waitcnt lgkmcnt(0)
    v_min3_u32 v12, v12, v13, v14
    v_min_u32 v12, v12, v15
    v_cmp_gt_u32 vcc, 23, v12
    s_cbranch_vccz G2_sl6_ok
    s_add_u32 s15, s15, 1
    s_cmp_lt_u32 s15, 160000
    s_cbranch_scc1 G2_sl6_w
G2_sl6_ok:
    s_branch G2_back6
G2_slow7:
    s_mov_b32 s15, 0
G2_sl7_w:
    ds_read_b128 v[12:15], v11 offset:0
    s_waitcnt lgkmcnt(0)
    v_min3_u32 v12, v12, v13, v14
    v_min_u32 v12, v12, v15
    v_cmp_gt_u32 vcc, 24, v12
    s_cbranch_vccz G2_sl7_ok
    s_add_u32 s15, s15, 1
    s_cmp_lt_u32 s15, 160000
    s_cbranch_scc1 G2_sl7_w
G2_sl7_ok:
    s_branch G2_back7
G2_slow8:
    s_mov_b32 s15, 0
G2_sl8_w:
    ds_read_b128 v[12:15], v11 offset:0
    s_waitcnt lgkmcnt(0)
    v_min3_u32 v12, v12, v13, v14
    v_min_u32 v12, v12, v15
    v_cmp_gt_u32 vcc, 25, v12
    s_cbranch_vccz G2_sl8_ok
    s_add_u32 s15, s15, 1
    s_cmp_lt_u32 s15, 160000
    s_cbranch_scc1 G2_sl8_w
G2_sl8_ok:
    s_branch G2_back8
G2_slow10:
    s_mov_b32 s15, 0
G2_sl10_w:
    ds_read_b128 v[12:15], v11 offset:0
    s_waitcnt lgkmcnt(0)
    v_min3_u32 v12, v12, v13, v14
    v_min_u32 v12, v12, v15
    v_cmp_gt_u32 vcc, 27, v12
    s_cbranch_vccz G2_sl10_ok
    s_add_u32 s15, s15, 1
    s_cmp_lt_u32 s15, 160000
    s_cbranch_scc1 G2_sl10_w
G2_sl10_ok:
    s_branch G2_back10
G2_slowc:
    s_mov_b32 s15, 0
G2_slc_w:
    ds_read_b32 v18, v11 offset:68
    s_waitcnt lgkmcnt(0)
    v_cmp_gt_u32 vcc, 4, v18
    s_cbranch_vccz G2_slc_ok
    s_add_u32 s15, s15, 1
    s_cmp_lt_u32 s15, 160000
    s_cbranch_scc1 G2_slc_w
G2_slc_ok:
    s_branch G2_backc
Y_done:
    s_endpgm
Y_end:
.section .rodata,"a"
.p2align 6
.amdhsa_kernel concat_heads__ssm_conv_h3__ssm_conv_s5__prompt_kernel
  .amdhsa_next_free_vgpr 256
  .amdhsa_next_free_sgpr 102
  .amdhsa_accum_offset 256
  .amdhsa_group_segment_fixed_size 0
  .amdhsa_kernarg_size 144
  .amdhsa_user_sgpr_count 2
  .amdhsa_user_sgpr_kernarg_segment_ptr 1
  .amdhsa_system_sgpr_workgroup_id_x 1
.end_amdhsa_kernel
```

```asm
; @launch grid=(256,1,1) block=(512,1,1) lds=163840
.amdgcn_target "amdgcn-amd-amdhsa--gfx950"
.text
.globl concat_heads__ssm_conv_h3__ssm_conv_s5__prompt_kernel
.p2align 8
.type concat_heads__ssm_conv_h3__ssm_conv_s5__prompt_kernel,@function
concat_heads__ssm_conv_h3__ssm_conv_s5__prompt_kernel:
    s_cmp_ge_u32 s2, 256
    s_cbranch_scc1 Y_done
    s_load_dwordx16 s[16:31], s[0:1], 0
    s_load_dwordx16 s[32:47], s[0:1], 64
    s_load_dwordx4 s[48:51], s[0:1], 128
    s_getpc_b64 s[52:53]
Y_pc:
    v_lshrrev_b32 v1, 6, v0
    v_and_b32 v2, 63, v0
    s_and_b32 s4, s2, 7
    v_readfirstlane_b32 s3, v1
    s_lshr_b32 s5, s2, 3
    s_and_b32 s6, s4, 1
    s_lshl_b32 s6, s6, 3
    s_and_b32 s7, s5, 7
    s_add_u32 s6, s6, s7
    s_and_b32 s7, s4, 6
    s_lshl_b32 s7, s7, 1
    s_lshr_b32 s8, s5, 3
    s_add_u32 s7, s7, s8
    s_cmp_lt_u32 s3, 4
    s_cbranch_scc0 Y_L
    s_lshl_b32 s54, s5, 2
    s_add_u32 s54, s54, s3
    s_lshl_b32 s54, s54, 7
    s_load_dword s56, s[52:53], s54
    s_add_u32 s54, s54, 64
    s_load_dword s57, s[52:53], s54
    s_add_u32 s54, s54, 16320
    s_min_u32 s54, s54, Y_end-Y_pc-4
    s_load_dword s58, s[52:53], s54
    s_add_u32 s54, s54, 64
    s_min_u32 s54, s54, Y_end-Y_pc-4
    s_load_dword s59, s[52:53], s54
    s_barrier
    s_branch Y_G
Y_L:
    s_add_u32 s13, s5, s8
    s_lshl_b32 s13, s13, 3
    s_and_b32 s9, s4, 6
    s_add_u32 s13, s13, s9
    s_and_b32 s9, s4, 1
    s_lshl_b32 s9, s9, 2
    s_add_u32 s13, s13, s9
    s_and_b32 s13, s13, 15
    s_lshl_b32 s13, s13, 7
    s_setprio 2
    s_sub_u32 s8, s3, 4
    s_lshr_b32 s11, s8, 1
    s_and_b32 s9, s8, 1
    s_cmp_eq_u32 s11, 1
    s_cbranch_scc1 L_ns0
    s_lshl_b32 s10, s6, 7
    s_lshl_b32 s12, s9, 6
    s_add_u32 s10, s10, s12
    v_and_b32 v24, 32, v2
    v_bfe_u32 v25, v2, 3, 1
    v_lshl_add_u32 v24, v25, 4, v24
    v_bfe_u32 v25, v2, 4, 1
    v_add_u32 v24, v24, v25
    v_add_u32 v24, s10, v24
    v_lshlrev_b32 v24, 11, v24
    v_lshrrev_b32 v25, 4, v2
    v_xor_b32 v25, v25, v2
    v_and_b32 v25, 7, v25
    v_lshl_add_u32 v4, v25, 4, v24
    v_xor_b32 v5, 64, v4
    v_add_u32 v5, 3072, v5
    v_add_u32 v6, 6144, v4
    v_add_u32 v7, 6144, v5
    s_lshl_b32 s10, s7, 6
    v_lshrrev_b32 v24, 3, v2
    s_lshl_b32 s12, s9, 5
    s_add_u32 s10, s10, s12
    v_add_u32 v24, s10, v24
    v_lshlrev_b32 v24, 11, v24
    v_lshrrev_b32 v25, 4, v2
    v_xor_b32 v25, v25, v2
    v_and_b32 v25, 7, v25
    v_lshl_add_u32 v8, v25, 4, v24
    v_xor_b32 v9, 64, v8
    v_add_u32 v9, 15360, v9
    v_add_u32 v10, 30720, v8
    v_add_u32 v11, 30720, v9
    s_lshl_b32 s14, s8, 13
    s_mov_b32 s54, 4194304
    s_mov_b32 s55, 0x00020000
    s_mov_b32 s58, 2097152
    s_mov_b32 s59, 0x00020000
    s_mov_b32 s62, 2097152
    s_mov_b32 s63, 0x00020000
    s_waitcnt lgkmcnt(0)
    s_mov_b32 s52, s28
    s_mov_b32 s53, s29
    s_mov_b32 s56, s34
    s_mov_b32 s57, s35
    s_mov_b32 s60, s36
    s_mov_b32 s61, s37
    s_mov_b32 s22, 1043403025
    s_mov_b32 s23, 17895742
    s_add_u32 m0, s14, 0
    s_nop 0
    buffer_load_dwordx4 v4, s[52:55], s13 offen offset:0 lds
    buffer_load_dwordx4 v5, s[52:55], s13 offen offset:1024 lds
    buffer_load_dwordx4 v6, s[52:55], s13 offen offset:2048 lds
    buffer_load_dwordx4 v7, s[52:55], s13 offen offset:3072 lds
    s_add_u32 m0, s14, 16384
    s_nop 0
    buffer_load_dwordx4 v8, s[56:59], s13 offen offset:0 lds
    buffer_load_dwordx4 v9, s[56:59], s13 offen offset:1024 lds
    buffer_load_dwordx4 v10, s[56:59], s13 offen offset:2048 lds
    buffer_load_dwordx4 v11, s[56:59], s13 offen offset:3072 lds
    s_add_u32 m0, s14, 4096
    s_add_u32 s12, s13, 16384
    buffer_load_dwordx4 v4, s[52:55], s12 offen offset:0 lds
    buffer_load_dwordx4 v5, s[52:55], s12 offen offset:1024 lds
    buffer_load_dwordx4 v6, s[52:55], s12 offen offset:2048 lds
    buffer_load_dwordx4 v7, s[52:55], s12 offen offset:3072 lds
    s_add_u32 m0, s14, 20480
    s_nop 0
    buffer_load_dwordx4 v8, s[60:63], s13 offen offset:0 lds
    buffer_load_dwordx4 v9, s[60:63], s13 offen offset:1024 lds
    buffer_load_dwordx4 v10, s[60:63], s13 offen offset:2048 lds
    buffer_load_dwordx4 v11, s[60:63], s13 offen offset:3072 lds
    s_and_b32 s12, s22, 15
    s_lshl_b32 s12, s12, 7
    s_add_u32 s13, s13, s12
    s_lshr_b64 s[22:23], s[22:23], 4
    s_and_b32 s13, s13, 2047
    s_add_u32 s14, s14, 32768
    s_and_b32 s14, s14, 131071
L_ns0:
    v_and_b32 v60, 31, v2
    v_mov_b32 v61, 0
    v_mov_b32 v62, 163712
    v_lshl_add_u32 v60, v60, 2, v62
    ds_write_b32 v60, v61
    s_and_b32 s68, s4, 6
    s_add_u32 s69, s5, s68
    s_lshl_b32 s69, s69, 1
    s_and_b32 s68, s4, 1
    s_add_u32 s69, s69, s68
    s_and_b32 s69, s69, 15
    s_mov_b32 s100, 0x76543210
    s_mov_b32 s101, 0xfedcba98
    s_lshl_b32 s68, s69, 2
    s_lshr_b64 s[64:65], s[100:101], s68
    s_sub_u32 s68, 64, s68
    s_lshl_b64 s[100:101], s[100:101], s68
    s_or_b64 s[100:101], s[100:101], s[64:65]
    s_sub_u32 s68, s7, s69
    s_and_b32 s68, s68, 15
    s_lshl_b32 s68, s68, 2
    s_bfm_b64 s[64:65], s68, 0
    s_and_b64 s[66:67], s[100:101], s[64:65]
    s_lshl_b64 s[66:67], s[66:67], 4
    s_lshl_b64 s[64:65], s[64:65], 4
    s_or_b32 s64, s64, 15
    s_andn2_b64 s[100:101], s[100:101], s[64:65]
    s_or_b64 s[100:101], s[100:101], s[66:67]
    s_or_b32 s100, s100, s7
    s_waitcnt lgkmcnt(0)
    s_barrier
    v_mov_b32 v19, 0
    s_lshl_b32 s10, s3, 2
    s_add_u32 s10, s10, 163712
    v_mov_b32 v22, s10
    v_mov_b32 v21, 163712
    s_add_u32 s72, s50, 17825792
    s_addc_u32 s73, s51, 0
    s_mov_b32 s74, 24576
    s_mov_b32 s75, 0x00020000
    s_mov_b32 s76, s48
    s_mov_b32 s77, s49
    s_mov_b32 s78, 256
    s_mov_b32 s79, 0x00020000
    s_mov_b32 s37, s100
    s_mov_b32 s30, s101
    s_lshl_b32 s100, s4, 7
    s_lshl_b32 s10, s5, 2
    s_add_u32 s100, s100, s10
    s_add_u32 s100, s100, s8
    s_lshr_b32 s10, s100, 1
    s_lshl_b32 s10, s10, 2
    s_load_dword s31, s[26:27], s10
    s_mul_i32 s101, s8, 12928
    s_add_u32 s101, s101, 98304
    s_lshl_b32 s10, s7, 5
    s_add_u32 s10, s10, s11
    s_lshl_b32 s10, s10, 12
    v_lshrrev_b32 v24, 3, v2
    v_lshl_add_u32 v24, v24, 13, s10
    v_lshrrev_b32 v25, 4, v2
    v_xor_b32 v25, v25, v2
    v_and_b32 v25, 7, v25
    v_lshl_add_u32 v12, v25, 4, v24
    v_xor_b32 v13, 64, v12
    v_add_u32 v13, 64512, v13
    s_cmp_eq_u32 s9, 1
    s_cselect_b32 s80, s40, s38
    s_cselect_b32 s81, s41, s39
    s_mov_b32 s82, 2097152
    s_mov_b32 s83, 0x00020000
    s_mov_b32 s68, s24
    s_mov_b32 s69, s25
    s_mov_b32 s70, 4194304
    s_mov_b32 s71, 0x00020000
    s_movk_i32 s32, 4096
    s_movk_i32 s33, 8192
    s_movk_i32 s34, 12288
    s_lshl_b32 s10, s5, 6
    v_and_b32 v23, 56, v2
    v_add_u32 v23, s10, v23
    v_lshlrev_b32 v26, 4, v2
    s_lshl_b32 s36, s100, 12
    s_lshl_b32 s10, s4, 1
    s_lshr_b32 s12, s5, 4
    s_add_u32 s10, s10, s12
    s_lshl_b32 s10, s10, 8
    v_and_b32 v60, 31, v2
    v_lshl_add_u32 v20, v60, 3, s10
    s_lshl_b32 s10, s4, 7
    s_lshl_b32 s12, s8, 5
    s_add_u32 s35, s10, s12
    v_and_b32 v25, 7, v2
    v_lshl_add_u32 v24, v25, 2, s35
    v_lshlrev_b32 v25, 1, v24
    v_lshl_add_u32 v16, v23, 11, v25
    v_add_u32 v60, 12416, v26
    v_and_b32 v61, 16, v26
    v_and_b32 v62, 32, v26
    v_mul_u32_u24 v62, 130, v62
    v_add_u32 v61, v61, v62
    v_cmp_gt_u32 vcc, 32, v2
    s_nop 1
    v_cndmask_b32 v60, v61, v60, vcc
    v_add_u32 v18, s101, v60
    s_lshl_b32 s10, s4, 10
    s_add_u32 s10, s10, 8192
    v_add_u32 v3, s10, v26
    v_and_b32 v17, 15, v2
    v_lshrrev_b32 v27, 4, v2
    v_lshlrev_b32 v60, 1, v17
    v_lshlrev_b32 v61, 4, v27
    v_sub_u32 v60, v60, v61
    v_and_b32 v62, 1, v17
    v_mov_b32 v63, 4212
    v_cmp_eq_u32 vcc, 1, v62
    s_nop 1
    v_cndmask_b32 v63, v63, 50, vcc
    v_add3_u32 v28, v60, v63, s101
    v_add_u32 v29, 1024, v28
    v_add_u32 v30, 2048, v28
    v_add_u32 v31, 3072, v28
    v_lshl_add_u32 v60, v17, 5, v61
    s_add_u32 s10, s101, 8848
    v_sub_u32 v32, s10, v60
    s_add_u32 s10, s101, 8320
    v_add_u32 v33, s10, v26
    s_cmp_eq_u32 s11, 1
    s_cbranch_scc1 L_idle
    s_mov_b32 s29, 1
    v_mov_b32 v25, 1
    s_branch L_free
L_loop:
    s_sub_i32 s28, s29, 3
    s_max_i32 s28, s28, 0
    s_waitcnt lgkmcnt(0)
    v_min3_u32 v60, v60, v61, v62
    v_min_u32 v60, v60, v63
    v_mov_b32 v25, s29
    v_cmp_gt_u32 vcc, s28, v60
    s_cbranch_vccz L_free
    s_mov_b32 s15, 0
L_slot_w:
    ds_read_b128 v[60:63], v21 offset:0
    s_waitcnt lgkmcnt(0)
    v_min3_u32 v60, v60, v61, v62
    v_min_u32 v60, v60, v63
    v_cmp_gt_u32 vcc, s28, v60
    s_cbranch_vccz L_slot_ok
    s_sleep 1
    s_add_u32 s15, s15, 1
    s_cmp_lt_u32 s15, 160000
    s_cbranch_scc1 L_slot_w
L_slot_ok:
L_free:
    s_cmp_ge_u32 s29, 10
    s_cbranch_scc1 L_sh
    s_add_u32 m0, s14, 0
    s_waitcnt vmcnt(15)
    buffer_load_dwordx4 v4, s[52:55], s13 offen offset:0 lds
    s_waitcnt vmcnt(15)
    buffer_load_dwordx4 v5, s[52:55], s13 offen offset:1024 lds
    s_waitcnt vmcnt(15)
    buffer_load_dwordx4 v6, s[52:55], s13 offen offset:2048 lds
    s_waitcnt vmcnt(15)
    buffer_load_dwordx4 v7, s[52:55], s13 offen offset:3072 lds
    s_add_u32 m0, s14, 16384
    s_waitcnt vmcnt(15)
    buffer_load_dwordx4 v8, s[56:59], s13 offen offset:0 lds
    s_waitcnt vmcnt(15)
    buffer_load_dwordx4 v9, s[56:59], s13 offen offset:1024 lds
    s_waitcnt vmcnt(15)
    buffer_load_dwordx4 v10, s[56:59], s13 offen offset:2048 lds
    s_waitcnt vmcnt(15)
    buffer_load_dwordx4 v11, s[56:59], s13 offen offset:3072 lds
    s_add_u32 m0, s14, 4096
    s_add_u32 s12, s13, 16384
    s_waitcnt vmcnt(15)
    buffer_load_dwordx4 v4, s[52:55], s12 offen offset:0 lds
    s_waitcnt vmcnt(15)
    buffer_load_dwordx4 v5, s[52:55], s12 offen offset:1024 lds
    s_waitcnt vmcnt(15)
    buffer_load_dwordx4 v6, s[52:55], s12 offen offset:2048 lds
    s_waitcnt vmcnt(15)
    buffer_load_dwordx4 v7, s[52:55], s12 offen offset:3072 lds
    ds_read_b128 v[60:63], v21
    s_add_u32 m0, s14, 20480
    s_waitcnt vmcnt(15)
    buffer_load_dwordx4 v8, s[60:63], s13 offen offset:0 lds
    s_waitcnt vmcnt(15)
    buffer_load_dwordx4 v9, s[60:63], s13 offen offset:1024 lds
    s_waitcnt vmcnt(15)
    buffer_load_dwordx4 v10, s[60:63], s13 offen offset:2048 lds
    s_waitcnt vmcnt(15)
    ds_write_b32 v22, v25
    buffer_load_dwordx4 v11, s[60:63], s13 offen offset:3072 lds
    s_and_b32 s12, s22, 15
    s_lshl_b32 s12, s12, 7
    s_add_u32 s13, s13, s12
    s_lshr_b64 s[22:23], s[22:23], 4
    s_and_b32 s13, s13, 2047
    s_add_u32 s14, s14, 32768
    s_and_b32 s14, s14, 131071
    s_add_u32 s29, s29, 1
    s_branch L_loop
L_sh:
    s_add_u32 m0, s14, 0
    s_waitcnt vmcnt(7)
    buffer_load_dwordx4 v4, s[52:55], s13 offen offset:0 lds
    s_waitcnt vmcnt(7)
    buffer_load_dwordx4 v5, s[52:55], s13 offen offset:1024 lds
    s_waitcnt vmcnt(7)
    buffer_load_dwordx4 v6, s[52:55], s13 offen offset:2048 lds
    s_waitcnt vmcnt(7)
    buffer_load_dwordx4 v7, s[52:55], s13 offen offset:3072 lds
    s_add_u32 m0, s14, 16384
    s_waitcnt vmcnt(7)
    buffer_load_dwordx4 v8, s[56:59], s13 offen offset:0 lds
    s_waitcnt vmcnt(7)
    buffer_load_dwordx4 v9, s[56:59], s13 offen offset:1024 lds
    s_waitcnt vmcnt(7)
    buffer_load_dwordx4 v10, s[56:59], s13 offen offset:2048 lds
    s_waitcnt vmcnt(7)
    ds_write_b32 v22, v25
    buffer_load_dwordx4 v11, s[56:59], s13 offen offset:3072 lds
    s_add_u32 m0, s14, 4096
    s_add_u32 s12, s13, 16384
    s_waitcnt vmcnt(7)
    buffer_load_dwordx4 v4, s[52:55], s12 offen offset:0 lds
    s_waitcnt vmcnt(7)
    buffer_load_dwordx4 v5, s[52:55], s12 offen offset:1024 lds
    s_waitcnt vmcnt(7)
    buffer_load_dwordx4 v6, s[52:55], s12 offen offset:2048 lds
    s_waitcnt vmcnt(7)
    buffer_load_dwordx4 v7, s[52:55], s12 offen offset:3072 lds
    ds_read_b128 v[60:63], v21
    s_add_u32 m0, s14, 20480
    s_waitcnt vmcnt(7)
    buffer_load_dwordx4 v8, s[60:63], s13 offen offset:0 lds
    s_waitcnt vmcnt(7)
    buffer_load_dwordx4 v9, s[60:63], s13 offen offset:1024 lds
    s_waitcnt vmcnt(7)
    buffer_load_dwordx4 v10, s[60:63], s13 offen offset:2048 lds
    s_waitcnt vmcnt(7)
    buffer_load_dwordx4 v11, s[60:63], s13 offen offset:3072 lds
    s_and_b32 s12, s22, 15
    s_lshl_b32 s12, s12, 7
    s_add_u32 s13, s13, s12
    s_lshr_b64 s[22:23], s[22:23], 4
    s_and_b32 s13, s13, 2047
    s_add_u32 s14, s14, 32768
    s_and_b32 s14, s14, 131071
    s_add_u32 s29, s29, 1
    s_cmp_lt_u32 s29, 16
    s_cbranch_scc1 L_loop
    v_mov_b32 v25, 16
    v_mov_b32 v60, 1
    s_mov_b64 exec, 1
    ds_add_u32 v21, v60 offset:40
    s_mov_b64 exec, -1
    s_waitcnt vmcnt(0)
    ds_write_b32 v22, v25
    s_mov_b32 s15, 0
L_is0_w:
    ds_read_b32 v60, v21 offset:40
    s_waitcnt lgkmcnt(0)
    v_cmp_gt_u32 vcc, 2, v60
    s_cbranch_vccz L_is0_ok
    s_add_u32 s15, s15, 1
    s_cmp_lt_u32 s15, 160000
    s_cbranch_scc1 L_is0_w
L_is0_ok:
    buffer_load_dwordx4 v[192:195], v26, s[68:71], s36 offen offset:0 nt
    buffer_load_dwordx4 v[196:199], v26, s[68:71], s36 offen offset:1024 nt
    buffer_load_dwordx4 v[200:203], v26, s[68:71], s36 offen offset:2048 nt
    buffer_load_dwordx4 v[204:207], v26, s[68:71], s36 offen offset:3072 nt
    s_branch L_t2
L_idle:
    s_setprio 0
    s_cmp_eq_u32 s8, 3
    s_cbranch_scc0 L_ntls
    s_lshl_b32 s10, s5, 16
    s_load_dword s29, s[22:23], 0
    s_load_dword s29, s[44:45], 0
    s_load_dword s29, s[18:19], s10
    s_load_dword s29, s[20:21], s10
    s_load_dword s29, s[50:51], s10
    s_add_u32 s10, s10, 2097152
    s_load_dword s29, s[18:19], s10
    s_load_dword s29, s[20:21], s10
    s_load_dword s29, s[50:51], s10
    s_add_u32 s10, s10, 2097152
    s_add_u32 s10, s10, 2097152
    s_add_u32 s10, s10, 2097152
    s_load_dword s29, s[50:51], s10
    s_add_u32 s10, s10, 2097152
    s_load_dword s29, s[50:51], s10
    s_add_u32 s10, s10, 2097152
    s_load_dword s29, s[50:51], s10
    s_add_u32 s10, s10, 2097152
    s_load_dword s29, s[50:51], s10
    s_add_u32 s10, s10, 2097152
    s_load_dword s29, s[50:51], s10
L_ntls:
    s_mov_b32 s52, s18
    s_mov_b32 s53, s19
    s_mov_b32 s54, 4194304
    s_mov_b32 s55, 0x00020000
    s_mov_b32 s56, s20
    s_mov_b32 s57, s21
    s_mov_b32 s58, 4194304
    s_mov_b32 s59, 0x00020000
    s_mov_b32 s60, s22
    s_mov_b32 s61, s23
    s_mov_b32 s62, 8192
    s_mov_b32 s63, 0x00020000
    s_mov_b32 s64, s50
    s_mov_b32 s65, s51
    s_mov_b32 s66, 4194304
    s_mov_b32 s67, 0x00020000
    s_lshl_b32 s10, s4, 7
    s_lshl_b32 s12, s9, 6
    s_add_u32 s10, s10, s12
    v_and_b32 v60, 7, v2
    v_lshl_add_u32 v4, v60, 3, s10
    v_lshlrev_b32 v60, 1, v4
    v_lshl_add_u32 v5, v23, 11, v60
    v_subrev_u32 v6, 6144, v5
    v_bfrev_b32 v60, 1
    v_cmp_eq_u32 vcc, 0, v23
    s_nop 1
    v_cndmask_b32 v6, v6, v60, vcc
    v_lshlrev_b32 v7, 3, v4
    v_sub_u32 v8, 2040, v23
    v_lshlrev_b32 v8, 1, v8
    v_lshl_add_u32 v8, v4, 12, v8
    v_add_u32 v9, 16384, v8
    s_lshl_b32 s13, s4, 1
    s_add_u32 s13, s13, s9
    s_lshl_b32 s13, s13, 5
    s_add_u32 s13, s13, s5
    s_lshl_b32 s13, s13, 3
    v_mov_b32 v25, 16
    s_getreg_b32 s14, hwreg(HW_REG_XCC_ID, 0, 8)
    s_add_u32 s14, s14, 1
    s_lshl_b32 s14, s14, 20
    s_lshl_b32 s10, s4, 8
    s_add_u32 s10, s10, 4096
    v_and_b32 v14, 31, v2
    v_lshl_add_u32 v14, v14, 3, s10
    s_lshl_b32 s28, s5, 3
    s_add_u32 s28, s28, s10
    s_cmp_eq_u32 s9, 0
    s_cbranch_scc0 L_x1
    s_mov_b32 s15, 0
L_x0_w:
    ds_read_b64 v[60:61], v21 offset:16
    s_waitcnt lgkmcnt(0)
    v_min_u32 v60, v60, v61
    v_cmp_gt_u32 vcc, 1, v60
    s_cbranch_vccz L_x0_ok
    s_sleep 2
    s_add_u32 s15, s15, 1
    s_cmp_lt_u32 s15, 160000
    s_cbranch_scc1 L_x0_w
L_x0_ok:
    buffer_load_dwordx2 v[10:11], v19, s[76:79], 0 offen sc1
    s_waitcnt vmcnt(0)
    s_mov_b32 s12, 0
LX_np:
    v_cmp_eq_u32 vcc, 0, v10
    s_cbranch_vccz LX_nok
    buffer_load_dwordx2 v[10:11], v19, s[76:79], 0 offen sc1
    s_add_u32 s12, s12, 1
    s_waitcnt vmcnt(0)
    s_cmp_lt_u32 s12, 20000
    s_cbranch_scc1 LX_np
LX_nok:
    v_xor_b32 v11, s14, v11
    s_mov_b64 exec, 1
    buffer_store_dwordx2 v[10:11], v19, s[72:75], s28 offen sc1
    s_mov_b64 exec, -1
L_x1:
    s_mov_b32 s15, 0
L_i1_w:
    ds_read_b64 v[60:61], v21 offset:16
    s_waitcnt lgkmcnt(0)
    v_min_u32 v60, v60, v61
    v_cmp_gt_u32 vcc, 4, v60
    s_cbranch_vccz L_i1_ok
    s_sleep 2
    s_add_u32 s15, s15, 1
    s_cmp_lt_u32 s15, 160000
    s_cbranch_scc1 L_i1_w
L_i1_ok:
    buffer_load_dwordx4 v[64:67], v7, s[60:63], 0 offen offset:0
    buffer_load_dwordx4 v[68:71], v7, s[60:63], 0 offen offset:16
    buffer_load_dwordx4 v[72:75], v7, s[60:63], 0 offen offset:32
    buffer_load_dwordx4 v[76:79], v7, s[60:63], 0 offen offset:48
    buffer_load_dwordx4 v[92:95], v5, s[52:55], 0 offen offset:0 nt
    buffer_load_dwordx4 v[96:99], v5, s[52:55], 0 offen offset:2048 nt
    buffer_load_dwordx4 v[100:103], v5, s[52:55], s32 offen offset:0 nt
    buffer_load_dwordx4 v[104:107], v5, s[52:55], s32 offen offset:2048 nt
    buffer_load_dwordx4 v[108:111], v5, s[52:55], s33 offen offset:0 nt
    buffer_load_dwordx4 v[112:115], v5, s[52:55], s33 offen offset:2048 nt
    buffer_load_dwordx4 v[116:119], v5, s[52:55], s34 offen offset:0 nt
    buffer_load_dwordx4 v[120:123], v5, s[52:55], s34 offen offset:2048 nt
    buffer_load_dwordx4 v[80:83], v6, s[52:55], 0 offen offset:0 nt
    buffer_load_dwordx4 v[84:87], v6, s[52:55], 0 offen offset:2048 nt
    buffer_load_dwordx4 v[88:91], v6, s[52:55], s32 offen offset:0 nt
    buffer_load_dwordx4 v[124:127], v5, s[56:59], 0 offen offset:0 nt
    buffer_load_dwordx4 v[128:131], v5, s[56:59], 0 offen offset:2048 nt
    buffer_load_dwordx4 v[132:135], v5, s[56:59], s32 offen offset:0 nt
    buffer_load_dwordx4 v[136:139], v5, s[56:59], s32 offen offset:2048 nt
    buffer_load_dwordx4 v[140:143], v5, s[56:59], s33 offen offset:0 nt
    buffer_load_dwordx4 v[144:147], v5, s[56:59], s33 offen offset:2048 nt
    buffer_load_dwordx4 v[148:151], v5, s[56:59], s34 offen offset:0 nt
    buffer_load_dwordx4 v[152:155], v5, s[56:59], s34 offen offset:2048 nt
    buffer_load_dwordx2 v[58:59], v14, s[72:75], 0 offen sc1
    buffer_load_dwordx2 v[0:1], v19, s[76:79], 0 offen sc1
    s_waitcnt vmcnt(21)
    v_lshlrev_b32 v156, 16, v64
    v_and_b32 v160, 0xffff0000, v64
    v_lshlrev_b32 v164, 16, v65
    v_and_b32 v168, 0xffff0000, v65
    v_lshlrev_b32 v157, 16, v66
    v_and_b32 v161, 0xffff0000, v66
    v_lshlrev_b32 v165, 16, v67
    v_and_b32 v169, 0xffff0000, v67
    v_lshlrev_b32 v158, 16, v68
    v_and_b32 v162, 0xffff0000, v68
    v_lshlrev_b32 v166, 16, v69
    v_and_b32 v170, 0xffff0000, v69
    v_lshlrev_b32 v159, 16, v70
    v_and_b32 v163, 0xffff0000, v70
    v_lshlrev_b32 v167, 16, v71
    v_and_b32 v171, 0xffff0000, v71
    s_waitcnt vmcnt(10)
    v_lshlrev_b32 v172, 16, v80
    v_and_b32 v173, 0xffff0000, v80
    v_lshlrev_b32 v174, 16, v81
    v_and_b32 v175, 0xffff0000, v81
    v_lshlrev_b32 v176, 16, v84
    v_and_b32 v177, 0xffff0000, v84
    v_lshlrev_b32 v178, 16, v85
    v_and_b32 v179, 0xffff0000, v85
    v_lshlrev_b32 v180, 16, v88
    v_and_b32 v181, 0xffff0000, v88
    v_lshlrev_b32 v182, 16, v89
    v_and_b32 v183, 0xffff0000, v89
    v_lshlrev_b32 v184, 16, v92
    v_and_b32 v185, 0xffff0000, v92
    v_lshlrev_b32 v186, 16, v93
    v_and_b32 v187, 0xffff0000, v93
    v_lshlrev_b32 v188, 16, v96
    v_and_b32 v189, 0xffff0000, v96
    v_lshlrev_b32 v190, 16, v97
    v_and_b32 v191, 0xffff0000, v97
    v_lshlrev_b32 v192, 16, v100
    v_and_b32 v193, 0xffff0000, v100
    v_lshlrev_b32 v194, 16, v101
    v_and_b32 v195, 0xffff0000, v101
    v_lshlrev_b32 v196, 16, v104
    v_and_b32 v197, 0xffff0000, v104
    v_lshlrev_b32 v198, 16, v105
    v_and_b32 v199, 0xffff0000, v105
    v_lshlrev_b32 v200, 16, v108
    v_and_b32 v201, 0xffff0000, v108
    v_lshlrev_b32 v202, 16, v109
    v_and_b32 v203, 0xffff0000, v109
    v_lshlrev_b32 v204, 16, v112
    v_and_b32 v205, 0xffff0000, v112
    v_lshlrev_b32 v206, 16, v113
    v_and_b32 v207, 0xffff0000, v113
    v_lshlrev_b32 v208, 16, v116
    v_and_b32 v209, 0xffff0000, v116
    v_lshlrev_b32 v210, 16, v117
    v_and_b32 v211, 0xffff0000, v117
    v_lshlrev_b32 v212, 16, v120
    v_and_b32 v213, 0xffff0000, v120
    v_lshlrev_b32 v214, 16, v121
    v_and_b32 v215, 0xffff0000, v121
    v_mul_f32 v216, v184, v156
    v_mul_f32 v217, v185, v157
    v_mul_f32 v218, v186, v158
    v_mul_f32 v219, v187, v159
    v_mul_f32 v220, v188, v156
    v_mul_f32 v221, v189, v157
    v_mul_f32 v222, v190, v158
    v_mul_f32 v223, v191, v159
    v_mul_f32 v224, v192, v156
    v_mul_f32 v225, v193, v157
    v_mul_f32 v226, v194, v158
    v_mul_f32 v227, v195, v159
    v_mul_f32 v228, v196, v156
    v_mul_f32 v229, v197, v157
    v_mul_f32 v230, v198, v158
    v_mul_f32 v231, v199, v159
    v_mul_f32 v232, v200, v156
    v_mul_f32 v233, v201, v157
    v_mul_f32 v234, v202, v158
    v_mul_f32 v235, v203, v159
    v_mul_f32 v236, v204, v156
    v_mul_f32 v237, v205, v157
    v_mul_f32 v238, v206, v158
    v_mul_f32 v239, v207, v159
    v_mul_f32 v240, v208, v156
    v_mul_f32 v241, v209, v157
    v_mul_f32 v242, v210, v158
    v_mul_f32 v243, v211, v159
    v_mul_f32 v244, v212, v156
    v_mul_f32 v245, v213, v157
    v_mul_f32 v246, v214, v158
    v_mul_f32 v247, v215, v159
    v_fmac_f32 v216, v180, v160
    v_fmac_f32 v217, v181, v161
    v_fmac_f32 v218, v182, v162
    v_fmac_f32 v219, v183, v163
    v_fmac_f32 v220, v184, v160
    v_fmac_f32 v221, v185, v161
    v_fmac_f32 v222, v186, v162
    v_fmac_f32 v223, v187, v163
    v_fmac_f32 v224, v188, v160
    v_fmac_f32 v225, v189, v161
    v_fmac_f32 v226, v190, v162
    v_fmac_f32 v227, v191, v163
    v_fmac_f32 v228, v192, v160
    v_fmac_f32 v229, v193, v161
    v_fmac_f32 v230, v194, v162
    v_fmac_f32 v231, v195, v163
    v_fmac_f32 v232, v196, v160
    v_fmac_f32 v233, v197, v161
    v_fmac_f32 v234, v198, v162
    v_fmac_f32 v235, v199, v163
    v_fmac_f32 v236, v200, v160
    v_fmac_f32 v237, v201, v161
    v_fmac_f32 v238, v202, v162
    v_fmac_f32 v239, v203, v163
    v_fmac_f32 v240, v204, v160
    v_fmac_f32 v241, v205, v161
    v_fmac_f32 v242, v206, v162
    v_fmac_f32 v243, v207, v163
    v_fmac_f32 v244, v208, v160
    v_fmac_f32 v245, v209, v161
    v_fmac_f32 v246, v210, v162
    v_fmac_f32 v247, v211, v163
    v_fmac_f32 v216, v176, v164
    v_fmac_f32 v217, v177, v165
    v_fmac_f32 v218, v178, v166
    v_fmac_f32 v219, v179, v167
    v_fmac_f32 v220, v180, v164
    v_fmac_f32 v221, v181, v165
    v_fmac_f32 v222, v182, v166
    v_fmac_f32 v223, v183, v167
    v_fmac_f32 v224, v184, v164
    v_fmac_f32 v225, v185, v165
    v_fmac_f32 v226, v186, v166
    v_fmac_f32 v227, v187, v167
    v_fmac_f32 v228, v188, v164
    v_fmac_f32 v229, v189, v165
    v_fmac_f32 v230, v190, v166
    v_fmac_f32 v231, v191, v167
    v_fmac_f32 v232, v192, v164
    v_fmac_f32 v233, v193, v165
    v_fmac_f32 v234, v194, v166
    v_fmac_f32 v235, v195, v167
    v_fmac_f32 v236, v196, v164
    v_fmac_f32 v237, v197, v165
    v_fmac_f32 v238, v198, v166
    v_fmac_f32 v239, v199, v167
    v_fmac_f32 v240, v200, v164
    v_fmac_f32 v241, v201, v165
    v_fmac_f32 v242, v202, v166
    v_fmac_f32 v243, v203, v167
    v_fmac_f32 v244, v204, v164
    v_fmac_f32 v245, v205, v165
    v_fmac_f32 v246, v206, v166
    v_fmac_f32 v247, v207, v167
    v_fmac_f32 v216, v172, v168
    v_fmac_f32 v217, v173, v169
    v_fmac_f32 v218, v174, v170
    v_fmac_f32 v219, v175, v171
    v_fmac_f32 v220, v176, v168
    v_fmac_f32 v221, v177, v169
    v_fmac_f32 v222, v178, v170
    v_fmac_f32 v223, v179, v171
    v_fmac_f32 v224, v180, v168
    v_fmac_f32 v225, v181, v169
    v_fmac_f32 v226, v182, v170
    v_fmac_f32 v227, v183, v171
    v_fmac_f32 v228, v184, v168
    v_fmac_f32 v229, v185, v169
    v_fmac_f32 v230, v186, v170
    v_fmac_f32 v231, v187, v171
    v_fmac_f32 v232, v188, v168
    v_fmac_f32 v233, v189, v169
    v_fmac_f32 v234, v190, v170
    v_fmac_f32 v235, v191, v171
    v_fmac_f32 v236, v192, v168
    v_fmac_f32 v237, v193, v169
    v_fmac_f32 v238, v194, v170
    v_fmac_f32 v239, v195, v171
    v_fmac_f32 v240, v196, v168
    v_fmac_f32 v241, v197, v169
    v_fmac_f32 v242, v198, v170
    v_fmac_f32 v243, v199, v171
    v_fmac_f32 v244, v200, v168
    v_fmac_f32 v245, v201, v169
    v_fmac_f32 v246, v202, v170
    v_fmac_f32 v247, v203, v171
    s_waitcnt vmcnt(0)
    s_mov_b32 s12, 0
L_np:
    v_cmp_eq_u32 vcc, 0, v0
    s_cbranch_vccz L_nok
    buffer_load_dwordx2 v[0:1], v19, s[76:79], 0 offen sc1
    s_add_u32 s12, s12, 1
    s_waitcnt vmcnt(0)
    s_cmp_lt_u32 s12, 20000
    s_cbranch_scc1 L_np
L_nok:
    ds_write_b64 v21, v[0:1] offset:32
    v_xor_b32 v59, s14, v59
    v_cmp_ne_u64 vcc, v[58:59], v[0:1]
    s_cmp_eq_u64 vcc, 0
    s_cselect_b32 s14, 1, 0
    v_mov_b32 v58, s14
    ds_or_b32 v21, v58 offset:72
    v_lshlrev_b32 v172, 16, v124
    v_and_b32 v173, 0xffff0000, v124
    v_lshlrev_b32 v174, 16, v125
    v_and_b32 v175, 0xffff0000, v125
    v_lshlrev_b32 v176, 16, v128
    v_and_b32 v177, 0xffff0000, v128
    v_lshlrev_b32 v178, 16, v129
    v_and_b32 v179, 0xffff0000, v129
    v_lshlrev_b32 v180, 16, v132
    v_and_b32 v181, 0xffff0000, v132
    v_lshlrev_b32 v182, 16, v133
    v_and_b32 v183, 0xffff0000, v133
    v_lshlrev_b32 v184, 16, v136
    v_and_b32 v185, 0xffff0000, v136
    v_lshlrev_b32 v186, 16, v137
    v_and_b32 v187, 0xffff0000, v137
    v_lshlrev_b32 v188, 16, v140
    v_and_b32 v189, 0xffff0000, v140
    v_lshlrev_b32 v190, 16, v141
    v_and_b32 v191, 0xffff0000, v141
    v_lshlrev_b32 v192, 16, v144
    v_and_b32 v193, 0xffff0000, v144
    v_lshlrev_b32 v194, 16, v145
    v_and_b32 v195, 0xffff0000, v145
    v_lshlrev_b32 v196, 16, v148
    v_and_b32 v197, 0xffff0000, v148
    v_lshlrev_b32 v198, 16, v149
    v_and_b32 v199, 0xffff0000, v149
    v_lshlrev_b32 v200, 16, v152
    v_and_b32 v201, 0xffff0000, v152
    v_lshlrev_b32 v202, 16, v153
    v_and_b32 v203, 0xffff0000, v153
    v_mul_f32 v216, v216, v172
    v_mul_f32 v217, v217, v173
    v_mul_f32 v218, v218, v174
    v_mul_f32 v219, v219, v175
    v_mul_f32 v220, v220, v176
    v_mul_f32 v221, v221, v177
    v_mul_f32 v222, v222, v178
    v_mul_f32 v223, v223, v179
    v_mul_f32 v224, v224, v180
    v_mul_f32 v225, v225, v181
    v_mul_f32 v226, v226, v182
    v_mul_f32 v227, v227, v183
    v_mul_f32 v228, v228, v184
    v_mul_f32 v229, v229, v185
    v_mul_f32 v230, v230, v186
    v_mul_f32 v231, v231, v187
    v_mul_f32 v232, v232, v188
    v_mul_f32 v233, v233, v189
    v_mul_f32 v234, v234, v190
    v_mul_f32 v235, v235, v191
    v_mul_f32 v236, v236, v192
    v_mul_f32 v237, v237, v193
    v_mul_f32 v238, v238, v194
    v_mul_f32 v239, v239, v195
    v_mul_f32 v240, v240, v196
    v_mul_f32 v241, v241, v197
    v_mul_f32 v242, v242, v198
    v_mul_f32 v243, v243, v199
    v_mul_f32 v244, v244, v200
    v_mul_f32 v245, v245, v201
    v_mul_f32 v246, v246, v202
    v_mul_f32 v247, v247, v203
    v_cvt_pk_bf16_f32 v40, v244, v240
    v_cvt_pk_bf16_f32 v41, v236, v232
    v_cvt_pk_bf16_f32 v42, v228, v224
    v_cvt_pk_bf16_f32 v43, v220, v216
    v_cvt_pk_bf16_f32 v44, v245, v241
    v_cvt_pk_bf16_f32 v45, v237, v233
    v_cvt_pk_bf16_f32 v46, v229, v225
    v_cvt_pk_bf16_f32 v47, v221, v217
    v_cvt_pk_bf16_f32 v48, v246, v242
    v_cvt_pk_bf16_f32 v49, v238, v234
    v_cvt_pk_bf16_f32 v50, v230, v226
    v_cvt_pk_bf16_f32 v51, v222, v218
    v_cvt_pk_bf16_f32 v52, v247, v243
    v_cvt_pk_bf16_f32 v53, v239, v235
    v_cvt_pk_bf16_f32 v54, v231, v227
    v_cvt_pk_bf16_f32 v55, v223, v219
    s_cmp_eq_u32 s14, 1
    s_cbranch_scc1 L_xp0
    buffer_store_dwordx4 v[40:43], v8, s[64:67], 0 offen sc1
    buffer_store_dwordx4 v[44:47], v8, s[64:67], s32 offen sc1
    buffer_store_dwordx4 v[48:51], v8, s[64:67], s33 offen sc1
    buffer_store_dwordx4 v[52:55], v8, s[64:67], s34 offen sc1
    s_branch L_xq0
L_xp0:
    buffer_store_dwordx4 v[40:43], v8, s[64:67], 0 offen
    buffer_store_dwordx4 v[44:47], v8, s[64:67], s32 offen
    buffer_store_dwordx4 v[48:51], v8, s[64:67], s33 offen
    buffer_store_dwordx4 v[52:55], v8, s[64:67], s34 offen
L_xq0:
    v_lshlrev_b32 v156, 16, v72
    v_and_b32 v160, 0xffff0000, v72
    v_lshlrev_b32 v164, 16, v73
    v_and_b32 v168, 0xffff0000, v73
    v_lshlrev_b32 v157, 16, v74
    v_and_b32 v161, 0xffff0000, v74
    v_lshlrev_b32 v165, 16, v75
    v_and_b32 v169, 0xffff0000, v75
    v_lshlrev_b32 v158, 16, v76
    v_and_b32 v162, 0xffff0000, v76
    v_lshlrev_b32 v166, 16, v77
    v_and_b32 v170, 0xffff0000, v77
    v_lshlrev_b32 v159, 16, v78
    v_and_b32 v163, 0xffff0000, v78
    v_lshlrev_b32 v167, 16, v79
    v_and_b32 v171, 0xffff0000, v79
    v_lshlrev_b32 v172, 16, v82
    v_and_b32 v173, 0xffff0000, v82
    v_lshlrev_b32 v174, 16, v83
    v_and_b32 v175, 0xffff0000, v83
    v_lshlrev_b32 v176, 16, v86
    v_and_b32 v177, 0xffff0000, v86
    v_lshlrev_b32 v178, 16, v87
    v_and_b32 v179, 0xffff0000, v87
    v_lshlrev_b32 v180, 16, v90
    v_and_b32 v181, 0xffff0000, v90
    v_lshlrev_b32 v182, 16, v91
    v_and_b32 v183, 0xffff0000, v91
    v_lshlrev_b32 v184, 16, v94
    v_and_b32 v185, 0xffff0000, v94
    v_lshlrev_b32 v186, 16, v95
    v_and_b32 v187, 0xffff0000, v95
    v_lshlrev_b32 v188, 16, v98
    v_and_b32 v189, 0xffff0000, v98
    v_lshlrev_b32 v190, 16, v99
    v_and_b32 v191, 0xffff0000, v99
    v_lshlrev_b32 v192, 16, v102
    v_and_b32 v193, 0xffff0000, v102
    v_lshlrev_b32 v194, 16, v103
    v_and_b32 v195, 0xffff0000, v103
    v_lshlrev_b32 v196, 16, v106
    v_and_b32 v197, 0xffff0000, v106
    v_lshlrev_b32 v198, 16, v107
    v_and_b32 v199, 0xffff0000, v107
    v_lshlrev_b32 v200, 16, v110
    v_and_b32 v201, 0xffff0000, v110
    v_lshlrev_b32 v202, 16, v111
    v_and_b32 v203, 0xffff0000, v111
    v_lshlrev_b32 v204, 16, v114
    v_and_b32 v205, 0xffff0000, v114
    v_lshlrev_b32 v206, 16, v115
    v_and_b32 v207, 0xffff0000, v115
    v_lshlrev_b32 v208, 16, v118
    v_and_b32 v209, 0xffff0000, v118
    v_lshlrev_b32 v210, 16, v119
    v_and_b32 v211, 0xffff0000, v119
    v_lshlrev_b32 v212, 16, v122
    v_and_b32 v213, 0xffff0000, v122
    v_lshlrev_b32 v214, 16, v123
    v_and_b32 v215, 0xffff0000, v123
    v_mul_f32 v216, v184, v156
    v_mul_f32 v217, v185, v157
    v_mul_f32 v218, v186, v158
    v_mul_f32 v219, v187, v159
    v_mul_f32 v220, v188, v156
    v_mul_f32 v221, v189, v157
    v_mul_f32 v222, v190, v158
    v_mul_f32 v223, v191, v159
    v_mul_f32 v224, v192, v156
    v_mul_f32 v225, v193, v157
    v_mul_f32 v226, v194, v158
    v_mul_f32 v227, v195, v159
    v_mul_f32 v228, v196, v156
    v_mul_f32 v229, v197, v157
    v_mul_f32 v230, v198, v158
    v_mul_f32 v231, v199, v159
    v_mul_f32 v232, v200, v156
    v_mul_f32 v233, v201, v157
    v_mul_f32 v234, v202, v158
    v_mul_f32 v235, v203, v159
    v_mul_f32 v236, v204, v156
    v_mul_f32 v237, v205, v157
    v_mul_f32 v238, v206, v158
    v_mul_f32 v239, v207, v159
    v_mul_f32 v240, v208, v156
    v_mul_f32 v241, v209, v157
    v_mul_f32 v242, v210, v158
    v_mul_f32 v243, v211, v159
    v_mul_f32 v244, v212, v156
    v_mul_f32 v245, v213, v157
    v_mul_f32 v246, v214, v158
    v_mul_f32 v247, v215, v159
    v_fmac_f32 v216, v180, v160
    v_fmac_f32 v217, v181, v161
    v_fmac_f32 v218, v182, v162
    v_fmac_f32 v219, v183, v163
    v_fmac_f32 v220, v184, v160
    v_fmac_f32 v221, v185, v161
    v_fmac_f32 v222, v186, v162
    v_fmac_f32 v223, v187, v163
    v_fmac_f32 v224, v188, v160
    v_fmac_f32 v225, v189, v161
    v_fmac_f32 v226, v190, v162
    v_fmac_f32 v227, v191, v163
    v_fmac_f32 v228, v192, v160
    v_fmac_f32 v229, v193, v161
    v_fmac_f32 v230, v194, v162
    v_fmac_f32 v231, v195, v163
    v_fmac_f32 v232, v196, v160
    v_fmac_f32 v233, v197, v161
    v_fmac_f32 v234, v198, v162
    v_fmac_f32 v235, v199, v163
    v_fmac_f32 v236, v200, v160
    v_fmac_f32 v237, v201, v161
    v_fmac_f32 v238, v202, v162
    v_fmac_f32 v239, v203, v163
    v_fmac_f32 v240, v204, v160
    v_fmac_f32 v241, v205, v161
    v_fmac_f32 v242, v206, v162
    v_fmac_f32 v243, v207, v163
    v_fmac_f32 v244, v208, v160
    v_fmac_f32 v245, v209, v161
    v_fmac_f32 v246, v210, v162
    v_fmac_f32 v247, v211, v163
    v_fmac_f32 v216, v176, v164
    v_fmac_f32 v217, v177, v165
    v_fmac_f32 v218, v178, v166
    v_fmac_f32 v219, v179, v167
    v_fmac_f32 v220, v180, v164
    v_fmac_f32 v221, v181, v165
    v_fmac_f32 v222, v182, v166
    v_fmac_f32 v223, v183, v167
    v_fmac_f32 v224, v184, v164
    v_fmac_f32 v225, v185, v165
    v_fmac_f32 v226, v186, v166
    v_fmac_f32 v227, v187, v167
    v_fmac_f32 v228, v188, v164
    v_fmac_f32 v229, v189, v165
    v_fmac_f32 v230, v190, v166
    v_fmac_f32 v231, v191, v167
    v_fmac_f32 v232, v192, v164
    v_fmac_f32 v233, v193, v165
    v_fmac_f32 v234, v194, v166
    v_fmac_f32 v235, v195, v167
    v_fmac_f32 v236, v196, v164
    v_fmac_f32 v237, v197, v165
    v_fmac_f32 v238, v198, v166
    v_fmac_f32 v239, v199, v167
    v_fmac_f32 v240, v200, v164
    v_fmac_f32 v241, v201, v165
    v_fmac_f32 v242, v202, v166
    v_fmac_f32 v243, v203, v167
    v_fmac_f32 v244, v204, v164
    v_fmac_f32 v245, v205, v165
    v_fmac_f32 v246, v206, v166
    v_fmac_f32 v247, v207, v167
    v_fmac_f32 v216, v172, v168
    v_fmac_f32 v217, v173, v169
    v_fmac_f32 v218, v174, v170
    v_fmac_f32 v219, v175, v171
    v_fmac_f32 v220, v176, v168
    v_fmac_f32 v221, v177, v169
    v_fmac_f32 v222, v178, v170
    v_fmac_f32 v223, v179, v171
    v_fmac_f32 v224, v180, v168
    v_fmac_f32 v225, v181, v169
    v_fmac_f32 v226, v182, v170
    v_fmac_f32 v227, v183, v171
    v_fmac_f32 v228, v184, v168
    v_fmac_f32 v229, v185, v169
    v_fmac_f32 v230, v186, v170
    v_fmac_f32 v231, v187, v171
    v_fmac_f32 v232, v188, v168
    v_fmac_f32 v233, v189, v169
    v_fmac_f32 v234, v190, v170
    v_fmac_f32 v235, v191, v171
    v_fmac_f32 v236, v192, v168
    v_fmac_f32 v237, v193, v169
    v_fmac_f32 v238, v194, v170
    v_fmac_f32 v239, v195, v171
    v_fmac_f32 v240, v196, v168
    v_fmac_f32 v241, v197, v169
    v_fmac_f32 v242, v198, v170
    v_fmac_f32 v243, v199, v171
    v_fmac_f32 v244, v200, v168
    v_fmac_f32 v245, v201, v169
    v_fmac_f32 v246, v202, v170
    v_fmac_f32 v247, v203, v171
    v_lshlrev_b32 v172, 16, v126
    v_and_b32 v173, 0xffff0000, v126
    v_lshlrev_b32 v174, 16, v127
    v_and_b32 v175, 0xffff0000, v127
    v_lshlrev_b32 v176, 16, v130
    v_and_b32 v177, 0xffff0000, v130
    v_lshlrev_b32 v178, 16, v131
    v_and_b32 v179, 0xffff0000, v131
    v_lshlrev_b32 v180, 16, v134
    v_and_b32 v181, 0xffff0000, v134
    v_lshlrev_b32 v182, 16, v135
    v_and_b32 v183, 0xffff0000, v135
    v_lshlrev_b32 v184, 16, v138
    v_and_b32 v185, 0xffff0000, v138
    v_lshlrev_b32 v186, 16, v139
    v_and_b32 v187, 0xffff0000, v139
    v_lshlrev_b32 v188, 16, v142
    v_and_b32 v189, 0xffff0000, v142
    v_lshlrev_b32 v190, 16, v143
    v_and_b32 v191, 0xffff0000, v143
    v_lshlrev_b32 v192, 16, v146
    v_and_b32 v193, 0xffff0000, v146
    v_lshlrev_b32 v194, 16, v147
    v_and_b32 v195, 0xffff0000, v147
    v_lshlrev_b32 v196, 16, v150
    v_and_b32 v197, 0xffff0000, v150
    v_lshlrev_b32 v198, 16, v151
    v_and_b32 v199, 0xffff0000, v151
    v_lshlrev_b32 v200, 16, v154
    v_and_b32 v201, 0xffff0000, v154
    v_lshlrev_b32 v202, 16, v155
    v_and_b32 v203, 0xffff0000, v155
    v_mul_f32 v216, v216, v172
    v_mul_f32 v217, v217, v173
    v_mul_f32 v218, v218, v174
    v_mul_f32 v219, v219, v175
    v_mul_f32 v220, v220, v176
    v_mul_f32 v221, v221, v177
    v_mul_f32 v222, v222, v178
    v_mul_f32 v223, v223, v179
    v_mul_f32 v224, v224, v180
    v_mul_f32 v225, v225, v181
    v_mul_f32 v226, v226, v182
    v_mul_f32 v227, v227, v183
    v_mul_f32 v228, v228, v184
    v_mul_f32 v229, v229, v185
    v_mul_f32 v230, v230, v186
    v_mul_f32 v231, v231, v187
    v_mul_f32 v232, v232, v188
    v_mul_f32 v233, v233, v189
    v_mul_f32 v234, v234, v190
    v_mul_f32 v235, v235, v191
    v_mul_f32 v236, v236, v192
    v_mul_f32 v237, v237, v193
    v_mul_f32 v238, v238, v194
    v_mul_f32 v239, v239, v195
    v_mul_f32 v240, v240, v196
    v_mul_f32 v241, v241, v197
    v_mul_f32 v242, v242, v198
    v_mul_f32 v243, v243, v199
    v_mul_f32 v244, v244, v200
    v_mul_f32 v245, v245, v201
    v_mul_f32 v246, v246, v202
    v_mul_f32 v247, v247, v203
    v_cvt_pk_bf16_f32 v40, v244, v240
    v_cvt_pk_bf16_f32 v41, v236, v232
    v_cvt_pk_bf16_f32 v42, v228, v224
    v_cvt_pk_bf16_f32 v43, v220, v216
    v_cvt_pk_bf16_f32 v44, v245, v241
    v_cvt_pk_bf16_f32 v45, v237, v233
    v_cvt_pk_bf16_f32 v46, v229, v225
    v_cvt_pk_bf16_f32 v47, v221, v217
    v_cvt_pk_bf16_f32 v48, v246, v242
    v_cvt_pk_bf16_f32 v49, v238, v234
    v_cvt_pk_bf16_f32 v50, v230, v226
    v_cvt_pk_bf16_f32 v51, v222, v218
    v_cvt_pk_bf16_f32 v52, v247, v243
    v_cvt_pk_bf16_f32 v53, v239, v235
    v_cvt_pk_bf16_f32 v54, v231, v227
    v_cvt_pk_bf16_f32 v55, v223, v219
    s_cmp_eq_u32 s14, 1
    s_cbranch_scc1 L_xp1
    buffer_store_dwordx4 v[40:43], v9, s[64:67], 0 offen sc1
    buffer_store_dwordx4 v[44:47], v9, s[64:67], s32 offen sc1
    buffer_store_dwordx4 v[48:51], v9, s[64:67], s33 offen sc1
    buffer_store_dwordx4 v[52:55], v9, s[64:67], s34 offen sc1
    s_branch L_xq1
L_xp1:
    buffer_store_dwordx4 v[40:43], v9, s[64:67], 0 offen
    buffer_store_dwordx4 v[44:47], v9, s[64:67], s32 offen
    buffer_store_dwordx4 v[48:51], v9, s[64:67], s33 offen
    buffer_store_dwordx4 v[52:55], v9, s[64:67], s34 offen
L_xq1:
    s_waitcnt vmcnt(0)
    s_mov_b64 exec, 1
    s_cmp_eq_u32 s14, 1
    s_cbranch_scc0 L_xf0
    buffer_store_dwordx2 v[0:1], v19, s[72:75], s13 offen
    s_branch L_xf1
L_xf0:
    buffer_store_dwordx2 v[0:1], v19, s[72:75], s13 offen sc1
L_xf1:
    s_mov_b64 exec, -1
    s_cmp_eq_u32 s8, 3
    s_cbranch_scc0 L_id2
    s_mov_b32 s15, 0
L_i2_w:
    ds_read_b64 v[60:61], v21 offset:16
    s_waitcnt lgkmcnt(0)
    v_min_u32 v60, v60, v61
    v_cmp_gt_u32 vcc, 14, v60
    s_cbranch_vccz L_i2_ok
    s_sleep 2
    s_add_u32 s15, s15, 1
    s_cmp_lt_u32 s15, 160000
    s_cbranch_scc1 L_i2_w
L_i2_ok:
    s_mov_b32 s15, 0
LK_poll:
    buffer_load_dwordx2 v[60:61], v20, s[72:75], 0 offen sc1
    s_waitcnt vmcnt(0)
    v_cmp_ne_u64 vcc, v[60:61], v[0:1]
    s_cbranch_vccz LK_ok
    s_add_u32 s15, s15, 1
    s_cmp_lt_u32 s15, 20000
    s_cbranch_scc1 LK_poll
LK_ok:
    ds_write_b32 v21, v25 offset:44
L_id2:
    s_mov_b32 s15, 0
L_is1_w:
    ds_read_b32 v60, v21 offset:40
    s_waitcnt lgkmcnt(0)
    v_cmp_gt_u32 vcc, 2, v60
    s_cbranch_vccz L_is1_ok
    s_sleep 2
    s_add_u32 s15, s15, 1
    s_cmp_lt_u32 s15, 160000
    s_cbranch_scc1 L_is1_w
L_is1_ok:
    buffer_load_dwordx4 v[192:195], v26, s[68:71], s36 offen offset:0 nt
    buffer_load_dwordx4 v[196:199], v26, s[68:71], s36 offen offset:1024 nt
    buffer_load_dwordx4 v[200:203], v26, s[68:71], s36 offen offset:2048 nt
    buffer_load_dwordx4 v[204:207], v26, s[68:71], s36 offen offset:3072 nt
L_t2:
    s_mov_b32 s52, s50
    s_mov_b32 s53, s51
    s_mov_b32 s54, 4194304
    s_mov_b32 s55, 0x00020000
    s_mov_b32 s56, s50
    s_mov_b32 s57, s51
    s_mov_b32 s58, 4194304
    s_mov_b32 s59, 0x00020000
    s_mov_b32 s60, s16
    s_mov_b32 s61, s17
    s_mov_b32 s62, 4194304
    s_mov_b32 s63, 0x00020000
    s_mov_b32 s64, s46
    s_mov_b32 s65, s47
    s_mov_b32 s66, 16777216
    s_mov_b32 s67, 0x00020000
    s_mov_b32 s15, 0
L_fk_w:
    ds_read_b32 v60, v21 offset:44
    s_waitcnt lgkmcnt(0)
    v_cmp_gt_u32 vcc, 1, v60
    s_cbranch_vccz L_fk_ok
    s_sleep 1
    s_add_u32 s15, s15, 1
    s_cmp_lt_u32 s15, 160000
    s_cbranch_scc1 L_fk_w
L_fk_ok:
    ds_read_b64 v[0:1], v21 offset:32
    buffer_load_dwordx4 v[224:227], v26, s[52:55], s36 offen offset:0 sc1
    buffer_load_dwordx4 v[228:231], v26, s[52:55], s36 offen offset:1024 sc1
    buffer_load_dwordx4 v[232:235], v26, s[52:55], s36 offen offset:2048 sc1
    buffer_load_dwordx4 v[236:239], v26, s[52:55], s36 offen offset:3072 sc1
    buffer_load_dwordx2 v[4:5], v16, s[60:63], 0 offen offset:0 nt
    buffer_load_dwordx2 v[6:7], v16, s[60:63], 0 offen offset:2048 nt
    s_waitcnt vmcnt(9)
    buffer_load_dwordx2 v[8:9], v16, s[60:63], s32 offen offset:0 nt
    s_waitcnt vmcnt(9)
    buffer_load_dwordx2 v[10:11], v16, s[60:63], s32 offen offset:2048 nt
    s_waitcnt vmcnt(9)
    buffer_load_dwordx2 v[14:15], v16, s[60:63], s33 offen offset:0 nt
    s_waitcnt vmcnt(9)
    buffer_load_dwordx2 v[56:57], v16, s[60:63], s33 offen offset:2048 nt
    s_waitcnt vmcnt(9)
    buffer_load_dwordx2 v[58:59], v16, s[60:63], s34 offen offset:0 nt
    s_waitcnt vmcnt(9)
    buffer_load_dwordx2 v[34:35], v16, s[60:63], s34 offen offset:2048 nt
    s_lshl_b32 s14, s9, 13
    s_lshl_b32 s10, s11, 12
    s_add_u32 s14, s14, s10
    s_mov_b32 s15, 0
L_c1_w:
    ds_read_b128 v[60:63], v21 offset:0
    s_waitcnt lgkmcnt(0)
    v_min3_u32 v60, v60, v61, v62
    v_min_u32 v60, v60, v63
    v_cmp_gt_u32 vcc, 14, v60
    s_cbranch_vccz L_c1_ok
    s_sleep 1
    s_add_u32 s15, s15, 1
    s_cmp_lt_u32 s15, 160000
    s_cbranch_scc1 L_c1_w
L_c1_ok:
    s_waitcnt vmcnt(9)
    s_bfe_u32 s13, s37, 0 + (4 << 16)
    s_lshl_b32 s13, s13, 7
    s_add_u32 m0, s14, 0
    s_nop 0
    buffer_load_dwordx4 v12, s[80:83], s13 offen offset:0 lds
    s_waitcnt vmcnt(9)
    buffer_load_dwordx4 v13, s[80:83], s13 offen offset:1024 lds
    s_waitcnt vmcnt(9)
    buffer_load_dwordx4 v12, s[80:83], s13 offen offset:2048 lds
    s_waitcnt vmcnt(9)
    buffer_load_dwordx4 v13, s[80:83], s13 offen offset:3072 lds
    s_waitcnt vmcnt(9)
    s_bfe_u32 s13, s37, 4 + (4 << 16)
    s_lshl_b32 s13, s13, 7
    s_add_u32 m0, s14, 16384
    s_nop 0
    buffer_load_dwordx4 v12, s[80:83], s13 offen offset:0 lds
    s_waitcnt vmcnt(9)
    buffer_load_dwordx4 v13, s[80:83], s13 offen offset:1024 lds
    s_waitcnt vmcnt(9)
    buffer_load_dwordx4 v12, s[80:83], s13 offen offset:2048 lds
    s_waitcnt vmcnt(9)
    buffer_load_dwordx4 v13, s[80:83], s13 offen offset:3072 lds
    s_waitcnt vmcnt(9)
    s_bfe_u32 s13, s37, 8 + (4 << 16)
    s_lshl_b32 s13, s13, 7
    s_add_u32 m0, s14, 32768
    s_nop 0
    buffer_load_dwordx4 v12, s[80:83], s13 offen offset:0 lds
    s_waitcnt vmcnt(9)
    buffer_load_dwordx4 v13, s[80:83], s13 offen offset:1024 lds
    s_waitcnt vmcnt(9)
    buffer_load_dwordx4 v12, s[80:83], s13 offen offset:2048 lds
    s_waitcnt vmcnt(9)
    buffer_load_dwordx4 v13, s[80:83], s13 offen offset:3072 lds
    s_bitcmp1_b32 s100, 0
    s_cselect_b32 s10, 16, 0
    s_lshr_b32 s31, s31, s10
    s_and_b32 s31, s31, 0xffff
    v_lshlrev_b32 v60, 3, v27
    v_sub_u32 v60, v60, v17
    v_add_u32 v60, -9, v60
    v_and_b32 v61, 1, v60
    v_lshlrev_b32 v61, 4, v61
    v_lshlrev_b32 v61, v61, s31
    v_ashrrev_i32 v60, 1, v60
    v_cmp_eq_u32 vcc, 0, v60
    s_nop 1
    v_cndmask_b32 v36, 0, v61, vcc
    v_cmp_eq_u32 vcc, 1, v60
    s_nop 1
    v_cndmask_b32 v37, 0, v61, vcc
    v_cmp_eq_u32 vcc, 2, v60
    s_nop 1
    v_cndmask_b32 v38, 0, v61, vcc
    v_cmp_eq_u32 vcc, 3, v60
    s_nop 1
    v_cndmask_b32 v39, 0, v61, vcc
    v_mov_b32 v128, 0
    v_mov_b32 v129, 0
    v_mov_b32 v130, 0
    v_mov_b32 v131, 0
    v_and_b32 v60, 1, v27
    v_lshlrev_b32 v60, 9, v60
    v_lshl_add_u32 v60, v17, 5, v60
    v_lshrrev_b32 v61, 1, v27
    v_lshl_add_u32 v17, v61, 4, v60
    v_and_b32 v60, 1, v2
    v_lshrrev_b32 v61, 5, v2
    v_lshl_add_u32 v60, v60, 1, v61
    v_bfe_u32 v61, v2, 1, 4
    v_lshl_add_u32 v60, v60, 4, v61
    v_lshlrev_b32 v17, 2, v60
    s_waitcnt vmcnt(24)
    v_mov_b32 v208, 0
    v_alignbit_b32 v209, v193, v192, 16
    v_alignbit_b32 v210, v194, v193, 16
    v_alignbit_b32 v211, v195, v194, 16
    s_nop 0
    v_mov_b32_dpp v208, v195 wave_shr:1 row_mask:0xf bank_mask:0xf
    v_alignbit_b32 v208, v192, v208, 16
    v_readlane_b32 s10, v195, 63
    v_alignbit_b32 v213, v197, v196, 16
    v_alignbit_b32 v214, v198, v197, 16
    v_mov_b32 v212, s10
    v_alignbit_b32 v215, v199, v198, 16
    s_nop 0
    v_mov_b32_dpp v212, v199 wave_shr:1 row_mask:0xf bank_mask:0xf
    v_alignbit_b32 v212, v196, v212, 16
    v_readlane_b32 s10, v199, 63
    v_alignbit_b32 v217, v201, v200, 16
    v_alignbit_b32 v218, v202, v201, 16
    v_mov_b32 v216, s10
    v_alignbit_b32 v219, v203, v202, 16
    s_nop 0
    v_mov_b32_dpp v216, v203 wave_shr:1 row_mask:0xf bank_mask:0xf
    v_alignbit_b32 v216, v200, v216, 16
    v_readlane_b32 s10, v203, 63
    v_alignbit_b32 v221, v205, v204, 16
    v_alignbit_b32 v222, v206, v205, 16
    v_mov_b32 v220, s10
    v_alignbit_b32 v223, v207, v206, 16
    s_nop 0
    v_mov_b32_dpp v220, v207 wave_shr:1 row_mask:0xf bank_mask:0xf
    v_alignbit_b32 v220, v204, v220, 16
    s_mov_b32 s15, 0
L_c2_w:
    ds_read_b128 v[60:63], v21 offset:0
    s_waitcnt lgkmcnt(0)
    v_min3_u32 v60, v60, v61, v62
    v_min_u32 v60, v60, v63
    v_cmp_gt_u32 vcc, 16, v60
    s_cbranch_vccz L_c2_ok
    s_sleep 1
    s_add_u32 s15, s15, 1
    s_cmp_lt_u32 s15, 160000
    s_cbranch_scc1 L_c2_w
L_c2_ok:
    s_setprio 0
    ds_write_b128 v18, v[128:131]
    v_add_u32 v62, -8288, v33
    ds_write_b128 v62, v[192:195] offset:0
    ds_write_b128 v62, v[196:199] offset:1024
    ds_write_b128 v62, v[200:203] offset:2048
    ds_write_b128 v62, v[204:207] offset:3072
    ds_write_b128 v62, v[208:211] offset:4160
    ds_write_b128 v62, v[212:215] offset:5184
    ds_write_b128 v62, v[216:219] offset:6208
    ds_write_b128 v62, v[220:223] offset:7232
    ds_read2_b32 v[128:129], v28 offset0:0 offset1:1
    ds_read2_b32 v[130:131], v28 offset0:2 offset1:3
    ds_read2_b32 v[132:133], v28 offset0:128 offset1:129
    ds_read2_b32 v[134:135], v28 offset0:130 offset1:131
    ds_read2_b32 v[136:137], v29 offset0:0 offset1:1
    ds_read2_b32 v[138:139], v29 offset0:2 offset1:3
    ds_read2_b32 v[140:141], v29 offset0:128 offset1:129
    ds_read2_b32 v[142:143], v29 offset0:130 offset1:131
    ds_read2_b32 v[144:145], v30 offset0:0 offset1:1
    ds_read2_b32 v[146:147], v30 offset0:2 offset1:3
    ds_read2_b32 v[148:149], v30 offset0:128 offset1:129
    ds_read2_b32 v[150:151], v30 offset0:130 offset1:131
    ds_read2_b32 v[152:153], v31 offset0:0 offset1:1
    ds_read2_b32 v[154:155], v31 offset0:2 offset1:3
    ds_read2_b32 v[156:157], v31 offset0:128 offset1:129
    ds_read2_b32 v[158:159], v31 offset0:130 offset1:131
    s_waitcnt vmcnt(23)
    ds_write_b128 v33, v[224:227] offset:0
    s_waitcnt vmcnt(22)
    ds_write_b128 v33, v[228:231] offset:1024
    s_waitcnt vmcnt(21)
    ds_write_b128 v33, v[232:235] offset:2048
    s_waitcnt vmcnt(20)
    ds_write_b128 v33, v[236:239] offset:3072
    ds_read_b128 v[160:163], v32 offset:3584
    ds_read_b128 v[164:167], v32 offset:3072
    ds_read_b128 v[168:171], v32 offset:2560
    ds_read_b128 v[172:175], v32 offset:2048
    ds_read_b128 v[176:179], v32 offset:1536
    ds_read_b128 v[180:183], v32 offset:1024
    ds_read_b128 v[184:187], v32 offset:512
    ds_read_b128 v[188:191], v32 offset:0
    s_setprio 2
    s_waitcnt lgkmcnt(0)
    v_mfma_f32_16x16x32_bf16 v[96:99], v[36:39], v[160:163], 0
    v_mfma_f32_16x16x32_bf16 v[100:103], v[36:39], v[164:167], 0
    v_mfma_f32_16x16x32_bf16 v[104:107], v[36:39], v[168:171], 0
    v_mfma_f32_16x16x32_bf16 v[108:111], v[36:39], v[172:175], 0
    v_mfma_f32_16x16x32_bf16 v[112:115], v[36:39], v[176:179], 0
    v_mfma_f32_16x16x32_bf16 v[116:119], v[36:39], v[180:183], 0
    v_mfma_f32_16x16x32_bf16 v[120:123], v[36:39], v[184:187], 0
    v_mfma_f32_16x16x32_bf16 v[124:127], v[36:39], v[188:191], 0
    v_mfma_f32_16x16x32_bf16 v[96:99], v[128:131], v[160:163], v[96:99]
    ds_read2_b32 v[192:193], v28 offset0:16 offset1:17
    s_bfe_u32 s13, s37, 12 + (4 << 16)
    s_lshl_b32 s13, s13, 7
    s_add_u32 m0, s14, 49152
    s_nop 0
    buffer_load_dwordx4 v12, s[80:83], s13 offen offset:0 lds
    v_mfma_f32_16x16x32_bf16 v[100:103], v[128:131], v[164:167], v[100:103]
    ds_read2_b32 v[194:195], v28 offset0:18 offset1:19
    v_mfma_f32_16x16x32_bf16 v[104:107], v[128:131], v[168:171], v[104:107]
    ds_read_b128 v[224:227], v32 offset:3648
    v_mfma_f32_16x16x32_bf16 v[108:111], v[128:131], v[172:175], v[108:111]
    ds_read2_b32 v[196:197], v28 offset0:144 offset1:145
    v_mfma_f32_16x16x32_bf16 v[112:115], v[128:131], v[176:179], v[112:115]
    ds_read2_b32 v[198:199], v28 offset0:146 offset1:147
    v_mfma_f32_16x16x32_bf16 v[116:119], v[128:131], v[180:183], v[116:119]
    ds_read_b128 v[228:231], v32 offset:3136
    v_mfma_f32_16x16x32_bf16 v[120:123], v[128:131], v[184:187], v[120:123]
    ds_read2_b32 v[200:201], v29 offset0:16 offset1:17
    v_mfma_f32_16x16x32_bf16 v[124:127], v[128:131], v[188:191], v[124:127]
    ds_read2_b32 v[202:203], v29 offset0:18 offset1:19
    v_mfma_f32_16x16x32_bf16 v[100:103], v[132:135], v[160:163], v[100:103]
    ds_read_b128 v[232:235], v32 offset:2624
    buffer_load_dwordx4 v13, s[80:83], s13 offen offset:1024 lds
    v_mfma_f32_16x16x32_bf16 v[104:107], v[132:135], v[164:167], v[104:107]
    ds_read2_b32 v[204:205], v29 offset0:144 offset1:145
    v_mfma_f32_16x16x32_bf16 v[108:111], v[132:135], v[168:171], v[108:111]
    ds_read2_b32 v[206:207], v29 offset0:146 offset1:147
    v_mfma_f32_16x16x32_bf16 v[112:115], v[132:135], v[172:175], v[112:115]
    ds_read_b128 v[236:239], v32 offset:2112
    v_mfma_f32_16x16x32_bf16 v[116:119], v[132:135], v[176:179], v[116:119]
    ds_read2_b32 v[208:209], v30 offset0:16 offset1:17
    v_mfma_f32_16x16x32_bf16 v[120:123], v[132:135], v[180:183], v[120:123]
    ds_read2_b32 v[210:211], v30 offset0:18 offset1:19
    v_mfma_f32_16x16x32_bf16 v[124:127], v[132:135], v[184:187], v[124:127]
    ds_read_b128 v[240:243], v32 offset:1600
    v_mfma_f32_16x16x32_bf16 v[104:107], v[136:139], v[160:163], v[104:107]
    ds_read2_b32 v[212:213], v30 offset0:144 offset1:145
    v_mfma_f32_16x16x32_bf16 v[108:111], v[136:139], v[164:167], v[108:111]
    ds_read2_b32 v[214:215], v30 offset0:146 offset1:147
    buffer_load_dwordx4 v12, s[80:83], s13 offen offset:2048 lds
    v_mfma_f32_16x16x32_bf16 v[112:115], v[136:139], v[168:171], v[112:115]
    ds_read_b128 v[244:247], v32 offset:1088
    v_mfma_f32_16x16x32_bf16 v[116:119], v[136:139], v[172:175], v[116:119]
    ds_read2_b32 v[216:217], v31 offset0:16 offset1:17
    v_mfma_f32_16x16x32_bf16 v[120:123], v[136:139], v[176:179], v[120:123]
    ds_read2_b32 v[218:219], v31 offset0:18 offset1:19
    v_mfma_f32_16x16x32_bf16 v[124:127], v[136:139], v[180:183], v[124:127]
    ds_read_b128 v[248:251], v32 offset:576
    v_mfma_f32_16x16x32_bf16 v[108:111], v[140:143], v[160:163], v[108:111]
    ds_read2_b32 v[220:221], v31 offset0:144 offset1:145
    v_mfma_f32_16x16x32_bf16 v[112:115], v[140:143], v[164:167], v[112:115]
    ds_read2_b32 v[222:223], v31 offset0:146 offset1:147
    v_mfma_f32_16x16x32_bf16 v[116:119], v[140:143], v[168:171], v[116:119]
    ds_read_b128 v[252:255], v32 offset:64
    v_mfma_f32_16x16x32_bf16 v[120:123], v[140:143], v[172:175], v[120:123]
    buffer_load_dwordx4 v13, s[80:83], s13 offen offset:3072 lds
    v_mfma_f32_16x16x32_bf16 v[124:127], v[140:143], v[176:179], v[124:127]
    v_mfma_f32_16x16x32_bf16 v[112:115], v[144:147], v[160:163], v[112:115]
    v_mfma_f32_16x16x32_bf16 v[116:119], v[144:147], v[164:167], v[116:119]
    v_mfma_f32_16x16x32_bf16 v[120:123], v[144:147], v[168:171], v[120:123]
    v_mfma_f32_16x16x32_bf16 v[124:127], v[144:147], v[172:175], v[124:127]
    v_mfma_f32_16x16x32_bf16 v[116:119], v[148:151], v[160:163], v[116:119]
    v_mfma_f32_16x16x32_bf16 v[120:123], v[148:151], v[164:167], v[120:123]
    v_mfma_f32_16x16x32_bf16 v[124:127], v[148:151], v[168:171], v[124:127]
    s_bfe_u32 s13, s30, 28 + (4 << 16)
    s_lshl_b32 s13, s13, 7
    buffer_load_dwordx4 v[40:43], v12, s[80:83], s13 offen offset:0
    v_mfma_f32_16x16x32_bf16 v[120:123], v[152:155], v[160:163], v[120:123]
    v_mfma_f32_16x16x32_bf16 v[124:127], v[152:155], v[164:167], v[124:127]
    v_mfma_f32_16x16x32_bf16 v[124:127], v[156:159], v[160:163], v[124:127]
    s_waitcnt lgkmcnt(0)
    v_mfma_f32_16x16x32_bf16 v[96:99], v[192:195], v[224:227], v[96:99]
    ds_read2_b32 v[128:129], v28 offset0:32 offset1:33
    v_mfma_f32_16x16x32_bf16 v[100:103], v[192:195], v[228:231], v[100:103]
    ds_read2_b32 v[130:131], v28 offset0:34 offset1:35
    v_mfma_f32_16x16x32_bf16 v[104:107], v[192:195], v[232:235], v[104:107]
    ds_read_b128 v[160:163], v32 offset:3712
    v_mfma_f32_16x16x32_bf16 v[108:111], v[192:195], v[236:239], v[108:111]
    ds_read2_b32 v[132:133], v28 offset0:160 offset1:161
    v_mfma_f32_16x16x32_bf16 v[112:115], v[192:195], v[240:243], v[112:115]
    ds_read2_b32 v[134:135], v28 offset0:162 offset1:163
    buffer_load_dwordx4 v[44:47], v13, s[80:83], s13 offen offset:1024
    v_mfma_f32_16x16x32_bf16 v[116:119], v[192:195], v[244:247], v[116:119]
    ds_read_b128 v[164:167], v32 offset:3200
    v_mfma_f32_16x16x32_bf16 v[120:123], v[192:195], v[248:251], v[120:123]
    ds_read2_b32 v[136:137], v29 offset0:32 offset1:33
    v_mfma_f32_16x16x32_bf16 v[124:127], v[192:195], v[252:255], v[124:127]
    ds_read2_b32 v[138:139], v29 offset0:34 offset1:35
    v_mfma_f32_16x16x32_bf16 v[100:103], v[196:199], v[224:227], v[100:103]
    ds_read_b128 v[168:171], v32 offset:2688
    v_mfma_f32_16x16x32_bf16 v[104:107], v[196:199], v[228:231], v[104:107]
    ds_read2_b32 v[140:141], v29 offset0:160 offset1:161
    v_mfma_f32_16x16x32_bf16 v[108:111], v[196:199], v[232:235], v[108:111]
    ds_read2_b32 v[142:143], v29 offset0:162 offset1:163
    v_mfma_f32_16x16x32_bf16 v[112:115], v[196:199], v[236:239], v[112:115]
    ds_read_b128 v[172:175], v32 offset:2176
    v_mfma_f32_16x16x32_bf16 v[116:119], v[196:199], v[240:243], v[116:119]
    ds_read2_b32 v[144:145], v30 offset0:32 offset1:33
    buffer_load_dwordx4 v[48:51], v12, s[80:83], s13 offen offset:2048
    v_mfma_f32_16x16x32_bf16 v[120:123], v[196:199], v[244:247], v[120:123]
    ds_read2_b32 v[146:147], v30 offset0:34 offset1:35
    v_mfma_f32_16x16x32_bf16 v[124:127], v[196:199], v[248:251], v[124:127]
    ds_read_b128 v[176:179], v32 offset:1664
    v_mfma_f32_16x16x32_bf16 v[104:107], v[200:203], v[224:227], v[104:107]
    ds_read2_b32 v[148:149], v30 offset0:160 offset1:161
    v_mfma_f32_16x16x32_bf16 v[108:111], v[200:203], v[228:231], v[108:111]
    ds_read2_b32 v[150:151], v30 offset0:162 offset1:163
    v_mfma_f32_16x16x32_bf16 v[112:115], v[200:203], v[232:235], v[112:115]
    ds_read_b128 v[180:183], v32 offset:1152
    v_mfma_f32_16x16x32_bf16 v[116:119], v[200:203], v[236:239], v[116:119]
    ds_read2_b32 v[152:153], v31 offset0:32 offset1:33
    v_mfma_f32_16x16x32_bf16 v[120:123], v[200:203], v[240:243], v[120:123]
    ds_read2_b32 v[154:155], v31 offset0:34 offset1:35
    v_mfma_f32_16x16x32_bf16 v[124:127], v[200:203], v[244:247], v[124:127]
    ds_read_b128 v[184:187], v32 offset:640
    buffer_load_dwordx4 v[52:55], v13, s[80:83], s13 offen offset:3072
    v_mfma_f32_16x16x32_bf16 v[108:111], v[204:207], v[224:227], v[108:111]
    ds_read2_b32 v[156:157], v31 offset0:160 offset1:161
    v_mfma_f32_16x16x32_bf16 v[112:115], v[204:207], v[228:231], v[112:115]
    ds_read2_b32 v[158:159], v31 offset0:162 offset1:163
    v_mfma_f32_16x16x32_bf16 v[116:119], v[204:207], v[232:235], v[116:119]
    ds_read_b128 v[188:191], v32 offset:128
    v_mfma_f32_16x16x32_bf16 v[120:123], v[204:207], v[236:239], v[120:123]
    v_mfma_f32_16x16x32_bf16 v[124:127], v[204:207], v[240:243], v[124:127]
    v_mfma_f32_16x16x32_bf16 v[112:115], v[208:211], v[224:227], v[112:115]
    v_mfma_f32_16x16x32_bf16 v[116:119], v[208:211], v[228:231], v[116:119]
    v_mfma_f32_16x16x32_bf16 v[120:123], v[208:211], v[232:235], v[120:123]
    s_bfe_u32 s13, s30, 24 + (4 << 16)
    s_lshl_b32 s13, s13, 7
    buffer_load_dwordx4 v[80:83], v12, s[80:83], s13 offen offset:0
    v_mfma_f32_16x16x32_bf16 v[124:127], v[208:211], v[236:239], v[124:127]
    v_mfma_f32_16x16x32_bf16 v[116:119], v[212:215], v[224:227], v[116:119]
    v_mfma_f32_16x16x32_bf16 v[120:123], v[212:215], v[228:231], v[120:123]
    v_mfma_f32_16x16x32_bf16 v[124:127], v[212:215], v[232:235], v[124:127]
    v_mfma_f32_16x16x32_bf16 v[120:123], v[216:219], v[224:227], v[120:123]
    v_mfma_f32_16x16x32_bf16 v[124:127], v[216:219], v[228:231], v[124:127]
    v_mfma_f32_16x16x32_bf16 v[124:127], v[220:223], v[224:227], v[124:127]
    s_waitcnt lgkmcnt(0)
    v_mfma_f32_16x16x32_bf16 v[96:99], v[128:131], v[160:163], v[96:99]
    ds_read2_b32 v[192:193], v28 offset0:48 offset1:49
    buffer_load_dwordx4 v[84:87], v13, s[80:83], s13 offen offset:1024
    v_mfma_f32_16x16x32_bf16 v[100:103], v[128:131], v[164:167], v[100:103]
    ds_read2_b32 v[194:195], v28 offset0:50 offset1:51
    v_mfma_f32_16x16x32_bf16 v[104:107], v[128:131], v[168:171], v[104:107]
    ds_read_b128 v[224:227], v32 offset:3776
    v_mfma_f32_16x16x32_bf16 v[108:111], v[128:131], v[172:175], v[108:111]
    ds_read2_b32 v[196:197], v28 offset0:176 offset1:177
    v_mfma_f32_16x16x32_bf16 v[112:115], v[128:131], v[176:179], v[112:115]
    ds_read2_b32 v[198:199], v28 offset0:178 offset1:179
    v_mfma_f32_16x16x32_bf16 v[116:119], v[128:131], v[180:183], v[116:119]
    ds_read_b128 v[228:231], v32 offset:3264
    v_mfma_f32_16x16x32_bf16 v[120:123], v[128:131], v[184:187], v[120:123]
    ds_read2_b32 v[200:201], v29 offset0:48 offset1:49
    v_mfma_f32_16x16x32_bf16 v[124:127], v[128:131], v[188:191], v[124:127]
    ds_read2_b32 v[202:203], v29 offset0:50 offset1:51
    v_mfma_f32_16x16x32_bf16 v[100:103], v[132:135], v[160:163], v[100:103]
    ds_read_b128 v[232:235], v32 offset:2752
    buffer_load_dwordx4 v[88:91], v12, s[80:83], s13 offen offset:2048
    v_mfma_f32_16x16x32_bf16 v[104:107], v[132:135], v[164:167], v[104:107]
    ds_read2_b32 v[204:205], v29 offset0:176 offset1:177
    v_mfma_f32_16x16x32_bf16 v[108:111], v[132:135], v[168:171], v[108:111]
    ds_read2_b32 v[206:207], v29 offset0:178 offset1:179
    v_mfma_f32_16x16x32_bf16 v[112:115], v[132:135], v[172:175], v[112:115]
    ds_read_b128 v[236:239], v32 offset:2240
    v_mfma_f32_16x16x32_bf16 v[116:119], v[132:135], v[176:179], v[116:119]
    ds_read2_b32 v[208:209], v30 offset0:48 offset1:49
    v_mfma_f32_16x16x32_bf16 v[120:123], v[132:135], v[180:183], v[120:123]
    ds_read2_b32 v[210:211], v30 offset0:50 offset1:51
    v_mfma_f32_16x16x32_bf16 v[124:127], v[132:135], v[184:187], v[124:127]
    ds_read_b128 v[240:243], v32 offset:1728
    v_mfma_f32_16x16x32_bf16 v[104:107], v[136:139], v[160:163], v[104:107]
    ds_read2_b32 v[212:213], v30 offset0:176 offset1:177
    v_mfma_f32_16x16x32_bf16 v[108:111], v[136:139], v[164:167], v[108:111]
    ds_read2_b32 v[214:215], v30 offset0:178 offset1:179
    buffer_load_dwordx4 v[92:95], v13, s[80:83], s13 offen offset:3072
    v_mfma_f32_16x16x32_bf16 v[112:115], v[136:139], v[168:171], v[112:115]
    ds_read_b128 v[244:247], v32 offset:1216
    v_mfma_f32_16x16x32_bf16 v[116:119], v[136:139], v[172:175], v[116:119]
    ds_read2_b32 v[216:217], v31 offset0:48 offset1:49
    v_mfma_f32_16x16x32_bf16 v[120:123], v[136:139], v[176:179], v[120:123]
    ds_read2_b32 v[218:219], v31 offset0:50 offset1:51
    v_mfma_f32_16x16x32_bf16 v[124:127], v[136:139], v[180:183], v[124:127]
    ds_read_b128 v[248:251], v32 offset:704
    v_mfma_f32_16x16x32_bf16 v[108:111], v[140:143], v[160:163], v[108:111]
    ds_read2_b32 v[220:221], v31 offset0:176 offset1:177
    v_mfma_f32_16x16x32_bf16 v[112:115], v[140:143], v[164:167], v[112:115]
    ds_read2_b32 v[222:223], v31 offset0:178 offset1:179
    v_mfma_f32_16x16x32_bf16 v[116:119], v[140:143], v[168:171], v[116:119]
    ds_read_b128 v[252:255], v32 offset:192
    v_mfma_f32_16x16x32_bf16 v[120:123], v[140:143], v[172:175], v[120:123]
    s_bfe_u32 s13, s30, 20 + (4 << 16)
    s_lshl_b32 s13, s13, 7
    buffer_load_dwordx4 v[64:67], v12, s[80:83], s13 offen offset:0
    v_mfma_f32_16x16x32_bf16 v[124:127], v[140:143], v[176:179], v[124:127]
    v_mfma_f32_16x16x32_bf16 v[112:115], v[144:147], v[160:163], v[112:115]
    v_mfma_f32_16x16x32_bf16 v[116:119], v[144:147], v[164:167], v[116:119]
    v_mfma_f32_16x16x32_bf16 v[120:123], v[144:147], v[168:171], v[120:123]
    v_mfma_f32_16x16x32_bf16 v[124:127], v[144:147], v[172:175], v[124:127]
    v_mfma_f32_16x16x32_bf16 v[116:119], v[148:151], v[160:163], v[116:119]
    s_waitcnt vmcnt(9)
    v_mov_b32 v60, 1
    s_mov_b64 exec, 1
    ds_add_u32 v21, v60 offset:60
    s_mov_b64 exec, -1
    v_mfma_f32_16x16x32_bf16 v[120:123], v[148:151], v[164:167], v[120:123]
    v_mfma_f32_16x16x32_bf16 v[124:127], v[148:151], v[168:171], v[124:127]
    buffer_load_dwordx4 v[68:71], v13, s[80:83], s13 offen offset:1024
    v_mfma_f32_16x16x32_bf16 v[120:123], v[152:155], v[160:163], v[120:123]
    v_mfma_f32_16x16x32_bf16 v[124:127], v[152:155], v[164:167], v[124:127]
    v_mfma_f32_16x16x32_bf16 v[124:127], v[156:159], v[160:163], v[124:127]
    s_waitcnt lgkmcnt(0)
    v_mfma_f32_16x16x32_bf16 v[96:99], v[192:195], v[224:227], v[96:99]
    ds_read2_b32 v[128:129], v28 offset0:64 offset1:65
    v_mfma_f32_16x16x32_bf16 v[100:103], v[192:195], v[228:231], v[100:103]
    ds_read2_b32 v[130:131], v28 offset0:66 offset1:67
    v_mfma_f32_16x16x32_bf16 v[104:107], v[192:195], v[232:235], v[104:107]
    ds_read_b128 v[160:163], v32 offset:3840
    v_mfma_f32_16x16x32_bf16 v[108:111], v[192:195], v[236:239], v[108:111]
    ds_read2_b32 v[132:133], v28 offset0:192 offset1:193
    v_mfma_f32_16x16x32_bf16 v[112:115], v[192:195], v[240:243], v[112:115]
    ds_read2_b32 v[134:135], v28 offset0:194 offset1:195
    buffer_load_dwordx4 v[72:75], v12, s[80:83], s13 offen offset:2048
    v_mfma_f32_16x16x32_bf16 v[116:119], v[192:195], v[244:247], v[116:119]
    ds_read_b128 v[164:167], v32 offset:3328
    v_mfma_f32_16x16x32_bf16 v[120:123], v[192:195], v[248:251], v[120:123]
    ds_read2_b32 v[136:137], v29 offset0:64 offset1:65
    v_mfma_f32_16x16x32_bf16 v[124:127], v[192:195], v[252:255], v[124:127]
    ds_read2_b32 v[138:139], v29 offset0:66 offset1:67
    v_mfma_f32_16x16x32_bf16 v[100:103], v[196:199], v[224:227], v[100:103]
    ds_read_b128 v[168:171], v32 offset:2816
    v_mfma_f32_16x16x32_bf16 v[104:107], v[196:199], v[228:231], v[104:107]
    ds_read2_b32 v[140:141], v29 offset0:192 offset1:193
    v_mfma_f32_16x16x32_bf16 v[108:111], v[196:199], v[232:235], v[108:111]
    ds_read2_b32 v[142:143], v29 offset0:194 offset1:195
    v_mfma_f32_16x16x32_bf16 v[112:115], v[196:199], v[236:239], v[112:115]
    ds_read_b128 v[172:175], v32 offset:2304
    v_mfma_f32_16x16x32_bf16 v[116:119], v[196:199], v[240:243], v[116:119]
    ds_read2_b32 v[144:145], v30 offset0:64 offset1:65
    buffer_load_dwordx4 v[76:79], v13, s[80:83], s13 offen offset:3072
    v_mfma_f32_16x16x32_bf16 v[120:123], v[196:199], v[244:247], v[120:123]
    ds_read2_b32 v[146:147], v30 offset0:66 offset1:67
    v_mfma_f32_16x16x32_bf16 v[124:127], v[196:199], v[248:251], v[124:127]
    ds_read_b128 v[176:179], v32 offset:1792
    v_mfma_f32_16x16x32_bf16 v[104:107], v[200:203], v[224:227], v[104:107]
    ds_read2_b32 v[148:149], v30 offset0:192 offset1:193
    v_mfma_f32_16x16x32_bf16 v[108:111], v[200:203], v[228:231], v[108:111]
    ds_read2_b32 v[150:151], v30 offset0:194 offset1:195
    v_mfma_f32_16x16x32_bf16 v[112:115], v[200:203], v[232:235], v[112:115]
    ds_read_b128 v[180:183], v32 offset:1280
    v_mfma_f32_16x16x32_bf16 v[116:119], v[200:203], v[236:239], v[116:119]
    ds_read2_b32 v[152:153], v31 offset0:64 offset1:65
    v_mfma_f32_16x16x32_bf16 v[120:123], v[200:203], v[240:243], v[120:123]
    ds_read2_b32 v[154:155], v31 offset0:66 offset1:67
    v_mfma_f32_16x16x32_bf16 v[124:127], v[200:203], v[244:247], v[124:127]
    ds_read_b128 v[184:187], v32 offset:768
    v_mfma_f32_16x16x32_bf16 v[108:111], v[204:207], v[224:227], v[108:111]
    ds_read2_b32 v[156:157], v31 offset0:192 offset1:193
    v_mfma_f32_16x16x32_bf16 v[112:115], v[204:207], v[228:231], v[112:115]
    ds_read2_b32 v[158:159], v31 offset0:194 offset1:195
    v_mfma_f32_16x16x32_bf16 v[116:119], v[204:207], v[232:235], v[116:119]
    ds_read_b128 v[188:191], v32 offset:256
    v_mfma_f32_16x16x32_bf16 v[120:123], v[204:207], v[236:239], v[120:123]
    v_mfma_f32_16x16x32_bf16 v[124:127], v[204:207], v[240:243], v[124:127]
    v_mfma_f32_16x16x32_bf16 v[112:115], v[208:211], v[224:227], v[112:115]
    v_mfma_f32_16x16x32_bf16 v[116:119], v[208:211], v[228:231], v[116:119]
    v_mfma_f32_16x16x32_bf16 v[120:123], v[208:211], v[232:235], v[120:123]
    v_mfma_f32_16x16x32_bf16 v[124:127], v[208:211], v[236:239], v[124:127]
    v_mfma_f32_16x16x32_bf16 v[116:119], v[212:215], v[224:227], v[116:119]
    v_mfma_f32_16x16x32_bf16 v[120:123], v[212:215], v[228:231], v[120:123]
    v_mfma_f32_16x16x32_bf16 v[124:127], v[212:215], v[232:235], v[124:127]
    v_mfma_f32_16x16x32_bf16 v[120:123], v[216:219], v[224:227], v[120:123]
    v_mfma_f32_16x16x32_bf16 v[124:127], v[216:219], v[228:231], v[124:127]
    v_mfma_f32_16x16x32_bf16 v[124:127], v[220:223], v[224:227], v[124:127]
    s_waitcnt lgkmcnt(0)
    v_mfma_f32_16x16x32_bf16 v[96:99], v[128:131], v[160:163], v[96:99]
    ds_read2_b32 v[192:193], v28 offset0:80 offset1:81
    v_mfma_f32_16x16x32_bf16 v[100:103], v[128:131], v[164:167], v[100:103]
    ds_read2_b32 v[194:195], v28 offset0:82 offset1:83
    v_mfma_f32_16x16x32_bf16 v[104:107], v[128:131], v[168:171], v[104:107]
    ds_read_b128 v[224:227], v32 offset:3904
    v_mfma_f32_16x16x32_bf16 v[108:111], v[128:131], v[172:175], v[108:111]
    ds_read2_b32 v[196:197], v28 offset0:208 offset1:209
    v_mfma_f32_16x16x32_bf16 v[112:115], v[128:131], v[176:179], v[112:115]
    ds_read2_b32 v[198:199], v28 offset0:210 offset1:211
    v_mfma_f32_16x16x32_bf16 v[116:119], v[128:131], v[180:183], v[116:119]
    ds_read_b128 v[228:231], v32 offset:3392
    v_mfma_f32_16x16x32_bf16 v[120:123], v[128:131], v[184:187], v[120:123]
    ds_read2_b32 v[200:201], v29 offset0:80 offset1:81
    v_mfma_f32_16x16x32_bf16 v[124:127], v[128:131], v[188:191], v[124:127]
    ds_read2_b32 v[202:203], v29 offset0:82 offset1:83
    v_mfma_f32_16x16x32_bf16 v[100:103], v[132:135], v[160:163], v[100:103]
    ds_read_b128 v[232:235], v32 offset:2880
    v_mfma_f32_16x16x32_bf16 v[104:107], v[132:135], v[164:167], v[104:107]
    ds_read2_b32 v[204:205], v29 offset0:208 offset1:209
    v_mfma_f32_16x16x32_bf16 v[108:111], v[132:135], v[168:171], v[108:111]
    ds_read2_b32 v[206:207], v29 offset0:210 offset1:211
    v_mfma_f32_16x16x32_bf16 v[112:115], v[132:135], v[172:175], v[112:115]
    ds_read_b128 v[236:239], v32 offset:2368
    v_mfma_f32_16x16x32_bf16 v[116:119], v[132:135], v[176:179], v[116:119]
    ds_read2_b32 v[208:209], v30 offset0:80 offset1:81
    v_mfma_f32_16x16x32_bf16 v[120:123], v[132:135], v[180:183], v[120:123]
    ds_read2_b32 v[210:211], v30 offset0:82 offset1:83
    v_mfma_f32_16x16x32_bf16 v[124:127], v[132:135], v[184:187], v[124:127]
    ds_read_b128 v[240:243], v32 offset:1856
    v_mfma_f32_16x16x32_bf16 v[104:107], v[136:139], v[160:163], v[104:107]
    ds_read2_b32 v[212:213], v30 offset0:208 offset1:209
    v_mfma_f32_16x16x32_bf16 v[108:111], v[136:139], v[164:167], v[108:111]
    ds_read2_b32 v[214:215], v30 offset0:210 offset1:211
    v_mfma_f32_16x16x32_bf16 v[112:115], v[136:139], v[168:171], v[112:115]
    ds_read_b128 v[244:247], v32 offset:1344
    v_mfma_f32_16x16x32_bf16 v[116:119], v[136:139], v[172:175], v[116:119]
    ds_read2_b32 v[216:217], v31 offset0:80 offset1:81
    v_mfma_f32_16x16x32_bf16 v[120:123], v[136:139], v[176:179], v[120:123]
    ds_read2_b32 v[218:219], v31 offset0:82 offset1:83
    v_mfma_f32_16x16x32_bf16 v[124:127], v[136:139], v[180:183], v[124:127]
    ds_read_b128 v[248:251], v32 offset:832
    v_mfma_f32_16x16x32_bf16 v[108:111], v[140:143], v[160:163], v[108:111]
    ds_read2_b32 v[220:221], v31 offset0:208 offset1:209
    v_mfma_f32_16x16x32_bf16 v[112:115], v[140:143], v[164:167], v[112:115]
    ds_read2_b32 v[222:223], v31 offset0:210 offset1:211
    v_mfma_f32_16x16x32_bf16 v[116:119], v[140:143], v[168:171], v[116:119]
    ds_read_b128 v[252:255], v32 offset:320
    v_mfma_f32_16x16x32_bf16 v[120:123], v[140:143], v[172:175], v[120:123]
    v_mfma_f32_16x16x32_bf16 v[124:127], v[140:143], v[176:179], v[124:127]
    v_mfma_f32_16x16x32_bf16 v[112:115], v[144:147], v[160:163], v[112:115]
    v_mfma_f32_16x16x32_bf16 v[116:119], v[144:147], v[164:167], v[116:119]
    v_mfma_f32_16x16x32_bf16 v[120:123], v[144:147], v[168:171], v[120:123]
    v_mfma_f32_16x16x32_bf16 v[124:127], v[144:147], v[172:175], v[124:127]
    v_mfma_f32_16x16x32_bf16 v[116:119], v[148:151], v[160:163], v[116:119]
    v_mfma_f32_16x16x32_bf16 v[120:123], v[148:151], v[164:167], v[120:123]
    v_mfma_f32_16x16x32_bf16 v[124:127], v[148:151], v[168:171], v[124:127]
    v_mfma_f32_16x16x32_bf16 v[120:123], v[152:155], v[160:163], v[120:123]
    v_mfma_f32_16x16x32_bf16 v[124:127], v[152:155], v[164:167], v[124:127]
    v_mfma_f32_16x16x32_bf16 v[124:127], v[156:159], v[160:163], v[124:127]
    s_waitcnt lgkmcnt(0)
    v_mfma_f32_16x16x32_bf16 v[96:99], v[192:195], v[224:227], v[96:99]
    ds_read2_b32 v[128:129], v28 offset0:96 offset1:97
    v_mfma_f32_16x16x32_bf16 v[100:103], v[192:195], v[228:231], v[100:103]
    ds_read2_b32 v[130:131], v28 offset0:98 offset1:99
    v_mfma_f32_16x16x32_bf16 v[104:107], v[192:195], v[232:235], v[104:107]
    ds_read_b128 v[160:163], v32 offset:3968
    v_mfma_f32_16x16x32_bf16 v[108:111], v[192:195], v[236:239], v[108:111]
    ds_read2_b32 v[132:133], v28 offset0:224 offset1:225
    v_mfma_f32_16x16x32_bf16 v[112:115], v[192:195], v[240:243], v[112:115]
    ds_read2_b32 v[134:135], v28 offset0:226 offset1:227
    v_mfma_f32_16x16x32_bf16 v[116:119], v[192:195], v[244:247], v[116:119]
    ds_read_b128 v[164:167], v32 offset:3456
    v_mfma_f32_16x16x32_bf16 v[120:123], v[192:195], v[248:251], v[120:123]
    ds_read2_b32 v[136:137], v29 offset0:96 offset1:97
    v_mfma_f32_16x16x32_bf16 v[124:127], v[192:195], v[252:255], v[124:127]
    ds_read2_b32 v[138:139], v29 offset0:98 offset1:99
    v_mfma_f32_16x16x32_bf16 v[100:103], v[196:199], v[224:227], v[100:103]
    ds_read_b128 v[168:171], v32 offset:2944
    v_mfma_f32_16x16x32_bf16 v[104:107], v[196:199], v[228:231], v[104:107]
    ds_read2_b32 v[140:141], v29 offset0:224 offset1:225
    v_mfma_f32_16x16x32_bf16 v[108:111], v[196:199], v[232:235], v[108:111]
    ds_read2_b32 v[142:143], v29 offset0:226 offset1:227
    v_mfma_f32_16x16x32_bf16 v[112:115], v[196:199], v[236:239], v[112:115]
    ds_read_b128 v[172:175], v32 offset:2432
    v_mfma_f32_16x16x32_bf16 v[116:119], v[196:199], v[240:243], v[116:119]
    ds_read2_b32 v[144:145], v30 offset0:96 offset1:97
    v_mfma_f32_16x16x32_bf16 v[120:123], v[196:199], v[244:247], v[120:123]
    ds_read2_b32 v[146:147], v30 offset0:98 offset1:99
    v_mfma_f32_16x16x32_bf16 v[124:127], v[196:199], v[248:251], v[124:127]
    ds_read_b128 v[176:179], v32 offset:1920
    v_mfma_f32_16x16x32_bf16 v[104:107], v[200:203], v[224:227], v[104:107]
    ds_read2_b32 v[148:149], v30 offset0:224 offset1:225
    v_mfma_f32_16x16x32_bf16 v[108:111], v[200:203], v[228:231], v[108:111]
    ds_read2_b32 v[150:151], v30 offset0:226 offset1:227
    v_mfma_f32_16x16x32_bf16 v[112:115], v[200:203], v[232:235], v[112:115]
    ds_read_b128 v[180:183], v32 offset:1408
    v_mfma_f32_16x16x32_bf16 v[116:119], v[200:203], v[236:239], v[116:119]
    ds_read2_b32 v[152:153], v31 offset0:96 offset1:97
    v_mfma_f32_16x16x32_bf16 v[120:123], v[200:203], v[240:243], v[120:123]
    ds_read2_b32 v[154:155], v31 offset0:98 offset1:99
    v_mfma_f32_16x16x32_bf16 v[124:127], v[200:203], v[244:247], v[124:127]
    ds_read_b128 v[184:187], v32 offset:896
    v_mfma_f32_16x16x32_bf16 v[108:111], v[204:207], v[224:227], v[108:111]
    ds_read2_b32 v[156:157], v31 offset0:224 offset1:225
    v_mfma_f32_16x16x32_bf16 v[112:115], v[204:207], v[228:231], v[112:115]
    ds_read2_b32 v[158:159], v31 offset0:226 offset1:227
    v_mfma_f32_16x16x32_bf16 v[116:119], v[204:207], v[232:235], v[116:119]
    ds_read_b128 v[188:191], v32 offset:384
    v_mfma_f32_16x16x32_bf16 v[120:123], v[204:207], v[236:239], v[120:123]
    v_mfma_f32_16x16x32_bf16 v[124:127], v[204:207], v[240:243], v[124:127]
    v_mfma_f32_16x16x32_bf16 v[112:115], v[208:211], v[224:227], v[112:115]
    v_mfma_f32_16x16x32_bf16 v[116:119], v[208:211], v[228:231], v[116:119]
    v_mfma_f32_16x16x32_bf16 v[120:123], v[208:211], v[232:235], v[120:123]
    v_mfma_f32_16x16x32_bf16 v[124:127], v[208:211], v[236:239], v[124:127]
    v_mfma_f32_16x16x32_bf16 v[116:119], v[212:215], v[224:227], v[116:119]
    v_mfma_f32_16x16x32_bf16 v[120:123], v[212:215], v[228:231], v[120:123]
    v_mfma_f32_16x16x32_bf16 v[124:127], v[212:215], v[232:235], v[124:127]
    v_mfma_f32_16x16x32_bf16 v[120:123], v[216:219], v[224:227], v[120:123]
    v_mfma_f32_16x16x32_bf16 v[124:127], v[216:219], v[228:231], v[124:127]
    v_mfma_f32_16x16x32_bf16 v[124:127], v[220:223], v[224:227], v[124:127]
    s_waitcnt lgkmcnt(0)
    v_mfma_f32_16x16x32_bf16 v[96:99], v[128:131], v[160:163], v[96:99]
    ds_read2_b32 v[192:193], v28 offset0:112 offset1:113
    v_mfma_f32_16x16x32_bf16 v[100:103], v[128:131], v[164:167], v[100:103]
    ds_read2_b32 v[194:195], v28 offset0:114 offset1:115
    v_mfma_f32_16x16x32_bf16 v[104:107], v[128:131], v[168:171], v[104:107]
    ds_read_b128 v[224:227], v32 offset:4032
    v_mfma_f32_16x16x32_bf16 v[108:111], v[128:131], v[172:175], v[108:111]
    ds_read2_b32 v[196:197], v28 offset0:240 offset1:241
    v_mfma_f32_16x16x32_bf16 v[112:115], v[128:131], v[176:179], v[112:115]
    ds_read2_b32 v[198:199], v28 offset0:242 offset1:243
    v_mfma_f32_16x16x32_bf16 v[116:119], v[128:131], v[180:183], v[116:119]
    ds_read_b128 v[228:231], v32 offset:3520
    v_mfma_f32_16x16x32_bf16 v[120:123], v[128:131], v[184:187], v[120:123]
    ds_read2_b32 v[200:201], v29 offset0:112 offset1:113
    v_mfma_f32_16x16x32_bf16 v[124:127], v[128:131], v[188:191], v[124:127]
    ds_read2_b32 v[202:203], v29 offset0:114 offset1:115
    v_mfma_f32_16x16x32_bf16 v[100:103], v[132:135], v[160:163], v[100:103]
    ds_read_b128 v[232:235], v32 offset:3008
    v_mfma_f32_16x16x32_bf16 v[104:107], v[132:135], v[164:167], v[104:107]
    ds_read2_b32 v[204:205], v29 offset0:240 offset1:241
    v_mfma_f32_16x16x32_bf16 v[108:111], v[132:135], v[168:171], v[108:111]
    ds_read2_b32 v[206:207], v29 offset0:242 offset1:243
    v_mfma_f32_16x16x32_bf16 v[112:115], v[132:135], v[172:175], v[112:115]
    ds_read_b128 v[236:239], v32 offset:2496
    v_mfma_f32_16x16x32_bf16 v[116:119], v[132:135], v[176:179], v[116:119]
    ds_read2_b32 v[208:209], v30 offset0:112 offset1:113
    v_mfma_f32_16x16x32_bf16 v[120:123], v[132:135], v[180:183], v[120:123]
    ds_read2_b32 v[210:211], v30 offset0:114 offset1:115
    v_mfma_f32_16x16x32_bf16 v[124:127], v[132:135], v[184:187], v[124:127]
    ds_read_b128 v[240:243], v32 offset:1984
    v_mfma_f32_16x16x32_bf16 v[104:107], v[136:139], v[160:163], v[104:107]
    ds_read2_b32 v[212:213], v30 offset0:240 offset1:241
    v_mfma_f32_16x16x32_bf16 v[108:111], v[136:139], v[164:167], v[108:111]
    ds_read2_b32 v[214:215], v30 offset0:242 offset1:243
    v_mfma_f32_16x16x32_bf16 v[112:115], v[136:139], v[168:171], v[112:115]
    ds_read_b128 v[244:247], v32 offset:1472
    v_mfma_f32_16x16x32_bf16 v[116:119], v[136:139], v[172:175], v[116:119]
    ds_read2_b32 v[216:217], v31 offset0:112 offset1:113
    v_mfma_f32_16x16x32_bf16 v[120:123], v[136:139], v[176:179], v[120:123]
    ds_read2_b32 v[218:219], v31 offset0:114 offset1:115
    v_mfma_f32_16x16x32_bf16 v[124:127], v[136:139], v[180:183], v[124:127]
    ds_read_b128 v[248:251], v32 offset:960
    v_mfma_f32_16x16x32_bf16 v[108:111], v[140:143], v[160:163], v[108:111]
    ds_read2_b32 v[220:221], v31 offset0:240 offset1:241
    v_mfma_f32_16x16x32_bf16 v[112:115], v[140:143], v[164:167], v[112:115]
    ds_read2_b32 v[222:223], v31 offset0:242 offset1:243
    v_mfma_f32_16x16x32_bf16 v[116:119], v[140:143], v[168:171], v[116:119]
    ds_read_b128 v[252:255], v32 offset:448
    v_mfma_f32_16x16x32_bf16 v[120:123], v[140:143], v[172:175], v[120:123]
    v_mfma_f32_16x16x32_bf16 v[124:127], v[140:143], v[176:179], v[124:127]
    v_mfma_f32_16x16x32_bf16 v[112:115], v[144:147], v[160:163], v[112:115]
    v_mfma_f32_16x16x32_bf16 v[116:119], v[144:147], v[164:167], v[116:119]
    v_mfma_f32_16x16x32_bf16 v[120:123], v[144:147], v[168:171], v[120:123]
    v_mfma_f32_16x16x32_bf16 v[124:127], v[144:147], v[172:175], v[124:127]
    v_mfma_f32_16x16x32_bf16 v[116:119], v[148:151], v[160:163], v[116:119]
    v_mfma_f32_16x16x32_bf16 v[120:123], v[148:151], v[164:167], v[120:123]
    v_mfma_f32_16x16x32_bf16 v[124:127], v[148:151], v[168:171], v[124:127]
    v_mfma_f32_16x16x32_bf16 v[120:123], v[152:155], v[160:163], v[120:123]
    v_mfma_f32_16x16x32_bf16 v[124:127], v[152:155], v[164:167], v[124:127]
    v_mfma_f32_16x16x32_bf16 v[124:127], v[156:159], v[160:163], v[124:127]
    s_waitcnt lgkmcnt(0)
    v_mfma_f32_16x16x32_bf16 v[96:99], v[192:195], v[224:227], v[96:99]
    v_mfma_f32_16x16x32_bf16 v[100:103], v[192:195], v[228:231], v[100:103]
    v_mfma_f32_16x16x32_bf16 v[104:107], v[192:195], v[232:235], v[104:107]
    v_mfma_f32_16x16x32_bf16 v[108:111], v[192:195], v[236:239], v[108:111]
    v_mfma_f32_16x16x32_bf16 v[112:115], v[192:195], v[240:243], v[112:115]
    v_mfma_f32_16x16x32_bf16 v[116:119], v[192:195], v[244:247], v[116:119]
    v_mfma_f32_16x16x32_bf16 v[120:123], v[192:195], v[248:251], v[120:123]
    v_mfma_f32_16x16x32_bf16 v[124:127], v[192:195], v[252:255], v[124:127]
    v_mfma_f32_16x16x32_bf16 v[100:103], v[196:199], v[224:227], v[100:103]
    v_mfma_f32_16x16x32_bf16 v[104:107], v[196:199], v[228:231], v[104:107]
    v_mfma_f32_16x16x32_bf16 v[108:111], v[196:199], v[232:235], v[108:111]
    v_mfma_f32_16x16x32_bf16 v[112:115], v[196:199], v[236:239], v[112:115]
    v_mfma_f32_16x16x32_bf16 v[116:119], v[196:199], v[240:243], v[116:119]
    v_mfma_f32_16x16x32_bf16 v[120:123], v[196:199], v[244:247], v[120:123]
    v_mfma_f32_16x16x32_bf16 v[124:127], v[196:199], v[248:251], v[124:127]
    v_mfma_f32_16x16x32_bf16 v[104:107], v[200:203], v[224:227], v[104:107]
    v_mfma_f32_16x16x32_bf16 v[108:111], v[200:203], v[228:231], v[108:111]
    v_mfma_f32_16x16x32_bf16 v[112:115], v[200:203], v[232:235], v[112:115]
    v_mfma_f32_16x16x32_bf16 v[116:119], v[200:203], v[236:239], v[116:119]
    v_mfma_f32_16x16x32_bf16 v[120:123], v[200:203], v[240:243], v[120:123]
    v_mfma_f32_16x16x32_bf16 v[124:127], v[200:203], v[244:247], v[124:127]
    v_mfma_f32_16x16x32_bf16 v[108:111], v[204:207], v[224:227], v[108:111]
    v_mfma_f32_16x16x32_bf16 v[112:115], v[204:207], v[228:231], v[112:115]
    v_mfma_f32_16x16x32_bf16 v[116:119], v[204:207], v[232:235], v[116:119]
    v_mfma_f32_16x16x32_bf16 v[120:123], v[204:207], v[236:239], v[120:123]
    v_mfma_f32_16x16x32_bf16 v[124:127], v[204:207], v[240:243], v[124:127]
    v_mfma_f32_16x16x32_bf16 v[112:115], v[208:211], v[224:227], v[112:115]
    v_mfma_f32_16x16x32_bf16 v[116:119], v[208:211], v[228:231], v[116:119]
    v_mfma_f32_16x16x32_bf16 v[120:123], v[208:211], v[232:235], v[120:123]
    v_mfma_f32_16x16x32_bf16 v[124:127], v[208:211], v[236:239], v[124:127]
    v_mfma_f32_16x16x32_bf16 v[116:119], v[212:215], v[224:227], v[116:119]
    v_mfma_f32_16x16x32_bf16 v[120:123], v[212:215], v[228:231], v[120:123]
    v_mfma_f32_16x16x32_bf16 v[124:127], v[212:215], v[232:235], v[124:127]
    v_mfma_f32_16x16x32_bf16 v[120:123], v[216:219], v[224:227], v[120:123]
    v_mfma_f32_16x16x32_bf16 v[124:127], v[216:219], v[228:231], v[124:127]
    v_mfma_f32_16x16x32_bf16 v[124:127], v[220:223], v[224:227], v[124:127]
    s_setprio 0
    v_cvt_pk_bf16_f32 v192, v96, v97
    v_cvt_pk_bf16_f32 v193, v98, v99
    v_cvt_pk_bf16_f32 v194, v100, v101
    v_cvt_pk_bf16_f32 v195, v102, v103
    v_cvt_pk_bf16_f32 v196, v104, v105
    v_cvt_pk_bf16_f32 v197, v106, v107
    v_cvt_pk_bf16_f32 v198, v108, v109
    v_cvt_pk_bf16_f32 v199, v110, v111
    v_cvt_pk_bf16_f32 v200, v112, v113
    v_cvt_pk_bf16_f32 v201, v114, v115
    v_cvt_pk_bf16_f32 v202, v116, v117
    v_cvt_pk_bf16_f32 v203, v118, v119
    v_cvt_pk_bf16_f32 v204, v120, v121
    v_cvt_pk_bf16_f32 v205, v122, v123
    v_cvt_pk_bf16_f32 v206, v124, v125
    v_cvt_pk_bf16_f32 v207, v126, v127
    v_permlane16_swap_b32 v192, v194
    v_permlane16_swap_b32 v193, v195
    v_permlane16_swap_b32 v196, v198
    v_permlane16_swap_b32 v197, v199
    v_permlane16_swap_b32 v200, v202
    v_permlane16_swap_b32 v201, v203
    v_permlane16_swap_b32 v204, v206
    v_permlane16_swap_b32 v205, v207
    ds_bpermute_b32 v192, v17, v192
    ds_bpermute_b32 v193, v17, v193
    ds_bpermute_b32 v194, v17, v194
    ds_bpermute_b32 v195, v17, v195
    ds_bpermute_b32 v196, v17, v196
    ds_bpermute_b32 v197, v17, v197
    ds_bpermute_b32 v198, v17, v198
    ds_bpermute_b32 v199, v17, v199
    ds_bpermute_b32 v200, v17, v200
    ds_bpermute_b32 v201, v17, v201
    ds_bpermute_b32 v202, v17, v202
    ds_bpermute_b32 v203, v17, v203
    ds_bpermute_b32 v204, v17, v204
    ds_bpermute_b32 v205, v17, v205
    ds_bpermute_b32 v206, v17, v206
    ds_bpermute_b32 v207, v17, v207
    ds_read_b32 v60, v21 offset:72
    s_waitcnt lgkmcnt(0)
    v_cmp_eq_u32 vcc, 1, v60
    s_cbranch_vccnz L_zp
    s_mov_b32 s13, 0
    buffer_store_dwordx4 v[192:195], v26, s[56:59], s36 offen offset:0 sc1
    buffer_store_dwordx4 v[196:199], v26, s[56:59], s36 offen offset:1024 sc1
    buffer_store_dwordx4 v[200:203], v26, s[56:59], s36 offen offset:2048 sc1
    buffer_store_dwordx4 v[204:207], v26, s[56:59], s36 offen offset:3072 sc1
    s_branch L_zq
L_zp:
    s_mov_b32 s13, 1
    buffer_store_dwordx4 v[192:195], v26, s[56:59], s36 offen offset:0
    buffer_store_dwordx4 v[196:199], v26, s[56:59], s36 offen offset:1024
    buffer_store_dwordx4 v[200:203], v26, s[56:59], s36 offen offset:2048
    buffer_store_dwordx4 v[204:207], v26, s[56:59], s36 offen offset:3072
L_zq:
    v_add_u32 v33, s101, v26
    s_waitcnt vmcnt(4)
    ds_write_b128 v33, v[64:67] offset:0
    ds_write_b128 v33, v[68:71] offset:1024
    ds_write_b128 v33, v[72:75] offset:2048
    ds_write_b128 v33, v[76:79] offset:3072
    ds_write_b128 v33, v[80:83] offset:4096
    ds_write_b128 v33, v[84:87] offset:5120
    ds_write_b128 v33, v[88:91] offset:6144
    ds_write_b128 v33, v[92:95] offset:7168
    ds_write_b128 v33, v[40:43] offset:8192
    ds_write_b128 v33, v[44:47] offset:9216
    ds_write_b128 v33, v[48:51] offset:10240
    ds_write_b128 v33, v[52:55] offset:11264
    v_mov_b32 v60, 1
    s_mov_b64 exec, 1
    ds_add_u32 v21, v60 offset:68
    s_mov_b64 exec, -1
    s_lshl_b32 s12, s100, 3
    s_add_u32 s12, s12, 8192
    v_lshlrev_b32 v28, 1, v23
    v_lshl_add_u32 v28, v24, 12, v28
    v_lshlrev_b32 v29, 2, v24
    v_lshl_add_u32 v29, v23, 13, v29
    v_lshrrev_b32 v60, 3, v2
    v_and_b32 v61, 7, v2
    v_lshl_add_u32 v28, v60, 2, s35
    v_lshlrev_b32 v28, 12, v28
    v_lshl_add_u32 v28, v61, 4, v28
    s_lshl_b32 s10, s5, 7
    v_add_u32 v28, s10, v28
    v_lshl_add_u32 v30, v61, 3, v60
    v_lshlrev_b32 v30, 2, v30
    s_waitcnt vmcnt(0)
    s_mov_b64 exec, 1
    s_cmp_eq_u32 s13, 1
    s_cbranch_scc0 L_xf2
    buffer_store_dwordx2 v[0:1], v19, s[72:75], s12 offen
    s_branch L_xf3
L_xf2:
    buffer_store_dwordx2 v[0:1], v19, s[72:75], s12 offen sc1
L_xf3:
    s_mov_b64 exec, -1
    s_mov_b32 s15, 0
L_zw_w:
    ds_read_b128 v[60:63], v21 offset:0
    s_waitcnt lgkmcnt(0)
    v_min3_u32 v60, v60, v61, v62
    v_min_u32 v60, v60, v63
    v_cmp_gt_u32 vcc, 22, v60
    s_cbranch_vccz L_zw_ok
    s_sleep 4
    s_add_u32 s15, s15, 1
    s_cmp_lt_u32 s15, 160000
    s_cbranch_scc1 L_zw_w
L_zw_ok:
    s_cmp_eq_u32 s8, 0
    s_cbranch_scc0 L_z1
    s_mov_b32 s15, 0
LZ_poll:
    buffer_load_dwordx4 v[60:63], v3, s[72:75], 0 offen sc1
    s_waitcnt vmcnt(0)
LZ_chk:
    v_cmp_ne_u64 vcc, v[60:61], v[0:1]
    v_cmp_ne_u64 s[10:11], v[62:63], v[0:1]
    s_or_b64 vcc, vcc, s[10:11]
    s_cbranch_scc0 LZ_ok
    s_sleep 4
    s_add_u32 s15, s15, 1
    s_cmp_lt_u32 s15, 20000
    s_cbranch_scc1 LZ_poll
LZ_ok:
    ds_write_b32 v21, v25 offset:48
L_z1:
    s_waitcnt vmcnt(0)
    v_lshlrev_b32 v128, 16, v4
    v_and_b32 v129, 0xffff0000, v4
    v_lshlrev_b32 v130, 16, v5
    v_and_b32 v131, 0xffff0000, v5
    v_lshlrev_b32 v132, 16, v6
    v_and_b32 v133, 0xffff0000, v6
    v_lshlrev_b32 v134, 16, v7
    v_and_b32 v135, 0xffff0000, v7
    v_lshlrev_b32 v136, 16, v8
    v_and_b32 v137, 0xffff0000, v8
    v_lshlrev_b32 v138, 16, v9
    v_and_b32 v139, 0xffff0000, v9
    v_lshlrev_b32 v140, 16, v10
    v_and_b32 v141, 0xffff0000, v10
    v_lshlrev_b32 v142, 16, v11
    v_and_b32 v143, 0xffff0000, v11
    v_lshlrev_b32 v144, 16, v14
    v_and_b32 v145, 0xffff0000, v14
    v_lshlrev_b32 v146, 16, v15
    v_and_b32 v147, 0xffff0000, v15
    v_lshlrev_b32 v148, 16, v56
    v_and_b32 v149, 0xffff0000, v56
    v_lshlrev_b32 v150, 16, v57
    v_and_b32 v151, 0xffff0000, v57
    v_lshlrev_b32 v152, 16, v58
    v_and_b32 v153, 0xffff0000, v58
    v_lshlrev_b32 v154, 16, v59
    v_and_b32 v155, 0xffff0000, v59
    v_lshlrev_b32 v156, 16, v34
    v_and_b32 v157, 0xffff0000, v34
    v_lshlrev_b32 v158, 16, v35
    v_and_b32 v159, 0xffff0000, v35
    s_mov_b32 s15, 0
L_fz_w:
    ds_read_b32 v60, v21 offset:48
    s_waitcnt lgkmcnt(0)
    v_cmp_gt_u32 vcc, 1, v60
    s_cbranch_vccz L_fz_ok
    s_sleep 1
    s_add_u32 s15, s15, 1
    s_cmp_lt_u32 s15, 160000
    s_cbranch_scc1 L_fz_w
L_fz_ok:
    buffer_load_dwordx4 v[64:67], v28, s[56:59], 0 offen sc1
    buffer_load_dwordx4 v[68:71], v28, s[56:59], s32 offen sc1
    buffer_load_dwordx4 v[72:75], v28, s[56:59], s33 offen sc1
    buffer_load_dwordx4 v[76:79], v28, s[56:59], s34 offen sc1
    s_waitcnt vmcnt(3)
    ds_bpermute_b32 v64, v30, v64
    ds_bpermute_b32 v65, v30, v65
    ds_bpermute_b32 v66, v30, v66
    ds_bpermute_b32 v67, v30, v67
    s_waitcnt vmcnt(2)
    ds_bpermute_b32 v68, v30, v68
    ds_bpermute_b32 v69, v30, v69
    ds_bpermute_b32 v70, v30, v70
    ds_bpermute_b32 v71, v30, v71
    s_waitcnt vmcnt(1)
    ds_bpermute_b32 v72, v30, v72
    ds_bpermute_b32 v73, v30, v73
    ds_bpermute_b32 v74, v30, v74
    ds_bpermute_b32 v75, v30, v75
    s_waitcnt vmcnt(0)
    ds_bpermute_b32 v76, v30, v76
    ds_bpermute_b32 v77, v30, v77
    ds_bpermute_b32 v78, v30, v78
    ds_bpermute_b32 v79, v30, v79
    s_waitcnt lgkmcnt(0)
    s_waitcnt vmcnt(0)
    v_lshlrev_b32 v160, 16, v64
    v_lshlrev_b32 v161, 16, v68
    v_lshlrev_b32 v162, 16, v72
    v_lshlrev_b32 v163, 16, v76
    v_mul_f32 v160, v160, v128
    v_mul_f32 v161, v161, v129
    v_mul_f32 v162, v162, v130
    v_mul_f32 v163, v163, v131
    v_and_b32 v164, 0xffff0000, v64
    v_and_b32 v165, 0xffff0000, v68
    v_and_b32 v166, 0xffff0000, v72
    v_and_b32 v167, 0xffff0000, v76
    v_mul_f32 v164, v164, v132
    v_mul_f32 v165, v165, v133
    v_mul_f32 v166, v166, v134
    v_mul_f32 v167, v167, v135
    v_lshlrev_b32 v168, 16, v65
    v_lshlrev_b32 v169, 16, v69
    v_lshlrev_b32 v170, 16, v73
    v_lshlrev_b32 v171, 16, v77
    v_mul_f32 v168, v168, v136
    v_mul_f32 v169, v169, v137
    v_mul_f32 v170, v170, v138
    v_mul_f32 v171, v171, v139
    v_and_b32 v172, 0xffff0000, v65
    v_and_b32 v173, 0xffff0000, v69
    v_and_b32 v174, 0xffff0000, v73
    v_and_b32 v175, 0xffff0000, v77
    v_mul_f32 v172, v172, v140
    v_mul_f32 v173, v173, v141
    v_mul_f32 v174, v174, v142
    v_mul_f32 v175, v175, v143
    v_lshlrev_b32 v176, 16, v66
    v_lshlrev_b32 v177, 16, v70
    v_lshlrev_b32 v178, 16, v74
    v_lshlrev_b32 v179, 16, v78
    v_mul_f32 v176, v176, v144
    v_mul_f32 v177, v177, v145
    v_mul_f32 v178, v178, v146
    v_mul_f32 v179, v179, v147
    v_and_b32 v180, 0xffff0000, v66
    v_and_b32 v181, 0xffff0000, v70
    v_and_b32 v182, 0xffff0000, v74
    v_and_b32 v183, 0xffff0000, v78
    v_mul_f32 v180, v180, v148
    v_mul_f32 v181, v181, v149
    v_mul_f32 v182, v182, v150
    v_mul_f32 v183, v183, v151
    v_lshlrev_b32 v184, 16, v67
    v_lshlrev_b32 v185, 16, v71
    v_lshlrev_b32 v186, 16, v75
    v_lshlrev_b32 v187, 16, v79
    v_mul_f32 v184, v184, v152
    v_mul_f32 v185, v185, v153
    v_mul_f32 v186, v186, v154
    v_mul_f32 v187, v187, v155
    v_and_b32 v188, 0xffff0000, v67
    v_and_b32 v189, 0xffff0000, v71
    v_and_b32 v190, 0xffff0000, v75
    v_and_b32 v191, 0xffff0000, v79
    v_mul_f32 v188, v188, v156
    v_mul_f32 v189, v189, v157
    v_mul_f32 v190, v190, v158
    v_mul_f32 v191, v191, v159
    s_mov_b32 s15, 0
L_ow0_w:
    ds_read_b128 v[60:63], v21 offset:0
    s_waitcnt lgkmcnt(0)
    v_min3_u32 v60, v60, v61, v62
    v_min_u32 v60, v60, v63
    v_cmp_gt_u32 vcc, 27, v60
    s_cbranch_vccz L_ow0_ok
    s_sleep 2
    s_add_u32 s15, s15, 1
    s_cmp_lt_u32 s15, 160000
    s_cbranch_scc1 L_ow0_w
L_ow0_ok:
    s_mov_b32 s10, 0
    buffer_store_dwordx4 v[160:163], v29, s[64:67], s10 offen nt
    s_mov_b32 s15, 0
L_ow1_w:
    ds_read_b128 v[60:63], v21 offset:0
    s_waitcnt lgkmcnt(0)
    v_min3_u32 v60, v60, v61, v62
    v_min_u32 v60, v60, v63
    v_cmp_gt_u32 vcc, 28, v60
    s_cbranch_vccz L_ow1_ok
    s_sleep 2
    s_add_u32 s15, s15, 1
    s_cmp_lt_u32 s15, 160000
    s_cbranch_scc1 L_ow1_w
L_ow1_ok:
    s_mov_b32 s10, 8192
    buffer_store_dwordx4 v[164:167], v29, s[64:67], s10 offen nt
    s_mov_b32 s15, 0
L_ow2_w:
    ds_read_b128 v[60:63], v21 offset:0
    s_waitcnt lgkmcnt(0)
    v_min3_u32 v60, v60, v61, v62
    v_min_u32 v60, v60, v63
    v_cmp_gt_u32 vcc, 29, v60
    s_cbranch_vccz L_ow2_ok
    s_sleep 2
    s_add_u32 s15, s15, 1
    s_cmp_lt_u32 s15, 160000
    s_cbranch_scc1 L_ow2_w
L_ow2_ok:
    s_mov_b32 s10, 16384
    buffer_store_dwordx4 v[168:171], v29, s[64:67], s10 offen nt
    s_mov_b32 s15, 0
L_ow3_w:
    ds_read_b128 v[60:63], v21 offset:0
    s_waitcnt lgkmcnt(0)
    v_min3_u32 v60, v60, v61, v62
    v_min_u32 v60, v60, v63
    v_cmp_gt_u32 vcc, 30, v60
    s_cbranch_vccz L_ow3_ok
    s_sleep 2
    s_add_u32 s15, s15, 1
    s_cmp_lt_u32 s15, 160000
    s_cbranch_scc1 L_ow3_w
L_ow3_ok:
    s_mov_b32 s10, 24576
    buffer_store_dwordx4 v[172:175], v29, s[64:67], s10 offen nt
    s_mov_b32 s15, 0
L_ow4_w:
    ds_read_b128 v[60:63], v21 offset:0
    s_waitcnt lgkmcnt(0)
    v_min3_u32 v60, v60, v61, v62
    v_min_u32 v60, v60, v63
    v_cmp_gt_u32 vcc, 31, v60
    s_cbranch_vccz L_ow4_ok
    s_sleep 2
    s_add_u32 s15, s15, 1
    s_cmp_lt_u32 s15, 160000
    s_cbranch_scc1 L_ow4_w
L_ow4_ok:
    s_mov_b32 s10, 32768
    buffer_store_dwordx4 v[176:179], v29, s[64:67], s10 offen nt
    s_mov_b32 s15, 0
L_ow5_w:
    ds_read_b128 v[60:63], v21 offset:0
    s_waitcnt lgkmcnt(0)
    v_min3_u32 v60, v60, v61, v62
    v_min_u32 v60, v60, v63
    v_cmp_gt_u32 vcc, 32, v60
    s_cbranch_vccz L_ow5_ok
    s_sleep 2
    s_add_u32 s15, s15, 1
    s_cmp_lt_u32 s15, 160000
    s_cbranch_scc1 L_ow5_w
L_ow5_ok:
    s_mov_b32 s10, 40960
    buffer_store_dwordx4 v[180:183], v29, s[64:67], s10 offen nt
    s_mov_b32 s15, 0
L_ow6_w:
    ds_read_b128 v[60:63], v21 offset:0
    s_waitcnt lgkmcnt(0)
    v_min3_u32 v60, v60, v61, v62
    v_min_u32 v60, v60, v63
    v_cmp_gt_u32 vcc, 33, v60
    s_cbranch_vccz L_ow6_ok
    s_sleep 2
    s_add_u32 s15, s15, 1
    s_cmp_lt_u32 s15, 160000
    s_cbranch_scc1 L_ow6_w
L_ow6_ok:
    s_mov_b32 s10, 49152
    buffer_store_dwordx4 v[184:187], v29, s[64:67], s10 offen nt
    s_mov_b32 s15, 0
L_ow7_w:
    ds_read_b128 v[60:63], v21 offset:0
    s_waitcnt lgkmcnt(0)
    v_min3_u32 v60, v60, v61, v62
    v_min_u32 v60, v60, v63
    v_cmp_gt_u32 vcc, 33, v60
    s_cbranch_vccz L_ow7_ok
    s_sleep 2
    s_add_u32 s15, s15, 1
    s_cmp_lt_u32 s15, 160000
    s_cbranch_scc1 L_ow7_w
L_ow7_ok:
    s_mov_b32 s10, 57344
    buffer_store_dwordx4 v[188:191], v29, s[64:67], s10 offen nt
    s_endpgm
Y_G:
    s_and_b32 s68, s4, 6
    s_add_u32 s69, s5, s68
    s_lshl_b32 s69, s69, 1
    s_and_b32 s68, s4, 1
    s_add_u32 s69, s69, s68
    s_and_b32 s69, s69, 15
    s_mov_b32 s100, 0x76543210
    s_mov_b32 s101, 0xfedcba98
    s_lshl_b32 s68, s69, 2
    s_lshr_b64 s[64:65], s[100:101], s68
    s_sub_u32 s68, 64, s68
    s_lshl_b64 s[100:101], s[100:101], s68
    s_or_b64 s[100:101], s[100:101], s[64:65]
    s_sub_u32 s68, s7, s69
    s_and_b32 s68, s68, 15
    s_lshl_b32 s68, s68, 2
    s_bfm_b64 s[64:65], s68, 0
    s_and_b64 s[66:67], s[100:101], s[64:65]
    s_lshl_b64 s[66:67], s[66:67], 4
    s_lshl_b64 s[64:65], s[64:65], 4
    s_or_b32 s64, s64, 15
    s_andn2_b64 s[100:101], s[100:101], s[64:65]
    s_or_b64 s[100:101], s[100:101], s[66:67]
    s_or_b32 s100, s100, s7
    s_setprio 0
    v_and_b32 v3, 31, v2
    v_mov_b32 v23, 0
    v_mov_b32 v11, 163712
    v_lshrrev_b32 v4, 5, v2
    s_lshr_b32 s8, s3, 1
    s_and_b32 s9, s3, 1
    s_lshl_b32 s10, s7, 6
    s_lshl_b32 s11, s9, 5
    s_add_u32 s10, s10, s11
    v_add_u32 v5, s10, v3
    v_lshlrev_b32 v48, 1, v5
    s_lshl_b32 s10, s7, 7
    v_and_b32 v49, 15, v2
    v_lshl_add_u32 v49, v49, 3, s10
    s_lshl_b32 s10, s3, 2
    s_add_u32 s10, s10, 163712
    v_mov_b32 v10, s10
    s_waitcnt lgkmcnt(0)
    s_mov_b32 s76, s48
    s_mov_b32 s77, s49
    s_mov_b32 s78, 256
    s_mov_b32 s79, 0x00020000
    s_or_b32 s10, s2, s3
    s_cmp_eq_u32 s10, 0
    s_cbranch_scc0 G_nononce
    s_memrealtime s[10:11]
    s_waitcnt lgkmcnt(0)
    s_or_b32 s10, s10, 1
    v_mov_b32 v54, s10
    v_mov_b32 v55, s11
    s_mov_b64 exec, 1
    buffer_store_dwordx2 v[54:55], v23, s[76:79], 0 offen sc1
    s_mov_b64 exec, -1
G_nononce:
    s_mov_b32 s52, s42
    s_mov_b32 s53, s43
    s_mov_b32 s54, 2048
    s_mov_b32 s55, 0x00020000
    buffer_load_ushort v12, v48, s[52:55], 0 offen
    s_mov_b32 s52, s30
    s_mov_b32 s53, s31
    buffer_load_ushort v13, v48, s[52:55], 0 offen
    s_mov_b32 s52, s32
    s_mov_b32 s53, s33
    buffer_load_ushort v14, v48, s[52:55], 0 offen
    s_mov_b32 s52, s44
    s_mov_b32 s53, s45
    buffer_load_dwordx2 v[24:25], v49, s[52:55], 0 offen
    s_mov_b32 s52, s28
    s_mov_b32 s53, s29
    s_mov_b32 s54, 4194304
    s_mov_b32 s55, 0x00020000
    s_mov_b32 s60, s46
    s_mov_b32 s61, s47
    s_mov_b32 s62, 16777216
    s_mov_b32 s63, 0x00020000
    s_add_u32 s64, s50, 16777216
    s_addc_u32 s65, s51, 0
    s_mov_b32 s66, 278528
    s_mov_b32 s67, 0x00020000
    s_add_u32 s68, s50, 8388608
    s_addc_u32 s69, s51, 0
    s_mov_b32 s70, 8388608
    s_mov_b32 s71, 0x00020000
    s_add_u32 s72, s50, 17825792
    s_addc_u32 s73, s51, 0
    s_mov_b32 s74, 65536
    s_mov_b32 s75, 0x00020000
    s_cmp_eq_u32 s9, 1
    s_cselect_b32 s80, s40, s38
    s_cselect_b32 s81, s41, s39
    s_mov_b32 s82, 2097152
    s_mov_b32 s83, 0x00020000
    s_lshl_b32 s10, s6, 7
    s_lshl_b32 s11, s3, 5
    s_add_u32 s10, s10, s11
    v_lshrrev_b32 v50, 4, v2
    v_lshl_add_u32 v50, v50, 2, s10
    v_lshl_add_u32 v22, v50, 11, v49
    v_xor_b32 v50, 1, v4
    v_lshlrev_b32 v50, 14, v50
    v_lshl_add_u32 v53, v5, 4, v50
    v_lshlrev_b32 v26, 4, v2
    v_add_u32 v27, 4096, v26
    v_lshrrev_b32 v50, 1, v3
    v_and_b32 v50, 7, v50
    v_xor_b32 v50, v50, v4
    v_lshlrev_b32 v50, 4, v50
    v_lshl_add_u32 v50, v3, 7, v50
    s_lshl_b32 s10, s8, 13
    s_lshl_b32 s11, s9, 13
    s_add_u32 s11, s11, 16384
    v_add_u32 v32, s10, v50
    v_add_u32 v36, s11, v50
    v_xor_b32 v33, 32, v32
    v_xor_b32 v37, 32, v36
    v_xor_b32 v34, 64, v32
    v_xor_b32 v38, 64, v36
    v_xor_b32 v35, 96, v32
    v_xor_b32 v39, 96, v36
    v_add_u32 v40, 65536, v32
    v_add_u32 v41, 65536, v33
    v_add_u32 v42, 65536, v34
    v_add_u32 v43, 65536, v35
    v_add_u32 v44, 65536, v36
    v_add_u32 v45, 65536, v37
    v_add_u32 v46, 65536, v38
    v_add_u32 v47, 65536, v39
    v_mov_b32 v64, 0
    v_mov_b32 v65, 0
    v_mov_b32 v66, 0
    v_mov_b32 v67, 0
    v_mov_b32 v68, 0
    v_mov_b32 v69, 0
    v_mov_b32 v70, 0
    v_mov_b32 v71, 0
    v_mov_b32 v72, 0
    v_mov_b32 v73, 0
    v_mov_b32 v74, 0
    v_mov_b32 v75, 0
    v_mov_b32 v76, 0
    v_mov_b32 v77, 0
    v_mov_b32 v78, 0
    v_mov_b32 v79, 0
    v_mov_b32 v80, 0
    v_mov_b32 v81, 0
    v_mov_b32 v82, 0
    v_mov_b32 v83, 0
    v_mov_b32 v84, 0
    v_mov_b32 v85, 0
    v_mov_b32 v86, 0
    v_mov_b32 v87, 0
    v_mov_b32 v88, 0
    v_mov_b32 v89, 0
    v_mov_b32 v90, 0
    v_mov_b32 v91, 0
    v_mov_b32 v92, 0
    v_mov_b32 v93, 0
    v_mov_b32 v94, 0
    v_mov_b32 v95, 0
    v_mov_b32 v96, 0
    v_mov_b32 v97, 0
    v_mov_b32 v98, 0
    v_mov_b32 v99, 0
    v_mov_b32 v100, 0
    v_mov_b32 v101, 0
    v_mov_b32 v102, 0
    v_mov_b32 v103, 0
    v_mov_b32 v104, 0
    v_mov_b32 v105, 0
    v_mov_b32 v106, 0
    v_mov_b32 v107, 0
    v_mov_b32 v108, 0
    v_mov_b32 v109, 0
    v_mov_b32 v110, 0
    v_mov_b32 v111, 0
    v_mov_b32 v112, 0
    v_mov_b32 v113, 0
    v_mov_b32 v114, 0
    v_mov_b32 v115, 0
    v_mov_b32 v116, 0
    v_mov_b32 v117, 0
    v_mov_b32 v118, 0
    v_mov_b32 v119, 0
    v_mov_b32 v120, 0
    v_mov_b32 v121, 0
    v_mov_b32 v122, 0
    v_mov_b32 v123, 0
    v_mov_b32 v124, 0
    v_mov_b32 v125, 0
    v_mov_b32 v126, 0
    v_mov_b32 v127, 0
    s_lshl_b32 s10, s8, 10
    s_lshl_b32 s11, s9, 9
    s_add_u32 s10, s10, s11
    s_add_u32 s10, s10, 151552
    v_lshl_add_u32 v0, v3, 4, s10
    v_xor_b32 v1, 1024, v0
    s_lshl_b32 s10, s8, 1
    s_sub_i32 s10, s6, s10
    v_sub_u32 v56, s10, v4
    v_add_u32 v57, 0, v56
    v_max_i32 v57, 0, v57
    v_lshlrev_b32 v57, 14, v57
    v_lshl_add_u32 v60, v5, 4, v57
    v_add_u32 v57, -4, v56
    v_max_i32 v57, 0, v57
    v_lshlrev_b32 v57, 14, v57
    v_lshl_add_u32 v61, v5, 4, v57
    v_add_u32 v57, -8, v56
    v_max_i32 v57, 0, v57
    v_lshlrev_b32 v57, 14, v57
    v_lshl_add_u32 v62, v5, 4, v57
    v_add_u32 v57, -12, v56
    v_max_i32 v57, 0, v57
    v_lshlrev_b32 v57, 14, v57
    v_lshl_add_u32 v63, v5, 4, v57
    s_mov_b32 s15, 0
G_s0_w:
    ds_read_b64 v[48:49], v11 offset:16
    s_waitcnt lgkmcnt(0)
    v_min_u32 v48, v48, v49
    v_cmp_gt_u32 vcc, 1, v48
    s_cbranch_vccz G_s0_ok
    s_add_u32 s15, s15, 1
    s_cmp_lt_u32 s15, 160000
    s_cbranch_scc1 G_s0_w
G_s0_ok:
    ds_read_b128 v[128:131], v32 offset:0
    ds_read_b128 v[136:139], v36 offset:0
    ds_read_b128 v[140:143], v36 offset:4096
    ds_read_b128 v[132:135], v32 offset:4096
    ds_read_b128 v[144:147], v33 offset:0
    ds_read_b128 v[152:155], v37 offset:0
    ds_read_b128 v[156:159], v37 offset:4096
    ds_read_b128 v[148:151], v33 offset:4096
    ds_read_b128 v[160:163], v34 offset:0
    ds_read_b128 v[168:171], v38 offset:0
    ds_read_b128 v[172:175], v38 offset:4096
    ds_read_b128 v[164:167], v34 offset:4096
    ds_read_b128 v[176:179], v35 offset:0
    ds_read_b128 v[184:187], v39 offset:0
    ds_read_b128 v[188:191], v39 offset:4096
    ds_read_b128 v[180:183], v35 offset:4096
    ds_read_b64 v[48:49], v11 offset:16
    v_mov_b32 v52, 1
    s_mov_b32 s12, 2
    s_waitcnt lgkmcnt(0)
    ds_write_b32 v10, v52
G1_loop:
    v_mfma_f32_32x32x16_bf16 v[64:79], v[128:131], v[136:139], v[64:79]
    s_waitcnt lgkmcnt(0)
    v_min_u32 v48, v48, v49
    v_cmp_gt_u32 vcc, s12, v48
    s_cbranch_vccnz G1_slow0
G1_back0:
    ds_read_b128 v[192:195], v32 offset:32768
    ds_read_b128 v[200:203], v36 offset:32768
    v_mfma_f32_32x32x16_bf16 v[80:95], v[128:131], v[140:143], v[80:95]
    ds_read_b128 v[204:207], v36 offset:36864
    ds_read_b128 v[196:199], v32 offset:36864
    v_mfma_f32_32x32x16_bf16 v[96:111], v[132:135], v[136:139], v[96:111]
    ds_read_b128 v[208:211], v33 offset:32768
    ds_read_b128 v[216:219], v37 offset:32768
    v_mfma_f32_32x32x16_bf16 v[112:127], v[132:135], v[140:143], v[112:127]
    ds_read_b128 v[220:223], v37 offset:36864
    ds_read_b128 v[212:215], v33 offset:36864
    v_mfma_f32_32x32x16_bf16 v[64:79], v[144:147], v[152:155], v[64:79]
    ds_read_b128 v[224:227], v34 offset:32768
    ds_read_b128 v[232:235], v38 offset:32768
    v_mfma_f32_32x32x16_bf16 v[80:95], v[144:147], v[156:159], v[80:95]
    ds_read_b128 v[236:239], v38 offset:36864
    ds_read_b128 v[228:231], v34 offset:36864
    v_mfma_f32_32x32x16_bf16 v[96:111], v[148:151], v[152:155], v[96:111]
    ds_read_b128 v[240:243], v35 offset:32768
    ds_read_b128 v[248:251], v39 offset:32768
    v_mfma_f32_32x32x16_bf16 v[112:127], v[148:151], v[156:159], v[112:127]
    ds_read_b128 v[252:255], v39 offset:36864
    ds_read_b128 v[244:247], v35 offset:36864
    v_mfma_f32_32x32x16_bf16 v[64:79], v[160:163], v[168:171], v[64:79]
    v_mfma_f32_32x32x16_bf16 v[80:95], v[160:163], v[172:175], v[80:95]
    v_mfma_f32_32x32x16_bf16 v[96:111], v[164:167], v[168:171], v[96:111]
    v_mfma_f32_32x32x16_bf16 v[112:127], v[164:167], v[172:175], v[112:127]
    v_mfma_f32_32x32x16_bf16 v[64:79], v[176:179], v[184:187], v[64:79]
    v_mov_b32 v52, s12
    s_waitcnt lgkmcnt(0)
    ds_write_b32 v10, v52
    s_add_u32 s12, s12, 1
    v_mfma_f32_32x32x16_bf16 v[80:95], v[176:179], v[188:191], v[80:95]
    ds_read_b64 v[48:49], v11 offset:16
    v_mfma_f32_32x32x16_bf16 v[96:111], v[180:183], v[184:187], v[96:111]
    v_mfma_f32_32x32x16_bf16 v[112:127], v[180:183], v[188:191], v[112:127]
    v_mfma_f32_32x32x16_bf16 v[64:79], v[192:195], v[200:203], v[64:79]
    s_waitcnt lgkmcnt(0)
    v_min_u32 v48, v48, v49
    v_cmp_gt_u32 vcc, s12, v48
    s_cbranch_vccnz G1_slow1
G1_back1:
    ds_read_b128 v[128:131], v40 offset:0
    ds_read_b128 v[136:139], v44 offset:0
    v_mfma_f32_32x32x16_bf16 v[80:95], v[192:195], v[204:207], v[80:95]
    ds_read_b128 v[140:143], v44 offset:4096
    ds_read_b128 v[132:135], v40 offset:4096
    v_mfma_f32_32x32x16_bf16 v[96:111], v[196:199], v[200:203], v[96:111]
    ds_read_b128 v[144:147], v41 offset:0
    ds_read_b128 v[152:155], v45 offset:0
    v_mfma_f32_32x32x16_bf16 v[112:127], v[196:199], v[204:207], v[112:127]
    ds_read_b128 v[156:159], v45 offset:4096
    ds_read_b128 v[148:151], v41 offset:4096
    v_mfma_f32_32x32x16_bf16 v[64:79], v[208:211], v[216:219], v[64:79]
    ds_read_b128 v[160:163], v42 offset:0
    ds_read_b128 v[168:171], v46 offset:0
    v_mfma_f32_32x32x16_bf16 v[80:95], v[208:211], v[220:223], v[80:95]
    ds_read_b128 v[172:175], v46 offset:4096
    ds_read_b128 v[164:167], v42 offset:4096
    v_mfma_f32_32x32x16_bf16 v[96:111], v[212:215], v[216:219], v[96:111]
    ds_read_b128 v[176:179], v43 offset:0
    ds_read_b128 v[184:187], v47 offset:0
    v_mfma_f32_32x32x16_bf16 v[112:127], v[212:215], v[220:223], v[112:127]
    ds_read_b128 v[188:191], v47 offset:4096
    ds_read_b128 v[180:183], v43 offset:4096
    v_mfma_f32_32x32x16_bf16 v[64:79], v[224:227], v[232:235], v[64:79]
    v_mfma_f32_32x32x16_bf16 v[80:95], v[224:227], v[236:239], v[80:95]
    v_mfma_f32_32x32x16_bf16 v[96:111], v[228:231], v[232:235], v[96:111]
    v_mfma_f32_32x32x16_bf16 v[112:127], v[228:231], v[236:239], v[112:127]
    v_mfma_f32_32x32x16_bf16 v[64:79], v[240:243], v[248:251], v[64:79]
    v_mov_b32 v52, s12
    s_waitcnt lgkmcnt(0)
    ds_write_b32 v10, v52
    s_add_u32 s12, s12, 1
    v_mfma_f32_32x32x16_bf16 v[80:95], v[240:243], v[252:255], v[80:95]
    ds_read_b64 v[48:49], v11 offset:16
    v_mfma_f32_32x32x16_bf16 v[96:111], v[244:247], v[248:251], v[96:111]
    v_mfma_f32_32x32x16_bf16 v[112:127], v[244:247], v[252:255], v[112:127]
    v_mfma_f32_32x32x16_bf16 v[64:79], v[128:131], v[136:139], v[64:79]
    s_waitcnt lgkmcnt(0)
    v_min_u32 v48, v48, v49
    v_cmp_gt_u32 vcc, s12, v48
    s_cbranch_vccnz G1_slow2
G1_back2:
    ds_read_b128 v[192:195], v40 offset:32768
    ds_read_b128 v[200:203], v44 offset:32768
    v_mfma_f32_32x32x16_bf16 v[80:95], v[128:131], v[140:143], v[80:95]
    ds_read_b128 v[204:207], v44 offset:36864
    ds_read_b128 v[196:199], v40 offset:36864
    v_mfma_f32_32x32x16_bf16 v[96:111], v[132:135], v[136:139], v[96:111]
    ds_read_b128 v[208:211], v41 offset:32768
    ds_read_b128 v[216:219], v45 offset:32768
    v_mfma_f32_32x32x16_bf16 v[112:127], v[132:135], v[140:143], v[112:127]
    ds_read_b128 v[220:223], v45 offset:36864
    ds_read_b128 v[212:215], v41 offset:36864
    v_mfma_f32_32x32x16_bf16 v[64:79], v[144:147], v[152:155], v[64:79]
    ds_read_b128 v[224:227], v42 offset:32768
    ds_read_b128 v[232:235], v46 offset:32768
    v_mfma_f32_32x32x16_bf16 v[80:95], v[144:147], v[156:159], v[80:95]
    ds_read_b128 v[236:239], v46 offset:36864
    ds_read_b128 v[228:231], v42 offset:36864
    v_mfma_f32_32x32x16_bf16 v[96:111], v[148:151], v[152:155], v[96:111]
    ds_read_b128 v[240:243], v43 offset:32768
    ds_read_b128 v[248:251], v47 offset:32768
    v_mfma_f32_32x32x16_bf16 v[112:127], v[148:151], v[156:159], v[112:127]
    ds_read_b128 v[252:255], v47 offset:36864
    ds_read_b128 v[244:247], v43 offset:36864
    v_mfma_f32_32x32x16_bf16 v[64:79], v[160:163], v[168:171], v[64:79]
    v_mfma_f32_32x32x16_bf16 v[80:95], v[160:163], v[172:175], v[80:95]
    v_mfma_f32_32x32x16_bf16 v[96:111], v[164:167], v[168:171], v[96:111]
    v_mfma_f32_32x32x16_bf16 v[112:127], v[164:167], v[172:175], v[112:127]
    v_mfma_f32_32x32x16_bf16 v[64:79], v[176:179], v[184:187], v[64:79]
    v_mov_b32 v52, s12
    s_waitcnt lgkmcnt(0)
    ds_write_b32 v10, v52
    s_add_u32 s12, s12, 1
    v_mfma_f32_32x32x16_bf16 v[80:95], v[176:179], v[188:191], v[80:95]
    ds_read_b64 v[48:49], v11 offset:16
    v_mfma_f32_32x32x16_bf16 v[96:111], v[180:183], v[184:187], v[96:111]
    v_mfma_f32_32x32x16_bf16 v[112:127], v[180:183], v[188:191], v[112:127]
    s_cmp_eq_u32 s12, 17
    s_cbranch_scc1 G1_last
    v_mfma_f32_32x32x16_bf16 v[64:79], v[192:195], v[200:203], v[64:79]
    s_waitcnt lgkmcnt(0)
    v_min_u32 v48, v48, v49
    v_cmp_gt_u32 vcc, s12, v48
    s_cbranch_vccnz G1_slow3
G1_back3:
    ds_read_b128 v[128:131], v32 offset:0
    ds_read_b128 v[136:139], v36 offset:0
    v_mfma_f32_32x32x16_bf16 v[80:95], v[192:195], v[204:207], v[80:95]
    ds_read_b128 v[140:143], v36 offset:4096
    ds_read_b128 v[132:135], v32 offset:4096
    v_mfma_f32_32x32x16_bf16 v[96:111], v[196:199], v[200:203], v[96:111]
    ds_read_b128 v[144:147], v33 offset:0
    ds_read_b128 v[152:155], v37 offset:0
    v_mfma_f32_32x32x16_bf16 v[112:127], v[196:199], v[204:207], v[112:127]
    ds_read_b128 v[156:159], v37 offset:4096
    ds_read_b128 v[148:151], v33 offset:4096
    v_mfma_f32_32x32x16_bf16 v[64:79], v[208:211], v[216:219], v[64:79]
    ds_read_b128 v[160:163], v34 offset:0
    ds_read_b128 v[168:171], v38 offset:0
    v_mfma_f32_32x32x16_bf16 v[80:95], v[208:211], v[220:223], v[80:95]
    ds_read_b128 v[172:175], v38 offset:4096
    ds_read_b128 v[164:167], v34 offset:4096
    v_mfma_f32_32x32x16_bf16 v[96:111], v[212:215], v[216:219], v[96:111]
    ds_read_b128 v[176:179], v35 offset:0
    ds_read_b128 v[184:187], v39 offset:0
    v_mfma_f32_32x32x16_bf16 v[112:127], v[212:215], v[220:223], v[112:127]
    ds_read_b128 v[188:191], v39 offset:4096
    ds_read_b128 v[180:183], v35 offset:4096
    v_mfma_f32_32x32x16_bf16 v[64:79], v[224:227], v[232:235], v[64:79]
    v_mfma_f32_32x32x16_bf16 v[80:95], v[224:227], v[236:239], v[80:95]
    v_mfma_f32_32x32x16_bf16 v[96:111], v[228:231], v[232:235], v[96:111]
    v_mfma_f32_32x32x16_bf16 v[112:127], v[228:231], v[236:239], v[112:127]
    v_mfma_f32_32x32x16_bf16 v[64:79], v[240:243], v[248:251], v[64:79]
    v_mov_b32 v52, s12
    s_waitcnt lgkmcnt(0)
    ds_write_b32 v10, v52
    s_add_u32 s12, s12, 1
    v_mfma_f32_32x32x16_bf16 v[80:95], v[240:243], v[252:255], v[80:95]
    ds_read_b64 v[48:49], v11 offset:16
    v_mfma_f32_32x32x16_bf16 v[96:111], v[244:247], v[248:251], v[96:111]
    v_mfma_f32_32x32x16_bf16 v[112:127], v[244:247], v[252:255], v[112:127]
    s_branch G1_loop
G1_slow0:
    s_mov_b32 s15, 0
G1_sl0_w:
    ds_read_b64 v[48:49], v11 offset:16
    s_waitcnt lgkmcnt(0)
    v_min_u32 v48, v48, v49
    v_cmp_gt_u32 vcc, s12, v48
    s_cbranch_vccz G1_sl0_ok
    s_add_u32 s15, s15, 1
    s_cmp_lt_u32 s15, 160000
    s_cbranch_scc1 G1_sl0_w
G1_sl0_ok:
    s_branch G1_back0
G1_slow1:
    s_mov_b32 s15, 0
G1_sl1_w:
    ds_read_b64 v[48:49], v11 offset:16
    s_waitcnt lgkmcnt(0)
    v_min_u32 v48, v48, v49
    v_cmp_gt_u32 vcc, s12, v48
    s_cbranch_vccz G1_sl1_ok
    s_add_u32 s15, s15, 1
    s_cmp_lt_u32 s15, 160000
    s_cbranch_scc1 G1_sl1_w
G1_sl1_ok:
    s_branch G1_back1
G1_slow2:
    s_mov_b32 s15, 0
G1_sl2_w:
    ds_read_b64 v[48:49], v11 offset:16
    s_waitcnt lgkmcnt(0)
    v_min_u32 v48, v48, v49
    v_cmp_gt_u32 vcc, s12, v48
    s_cbranch_vccz G1_sl2_ok
    s_add_u32 s15, s15, 1
    s_cmp_lt_u32 s15, 160000
    s_cbranch_scc1 G1_sl2_w
G1_sl2_ok:
    s_branch G1_back2
G1_slow3:
    s_mov_b32 s15, 0
G1_sl3_w:
    ds_read_b64 v[48:49], v11 offset:16
    s_waitcnt lgkmcnt(0)
    v_min_u32 v48, v48, v49
    v_cmp_gt_u32 vcc, s12, v48
    s_cbranch_vccz G1_sl3_ok
    s_add_u32 s15, s15, 1
    s_cmp_lt_u32 s15, 160000
    s_cbranch_scc1 G1_sl3_w
G1_sl3_ok:
    s_branch G1_back3
G1_last:
    v_mfma_f32_32x32x16_bf16 v[64:79], v[192:195], v[200:203], v[64:79]
    s_setprio 3
    s_waitcnt vmcnt(0)
    ds_read_b64 v[30:31], v11 offset:32
    v_lshlrev_b32 v133, 16, v12
    v_lshlrev_b32 v134, 16, v13
    v_lshlrev_b32 v135, 16, v14
    v_mul_f32 v133, 0x3fb8aa3b, v133
    v_mfma_f32_32x32x16_bf16 v[80:95], v[192:195], v[204:207], v[80:95]
    v_exp_f32 v133, v133
    v_mul_f32 v140, v134, v134
    v_cvt_pk_bf16_f32 v133, v133, v133
    v_fmac_f32 v140, v135, v135
    v_mfma_f32_32x32x16_bf16 v[96:111], v[196:199], v[200:203], v[96:111]
    v_lshlrev_b32 v133, 16, v133
    v_rcp_f32 v140, v140
    v_mul_f32 v136, v133, v134
    v_mul_f32 v137, v133, v135
    v_mfma_f32_32x32x16_bf16 v[112:127], v[196:199], v[204:207], v[112:127]
    v_mul_f32 v136, 0x3fb8aa3b, v136
    v_exp_f32 v136, v136
    v_mul_f32 v137, 0.15915494, v137
    v_cos_f32 v138, v137
    v_mfma_f32_32x32x16_bf16 v[64:79], v[208:211], v[216:219], v[64:79]
    v_sin_f32 v139, v137
    v_add_f32 v140, v140, v140
    v_mul_f32 v6, v136, v138
    v_mul_f32 v7, v136, v139
    v_mfma_f32_32x32x16_bf16 v[80:95], v[208:211], v[220:223], v[80:95]
    v_mul_f32 v128, v6, v6
    v_mul_f32 v129, v6, v7
    v_fma_f32 v128, -v7, v7, v128
    v_fmac_f32 v129, v7, v6
    v_mfma_f32_32x32x16_bf16 v[96:111], v[212:215], v[216:219], v[96:111]
    v_mul_f32 v130, v128, v128
    v_mul_f32 v131, v128, v129
    v_fma_f32 v130, -v129, v129, v130
    v_fmac_f32 v131, v129, v128
    v_mfma_f32_32x32x16_bf16 v[112:127], v[212:215], v[220:223], v[112:127]
    v_mul_f32 v12, v130, v130
    v_mul_f32 v13, v130, v131
    v_fma_f32 v12, -v131, v131, v12
    v_fmac_f32 v13, v131, v130
    v_mfma_f32_32x32x16_bf16 v[64:79], v[224:227], v[232:235], v[64:79]
    v_mul_f32 v14, v12, v12
    v_mul_f32 v15, v12, v13
    v_fma_f32 v14, -v13, v13, v14
    v_fmac_f32 v15, v13, v12
    v_mfma_f32_32x32x16_bf16 v[80:95], v[224:227], v[236:239], v[80:95]
    v_mul_f32 v16, v14, v14
    v_mul_f32 v17, v14, v15
    v_fma_f32 v16, -v15, v15, v16
    v_fmac_f32 v17, v15, v14
    v_mfma_f32_32x32x16_bf16 v[96:111], v[228:231], v[232:235], v[96:111]
    v_add_f32 v136, -1.0, v6
    v_mul_f32 v138, v136, v134
    v_fmac_f32 v138, v7, v135
    v_mul_f32 v139, v7, v134
    v_mfma_f32_32x32x16_bf16 v[112:127], v[228:231], v[236:239], v[112:127]
    v_fma_f32 v139, -v136, v135, v139
    v_mul_f32 v8, v138, v140
    v_mul_f32 v9, v139, v140
    v_mul_f32 v18, v16, v16
    v_mfma_f32_32x32x16_bf16 v[64:79], v[240:243], v[248:251], v[64:79]
    v_mul_f32 v19, v16, v17
    v_fma_f32 v18, -v17, v17, v18
    v_fmac_f32 v19, v17, v16
    v_mul_f32 v20, v18, v18
    v_mfma_f32_32x32x16_bf16 v[80:95], v[240:243], v[252:255], v[80:95]
    v_mul_f32 v21, v18, v19
    v_fma_f32 v20, -v19, v19, v20
    v_fmac_f32 v21, v19, v18
    v_mfma_f32_32x32x16_bf16 v[96:111], v[244:247], v[248:251], v[96:111]
    v_mfma_f32_32x32x16_bf16 v[112:127], v[244:247], v[252:255], v[112:127]
    s_nop 1
    v_fma_f32 v40, v6, v64, v66
    v_fma_f32 v41, v6, v65, v67
    s_nop 2
    v_fma_f32 v42, v6, v80, v82
    v_fma_f32 v43, v6, v81, v83
    s_nop 1
    v_fma_f32 v44, v6, v96, v98
    v_fma_f32 v45, v6, v97, v99
    v_fma_f32 v46, v6, v112, v114
    v_fma_f32 v47, v6, v113, v115
    v_fma_f32 v40, -v7, v80, v40
    v_fma_f32 v41, -v7, v81, v41
    v_fmac_f32 v42, v7, v64
    v_fmac_f32 v43, v7, v65
    v_fma_f32 v44, -v7, v112, v44
    v_fma_f32 v45, -v7, v113, v45
    v_fmac_f32 v46, v7, v96
    v_fmac_f32 v47, v7, v97
    v_fma_f32 v32, v6, v40, v68
    v_fma_f32 v33, v6, v41, v69
    v_fma_f32 v34, v6, v42, v84
    v_fma_f32 v35, v6, v43, v85
    v_fma_f32 v36, v6, v44, v100
    v_fma_f32 v37, v6, v45, v101
    v_fma_f32 v38, v6, v46, v116
    v_fma_f32 v39, v6, v47, v117
    v_fma_f32 v32, -v7, v42, v32
    v_fma_f32 v33, -v7, v43, v33
    v_fmac_f32 v34, v7, v40
    v_fmac_f32 v35, v7, v41
    v_fma_f32 v36, -v7, v46, v36
    v_fma_f32 v37, -v7, v47, v37
    v_fmac_f32 v38, v7, v44
    v_fmac_f32 v39, v7, v45
    v_fma_f32 v40, v6, v32, v70
    v_fma_f32 v41, v6, v33, v71
    v_fma_f32 v42, v6, v34, v86
    v_fma_f32 v43, v6, v35, v87
    v_fma_f32 v44, v6, v36, v102
    v_fma_f32 v45, v6, v37, v103
    v_fma_f32 v46, v6, v38, v118
    v_fma_f32 v47, v6, v39, v119
    v_fma_f32 v40, -v7, v34, v40
    v_fma_f32 v41, -v7, v35, v41
    v_fmac_f32 v42, v7, v32
    v_fmac_f32 v43, v7, v33
    v_fma_f32 v44, -v7, v38, v44
    v_fma_f32 v45, -v7, v39, v45
    v_fmac_f32 v46, v7, v36
    v_fmac_f32 v47, v7, v37
    v_fma_f32 v32, v6, v40, v72
    v_fma_f32 v33, v6, v41, v73
    v_fma_f32 v34, v6, v42, v88
    v_fma_f32 v35, v6, v43, v89
    v_fma_f32 v36, v6, v44, v104
    v_fma_f32 v37, v6, v45, v105
    v_fma_f32 v38, v6, v46, v120
    v_fma_f32 v39, v6, v47, v121
    v_fma_f32 v32, -v7, v42, v32
    v_fma_f32 v33, -v7, v43, v33
    v_fmac_f32 v34, v7, v40
    v_fmac_f32 v35, v7, v41
    v_fma_f32 v36, -v7, v46, v36
    v_fma_f32 v37, -v7, v47, v37
    v_fmac_f32 v38, v7, v44
    v_fmac_f32 v39, v7, v45
    v_fma_f32 v40, v6, v32, v74
    v_fma_f32 v41, v6, v33, v75
    v_fma_f32 v42, v6, v34, v90
    v_fma_f32 v43, v6, v35, v91
    v_fma_f32 v44, v6, v36, v106
    v_fma_f32 v45, v6, v37, v107
    v_fma_f32 v46, v6, v38, v122
    v_fma_f32 v47, v6, v39, v123
    v_fma_f32 v40, -v7, v34, v40
    v_fma_f32 v41, -v7, v35, v41
    v_fmac_f32 v42, v7, v32
    v_fmac_f32 v43, v7, v33
    v_fma_f32 v44, -v7, v38, v44
    v_fma_f32 v45, -v7, v39, v45
    v_fmac_f32 v46, v7, v36
    v_fmac_f32 v47, v7, v37
    v_fma_f32 v32, v6, v40, v76
    v_fma_f32 v33, v6, v41, v77
    v_fma_f32 v34, v6, v42, v92
    v_fma_f32 v35, v6, v43, v93
    v_fma_f32 v36, v6, v44, v108
    v_fma_f32 v37, v6, v45, v109
    v_fma_f32 v38, v6, v46, v124
    v_fma_f32 v39, v6, v47, v125
    v_fma_f32 v32, -v7, v42, v32
    v_fma_f32 v33, -v7, v43, v33
    v_fmac_f32 v34, v7, v40
    v_fmac_f32 v35, v7, v41
    v_fma_f32 v36, -v7, v46, v36
    v_fma_f32 v37, -v7, v47, v37
    v_fmac_f32 v38, v7, v44
    v_fmac_f32 v39, v7, v45
    v_fma_f32 v40, v6, v32, v78
    v_fma_f32 v41, v6, v33, v79
    v_fma_f32 v42, v6, v34, v94
    v_fma_f32 v43, v6, v35, v95
    v_fma_f32 v44, v6, v36, v110
    v_fma_f32 v45, v6, v37, v111
    v_fma_f32 v46, v6, v38, v126
    v_fma_f32 v47, v6, v39, v127
    v_fma_f32 v40, -v7, v34, v40
    v_fma_f32 v41, -v7, v35, v41
    v_fmac_f32 v42, v7, v32
    v_fmac_f32 v43, v7, v33
    v_fma_f32 v44, -v7, v38, v44
    v_fma_f32 v45, -v7, v39, v45
    v_fmac_f32 v46, v7, v36
    v_fmac_f32 v47, v7, v37
    v_fmac_f32 v44, v12, v40
    v_fmac_f32 v45, v12, v41
    v_fmac_f32 v46, v12, v42
    v_fmac_f32 v47, v12, v43
    v_fma_f32 v44, -v13, v42, v44
    v_fma_f32 v45, -v13, v43, v45
    v_fmac_f32 v46, v13, v40
    v_fmac_f32 v47, v13, v41
    v_fma_f32 v32, v14, v44, v45
    v_fma_f32 v34, v14, v46, v47
    v_fma_f32 v32, -v15, v46, v32
    v_fmac_f32 v34, v15, v44
    v_mov_b32 v33, v32
    v_mov_b32 v35, v34
    s_lshl_b32 s12, s6, 1
    s_add_u32 s12, s12, s8
    v_permlane32_swap_b32 v32, v33
    v_permlane32_swap_b32 v34, v35
    v_fma_f32 v28, v16, v32, v33
    v_fma_f32 v29, v16, v34, v35
    v_fma_f32 v28, -v17, v34, v28
    v_fmac_f32 v29, v17, v32
    s_waitcnt lgkmcnt(0)
    s_mov_b32 s15, 0
G_nw:
    v_cmp_eq_u32 vcc, 0, v30
    s_cbranch_vccz G_nok
    ds_read_b64 v[30:31], v11 offset:32
    s_add_u32 s15, s15, 1
    s_waitcnt lgkmcnt(0)
    s_cmp_lt_u32 s15, 160000
    s_cbranch_scc1 G_nw
G_nok:
    s_cmp_eq_u32 s8, 0
    s_cbranch_scc0 G_pw1
    ds_write_b128 v0, v[28:31] offset:2048
    s_branch G_pub1
G_pw1:
    s_mov_b32 s15, 0
G_x1:
    ds_read_b128 v[56:59], v1 offset:2048
    s_add_u32 s15, s15, 1
    s_waitcnt lgkmcnt(0)
    v_cmp_ne_u64 vcc, v[58:59], v[30:31]
    s_cbranch_vccz G_x1_ok
    s_cmp_lt_u32 s15, 160000
    s_cbranch_scc1 G_x1
G_x1_ok:
    v_fmac_f32 v28, v18, v56
    v_fmac_f32 v29, v18, v57
    s_lshl_b32 s13, s6, 14
    v_fma_f32 v28, -v19, v57, v28
    v_fmac_f32 v29, v19, v56
    s_mov_b32 exec_hi, 0
    buffer_store_dwordx4 v[28:31], v53, s[64:67], s13 offen sc1
    s_cmp_eq_u32 s6, 0
    s_cbranch_scc0 G_pub1
    s_not_b64 exec, exec
    v_mov_b32 v28, 0
    v_mov_b32 v29, 0
    buffer_store_dwordx4 v[28:31], v53, s[64:67], 0 offen sc1
G_pub1:
    s_mov_b64 exec, -1
    v_mul_f32 v128, v8, v64
    v_mul_f32 v129, v8, v65
    v_mul_f32 v144, -v8, v80
    v_mul_f32 v145, -v8, v81
    v_mul_f32 v160, v8, v96
    v_mul_f32 v161, v8, v97
    v_mul_f32 v176, -v8, v112
    v_mul_f32 v177, -v8, v113
    v_fma_f32 v128, -v9, v80, v128
    v_fma_f32 v129, -v9, v81, v129
    v_fma_f32 v144, -v9, v64, v144
    v_fma_f32 v145, -v9, v65, v145
    v_fma_f32 v160, -v9, v112, v160
    v_fma_f32 v161, -v9, v113, v161
    v_fma_f32 v176, -v9, v96, v176
    v_fma_f32 v177, -v9, v97, v177
    v_mul_f32 v130, v8, v66
    v_mul_f32 v131, v8, v67
    v_mul_f32 v146, -v8, v82
    v_mul_f32 v147, -v8, v83
    v_mul_f32 v162, v8, v98
    v_mul_f32 v163, v8, v99
    v_mul_f32 v178, -v8, v114
    v_mul_f32 v179, -v8, v115
    v_fma_f32 v130, -v9, v82, v130
    v_fma_f32 v131, -v9, v83, v131
    v_fma_f32 v146, -v9, v66, v146
    v_fma_f32 v147, -v9, v67, v147
    v_fma_f32 v162, -v9, v114, v162
    v_fma_f32 v163, -v9, v115, v163
    v_fma_f32 v178, -v9, v98, v178
    v_fma_f32 v179, -v9, v99, v179
    v_mul_f32 v132, v8, v68
    v_mul_f32 v133, v8, v69
    v_mul_f32 v148, -v8, v84
    v_mul_f32 v149, -v8, v85
    v_mul_f32 v164, v8, v100
    v_mul_f32 v165, v8, v101
    v_mul_f32 v180, -v8, v116
    v_mul_f32 v181, -v8, v117
    v_fma_f32 v132, -v9, v84, v132
    v_fma_f32 v133, -v9, v85, v133
    v_fma_f32 v148, -v9, v68, v148
    v_fma_f32 v149, -v9, v69, v149
    v_fma_f32 v164, -v9, v116, v164
    v_fma_f32 v165, -v9, v117, v165
    v_fma_f32 v180, -v9, v100, v180
    v_fma_f32 v181, -v9, v101, v181
    v_mul_f32 v134, v8, v70
    v_mul_f32 v135, v8, v71
    v_mul_f32 v150, -v8, v86
    v_mul_f32 v151, -v8, v87
    v_mul_f32 v166, v8, v102
    v_mul_f32 v167, v8, v103
    v_mul_f32 v182, -v8, v118
    v_mul_f32 v183, -v8, v119
    v_fma_f32 v134, -v9, v86, v134
    v_fma_f32 v135, -v9, v87, v135
    v_fma_f32 v150, -v9, v70, v150
    v_fma_f32 v151, -v9, v71, v151
    v_fma_f32 v166, -v9, v118, v166
    v_fma_f32 v167, -v9, v119, v167
    v_fma_f32 v182, -v9, v102, v182
    v_fma_f32 v183, -v9, v103, v183
    v_mul_f32 v136, v8, v72
    v_mul_f32 v137, v8, v73
    v_mul_f32 v152, -v8, v88
    v_mul_f32 v153, -v8, v89
    v_mul_f32 v168, v8, v104
    v_mul_f32 v169, v8, v105
    v_mul_f32 v184, -v8, v120
    v_mul_f32 v185, -v8, v121
    v_fma_f32 v136, -v9, v88, v136
    v_fma_f32 v137, -v9, v89, v137
    v_fma_f32 v152, -v9, v72, v152
    v_fma_f32 v153, -v9, v73, v153
    v_fma_f32 v168, -v9, v120, v168
    v_fma_f32 v169, -v9, v121, v169
    v_fma_f32 v184, -v9, v104, v184
    v_fma_f32 v185, -v9, v105, v185
    v_mul_f32 v138, v8, v74
    v_mul_f32 v139, v8, v75
    v_mul_f32 v154, -v8, v90
    v_mul_f32 v155, -v8, v91
    v_mul_f32 v170, v8, v106
    v_mul_f32 v171, v8, v107
    v_mul_f32 v186, -v8, v122
    v_mul_f32 v187, -v8, v123
    v_fma_f32 v138, -v9, v90, v138
    v_fma_f32 v139, -v9, v91, v139
    v_fma_f32 v154, -v9, v74, v154
    v_fma_f32 v155, -v9, v75, v155
    v_fma_f32 v170, -v9, v122, v170
    v_fma_f32 v171, -v9, v123, v171
    v_fma_f32 v186, -v9, v106, v186
    v_fma_f32 v187, -v9, v107, v187
    v_mul_f32 v140, v8, v76
    v_mul_f32 v141, v8, v77
    v_mul_f32 v156, -v8, v92
    v_mul_f32 v157, -v8, v93
    v_mul_f32 v172, v8, v108
    v_mul_f32 v173, v8, v109
    v_mul_f32 v188, -v8, v124
    v_mul_f32 v189, -v8, v125
    v_fma_f32 v140, -v9, v92, v140
    v_fma_f32 v141, -v9, v93, v141
    v_fma_f32 v156, -v9, v76, v156
    v_fma_f32 v157, -v9, v77, v157
    v_fma_f32 v172, -v9, v124, v172
    v_fma_f32 v173, -v9, v125, v173
    v_fma_f32 v188, -v9, v108, v188
    v_fma_f32 v189, -v9, v109, v189
    v_mul_f32 v142, v8, v78
    v_mul_f32 v143, v8, v79
    v_mul_f32 v158, -v8, v94
    v_mul_f32 v159, -v8, v95
    v_mul_f32 v174, v8, v110
    v_mul_f32 v175, v8, v111
    v_mul_f32 v190, -v8, v126
    v_mul_f32 v191, -v8, v127
    v_fma_f32 v142, -v9, v94, v142
    v_fma_f32 v143, -v9, v95, v143
    v_fma_f32 v158, -v9, v78, v158
    v_fma_f32 v159, -v9, v79, v159
    v_fma_f32 v174, -v9, v126, v174
    v_fma_f32 v175, -v9, v127, v175
    v_fma_f32 v190, -v9, v110, v190
    v_fma_f32 v191, -v9, v111, v191
    s_mov_b32 s13, 0
    buffer_load_dwordx2 v[80:81], v22, s[52:55], s13 offen offset:0
    buffer_load_dwordx2 v[82:83], v22, s[52:55], s13 offen offset:2048
    s_mov_b32 s13, 4096
    buffer_load_dwordx2 v[84:85], v22, s[52:55], s13 offen offset:0
    buffer_load_dwordx2 v[86:87], v22, s[52:55], s13 offen offset:2048
    s_mov_b32 s13, 32768
    buffer_load_dwordx2 v[88:89], v22, s[52:55], s13 offen offset:0
    buffer_load_dwordx2 v[90:91], v22, s[52:55], s13 offen offset:2048
    s_mov_b32 s13, 36864
    buffer_load_dwordx2 v[92:93], v22, s[52:55], s13 offen offset:0
    buffer_load_dwordx2 v[94:95], v22, s[52:55], s13 offen offset:2048
    v_cmp_eq_u32 vcc, 1, v4
    v_mov_b32 v36, 1.0
    s_nop 0
    v_cndmask_b32 v72, v36, v20, vcc
    v_cndmask_b32 v73, 0, v21, vcc
    v_cndmask_b32 v96, 0, v32, vcc
    v_cndmask_b32 v98, 0, v34, vcc
    v_cndmask_b32 v36, v36, v16, vcc
    v_cndmask_b32 v37, 0, v17, vcc
    s_cmp_eq_u32 s8, 1
    s_cselect_b64 s[14:15], -1, 0
    v_mul_f32 v74, v20, v20
    v_fma_f32 v97, v14, v96, v44
    v_mul_f32 v75, v20, v21
    v_fma_f32 v99, v14, v98, v46
    v_fma_f32 v74, -v21, v21, v74
    v_fma_f32 v97, -v15, v98, v97
    v_fmac_f32 v75, v21, v20
    v_fmac_f32 v99, v15, v96
    v_mul_f32 v76, v74, v74
    v_fma_f32 v100, v12, v96, v40
    v_mul_f32 v77, v74, v75
    v_fma_f32 v101, v12, v97, v41
    v_fma_f32 v76, -v75, v75, v76
    v_fma_f32 v102, v12, v98, v42
    v_fmac_f32 v77, v75, v74
    v_fma_f32 v103, v12, v99, v43
    v_cndmask_b32 v74, 1.0, v74, s[14:15]
    v_fma_f32 v100, -v13, v98, v100
    v_cndmask_b32 v75, 0, v75, s[14:15]
    v_fma_f32 v101, -v13, v99, v101
    v_mul_f32 v64, v72, v74
    v_fmac_f32 v102, v13, v96
    v_mul_f32 v65, v72, v75
    v_fmac_f32 v103, v13, v97
    v_fma_f32 v64, -v73, v75, v64
    v_mul_f32 v104, v8, v36
    v_fmac_f32 v65, v73, v74
    v_mul_f32 v106, v8, v37
    v_mul_f32 v66, v64, v76
    v_fma_f32 v104, -v9, v37, v104
    v_mul_f32 v67, v64, v77
    v_fmac_f32 v106, v9, v36
    v_fma_f32 v66, -v65, v77, v66
    v_mul_f32 v105, v14, v104
    v_fmac_f32 v67, v65, v76
    v_mul_f32 v107, v14, v106
    v_mul_f32 v68, v66, v76
    v_fma_f32 v105, -v15, v106, v105
    v_mul_f32 v69, v66, v77
    v_fmac_f32 v107, v15, v104
    v_fma_f32 v68, -v67, v77, v68
    v_mul_f32 v108, v12, v104
    v_fmac_f32 v69, v67, v76
    v_mul_f32 v109, v12, v105
    v_mul_f32 v70, v68, v76
    v_mul_f32 v110, v12, v106
    v_mul_f32 v71, v68, v77
    v_mul_f32 v111, v12, v107
    v_fma_f32 v70, -v69, v77, v70
    v_fma_f32 v108, -v13, v106, v108
    v_fmac_f32 v71, v69, v76
    v_fma_f32 v109, -v13, v107, v109
    v_fmac_f32 v110, v13, v104
    v_fmac_f32 v111, v13, v105
    v_mul_f32 v112, v8, v96
    v_mul_f32 v113, v8, v97
    v_mul_f32 v114, -v8, v98
    v_mul_f32 v115, -v8, v99
    v_fma_f32 v112, -v9, v98, v112
    v_fma_f32 v113, -v9, v99, v113
    v_fma_f32 v114, -v9, v96, v114
    v_fma_f32 v115, -v9, v97, v115
    v_mul_f32 v116, v8, v100
    v_mul_f32 v117, v8, v101
    v_mul_f32 v118, -v8, v102
    v_mul_f32 v119, -v8, v103
    v_fma_f32 v116, -v9, v102, v116
    v_fma_f32 v117, -v9, v103, v117
    v_fma_f32 v118, -v9, v100, v118
    v_fma_f32 v119, -v9, v101, v119
    s_lshl_b32 s13, s3, 13
    s_add_u32 s13, s13, 65536
    v_and_b32 v32, 1, v2
    v_and_b32 v33, 2, v2
    v_lshl_or_b32 v32, v33, 1, v32
    v_lshrrev_b32 v33, 1, v2
    v_xor_b32 v33, v33, v2
    v_bfe_u32 v33, v33, 2, 1
    v_lshl_or_b32 v32, v33, 1, v32
    v_lshlrev_b32 v33, 2, v4
    v_xor_b32 v32, v32, v33
    v_lshlrev_b32 v32, 4, v32
    v_lshl_add_u32 v32, v3, 7, v32
    v_add_u32 v120, s13, v32
    v_xor_b32 v121, 16, v120
    v_xor_b32 v122, 32, v120
    v_xor_b32 v123, 48, v120
    v_bfe_u32 v32, v2, 2, 2
    v_lshrrev_b32 v33, 4, v2
    v_lshl_add_u32 v33, v33, 3, v32
    v_lshlrev_b32 v33, 7, v33
    v_and_b32 v34, 1, v32
    v_and_b32 v32, 2, v32
    v_lshl_or_b32 v32, v32, 1, v34
    v_bfe_u32 v34, v2, 4, 1
    v_bfe_u32 v35, v2, 1, 1
    v_lshl_or_b32 v34, v34, 1, v35
    v_xor_b32 v32, v32, v34
    v_lshl_add_u32 v33, v32, 4, v33
    v_and_b32 v32, 1, v2
    v_lshl_add_u32 v33, v32, 3, v33
    v_add_u32 v124, s13, v33
    v_xor_b32 v125, 64, v124
    v_xor_b32 v126, 32, v124
    v_xor_b32 v127, 64, v126
    s_lshl_b32 s10, s7, 5
    s_add_u32 s10, s10, s8
    s_lshl_b32 s10, s10, 12
    v_lshrrev_b32 v40, 3, v2
    v_lshl_add_u32 v40, v40, 13, s10
    v_lshrrev_b32 v41, 4, v2
    v_xor_b32 v41, v41, v2
    v_and_b32 v41, 7, v41
    v_lshl_add_u32 v16, v41, 4, v40
    v_xor_b32 v17, 64, v16
    v_add_u32 v17, 64512, v17
    s_lshl_b32 s16, s6, 2
    s_add_u32 s16, s16, s3
    s_lshl_b32 s16, s16, 17
    s_lshl_b32 s22, s9, 13
    s_lshl_b32 s10, s8, 12
    s_add_u32 s22, s22, s10
    s_lshl_b32 s10, s9, 6
    s_lshl_b32 s11, s9, 13
    v_xor_b32 v20, s10, v124
    v_xor_b32 v21, s10, v126
    v_subrev_u32 v20, s11, v20
    v_subrev_u32 v21, s11, v21
    s_mov_b32 s15, 0
G_all16_w:
    ds_read_b128 v[48:51], v11 offset:0
    s_waitcnt lgkmcnt(0)
    v_min3_u32 v48, v48, v49, v50
    v_min_u32 v48, v48, v51
    v_cmp_gt_u32 vcc, 16, v48
    s_cbranch_vccz G_all16_ok
    s_add_u32 s15, s15, 1
    s_cmp_lt_u32 s15, 160000
    s_cbranch_scc1 G_all16_w
G_all16_ok:
    v_mov_b32 v36, 0
    v_mov_b32 v37, 0
    s_mov_b32 s15, 0
    s_cmp_eq_u32 s6, 0
    s_cbranch_scc1 G_lb4
    s_lshl_b32 s14, s8, 1
    s_sub_i32 s14, s6, s14
    s_cmp_le_i32 s14, 0
    s_cbranch_scc1 G_lb3
G_lb:
    buffer_load_dwordx4 v[192:195], v60, s[64:67], 0 offen sc1
    s_cmp_le_i32 s14, 4
    s_cbranch_scc1 G_lb1
    buffer_load_dwordx4 v[196:199], v61, s[64:67], 0 offen sc1
    s_cmp_le_i32 s14, 8
    s_cbranch_scc1 G_lb1
    buffer_load_dwordx4 v[200:203], v62, s[64:67], 0 offen sc1
    s_cmp_le_i32 s14, 12
    s_cbranch_scc1 G_lb1
    buffer_load_dwordx4 v[204:207], v63, s[64:67], 0 offen sc1
G_lb1:
    v_mov_b32 v36, 0
    v_mov_b32 v37, 0
    s_mov_b64 s[10:11], 0
    s_waitcnt vmcnt(0)
    v_cmp_ne_u64 vcc, v[194:195], v[30:31]
    v_fmac_f32 v36, v64, v192
    v_fmac_f32 v37, v64, v193
    s_or_b64 s[10:11], s[10:11], vcc
    v_fma_f32 v36, -v65, v193, v36
    v_fmac_f32 v37, v65, v192
    s_cmp_le_i32 s14, 4
    s_cbranch_scc1 G_lb2
    v_cmp_ne_u64 vcc, v[198:199], v[30:31]
    v_fmac_f32 v36, v66, v196
    v_fmac_f32 v37, v66, v197
    s_or_b64 s[10:11], s[10:11], vcc
    v_fma_f32 v36, -v67, v197, v36
    v_fmac_f32 v37, v67, v196
    s_cmp_le_i32 s14, 8
    s_cbranch_scc1 G_lb2
    v_cmp_ne_u64 vcc, v[202:203], v[30:31]
    v_fmac_f32 v36, v68, v200
    v_fmac_f32 v37, v68, v201
    s_or_b64 s[10:11], s[10:11], vcc
    v_fma_f32 v36, -v69, v201, v36
    v_fmac_f32 v37, v69, v200
    s_cmp_le_i32 s14, 12
    s_cbranch_scc1 G_lb2
    v_cmp_ne_u64 vcc, v[206:207], v[30:31]
    v_fmac_f32 v36, v70, v204
    v_fmac_f32 v37, v70, v205
    s_or_b64 s[10:11], s[10:11], vcc
    v_fma_f32 v36, -v71, v205, v36
    v_fmac_f32 v37, v71, v204
G_lb2:
    s_cmp_eq_u64 s[10:11], 0
    s_cbranch_scc1 G_lb2b
    s_add_u32 s15, s15, 1
    s_cmp_lt_u32 s15, 20000
    s_cbranch_scc1 G_lb
G_lb2b:
    v_mov_b32 v38, v36
    v_mov_b32 v39, v37
    s_nop 0
    v_permlane32_swap_b32 v36, v38
    v_permlane32_swap_b32 v37, v39
    v_add_f32 v36, v36, v38
    v_add_f32 v37, v37, v39
G_lb3:
    v_mov_b32 v28, v36
    v_mov_b32 v29, v37
    ds_write_b128 v0, v[28:31]
    s_mov_b32 s15, 0
G_x2:
    ds_read_b128 v[192:195], v1 offset:0
    s_add_u32 s15, s15, 1
    s_waitcnt lgkmcnt(0)
    v_cmp_ne_u64 vcc, v[194:195], v[30:31]
    s_cbranch_vccz G_x2_ok
    s_cmp_lt_u32 s15, 160000
    s_cbranch_scc1 G_x2
G_x2_ok:
    v_add_f32 v36, v36, v192
    v_add_f32 v37, v37, v193
G_lb4:
    s_cmp_eq_u32 s8, 0
    s_cbranch_scc1 G_lbdone
    v_fma_f32 v56, v18, v36, v56
    v_fma_f32 v57, v18, v37, v57
    v_fma_f32 v56, -v19, v37, v56
    v_fma_f32 v37, v19, v36, v57
    v_mov_b32 v36, v56
G_lbdone:
    v_fmac_f32 v112, v36, v104
    v_fmac_f32 v113, v36, v105
    v_fma_f32 v114, -v37, v104, v114
    v_fma_f32 v115, -v37, v105, v115
    v_fmac_f32 v116, v36, v108
    v_fmac_f32 v117, v36, v109
    v_fma_f32 v118, -v37, v108, v118
    v_fma_f32 v119, -v37, v109, v119
    v_fma_f32 v112, -v37, v106, v112
    v_fma_f32 v113, -v37, v107, v113
    v_fma_f32 v114, -v36, v106, v114
    v_fma_f32 v115, -v36, v107, v115
    v_fma_f32 v116, -v37, v110, v116
    v_fma_f32 v117, -v37, v111, v117
    v_fma_f32 v118, -v36, v110, v118
    v_fma_f32 v119, -v36, v111, v119
    s_bfe_u32 s18, s100, 28 + (4 << 16)
    s_lshl_b32 s18, s18, 7
    buffer_load_dwordx4 v[224:227], v16, s[80:83], s18 offen offset:0
    v_fmac_f32 v128, v6, v112
    v_fmac_f32 v129, v6, v113
    v_fmac_f32 v144, v6, v114
    v_fmac_f32 v145, v6, v115
    v_fmac_f32 v160, v6, v116
    v_fmac_f32 v161, v6, v117
    v_fmac_f32 v176, v6, v118
    v_fmac_f32 v177, v6, v119
    v_fmac_f32 v128, v7, v114
    v_fmac_f32 v129, v7, v115
    v_fma_f32 v144, -v7, v112, v144
    v_fma_f32 v145, -v7, v113, v145
    v_fmac_f32 v160, v7, v118
    v_fmac_f32 v161, v7, v119
    v_fma_f32 v176, -v7, v116, v176
    v_fma_f32 v177, -v7, v117, v177
    buffer_load_dwordx4 v[228:231], v17, s[80:83], s18 offen offset:1024
    v_fmac_f32 v130, v6, v128
    v_fmac_f32 v131, v6, v129
    v_fmac_f32 v146, v6, v144
    v_fmac_f32 v147, v6, v145
    v_fmac_f32 v162, v6, v160
    v_fmac_f32 v163, v6, v161
    v_fmac_f32 v178, v6, v176
    v_fmac_f32 v179, v6, v177
    v_fmac_f32 v130, v7, v144
    v_fmac_f32 v131, v7, v145
    v_fma_f32 v146, -v7, v128, v146
    v_fma_f32 v147, -v7, v129, v147
    v_fmac_f32 v162, v7, v176
    v_fmac_f32 v163, v7, v177
    v_fma_f32 v178, -v7, v160, v178
    v_fma_f32 v179, -v7, v161, v179
    buffer_load_dwordx4 v[232:235], v16, s[80:83], s18 offen offset:2048
    v_fmac_f32 v132, v6, v130
    v_fmac_f32 v133, v6, v131
    v_fmac_f32 v148, v6, v146
    v_fmac_f32 v149, v6, v147
    v_fmac_f32 v164, v6, v162
    v_fmac_f32 v165, v6, v163
    v_fmac_f32 v180, v6, v178
    v_fmac_f32 v181, v6, v179
    v_fmac_f32 v132, v7, v146
    v_fmac_f32 v133, v7, v147
    v_fma_f32 v148, -v7, v130, v148
    v_fma_f32 v149, -v7, v131, v149
    v_fmac_f32 v164, v7, v178
    v_fmac_f32 v165, v7, v179
    v_fma_f32 v180, -v7, v162, v180
    v_fma_f32 v181, -v7, v163, v181
    buffer_load_dwordx4 v[236:239], v17, s[80:83], s18 offen offset:3072
    v_fmac_f32 v134, v6, v132
    v_fmac_f32 v135, v6, v133
    v_fmac_f32 v150, v6, v148
    v_fmac_f32 v151, v6, v149
    v_fmac_f32 v166, v6, v164
    v_fmac_f32 v167, v6, v165
    v_fmac_f32 v182, v6, v180
    v_fmac_f32 v183, v6, v181
    v_fmac_f32 v134, v7, v148
    v_fmac_f32 v135, v7, v149
    v_fma_f32 v150, -v7, v132, v150
    v_fma_f32 v151, -v7, v133, v151
    v_fmac_f32 v166, v7, v180
    v_fmac_f32 v167, v7, v181
    v_fma_f32 v182, -v7, v164, v182
    v_fma_f32 v183, -v7, v165, v183
    s_bfe_u32 s18, s101, 0 + (4 << 16)
    s_lshl_b32 s18, s18, 7
    buffer_load_dwordx4 v[240:243], v16, s[80:83], s18 offen offset:0
    v_fmac_f32 v136, v6, v134
    v_fmac_f32 v137, v6, v135
    v_fmac_f32 v152, v6, v150
    v_fmac_f32 v153, v6, v151
    v_fmac_f32 v168, v6, v166
    v_fmac_f32 v169, v6, v167
    v_fmac_f32 v184, v6, v182
    v_fmac_f32 v185, v6, v183
    v_fmac_f32 v136, v7, v150
    v_fmac_f32 v137, v7, v151
    v_fma_f32 v152, -v7, v134, v152
    v_fma_f32 v153, -v7, v135, v153
    v_fmac_f32 v168, v7, v182
    v_fmac_f32 v169, v7, v183
    v_fma_f32 v184, -v7, v166, v184
    v_fma_f32 v185, -v7, v167, v185
    buffer_load_dwordx4 v[244:247], v17, s[80:83], s18 offen offset:1024
    v_fmac_f32 v138, v6, v136
    v_fmac_f32 v139, v6, v137
    v_fmac_f32 v154, v6, v152
    v_fmac_f32 v155, v6, v153
    v_fmac_f32 v170, v6, v168
    v_fmac_f32 v171, v6, v169
    v_fmac_f32 v186, v6, v184
    v_fmac_f32 v187, v6, v185
    v_fmac_f32 v138, v7, v152
    v_fmac_f32 v139, v7, v153
    v_fma_f32 v154, -v7, v136, v154
    v_fma_f32 v155, -v7, v137, v155
    v_fmac_f32 v170, v7, v184
    v_fmac_f32 v171, v7, v185
    v_fma_f32 v186, -v7, v168, v186
    v_fma_f32 v187, -v7, v169, v187
    buffer_load_dwordx4 v[248:251], v16, s[80:83], s18 offen offset:2048
    v_fmac_f32 v140, v6, v138
    v_fmac_f32 v141, v6, v139
    v_fmac_f32 v156, v6, v154
    v_fmac_f32 v157, v6, v155
    v_fmac_f32 v172, v6, v170
    v_fmac_f32 v173, v6, v171
    v_fmac_f32 v188, v6, v186
    v_fmac_f32 v189, v6, v187
    v_fmac_f32 v140, v7, v154
    v_fmac_f32 v141, v7, v155
    v_fma_f32 v156, -v7, v138, v156
    v_fma_f32 v157, -v7, v139, v157
    v_fmac_f32 v172, v7, v186
    v_fmac_f32 v173, v7, v187
    v_fma_f32 v188, -v7, v170, v188
    v_fma_f32 v189, -v7, v171, v189
    buffer_load_dwordx4 v[252:255], v17, s[80:83], s18 offen offset:3072
    v_fmac_f32 v142, v6, v140
    v_fmac_f32 v143, v6, v141
    v_fmac_f32 v158, v6, v156
    v_fmac_f32 v159, v6, v157
    v_fmac_f32 v174, v6, v172
    v_fmac_f32 v175, v6, v173
    v_fmac_f32 v190, v6, v188
    v_fmac_f32 v191, v6, v189
    v_fmac_f32 v142, v7, v156
    v_fmac_f32 v143, v7, v157
    v_fma_f32 v158, -v7, v140, v158
    v_fma_f32 v159, -v7, v141, v159
    v_fmac_f32 v174, v7, v188
    v_fmac_f32 v175, v7, v189
    v_fma_f32 v190, -v7, v172, v190
    v_fma_f32 v191, -v7, v173, v191
    v_cvt_pk_bf16_f32 v192, v128, v130
    v_cvt_pk_bf16_f32 v193, v132, v134
    v_cvt_pk_bf16_f32 v194, v136, v138
    v_cvt_pk_bf16_f32 v195, v140, v142
    ds_write_b128 v120, v[192:195] offset:0
    v_cvt_pk_bf16_f32 v196, v160, v162
    v_cvt_pk_bf16_f32 v197, v164, v166
    v_cvt_pk_bf16_f32 v198, v168, v170
    v_cvt_pk_bf16_f32 v199, v172, v174
    ds_write_b128 v121, v[196:199] offset:0
    v_cvt_pk_bf16_f32 v200, v129, v131
    v_cvt_pk_bf16_f32 v201, v133, v135
    v_cvt_pk_bf16_f32 v202, v137, v139
    v_cvt_pk_bf16_f32 v203, v141, v143
    ds_write_b128 v122, v[200:203] offset:0
    v_cvt_pk_bf16_f32 v204, v161, v163
    v_cvt_pk_bf16_f32 v205, v165, v167
    v_cvt_pk_bf16_f32 v206, v169, v171
    v_cvt_pk_bf16_f32 v207, v173, v175
    ds_write_b128 v123, v[204:207] offset:0
    v_cvt_pk_bf16_f32 v208, v144, v146
    v_cvt_pk_bf16_f32 v209, v148, v150
    v_cvt_pk_bf16_f32 v210, v152, v154
    v_cvt_pk_bf16_f32 v211, v156, v158
    ds_write_b128 v120, v[208:211] offset:4096
    v_cvt_pk_bf16_f32 v212, v176, v178
    v_cvt_pk_bf16_f32 v213, v180, v182
    v_cvt_pk_bf16_f32 v214, v184, v186
    v_cvt_pk_bf16_f32 v215, v188, v190
    ds_write_b128 v121, v[212:215] offset:4096
    v_cvt_pk_bf16_f32 v216, v145, v147
    v_cvt_pk_bf16_f32 v217, v149, v151
    v_cvt_pk_bf16_f32 v218, v153, v155
    v_cvt_pk_bf16_f32 v219, v157, v159
    ds_write_b128 v122, v[216:219] offset:4096
    v_cvt_pk_bf16_f32 v220, v177, v179
    v_cvt_pk_bf16_f32 v221, v181, v183
    v_cvt_pk_bf16_f32 v222, v185, v187
    v_cvt_pk_bf16_f32 v223, v189, v191
    ds_write_b128 v123, v[220:223] offset:4096
    s_lshl_b32 s10, s12, 18
    s_lshl_b32 s11, s7, 13
    s_add_u32 s10, s10, s11
    s_lshl_b32 s11, s9, 11
    s_add_u32 s10, s10, s11
    s_add_u32 s11, s10, 131072
    v_mov_b32 v22, 17
    s_waitcnt lgkmcnt(0)
    ds_read_b64_tr_b16 v[160:161], v124 offset:0
    ds_read_b64_tr_b16 v[162:163], v126 offset:512
    ds_read_b64_tr_b16 v[164:165], v126 offset:0
    ds_read_b64_tr_b16 v[166:167], v124 offset:512
    ds_read_b64_tr_b16 v[168:169], v125 offset:0
    ds_read_b64_tr_b16 v[170:171], v127 offset:512
    ds_read_b64_tr_b16 v[172:173], v127 offset:0
    ds_read_b64_tr_b16 v[174:175], v125 offset:512
    ds_read_b64_tr_b16 v[176:177], v124 offset:4096
    ds_read_b64_tr_b16 v[178:179], v126 offset:4608
    ds_read_b64_tr_b16 v[180:181], v126 offset:4096
    ds_read_b64_tr_b16 v[182:183], v124 offset:4608
    ds_read_b64_tr_b16 v[184:185], v125 offset:4096
    ds_read_b64_tr_b16 v[186:187], v127 offset:4608
    ds_read_b64_tr_b16 v[188:189], v127 offset:4096
    ds_read_b64_tr_b16 v[190:191], v125 offset:4608
    s_waitcnt lgkmcnt(14)
    buffer_store_dwordx4 v[160:163], v26, s[68:71], s10 offen offset:0 sc1
    s_waitcnt lgkmcnt(12)
    buffer_store_dwordx4 v[164:167], v26, s[68:71], s10 offen offset:1024 sc1
    s_waitcnt lgkmcnt(10)
    buffer_store_dwordx4 v[168:171], v26, s[68:71], s11 offen offset:0 sc1
    s_waitcnt lgkmcnt(8)
    buffer_store_dwordx4 v[172:175], v26, s[68:71], s11 offen offset:1024 sc1
    s_waitcnt lgkmcnt(6)
    buffer_store_dwordx4 v[176:179], v27, s[68:71], s10 offen offset:0 sc1
    s_waitcnt lgkmcnt(4)
    buffer_store_dwordx4 v[180:183], v27, s[68:71], s10 offen offset:1024 sc1
    s_waitcnt lgkmcnt(2)
    buffer_store_dwordx4 v[184:187], v27, s[68:71], s11 offen offset:0 sc1
    s_waitcnt lgkmcnt(0)
    buffer_store_dwordx4 v[188:191], v27, s[68:71], s11 offen offset:1024 sc1
    ds_write_b32 v10, v22
    v_and_b32 v112, 15, v2
    v_lshrrev_b32 v113, 1, v112
    v_lshrrev_b32 v114, 4, v2
    v_xor_b32 v113, v113, v114
    v_lshlrev_b32 v113, 4, v113
    v_lshl_add_u32 v6, v112, 7, v113
    v_xor_b32 v7, 64, v6
    v_add_u32 v8, 65536, v6
    v_add_u32 v9, 65536, v7
    v_add_u32 v0, s22, v26
    v_add_u32 v1, 65536, v0
    s_lshl_b32 s10, s6, 11
    s_add_u32 s10, s10, 32768
    s_lshl_b32 s11, s7, 7
    s_add_u32 s11, s11, s10
    v_lshl_add_u32 v5, v112, 7, s10
    v_cmp_ne_u32 s[20:21], s7, v112
    v_lshlrev_b32 v116, 16, v24
    v_and_b32 v117, 0xffff0000, v24
    v_lshlrev_b32 v118, 16, v25
    v_and_b32 v119, 0xffff0000, v25
    v_add_u32 v26, s16, v26
    v_add_u32 v27, s16, v27
    s_waitcnt vmcnt(16)
    v_lshlrev_b32 v192, 16, v80
    v_and_b32 v193, 0xffff0000, v80
    v_lshlrev_b32 v194, 16, v81
    v_and_b32 v195, 0xffff0000, v81
    v_lshlrev_b32 v196, 16, v82
    v_and_b32 v197, 0xffff0000, v82
    v_lshlrev_b32 v198, 16, v83
    v_and_b32 v199, 0xffff0000, v83
    v_lshlrev_b32 v200, 16, v84
    v_and_b32 v201, 0xffff0000, v84
    v_lshlrev_b32 v202, 16, v85
    v_and_b32 v203, 0xffff0000, v85
    v_lshlrev_b32 v204, 16, v86
    v_and_b32 v205, 0xffff0000, v86
    v_lshlrev_b32 v206, 16, v87
    v_and_b32 v207, 0xffff0000, v87
    v_lshlrev_b32 v208, 16, v88
    v_and_b32 v209, 0xffff0000, v88
    v_lshlrev_b32 v210, 16, v89
    v_and_b32 v211, 0xffff0000, v89
    v_lshlrev_b32 v212, 16, v90
    v_and_b32 v213, 0xffff0000, v90
    v_lshlrev_b32 v214, 16, v91
    v_and_b32 v215, 0xffff0000, v91
    v_lshlrev_b32 v216, 16, v92
    v_and_b32 v217, 0xffff0000, v92
    v_lshlrev_b32 v218, 16, v93
    v_and_b32 v219, 0xffff0000, v93
    v_lshlrev_b32 v220, 16, v94
    v_and_b32 v221, 0xffff0000, v94
    v_lshlrev_b32 v222, 16, v95
    v_and_b32 v223, 0xffff0000, v95
    v_mul_f32 v64, v192, v116
    v_mul_f32 v72, v193, v117
    v_mul_f32 v80, v194, v118
    v_mul_f32 v88, v195, v119
    v_mul_f32 v65, v196, v116
    v_mul_f32 v73, v197, v117
    v_mul_f32 v81, v198, v118
    v_mul_f32 v89, v199, v119
    v_mul_f32 v66, v200, v116
    v_mul_f32 v74, v201, v117
    v_mul_f32 v82, v202, v118
    v_mul_f32 v90, v203, v119
    v_mul_f32 v67, v204, v116
    v_mul_f32 v75, v205, v117
    v_mul_f32 v83, v206, v118
    v_mul_f32 v91, v207, v119
    v_mul_f32 v68, v208, v116
    v_mul_f32 v76, v209, v117
    v_mul_f32 v84, v210, v118
    v_mul_f32 v92, v211, v119
    v_mul_f32 v69, v212, v116
    v_mul_f32 v77, v213, v117
    v_mul_f32 v85, v214, v118
    v_mul_f32 v93, v215, v119
    v_mul_f32 v70, v216, v116
    v_mul_f32 v78, v217, v117
    v_mul_f32 v86, v218, v118
    v_mul_f32 v94, v219, v119
    v_mul_f32 v71, v220, v116
    v_mul_f32 v79, v221, v117
    v_mul_f32 v87, v222, v118
    v_mul_f32 v95, v223, v119
    s_mov_b32 s15, 0
G_all17_w:
    ds_read_b128 v[12:15], v11 offset:0
    s_waitcnt lgkmcnt(0)
    v_min3_u32 v12, v12, v13, v14
    v_min_u32 v12, v12, v15
    v_cmp_gt_u32 vcc, 17, v12
    s_cbranch_vccz G_all17_ok
    s_add_u32 s15, s15, 1
    s_cmp_lt_u32 s15, 160000
    s_cbranch_scc1 G_all17_w
G_all17_ok:
    ds_read_b64_tr_b16 v[128:129], v20 offset:0
    ds_read_b64_tr_b16 v[130:131], v21 offset:512
    ds_read_b64_tr_b16 v[132:133], v21 offset:0
    ds_read_b64_tr_b16 v[134:135], v20 offset:512
    ds_read_b64_tr_b16 v[136:137], v20 offset:8192
    ds_read_b64_tr_b16 v[138:139], v21 offset:8704
    ds_read_b64_tr_b16 v[140:141], v21 offset:8192
    ds_read_b64_tr_b16 v[142:143], v20 offset:8704
    ds_read_b64_tr_b16 v[144:145], v20 offset:4096
    ds_read_b64_tr_b16 v[146:147], v21 offset:4608
    ds_read_b64_tr_b16 v[148:149], v21 offset:4096
    ds_read_b64_tr_b16 v[150:151], v20 offset:4608
    ds_read_b64_tr_b16 v[152:153], v20 offset:12288
    ds_read_b64_tr_b16 v[154:155], v21 offset:12800
    ds_read_b64_tr_b16 v[156:157], v21 offset:12288
    ds_read_b64_tr_b16 v[158:159], v20 offset:12800
    v_mov_b32 v18, 1
    s_waitcnt vmcnt(0)
    s_mov_b64 exec, 1
    ds_add_rtn_u32 v18, v11, v18 offset:52
    s_waitcnt lgkmcnt(0)
    v_readfirstlane_b32 s14, v18
    s_cmp_eq_u32 s14, 3
    s_cbranch_scc0 G_nl
    buffer_store_dwordx2 v[30:31], v23, s[72:75], s11 offen sc1
    s_mov_b64 exec, -1
G_nl:
    s_mov_b64 exec, -1
    s_mov_b32 s15, 0
G_f0_w:
    ds_read_b32 v18, v11 offset:60
    s_waitcnt lgkmcnt(0)
    v_cmp_gt_u32 vcc, 4, v18
    s_cbranch_vccz G_f0_ok
    s_sleep 1
    s_add_u32 s15, s15, 1
    s_cmp_lt_u32 s15, 160000
    s_cbranch_scc1 G_f0_w
G_f0_ok:
    ds_read_b128 v[192:195], v6 offset:0
    ds_read_b128 v[196:199], v6 offset:2048
    ds_read_b128 v[200:203], v6 offset:4096
    ds_read_b128 v[204:207], v6 offset:6144
    ds_read_b128 v[208:211], v7 offset:0
    ds_read_b128 v[212:215], v7 offset:2048
    ds_read_b128 v[216:219], v7 offset:4096
    s_waitcnt lgkmcnt(6)
    v_mfma_f32_16x16x32_bf16 v[64:67], v[128:131], v[192:195], v[64:67]
    ds_read_b128 v[220:223], v7 offset:6144
    v_mfma_f32_16x16x32_bf16 v[68:71], v[132:135], v[192:195], v[68:71]
    s_bfe_u32 s18, s101, 4 + (4 << 16)
    s_lshl_b32 s18, s18, 7
    buffer_load_dwordx4 v[48:51], v16, s[80:83], s18 offen offset:0
    s_waitcnt lgkmcnt(6)
    v_mfma_f32_16x16x32_bf16 v[72:75], v[128:131], v[196:199], v[72:75]
    ds_read_b128 v[192:195], v6 offset:8192
    v_mfma_f32_16x16x32_bf16 v[76:79], v[132:135], v[196:199], v[76:79]
    s_waitcnt lgkmcnt(6)
    v_mfma_f32_16x16x32_bf16 v[80:83], v[128:131], v[200:203], v[80:83]
    ds_read_b128 v[196:199], v6 offset:10240
    v_mfma_f32_16x16x32_bf16 v[84:87], v[132:135], v[200:203], v[84:87]
    buffer_load_dwordx4 v[52:55], v17, s[80:83], s18 offen offset:1024
    s_waitcnt lgkmcnt(6)
    v_mfma_f32_16x16x32_bf16 v[88:91], v[128:131], v[204:207], v[88:91]
    ds_read_b128 v[200:203], v6 offset:12288
    v_mfma_f32_16x16x32_bf16 v[92:95], v[132:135], v[204:207], v[92:95]
    s_waitcnt lgkmcnt(6)
    v_mfma_f32_16x16x32_bf16 v[64:67], v[136:139], v[208:211], v[64:67]
    ds_read_b128 v[204:207], v6 offset:14336
    v_mfma_f32_16x16x32_bf16 v[68:71], v[140:143], v[208:211], v[68:71]
    buffer_load_dwordx4 v[56:59], v16, s[80:83], s18 offen offset:2048
    s_waitcnt lgkmcnt(6)
    v_mfma_f32_16x16x32_bf16 v[72:75], v[136:139], v[212:215], v[72:75]
    ds_read_b128 v[208:211], v7 offset:8192
    v_mfma_f32_16x16x32_bf16 v[76:79], v[140:143], v[212:215], v[76:79]
    s_waitcnt lgkmcnt(6)
    v_mfma_f32_16x16x32_bf16 v[80:83], v[136:139], v[216:219], v[80:83]
    ds_read_b128 v[212:215], v7 offset:10240
    v_mfma_f32_16x16x32_bf16 v[84:87], v[140:143], v[216:219], v[84:87]
    buffer_load_dwordx4 v[60:63], v17, s[80:83], s18 offen offset:3072
    s_waitcnt lgkmcnt(6)
    v_mfma_f32_16x16x32_bf16 v[88:91], v[136:139], v[220:223], v[88:91]
    ds_read_b128 v[216:219], v7 offset:12288
    v_mfma_f32_16x16x32_bf16 v[92:95], v[140:143], v[220:223], v[92:95]
    s_waitcnt lgkmcnt(6)
    v_mfma_f32_16x16x32_bf16 v[64:67], v[144:147], v[192:195], v[64:67]
    ds_read_b128 v[220:223], v7 offset:14336
    v_mfma_f32_16x16x32_bf16 v[68:71], v[148:151], v[192:195], v[68:71]
    s_bfe_u32 s18, s101, 8 + (4 << 16)
    s_lshl_b32 s18, s18, 7
    buffer_load_dwordx4 v[32:35], v16, s[80:83], s18 offen offset:0
    s_waitcnt lgkmcnt(6)
    v_mfma_f32_16x16x32_bf16 v[72:75], v[144:147], v[196:199], v[72:75]
    ds_read_b128 v[192:195], v6 offset:16384
    v_mfma_f32_16x16x32_bf16 v[76:79], v[148:151], v[196:199], v[76:79]
    s_waitcnt lgkmcnt(6)
    v_mfma_f32_16x16x32_bf16 v[80:83], v[144:147], v[200:203], v[80:83]
    ds_read_b128 v[196:199], v6 offset:18432
    v_mfma_f32_16x16x32_bf16 v[84:87], v[148:151], v[200:203], v[84:87]
    buffer_load_dwordx4 v[36:39], v17, s[80:83], s18 offen offset:1024
    s_waitcnt lgkmcnt(6)
    v_mfma_f32_16x16x32_bf16 v[88:91], v[144:147], v[204:207], v[88:91]
    ds_read_b128 v[200:203], v6 offset:20480
    v_mfma_f32_16x16x32_bf16 v[92:95], v[148:151], v[204:207], v[92:95]
    s_waitcnt lgkmcnt(6)
    v_mfma_f32_16x16x32_bf16 v[64:67], v[152:155], v[208:211], v[64:67]
    ds_read_b128 v[204:207], v6 offset:22528
    v_mfma_f32_16x16x32_bf16 v[68:71], v[156:159], v[208:211], v[68:71]
    buffer_load_dwordx4 v[40:43], v16, s[80:83], s18 offen offset:2048
    s_waitcnt lgkmcnt(6)
    v_mfma_f32_16x16x32_bf16 v[72:75], v[152:155], v[212:215], v[72:75]
    ds_read_b128 v[208:211], v7 offset:16384
    v_mfma_f32_16x16x32_bf16 v[76:79], v[156:159], v[212:215], v[76:79]
    s_waitcnt lgkmcnt(6)
    v_mfma_f32_16x16x32_bf16 v[80:83], v[152:155], v[216:219], v[80:83]
    ds_read_b128 v[212:215], v7 offset:18432
    v_mfma_f32_16x16x32_bf16 v[84:87], v[156:159], v[216:219], v[84:87]
    buffer_load_dwordx4 v[44:47], v17, s[80:83], s18 offen offset:3072
    s_waitcnt lgkmcnt(6)
    v_mfma_f32_16x16x32_bf16 v[88:91], v[152:155], v[220:223], v[88:91]
    ds_read_b128 v[216:219], v7 offset:20480
    v_mfma_f32_16x16x32_bf16 v[92:95], v[156:159], v[220:223], v[92:95]
    v_mov_b32 v22, 18
    ds_write_b32 v10, v22
    s_bfe_u32 s18, s101, 12 + (4 << 16)
    s_lshl_b32 s18, s18, 7
    buffer_load_dwordx4 v[96:99], v16, s[80:83], s18 offen offset:0
    buffer_load_dwordx4 v[100:103], v17, s[80:83], s18 offen offset:1024
    buffer_load_dwordx4 v[104:107], v16, s[80:83], s18 offen offset:2048
    buffer_load_dwordx4 v[108:111], v17, s[80:83], s18 offen offset:3072
    s_bfe_u32 s18, s101, 16 + (4 << 16)
    s_lshl_b32 s18, s18, 7
    buffer_load_dwordx4 v[112:115], v16, s[80:83], s18 offen offset:0
    buffer_load_dwordx4 v[116:119], v17, s[80:83], s18 offen offset:1024
    buffer_load_dwordx4 v[120:123], v16, s[80:83], s18 offen offset:2048
    buffer_load_dwordx4 v[124:127], v17, s[80:83], s18 offen offset:3072
    s_mov_b32 s15, 0
G_all18_w:
    ds_read_b128 v[12:15], v11 offset:0
    s_waitcnt lgkmcnt(0)
    v_min3_u32 v12, v12, v13, v14
    v_min_u32 v12, v12, v15
    v_cmp_gt_u32 vcc, 18, v12
    s_cbranch_vccz G_all18_ok
    s_add_u32 s15, s15, 1
    s_cmp_lt_u32 s15, 160000
    s_cbranch_scc1 G_all18_w
G_all18_ok:
    s_cmp_eq_u32 s14, 3
    s_cbranch_scc0 G_pl
    buffer_load_dwordx2 v[28:29], v5, s[72:75], 0 offen sc1
G_pl:
    s_bfe_u32 s18, s100, 16 + (4 << 16)
    s_lshl_b32 s18, s18, 7
    s_add_u32 m0, s22, 65536
    s_nop 0
    buffer_load_dwordx4 v16, s[80:83], s18 offen offset:0 lds
    buffer_load_dwordx4 v17, s[80:83], s18 offen offset:1024 lds
    buffer_load_dwordx4 v16, s[80:83], s18 offen offset:2048 lds
    buffer_load_dwordx4 v17, s[80:83], s18 offen offset:3072 lds
    s_bfe_u32 s18, s100, 20 + (4 << 16)
    s_lshl_b32 s18, s18, 7
    s_add_u32 m0, s22, 81920
    s_nop 0
    buffer_load_dwordx4 v16, s[80:83], s18 offen offset:0 lds
    buffer_load_dwordx4 v17, s[80:83], s18 offen offset:1024 lds
    buffer_load_dwordx4 v16, s[80:83], s18 offen offset:2048 lds
    buffer_load_dwordx4 v17, s[80:83], s18 offen offset:3072 lds
    s_bfe_u32 s18, s100, 24 + (4 << 16)
    s_lshl_b32 s18, s18, 7
    s_add_u32 m0, s22, 0
    s_nop 0
    buffer_load_dwordx4 v16, s[80:83], s18 offen offset:0 lds
    buffer_load_dwordx4 v17, s[80:83], s18 offen offset:1024 lds
    buffer_load_dwordx4 v16, s[80:83], s18 offen offset:2048 lds
    buffer_load_dwordx4 v17, s[80:83], s18 offen offset:3072 lds
    s_mov_b32 s15, 0
    s_cmp_eq_u32 s14, 3
    s_cbranch_scc0 G_np
    s_waitcnt vmcnt(12)
GH_chk:
    v_cmp_ne_u64 vcc, v[28:29], v[30:31]
    s_and_b64 vcc, vcc, s[20:21]
    s_cbranch_scc0 GH_ok
    buffer_load_dwordx2 v[28:29], v5, s[72:75], 0 offen sc1
    s_add_u32 s15, s15, 1
    s_cmp_lt_u32 s15, 20000
    s_waitcnt vmcnt(0)
    s_cbranch_scc1 GH_chk
GH_ok:
    ds_write_b32 v11, v22 offset:56
    s_branch G_go
G_np:
    s_mov_b32 s15, 0
G_fho_w:
    ds_read_b32 v18, v11 offset:56
    s_waitcnt lgkmcnt(0)
    v_cmp_gt_u32 vcc, 1, v18
    s_cbranch_vccz G_fho_ok
    s_sleep 1
    s_add_u32 s15, s15, 1
    s_cmp_lt_u32 s15, 160000
    s_cbranch_scc1 G_fho_w
G_fho_ok:
G_go:
    s_bfe_u32 s19, s100, 4 + (4 << 16)
    s_lshl_b32 s19, s19, 13
    buffer_load_dwordx4 v[160:163], v26, s[68:71], s19 offen offset:0 sc1
    buffer_load_dwordx4 v[164:167], v26, s[68:71], s19 offen offset:1024 sc1
    buffer_load_dwordx4 v[168:171], v26, s[68:71], s19 offen offset:2048 sc1
    buffer_load_dwordx4 v[172:175], v26, s[68:71], s19 offen offset:3072 sc1
    buffer_load_dwordx4 v[176:179], v27, s[68:71], s19 offen offset:0 sc1
    buffer_load_dwordx4 v[180:183], v27, s[68:71], s19 offen offset:1024 sc1
    buffer_load_dwordx4 v[184:187], v27, s[68:71], s19 offen offset:2048 sc1
    buffer_load_dwordx4 v[188:191], v27, s[68:71], s19 offen offset:3072 sc1
    s_bfe_u32 s19, s100, 8 + (4 << 16)
    s_lshl_b32 s19, s19, 13
    buffer_load_dwordx4 v[128:131], v26, s[68:71], s19 offen offset:0 sc1
    buffer_load_dwordx4 v[132:135], v26, s[68:71], s19 offen offset:1024 sc1
    buffer_load_dwordx4 v[136:139], v26, s[68:71], s19 offen offset:2048 sc1
    buffer_load_dwordx4 v[140:143], v26, s[68:71], s19 offen offset:3072 sc1
    buffer_load_dwordx4 v[144:147], v27, s[68:71], s19 offen offset:0 sc1
    buffer_load_dwordx4 v[148:151], v27, s[68:71], s19 offen offset:1024 sc1
    buffer_load_dwordx4 v[152:155], v27, s[68:71], s19 offen offset:2048 sc1
    buffer_load_dwordx4 v[156:159], v27, s[68:71], s19 offen offset:3072 sc1
    s_setprio 1
    s_waitcnt vmcnt(14)
    v_mfma_f32_16x16x32_bf16 v[64:67], v[160:163], v[192:195], v[64:67]
    ds_read_b128 v[220:223], v7 offset:22528
    v_mov_b32 v22, 19
    v_mfma_f32_16x16x32_bf16 v[68:71], v[164:167], v[192:195], v[68:71]
    v_mfma_f32_16x16x32_bf16 v[72:75], v[160:163], v[196:199], v[72:75]
    ds_read_b128 v[192:195], v6 offset:24576
    v_mfma_f32_16x16x32_bf16 v[76:79], v[164:167], v[196:199], v[76:79]
    ds_write_b32 v10, v22
    v_mfma_f32_16x16x32_bf16 v[80:83], v[160:163], v[200:203], v[80:83]
    ds_read_b128 v[196:199], v6 offset:26624
    v_mfma_f32_16x16x32_bf16 v[84:87], v[164:167], v[200:203], v[84:87]
    v_mfma_f32_16x16x32_bf16 v[88:91], v[160:163], v[204:207], v[88:91]
    ds_read_b128 v[200:203], v6 offset:28672
    s_bfe_u32 s19, s100, 12 + (4 << 16)
    v_mfma_f32_16x16x32_bf16 v[92:95], v[164:167], v[204:207], v[92:95]
    s_lshl_b32 s19, s19, 13
    s_waitcnt vmcnt(12)
    v_mfma_f32_16x16x32_bf16 v[64:67], v[168:171], v[208:211], v[64:67]
    ds_read_b128 v[204:207], v6 offset:30720
    v_mfma_f32_16x16x32_bf16 v[68:71], v[172:175], v[208:211], v[68:71]
    buffer_load_dwordx4 v[160:163], v26, s[68:71], s19 offen offset:0 sc1
    v_mfma_f32_16x16x32_bf16 v[72:75], v[168:171], v[212:215], v[72:75]
    ds_read_b128 v[208:211], v7 offset:24576
    v_mfma_f32_16x16x32_bf16 v[76:79], v[172:175], v[212:215], v[76:79]
    v_mfma_f32_16x16x32_bf16 v[80:83], v[168:171], v[216:219], v[80:83]
    ds_read_b128 v[212:215], v7 offset:26624
    v_mfma_f32_16x16x32_bf16 v[84:87], v[172:175], v[216:219], v[84:87]
    buffer_load_dwordx4 v[164:167], v26, s[68:71], s19 offen offset:1024 sc1
    s_waitcnt lgkmcnt(7)
    v_mfma_f32_16x16x32_bf16 v[88:91], v[168:171], v[220:223], v[88:91]
    ds_read_b128 v[216:219], v7 offset:28672
    v_mfma_f32_16x16x32_bf16 v[92:95], v[172:175], v[220:223], v[92:95]
    s_waitcnt vmcnt(12) lgkmcnt(7)
    v_mfma_f32_16x16x32_bf16 v[64:67], v[176:179], v[192:195], v[64:67]
    ds_read_b128 v[220:223], v7 offset:30720
    v_mfma_f32_16x16x32_bf16 v[68:71], v[180:183], v[192:195], v[68:71]
    buffer_load_dwordx4 v[168:171], v26, s[68:71], s19 offen offset:2048 sc1
    s_waitcnt lgkmcnt(6)
    v_mfma_f32_16x16x32_bf16 v[72:75], v[176:179], v[196:199], v[72:75]
    ds_read_b128 v[192:195], v6 offset:32768
    v_mfma_f32_16x16x32_bf16 v[76:79], v[180:183], v[196:199], v[76:79]
    s_waitcnt lgkmcnt(6)
    v_mfma_f32_16x16x32_bf16 v[80:83], v[176:179], v[200:203], v[80:83]
    ds_read_b128 v[196:199], v6 offset:34816
    v_mfma_f32_16x16x32_bf16 v[84:87], v[180:183], v[200:203], v[84:87]
    buffer_load_dwordx4 v[172:175], v26, s[68:71], s19 offen offset:3072 sc1
    s_waitcnt lgkmcnt(6)
    v_mfma_f32_16x16x32_bf16 v[88:91], v[176:179], v[204:207], v[88:91]
    ds_read_b128 v[200:203], v6 offset:36864
    v_mfma_f32_16x16x32_bf16 v[92:95], v[180:183], v[204:207], v[92:95]
    s_waitcnt vmcnt(12) lgkmcnt(6)
    v_mfma_f32_16x16x32_bf16 v[64:67], v[184:187], v[208:211], v[64:67]
    ds_read_b128 v[204:207], v6 offset:38912
    v_mfma_f32_16x16x32_bf16 v[68:71], v[188:191], v[208:211], v[68:71]
    buffer_load_dwordx4 v[176:179], v27, s[68:71], s19 offen offset:0 sc1
    s_waitcnt lgkmcnt(6)
    v_mfma_f32_16x16x32_bf16 v[72:75], v[184:187], v[212:215], v[72:75]
    ds_read_b128 v[208:211], v7 offset:32768
    v_mfma_f32_16x16x32_bf16 v[76:79], v[188:191], v[212:215], v[76:79]
    s_waitcnt lgkmcnt(6)
    v_mfma_f32_16x16x32_bf16 v[80:83], v[184:187], v[216:219], v[80:83]
    ds_read_b128 v[212:215], v7 offset:34816
    v_mfma_f32_16x16x32_bf16 v[84:87], v[188:191], v[216:219], v[84:87]
    buffer_load_dwordx4 v[180:183], v27, s[68:71], s19 offen offset:1024 sc1
    s_waitcnt lgkmcnt(6)
    v_mfma_f32_16x16x32_bf16 v[88:91], v[184:187], v[220:223], v[88:91]
    ds_read_b128 v[216:219], v7 offset:36864
    v_mfma_f32_16x16x32_bf16 v[92:95], v[188:191], v[220:223], v[92:95]
    s_waitcnt vmcnt(12) lgkmcnt(6)
    v_mfma_f32_16x16x32_bf16 v[64:67], v[128:131], v[192:195], v[64:67]
    ds_read_b128 v[220:223], v7 offset:38912
    v_mov_b32 v22, 20
    v_mfma_f32_16x16x32_bf16 v[68:71], v[132:135], v[192:195], v[68:71]
    buffer_load_dwordx4 v[184:187], v27, s[68:71], s19 offen offset:2048 sc1
    s_waitcnt lgkmcnt(6)
    v_mfma_f32_16x16x32_bf16 v[72:75], v[128:131], v[196:199], v[72:75]
    ds_read_b128 v[192:195], v6 offset:40960
    v_mfma_f32_16x16x32_bf16 v[76:79], v[132:135], v[196:199], v[76:79]
    ds_write_b32 v10, v22
    s_waitcnt lgkmcnt(7)
    v_mfma_f32_16x16x32_bf16 v[80:83], v[128:131], v[200:203], v[80:83]
    ds_read_b128 v[196:199], v6 offset:43008
    v_mfma_f32_16x16x32_bf16 v[84:87], v[132:135], v[200:203], v[84:87]
    buffer_load_dwordx4 v[188:191], v27, s[68:71], s19 offen offset:3072 sc1
    s_waitcnt lgkmcnt(7)
    v_mfma_f32_16x16x32_bf16 v[88:91], v[128:131], v[204:207], v[88:91]
    ds_read_b128 v[200:203], v6 offset:45056
    s_bfe_u32 s19, s100, 16 + (4 << 16)
    v_mfma_f32_16x16x32_bf16 v[92:95], v[132:135], v[204:207], v[92:95]
    s_lshl_b32 s19, s19, 13
    s_waitcnt vmcnt(12) lgkmcnt(7)
    v_mfma_f32_16x16x32_bf16 v[64:67], v[136:139], v[208:211], v[64:67]
    ds_read_b128 v[204:207], v6 offset:47104
    v_mfma_f32_16x16x32_bf16 v[68:71], v[140:143], v[208:211], v[68:71]
    buffer_load_dwordx4 v[128:131], v26, s[68:71], s19 offen offset:0 sc1
    s_waitcnt lgkmcnt(7)
    v_mfma_f32_16x16x32_bf16 v[72:75], v[136:139], v[212:215], v[72:75]
    ds_read_b128 v[208:211], v7 offset:40960
    v_mfma_f32_16x16x32_bf16 v[76:79], v[140:143], v[212:215], v[76:79]
    s_waitcnt lgkmcnt(7)
    v_mfma_f32_16x16x32_bf16 v[80:83], v[136:139], v[216:219], v[80:83]
    ds_read_b128 v[212:215], v7 offset:43008
    v_mfma_f32_16x16x32_bf16 v[84:87], v[140:143], v[216:219], v[84:87]
    buffer_load_dwordx4 v[132:135], v26, s[68:71], s19 offen offset:1024 sc1
    s_waitcnt lgkmcnt(7)
    v_mfma_f32_16x16x32_bf16 v[88:91], v[136:139], v[220:223], v[88:91]
    ds_read_b128 v[216:219], v7 offset:45056
    v_mfma_f32_16x16x32_bf16 v[92:95], v[140:143], v[220:223], v[92:95]
    s_waitcnt vmcnt(12) lgkmcnt(7)
    v_mfma_f32_16x16x32_bf16 v[64:67], v[144:147], v[192:195], v[64:67]
    ds_read_b128 v[220:223], v7 offset:47104
    v_mfma_f32_16x16x32_bf16 v[68:71], v[148:151], v[192:195], v[68:71]
    buffer_load_dwordx4 v[136:139], v26, s[68:71], s19 offen offset:2048 sc1
    s_waitcnt lgkmcnt(6)
    v_mfma_f32_16x16x32_bf16 v[72:75], v[144:147], v[196:199], v[72:75]
    ds_read_b128 v[192:195], v6 offset:49152
    v_mfma_f32_16x16x32_bf16 v[76:79], v[148:151], v[196:199], v[76:79]
    s_waitcnt lgkmcnt(6)
    v_mfma_f32_16x16x32_bf16 v[80:83], v[144:147], v[200:203], v[80:83]
    ds_read_b128 v[196:199], v6 offset:51200
    ds_read_b128 v[12:15], v11
    v_mfma_f32_16x16x32_bf16 v[84:87], v[148:151], v[200:203], v[84:87]
    buffer_load_dwordx4 v[140:143], v26, s[68:71], s19 offen offset:3072 sc1
    s_waitcnt lgkmcnt(7)
    v_mfma_f32_16x16x32_bf16 v[88:91], v[144:147], v[204:207], v[88:91]
    ds_read_b128 v[200:203], v6 offset:53248
    v_mfma_f32_16x16x32_bf16 v[92:95], v[148:151], v[204:207], v[92:95]
    s_waitcnt vmcnt(12) lgkmcnt(7)
    v_mfma_f32_16x16x32_bf16 v[64:67], v[152:155], v[208:211], v[64:67]
    ds_read_b128 v[204:207], v6 offset:55296
    v_mfma_f32_16x16x32_bf16 v[68:71], v[156:159], v[208:211], v[68:71]
    buffer_load_dwordx4 v[144:147], v27, s[68:71], s19 offen offset:0 sc1
    s_waitcnt lgkmcnt(7)
    v_mfma_f32_16x16x32_bf16 v[72:75], v[152:155], v[212:215], v[72:75]
    ds_read_b128 v[208:211], v7 offset:49152
    v_mfma_f32_16x16x32_bf16 v[76:79], v[156:159], v[212:215], v[76:79]
    s_waitcnt lgkmcnt(7)
    v_mfma_f32_16x16x32_bf16 v[80:83], v[152:155], v[216:219], v[80:83]
    ds_read_b128 v[212:215], v7 offset:51200
    v_mfma_f32_16x16x32_bf16 v[84:87], v[156:159], v[216:219], v[84:87]
    buffer_load_dwordx4 v[148:151], v27, s[68:71], s19 offen offset:1024 sc1
    s_waitcnt lgkmcnt(7)
    v_mfma_f32_16x16x32_bf16 v[88:91], v[152:155], v[220:223], v[88:91]
    ds_read_b128 v[216:219], v7 offset:53248
    v_mfma_f32_16x16x32_bf16 v[92:95], v[156:159], v[220:223], v[92:95]
    s_waitcnt vmcnt(12) lgkmcnt(7)
    v_mfma_f32_16x16x32_bf16 v[64:67], v[160:163], v[192:195], v[64:67]
    ds_read_b128 v[220:223], v7 offset:55296
    v_mov_b32 v22, 21
    v_mfma_f32_16x16x32_bf16 v[68:71], v[164:167], v[192:195], v[68:71]
    buffer_load_dwordx4 v[152:155], v27, s[68:71], s19 offen offset:2048 sc1
    s_waitcnt lgkmcnt(7)
    v_mfma_f32_16x16x32_bf16 v[72:75], v[160:163], v[196:199], v[72:75]
    ds_read_b128 v[192:195], v6 offset:57344
    s_waitcnt lgkmcnt(7)
    v_min3_u32 v12, v12, v13, v14
    v_mfma_f32_16x16x32_bf16 v[76:79], v[164:167], v[196:199], v[76:79]
    ds_write_b32 v10, v22
    s_waitcnt lgkmcnt(7)
    v_mfma_f32_16x16x32_bf16 v[80:83], v[160:163], v[200:203], v[80:83]
    ds_read_b128 v[196:199], v6 offset:59392
    v_min_u32 v12, v12, v15
    v_mfma_f32_16x16x32_bf16 v[84:87], v[164:167], v[200:203], v[84:87]
    buffer_load_dwordx4 v[156:159], v27, s[68:71], s19 offen offset:3072 sc1
    s_waitcnt lgkmcnt(7)
    v_mfma_f32_16x16x32_bf16 v[88:91], v[160:163], v[204:207], v[88:91]
    ds_read_b128 v[200:203], v6 offset:61440
    s_bfe_u32 s19, s100, 20 + (4 << 16)
    v_mfma_f32_16x16x32_bf16 v[92:95], v[164:167], v[204:207], v[92:95]
    s_lshl_b32 s19, s19, 13
    s_waitcnt vmcnt(12) lgkmcnt(7)
    v_mfma_f32_16x16x32_bf16 v[64:67], v[168:171], v[208:211], v[64:67]
    ds_read_b128 v[204:207], v6 offset:63488
    v_cmp_gt_u32 vcc, 20, v12
    v_mfma_f32_16x16x32_bf16 v[68:71], v[172:175], v[208:211], v[68:71]
    buffer_load_dwordx4 v[160:163], v26, s[68:71], s19 offen offset:0 sc1
    s_waitcnt lgkmcnt(7)
    v_mfma_f32_16x16x32_bf16 v[72:75], v[168:171], v[212:215], v[72:75]
    ds_read_b128 v[208:211], v7 offset:57344
    s_cbranch_vccnz G2_slow3
G2_back3:
    v_mfma_f32_16x16x32_bf16 v[76:79], v[172:175], v[212:215], v[76:79]
    ds_write_b64 v0, v[224:225] offset:16384
    s_waitcnt lgkmcnt(8)
    v_mfma_f32_16x16x32_bf16 v[80:83], v[168:171], v[216:219], v[80:83]
    ds_read_b128 v[212:215], v7 offset:59392
    v_mfma_f32_16x16x32_bf16 v[84:87], v[172:175], v[216:219], v[84:87]
    buffer_load_dwordx4 v[164:167], v26, s[68:71], s19 offen offset:1024 sc1
    s_waitcnt lgkmcnt(8)
    v_mfma_f32_16x16x32_bf16 v[88:91], v[168:171], v[220:223], v[88:91]
    ds_read_b128 v[216:219], v7 offset:61440
    v_mfma_f32_16x16x32_bf16 v[92:95], v[172:175], v[220:223], v[92:95]
    ds_write_b64 v0, v[226:227] offset:16392
    s_waitcnt vmcnt(12) lgkmcnt(9)
    v_mfma_f32_16x16x32_bf16 v[64:67], v[176:179], v[192:195], v[64:67]
    ds_read_b128 v[220:223], v7 offset:63488
    ds_write_b64 v0, v[228:229] offset:17408
    v_mfma_f32_16x16x32_bf16 v[68:71], v[180:183], v[192:195], v[68:71]
    buffer_load_dwordx4 v[168:171], v26, s[68:71], s19 offen offset:2048 sc1
    s_waitcnt lgkmcnt(9)
    v_mfma_f32_16x16x32_bf16 v[72:75], v[176:179], v[196:199], v[72:75]
    ds_read_b128 v[192:195], v8 offset:0
    v_mfma_f32_16x16x32_bf16 v[76:79], v[180:183], v[196:199], v[76:79]
    ds_write_b64 v0, v[230:231] offset:17416
    s_waitcnt lgkmcnt(10)
    v_mfma_f32_16x16x32_bf16 v[80:83], v[176:179], v[200:203], v[80:83]
    ds_read_b128 v[196:199], v8 offset:2048
    ds_read_b128 v[12:15], v11
    v_mfma_f32_16x16x32_bf16 v[84:87], v[180:183], v[200:203], v[84:87]
    buffer_load_dwordx4 v[172:175], v26, s[68:71], s19 offen offset:3072 sc1
    s_waitcnt lgkmcnt(11)
    v_mfma_f32_16x16x32_bf16 v[88:91], v[176:179], v[204:207], v[88:91]
    ds_read_b128 v[200:203], v8 offset:4096
    v_mfma_f32_16x16x32_bf16 v[92:95], v[180:183], v[204:207], v[92:95]
    ds_write_b64 v0, v[232:233] offset:18432
    s_waitcnt vmcnt(12) lgkmcnt(12)
    v_mfma_f32_16x16x32_bf16 v[64:67], v[184:187], v[208:211], v[64:67]
    ds_read_b128 v[204:207], v8 offset:6144
    ds_write_b64 v0, v[234:235] offset:18440
    v_mfma_f32_16x16x32_bf16 v[68:71], v[188:191], v[208:211], v[68:71]
    buffer_load_dwordx4 v[176:179], v27, s[68:71], s19 offen offset:0 sc1
    s_waitcnt lgkmcnt(12)
    v_mfma_f32_16x16x32_bf16 v[72:75], v[184:187], v[212:215], v[72:75]
    ds_read_b128 v[208:211], v9 offset:0
    v_mfma_f32_16x16x32_bf16 v[76:79], v[188:191], v[212:215], v[76:79]
    ds_write_b64 v0, v[236:237] offset:19456
    s_waitcnt lgkmcnt(13)
    v_mfma_f32_16x16x32_bf16 v[80:83], v[184:187], v[216:219], v[80:83]
    ds_read_b128 v[212:215], v9 offset:2048
    v_mfma_f32_16x16x32_bf16 v[84:87], v[188:191], v[216:219], v[84:87]
    buffer_load_dwordx4 v[180:183], v27, s[68:71], s19 offen offset:1024 sc1
    s_waitcnt lgkmcnt(12)
    v_mfma_f32_16x16x32_bf16 v[88:91], v[184:187], v[220:223], v[88:91]
    ds_read_b128 v[216:219], v9 offset:4096
    v_mfma_f32_16x16x32_bf16 v[92:95], v[188:191], v[220:223], v[92:95]
    ds_write_b64 v0, v[238:239] offset:19464
    s_waitcnt vmcnt(12) lgkmcnt(12)
    v_mfma_f32_16x16x32_bf16 v[64:67], v[128:131], v[192:195], v[64:67]
    ds_read_b128 v[220:223], v9 offset:6144
    v_mov_b32 v22, 22
    v_mfma_f32_16x16x32_bf16 v[68:71], v[132:135], v[192:195], v[68:71]
    buffer_load_dwordx4 v[184:187], v27, s[68:71], s19 offen offset:2048 sc1
    s_waitcnt lgkmcnt(11)
    v_mfma_f32_16x16x32_bf16 v[72:75], v[128:131], v[196:199], v[72:75]
    ds_read_b128 v[192:195], v8 offset:8192
    s_waitcnt lgkmcnt(11)
    v_min3_u32 v12, v12, v13, v14
    v_mfma_f32_16x16x32_bf16 v[76:79], v[132:135], v[196:199], v[76:79]
    ds_write_b32 v10, v22
    s_waitcnt lgkmcnt(11)
    v_mfma_f32_16x16x32_bf16 v[80:83], v[128:131], v[200:203], v[80:83]
    ds_read_b128 v[196:199], v8 offset:10240
    v_min_u32 v12, v12, v15
    v_mfma_f32_16x16x32_bf16 v[84:87], v[132:135], v[200:203], v[84:87]
    buffer_load_dwordx4 v[188:191], v27, s[68:71], s19 offen offset:3072 sc1
    s_waitcnt lgkmcnt(10)
    v_mfma_f32_16x16x32_bf16 v[88:91], v[128:131], v[204:207], v[88:91]
    ds_read_b128 v[200:203], v8 offset:12288
    s_bfe_u32 s19, s100, 24 + (4 << 16)
    v_mfma_f32_16x16x32_bf16 v[92:95], v[132:135], v[204:207], v[92:95]
    s_lshl_b32 s19, s19, 13
    s_waitcnt vmcnt(12) lgkmcnt(9)
    v_mfma_f32_16x16x32_bf16 v[64:67], v[136:139], v[208:211], v[64:67]
    ds_read_b128 v[204:207], v8 offset:14336
    v_cmp_gt_u32 vcc, 21, v12
    v_mfma_f32_16x16x32_bf16 v[68:71], v[140:143], v[208:211], v[68:71]
    buffer_load_dwordx4 v[128:131], v26, s[68:71], s19 offen offset:0 sc1
    s_waitcnt lgkmcnt(8)
    v_mfma_f32_16x16x32_bf16 v[72:75], v[136:139], v[212:215], v[72:75]
    ds_read_b128 v[208:211], v9 offset:8192
    s_cbranch_vccnz G2_slow4
G2_back4:
    v_mfma_f32_16x16x32_bf16 v[76:79], v[140:143], v[212:215], v[76:79]
    ds_write_b64 v0, v[240:241] offset:32768
    s_waitcnt lgkmcnt(9)
    v_mfma_f32_16x16x32_bf16 v[80:83], v[136:139], v[216:219], v[80:83]
    ds_read_b128 v[212:215], v9 offset:10240
    v_mfma_f32_16x16x32_bf16 v[84:87], v[140:143], v[216:219], v[84:87]
    buffer_load_dwordx4 v[132:135], v26, s[68:71], s19 offen offset:1024 sc1
    s_waitcnt lgkmcnt(8)
    v_mfma_f32_16x16x32_bf16 v[88:91], v[136:139], v[220:223], v[88:91]
    ds_read_b128 v[216:219], v9 offset:12288
    v_mfma_f32_16x16x32_bf16 v[92:95], v[140:143], v[220:223], v[92:95]
    ds_write_b64 v0, v[242:243] offset:32776
    s_waitcnt vmcnt(12) lgkmcnt(9)
    v_mfma_f32_16x16x32_bf16 v[64:67], v[144:147], v[192:195], v[64:67]
    ds_read_b128 v[220:223], v9 offset:14336
    ds_write_b64 v0, v[244:245] offset:33792
    v_mfma_f32_16x16x32_bf16 v[68:71], v[148:151], v[192:195], v[68:71]
    buffer_load_dwordx4 v[136:139], v26, s[68:71], s19 offen offset:2048 sc1
    s_waitcnt lgkmcnt(9)
    v_mfma_f32_16x16x32_bf16 v[72:75], v[144:147], v[196:199], v[72:75]
    ds_read_b128 v[192:195], v8 offset:16384
    v_mfma_f32_16x16x32_bf16 v[76:79], v[148:151], v[196:199], v[76:79]
    ds_write_b64 v0, v[246:247] offset:33800
    s_waitcnt lgkmcnt(10)
    v_mfma_f32_16x16x32_bf16 v[80:83], v[144:147], v[200:203], v[80:83]
    ds_read_b128 v[196:199], v8 offset:18432
    ds_read_b128 v[12:15], v11
    v_mfma_f32_16x16x32_bf16 v[84:87], v[148:151], v[200:203], v[84:87]
    buffer_load_dwordx4 v[140:143], v26, s[68:71], s19 offen offset:3072 sc1
    s_waitcnt lgkmcnt(11)
    v_mfma_f32_16x16x32_bf16 v[88:91], v[144:147], v[204:207], v[88:91]
    ds_read_b128 v[200:203], v8 offset:20480
    v_mfma_f32_16x16x32_bf16 v[92:95], v[148:151], v[204:207], v[92:95]
    ds_write_b64 v0, v[248:249] offset:34816
    s_waitcnt vmcnt(12) lgkmcnt(12)
    v_mfma_f32_16x16x32_bf16 v[64:67], v[152:155], v[208:211], v[64:67]
    ds_read_b128 v[204:207], v8 offset:22528
    ds_write_b64 v0, v[250:251] offset:34824
    v_mfma_f32_16x16x32_bf16 v[68:71], v[156:159], v[208:211], v[68:71]
    buffer_load_dwordx4 v[144:147], v27, s[68:71], s19 offen offset:0 sc1
    s_waitcnt lgkmcnt(12)
    v_mfma_f32_16x16x32_bf16 v[72:75], v[152:155], v[212:215], v[72:75]
    ds_read_b128 v[208:211], v9 offset:16384
    v_mfma_f32_16x16x32_bf16 v[76:79], v[156:159], v[212:215], v[76:79]
    ds_write_b64 v0, v[252:253] offset:35840
    s_waitcnt lgkmcnt(13)
    v_mfma_f32_16x16x32_bf16 v[80:83], v[152:155], v[216:219], v[80:83]
    ds_read_b128 v[212:215], v9 offset:18432
    v_mfma_f32_16x16x32_bf16 v[84:87], v[156:159], v[216:219], v[84:87]
    buffer_load_dwordx4 v[148:151], v27, s[68:71], s19 offen offset:1024 sc1
    s_waitcnt lgkmcnt(12)
    v_mfma_f32_16x16x32_bf16 v[88:91], v[152:155], v[220:223], v[88:91]
    ds_read_b128 v[216:219], v9 offset:20480
    v_mfma_f32_16x16x32_bf16 v[92:95], v[156:159], v[220:223], v[92:95]
    ds_write_b64 v0, v[254:255] offset:35848
    s_waitcnt vmcnt(12) lgkmcnt(12)
    v_mfma_f32_16x16x32_bf16 v[64:67], v[160:163], v[192:195], v[64:67]
    ds_read_b128 v[220:223], v9 offset:22528
    v_mov_b32 v22, 23
    v_mfma_f32_16x16x32_bf16 v[68:71], v[164:167], v[192:195], v[68:71]
    buffer_load_dwordx4 v[152:155], v27, s[68:71], s19 offen offset:2048 sc1
    s_waitcnt lgkmcnt(11)
    v_mfma_f32_16x16x32_bf16 v[72:75], v[160:163], v[196:199], v[72:75]
    ds_read_b128 v[192:195], v8 offset:24576
    s_waitcnt lgkmcnt(11)
    v_min3_u32 v12, v12, v13, v14
    v_mfma_f32_16x16x32_bf16 v[76:79], v[164:167], v[196:199], v[76:79]
    ds_write_b32 v10, v22
    s_waitcnt lgkmcnt(11)
    v_mfma_f32_16x16x32_bf16 v[80:83], v[160:163], v[200:203], v[80:83]
    ds_read_b128 v[196:199], v8 offset:26624
    v_min_u32 v12, v12, v15
    v_mfma_f32_16x16x32_bf16 v[84:87], v[164:167], v[200:203], v[84:87]
    buffer_load_dwordx4 v[156:159], v27, s[68:71], s19 offen offset:3072 sc1
    s_waitcnt lgkmcnt(10)
    v_mfma_f32_16x16x32_bf16 v[88:91], v[160:163], v[204:207], v[88:91]
    ds_read_b128 v[200:203], v8 offset:28672
    s_bfe_u32 s19, s100, 28 + (4 << 16)
    v_mfma_f32_16x16x32_bf16 v[92:95], v[164:167], v[204:207], v[92:95]
    s_lshl_b32 s19, s19, 13
    s_waitcnt vmcnt(12) lgkmcnt(9)
    v_mfma_f32_16x16x32_bf16 v[64:67], v[168:171], v[208:211], v[64:67]
    ds_read_b128 v[204:207], v8 offset:30720
    v_cmp_gt_u32 vcc, 22, v12
    v_mfma_f32_16x16x32_bf16 v[68:71], v[172:175], v[208:211], v[68:71]
    buffer_load_dwordx4 v[160:163], v26, s[68:71], s19 offen offset:0 sc1
    s_waitcnt lgkmcnt(8)
    v_mfma_f32_16x16x32_bf16 v[72:75], v[168:171], v[212:215], v[72:75]
    ds_read_b128 v[208:211], v9 offset:24576
    s_cbranch_vccnz G2_slow5
G2_back5:
    v_mfma_f32_16x16x32_bf16 v[76:79], v[172:175], v[212:215], v[76:79]
    ds_write_b64 v0, v[48:49] offset:49152
    s_waitcnt lgkmcnt(9)
    v_mfma_f32_16x16x32_bf16 v[80:83], v[168:171], v[216:219], v[80:83]
    ds_read_b128 v[212:215], v9 offset:26624
    v_mfma_f32_16x16x32_bf16 v[84:87], v[172:175], v[216:219], v[84:87]
    buffer_load_dwordx4 v[164:167], v26, s[68:71], s19 offen offset:1024 sc1
    s_waitcnt lgkmcnt(8)
    v_mfma_f32_16x16x32_bf16 v[88:91], v[168:171], v[220:223], v[88:91]
    ds_read_b128 v[216:219], v9 offset:28672
    v_mfma_f32_16x16x32_bf16 v[92:95], v[172:175], v[220:223], v[92:95]
    ds_write_b64 v0, v[50:51] offset:49160
    s_waitcnt vmcnt(12) lgkmcnt(9)
    v_mfma_f32_16x16x32_bf16 v[64:67], v[176:179], v[192:195], v[64:67]
    ds_read_b128 v[220:223], v9 offset:30720
    ds_write_b64 v0, v[52:53] offset:50176
    v_mfma_f32_16x16x32_bf16 v[68:71], v[180:183], v[192:195], v[68:71]
    buffer_load_dwordx4 v[168:171], v26, s[68:71], s19 offen offset:2048 sc1
    s_waitcnt lgkmcnt(9)
    v_mfma_f32_16x16x32_bf16 v[72:75], v[176:179], v[196:199], v[72:75]
    ds_read_b128 v[192:195], v6 offset:0
    v_mfma_f32_16x16x32_bf16 v[76:79], v[180:183], v[196:199], v[76:79]
    ds_write_b64 v0, v[54:55] offset:50184
    s_waitcnt lgkmcnt(10)
    v_mfma_f32_16x16x32_bf16 v[80:83], v[176:179], v[200:203], v[80:83]
    ds_read_b128 v[196:199], v6 offset:2048
    ds_read_b128 v[12:15], v11
    v_mfma_f32_16x16x32_bf16 v[84:87], v[180:183], v[200:203], v[84:87]
    buffer_load_dwordx4 v[172:175], v26, s[68:71], s19 offen offset:3072 sc1
    s_waitcnt lgkmcnt(11)
    v_mfma_f32_16x16x32_bf16 v[88:91], v[176:179], v[204:207], v[88:91]
    ds_read_b128 v[200:203], v6 offset:4096
    v_mfma_f32_16x16x32_bf16 v[92:95], v[180:183], v[204:207], v[92:95]
    ds_write_b64 v0, v[56:57] offset:51200
    s_waitcnt vmcnt(12) lgkmcnt(12)
    v_mfma_f32_16x16x32_bf16 v[64:67], v[184:187], v[208:211], v[64:67]
    ds_read_b128 v[204:207], v6 offset:6144
    ds_write_b64 v0, v[58:59] offset:51208
    v_mfma_f32_16x16x32_bf16 v[68:71], v[188:191], v[208:211], v[68:71]
    buffer_load_dwordx4 v[176:179], v27, s[68:71], s19 offen offset:0 sc1
    s_waitcnt lgkmcnt(12)
    v_mfma_f32_16x16x32_bf16 v[72:75], v[184:187], v[212:215], v[72:75]
    ds_read_b128 v[208:211], v7 offset:0
    v_mfma_f32_16x16x32_bf16 v[76:79], v[188:191], v[212:215], v[76:79]
    ds_write_b64 v0, v[60:61] offset:52224
    s_waitcnt lgkmcnt(13)
    v_mfma_f32_16x16x32_bf16 v[80:83], v[184:187], v[216:219], v[80:83]
    ds_read_b128 v[212:215], v7 offset:2048
    v_mfma_f32_16x16x32_bf16 v[84:87], v[188:191], v[216:219], v[84:87]
    buffer_load_dwordx4 v[180:183], v27, s[68:71], s19 offen offset:1024 sc1
    s_waitcnt lgkmcnt(12)
    v_mfma_f32_16x16x32_bf16 v[88:91], v[184:187], v[220:223], v[88:91]
    ds_read_b128 v[216:219], v7 offset:4096
    v_mfma_f32_16x16x32_bf16 v[92:95], v[188:191], v[220:223], v[92:95]
    ds_write_b64 v0, v[62:63] offset:52232
    s_waitcnt vmcnt(12) lgkmcnt(12)
    v_mfma_f32_16x16x32_bf16 v[64:67], v[128:131], v[192:195], v[64:67]
    ds_read_b128 v[220:223], v7 offset:6144
    v_mov_b32 v22, 24
    v_mfma_f32_16x16x32_bf16 v[68:71], v[132:135], v[192:195], v[68:71]
    buffer_load_dwordx4 v[184:187], v27, s[68:71], s19 offen offset:2048 sc1
    s_waitcnt lgkmcnt(11)
    v_mfma_f32_16x16x32_bf16 v[72:75], v[128:131], v[196:199], v[72:75]
    ds_read_b128 v[192:195], v6 offset:8192
    s_waitcnt lgkmcnt(11)
    v_min3_u32 v12, v12, v13, v14
    v_mfma_f32_16x16x32_bf16 v[76:79], v[132:135], v[196:199], v[76:79]
    ds_write_b32 v10, v22
    s_waitcnt lgkmcnt(11)
    v_mfma_f32_16x16x32_bf16 v[80:83], v[128:131], v[200:203], v[80:83]
    ds_read_b128 v[196:199], v6 offset:10240
    v_min_u32 v12, v12, v15
    v_mfma_f32_16x16x32_bf16 v[84:87], v[132:135], v[200:203], v[84:87]
    buffer_load_dwordx4 v[188:191], v27, s[68:71], s19 offen offset:3072 sc1
    s_waitcnt lgkmcnt(10)
    v_mfma_f32_16x16x32_bf16 v[88:91], v[128:131], v[204:207], v[88:91]
    ds_read_b128 v[200:203], v6 offset:12288
    s_bfe_u32 s19, s101, 0 + (4 << 16)
    v_mfma_f32_16x16x32_bf16 v[92:95], v[132:135], v[204:207], v[92:95]
    s_lshl_b32 s19, s19, 13
    s_waitcnt vmcnt(12) lgkmcnt(9)
    v_mfma_f32_16x16x32_bf16 v[64:67], v[136:139], v[208:211], v[64:67]
    ds_read_b128 v[204:207], v6 offset:14336
    v_cmp_gt_u32 vcc, 23, v12
    v_mfma_f32_16x16x32_bf16 v[68:71], v[140:143], v[208:211], v[68:71]
    buffer_load_dwordx4 v[128:131], v26, s[68:71], s19 offen offset:0 sc1
    s_waitcnt lgkmcnt(8)
    v_mfma_f32_16x16x32_bf16 v[72:75], v[136:139], v[212:215], v[72:75]
    ds_read_b128 v[208:211], v7 offset:8192
    s_cbranch_vccnz G2_slow6
G2_back6:
    v_mfma_f32_16x16x32_bf16 v[76:79], v[140:143], v[212:215], v[76:79]
    ds_write_b64 v1, v[32:33] offset:0
    s_waitcnt lgkmcnt(9)
    v_mfma_f32_16x16x32_bf16 v[80:83], v[136:139], v[216:219], v[80:83]
    ds_read_b128 v[212:215], v7 offset:10240
    v_mfma_f32_16x16x32_bf16 v[84:87], v[140:143], v[216:219], v[84:87]
    buffer_load_dwordx4 v[132:135], v26, s[68:71], s19 offen offset:1024 sc1
    s_waitcnt lgkmcnt(8)
    v_mfma_f32_16x16x32_bf16 v[88:91], v[136:139], v[220:223], v[88:91]
    ds_read_b128 v[216:219], v7 offset:12288
    v_mfma_f32_16x16x32_bf16 v[92:95], v[140:143], v[220:223], v[92:95]
    ds_write_b64 v1, v[34:35] offset:8
    s_waitcnt vmcnt(12) lgkmcnt(9)
    v_mfma_f32_16x16x32_bf16 v[64:67], v[144:147], v[192:195], v[64:67]
    ds_read_b128 v[220:223], v7 offset:14336
    ds_write_b64 v1, v[36:37] offset:1024
    v_mfma_f32_16x16x32_bf16 v[68:71], v[148:151], v[192:195], v[68:71]
    buffer_load_dwordx4 v[136:139], v26, s[68:71], s19 offen offset:2048 sc1
    s_waitcnt lgkmcnt(9)
    v_mfma_f32_16x16x32_bf16 v[72:75], v[144:147], v[196:199], v[72:75]
    ds_read_b128 v[192:195], v6 offset:16384
    v_mfma_f32_16x16x32_bf16 v[76:79], v[148:151], v[196:199], v[76:79]
    ds_write_b64 v1, v[38:39] offset:1032
    s_waitcnt lgkmcnt(10)
    v_mfma_f32_16x16x32_bf16 v[80:83], v[144:147], v[200:203], v[80:83]
    ds_read_b128 v[196:199], v6 offset:18432
    ds_read_b128 v[12:15], v11
    v_mfma_f32_16x16x32_bf16 v[84:87], v[148:151], v[200:203], v[84:87]
    buffer_load_dwordx4 v[140:143], v26, s[68:71], s19 offen offset:3072 sc1
    s_waitcnt lgkmcnt(11)
    v_mfma_f32_16x16x32_bf16 v[88:91], v[144:147], v[204:207], v[88:91]
    ds_read_b128 v[200:203], v6 offset:20480
    v_mfma_f32_16x16x32_bf16 v[92:95], v[148:151], v[204:207], v[92:95]
    ds_write_b64 v1, v[40:41] offset:2048
    s_waitcnt vmcnt(12) lgkmcnt(12)
    v_mfma_f32_16x16x32_bf16 v[64:67], v[152:155], v[208:211], v[64:67]
    ds_read_b128 v[204:207], v6 offset:22528
    ds_write_b64 v1, v[42:43] offset:2056
    v_mfma_f32_16x16x32_bf16 v[68:71], v[156:159], v[208:211], v[68:71]
    buffer_load_dwordx4 v[144:147], v27, s[68:71], s19 offen offset:0 sc1
    s_waitcnt lgkmcnt(12)
    v_mfma_f32_16x16x32_bf16 v[72:75], v[152:155], v[212:215], v[72:75]
    ds_read_b128 v[208:211], v7 offset:16384
    v_mfma_f32_16x16x32_bf16 v[76:79], v[156:159], v[212:215], v[76:79]
    ds_write_b64 v1, v[44:45] offset:3072
    s_waitcnt lgkmcnt(13)
    v_mfma_f32_16x16x32_bf16 v[80:83], v[152:155], v[216:219], v[80:83]
    ds_read_b128 v[212:215], v7 offset:18432
    v_mfma_f32_16x16x32_bf16 v[84:87], v[156:159], v[216:219], v[84:87]
    buffer_load_dwordx4 v[148:151], v27, s[68:71], s19 offen offset:1024 sc1
    s_waitcnt lgkmcnt(12)
    v_mfma_f32_16x16x32_bf16 v[88:91], v[152:155], v[220:223], v[88:91]
    ds_read_b128 v[216:219], v7 offset:20480
    v_mfma_f32_16x16x32_bf16 v[92:95], v[156:159], v[220:223], v[92:95]
    ds_write_b64 v1, v[46:47] offset:3080
    s_waitcnt vmcnt(12) lgkmcnt(12)
    v_mfma_f32_16x16x32_bf16 v[64:67], v[160:163], v[192:195], v[64:67]
    ds_read_b128 v[220:223], v7 offset:22528
    v_mov_b32 v22, 25
    v_mfma_f32_16x16x32_bf16 v[68:71], v[164:167], v[192:195], v[68:71]
    buffer_load_dwordx4 v[152:155], v27, s[68:71], s19 offen offset:2048 sc1
    s_waitcnt lgkmcnt(11)
    v_mfma_f32_16x16x32_bf16 v[72:75], v[160:163], v[196:199], v[72:75]
    ds_read_b128 v[192:195], v6 offset:24576
    s_waitcnt lgkmcnt(11)
    v_min3_u32 v12, v12, v13, v14
    v_mfma_f32_16x16x32_bf16 v[76:79], v[164:167], v[196:199], v[76:79]
    ds_write_b32 v10, v22
    s_waitcnt lgkmcnt(11)
    v_mfma_f32_16x16x32_bf16 v[80:83], v[160:163], v[200:203], v[80:83]
    ds_read_b128 v[196:199], v6 offset:26624
    v_min_u32 v12, v12, v15
    v_mfma_f32_16x16x32_bf16 v[84:87], v[164:167], v[200:203], v[84:87]
    buffer_load_dwordx4 v[156:159], v27, s[68:71], s19 offen offset:3072 sc1
    s_waitcnt lgkmcnt(10)
    v_mfma_f32_16x16x32_bf16 v[88:91], v[160:163], v[204:207], v[88:91]
    ds_read_b128 v[200:203], v6 offset:28672
    s_bfe_u32 s19, s101, 4 + (4 << 16)
    v_mfma_f32_16x16x32_bf16 v[92:95], v[164:167], v[204:207], v[92:95]
    s_lshl_b32 s19, s19, 13
    s_waitcnt vmcnt(12) lgkmcnt(9)
    v_mfma_f32_16x16x32_bf16 v[64:67], v[168:171], v[208:211], v[64:67]
    ds_read_b128 v[204:207], v6 offset:30720
    v_cmp_gt_u32 vcc, 24, v12
    v_mfma_f32_16x16x32_bf16 v[68:71], v[172:175], v[208:211], v[68:71]
    buffer_load_dwordx4 v[160:163], v26, s[68:71], s19 offen offset:0 sc1
    s_waitcnt lgkmcnt(8)
    v_mfma_f32_16x16x32_bf16 v[72:75], v[168:171], v[212:215], v[72:75]
    ds_read_b128 v[208:211], v7 offset:24576
    s_cbranch_vccnz G2_slow7
G2_back7:
    v_mfma_f32_16x16x32_bf16 v[76:79], v[172:175], v[212:215], v[76:79]
    ds_write_b64 v1, v[96:97] offset:16384
    s_waitcnt lgkmcnt(9)
    v_mfma_f32_16x16x32_bf16 v[80:83], v[168:171], v[216:219], v[80:83]
    ds_read_b128 v[212:215], v7 offset:26624
    v_mfma_f32_16x16x32_bf16 v[84:87], v[172:175], v[216:219], v[84:87]
    buffer_load_dwordx4 v[164:167], v26, s[68:71], s19 offen offset:1024 sc1
    s_waitcnt lgkmcnt(8)
    v_mfma_f32_16x16x32_bf16 v[88:91], v[168:171], v[220:223], v[88:91]
    ds_read_b128 v[216:219], v7 offset:28672
    v_mfma_f32_16x16x32_bf16 v[92:95], v[172:175], v[220:223], v[92:95]
    ds_write_b64 v1, v[98:99] offset:16392
    s_waitcnt vmcnt(12) lgkmcnt(9)
    v_mfma_f32_16x16x32_bf16 v[64:67], v[176:179], v[192:195], v[64:67]
    ds_read_b128 v[220:223], v7 offset:30720
    ds_write_b64 v1, v[100:101] offset:17408
    v_mfma_f32_16x16x32_bf16 v[68:71], v[180:183], v[192:195], v[68:71]
    buffer_load_dwordx4 v[168:171], v26, s[68:71], s19 offen offset:2048 sc1
    s_waitcnt lgkmcnt(9)
    v_mfma_f32_16x16x32_bf16 v[72:75], v[176:179], v[196:199], v[72:75]
    ds_read_b128 v[192:195], v6 offset:32768
    v_mfma_f32_16x16x32_bf16 v[76:79], v[180:183], v[196:199], v[76:79]
    ds_write_b64 v1, v[102:103] offset:17416
    s_waitcnt lgkmcnt(10)
    v_mfma_f32_16x16x32_bf16 v[80:83], v[176:179], v[200:203], v[80:83]
    ds_read_b128 v[196:199], v6 offset:34816
    ds_read_b128 v[12:15], v11
    v_mfma_f32_16x16x32_bf16 v[84:87], v[180:183], v[200:203], v[84:87]
    buffer_load_dwordx4 v[172:175], v26, s[68:71], s19 offen offset:3072 sc1
    s_waitcnt lgkmcnt(11)
    v_mfma_f32_16x16x32_bf16 v[88:91], v[176:179], v[204:207], v[88:91]
    ds_read_b128 v[200:203], v6 offset:36864
    v_mfma_f32_16x16x32_bf16 v[92:95], v[180:183], v[204:207], v[92:95]
    ds_write_b64 v1, v[104:105] offset:18432
    s_waitcnt vmcnt(12) lgkmcnt(12)
    v_mfma_f32_16x16x32_bf16 v[64:67], v[184:187], v[208:211], v[64:67]
    ds_read_b128 v[204:207], v6 offset:38912
    ds_write_b64 v1, v[106:107] offset:18440
    v_mfma_f32_16x16x32_bf16 v[68:71], v[188:191], v[208:211], v[68:71]
    buffer_load_dwordx4 v[176:179], v27, s[68:71], s19 offen offset:0 sc1
    s_waitcnt lgkmcnt(12)
    v_mfma_f32_16x16x32_bf16 v[72:75], v[184:187], v[212:215], v[72:75]
    ds_read_b128 v[208:211], v7 offset:32768
    v_mfma_f32_16x16x32_bf16 v[76:79], v[188:191], v[212:215], v[76:79]
    ds_write_b64 v1, v[108:109] offset:19456
    s_waitcnt lgkmcnt(13)
    v_mfma_f32_16x16x32_bf16 v[80:83], v[184:187], v[216:219], v[80:83]
    ds_read_b128 v[212:215], v7 offset:34816
    v_mfma_f32_16x16x32_bf16 v[84:87], v[188:191], v[216:219], v[84:87]
    buffer_load_dwordx4 v[180:183], v27, s[68:71], s19 offen offset:1024 sc1
    s_waitcnt lgkmcnt(12)
    v_mfma_f32_16x16x32_bf16 v[88:91], v[184:187], v[220:223], v[88:91]
    ds_read_b128 v[216:219], v7 offset:36864
    v_mfma_f32_16x16x32_bf16 v[92:95], v[188:191], v[220:223], v[92:95]
    ds_write_b64 v1, v[110:111] offset:19464
    s_waitcnt vmcnt(12) lgkmcnt(12)
    v_mfma_f32_16x16x32_bf16 v[64:67], v[128:131], v[192:195], v[64:67]
    ds_read_b128 v[220:223], v7 offset:38912
    v_mov_b32 v22, 26
    v_mfma_f32_16x16x32_bf16 v[68:71], v[132:135], v[192:195], v[68:71]
    buffer_load_dwordx4 v[184:187], v27, s[68:71], s19 offen offset:2048 sc1
    s_waitcnt lgkmcnt(11)
    v_mfma_f32_16x16x32_bf16 v[72:75], v[128:131], v[196:199], v[72:75]
    ds_read_b128 v[192:195], v6 offset:40960
    s_waitcnt lgkmcnt(11)
    v_min3_u32 v12, v12, v13, v14
    v_mfma_f32_16x16x32_bf16 v[76:79], v[132:135], v[196:199], v[76:79]
    ds_write_b32 v10, v22
    s_waitcnt lgkmcnt(11)
    v_mfma_f32_16x16x32_bf16 v[80:83], v[128:131], v[200:203], v[80:83]
    ds_read_b128 v[196:199], v6 offset:43008
    v_min_u32 v12, v12, v15
    v_mfma_f32_16x16x32_bf16 v[84:87], v[132:135], v[200:203], v[84:87]
    buffer_load_dwordx4 v[188:191], v27, s[68:71], s19 offen offset:3072 sc1
    s_waitcnt lgkmcnt(10)
    v_mfma_f32_16x16x32_bf16 v[88:91], v[128:131], v[204:207], v[88:91]
    ds_read_b128 v[200:203], v6 offset:45056
    s_bfe_u32 s19, s101, 8 + (4 << 16)
    v_mfma_f32_16x16x32_bf16 v[92:95], v[132:135], v[204:207], v[92:95]
    s_lshl_b32 s19, s19, 13
    s_waitcnt vmcnt(12) lgkmcnt(9)
    v_mfma_f32_16x16x32_bf16 v[64:67], v[136:139], v[208:211], v[64:67]
    ds_read_b128 v[204:207], v6 offset:47104
    v_cmp_gt_u32 vcc, 25, v12
    v_mfma_f32_16x16x32_bf16 v[68:71], v[140:143], v[208:211], v[68:71]
    buffer_load_dwordx4 v[128:131], v26, s[68:71], s19 offen offset:0 sc1
    s_waitcnt lgkmcnt(8)
    v_mfma_f32_16x16x32_bf16 v[72:75], v[136:139], v[212:215], v[72:75]
    ds_read_b128 v[208:211], v7 offset:40960
    s_cbranch_vccnz G2_slow8
G2_back8:
    v_mfma_f32_16x16x32_bf16 v[76:79], v[140:143], v[212:215], v[76:79]
    ds_write_b64 v0, v[112:113] offset:0
    s_waitcnt lgkmcnt(9)
    v_mfma_f32_16x16x32_bf16 v[80:83], v[136:139], v[216:219], v[80:83]
    ds_read_b128 v[212:215], v7 offset:43008
    v_mfma_f32_16x16x32_bf16 v[84:87], v[140:143], v[216:219], v[84:87]
    buffer_load_dwordx4 v[132:135], v26, s[68:71], s19 offen offset:1024 sc1
    s_waitcnt lgkmcnt(8)
    v_mfma_f32_16x16x32_bf16 v[88:91], v[136:139], v[220:223], v[88:91]
    ds_read_b128 v[216:219], v7 offset:45056
    v_mfma_f32_16x16x32_bf16 v[92:95], v[140:143], v[220:223], v[92:95]
    ds_write_b64 v0, v[114:115] offset:8
    s_waitcnt vmcnt(12) lgkmcnt(9)
    v_mfma_f32_16x16x32_bf16 v[64:67], v[144:147], v[192:195], v[64:67]
    ds_read_b128 v[220:223], v7 offset:47104
    ds_write_b64 v0, v[116:117] offset:1024
    v_mfma_f32_16x16x32_bf16 v[68:71], v[148:151], v[192:195], v[68:71]
    buffer_load_dwordx4 v[136:139], v26, s[68:71], s19 offen offset:2048 sc1
    s_waitcnt lgkmcnt(9)
    v_mfma_f32_16x16x32_bf16 v[72:75], v[144:147], v[196:199], v[72:75]
    ds_read_b128 v[192:195], v6 offset:49152
    v_mfma_f32_16x16x32_bf16 v[76:79], v[148:151], v[196:199], v[76:79]
    ds_write_b64 v0, v[118:119] offset:1032
    s_waitcnt lgkmcnt(10)
    v_mfma_f32_16x16x32_bf16 v[80:83], v[144:147], v[200:203], v[80:83]
    ds_read_b128 v[196:199], v6 offset:51200
    v_mfma_f32_16x16x32_bf16 v[84:87], v[148:151], v[200:203], v[84:87]
    buffer_load_dwordx4 v[140:143], v26, s[68:71], s19 offen offset:3072 sc1
    s_waitcnt lgkmcnt(10)
    v_mfma_f32_16x16x32_bf16 v[88:91], v[144:147], v[204:207], v[88:91]
    ds_read_b128 v[200:203], v6 offset:53248
    v_mfma_f32_16x16x32_bf16 v[92:95], v[148:151], v[204:207], v[92:95]
    ds_write_b64 v0, v[120:121] offset:2048
    s_waitcnt vmcnt(12) lgkmcnt(11)
    v_mfma_f32_16x16x32_bf16 v[64:67], v[152:155], v[208:211], v[64:67]
    ds_read_b128 v[204:207], v6 offset:55296
    ds_write_b64 v0, v[122:123] offset:2056
    v_mfma_f32_16x16x32_bf16 v[68:71], v[156:159], v[208:211], v[68:71]
    buffer_load_dwordx4 v[144:147], v27, s[68:71], s19 offen offset:0 sc1
    s_waitcnt lgkmcnt(11)
    v_mfma_f32_16x16x32_bf16 v[72:75], v[152:155], v[212:215], v[72:75]
    ds_read_b128 v[208:211], v7 offset:49152
    v_mfma_f32_16x16x32_bf16 v[76:79], v[156:159], v[212:215], v[76:79]
    ds_write_b64 v0, v[124:125] offset:3072
    s_waitcnt lgkmcnt(12)
    v_mfma_f32_16x16x32_bf16 v[80:83], v[152:155], v[216:219], v[80:83]
    ds_read_b128 v[212:215], v7 offset:51200
    v_mfma_f32_16x16x32_bf16 v[84:87], v[156:159], v[216:219], v[84:87]
    buffer_load_dwordx4 v[148:151], v27, s[68:71], s19 offen offset:1024 sc1
    s_waitcnt lgkmcnt(11)
    v_mfma_f32_16x16x32_bf16 v[88:91], v[152:155], v[220:223], v[88:91]
    ds_read_b128 v[216:219], v7 offset:53248
    v_mfma_f32_16x16x32_bf16 v[92:95], v[156:159], v[220:223], v[92:95]
    ds_write_b64 v0, v[126:127] offset:3080
    s_waitcnt vmcnt(12) lgkmcnt(11)
    v_mfma_f32_16x16x32_bf16 v[64:67], v[160:163], v[192:195], v[64:67]
    ds_read_b128 v[220:223], v7 offset:55296
    v_mov_b32 v22, 27
    v_mfma_f32_16x16x32_bf16 v[68:71], v[164:167], v[192:195], v[68:71]
    buffer_load_dwordx4 v[152:155], v27, s[68:71], s19 offen offset:2048 sc1
    s_waitcnt lgkmcnt(10)
    v_mfma_f32_16x16x32_bf16 v[72:75], v[160:163], v[196:199], v[72:75]
    ds_read_b128 v[192:195], v6 offset:57344
    v_mfma_f32_16x16x32_bf16 v[76:79], v[164:167], v[196:199], v[76:79]
    ds_write_b32 v10, v22
    s_waitcnt lgkmcnt(11)
    v_mfma_f32_16x16x32_bf16 v[80:83], v[160:163], v[200:203], v[80:83]
    ds_read_b128 v[196:199], v6 offset:59392
    v_mfma_f32_16x16x32_bf16 v[84:87], v[164:167], v[200:203], v[84:87]
    buffer_load_dwordx4 v[156:159], v27, s[68:71], s19 offen offset:3072 sc1
    s_waitcnt lgkmcnt(10)
    v_mfma_f32_16x16x32_bf16 v[88:91], v[160:163], v[204:207], v[88:91]
    ds_read_b128 v[200:203], v6 offset:61440
    s_bfe_u32 s19, s101, 12 + (4 << 16)
    v_mfma_f32_16x16x32_bf16 v[92:95], v[164:167], v[204:207], v[92:95]
    s_lshl_b32 s19, s19, 13
    s_waitcnt vmcnt(12) lgkmcnt(9)
    v_mfma_f32_16x16x32_bf16 v[64:67], v[168:171], v[208:211], v[64:67]
    ds_read_b128 v[204:207], v6 offset:63488
    v_mfma_f32_16x16x32_bf16 v[68:71], v[172:175], v[208:211], v[68:71]
    buffer_load_dwordx4 v[160:163], v26, s[68:71], s19 offen offset:0 sc1
    s_waitcnt lgkmcnt(8)
    v_mfma_f32_16x16x32_bf16 v[72:75], v[168:171], v[212:215], v[72:75]
    ds_read_b128 v[208:211], v7 offset:57344
    v_mfma_f32_16x16x32_bf16 v[76:79], v[172:175], v[212:215], v[76:79]
    s_waitcnt lgkmcnt(8)
    v_mfma_f32_16x16x32_bf16 v[80:83], v[168:171], v[216:219], v[80:83]
    ds_read_b128 v[212:215], v7 offset:59392
    v_mfma_f32_16x16x32_bf16 v[84:87], v[172:175], v[216:219], v[84:87]
    buffer_load_dwordx4 v[164:167], v26, s[68:71], s19 offen offset:1024 sc1
    s_waitcnt lgkmcnt(7)
    v_mfma_f32_16x16x32_bf16 v[88:91], v[168:171], v[220:223], v[88:91]
    ds_read_b128 v[216:219], v7 offset:61440
    v_mfma_f32_16x16x32_bf16 v[92:95], v[172:175], v[220:223], v[92:95]
    s_waitcnt vmcnt(12) lgkmcnt(7)
    v_mfma_f32_16x16x32_bf16 v[64:67], v[176:179], v[192:195], v[64:67]
    ds_read_b128 v[220:223], v7 offset:63488
    v_mfma_f32_16x16x32_bf16 v[68:71], v[180:183], v[192:195], v[68:71]
    buffer_load_dwordx4 v[168:171], v26, s[68:71], s19 offen offset:2048 sc1
    s_waitcnt lgkmcnt(6)
    v_mfma_f32_16x16x32_bf16 v[72:75], v[176:179], v[196:199], v[72:75]
    ds_read_b128 v[192:195], v8 offset:0
    v_mfma_f32_16x16x32_bf16 v[76:79], v[180:183], v[196:199], v[76:79]
    s_waitcnt lgkmcnt(6)
    v_mfma_f32_16x16x32_bf16 v[80:83], v[176:179], v[200:203], v[80:83]
    ds_read_b128 v[196:199], v8 offset:2048
    ds_read_b128 v[12:15], v11
    v_mfma_f32_16x16x32_bf16 v[84:87], v[180:183], v[200:203], v[84:87]
    buffer_load_dwordx4 v[172:175], v26, s[68:71], s19 offen offset:3072 sc1
    s_waitcnt lgkmcnt(7)
    v_mfma_f32_16x16x32_bf16 v[88:91], v[176:179], v[204:207], v[88:91]
    ds_read_b128 v[200:203], v8 offset:4096
    v_mfma_f32_16x16x32_bf16 v[92:95], v[180:183], v[204:207], v[92:95]
    s_waitcnt vmcnt(12) lgkmcnt(7)
    v_mfma_f32_16x16x32_bf16 v[64:67], v[184:187], v[208:211], v[64:67]
    ds_read_b128 v[204:207], v8 offset:6144
    v_mfma_f32_16x16x32_bf16 v[68:71], v[188:191], v[208:211], v[68:71]
    buffer_load_dwordx4 v[176:179], v27, s[68:71], s19 offen offset:0 sc1
    s_waitcnt lgkmcnt(7)
    v_mfma_f32_16x16x32_bf16 v[72:75], v[184:187], v[212:215], v[72:75]
    ds_read_b128 v[208:211], v9 offset:0
    v_mfma_f32_16x16x32_bf16 v[76:79], v[188:191], v[212:215], v[76:79]
    s_waitcnt lgkmcnt(7)
    v_mfma_f32_16x16x32_bf16 v[80:83], v[184:187], v[216:219], v[80:83]
    ds_read_b128 v[212:215], v9 offset:2048
    v_mfma_f32_16x16x32_bf16 v[84:87], v[188:191], v[216:219], v[84:87]
    buffer_load_dwordx4 v[180:183], v27, s[68:71], s19 offen offset:1024 sc1
    s_waitcnt lgkmcnt(7)
    v_mfma_f32_16x16x32_bf16 v[88:91], v[184:187], v[220:223], v[88:91]
    ds_read_b128 v[216:219], v9 offset:4096
    v_mfma_f32_16x16x32_bf16 v[92:95], v[188:191], v[220:223], v[92:95]
    s_waitcnt vmcnt(12) lgkmcnt(7)
    v_mfma_f32_16x16x32_bf16 v[64:67], v[128:131], v[192:195], v[64:67]
    ds_read_b128 v[220:223], v9 offset:6144
    v_mov_b32 v22, 28
    v_mfma_f32_16x16x32_bf16 v[68:71], v[132:135], v[192:195], v[68:71]
    buffer_load_dwordx4 v[184:187], v27, s[68:71], s19 offen offset:2048 sc1
    s_waitcnt lgkmcnt(7)
    v_mfma_f32_16x16x32_bf16 v[72:75], v[128:131], v[196:199], v[72:75]
    ds_read_b128 v[192:195], v8 offset:8192
    s_waitcnt lgkmcnt(7)
    v_min3_u32 v12, v12, v13, v14
    v_mfma_f32_16x16x32_bf16 v[76:79], v[132:135], v[196:199], v[76:79]
    ds_write_b32 v10, v22
    s_waitcnt lgkmcnt(7)
    v_mfma_f32_16x16x32_bf16 v[80:83], v[128:131], v[200:203], v[80:83]
    ds_read_b128 v[196:199], v8 offset:10240
    v_min_u32 v12, v12, v15
    v_mfma_f32_16x16x32_bf16 v[84:87], v[132:135], v[200:203], v[84:87]
    buffer_load_dwordx4 v[188:191], v27, s[68:71], s19 offen offset:3072 sc1
    s_waitcnt lgkmcnt(7)
    v_mfma_f32_16x16x32_bf16 v[88:91], v[128:131], v[204:207], v[88:91]
    ds_read_b128 v[200:203], v8 offset:12288
    s_bfe_u32 s19, s101, 16 + (4 << 16)
    v_mfma_f32_16x16x32_bf16 v[92:95], v[132:135], v[204:207], v[92:95]
    s_lshl_b32 s19, s19, 13
    s_waitcnt vmcnt(12) lgkmcnt(7)
    v_mfma_f32_16x16x32_bf16 v[64:67], v[136:139], v[208:211], v[64:67]
    ds_read_b128 v[204:207], v8 offset:14336
    v_cmp_gt_u32 vcc, 27, v12
    v_mfma_f32_16x16x32_bf16 v[68:71], v[140:143], v[208:211], v[68:71]
    buffer_load_dwordx4 v[128:131], v26, s[68:71], s19 offen offset:0 sc1
    s_waitcnt lgkmcnt(7)
    v_mfma_f32_16x16x32_bf16 v[72:75], v[136:139], v[212:215], v[72:75]
    ds_read_b128 v[208:211], v9 offset:8192
    s_cbranch_vccnz G2_slow10
G2_back10:
    v_mfma_f32_16x16x32_bf16 v[76:79], v[140:143], v[212:215], v[76:79]
    s_waitcnt lgkmcnt(7)
    v_mfma_f32_16x16x32_bf16 v[80:83], v[136:139], v[216:219], v[80:83]
    ds_read_b128 v[212:215], v9 offset:10240
    v_mfma_f32_16x16x32_bf16 v[84:87], v[140:143], v[216:219], v[84:87]
    buffer_load_dwordx4 v[132:135], v26, s[68:71], s19 offen offset:1024 sc1
    s_waitcnt lgkmcnt(7)
    v_mfma_f32_16x16x32_bf16 v[88:91], v[136:139], v[220:223], v[88:91]
    ds_read_b128 v[216:219], v9 offset:12288
    v_mfma_f32_16x16x32_bf16 v[92:95], v[140:143], v[220:223], v[92:95]
    s_waitcnt vmcnt(12) lgkmcnt(7)
    v_mfma_f32_16x16x32_bf16 v[64:67], v[144:147], v[192:195], v[64:67]
    ds_read_b128 v[220:223], v9 offset:14336
    v_mfma_f32_16x16x32_bf16 v[68:71], v[148:151], v[192:195], v[68:71]
    buffer_load_dwordx4 v[136:139], v26, s[68:71], s19 offen offset:2048 sc1
    s_waitcnt lgkmcnt(6)
    v_mfma_f32_16x16x32_bf16 v[72:75], v[144:147], v[196:199], v[72:75]
    ds_read_b128 v[192:195], v8 offset:16384
    v_mfma_f32_16x16x32_bf16 v[76:79], v[148:151], v[196:199], v[76:79]
    s_waitcnt lgkmcnt(6)
    v_mfma_f32_16x16x32_bf16 v[80:83], v[144:147], v[200:203], v[80:83]
    ds_read_b128 v[196:199], v8 offset:18432
    v_mfma_f32_16x16x32_bf16 v[84:87], v[148:151], v[200:203], v[84:87]
    buffer_load_dwordx4 v[140:143], v26, s[68:71], s19 offen offset:3072 sc1
    s_waitcnt lgkmcnt(6)
    v_mfma_f32_16x16x32_bf16 v[88:91], v[144:147], v[204:207], v[88:91]
    ds_read_b128 v[200:203], v8 offset:20480
    v_mfma_f32_16x16x32_bf16 v[92:95], v[148:151], v[204:207], v[92:95]
    s_waitcnt vmcnt(12) lgkmcnt(6)
    v_mfma_f32_16x16x32_bf16 v[64:67], v[152:155], v[208:211], v[64:67]
    ds_read_b128 v[204:207], v8 offset:22528
    v_mfma_f32_16x16x32_bf16 v[68:71], v[156:159], v[208:211], v[68:71]
    buffer_load_dwordx4 v[144:147], v27, s[68:71], s19 offen offset:0 sc1
    s_waitcnt lgkmcnt(6)
    v_mfma_f32_16x16x32_bf16 v[72:75], v[152:155], v[212:215], v[72:75]
    ds_read_b128 v[208:211], v9 offset:16384
    v_mfma_f32_16x16x32_bf16 v[76:79], v[156:159], v[212:215], v[76:79]
    s_waitcnt lgkmcnt(6)
    v_mfma_f32_16x16x32_bf16 v[80:83], v[152:155], v[216:219], v[80:83]
    ds_read_b128 v[212:215], v9 offset:18432
    v_mfma_f32_16x16x32_bf16 v[84:87], v[156:159], v[216:219], v[84:87]
    buffer_load_dwordx4 v[148:151], v27, s[68:71], s19 offen offset:1024 sc1
    s_waitcnt lgkmcnt(6)
    v_mfma_f32_16x16x32_bf16 v[88:91], v[152:155], v[220:223], v[88:91]
    ds_read_b128 v[216:219], v9 offset:20480
    v_mfma_f32_16x16x32_bf16 v[92:95], v[156:159], v[220:223], v[92:95]
    s_waitcnt vmcnt(12) lgkmcnt(6)
    v_mfma_f32_16x16x32_bf16 v[64:67], v[160:163], v[192:195], v[64:67]
    ds_read_b128 v[220:223], v9 offset:22528
    v_mov_b32 v22, 29
    v_mfma_f32_16x16x32_bf16 v[68:71], v[164:167], v[192:195], v[68:71]
    buffer_load_dwordx4 v[152:155], v27, s[68:71], s19 offen offset:2048 sc1
    s_waitcnt lgkmcnt(6)
    v_mfma_f32_16x16x32_bf16 v[72:75], v[160:163], v[196:199], v[72:75]
    ds_read_b128 v[192:195], v8 offset:24576
    v_mfma_f32_16x16x32_bf16 v[76:79], v[164:167], v[196:199], v[76:79]
    ds_write_b32 v10, v22
    s_waitcnt lgkmcnt(7)
    v_mfma_f32_16x16x32_bf16 v[80:83], v[160:163], v[200:203], v[80:83]
    ds_read_b128 v[196:199], v8 offset:26624
    v_mfma_f32_16x16x32_bf16 v[84:87], v[164:167], v[200:203], v[84:87]
    buffer_load_dwordx4 v[156:159], v27, s[68:71], s19 offen offset:3072 sc1
    s_waitcnt lgkmcnt(7)
    v_mfma_f32_16x16x32_bf16 v[88:91], v[160:163], v[204:207], v[88:91]
    ds_read_b128 v[200:203], v8 offset:28672
    s_bfe_u32 s19, s101, 20 + (4 << 16)
    v_mfma_f32_16x16x32_bf16 v[92:95], v[164:167], v[204:207], v[92:95]
    s_lshl_b32 s19, s19, 13
    s_waitcnt vmcnt(12) lgkmcnt(7)
    v_mfma_f32_16x16x32_bf16 v[64:67], v[168:171], v[208:211], v[64:67]
    ds_read_b128 v[204:207], v8 offset:30720
    v_mfma_f32_16x16x32_bf16 v[68:71], v[172:175], v[208:211], v[68:71]
    buffer_load_dwordx4 v[160:163], v26, s[68:71], s19 offen offset:0 sc1
    s_waitcnt lgkmcnt(7)
    v_mfma_f32_16x16x32_bf16 v[72:75], v[168:171], v[212:215], v[72:75]
    ds_read_b128 v[208:211], v9 offset:24576
    v_mfma_f32_16x16x32_bf16 v[76:79], v[172:175], v[212:215], v[76:79]
    s_waitcnt lgkmcnt(7)
    v_mfma_f32_16x16x32_bf16 v[80:83], v[168:171], v[216:219], v[80:83]
    ds_read_b128 v[212:215], v9 offset:26624
    v_mfma_f32_16x16x32_bf16 v[84:87], v[172:175], v[216:219], v[84:87]
    buffer_load_dwordx4 v[164:167], v26, s[68:71], s19 offen offset:1024 sc1
    s_waitcnt lgkmcnt(7)
    v_mfma_f32_16x16x32_bf16 v[88:91], v[168:171], v[220:223], v[88:91]
    ds_read_b128 v[216:219], v9 offset:28672
    v_mfma_f32_16x16x32_bf16 v[92:95], v[172:175], v[220:223], v[92:95]
    s_waitcnt vmcnt(12) lgkmcnt(7)
    v_mfma_f32_16x16x32_bf16 v[64:67], v[176:179], v[192:195], v[64:67]
    ds_read_b128 v[220:223], v9 offset:30720
    v_mfma_f32_16x16x32_bf16 v[68:71], v[180:183], v[192:195], v[68:71]
    buffer_load_dwordx4 v[168:171], v26, s[68:71], s19 offen offset:2048 sc1
    s_waitcnt lgkmcnt(6)
    v_mfma_f32_16x16x32_bf16 v[72:75], v[176:179], v[196:199], v[72:75]
    ds_read_b128 v[192:195], v6 offset:0
    v_mfma_f32_16x16x32_bf16 v[76:79], v[180:183], v[196:199], v[76:79]
    s_waitcnt lgkmcnt(6)
    v_mfma_f32_16x16x32_bf16 v[80:83], v[176:179], v[200:203], v[80:83]
    ds_read_b128 v[196:199], v6 offset:2048
    v_mfma_f32_16x16x32_bf16 v[84:87], v[180:183], v[200:203], v[84:87]
    buffer_load_dwordx4 v[172:175], v26, s[68:71], s19 offen offset:3072 sc1
    s_waitcnt lgkmcnt(6)
    v_mfma_f32_16x16x32_bf16 v[88:91], v[176:179], v[204:207], v[88:91]
    ds_read_b128 v[200:203], v6 offset:4096
    v_mfma_f32_16x16x32_bf16 v[92:95], v[180:183], v[204:207], v[92:95]
    s_waitcnt vmcnt(12) lgkmcnt(6)
    v_mfma_f32_16x16x32_bf16 v[64:67], v[184:187], v[208:211], v[64:67]
    ds_read_b128 v[204:207], v6 offset:6144
    v_mfma_f32_16x16x32_bf16 v[68:71], v[188:191], v[208:211], v[68:71]
    buffer_load_dwordx4 v[176:179], v27, s[68:71], s19 offen offset:0 sc1
    s_waitcnt lgkmcnt(6)
    v_mfma_f32_16x16x32_bf16 v[72:75], v[184:187], v[212:215], v[72:75]
    ds_read_b128 v[208:211], v7 offset:0
    ds_read_b32 v18, v11 offset:68
    v_mfma_f32_16x16x32_bf16 v[76:79], v[188:191], v[212:215], v[76:79]
    s_waitcnt lgkmcnt(7)
    v_mfma_f32_16x16x32_bf16 v[80:83], v[184:187], v[216:219], v[80:83]
    ds_read_b128 v[212:215], v7 offset:2048
    v_mfma_f32_16x16x32_bf16 v[84:87], v[188:191], v[216:219], v[84:87]
    buffer_load_dwordx4 v[180:183], v27, s[68:71], s19 offen offset:1024 sc1
    s_waitcnt lgkmcnt(7)
    v_mfma_f32_16x16x32_bf16 v[88:91], v[184:187], v[220:223], v[88:91]
    ds_read_b128 v[216:219], v7 offset:4096
    v_mfma_f32_16x16x32_bf16 v[92:95], v[188:191], v[220:223], v[92:95]
    s_waitcnt vmcnt(12) lgkmcnt(7)
    v_mfma_f32_16x16x32_bf16 v[64:67], v[128:131], v[192:195], v[64:67]
    ds_read_b128 v[220:223], v7 offset:6144
    v_mov_b32 v22, 30
    v_mfma_f32_16x16x32_bf16 v[68:71], v[132:135], v[192:195], v[68:71]
    buffer_load_dwordx4 v[184:187], v27, s[68:71], s19 offen offset:2048 sc1
    s_waitcnt lgkmcnt(7)
    v_mfma_f32_16x16x32_bf16 v[72:75], v[128:131], v[196:199], v[72:75]
    ds_read_b128 v[192:195], v6 offset:8192
    v_mfma_f32_16x16x32_bf16 v[76:79], v[132:135], v[196:199], v[76:79]
    ds_write_b32 v10, v22
    s_waitcnt lgkmcnt(8)
    v_mfma_f32_16x16x32_bf16 v[80:83], v[128:131], v[200:203], v[80:83]
    ds_read_b128 v[196:199], v6 offset:10240
    v_add_u32 v8, 32768, v8
    v_mfma_f32_16x16x32_bf16 v[84:87], v[132:135], v[200:203], v[84:87]
    buffer_load_dwordx4 v[188:191], v27, s[68:71], s19 offen offset:3072 sc1
    s_waitcnt lgkmcnt(8)
    v_mfma_f32_16x16x32_bf16 v[88:91], v[128:131], v[204:207], v[88:91]
    ds_read_b128 v[200:203], v6 offset:12288
    s_bfe_u32 s19, s101, 24 + (4 << 16)
    v_mfma_f32_16x16x32_bf16 v[92:95], v[132:135], v[204:207], v[92:95]
    s_lshl_b32 s19, s19, 13
    s_waitcnt vmcnt(12) lgkmcnt(8)
    v_mfma_f32_16x16x32_bf16 v[64:67], v[136:139], v[208:211], v[64:67]
    ds_read_b128 v[204:207], v6 offset:14336
    v_add_u32 v9, 32768, v9
    v_mfma_f32_16x16x32_bf16 v[68:71], v[140:143], v[208:211], v[68:71]
    buffer_load_dwordx4 v[128:131], v26, s[68:71], s19 offen offset:0 sc1
    s_waitcnt lgkmcnt(7)
    v_mfma_f32_16x16x32_bf16 v[72:75], v[136:139], v[212:215], v[72:75]
    ds_read_b128 v[208:211], v7 offset:8192
    v_cmp_gt_u32 vcc, 4, v18
    v_mfma_f32_16x16x32_bf16 v[76:79], v[140:143], v[212:215], v[76:79]
    s_waitcnt lgkmcnt(7)
    v_mfma_f32_16x16x32_bf16 v[80:83], v[136:139], v[216:219], v[80:83]
    ds_read_b128 v[212:215], v7 offset:10240
    v_mfma_f32_16x16x32_bf16 v[84:87], v[140:143], v[216:219], v[84:87]
    buffer_load_dwordx4 v[132:135], v26, s[68:71], s19 offen offset:1024 sc1
    s_waitcnt lgkmcnt(7)
    v_mfma_f32_16x16x32_bf16 v[88:91], v[136:139], v[220:223], v[88:91]
    ds_read_b128 v[216:219], v7 offset:12288
    s_cbranch_vccnz G2_slowc
G2_backc:
    v_mfma_f32_16x16x32_bf16 v[92:95], v[140:143], v[220:223], v[92:95]
    s_waitcnt vmcnt(12) lgkmcnt(7)
    v_mfma_f32_16x16x32_bf16 v[64:67], v[144:147], v[192:195], v[64:67]
    ds_read_b128 v[220:223], v7 offset:14336
    v_mfma_f32_16x16x32_bf16 v[68:71], v[148:151], v[192:195], v[68:71]
    buffer_load_dwordx4 v[136:139], v26, s[68:71], s19 offen offset:2048 sc1
    s_waitcnt lgkmcnt(6)
    v_mfma_f32_16x16x32_bf16 v[72:75], v[144:147], v[196:199], v[72:75]
    ds_read_b128 v[192:195], v8 offset:0
    v_mfma_f32_16x16x32_bf16 v[76:79], v[148:151], v[196:199], v[76:79]
    s_waitcnt lgkmcnt(6)
    v_mfma_f32_16x16x32_bf16 v[80:83], v[144:147], v[200:203], v[80:83]
    ds_read_b128 v[196:199], v8 offset:2048
    v_mfma_f32_16x16x32_bf16 v[84:87], v[148:151], v[200:203], v[84:87]
    buffer_load_dwordx4 v[140:143], v26, s[68:71], s19 offen offset:3072 sc1
    s_waitcnt lgkmcnt(6)
    v_mfma_f32_16x16x32_bf16 v[88:91], v[144:147], v[204:207], v[88:91]
    ds_read_b128 v[200:203], v8 offset:25856
    v_mfma_f32_16x16x32_bf16 v[92:95], v[148:151], v[204:207], v[92:95]
    s_waitcnt vmcnt(12) lgkmcnt(6)
    v_mfma_f32_16x16x32_bf16 v[64:67], v[152:155], v[208:211], v[64:67]
    ds_read_b128 v[204:207], v8 offset:27904
    v_mfma_f32_16x16x32_bf16 v[68:71], v[156:159], v[208:211], v[68:71]
    buffer_load_dwordx4 v[144:147], v27, s[68:71], s19 offen offset:0 sc1
    s_waitcnt lgkmcnt(6)
    v_mfma_f32_16x16x32_bf16 v[72:75], v[152:155], v[212:215], v[72:75]
    ds_read_b128 v[208:211], v9 offset:0
    v_mfma_f32_16x16x32_bf16 v[76:79], v[156:159], v[212:215], v[76:79]
    s_waitcnt lgkmcnt(6)
    v_mfma_f32_16x16x32_bf16 v[80:83], v[152:155], v[216:219], v[80:83]
    ds_read_b128 v[212:215], v9 offset:2048
    v_mfma_f32_16x16x32_bf16 v[84:87], v[156:159], v[216:219], v[84:87]
    buffer_load_dwordx4 v[148:151], v27, s[68:71], s19 offen offset:1024 sc1
    s_waitcnt lgkmcnt(6)
    v_mfma_f32_16x16x32_bf16 v[88:91], v[152:155], v[220:223], v[88:91]
    ds_read_b128 v[216:219], v9 offset:25856
    v_mfma_f32_16x16x32_bf16 v[92:95], v[156:159], v[220:223], v[92:95]
    s_waitcnt vmcnt(12) lgkmcnt(6)
    v_mfma_f32_16x16x32_bf16 v[64:67], v[160:163], v[192:195], v[64:67]
    ds_read_b128 v[220:223], v9 offset:27904
    v_mov_b32 v22, 31
    v_mfma_f32_16x16x32_bf16 v[68:71], v[164:167], v[192:195], v[68:71]
    buffer_load_dwordx4 v[152:155], v27, s[68:71], s19 offen offset:2048 sc1
    s_waitcnt lgkmcnt(6)
    v_mfma_f32_16x16x32_bf16 v[72:75], v[160:163], v[196:199], v[72:75]
    ds_read_b128 v[192:195], v8 offset:12928
    v_mfma_f32_16x16x32_bf16 v[76:79], v[164:167], v[196:199], v[76:79]
    ds_write_b32 v10, v22
    s_waitcnt lgkmcnt(7)
    v_mfma_f32_16x16x32_bf16 v[80:83], v[160:163], v[200:203], v[80:83]
    ds_read_b128 v[196:199], v8 offset:14976
    v_mfma_f32_16x16x32_bf16 v[84:87], v[164:167], v[200:203], v[84:87]
    buffer_load_dwordx4 v[156:159], v27, s[68:71], s19 offen offset:3072 sc1
    s_waitcnt lgkmcnt(7)
    v_mfma_f32_16x16x32_bf16 v[88:91], v[160:163], v[204:207], v[88:91]
    ds_read_b128 v[200:203], v8 offset:38784
    s_bfe_u32 s19, s101, 28 + (4 << 16)
    v_mfma_f32_16x16x32_bf16 v[92:95], v[164:167], v[204:207], v[92:95]
    s_lshl_b32 s19, s19, 13
    s_waitcnt vmcnt(12) lgkmcnt(7)
    v_mfma_f32_16x16x32_bf16 v[64:67], v[168:171], v[208:211], v[64:67]
    ds_read_b128 v[204:207], v8 offset:40832
    v_mfma_f32_16x16x32_bf16 v[68:71], v[172:175], v[208:211], v[68:71]
    buffer_load_dwordx4 v[160:163], v26, s[68:71], s19 offen offset:0 sc1
    s_waitcnt lgkmcnt(7)
    v_mfma_f32_16x16x32_bf16 v[72:75], v[168:171], v[212:215], v[72:75]
    ds_read_b128 v[208:211], v9 offset:12928
    v_mfma_f32_16x16x32_bf16 v[76:79], v[172:175], v[212:215], v[76:79]
    s_waitcnt lgkmcnt(7)
    v_mfma_f32_16x16x32_bf16 v[80:83], v[168:171], v[216:219], v[80:83]
    ds_read_b128 v[212:215], v9 offset:14976
    v_mfma_f32_16x16x32_bf16 v[84:87], v[172:175], v[216:219], v[84:87]
    buffer_load_dwordx4 v[164:167], v26, s[68:71], s19 offen offset:1024 sc1
    s_waitcnt lgkmcnt(7)
    v_mfma_f32_16x16x32_bf16 v[88:91], v[168:171], v[220:223], v[88:91]
    ds_read_b128 v[216:219], v9 offset:38784
    v_mfma_f32_16x16x32_bf16 v[92:95], v[172:175], v[220:223], v[92:95]
    s_waitcnt vmcnt(12) lgkmcnt(7)
    v_mfma_f32_16x16x32_bf16 v[64:67], v[176:179], v[192:195], v[64:67]
    ds_read_b128 v[220:223], v9 offset:40832
    v_mfma_f32_16x16x32_bf16 v[68:71], v[180:183], v[192:195], v[68:71]
    buffer_load_dwordx4 v[168:171], v26, s[68:71], s19 offen offset:2048 sc1
    s_waitcnt lgkmcnt(6)
    v_mfma_f32_16x16x32_bf16 v[72:75], v[176:179], v[196:199], v[72:75]
    ds_read_b128 v[192:195], v8 offset:4096
    v_mfma_f32_16x16x32_bf16 v[76:79], v[180:183], v[196:199], v[76:79]
    s_waitcnt lgkmcnt(6)
    v_mfma_f32_16x16x32_bf16 v[80:83], v[176:179], v[200:203], v[80:83]
    ds_read_b128 v[196:199], v8 offset:6144
    v_mfma_f32_16x16x32_bf16 v[84:87], v[180:183], v[200:203], v[84:87]
    buffer_load_dwordx4 v[172:175], v26, s[68:71], s19 offen offset:3072 sc1
    s_waitcnt lgkmcnt(6)
    v_mfma_f32_16x16x32_bf16 v[88:91], v[176:179], v[204:207], v[88:91]
    ds_read_b128 v[200:203], v8 offset:29952
    v_mfma_f32_16x16x32_bf16 v[92:95], v[180:183], v[204:207], v[92:95]
    s_waitcnt vmcnt(12) lgkmcnt(6)
    v_mfma_f32_16x16x32_bf16 v[64:67], v[184:187], v[208:211], v[64:67]
    ds_read_b128 v[204:207], v8 offset:32000
    v_mfma_f32_16x16x32_bf16 v[68:71], v[188:191], v[208:211], v[68:71]
    buffer_load_dwordx4 v[176:179], v27, s[68:71], s19 offen offset:0 sc1
    s_waitcnt lgkmcnt(6)
    v_mfma_f32_16x16x32_bf16 v[72:75], v[184:187], v[212:215], v[72:75]
    ds_read_b128 v[208:211], v9 offset:4096
    v_mfma_f32_16x16x32_bf16 v[76:79], v[188:191], v[212:215], v[76:79]
    s_waitcnt lgkmcnt(6)
    v_mfma_f32_16x16x32_bf16 v[80:83], v[184:187], v[216:219], v[80:83]
    ds_read_b128 v[212:215], v9 offset:6144
    v_mfma_f32_16x16x32_bf16 v[84:87], v[188:191], v[216:219], v[84:87]
    buffer_load_dwordx4 v[180:183], v27, s[68:71], s19 offen offset:1024 sc1
    s_waitcnt lgkmcnt(6)
    v_mfma_f32_16x16x32_bf16 v[88:91], v[184:187], v[220:223], v[88:91]
    ds_read_b128 v[216:219], v9 offset:29952
    v_mfma_f32_16x16x32_bf16 v[92:95], v[188:191], v[220:223], v[92:95]
    s_waitcnt vmcnt(12) lgkmcnt(6)
    v_mfma_f32_16x16x32_bf16 v[64:67], v[128:131], v[192:195], v[64:67]
    ds_read_b128 v[220:223], v9 offset:32000
    v_mov_b32 v22, 32
    v_mfma_f32_16x16x32_bf16 v[68:71], v[132:135], v[192:195], v[68:71]
    buffer_load_dwordx4 v[184:187], v27, s[68:71], s19 offen offset:2048 sc1
    s_waitcnt lgkmcnt(6)
    v_mfma_f32_16x16x32_bf16 v[72:75], v[128:131], v[196:199], v[72:75]
    ds_read_b128 v[192:195], v8 offset:17024
    v_mfma_f32_16x16x32_bf16 v[76:79], v[132:135], v[196:199], v[76:79]
    ds_write_b32 v10, v22
    s_waitcnt lgkmcnt(7)
    v_mfma_f32_16x16x32_bf16 v[80:83], v[128:131], v[200:203], v[80:83]
    ds_read_b128 v[196:199], v8 offset:19072
    v_mfma_f32_16x16x32_bf16 v[84:87], v[132:135], v[200:203], v[84:87]
    buffer_load_dwordx4 v[188:191], v27, s[68:71], s19 offen offset:3072 sc1
    s_waitcnt lgkmcnt(7)
    v_mfma_f32_16x16x32_bf16 v[88:91], v[128:131], v[204:207], v[88:91]
    ds_read_b128 v[200:203], v8 offset:42880
    v_mfma_f32_16x16x32_bf16 v[92:95], v[132:135], v[204:207], v[92:95]
    s_waitcnt vmcnt(12) lgkmcnt(7)
    v_mfma_f32_16x16x32_bf16 v[64:67], v[136:139], v[208:211], v[64:67]
    ds_read_b128 v[204:207], v8 offset:44928
    v_mfma_f32_16x16x32_bf16 v[68:71], v[140:143], v[208:211], v[68:71]
    s_waitcnt lgkmcnt(7)
    v_mfma_f32_16x16x32_bf16 v[72:75], v[136:139], v[212:215], v[72:75]
    ds_read_b128 v[208:211], v9 offset:17024
    v_mfma_f32_16x16x32_bf16 v[76:79], v[140:143], v[212:215], v[76:79]
    s_waitcnt lgkmcnt(7)
    v_mfma_f32_16x16x32_bf16 v[80:83], v[136:139], v[216:219], v[80:83]
    ds_read_b128 v[212:215], v9 offset:19072
    v_mfma_f32_16x16x32_bf16 v[84:87], v[140:143], v[216:219], v[84:87]
    s_waitcnt lgkmcnt(7)
    v_mfma_f32_16x16x32_bf16 v[88:91], v[136:139], v[220:223], v[88:91]
    ds_read_b128 v[216:219], v9 offset:42880
    v_mfma_f32_16x16x32_bf16 v[92:95], v[140:143], v[220:223], v[92:95]
    s_waitcnt vmcnt(10) lgkmcnt(7)
    v_mfma_f32_16x16x32_bf16 v[64:67], v[144:147], v[192:195], v[64:67]
    ds_read_b128 v[220:223], v9 offset:44928
    v_mfma_f32_16x16x32_bf16 v[68:71], v[148:151], v[192:195], v[68:71]
    s_waitcnt lgkmcnt(6)
    v_mfma_f32_16x16x32_bf16 v[72:75], v[144:147], v[196:199], v[72:75]
    ds_read_b128 v[192:195], v8 offset:8192
    v_mfma_f32_16x16x32_bf16 v[76:79], v[148:151], v[196:199], v[76:79]
    s_waitcnt lgkmcnt(6)
    v_mfma_f32_16x16x32_bf16 v[80:83], v[144:147], v[200:203], v[80:83]
    ds_read_b128 v[196:199], v8 offset:10240
    v_mfma_f32_16x16x32_bf16 v[84:87], v[148:151], v[200:203], v[84:87]
    s_waitcnt lgkmcnt(6)
    v_mfma_f32_16x16x32_bf16 v[88:91], v[144:147], v[204:207], v[88:91]
    ds_read_b128 v[200:203], v8 offset:34048
    v_mfma_f32_16x16x32_bf16 v[92:95], v[148:151], v[204:207], v[92:95]
    s_waitcnt vmcnt(8) lgkmcnt(6)
    v_mfma_f32_16x16x32_bf16 v[64:67], v[152:155], v[208:211], v[64:67]
    ds_read_b128 v[204:207], v8 offset:36096
    v_mfma_f32_16x16x32_bf16 v[68:71], v[156:159], v[208:211], v[68:71]
    s_waitcnt lgkmcnt(6)
    v_mfma_f32_16x16x32_bf16 v[72:75], v[152:155], v[212:215], v[72:75]
    ds_read_b128 v[208:211], v9 offset:8192
    v_mfma_f32_16x16x32_bf16 v[76:79], v[156:159], v[212:215], v[76:79]
    s_waitcnt lgkmcnt(6)
    v_mfma_f32_16x16x32_bf16 v[80:83], v[152:155], v[216:219], v[80:83]
    ds_read_b128 v[212:215], v9 offset:10240
    v_mfma_f32_16x16x32_bf16 v[84:87], v[156:159], v[216:219], v[84:87]
    s_waitcnt lgkmcnt(6)
    v_mfma_f32_16x16x32_bf16 v[88:91], v[152:155], v[220:223], v[88:91]
    ds_read_b128 v[216:219], v9 offset:34048
    v_mfma_f32_16x16x32_bf16 v[92:95], v[156:159], v[220:223], v[92:95]
    s_waitcnt vmcnt(6) lgkmcnt(6)
    v_mfma_f32_16x16x32_bf16 v[64:67], v[160:163], v[192:195], v[64:67]
    ds_read_b128 v[220:223], v9 offset:36096
    v_mov_b32 v22, 33
    v_mfma_f32_16x16x32_bf16 v[68:71], v[164:167], v[192:195], v[68:71]
    s_waitcnt lgkmcnt(6)
    v_mfma_f32_16x16x32_bf16 v[72:75], v[160:163], v[196:199], v[72:75]
    ds_read_b128 v[192:195], v8 offset:21120
    v_mfma_f32_16x16x32_bf16 v[76:79], v[164:167], v[196:199], v[76:79]
    ds_write_b32 v10, v22
    s_waitcnt lgkmcnt(7)
    v_mfma_f32_16x16x32_bf16 v[80:83], v[160:163], v[200:203], v[80:83]
    ds_read_b128 v[196:199], v8 offset:23168
    v_mfma_f32_16x16x32_bf16 v[84:87], v[164:167], v[200:203], v[84:87]
    s_waitcnt lgkmcnt(7)
    v_mfma_f32_16x16x32_bf16 v[88:91], v[160:163], v[204:207], v[88:91]
    ds_read_b128 v[200:203], v8 offset:46976
    v_mfma_f32_16x16x32_bf16 v[92:95], v[164:167], v[204:207], v[92:95]
    s_waitcnt vmcnt(4) lgkmcnt(7)
    v_mfma_f32_16x16x32_bf16 v[64:67], v[168:171], v[208:211], v[64:67]
    ds_read_b128 v[204:207], v8 offset:49024
    v_mfma_f32_16x16x32_bf16 v[68:71], v[172:175], v[208:211], v[68:71]
    s_waitcnt lgkmcnt(7)
    v_mfma_f32_16x16x32_bf16 v[72:75], v[168:171], v[212:215], v[72:75]
    ds_read_b128 v[208:211], v9 offset:21120
    v_mfma_f32_16x16x32_bf16 v[76:79], v[172:175], v[212:215], v[76:79]
    s_waitcnt lgkmcnt(7)
    v_mfma_f32_16x16x32_bf16 v[80:83], v[168:171], v[216:219], v[80:83]
    ds_read_b128 v[212:215], v9 offset:23168
    v_mfma_f32_16x16x32_bf16 v[84:87], v[172:175], v[216:219], v[84:87]
    s_waitcnt lgkmcnt(7)
    v_mfma_f32_16x16x32_bf16 v[88:91], v[168:171], v[220:223], v[88:91]
    ds_read_b128 v[216:219], v9 offset:46976
    v_mfma_f32_16x16x32_bf16 v[92:95], v[172:175], v[220:223], v[92:95]
    s_waitcnt vmcnt(2) lgkmcnt(7)
    v_mfma_f32_16x16x32_bf16 v[64:67], v[176:179], v[192:195], v[64:67]
    ds_read_b128 v[220:223], v9 offset:49024
    v_mfma_f32_16x16x32_bf16 v[68:71], v[180:183], v[192:195], v[68:71]
    s_waitcnt lgkmcnt(6)
    v_mfma_f32_16x16x32_bf16 v[72:75], v[176:179], v[196:199], v[72:75]
    v_mfma_f32_16x16x32_bf16 v[76:79], v[180:183], v[196:199], v[76:79]
    s_waitcnt lgkmcnt(5)
    v_mfma_f32_16x16x32_bf16 v[80:83], v[176:179], v[200:203], v[80:83]
    v_mfma_f32_16x16x32_bf16 v[84:87], v[180:183], v[200:203], v[84:87]
    s_waitcnt lgkmcnt(4)
    v_mfma_f32_16x16x32_bf16 v[88:91], v[176:179], v[204:207], v[88:91]
    v_mfma_f32_16x16x32_bf16 v[92:95], v[180:183], v[204:207], v[92:95]
    s_waitcnt vmcnt(0) lgkmcnt(3)
    v_mfma_f32_16x16x32_bf16 v[64:67], v[184:187], v[208:211], v[64:67]
    v_mfma_f32_16x16x32_bf16 v[68:71], v[188:191], v[208:211], v[68:71]
    s_waitcnt lgkmcnt(2)
    v_mfma_f32_16x16x32_bf16 v[72:75], v[184:187], v[212:215], v[72:75]
    v_mfma_f32_16x16x32_bf16 v[76:79], v[188:191], v[212:215], v[76:79]
    s_waitcnt lgkmcnt(1)
    v_mfma_f32_16x16x32_bf16 v[80:83], v[184:187], v[216:219], v[80:83]
    v_mfma_f32_16x16x32_bf16 v[84:87], v[188:191], v[216:219], v[84:87]
    s_waitcnt lgkmcnt(0)
    v_mfma_f32_16x16x32_bf16 v[88:91], v[184:187], v[220:223], v[88:91]
    v_mfma_f32_16x16x32_bf16 v[92:95], v[188:191], v[220:223], v[92:95]
    s_lshl_b32 s10, s6, 7
    s_lshl_b32 s11, s3, 5
    s_add_u32 s10, s10, s11
    v_lshrrev_b32 v32, 4, v2
    v_lshl_add_u32 v32, v32, 2, s10
    s_lshl_b32 s10, s7, 8
    s_add_u32 s10, s10, 4096
    v_and_b32 v33, 15, v2
    v_lshl_add_u32 v33, v33, 4, s10
    v_lshl_add_u32 v32, v32, 13, v33
    v_mov_b32 v224, v64
    v_mov_b32 v225, v72
    v_mov_b32 v226, v80
    v_mov_b32 v227, v88
    s_mov_b32 s10, 0
    buffer_store_dwordx4 v[224:227], v32, s[60:63], s10 offen nt
    v_mov_b32 v228, v65
    v_mov_b32 v229, v73
    v_mov_b32 v230, v81
    v_mov_b32 v231, v89
    s_mov_b32 s10, 8192
    buffer_store_dwordx4 v[228:231], v32, s[60:63], s10 offen nt
    v_mov_b32 v232, v66
    v_mov_b32 v233, v74
    v_mov_b32 v234, v82
    v_mov_b32 v235, v90
    s_mov_b32 s10, 16384
    buffer_store_dwordx4 v[232:235], v32, s[60:63], s10 offen nt
    v_mov_b32 v236, v67
    v_mov_b32 v237, v75
    v_mov_b32 v238, v83
    v_mov_b32 v239, v91
    s_mov_b32 s10, 24576
    buffer_store_dwordx4 v[236:239], v32, s[60:63], s10 offen nt
    v_mov_b32 v240, v68
    v_mov_b32 v241, v76
    v_mov_b32 v242, v84
    v_mov_b32 v243, v92
    s_mov_b32 s10, 131072
    buffer_store_dwordx4 v[240:243], v32, s[60:63], s10 offen nt
    v_mov_b32 v244, v69
    v_mov_b32 v245, v77
    v_mov_b32 v246, v85
    v_mov_b32 v247, v93
    s_mov_b32 s10, 139264
    buffer_store_dwordx4 v[244:247], v32, s[60:63], s10 offen nt
    v_mov_b32 v248, v70
    v_mov_b32 v249, v78
    v_mov_b32 v250, v86
    v_mov_b32 v251, v94
    s_mov_b32 s10, 147456
    buffer_store_dwordx4 v[248:251], v32, s[60:63], s10 offen nt
    v_mov_b32 v252, v71
    v_mov_b32 v253, v79
    v_mov_b32 v254, v87
    v_mov_b32 v255, v95
    s_mov_b32 s10, 155648
    buffer_store_dwordx4 v[252:255], v32, s[60:63], s10 offen nt
    s_endpgm
G2_slow3:
    s_mov_b32 s15, 0
G2_sl3_w:
    ds_read_b128 v[12:15], v11 offset:0
    s_waitcnt lgkmcnt(0)
    v_min3_u32 v12, v12, v13, v14
    v_min_u32 v12, v12, v15
    v_cmp_gt_u32 vcc, 20, v12
    s_cbranch_vccz G2_sl3_ok
    s_add_u32 s15, s15, 1
    s_cmp_lt_u32 s15, 160000
    s_cbranch_scc1 G2_sl3_w
G2_sl3_ok:
    s_branch G2_back3
G2_slow4:
    s_mov_b32 s15, 0
G2_sl4_w:
    ds_read_b128 v[12:15], v11 offset:0
    s_waitcnt lgkmcnt(0)
    v_min3_u32 v12, v12, v13, v14
    v_min_u32 v12, v12, v15
    v_cmp_gt_u32 vcc, 21, v12
    s_cbranch_vccz G2_sl4_ok
    s_add_u32 s15, s15, 1
    s_cmp_lt_u32 s15, 160000
    s_cbranch_scc1 G2_sl4_w
G2_sl4_ok:
    s_branch G2_back4
G2_slow5:
    s_mov_b32 s15, 0
G2_sl5_w:
    ds_read_b128 v[12:15], v11 offset:0
    s_waitcnt lgkmcnt(0)
    v_min3_u32 v12, v12, v13, v14
    v_min_u32 v12, v12, v15
    v_cmp_gt_u32 vcc, 22, v12
    s_cbranch_vccz G2_sl5_ok
    s_add_u32 s15, s15, 1
    s_cmp_lt_u32 s15, 160000
    s_cbranch_scc1 G2_sl5_w
G2_sl5_ok:
    s_branch G2_back5
G2_slow6:
    s_mov_b32 s15, 0
G2_sl6_w:
    ds_read_b128 v[12:15], v11 offset:0
    s_waitcnt lgkmcnt(0)
    v_min3_u32 v12, v12, v13, v14
    v_min_u32 v12, v12, v15
    v_cmp_gt_u32 vcc, 23, v12
    s_cbranch_vccz G2_sl6_ok
    s_add_u32 s15, s15, 1
    s_cmp_lt_u32 s15, 160000
    s_cbranch_scc1 G2_sl6_w
G2_sl6_ok:
    s_branch G2_back6
G2_slow7:
    s_mov_b32 s15, 0
G2_sl7_w:
    ds_read_b128 v[12:15], v11 offset:0
    s_waitcnt lgkmcnt(0)
    v_min3_u32 v12, v12, v13, v14
    v_min_u32 v12, v12, v15
    v_cmp_gt_u32 vcc, 24, v12
    s_cbranch_vccz G2_sl7_ok
    s_add_u32 s15, s15, 1
    s_cmp_lt_u32 s15, 160000
    s_cbranch_scc1 G2_sl7_w
G2_sl7_ok:
    s_branch G2_back7
G2_slow8:
    s_mov_b32 s15, 0
G2_sl8_w:
    ds_read_b128 v[12:15], v11 offset:0
    s_waitcnt lgkmcnt(0)
    v_min3_u32 v12, v12, v13, v14
    v_min_u32 v12, v12, v15
    v_cmp_gt_u32 vcc, 25, v12
    s_cbranch_vccz G2_sl8_ok
    s_add_u32 s15, s15, 1
    s_cmp_lt_u32 s15, 160000
    s_cbranch_scc1 G2_sl8_w
G2_sl8_ok:
    s_branch G2_back8
G2_slow10:
    s_mov_b32 s15, 0
G2_sl10_w:
    ds_read_b128 v[12:15], v11 offset:0
    s_waitcnt lgkmcnt(0)
    v_min3_u32 v12, v12, v13, v14
    v_min_u32 v12, v12, v15
    v_cmp_gt_u32 vcc, 27, v12
    s_cbranch_vccz G2_sl10_ok
    s_add_u32 s15, s15, 1
    s_cmp_lt_u32 s15, 160000
    s_cbranch_scc1 G2_sl10_w
G2_sl10_ok:
    s_branch G2_back10
G2_slowc:
    s_mov_b32 s15, 0
G2_slc_w:
    ds_read_b32 v18, v11 offset:68
    s_waitcnt lgkmcnt(0)
    v_cmp_gt_u32 vcc, 4, v18
    s_cbranch_vccz G2_slc_ok
    s_add_u32 s15, s15, 1
    s_cmp_lt_u32 s15, 160000
    s_cbranch_scc1 G2_slc_w
G2_slc_ok:
    s_branch G2_backc
Y_done:
    s_endpgm
Y_end:
.section .rodata,"a"
.p2align 6
.amdhsa_kernel concat_heads__ssm_conv_h3__ssm_conv_s5__prompt_kernel
  .amdhsa_next_free_vgpr 256
  .amdhsa_next_free_sgpr 102
  .amdhsa_accum_offset 256
  .amdhsa_group_segment_fixed_size 0
  .amdhsa_kernarg_size 144
  .amdhsa_user_sgpr_count 2
  .amdhsa_user_sgpr_kernarg_segment_ptr 1
  .amdhsa_system_sgpr_workgroup_id_x 1
.end_amdhsa_kernel
```

```asm
; @launch grid=(256,1,1) block=(512,1,1) lds=163840
.amdgcn_target "amdgcn-amd-amdhsa--gfx950"
.text
.globl concat_heads__ssm_conv_h3__ssm_conv_s5__prompt_kernel
.p2align 8
.type concat_heads__ssm_conv_h3__ssm_conv_s5__prompt_kernel,@function
concat_heads__ssm_conv_h3__ssm_conv_s5__prompt_kernel:
    s_cmp_ge_u32 s2, 256
    s_cbranch_scc1 Y_done
    s_load_dwordx16 s[16:31], s[0:1], 0
    s_load_dwordx16 s[32:47], s[0:1], 64
    s_load_dwordx4 s[48:51], s[0:1], 128
    s_getpc_b64 s[52:53]
Y_pc:
    v_lshrrev_b32 v1, 6, v0
    v_and_b32 v2, 63, v0
    s_and_b32 s4, s2, 7
    v_readfirstlane_b32 s3, v1
    s_lshr_b32 s5, s2, 3
    s_and_b32 s6, s4, 1
    s_lshl_b32 s6, s6, 3
    s_and_b32 s7, s5, 7
    s_add_u32 s6, s6, s7
    s_and_b32 s7, s4, 6
    s_lshl_b32 s7, s7, 1
    s_lshr_b32 s8, s5, 3
    s_add_u32 s7, s7, s8
    s_cmp_lt_u32 s3, 4
    s_cbranch_scc0 Y_L
    s_lshl_b32 s54, s5, 2
    s_add_u32 s54, s54, s3
    s_lshl_b32 s54, s54, 7
    s_load_dword s56, s[52:53], s54
    s_add_u32 s54, s54, 64
    s_load_dword s57, s[52:53], s54
    s_add_u32 s54, s54, 16320
    s_min_u32 s54, s54, Y_end-Y_pc-4
    s_load_dword s58, s[52:53], s54
    s_add_u32 s54, s54, 64
    s_min_u32 s54, s54, Y_end-Y_pc-4
    s_load_dword s59, s[52:53], s54
    s_barrier
    s_branch Y_G
Y_L:
    s_add_u32 s13, s5, s8
    s_lshl_b32 s13, s13, 3
    s_and_b32 s9, s4, 6
    s_add_u32 s13, s13, s9
    s_and_b32 s9, s4, 1
    s_lshl_b32 s9, s9, 2
    s_add_u32 s13, s13, s9
    s_and_b32 s13, s13, 15
    s_lshl_b32 s13, s13, 7
    s_setprio 2
    s_sub_u32 s8, s3, 4
    s_lshr_b32 s11, s8, 1
    s_and_b32 s9, s8, 1
    s_cmp_eq_u32 s11, 1
    s_cbranch_scc1 L_ns0
    s_lshl_b32 s10, s6, 7
    s_lshl_b32 s12, s9, 6
    s_add_u32 s10, s10, s12
    v_and_b32 v24, 32, v2
    v_bfe_u32 v25, v2, 3, 1
    v_lshl_add_u32 v24, v25, 4, v24
    v_bfe_u32 v25, v2, 4, 1
    v_add_u32 v24, v24, v25
    v_add_u32 v24, s10, v24
    v_lshlrev_b32 v24, 11, v24
    v_lshrrev_b32 v25, 4, v2
    v_xor_b32 v25, v25, v2
    v_and_b32 v25, 7, v25
    v_lshl_add_u32 v4, v25, 4, v24
    v_xor_b32 v5, 64, v4
    v_add_u32 v5, 3072, v5
    v_add_u32 v6, 6144, v4
    v_add_u32 v7, 6144, v5
    s_lshl_b32 s10, s7, 6
    v_lshrrev_b32 v24, 3, v2
    s_lshl_b32 s12, s9, 5
    s_add_u32 s10, s10, s12
    v_add_u32 v24, s10, v24
    v_lshlrev_b32 v24, 11, v24
    v_lshrrev_b32 v25, 4, v2
    v_xor_b32 v25, v25, v2
    v_and_b32 v25, 7, v25
    v_lshl_add_u32 v8, v25, 4, v24
    v_xor_b32 v9, 64, v8
    v_add_u32 v9, 15360, v9
    v_add_u32 v10, 30720, v8
    v_add_u32 v11, 30720, v9
    s_lshl_b32 s14, s8, 13
    s_mov_b32 s54, 4194304
    s_mov_b32 s55, 0x00020000
    s_mov_b32 s58, 2097152
    s_mov_b32 s59, 0x00020000
    s_mov_b32 s62, 2097152
    s_mov_b32 s63, 0x00020000
    s_waitcnt lgkmcnt(0)
    s_mov_b32 s52, s28
    s_mov_b32 s53, s29
    s_mov_b32 s56, s34
    s_mov_b32 s57, s35
    s_mov_b32 s60, s36
    s_mov_b32 s61, s37
    s_mov_b32 s22, 1043403025
    s_mov_b32 s23, 17895742
    s_add_u32 m0, s14, 0
    s_nop 0
    buffer_load_dwordx4 v4, s[52:55], s13 offen offset:0 lds
    buffer_load_dwordx4 v5, s[52:55], s13 offen offset:1024 lds
    buffer_load_dwordx4 v6, s[52:55], s13 offen offset:2048 lds
    buffer_load_dwordx4 v7, s[52:55], s13 offen offset:3072 lds
    s_add_u32 m0, s14, 16384
    s_nop 0
    buffer_load_dwordx4 v8, s[56:59], s13 offen offset:0 lds
    buffer_load_dwordx4 v9, s[56:59], s13 offen offset:1024 lds
    buffer_load_dwordx4 v10, s[56:59], s13 offen offset:2048 lds
    buffer_load_dwordx4 v11, s[56:59], s13 offen offset:3072 lds
    s_add_u32 m0, s14, 4096
    s_add_u32 s12, s13, 16384
    buffer_load_dwordx4 v4, s[52:55], s12 offen offset:0 lds
    buffer_load_dwordx4 v5, s[52:55], s12 offen offset:1024 lds
    buffer_load_dwordx4 v6, s[52:55], s12 offen offset:2048 lds
    buffer_load_dwordx4 v7, s[52:55], s12 offen offset:3072 lds
    s_add_u32 m0, s14, 20480
    s_nop 0
    buffer_load_dwordx4 v8, s[60:63], s13 offen offset:0 lds
    buffer_load_dwordx4 v9, s[60:63], s13 offen offset:1024 lds
    buffer_load_dwordx4 v10, s[60:63], s13 offen offset:2048 lds
    buffer_load_dwordx4 v11, s[60:63], s13 offen offset:3072 lds
    s_and_b32 s12, s22, 15
    s_lshl_b32 s12, s12, 7
    s_add_u32 s13, s13, s12
    s_lshr_b64 s[22:23], s[22:23], 4
    s_and_b32 s13, s13, 2047
    s_add_u32 s14, s14, 32768
    s_and_b32 s14, s14, 131071
L_ns0:
    v_and_b32 v60, 31, v2
    v_mov_b32 v61, 0
    v_mov_b32 v62, 163712
    v_lshl_add_u32 v60, v60, 2, v62
    ds_write_b32 v60, v61
    s_and_b32 s68, s4, 6
    s_add_u32 s69, s5, s68
    s_lshl_b32 s69, s69, 1
    s_and_b32 s68, s4, 1
    s_add_u32 s69, s69, s68
    s_and_b32 s69, s69, 15
    s_mov_b32 s100, 0x76543210
    s_mov_b32 s101, 0xfedcba98
    s_lshl_b32 s68, s69, 2
    s_lshr_b64 s[64:65], s[100:101], s68
    s_sub_u32 s68, 64, s68
    s_lshl_b64 s[100:101], s[100:101], s68
    s_or_b64 s[100:101], s[100:101], s[64:65]
    s_sub_u32 s68, s7, s69
    s_and_b32 s68, s68, 15
    s_lshl_b32 s68, s68, 2
    s_bfm_b64 s[64:65], s68, 0
    s_and_b64 s[66:67], s[100:101], s[64:65]
    s_lshl_b64 s[66:67], s[66:67], 4
    s_lshl_b64 s[64:65], s[64:65], 4
    s_or_b32 s64, s64, 15
    s_andn2_b64 s[100:101], s[100:101], s[64:65]
    s_or_b64 s[100:101], s[100:101], s[66:67]
    s_or_b32 s100, s100, s7
    s_waitcnt lgkmcnt(0)
    s_barrier
    v_mov_b32 v19, 0
    s_lshl_b32 s10, s3, 2
    s_add_u32 s10, s10, 163712
    v_mov_b32 v22, s10
    v_mov_b32 v21, 163712
    s_add_u32 s72, s50, 17825792
    s_addc_u32 s73, s51, 0
    s_mov_b32 s74, 24576
    s_mov_b32 s75, 0x00020000
    s_mov_b32 s76, s48
    s_mov_b32 s77, s49
    s_mov_b32 s78, 256
    s_mov_b32 s79, 0x00020000
    s_mov_b32 s37, s100
    s_mov_b32 s30, s101
    s_lshl_b32 s100, s4, 7
    s_lshl_b32 s10, s5, 2
    s_add_u32 s100, s100, s10
    s_add_u32 s100, s100, s8
    s_lshr_b32 s10, s100, 1
    s_lshl_b32 s10, s10, 2
    s_load_dword s31, s[26:27], s10
    s_mul_i32 s101, s8, 12928
    s_add_u32 s101, s101, 98304
    s_lshl_b32 s10, s7, 5
    s_add_u32 s10, s10, s11
    s_lshl_b32 s10, s10, 12
    v_lshrrev_b32 v24, 3, v2
    v_lshl_add_u32 v24, v24, 13, s10
    v_lshrrev_b32 v25, 4, v2
    v_xor_b32 v25, v25, v2
    v_and_b32 v25, 7, v25
    v_lshl_add_u32 v12, v25, 4, v24
    v_xor_b32 v13, 64, v12
    v_add_u32 v13, 64512, v13
    s_cmp_eq_u32 s9, 1
    s_cselect_b32 s80, s40, s38
    s_cselect_b32 s81, s41, s39
    s_mov_b32 s82, 2097152
    s_mov_b32 s83, 0x00020000
    s_mov_b32 s68, s24
    s_mov_b32 s69, s25
    s_mov_b32 s70, 4194304
    s_mov_b32 s71, 0x00020000
    s_movk_i32 s32, 4096
    s_movk_i32 s33, 8192
    s_movk_i32 s34, 12288
    s_lshl_b32 s10, s5, 6
    v_and_b32 v23, 56, v2
    v_add_u32 v23, s10, v23
    v_lshlrev_b32 v26, 4, v2
    s_lshl_b32 s36, s100, 12
    s_lshl_b32 s10, s4, 1
    s_lshr_b32 s12, s5, 4
    s_add_u32 s10, s10, s12
    s_lshl_b32 s10, s10, 8
    v_and_b32 v60, 31, v2
    v_lshl_add_u32 v20, v60, 3, s10
    s_lshl_b32 s10, s4, 7
    s_lshl_b32 s12, s8, 5
    s_add_u32 s35, s10, s12
    v_and_b32 v25, 7, v2
    v_lshl_add_u32 v24, v25, 2, s35
    v_lshlrev_b32 v25, 1, v24
    v_lshl_add_u32 v16, v23, 11, v25
    v_add_u32 v60, 12416, v26
    v_and_b32 v61, 16, v26
    v_and_b32 v62, 32, v26
    v_mul_u32_u24 v62, 130, v62
    v_add_u32 v61, v61, v62
    v_cmp_gt_u32 vcc, 32, v2
    s_nop 1
    v_cndmask_b32 v60, v61, v60, vcc
    v_add_u32 v18, s101, v60
    s_lshl_b32 s10, s4, 10
    s_add_u32 s10, s10, 8192
    v_add_u32 v3, s10, v26
    v_and_b32 v17, 15, v2
    v_lshrrev_b32 v27, 4, v2
    v_lshlrev_b32 v60, 1, v17
    v_lshlrev_b32 v61, 4, v27
    v_sub_u32 v60, v60, v61
    v_and_b32 v62, 1, v17
    v_mov_b32 v63, 4212
    v_cmp_eq_u32 vcc, 1, v62
    s_nop 1
    v_cndmask_b32 v63, v63, 50, vcc
    v_add3_u32 v28, v60, v63, s101
    v_add_u32 v29, 1024, v28
    v_add_u32 v30, 2048, v28
    v_add_u32 v31, 3072, v28
    v_lshl_add_u32 v60, v17, 5, v61
    s_add_u32 s10, s101, 8848
    v_sub_u32 v32, s10, v60
    s_add_u32 s10, s101, 8320
    v_add_u32 v33, s10, v26
    s_cmp_eq_u32 s11, 1
    s_cbranch_scc1 L_idle
    s_mov_b32 s29, 1
    v_mov_b32 v25, 1
    s_branch L_free
L_loop:
    s_sub_i32 s28, s29, 3
    s_max_i32 s28, s28, 0
    s_waitcnt lgkmcnt(0)
    v_min3_u32 v60, v60, v61, v62
    v_min_u32 v60, v60, v63
    v_mov_b32 v25, s29
    v_cmp_gt_u32 vcc, s28, v60
    s_cbranch_vccz L_free
    s_mov_b32 s15, 0
L_slot_w:
    ds_read_b128 v[60:63], v21 offset:0
    s_waitcnt lgkmcnt(0)
    v_min3_u32 v60, v60, v61, v62
    v_min_u32 v60, v60, v63
    v_cmp_gt_u32 vcc, s28, v60
    s_cbranch_vccz L_slot_ok
    s_sleep 1
    s_add_u32 s15, s15, 1
    s_cmp_lt_u32 s15, 160000
    s_cbranch_scc1 L_slot_w
L_slot_ok:
L_free:
    s_cmp_ge_u32 s29, 10
    s_cbranch_scc1 L_sh
    s_add_u32 m0, s14, 0
    s_waitcnt vmcnt(15)
    buffer_load_dwordx4 v4, s[52:55], s13 offen offset:0 lds
    s_waitcnt vmcnt(15)
    buffer_load_dwordx4 v5, s[52:55], s13 offen offset:1024 lds
    s_waitcnt vmcnt(15)
    buffer_load_dwordx4 v6, s[52:55], s13 offen offset:2048 lds
    s_waitcnt vmcnt(15)
    buffer_load_dwordx4 v7, s[52:55], s13 offen offset:3072 lds
    s_add_u32 m0, s14, 16384
    s_waitcnt vmcnt(15)
    buffer_load_dwordx4 v8, s[56:59], s13 offen offset:0 lds
    s_waitcnt vmcnt(15)
    buffer_load_dwordx4 v9, s[56:59], s13 offen offset:1024 lds
    s_waitcnt vmcnt(15)
    buffer_load_dwordx4 v10, s[56:59], s13 offen offset:2048 lds
    s_waitcnt vmcnt(15)
    buffer_load_dwordx4 v11, s[56:59], s13 offen offset:3072 lds
    s_add_u32 m0, s14, 4096
    s_add_u32 s12, s13, 16384
    s_waitcnt vmcnt(15)
    buffer_load_dwordx4 v4, s[52:55], s12 offen offset:0 lds
    s_waitcnt vmcnt(15)
    buffer_load_dwordx4 v5, s[52:55], s12 offen offset:1024 lds
    s_waitcnt vmcnt(15)
    buffer_load_dwordx4 v6, s[52:55], s12 offen offset:2048 lds
    s_waitcnt vmcnt(15)
    buffer_load_dwordx4 v7, s[52:55], s12 offen offset:3072 lds
    ds_read_b128 v[60:63], v21
    s_add_u32 m0, s14, 20480
    s_waitcnt vmcnt(15)
    buffer_load_dwordx4 v8, s[60:63], s13 offen offset:0 lds
    s_waitcnt vmcnt(15)
    buffer_load_dwordx4 v9, s[60:63], s13 offen offset:1024 lds
    s_waitcnt vmcnt(15)
    buffer_load_dwordx4 v10, s[60:63], s13 offen offset:2048 lds
    s_waitcnt vmcnt(15)
    ds_write_b32 v22, v25
    buffer_load_dwordx4 v11, s[60:63], s13 offen offset:3072 lds
    s_and_b32 s12, s22, 15
    s_lshl_b32 s12, s12, 7
    s_add_u32 s13, s13, s12
    s_lshr_b64 s[22:23], s[22:23], 4
    s_and_b32 s13, s13, 2047
    s_add_u32 s14, s14, 32768
    s_and_b32 s14, s14, 131071
    s_add_u32 s29, s29, 1
    s_branch L_loop
L_sh:
    s_add_u32 m0, s14, 0
    s_waitcnt vmcnt(7)
    buffer_load_dwordx4 v4, s[52:55], s13 offen offset:0 lds
    s_waitcnt vmcnt(7)
    buffer_load_dwordx4 v5, s[52:55], s13 offen offset:1024 lds
    s_waitcnt vmcnt(7)
    buffer_load_dwordx4 v6, s[52:55], s13 offen offset:2048 lds
    s_waitcnt vmcnt(7)
    buffer_load_dwordx4 v7, s[52:55], s13 offen offset:3072 lds
    s_add_u32 m0, s14, 16384
    s_waitcnt vmcnt(7)
    buffer_load_dwordx4 v8, s[56:59], s13 offen offset:0 lds
    s_waitcnt vmcnt(7)
    buffer_load_dwordx4 v9, s[56:59], s13 offen offset:1024 lds
    s_waitcnt vmcnt(7)
    buffer_load_dwordx4 v10, s[56:59], s13 offen offset:2048 lds
    s_waitcnt vmcnt(7)
    ds_write_b32 v22, v25
    buffer_load_dwordx4 v11, s[56:59], s13 offen offset:3072 lds
    s_add_u32 m0, s14, 4096
    s_add_u32 s12, s13, 16384
    s_waitcnt vmcnt(7)
    buffer_load_dwordx4 v4, s[52:55], s12 offen offset:0 lds
    s_waitcnt vmcnt(7)
    buffer_load_dwordx4 v5, s[52:55], s12 offen offset:1024 lds
    s_waitcnt vmcnt(7)
    buffer_load_dwordx4 v6, s[52:55], s12 offen offset:2048 lds
    s_waitcnt vmcnt(7)
    buffer_load_dwordx4 v7, s[52:55], s12 offen offset:3072 lds
    ds_read_b128 v[60:63], v21
    s_add_u32 m0, s14, 20480
    s_waitcnt vmcnt(7)
    buffer_load_dwordx4 v8, s[60:63], s13 offen offset:0 lds
    s_waitcnt vmcnt(7)
    buffer_load_dwordx4 v9, s[60:63], s13 offen offset:1024 lds
    s_waitcnt vmcnt(7)
    buffer_load_dwordx4 v10, s[60:63], s13 offen offset:2048 lds
    s_waitcnt vmcnt(7)
    buffer_load_dwordx4 v11, s[60:63], s13 offen offset:3072 lds
    s_and_b32 s12, s22, 15
    s_lshl_b32 s12, s12, 7
    s_add_u32 s13, s13, s12
    s_lshr_b64 s[22:23], s[22:23], 4
    s_and_b32 s13, s13, 2047
    s_add_u32 s14, s14, 32768
    s_and_b32 s14, s14, 131071
    s_add_u32 s29, s29, 1
    s_cmp_lt_u32 s29, 16
    s_cbranch_scc1 L_loop
    v_mov_b32 v25, 16
    v_mov_b32 v60, 1
    s_mov_b64 exec, 1
    ds_add_u32 v21, v60 offset:40
    s_mov_b64 exec, -1
    s_waitcnt vmcnt(0)
    ds_write_b32 v22, v25
    s_mov_b32 s15, 0
L_is0_w:
    ds_read_b32 v60, v21 offset:40
    s_waitcnt lgkmcnt(0)
    v_cmp_gt_u32 vcc, 2, v60
    s_cbranch_vccz L_is0_ok
    s_add_u32 s15, s15, 1
    s_cmp_lt_u32 s15, 160000
    s_cbranch_scc1 L_is0_w
L_is0_ok:
    buffer_load_dwordx4 v[192:195], v26, s[68:71], s36 offen offset:0 nt
    buffer_load_dwordx4 v[196:199], v26, s[68:71], s36 offen offset:1024 nt
    buffer_load_dwordx4 v[200:203], v26, s[68:71], s36 offen offset:2048 nt
    buffer_load_dwordx4 v[204:207], v26, s[68:71], s36 offen offset:3072 nt
    s_branch L_t2
L_idle:
    s_setprio 0
    s_cmp_eq_u32 s8, 3
    s_cbranch_scc0 L_ntls
    s_lshl_b32 s10, s5, 16
    s_load_dword s29, s[22:23], 0
    s_load_dword s29, s[44:45], 0
    s_load_dword s29, s[18:19], s10
    s_load_dword s29, s[20:21], s10
    s_load_dword s29, s[50:51], s10
    s_add_u32 s10, s10, 2097152
    s_load_dword s29, s[18:19], s10
    s_load_dword s29, s[20:21], s10
    s_load_dword s29, s[50:51], s10
    s_add_u32 s10, s10, 2097152
    s_add_u32 s10, s10, 2097152
    s_add_u32 s10, s10, 2097152
    s_load_dword s29, s[50:51], s10
    s_add_u32 s10, s10, 2097152
    s_load_dword s29, s[50:51], s10
    s_add_u32 s10, s10, 2097152
    s_load_dword s29, s[50:51], s10
    s_add_u32 s10, s10, 2097152
    s_load_dword s29, s[50:51], s10
    s_add_u32 s10, s10, 2097152
    s_load_dword s29, s[50:51], s10
L_ntls:
    s_mov_b32 s52, s18
    s_mov_b32 s53, s19
    s_mov_b32 s54, 4194304
    s_mov_b32 s55, 0x00020000
    s_mov_b32 s56, s20
    s_mov_b32 s57, s21
    s_mov_b32 s58, 4194304
    s_mov_b32 s59, 0x00020000
    s_mov_b32 s60, s22
    s_mov_b32 s61, s23
    s_mov_b32 s62, 8192
    s_mov_b32 s63, 0x00020000
    s_mov_b32 s64, s50
    s_mov_b32 s65, s51
    s_mov_b32 s66, 4194304
    s_mov_b32 s67, 0x00020000
    s_lshl_b32 s10, s4, 7
    s_lshl_b32 s12, s9, 6
    s_add_u32 s10, s10, s12
    v_and_b32 v60, 7, v2
    v_lshl_add_u32 v4, v60, 3, s10
    v_lshlrev_b32 v60, 1, v4
    v_lshl_add_u32 v5, v23, 11, v60
    v_subrev_u32 v6, 6144, v5
    v_bfrev_b32 v60, 1
    v_cmp_eq_u32 vcc, 0, v23
    s_nop 1
    v_cndmask_b32 v6, v6, v60, vcc
    v_lshlrev_b32 v7, 3, v4
    v_sub_u32 v8, 2040, v23
    v_lshlrev_b32 v8, 1, v8
    v_lshl_add_u32 v8, v4, 12, v8
    v_add_u32 v9, 16384, v8
    s_lshl_b32 s13, s4, 1
    s_add_u32 s13, s13, s9
    s_lshl_b32 s13, s13, 5
    s_add_u32 s13, s13, s5
    s_lshl_b32 s13, s13, 3
    v_mov_b32 v25, 16
    s_getreg_b32 s14, hwreg(HW_REG_XCC_ID, 0, 8)
    s_add_u32 s14, s14, 1
    s_lshl_b32 s14, s14, 20
    s_lshl_b32 s10, s4, 8
    s_add_u32 s10, s10, 4096
    v_and_b32 v14, 31, v2
    v_lshl_add_u32 v14, v14, 3, s10
    s_lshl_b32 s28, s5, 3
    s_add_u32 s28, s28, s10
    s_cmp_eq_u32 s9, 0
    s_cbranch_scc0 L_x1
    s_mov_b32 s15, 0
L_x0_w:
    ds_read_b64 v[60:61], v21 offset:16
    s_waitcnt lgkmcnt(0)
    v_min_u32 v60, v60, v61
    v_cmp_gt_u32 vcc, 1, v60
    s_cbranch_vccz L_x0_ok
    s_sleep 2
    s_add_u32 s15, s15, 1
    s_cmp_lt_u32 s15, 160000
    s_cbranch_scc1 L_x0_w
L_x0_ok:
    buffer_load_dwordx2 v[10:11], v19, s[76:79], 0 offen sc1
    s_waitcnt vmcnt(0)
    s_mov_b32 s12, 0
LX_np:
    v_cmp_eq_u32 vcc, 0, v10
    s_cbranch_vccz LX_nok
    buffer_load_dwordx2 v[10:11], v19, s[76:79], 0 offen sc1
    s_add_u32 s12, s12, 1
    s_waitcnt vmcnt(0)
    s_cmp_lt_u32 s12, 20000
    s_cbranch_scc1 LX_np
LX_nok:
    v_xor_b32 v11, s14, v11
    s_mov_b64 exec, 1
    buffer_store_dwordx2 v[10:11], v19, s[72:75], s28 offen sc1
    s_mov_b64 exec, -1
L_x1:
    s_lshr_b32 s10, s5, 1
    s_lshr_b32 s12, s5, 4
    s_lshl_b32 s12, s12, 1
    s_add_u32 s10, s10, s12
    s_and_b32 s10, s10, 3
    s_mul_i32 s10, s10, 1
    s_mul_i32 s12, s9, 0
    s_add_u32 s10, s10, s12
    s_add_u32 s10, s10, 2
    s_mov_b32 s15, 0
L_i1_w:
    ds_read_b64 v[60:61], v21 offset:16
    s_waitcnt lgkmcnt(0)
    v_min_u32 v60, v60, v61
    v_cmp_gt_u32 vcc, s10, v60
    s_cbranch_vccz L_i1_ok
    s_sleep 2
    s_add_u32 s15, s15, 1
    s_cmp_lt_u32 s15, 160000
    s_cbranch_scc1 L_i1_w
L_i1_ok:
    buffer_load_dwordx4 v[64:67], v7, s[60:63], 0 offen offset:0
    buffer_load_dwordx4 v[68:71], v7, s[60:63], 0 offen offset:16
    buffer_load_dwordx4 v[72:75], v7, s[60:63], 0 offen offset:32
    buffer_load_dwordx4 v[76:79], v7, s[60:63], 0 offen offset:48
    buffer_load_dwordx4 v[92:95], v5, s[52:55], 0 offen offset:0 nt
    buffer_load_dwordx4 v[96:99], v5, s[52:55], 0 offen offset:2048 nt
    buffer_load_dwordx4 v[100:103], v5, s[52:55], s32 offen offset:0 nt
    buffer_load_dwordx4 v[104:107], v5, s[52:55], s32 offen offset:2048 nt
    buffer_load_dwordx4 v[108:111], v5, s[52:55], s33 offen offset:0 nt
    buffer_load_dwordx4 v[112:115], v5, s[52:55], s33 offen offset:2048 nt
    buffer_load_dwordx4 v[116:119], v5, s[52:55], s34 offen offset:0 nt
    buffer_load_dwordx4 v[120:123], v5, s[52:55], s34 offen offset:2048 nt
    buffer_load_dwordx4 v[80:83], v6, s[52:55], 0 offen offset:0 nt
    buffer_load_dwordx4 v[84:87], v6, s[52:55], 0 offen offset:2048 nt
    buffer_load_dwordx4 v[88:91], v6, s[52:55], s32 offen offset:0 nt
    buffer_load_dwordx4 v[124:127], v5, s[56:59], 0 offen offset:0 nt
    buffer_load_dwordx4 v[128:131], v5, s[56:59], 0 offen offset:2048 nt
    buffer_load_dwordx4 v[132:135], v5, s[56:59], s32 offen offset:0 nt
    buffer_load_dwordx4 v[136:139], v5, s[56:59], s32 offen offset:2048 nt
    buffer_load_dwordx4 v[140:143], v5, s[56:59], s33 offen offset:0 nt
    buffer_load_dwordx4 v[144:147], v5, s[56:59], s33 offen offset:2048 nt
    buffer_load_dwordx4 v[148:151], v5, s[56:59], s34 offen offset:0 nt
    buffer_load_dwordx4 v[152:155], v5, s[56:59], s34 offen offset:2048 nt
    s_waitcnt vmcnt(19)
    v_lshlrev_b32 v156, 16, v64
    v_and_b32 v160, 0xffff0000, v64
    v_lshlrev_b32 v164, 16, v65
    v_and_b32 v168, 0xffff0000, v65
    v_lshlrev_b32 v157, 16, v66
    v_and_b32 v161, 0xffff0000, v66
    v_lshlrev_b32 v165, 16, v67
    v_and_b32 v169, 0xffff0000, v67
    v_lshlrev_b32 v158, 16, v68
    v_and_b32 v162, 0xffff0000, v68
    v_lshlrev_b32 v166, 16, v69
    v_and_b32 v170, 0xffff0000, v69
    v_lshlrev_b32 v159, 16, v70
    v_and_b32 v163, 0xffff0000, v70
    v_lshlrev_b32 v167, 16, v71
    v_and_b32 v171, 0xffff0000, v71
    s_waitcnt vmcnt(8)
    v_lshlrev_b32 v172, 16, v80
    v_and_b32 v173, 0xffff0000, v80
    v_lshlrev_b32 v174, 16, v81
    v_and_b32 v175, 0xffff0000, v81
    v_lshlrev_b32 v176, 16, v84
    v_and_b32 v177, 0xffff0000, v84
    v_lshlrev_b32 v178, 16, v85
    v_and_b32 v179, 0xffff0000, v85
    v_lshlrev_b32 v180, 16, v88
    v_and_b32 v181, 0xffff0000, v88
    v_lshlrev_b32 v182, 16, v89
    v_and_b32 v183, 0xffff0000, v89
    v_lshlrev_b32 v184, 16, v92
    v_and_b32 v185, 0xffff0000, v92
    v_lshlrev_b32 v186, 16, v93
    v_and_b32 v187, 0xffff0000, v93
    v_lshlrev_b32 v188, 16, v96
    v_and_b32 v189, 0xffff0000, v96
    v_lshlrev_b32 v190, 16, v97
    v_and_b32 v191, 0xffff0000, v97
    v_lshlrev_b32 v192, 16, v100
    v_and_b32 v193, 0xffff0000, v100
    v_lshlrev_b32 v194, 16, v101
    v_and_b32 v195, 0xffff0000, v101
    v_lshlrev_b32 v196, 16, v104
    v_and_b32 v197, 0xffff0000, v104
    v_lshlrev_b32 v198, 16, v105
    v_and_b32 v199, 0xffff0000, v105
    v_lshlrev_b32 v200, 16, v108
    v_and_b32 v201, 0xffff0000, v108
    v_lshlrev_b32 v202, 16, v109
    v_and_b32 v203, 0xffff0000, v109
    v_lshlrev_b32 v204, 16, v112
    v_and_b32 v205, 0xffff0000, v112
    v_lshlrev_b32 v206, 16, v113
    v_and_b32 v207, 0xffff0000, v113
    v_lshlrev_b32 v208, 16, v116
    v_and_b32 v209, 0xffff0000, v116
    v_lshlrev_b32 v210, 16, v117
    v_and_b32 v211, 0xffff0000, v117
    v_lshlrev_b32 v212, 16, v120
    v_and_b32 v213, 0xffff0000, v120
    v_lshlrev_b32 v214, 16, v121
    v_and_b32 v215, 0xffff0000, v121
    v_mul_f32 v216, v184, v156
    v_mul_f32 v217, v185, v157
    v_mul_f32 v218, v186, v158
    v_mul_f32 v219, v187, v159
    v_mul_f32 v220, v188, v156
    v_mul_f32 v221, v189, v157
    v_mul_f32 v222, v190, v158
    v_mul_f32 v223, v191, v159
    v_mul_f32 v224, v192, v156
    v_mul_f32 v225, v193, v157
    v_mul_f32 v226, v194, v158
    v_mul_f32 v227, v195, v159
    v_mul_f32 v228, v196, v156
    v_mul_f32 v229, v197, v157
    v_mul_f32 v230, v198, v158
    v_mul_f32 v231, v199, v159
    v_mul_f32 v232, v200, v156
    v_mul_f32 v233, v201, v157
    v_mul_f32 v234, v202, v158
    v_mul_f32 v235, v203, v159
    v_mul_f32 v236, v204, v156
    v_mul_f32 v237, v205, v157
    v_mul_f32 v238, v206, v158
    v_mul_f32 v239, v207, v159
    v_mul_f32 v240, v208, v156
    v_mul_f32 v241, v209, v157
    v_mul_f32 v242, v210, v158
    v_mul_f32 v243, v211, v159
    v_mul_f32 v244, v212, v156
    v_mul_f32 v245, v213, v157
    v_mul_f32 v246, v214, v158
    v_mul_f32 v247, v215, v159
    v_fmac_f32 v216, v180, v160
    v_fmac_f32 v217, v181, v161
    v_fmac_f32 v218, v182, v162
    v_fmac_f32 v219, v183, v163
    v_fmac_f32 v220, v184, v160
    v_fmac_f32 v221, v185, v161
    v_fmac_f32 v222, v186, v162
    v_fmac_f32 v223, v187, v163
    v_fmac_f32 v224, v188, v160
    v_fmac_f32 v225, v189, v161
    v_fmac_f32 v226, v190, v162
    v_fmac_f32 v227, v191, v163
    v_fmac_f32 v228, v192, v160
    v_fmac_f32 v229, v193, v161
    v_fmac_f32 v230, v194, v162
    v_fmac_f32 v231, v195, v163
    v_fmac_f32 v232, v196, v160
    v_fmac_f32 v233, v197, v161
    v_fmac_f32 v234, v198, v162
    v_fmac_f32 v235, v199, v163
    v_fmac_f32 v236, v200, v160
    v_fmac_f32 v237, v201, v161
    v_fmac_f32 v238, v202, v162
    v_fmac_f32 v239, v203, v163
    v_fmac_f32 v240, v204, v160
    v_fmac_f32 v241, v205, v161
    v_fmac_f32 v242, v206, v162
    v_fmac_f32 v243, v207, v163
    v_fmac_f32 v244, v208, v160
    v_fmac_f32 v245, v209, v161
    v_fmac_f32 v246, v210, v162
    v_fmac_f32 v247, v211, v163
    v_fmac_f32 v216, v176, v164
    v_fmac_f32 v217, v177, v165
    v_fmac_f32 v218, v178, v166
    v_fmac_f32 v219, v179, v167
    v_fmac_f32 v220, v180, v164
    v_fmac_f32 v221, v181, v165
    v_fmac_f32 v222, v182, v166
    v_fmac_f32 v223, v183, v167
    v_fmac_f32 v224, v184, v164
    v_fmac_f32 v225, v185, v165
    v_fmac_f32 v226, v186, v166
    v_fmac_f32 v227, v187, v167
    v_fmac_f32 v228, v188, v164
    v_fmac_f32 v229, v189, v165
    v_fmac_f32 v230, v190, v166
    v_fmac_f32 v231, v191, v167
    v_fmac_f32 v232, v192, v164
    v_fmac_f32 v233, v193, v165
    v_fmac_f32 v234, v194, v166
    v_fmac_f32 v235, v195, v167
    v_fmac_f32 v236, v196, v164
    v_fmac_f32 v237, v197, v165
    v_fmac_f32 v238, v198, v166
    v_fmac_f32 v239, v199, v167
    v_fmac_f32 v240, v200, v164
    v_fmac_f32 v241, v201, v165
    v_fmac_f32 v242, v202, v166
    v_fmac_f32 v243, v203, v167
    v_fmac_f32 v244, v204, v164
    v_fmac_f32 v245, v205, v165
    v_fmac_f32 v246, v206, v166
    v_fmac_f32 v247, v207, v167
    v_fmac_f32 v216, v172, v168
    v_fmac_f32 v217, v173, v169
    v_fmac_f32 v218, v174, v170
    v_fmac_f32 v219, v175, v171
    v_fmac_f32 v220, v176, v168
    v_fmac_f32 v221, v177, v169
    v_fmac_f32 v222, v178, v170
    v_fmac_f32 v223, v179, v171
    v_fmac_f32 v224, v180, v168
    v_fmac_f32 v225, v181, v169
    v_fmac_f32 v226, v182, v170
    v_fmac_f32 v227, v183, v171
    v_fmac_f32 v228, v184, v168
    v_fmac_f32 v229, v185, v169
    v_fmac_f32 v230, v186, v170
    v_fmac_f32 v231, v187, v171
    v_fmac_f32 v232, v188, v168
    v_fmac_f32 v233, v189, v169
    v_fmac_f32 v234, v190, v170
    v_fmac_f32 v235, v191, v171
    v_fmac_f32 v236, v192, v168
    v_fmac_f32 v237, v193, v169
    v_fmac_f32 v238, v194, v170
    v_fmac_f32 v239, v195, v171
    v_fmac_f32 v240, v196, v168
    v_fmac_f32 v241, v197, v169
    v_fmac_f32 v242, v198, v170
    v_fmac_f32 v243, v199, v171
    v_fmac_f32 v244, v200, v168
    v_fmac_f32 v245, v201, v169
    v_fmac_f32 v246, v202, v170
    v_fmac_f32 v247, v203, v171
    s_mov_b32 s15, 0
L_xl_w:
    ds_read_b64 v[60:61], v21 offset:16
    s_waitcnt lgkmcnt(0)
    v_min_u32 v60, v60, v61
    v_cmp_gt_u32 vcc, 4, v60
    s_cbranch_vccz L_xl_ok
    s_sleep 2
    s_add_u32 s15, s15, 1
    s_cmp_lt_u32 s15, 160000
    s_cbranch_scc1 L_xl_w
L_xl_ok:
    buffer_load_dwordx2 v[58:59], v14, s[72:75], 0 offen sc1
    buffer_load_dwordx2 v[0:1], v19, s[76:79], 0 offen sc1
    s_waitcnt vmcnt(0)
    s_mov_b32 s12, 0
L_np:
    v_cmp_eq_u32 vcc, 0, v0
    s_cbranch_vccz L_nok
    buffer_load_dwordx2 v[0:1], v19, s[76:79], 0 offen sc1
    s_add_u32 s12, s12, 1
    s_waitcnt vmcnt(0)
    s_cmp_lt_u32 s12, 20000
    s_cbranch_scc1 L_np
L_nok:
    ds_write_b64 v21, v[0:1] offset:32
    v_xor_b32 v59, s14, v59
    v_cmp_ne_u64 vcc, v[58:59], v[0:1]
    s_cmp_eq_u64 vcc, 0
    s_cselect_b32 s14, 1, 0
    v_mov_b32 v58, s14
    ds_or_b32 v21, v58 offset:72
    v_lshlrev_b32 v172, 16, v124
    v_and_b32 v173, 0xffff0000, v124
    v_lshlrev_b32 v174, 16, v125
    v_and_b32 v175, 0xffff0000, v125
    v_lshlrev_b32 v176, 16, v128
    v_and_b32 v177, 0xffff0000, v128
    v_lshlrev_b32 v178, 16, v129
    v_and_b32 v179, 0xffff0000, v129
    v_lshlrev_b32 v180, 16, v132
    v_and_b32 v181, 0xffff0000, v132
    v_lshlrev_b32 v182, 16, v133
    v_and_b32 v183, 0xffff0000, v133
    v_lshlrev_b32 v184, 16, v136
    v_and_b32 v185, 0xffff0000, v136
    v_lshlrev_b32 v186, 16, v137
    v_and_b32 v187, 0xffff0000, v137
    v_lshlrev_b32 v188, 16, v140
    v_and_b32 v189, 0xffff0000, v140
    v_lshlrev_b32 v190, 16, v141
    v_and_b32 v191, 0xffff0000, v141
    v_lshlrev_b32 v192, 16, v144
    v_and_b32 v193, 0xffff0000, v144
    v_lshlrev_b32 v194, 16, v145
    v_and_b32 v195, 0xffff0000, v145
    v_lshlrev_b32 v196, 16, v148
    v_and_b32 v197, 0xffff0000, v148
    v_lshlrev_b32 v198, 16, v149
    v_and_b32 v199, 0xffff0000, v149
    v_lshlrev_b32 v200, 16, v152
    v_and_b32 v201, 0xffff0000, v152
    v_lshlrev_b32 v202, 16, v153
    v_and_b32 v203, 0xffff0000, v153
    v_mul_f32 v216, v216, v172
    v_mul_f32 v217, v217, v173
    v_mul_f32 v218, v218, v174
    v_mul_f32 v219, v219, v175
    v_mul_f32 v220, v220, v176
    v_mul_f32 v221, v221, v177
    v_mul_f32 v222, v222, v178
    v_mul_f32 v223, v223, v179
    v_mul_f32 v224, v224, v180
    v_mul_f32 v225, v225, v181
    v_mul_f32 v226, v226, v182
    v_mul_f32 v227, v227, v183
    v_mul_f32 v228, v228, v184
    v_mul_f32 v229, v229, v185
    v_mul_f32 v230, v230, v186
    v_mul_f32 v231, v231, v187
    v_mul_f32 v232, v232, v188
    v_mul_f32 v233, v233, v189
    v_mul_f32 v234, v234, v190
    v_mul_f32 v235, v235, v191
    v_mul_f32 v236, v236, v192
    v_mul_f32 v237, v237, v193
    v_mul_f32 v238, v238, v194
    v_mul_f32 v239, v239, v195
    v_mul_f32 v240, v240, v196
    v_mul_f32 v241, v241, v197
    v_mul_f32 v242, v242, v198
    v_mul_f32 v243, v243, v199
    v_mul_f32 v244, v244, v200
    v_mul_f32 v245, v245, v201
    v_mul_f32 v246, v246, v202
    v_mul_f32 v247, v247, v203
    v_cvt_pk_bf16_f32 v40, v244, v240
    v_cvt_pk_bf16_f32 v41, v236, v232
    v_cvt_pk_bf16_f32 v42, v228, v224
    v_cvt_pk_bf16_f32 v43, v220, v216
    v_cvt_pk_bf16_f32 v44, v245, v241
    v_cvt_pk_bf16_f32 v45, v237, v233
    v_cvt_pk_bf16_f32 v46, v229, v225
    v_cvt_pk_bf16_f32 v47, v221, v217
    v_cvt_pk_bf16_f32 v48, v246, v242
    v_cvt_pk_bf16_f32 v49, v238, v234
    v_cvt_pk_bf16_f32 v50, v230, v226
    v_cvt_pk_bf16_f32 v51, v222, v218
    v_cvt_pk_bf16_f32 v52, v247, v243
    v_cvt_pk_bf16_f32 v53, v239, v235
    v_cvt_pk_bf16_f32 v54, v231, v227
    v_cvt_pk_bf16_f32 v55, v223, v219
    s_cmp_eq_u32 s14, 1
    s_cbranch_scc1 L_xp0
    buffer_store_dwordx4 v[40:43], v8, s[64:67], 0 offen sc1
    buffer_store_dwordx4 v[44:47], v8, s[64:67], s32 offen sc1
    buffer_store_dwordx4 v[48:51], v8, s[64:67], s33 offen sc1
    buffer_store_dwordx4 v[52:55], v8, s[64:67], s34 offen sc1
    s_branch L_xq0
L_xp0:
    buffer_store_dwordx4 v[40:43], v8, s[64:67], 0 offen
    buffer_store_dwordx4 v[44:47], v8, s[64:67], s32 offen
    buffer_store_dwordx4 v[48:51], v8, s[64:67], s33 offen
    buffer_store_dwordx4 v[52:55], v8, s[64:67], s34 offen
L_xq0:
    v_lshlrev_b32 v156, 16, v72
    v_and_b32 v160, 0xffff0000, v72
    v_lshlrev_b32 v164, 16, v73
    v_and_b32 v168, 0xffff0000, v73
    v_lshlrev_b32 v157, 16, v74
    v_and_b32 v161, 0xffff0000, v74
    v_lshlrev_b32 v165, 16, v75
    v_and_b32 v169, 0xffff0000, v75
    v_lshlrev_b32 v158, 16, v76
    v_and_b32 v162, 0xffff0000, v76
    v_lshlrev_b32 v166, 16, v77
    v_and_b32 v170, 0xffff0000, v77
    v_lshlrev_b32 v159, 16, v78
    v_and_b32 v163, 0xffff0000, v78
    v_lshlrev_b32 v167, 16, v79
    v_and_b32 v171, 0xffff0000, v79
    v_lshlrev_b32 v172, 16, v82
    v_and_b32 v173, 0xffff0000, v82
    v_lshlrev_b32 v174, 16, v83
    v_and_b32 v175, 0xffff0000, v83
    v_lshlrev_b32 v176, 16, v86
    v_and_b32 v177, 0xffff0000, v86
    v_lshlrev_b32 v178, 16, v87
    v_and_b32 v179, 0xffff0000, v87
    v_lshlrev_b32 v180, 16, v90
    v_and_b32 v181, 0xffff0000, v90
    v_lshlrev_b32 v182, 16, v91
    v_and_b32 v183, 0xffff0000, v91
    v_lshlrev_b32 v184, 16, v94
    v_and_b32 v185, 0xffff0000, v94
    v_lshlrev_b32 v186, 16, v95
    v_and_b32 v187, 0xffff0000, v95
    v_lshlrev_b32 v188, 16, v98
    v_and_b32 v189, 0xffff0000, v98
    v_lshlrev_b32 v190, 16, v99
    v_and_b32 v191, 0xffff0000, v99
    v_lshlrev_b32 v192, 16, v102
    v_and_b32 v193, 0xffff0000, v102
    v_lshlrev_b32 v194, 16, v103
    v_and_b32 v195, 0xffff0000, v103
    v_lshlrev_b32 v196, 16, v106
    v_and_b32 v197, 0xffff0000, v106
    v_lshlrev_b32 v198, 16, v107
    v_and_b32 v199, 0xffff0000, v107
    v_lshlrev_b32 v200, 16, v110
    v_and_b32 v201, 0xffff0000, v110
    v_lshlrev_b32 v202, 16, v111
    v_and_b32 v203, 0xffff0000, v111
    v_lshlrev_b32 v204, 16, v114
    v_and_b32 v205, 0xffff0000, v114
    v_lshlrev_b32 v206, 16, v115
    v_and_b32 v207, 0xffff0000, v115
    v_lshlrev_b32 v208, 16, v118
    v_and_b32 v209, 0xffff0000, v118
    v_lshlrev_b32 v210, 16, v119
    v_and_b32 v211, 0xffff0000, v119
    v_lshlrev_b32 v212, 16, v122
    v_and_b32 v213, 0xffff0000, v122
    v_lshlrev_b32 v214, 16, v123
    v_and_b32 v215, 0xffff0000, v123
    v_mul_f32 v216, v184, v156
    v_mul_f32 v217, v185, v157
    v_mul_f32 v218, v186, v158
    v_mul_f32 v219, v187, v159
    v_mul_f32 v220, v188, v156
    v_mul_f32 v221, v189, v157
    v_mul_f32 v222, v190, v158
    v_mul_f32 v223, v191, v159
    v_mul_f32 v224, v192, v156
    v_mul_f32 v225, v193, v157
    v_mul_f32 v226, v194, v158
    v_mul_f32 v227, v195, v159
    v_mul_f32 v228, v196, v156
    v_mul_f32 v229, v197, v157
    v_mul_f32 v230, v198, v158
    v_mul_f32 v231, v199, v159
    v_mul_f32 v232, v200, v156
    v_mul_f32 v233, v201, v157
    v_mul_f32 v234, v202, v158
    v_mul_f32 v235, v203, v159
    v_mul_f32 v236, v204, v156
    v_mul_f32 v237, v205, v157
    v_mul_f32 v238, v206, v158
    v_mul_f32 v239, v207, v159
    v_mul_f32 v240, v208, v156
    v_mul_f32 v241, v209, v157
    v_mul_f32 v242, v210, v158
    v_mul_f32 v243, v211, v159
    v_mul_f32 v244, v212, v156
    v_mul_f32 v245, v213, v157
    v_mul_f32 v246, v214, v158
    v_mul_f32 v247, v215, v159
    v_fmac_f32 v216, v180, v160
    v_fmac_f32 v217, v181, v161
    v_fmac_f32 v218, v182, v162
    v_fmac_f32 v219, v183, v163
    v_fmac_f32 v220, v184, v160
    v_fmac_f32 v221, v185, v161
    v_fmac_f32 v222, v186, v162
    v_fmac_f32 v223, v187, v163
    v_fmac_f32 v224, v188, v160
    v_fmac_f32 v225, v189, v161
    v_fmac_f32 v226, v190, v162
    v_fmac_f32 v227, v191, v163
    v_fmac_f32 v228, v192, v160
    v_fmac_f32 v229, v193, v161
    v_fmac_f32 v230, v194, v162
    v_fmac_f32 v231, v195, v163
    v_fmac_f32 v232, v196, v160
    v_fmac_f32 v233, v197, v161
    v_fmac_f32 v234, v198, v162
    v_fmac_f32 v235, v199, v163
    v_fmac_f32 v236, v200, v160
    v_fmac_f32 v237, v201, v161
    v_fmac_f32 v238, v202, v162
    v_fmac_f32 v239, v203, v163
    v_fmac_f32 v240, v204, v160
    v_fmac_f32 v241, v205, v161
    v_fmac_f32 v242, v206, v162
    v_fmac_f32 v243, v207, v163
    v_fmac_f32 v244, v208, v160
    v_fmac_f32 v245, v209, v161
    v_fmac_f32 v246, v210, v162
    v_fmac_f32 v247, v211, v163
    v_fmac_f32 v216, v176, v164
    v_fmac_f32 v217, v177, v165
    v_fmac_f32 v218, v178, v166
    v_fmac_f32 v219, v179, v167
    v_fmac_f32 v220, v180, v164
    v_fmac_f32 v221, v181, v165
    v_fmac_f32 v222, v182, v166
    v_fmac_f32 v223, v183, v167
    v_fmac_f32 v224, v184, v164
    v_fmac_f32 v225, v185, v165
    v_fmac_f32 v226, v186, v166
    v_fmac_f32 v227, v187, v167
    v_fmac_f32 v228, v188, v164
    v_fmac_f32 v229, v189, v165
    v_fmac_f32 v230, v190, v166
    v_fmac_f32 v231, v191, v167
    v_fmac_f32 v232, v192, v164
    v_fmac_f32 v233, v193, v165
    v_fmac_f32 v234, v194, v166
    v_fmac_f32 v235, v195, v167
    v_fmac_f32 v236, v196, v164
    v_fmac_f32 v237, v197, v165
    v_fmac_f32 v238, v198, v166
    v_fmac_f32 v239, v199, v167
    v_fmac_f32 v240, v200, v164
    v_fmac_f32 v241, v201, v165
    v_fmac_f32 v242, v202, v166
    v_fmac_f32 v243, v203, v167
    v_fmac_f32 v244, v204, v164
    v_fmac_f32 v245, v205, v165
    v_fmac_f32 v246, v206, v166
    v_fmac_f32 v247, v207, v167
    v_fmac_f32 v216, v172, v168
    v_fmac_f32 v217, v173, v169
    v_fmac_f32 v218, v174, v170
    v_fmac_f32 v219, v175, v171
    v_fmac_f32 v220, v176, v168
    v_fmac_f32 v221, v177, v169
    v_fmac_f32 v222, v178, v170
    v_fmac_f32 v223, v179, v171
    v_fmac_f32 v224, v180, v168
    v_fmac_f32 v225, v181, v169
    v_fmac_f32 v226, v182, v170
    v_fmac_f32 v227, v183, v171
    v_fmac_f32 v228, v184, v168
    v_fmac_f32 v229, v185, v169
    v_fmac_f32 v230, v186, v170
    v_fmac_f32 v231, v187, v171
    v_fmac_f32 v232, v188, v168
    v_fmac_f32 v233, v189, v169
    v_fmac_f32 v234, v190, v170
    v_fmac_f32 v235, v191, v171
    v_fmac_f32 v236, v192, v168
    v_fmac_f32 v237, v193, v169
    v_fmac_f32 v238, v194, v170
    v_fmac_f32 v239, v195, v171
    v_fmac_f32 v240, v196, v168
    v_fmac_f32 v241, v197, v169
    v_fmac_f32 v242, v198, v170
    v_fmac_f32 v243, v199, v171
    v_fmac_f32 v244, v200, v168
    v_fmac_f32 v245, v201, v169
    v_fmac_f32 v246, v202, v170
    v_fmac_f32 v247, v203, v171
    v_lshlrev_b32 v172, 16, v126
    v_and_b32 v173, 0xffff0000, v126
    v_lshlrev_b32 v174, 16, v127
    v_and_b32 v175, 0xffff0000, v127
    v_lshlrev_b32 v176, 16, v130
    v_and_b32 v177, 0xffff0000, v130
    v_lshlrev_b32 v178, 16, v131
    v_and_b32 v179, 0xffff0000, v131
    v_lshlrev_b32 v180, 16, v134
    v_and_b32 v181, 0xffff0000, v134
    v_lshlrev_b32 v182, 16, v135
    v_and_b32 v183, 0xffff0000, v135
    v_lshlrev_b32 v184, 16, v138
    v_and_b32 v185, 0xffff0000, v138
    v_lshlrev_b32 v186, 16, v139
    v_and_b32 v187, 0xffff0000, v139
    v_lshlrev_b32 v188, 16, v142
    v_and_b32 v189, 0xffff0000, v142
    v_lshlrev_b32 v190, 16, v143
    v_and_b32 v191, 0xffff0000, v143
    v_lshlrev_b32 v192, 16, v146
    v_and_b32 v193, 0xffff0000, v146
    v_lshlrev_b32 v194, 16, v147
    v_and_b32 v195, 0xffff0000, v147
    v_lshlrev_b32 v196, 16, v150
    v_and_b32 v197, 0xffff0000, v150
    v_lshlrev_b32 v198, 16, v151
    v_and_b32 v199, 0xffff0000, v151
    v_lshlrev_b32 v200, 16, v154
    v_and_b32 v201, 0xffff0000, v154
    v_lshlrev_b32 v202, 16, v155
    v_and_b32 v203, 0xffff0000, v155
    v_mul_f32 v216, v216, v172
    v_mul_f32 v217, v217, v173
    v_mul_f32 v218, v218, v174
    v_mul_f32 v219, v219, v175
    v_mul_f32 v220, v220, v176
    v_mul_f32 v221, v221, v177
    v_mul_f32 v222, v222, v178
    v_mul_f32 v223, v223, v179
    v_mul_f32 v224, v224, v180
    v_mul_f32 v225, v225, v181
    v_mul_f32 v226, v226, v182
    v_mul_f32 v227, v227, v183
    v_mul_f32 v228, v228, v184
    v_mul_f32 v229, v229, v185
    v_mul_f32 v230, v230, v186
    v_mul_f32 v231, v231, v187
    v_mul_f32 v232, v232, v188
    v_mul_f32 v233, v233, v189
    v_mul_f32 v234, v234, v190
    v_mul_f32 v235, v235, v191
    v_mul_f32 v236, v236, v192
    v_mul_f32 v237, v237, v193
    v_mul_f32 v238, v238, v194
    v_mul_f32 v239, v239, v195
    v_mul_f32 v240, v240, v196
    v_mul_f32 v241, v241, v197
    v_mul_f32 v242, v242, v198
    v_mul_f32 v243, v243, v199
    v_mul_f32 v244, v244, v200
    v_mul_f32 v245, v245, v201
    v_mul_f32 v246, v246, v202
    v_mul_f32 v247, v247, v203
    v_cvt_pk_bf16_f32 v40, v244, v240
    v_cvt_pk_bf16_f32 v41, v236, v232
    v_cvt_pk_bf16_f32 v42, v228, v224
    v_cvt_pk_bf16_f32 v43, v220, v216
    v_cvt_pk_bf16_f32 v44, v245, v241
    v_cvt_pk_bf16_f32 v45, v237, v233
    v_cvt_pk_bf16_f32 v46, v229, v225
    v_cvt_pk_bf16_f32 v47, v221, v217
    v_cvt_pk_bf16_f32 v48, v246, v242
    v_cvt_pk_bf16_f32 v49, v238, v234
    v_cvt_pk_bf16_f32 v50, v230, v226
    v_cvt_pk_bf16_f32 v51, v222, v218
    v_cvt_pk_bf16_f32 v52, v247, v243
    v_cvt_pk_bf16_f32 v53, v239, v235
    v_cvt_pk_bf16_f32 v54, v231, v227
    v_cvt_pk_bf16_f32 v55, v223, v219
    s_cmp_eq_u32 s14, 1
    s_cbranch_scc1 L_xp1
    buffer_store_dwordx4 v[40:43], v9, s[64:67], 0 offen sc1
    buffer_store_dwordx4 v[44:47], v9, s[64:67], s32 offen sc1
    buffer_store_dwordx4 v[48:51], v9, s[64:67], s33 offen sc1
    buffer_store_dwordx4 v[52:55], v9, s[64:67], s34 offen sc1
    s_branch L_xq1
L_xp1:
    buffer_store_dwordx4 v[40:43], v9, s[64:67], 0 offen
    buffer_store_dwordx4 v[44:47], v9, s[64:67], s32 offen
    buffer_store_dwordx4 v[48:51], v9, s[64:67], s33 offen
    buffer_store_dwordx4 v[52:55], v9, s[64:67], s34 offen
L_xq1:
    s_waitcnt vmcnt(0)
    s_mov_b64 exec, 1
    s_cmp_eq_u32 s14, 1
    s_cbranch_scc0 L_xf0
    buffer_store_dwordx2 v[0:1], v19, s[72:75], s13 offen
    s_branch L_xf1
L_xf0:
    buffer_store_dwordx2 v[0:1], v19, s[72:75], s13 offen sc1
L_xf1:
    s_mov_b64 exec, -1
    s_cmp_eq_u32 s8, 3
    s_cbranch_scc0 L_id2
    s_mov_b32 s15, 0
L_i2_w:
    ds_read_b64 v[60:61], v21 offset:16
    s_waitcnt lgkmcnt(0)
    v_min_u32 v60, v60, v61
    v_cmp_gt_u32 vcc, 14, v60
    s_cbranch_vccz L_i2_ok
    s_sleep 2
    s_add_u32 s15, s15, 1
    s_cmp_lt_u32 s15, 160000
    s_cbranch_scc1 L_i2_w
L_i2_ok:
    s_mov_b32 s15, 0
LK_poll:
    buffer_load_dwordx2 v[60:61], v20, s[72:75], 0 offen sc1
    s_waitcnt vmcnt(0)
    v_cmp_ne_u64 vcc, v[60:61], v[0:1]
    s_cbranch_vccz LK_ok
    s_add_u32 s15, s15, 1
    s_cmp_lt_u32 s15, 20000
    s_cbranch_scc1 LK_poll
LK_ok:
    ds_write_b32 v21, v25 offset:44
L_id2:
    s_mov_b32 s15, 0
L_is1_w:
    ds_read_b32 v60, v21 offset:40
    s_waitcnt lgkmcnt(0)
    v_cmp_gt_u32 vcc, 2, v60
    s_cbranch_vccz L_is1_ok
    s_sleep 2
    s_add_u32 s15, s15, 1
    s_cmp_lt_u32 s15, 160000
    s_cbranch_scc1 L_is1_w
L_is1_ok:
    buffer_load_dwordx4 v[192:195], v26, s[68:71], s36 offen offset:0 nt
    buffer_load_dwordx4 v[196:199], v26, s[68:71], s36 offen offset:1024 nt
    buffer_load_dwordx4 v[200:203], v26, s[68:71], s36 offen offset:2048 nt
    buffer_load_dwordx4 v[204:207], v26, s[68:71], s36 offen offset:3072 nt
L_t2:
    s_mov_b32 s52, s50
    s_mov_b32 s53, s51
    s_mov_b32 s54, 4194304
    s_mov_b32 s55, 0x00020000
    s_mov_b32 s56, s50
    s_mov_b32 s57, s51
    s_mov_b32 s58, 4194304
    s_mov_b32 s59, 0x00020000
    s_mov_b32 s60, s16
    s_mov_b32 s61, s17
    s_mov_b32 s62, 4194304
    s_mov_b32 s63, 0x00020000
    s_mov_b32 s64, s46
    s_mov_b32 s65, s47
    s_mov_b32 s66, 16777216
    s_mov_b32 s67, 0x00020000
    s_mov_b32 s15, 0
L_fk_w:
    ds_read_b32 v60, v21 offset:44
    s_waitcnt lgkmcnt(0)
    v_cmp_gt_u32 vcc, 1, v60
    s_cbranch_vccz L_fk_ok
    s_sleep 1
    s_add_u32 s15, s15, 1
    s_cmp_lt_u32 s15, 160000
    s_cbranch_scc1 L_fk_w
L_fk_ok:
    ds_read_b64 v[0:1], v21 offset:32
    buffer_load_dwordx4 v[224:227], v26, s[52:55], s36 offen offset:0 sc1
    buffer_load_dwordx4 v[228:231], v26, s[52:55], s36 offen offset:1024 sc1
    buffer_load_dwordx4 v[232:235], v26, s[52:55], s36 offen offset:2048 sc1
    buffer_load_dwordx4 v[236:239], v26, s[52:55], s36 offen offset:3072 sc1
    buffer_load_dwordx2 v[4:5], v16, s[60:63], 0 offen offset:0 nt
    buffer_load_dwordx2 v[6:7], v16, s[60:63], 0 offen offset:2048 nt
    s_waitcnt vmcnt(9)
    buffer_load_dwordx2 v[8:9], v16, s[60:63], s32 offen offset:0 nt
    s_waitcnt vmcnt(9)
    buffer_load_dwordx2 v[10:11], v16, s[60:63], s32 offen offset:2048 nt
    s_waitcnt vmcnt(9)
    buffer_load_dwordx2 v[14:15], v16, s[60:63], s33 offen offset:0 nt
    s_waitcnt vmcnt(9)
    buffer_load_dwordx2 v[56:57], v16, s[60:63], s33 offen offset:2048 nt
    s_waitcnt vmcnt(9)
    buffer_load_dwordx2 v[58:59], v16, s[60:63], s34 offen offset:0 nt
    s_waitcnt vmcnt(9)
    buffer_load_dwordx2 v[34:35], v16, s[60:63], s34 offen offset:2048 nt
    s_lshl_b32 s14, s9, 13
    s_lshl_b32 s10, s11, 12
    s_add_u32 s14, s14, s10
    s_mov_b32 s15, 0
L_c1_w:
    ds_read_b128 v[60:63], v21 offset:0
    s_waitcnt lgkmcnt(0)
    v_min3_u32 v60, v60, v61, v62
    v_min_u32 v60, v60, v63
    v_cmp_gt_u32 vcc, 14, v60
    s_cbranch_vccz L_c1_ok
    s_sleep 1
    s_add_u32 s15, s15, 1
    s_cmp_lt_u32 s15, 160000
    s_cbranch_scc1 L_c1_w
L_c1_ok:
    s_waitcnt vmcnt(9)
    s_bfe_u32 s13, s37, 0 + (4 << 16)
    s_lshl_b32 s13, s13, 7
    s_add_u32 m0, s14, 0
    s_nop 0
    buffer_load_dwordx4 v12, s[80:83], s13 offen offset:0 lds
    s_waitcnt vmcnt(9)
    buffer_load_dwordx4 v13, s[80:83], s13 offen offset:1024 lds
    s_waitcnt vmcnt(9)
    buffer_load_dwordx4 v12, s[80:83], s13 offen offset:2048 lds
    s_waitcnt vmcnt(9)
    buffer_load_dwordx4 v13, s[80:83], s13 offen offset:3072 lds
    s_waitcnt vmcnt(9)
    s_bfe_u32 s13, s37, 4 + (4 << 16)
    s_lshl_b32 s13, s13, 7
    s_add_u32 m0, s14, 16384
    s_nop 0
    buffer_load_dwordx4 v12, s[80:83], s13 offen offset:0 lds
    s_waitcnt vmcnt(9)
    buffer_load_dwordx4 v13, s[80:83], s13 offen offset:1024 lds
    s_waitcnt vmcnt(9)
    buffer_load_dwordx4 v12, s[80:83], s13 offen offset:2048 lds
    s_waitcnt vmcnt(9)
    buffer_load_dwordx4 v13, s[80:83], s13 offen offset:3072 lds
    s_waitcnt vmcnt(9)
    s_bfe_u32 s13, s37, 8 + (4 << 16)
    s_lshl_b32 s13, s13, 7
    s_add_u32 m0, s14, 32768
    s_nop 0
    buffer_load_dwordx4 v12, s[80:83], s13 offen offset:0 lds
    s_waitcnt vmcnt(9)
    buffer_load_dwordx4 v13, s[80:83], s13 offen offset:1024 lds
    s_waitcnt vmcnt(9)
    buffer_load_dwordx4 v12, s[80:83], s13 offen offset:2048 lds
    s_waitcnt vmcnt(9)
    buffer_load_dwordx4 v13, s[80:83], s13 offen offset:3072 lds
    s_bitcmp1_b32 s100, 0
    s_cselect_b32 s10, 16, 0
    s_lshr_b32 s31, s31, s10
    s_and_b32 s31, s31, 0xffff
    v_lshlrev_b32 v60, 3, v27
    v_sub_u32 v60, v60, v17
    v_add_u32 v60, -9, v60
    v_and_b32 v61, 1, v60
    v_lshlrev_b32 v61, 4, v61
    v_lshlrev_b32 v61, v61, s31
    v_ashrrev_i32 v60, 1, v60
    v_cmp_eq_u32 vcc, 0, v60
    s_nop 1
    v_cndmask_b32 v36, 0, v61, vcc
    v_cmp_eq_u32 vcc, 1, v60
    s_nop 1
    v_cndmask_b32 v37, 0, v61, vcc
    v_cmp_eq_u32 vcc, 2, v60
    s_nop 1
    v_cndmask_b32 v38, 0, v61, vcc
    v_cmp_eq_u32 vcc, 3, v60
    s_nop 1
    v_cndmask_b32 v39, 0, v61, vcc
    v_mov_b32 v128, 0
    v_mov_b32 v129, 0
    v_mov_b32 v130, 0
    v_mov_b32 v131, 0
    v_and_b32 v60, 1, v27
    v_lshlrev_b32 v60, 9, v60
    v_lshl_add_u32 v60, v17, 5, v60
    v_lshrrev_b32 v61, 1, v27
    v_lshl_add_u32 v17, v61, 4, v60
    v_and_b32 v60, 1, v2
    v_lshrrev_b32 v61, 5, v2
    v_lshl_add_u32 v60, v60, 1, v61
    v_bfe_u32 v61, v2, 1, 4
    v_lshl_add_u32 v60, v60, 4, v61
    v_lshlrev_b32 v17, 2, v60
    s_waitcnt vmcnt(24)
    v_mov_b32 v208, 0
    v_alignbit_b32 v209, v193, v192, 16
    v_alignbit_b32 v210, v194, v193, 16
    v_alignbit_b32 v211, v195, v194, 16
    s_nop 0
    v_mov_b32_dpp v208, v195 wave_shr:1 row_mask:0xf bank_mask:0xf
    v_alignbit_b32 v208, v192, v208, 16
    v_readlane_b32 s10, v195, 63
    v_alignbit_b32 v213, v197, v196, 16
    v_alignbit_b32 v214, v198, v197, 16
    v_mov_b32 v212, s10
    v_alignbit_b32 v215, v199, v198, 16
    s_nop 0
    v_mov_b32_dpp v212, v199 wave_shr:1 row_mask:0xf bank_mask:0xf
    v_alignbit_b32 v212, v196, v212, 16
    v_readlane_b32 s10, v199, 63
    v_alignbit_b32 v217, v201, v200, 16
    v_alignbit_b32 v218, v202, v201, 16
    v_mov_b32 v216, s10
    v_alignbit_b32 v219, v203, v202, 16
    s_nop 0
    v_mov_b32_dpp v216, v203 wave_shr:1 row_mask:0xf bank_mask:0xf
    v_alignbit_b32 v216, v200, v216, 16
    v_readlane_b32 s10, v203, 63
    v_alignbit_b32 v221, v205, v204, 16
    v_alignbit_b32 v222, v206, v205, 16
    v_mov_b32 v220, s10
    v_alignbit_b32 v223, v207, v206, 16
    s_nop 0
    v_mov_b32_dpp v220, v207 wave_shr:1 row_mask:0xf bank_mask:0xf
    v_alignbit_b32 v220, v204, v220, 16
    s_mov_b32 s15, 0
L_c2_w:
    ds_read_b128 v[60:63], v21 offset:0
    s_waitcnt lgkmcnt(0)
    v_min3_u32 v60, v60, v61, v62
    v_min_u32 v60, v60, v63
    v_cmp_gt_u32 vcc, 16, v60
    s_cbranch_vccz L_c2_ok
    s_sleep 1
    s_add_u32 s15, s15, 1
    s_cmp_lt_u32 s15, 160000
    s_cbranch_scc1 L_c2_w
L_c2_ok:
    s_setprio 0
    ds_write_b128 v18, v[128:131]
    v_add_u32 v62, -8288, v33
    ds_write_b128 v62, v[192:195] offset:0
    ds_write_b128 v62, v[196:199] offset:1024
    ds_write_b128 v62, v[200:203] offset:2048
    ds_write_b128 v62, v[204:207] offset:3072
    ds_write_b128 v62, v[208:211] offset:4160
    ds_write_b128 v62, v[212:215] offset:5184
    ds_write_b128 v62, v[216:219] offset:6208
    ds_write_b128 v62, v[220:223] offset:7232
    ds_read2_b32 v[128:129], v28 offset0:0 offset1:1
    ds_read2_b32 v[130:131], v28 offset0:2 offset1:3
    ds_read2_b32 v[132:133], v28 offset0:128 offset1:129
    ds_read2_b32 v[134:135], v28 offset0:130 offset1:131
    ds_read2_b32 v[136:137], v29 offset0:0 offset1:1
    ds_read2_b32 v[138:139], v29 offset0:2 offset1:3
    ds_read2_b32 v[140:141], v29 offset0:128 offset1:129
    ds_read2_b32 v[142:143], v29 offset0:130 offset1:131
    ds_read2_b32 v[144:145], v30 offset0:0 offset1:1
    ds_read2_b32 v[146:147], v30 offset0:2 offset1:3
    ds_read2_b32 v[148:149], v30 offset0:128 offset1:129
    ds_read2_b32 v[150:151], v30 offset0:130 offset1:131
    ds_read2_b32 v[152:153], v31 offset0:0 offset1:1
    ds_read2_b32 v[154:155], v31 offset0:2 offset1:3
    ds_read2_b32 v[156:157], v31 offset0:128 offset1:129
    ds_read2_b32 v[158:159], v31 offset0:130 offset1:131
    s_waitcnt vmcnt(23)
    ds_write_b128 v33, v[224:227] offset:0
    s_waitcnt vmcnt(22)
    ds_write_b128 v33, v[228:231] offset:1024
    s_waitcnt vmcnt(21)
    ds_write_b128 v33, v[232:235] offset:2048
    s_waitcnt vmcnt(20)
    ds_write_b128 v33, v[236:239] offset:3072
    ds_read_b128 v[160:163], v32 offset:3584
    ds_read_b128 v[164:167], v32 offset:3072
    ds_read_b128 v[168:171], v32 offset:2560
    ds_read_b128 v[172:175], v32 offset:2048
    ds_read_b128 v[176:179], v32 offset:1536
    ds_read_b128 v[180:183], v32 offset:1024
    ds_read_b128 v[184:187], v32 offset:512
    ds_read_b128 v[188:191], v32 offset:0
    s_setprio 2
    s_waitcnt lgkmcnt(0)
    v_mfma_f32_16x16x32_bf16 v[96:99], v[36:39], v[160:163], 0
    v_mfma_f32_16x16x32_bf16 v[100:103], v[36:39], v[164:167], 0
    v_mfma_f32_16x16x32_bf16 v[104:107], v[36:39], v[168:171], 0
    v_mfma_f32_16x16x32_bf16 v[108:111], v[36:39], v[172:175], 0
    v_mfma_f32_16x16x32_bf16 v[112:115], v[36:39], v[176:179], 0
    v_mfma_f32_16x16x32_bf16 v[116:119], v[36:39], v[180:183], 0
    v_mfma_f32_16x16x32_bf16 v[120:123], v[36:39], v[184:187], 0
    v_mfma_f32_16x16x32_bf16 v[124:127], v[36:39], v[188:191], 0
    v_mfma_f32_16x16x32_bf16 v[96:99], v[128:131], v[160:163], v[96:99]
    ds_read2_b32 v[192:193], v28 offset0:16 offset1:17
    s_bfe_u32 s13, s37, 12 + (4 << 16)
    s_lshl_b32 s13, s13, 7
    s_add_u32 m0, s14, 49152
    s_nop 0
    buffer_load_dwordx4 v12, s[80:83], s13 offen offset:0 lds
    v_mfma_f32_16x16x32_bf16 v[100:103], v[128:131], v[164:167], v[100:103]
    ds_read2_b32 v[194:195], v28 offset0:18 offset1:19
    v_mfma_f32_16x16x32_bf16 v[104:107], v[128:131], v[168:171], v[104:107]
    ds_read_b128 v[224:227], v32 offset:3648
    v_mfma_f32_16x16x32_bf16 v[108:111], v[128:131], v[172:175], v[108:111]
    ds_read2_b32 v[196:197], v28 offset0:144 offset1:145
    v_mfma_f32_16x16x32_bf16 v[112:115], v[128:131], v[176:179], v[112:115]
    ds_read2_b32 v[198:199], v28 offset0:146 offset1:147
    v_mfma_f32_16x16x32_bf16 v[116:119], v[128:131], v[180:183], v[116:119]
    ds_read_b128 v[228:231], v32 offset:3136
    v_mfma_f32_16x16x32_bf16 v[120:123], v[128:131], v[184:187], v[120:123]
    ds_read2_b32 v[200:201], v29 offset0:16 offset1:17
    v_mfma_f32_16x16x32_bf16 v[124:127], v[128:131], v[188:191], v[124:127]
    ds_read2_b32 v[202:203], v29 offset0:18 offset1:19
    v_mfma_f32_16x16x32_bf16 v[100:103], v[132:135], v[160:163], v[100:103]
    ds_read_b128 v[232:235], v32 offset:2624
    buffer_load_dwordx4 v13, s[80:83], s13 offen offset:1024 lds
    v_mfma_f32_16x16x32_bf16 v[104:107], v[132:135], v[164:167], v[104:107]
    ds_read2_b32 v[204:205], v29 offset0:144 offset1:145
    v_mfma_f32_16x16x32_bf16 v[108:111], v[132:135], v[168:171], v[108:111]
    ds_read2_b32 v[206:207], v29 offset0:146 offset1:147
    v_mfma_f32_16x16x32_bf16 v[112:115], v[132:135], v[172:175], v[112:115]
    ds_read_b128 v[236:239], v32 offset:2112
    v_mfma_f32_16x16x32_bf16 v[116:119], v[132:135], v[176:179], v[116:119]
    ds_read2_b32 v[208:209], v30 offset0:16 offset1:17
    v_mfma_f32_16x16x32_bf16 v[120:123], v[132:135], v[180:183], v[120:123]
    ds_read2_b32 v[210:211], v30 offset0:18 offset1:19
    v_mfma_f32_16x16x32_bf16 v[124:127], v[132:135], v[184:187], v[124:127]
    ds_read_b128 v[240:243], v32 offset:1600
    v_mfma_f32_16x16x32_bf16 v[104:107], v[136:139], v[160:163], v[104:107]
    ds_read2_b32 v[212:213], v30 offset0:144 offset1:145
    v_mfma_f32_16x16x32_bf16 v[108:111], v[136:139], v[164:167], v[108:111]
    ds_read2_b32 v[214:215], v30 offset0:146 offset1:147
    buffer_load_dwordx4 v12, s[80:83], s13 offen offset:2048 lds
    v_mfma_f32_16x16x32_bf16 v[112:115], v[136:139], v[168:171], v[112:115]
    ds_read_b128 v[244:247], v32 offset:1088
    v_mfma_f32_16x16x32_bf16 v[116:119], v[136:139], v[172:175], v[116:119]
    ds_read2_b32 v[216:217], v31 offset0:16 offset1:17
    v_mfma_f32_16x16x32_bf16 v[120:123], v[136:139], v[176:179], v[120:123]
    ds_read2_b32 v[218:219], v31 offset0:18 offset1:19
    v_mfma_f32_16x16x32_bf16 v[124:127], v[136:139], v[180:183], v[124:127]
    ds_read_b128 v[248:251], v32 offset:576
    v_mfma_f32_16x16x32_bf16 v[108:111], v[140:143], v[160:163], v[108:111]
    ds_read2_b32 v[220:221], v31 offset0:144 offset1:145
    v_mfma_f32_16x16x32_bf16 v[112:115], v[140:143], v[164:167], v[112:115]
    ds_read2_b32 v[222:223], v31 offset0:146 offset1:147
    v_mfma_f32_16x16x32_bf16 v[116:119], v[140:143], v[168:171], v[116:119]
    ds_read_b128 v[252:255], v32 offset:64
    v_mfma_f32_16x16x32_bf16 v[120:123], v[140:143], v[172:175], v[120:123]
    buffer_load_dwordx4 v13, s[80:83], s13 offen offset:3072 lds
    v_mfma_f32_16x16x32_bf16 v[124:127], v[140:143], v[176:179], v[124:127]
    v_mfma_f32_16x16x32_bf16 v[112:115], v[144:147], v[160:163], v[112:115]
    v_mfma_f32_16x16x32_bf16 v[116:119], v[144:147], v[164:167], v[116:119]
    v_mfma_f32_16x16x32_bf16 v[120:123], v[144:147], v[168:171], v[120:123]
    v_mfma_f32_16x16x32_bf16 v[124:127], v[144:147], v[172:175], v[124:127]
    v_mfma_f32_16x16x32_bf16 v[116:119], v[148:151], v[160:163], v[116:119]
    v_mfma_f32_16x16x32_bf16 v[120:123], v[148:151], v[164:167], v[120:123]
    v_mfma_f32_16x16x32_bf16 v[124:127], v[148:151], v[168:171], v[124:127]
    s_bfe_u32 s13, s30, 28 + (4 << 16)
    s_lshl_b32 s13, s13, 7
    buffer_load_dwordx4 v[40:43], v12, s[80:83], s13 offen offset:0
    v_mfma_f32_16x16x32_bf16 v[120:123], v[152:155], v[160:163], v[120:123]
    v_mfma_f32_16x16x32_bf16 v[124:127], v[152:155], v[164:167], v[124:127]
    v_mfma_f32_16x16x32_bf16 v[124:127], v[156:159], v[160:163], v[124:127]
    s_waitcnt lgkmcnt(0)
    v_mfma_f32_16x16x32_bf16 v[96:99], v[192:195], v[224:227], v[96:99]
    ds_read2_b32 v[128:129], v28 offset0:32 offset1:33
    v_mfma_f32_16x16x32_bf16 v[100:103], v[192:195], v[228:231], v[100:103]
    ds_read2_b32 v[130:131], v28 offset0:34 offset1:35
    v_mfma_f32_16x16x32_bf16 v[104:107], v[192:195], v[232:235], v[104:107]
    ds_read_b128 v[160:163], v32 offset:3712
    v_mfma_f32_16x16x32_bf16 v[108:111], v[192:195], v[236:239], v[108:111]
    ds_read2_b32 v[132:133], v28 offset0:160 offset1:161
    v_mfma_f32_16x16x32_bf16 v[112:115], v[192:195], v[240:243], v[112:115]
    ds_read2_b32 v[134:135], v28 offset0:162 offset1:163
    buffer_load_dwordx4 v[44:47], v13, s[80:83], s13 offen offset:1024
    v_mfma_f32_16x16x32_bf16 v[116:119], v[192:195], v[244:247], v[116:119]
    ds_read_b128 v[164:167], v32 offset:3200
    v_mfma_f32_16x16x32_bf16 v[120:123], v[192:195], v[248:251], v[120:123]
    ds_read2_b32 v[136:137], v29 offset0:32 offset1:33
    v_mfma_f32_16x16x32_bf16 v[124:127], v[192:195], v[252:255], v[124:127]
    ds_read2_b32 v[138:139], v29 offset0:34 offset1:35
    v_mfma_f32_16x16x32_bf16 v[100:103], v[196:199], v[224:227], v[100:103]
    ds_read_b128 v[168:171], v32 offset:2688
    v_mfma_f32_16x16x32_bf16 v[104:107], v[196:199], v[228:231], v[104:107]
    ds_read2_b32 v[140:141], v29 offset0:160 offset1:161
    v_mfma_f32_16x16x32_bf16 v[108:111], v[196:199], v[232:235], v[108:111]
    ds_read2_b32 v[142:143], v29 offset0:162 offset1:163
    v_mfma_f32_16x16x32_bf16 v[112:115], v[196:199], v[236:239], v[112:115]
    ds_read_b128 v[172:175], v32 offset:2176
    v_mfma_f32_16x16x32_bf16 v[116:119], v[196:199], v[240:243], v[116:119]
    ds_read2_b32 v[144:145], v30 offset0:32 offset1:33
    buffer_load_dwordx4 v[48:51], v12, s[80:83], s13 offen offset:2048
    v_mfma_f32_16x16x32_bf16 v[120:123], v[196:199], v[244:247], v[120:123]
    ds_read2_b32 v[146:147], v30 offset0:34 offset1:35
    v_mfma_f32_16x16x32_bf16 v[124:127], v[196:199], v[248:251], v[124:127]
    ds_read_b128 v[176:179], v32 offset:1664
    v_mfma_f32_16x16x32_bf16 v[104:107], v[200:203], v[224:227], v[104:107]
    ds_read2_b32 v[148:149], v30 offset0:160 offset1:161
    v_mfma_f32_16x16x32_bf16 v[108:111], v[200:203], v[228:231], v[108:111]
    ds_read2_b32 v[150:151], v30 offset0:162 offset1:163
    v_mfma_f32_16x16x32_bf16 v[112:115], v[200:203], v[232:235], v[112:115]
    ds_read_b128 v[180:183], v32 offset:1152
    v_mfma_f32_16x16x32_bf16 v[116:119], v[200:203], v[236:239], v[116:119]
    ds_read2_b32 v[152:153], v31 offset0:32 offset1:33
    v_mfma_f32_16x16x32_bf16 v[120:123], v[200:203], v[240:243], v[120:123]
    ds_read2_b32 v[154:155], v31 offset0:34 offset1:35
    v_mfma_f32_16x16x32_bf16 v[124:127], v[200:203], v[244:247], v[124:127]
    ds_read_b128 v[184:187], v32 offset:640
    buffer_load_dwordx4 v[52:55], v13, s[80:83], s13 offen offset:3072
    v_mfma_f32_16x16x32_bf16 v[108:111], v[204:207], v[224:227], v[108:111]
    ds_read2_b32 v[156:157], v31 offset0:160 offset1:161
    v_mfma_f32_16x16x32_bf16 v[112:115], v[204:207], v[228:231], v[112:115]
    ds_read2_b32 v[158:159], v31 offset0:162 offset1:163
    v_mfma_f32_16x16x32_bf16 v[116:119], v[204:207], v[232:235], v[116:119]
    ds_read_b128 v[188:191], v32 offset:128
    v_mfma_f32_16x16x32_bf16 v[120:123], v[204:207], v[236:239], v[120:123]
    v_mfma_f32_16x16x32_bf16 v[124:127], v[204:207], v[240:243], v[124:127]
    v_mfma_f32_16x16x32_bf16 v[112:115], v[208:211], v[224:227], v[112:115]
    v_mfma_f32_16x16x32_bf16 v[116:119], v[208:211], v[228:231], v[116:119]
    v_mfma_f32_16x16x32_bf16 v[120:123], v[208:211], v[232:235], v[120:123]
    s_bfe_u32 s13, s30, 24 + (4 << 16)
    s_lshl_b32 s13, s13, 7
    buffer_load_dwordx4 v[80:83], v12, s[80:83], s13 offen offset:0
    v_mfma_f32_16x16x32_bf16 v[124:127], v[208:211], v[236:239], v[124:127]
    v_mfma_f32_16x16x32_bf16 v[116:119], v[212:215], v[224:227], v[116:119]
    v_mfma_f32_16x16x32_bf16 v[120:123], v[212:215], v[228:231], v[120:123]
    v_mfma_f32_16x16x32_bf16 v[124:127], v[212:215], v[232:235], v[124:127]
    v_mfma_f32_16x16x32_bf16 v[120:123], v[216:219], v[224:227], v[120:123]
    v_mfma_f32_16x16x32_bf16 v[124:127], v[216:219], v[228:231], v[124:127]
    v_mfma_f32_16x16x32_bf16 v[124:127], v[220:223], v[224:227], v[124:127]
    s_waitcnt lgkmcnt(0)
    v_mfma_f32_16x16x32_bf16 v[96:99], v[128:131], v[160:163], v[96:99]
    ds_read2_b32 v[192:193], v28 offset0:48 offset1:49
    buffer_load_dwordx4 v[84:87], v13, s[80:83], s13 offen offset:1024
    v_mfma_f32_16x16x32_bf16 v[100:103], v[128:131], v[164:167], v[100:103]
    ds_read2_b32 v[194:195], v28 offset0:50 offset1:51
    v_mfma_f32_16x16x32_bf16 v[104:107], v[128:131], v[168:171], v[104:107]
    ds_read_b128 v[224:227], v32 offset:3776
    v_mfma_f32_16x16x32_bf16 v[108:111], v[128:131], v[172:175], v[108:111]
    ds_read2_b32 v[196:197], v28 offset0:176 offset1:177
    v_mfma_f32_16x16x32_bf16 v[112:115], v[128:131], v[176:179], v[112:115]
    ds_read2_b32 v[198:199], v28 offset0:178 offset1:179
    v_mfma_f32_16x16x32_bf16 v[116:119], v[128:131], v[180:183], v[116:119]
    ds_read_b128 v[228:231], v32 offset:3264
    v_mfma_f32_16x16x32_bf16 v[120:123], v[128:131], v[184:187], v[120:123]
    ds_read2_b32 v[200:201], v29 offset0:48 offset1:49
    v_mfma_f32_16x16x32_bf16 v[124:127], v[128:131], v[188:191], v[124:127]
    ds_read2_b32 v[202:203], v29 offset0:50 offset1:51
    v_mfma_f32_16x16x32_bf16 v[100:103], v[132:135], v[160:163], v[100:103]
    ds_read_b128 v[232:235], v32 offset:2752
    buffer_load_dwordx4 v[88:91], v12, s[80:83], s13 offen offset:2048
    v_mfma_f32_16x16x32_bf16 v[104:107], v[132:135], v[164:167], v[104:107]
    ds_read2_b32 v[204:205], v29 offset0:176 offset1:177
    v_mfma_f32_16x16x32_bf16 v[108:111], v[132:135], v[168:171], v[108:111]
    ds_read2_b32 v[206:207], v29 offset0:178 offset1:179
    v_mfma_f32_16x16x32_bf16 v[112:115], v[132:135], v[172:175], v[112:115]
    ds_read_b128 v[236:239], v32 offset:2240
    v_mfma_f32_16x16x32_bf16 v[116:119], v[132:135], v[176:179], v[116:119]
    ds_read2_b32 v[208:209], v30 offset0:48 offset1:49
    v_mfma_f32_16x16x32_bf16 v[120:123], v[132:135], v[180:183], v[120:123]
    ds_read2_b32 v[210:211], v30 offset0:50 offset1:51
    v_mfma_f32_16x16x32_bf16 v[124:127], v[132:135], v[184:187], v[124:127]
    ds_read_b128 v[240:243], v32 offset:1728
    v_mfma_f32_16x16x32_bf16 v[104:107], v[136:139], v[160:163], v[104:107]
    ds_read2_b32 v[212:213], v30 offset0:176 offset1:177
    v_mfma_f32_16x16x32_bf16 v[108:111], v[136:139], v[164:167], v[108:111]
    ds_read2_b32 v[214:215], v30 offset0:178 offset1:179
    buffer_load_dwordx4 v[92:95], v13, s[80:83], s13 offen offset:3072
    v_mfma_f32_16x16x32_bf16 v[112:115], v[136:139], v[168:171], v[112:115]
    ds_read_b128 v[244:247], v32 offset:1216
    v_mfma_f32_16x16x32_bf16 v[116:119], v[136:139], v[172:175], v[116:119]
    ds_read2_b32 v[216:217], v31 offset0:48 offset1:49
    v_mfma_f32_16x16x32_bf16 v[120:123], v[136:139], v[176:179], v[120:123]
    ds_read2_b32 v[218:219], v31 offset0:50 offset1:51
    v_mfma_f32_16x16x32_bf16 v[124:127], v[136:139], v[180:183], v[124:127]
    ds_read_b128 v[248:251], v32 offset:704
    v_mfma_f32_16x16x32_bf16 v[108:111], v[140:143], v[160:163], v[108:111]
    ds_read2_b32 v[220:221], v31 offset0:176 offset1:177
    v_mfma_f32_16x16x32_bf16 v[112:115], v[140:143], v[164:167], v[112:115]
    ds_read2_b32 v[222:223], v31 offset0:178 offset1:179
    v_mfma_f32_16x16x32_bf16 v[116:119], v[140:143], v[168:171], v[116:119]
    ds_read_b128 v[252:255], v32 offset:192
    v_mfma_f32_16x16x32_bf16 v[120:123], v[140:143], v[172:175], v[120:123]
    s_bfe_u32 s13, s30, 20 + (4 << 16)
    s_lshl_b32 s13, s13, 7
    buffer_load_dwordx4 v[64:67], v12, s[80:83], s13 offen offset:0
    v_mfma_f32_16x16x32_bf16 v[124:127], v[140:143], v[176:179], v[124:127]
    v_mfma_f32_16x16x32_bf16 v[112:115], v[144:147], v[160:163], v[112:115]
    v_mfma_f32_16x16x32_bf16 v[116:119], v[144:147], v[164:167], v[116:119]
    v_mfma_f32_16x16x32_bf16 v[120:123], v[144:147], v[168:171], v[120:123]
    v_mfma_f32_16x16x32_bf16 v[124:127], v[144:147], v[172:175], v[124:127]
    v_mfma_f32_16x16x32_bf16 v[116:119], v[148:151], v[160:163], v[116:119]
    s_waitcnt vmcnt(9)
    v_mov_b32 v60, 1
    s_mov_b64 exec, 1
    ds_add_u32 v21, v60 offset:60
    s_mov_b64 exec, -1
    v_mfma_f32_16x16x32_bf16 v[120:123], v[148:151], v[164:167], v[120:123]
    v_mfma_f32_16x16x32_bf16 v[124:127], v[148:151], v[168:171], v[124:127]
    buffer_load_dwordx4 v[68:71], v13, s[80:83], s13 offen offset:1024
    v_mfma_f32_16x16x32_bf16 v[120:123], v[152:155], v[160:163], v[120:123]
    v_mfma_f32_16x16x32_bf16 v[124:127], v[152:155], v[164:167], v[124:127]
    v_mfma_f32_16x16x32_bf16 v[124:127], v[156:159], v[160:163], v[124:127]
    s_waitcnt lgkmcnt(0)
    v_mfma_f32_16x16x32_bf16 v[96:99], v[192:195], v[224:227], v[96:99]
    ds_read2_b32 v[128:129], v28 offset0:64 offset1:65
    v_mfma_f32_16x16x32_bf16 v[100:103], v[192:195], v[228:231], v[100:103]
    ds_read2_b32 v[130:131], v28 offset0:66 offset1:67
    v_mfma_f32_16x16x32_bf16 v[104:107], v[192:195], v[232:235], v[104:107]
    ds_read_b128 v[160:163], v32 offset:3840
    v_mfma_f32_16x16x32_bf16 v[108:111], v[192:195], v[236:239], v[108:111]
    ds_read2_b32 v[132:133], v28 offset0:192 offset1:193
    v_mfma_f32_16x16x32_bf16 v[112:115], v[192:195], v[240:243], v[112:115]
    ds_read2_b32 v[134:135], v28 offset0:194 offset1:195
    buffer_load_dwordx4 v[72:75], v12, s[80:83], s13 offen offset:2048
    v_mfma_f32_16x16x32_bf16 v[116:119], v[192:195], v[244:247], v[116:119]
    ds_read_b128 v[164:167], v32 offset:3328
    v_mfma_f32_16x16x32_bf16 v[120:123], v[192:195], v[248:251], v[120:123]
    ds_read2_b32 v[136:137], v29 offset0:64 offset1:65
    v_mfma_f32_16x16x32_bf16 v[124:127], v[192:195], v[252:255], v[124:127]
    ds_read2_b32 v[138:139], v29 offset0:66 offset1:67
    v_mfma_f32_16x16x32_bf16 v[100:103], v[196:199], v[224:227], v[100:103]
    ds_read_b128 v[168:171], v32 offset:2816
    v_mfma_f32_16x16x32_bf16 v[104:107], v[196:199], v[228:231], v[104:107]
    ds_read2_b32 v[140:141], v29 offset0:192 offset1:193
    v_mfma_f32_16x16x32_bf16 v[108:111], v[196:199], v[232:235], v[108:111]
    ds_read2_b32 v[142:143], v29 offset0:194 offset1:195
    v_mfma_f32_16x16x32_bf16 v[112:115], v[196:199], v[236:239], v[112:115]
    ds_read_b128 v[172:175], v32 offset:2304
    v_mfma_f32_16x16x32_bf16 v[116:119], v[196:199], v[240:243], v[116:119]
    ds_read2_b32 v[144:145], v30 offset0:64 offset1:65
    buffer_load_dwordx4 v[76:79], v13, s[80:83], s13 offen offset:3072
    v_mfma_f32_16x16x32_bf16 v[120:123], v[196:199], v[244:247], v[120:123]
    ds_read2_b32 v[146:147], v30 offset0:66 offset1:67
    v_mfma_f32_16x16x32_bf16 v[124:127], v[196:199], v[248:251], v[124:127]
    ds_read_b128 v[176:179], v32 offset:1792
    v_mfma_f32_16x16x32_bf16 v[104:107], v[200:203], v[224:227], v[104:107]
    ds_read2_b32 v[148:149], v30 offset0:192 offset1:193
    v_mfma_f32_16x16x32_bf16 v[108:111], v[200:203], v[228:231], v[108:111]
    ds_read2_b32 v[150:151], v30 offset0:194 offset1:195
    v_mfma_f32_16x16x32_bf16 v[112:115], v[200:203], v[232:235], v[112:115]
    ds_read_b128 v[180:183], v32 offset:1280
    v_mfma_f32_16x16x32_bf16 v[116:119], v[200:203], v[236:239], v[116:119]
    ds_read2_b32 v[152:153], v31 offset0:64 offset1:65
    v_mfma_f32_16x16x32_bf16 v[120:123], v[200:203], v[240:243], v[120:123]
    ds_read2_b32 v[154:155], v31 offset0:66 offset1:67
    v_mfma_f32_16x16x32_bf16 v[124:127], v[200:203], v[244:247], v[124:127]
    ds_read_b128 v[184:187], v32 offset:768
    v_mfma_f32_16x16x32_bf16 v[108:111], v[204:207], v[224:227], v[108:111]
    ds_read2_b32 v[156:157], v31 offset0:192 offset1:193
    v_mfma_f32_16x16x32_bf16 v[112:115], v[204:207], v[228:231], v[112:115]
    ds_read2_b32 v[158:159], v31 offset0:194 offset1:195
    v_mfma_f32_16x16x32_bf16 v[116:119], v[204:207], v[232:235], v[116:119]
    ds_read_b128 v[188:191], v32 offset:256
    v_mfma_f32_16x16x32_bf16 v[120:123], v[204:207], v[236:239], v[120:123]
    v_mfma_f32_16x16x32_bf16 v[124:127], v[204:207], v[240:243], v[124:127]
    v_mfma_f32_16x16x32_bf16 v[112:115], v[208:211], v[224:227], v[112:115]
    v_mfma_f32_16x16x32_bf16 v[116:119], v[208:211], v[228:231], v[116:119]
    v_mfma_f32_16x16x32_bf16 v[120:123], v[208:211], v[232:235], v[120:123]
    v_mfma_f32_16x16x32_bf16 v[124:127], v[208:211], v[236:239], v[124:127]
    v_mfma_f32_16x16x32_bf16 v[116:119], v[212:215], v[224:227], v[116:119]
    v_mfma_f32_16x16x32_bf16 v[120:123], v[212:215], v[228:231], v[120:123]
    v_mfma_f32_16x16x32_bf16 v[124:127], v[212:215], v[232:235], v[124:127]
    v_mfma_f32_16x16x32_bf16 v[120:123], v[216:219], v[224:227], v[120:123]
    v_mfma_f32_16x16x32_bf16 v[124:127], v[216:219], v[228:231], v[124:127]
    v_mfma_f32_16x16x32_bf16 v[124:127], v[220:223], v[224:227], v[124:127]
    s_waitcnt lgkmcnt(0)
    v_mfma_f32_16x16x32_bf16 v[96:99], v[128:131], v[160:163], v[96:99]
    ds_read2_b32 v[192:193], v28 offset0:80 offset1:81
    v_mfma_f32_16x16x32_bf16 v[100:103], v[128:131], v[164:167], v[100:103]
    ds_read2_b32 v[194:195], v28 offset0:82 offset1:83
    v_mfma_f32_16x16x32_bf16 v[104:107], v[128:131], v[168:171], v[104:107]
    ds_read_b128 v[224:227], v32 offset:3904
    v_mfma_f32_16x16x32_bf16 v[108:111], v[128:131], v[172:175], v[108:111]
    ds_read2_b32 v[196:197], v28 offset0:208 offset1:209
    v_mfma_f32_16x16x32_bf16 v[112:115], v[128:131], v[176:179], v[112:115]
    ds_read2_b32 v[198:199], v28 offset0:210 offset1:211
    v_mfma_f32_16x16x32_bf16 v[116:119], v[128:131], v[180:183], v[116:119]
    ds_read_b128 v[228:231], v32 offset:3392
    v_mfma_f32_16x16x32_bf16 v[120:123], v[128:131], v[184:187], v[120:123]
    ds_read2_b32 v[200:201], v29 offset0:80 offset1:81
    v_mfma_f32_16x16x32_bf16 v[124:127], v[128:131], v[188:191], v[124:127]
    ds_read2_b32 v[202:203], v29 offset0:82 offset1:83
    v_mfma_f32_16x16x32_bf16 v[100:103], v[132:135], v[160:163], v[100:103]
    ds_read_b128 v[232:235], v32 offset:2880
    v_mfma_f32_16x16x32_bf16 v[104:107], v[132:135], v[164:167], v[104:107]
    ds_read2_b32 v[204:205], v29 offset0:208 offset1:209
    v_mfma_f32_16x16x32_bf16 v[108:111], v[132:135], v[168:171], v[108:111]
    ds_read2_b32 v[206:207], v29 offset0:210 offset1:211
    v_mfma_f32_16x16x32_bf16 v[112:115], v[132:135], v[172:175], v[112:115]
    ds_read_b128 v[236:239], v32 offset:2368
    v_mfma_f32_16x16x32_bf16 v[116:119], v[132:135], v[176:179], v[116:119]
    ds_read2_b32 v[208:209], v30 offset0:80 offset1:81
    v_mfma_f32_16x16x32_bf16 v[120:123], v[132:135], v[180:183], v[120:123]
    ds_read2_b32 v[210:211], v30 offset0:82 offset1:83
    v_mfma_f32_16x16x32_bf16 v[124:127], v[132:135], v[184:187], v[124:127]
    ds_read_b128 v[240:243], v32 offset:1856
    v_mfma_f32_16x16x32_bf16 v[104:107], v[136:139], v[160:163], v[104:107]
    ds_read2_b32 v[212:213], v30 offset0:208 offset1:209
    v_mfma_f32_16x16x32_bf16 v[108:111], v[136:139], v[164:167], v[108:111]
    ds_read2_b32 v[214:215], v30 offset0:210 offset1:211
    v_mfma_f32_16x16x32_bf16 v[112:115], v[136:139], v[168:171], v[112:115]
    ds_read_b128 v[244:247], v32 offset:1344
    v_mfma_f32_16x16x32_bf16 v[116:119], v[136:139], v[172:175], v[116:119]
    ds_read2_b32 v[216:217], v31 offset0:80 offset1:81
    v_mfma_f32_16x16x32_bf16 v[120:123], v[136:139], v[176:179], v[120:123]
    ds_read2_b32 v[218:219], v31 offset0:82 offset1:83
    v_mfma_f32_16x16x32_bf16 v[124:127], v[136:139], v[180:183], v[124:127]
    ds_read_b128 v[248:251], v32 offset:832
    v_mfma_f32_16x16x32_bf16 v[108:111], v[140:143], v[160:163], v[108:111]
    ds_read2_b32 v[220:221], v31 offset0:208 offset1:209
    v_mfma_f32_16x16x32_bf16 v[112:115], v[140:143], v[164:167], v[112:115]
    ds_read2_b32 v[222:223], v31 offset0:210 offset1:211
    v_mfma_f32_16x16x32_bf16 v[116:119], v[140:143], v[168:171], v[116:119]
    ds_read_b128 v[252:255], v32 offset:320
    v_mfma_f32_16x16x32_bf16 v[120:123], v[140:143], v[172:175], v[120:123]
    v_mfma_f32_16x16x32_bf16 v[124:127], v[140:143], v[176:179], v[124:127]
    v_mfma_f32_16x16x32_bf16 v[112:115], v[144:147], v[160:163], v[112:115]
    v_mfma_f32_16x16x32_bf16 v[116:119], v[144:147], v[164:167], v[116:119]
    v_mfma_f32_16x16x32_bf16 v[120:123], v[144:147], v[168:171], v[120:123]
    v_mfma_f32_16x16x32_bf16 v[124:127], v[144:147], v[172:175], v[124:127]
    v_mfma_f32_16x16x32_bf16 v[116:119], v[148:151], v[160:163], v[116:119]
    v_mfma_f32_16x16x32_bf16 v[120:123], v[148:151], v[164:167], v[120:123]
    v_mfma_f32_16x16x32_bf16 v[124:127], v[148:151], v[168:171], v[124:127]
    v_mfma_f32_16x16x32_bf16 v[120:123], v[152:155], v[160:163], v[120:123]
    v_mfma_f32_16x16x32_bf16 v[124:127], v[152:155], v[164:167], v[124:127]
    v_mfma_f32_16x16x32_bf16 v[124:127], v[156:159], v[160:163], v[124:127]
    s_waitcnt lgkmcnt(0)
    v_mfma_f32_16x16x32_bf16 v[96:99], v[192:195], v[224:227], v[96:99]
    ds_read2_b32 v[128:129], v28 offset0:96 offset1:97
    v_mfma_f32_16x16x32_bf16 v[100:103], v[192:195], v[228:231], v[100:103]
    ds_read2_b32 v[130:131], v28 offset0:98 offset1:99
    v_mfma_f32_16x16x32_bf16 v[104:107], v[192:195], v[232:235], v[104:107]
    ds_read_b128 v[160:163], v32 offset:3968
    v_mfma_f32_16x16x32_bf16 v[108:111], v[192:195], v[236:239], v[108:111]
    ds_read2_b32 v[132:133], v28 offset0:224 offset1:225
    v_mfma_f32_16x16x32_bf16 v[112:115], v[192:195], v[240:243], v[112:115]
    ds_read2_b32 v[134:135], v28 offset0:226 offset1:227
    v_mfma_f32_16x16x32_bf16 v[116:119], v[192:195], v[244:247], v[116:119]
    ds_read_b128 v[164:167], v32 offset:3456
    v_mfma_f32_16x16x32_bf16 v[120:123], v[192:195], v[248:251], v[120:123]
    ds_read2_b32 v[136:137], v29 offset0:96 offset1:97
    v_mfma_f32_16x16x32_bf16 v[124:127], v[192:195], v[252:255], v[124:127]
    ds_read2_b32 v[138:139], v29 offset0:98 offset1:99
    v_mfma_f32_16x16x32_bf16 v[100:103], v[196:199], v[224:227], v[100:103]
    ds_read_b128 v[168:171], v32 offset:2944
    v_mfma_f32_16x16x32_bf16 v[104:107], v[196:199], v[228:231], v[104:107]
    ds_read2_b32 v[140:141], v29 offset0:224 offset1:225
    v_mfma_f32_16x16x32_bf16 v[108:111], v[196:199], v[232:235], v[108:111]
    ds_read2_b32 v[142:143], v29 offset0:226 offset1:227
    v_mfma_f32_16x16x32_bf16 v[112:115], v[196:199], v[236:239], v[112:115]
    ds_read_b128 v[172:175], v32 offset:2432
    v_mfma_f32_16x16x32_bf16 v[116:119], v[196:199], v[240:243], v[116:119]
    ds_read2_b32 v[144:145], v30 offset0:96 offset1:97
    v_mfma_f32_16x16x32_bf16 v[120:123], v[196:199], v[244:247], v[120:123]
    ds_read2_b32 v[146:147], v30 offset0:98 offset1:99
    v_mfma_f32_16x16x32_bf16 v[124:127], v[196:199], v[248:251], v[124:127]
    ds_read_b128 v[176:179], v32 offset:1920
    v_mfma_f32_16x16x32_bf16 v[104:107], v[200:203], v[224:227], v[104:107]
    ds_read2_b32 v[148:149], v30 offset0:224 offset1:225
    v_mfma_f32_16x16x32_bf16 v[108:111], v[200:203], v[228:231], v[108:111]
    ds_read2_b32 v[150:151], v30 offset0:226 offset1:227
    v_mfma_f32_16x16x32_bf16 v[112:115], v[200:203], v[232:235], v[112:115]
    ds_read_b128 v[180:183], v32 offset:1408
    v_mfma_f32_16x16x32_bf16 v[116:119], v[200:203], v[236:239], v[116:119]
    ds_read2_b32 v[152:153], v31 offset0:96 offset1:97
    v_mfma_f32_16x16x32_bf16 v[120:123], v[200:203], v[240:243], v[120:123]
    ds_read2_b32 v[154:155], v31 offset0:98 offset1:99
    v_mfma_f32_16x16x32_bf16 v[124:127], v[200:203], v[244:247], v[124:127]
    ds_read_b128 v[184:187], v32 offset:896
    v_mfma_f32_16x16x32_bf16 v[108:111], v[204:207], v[224:227], v[108:111]
    ds_read2_b32 v[156:157], v31 offset0:224 offset1:225
    v_mfma_f32_16x16x32_bf16 v[112:115], v[204:207], v[228:231], v[112:115]
    ds_read2_b32 v[158:159], v31 offset0:226 offset1:227
    v_mfma_f32_16x16x32_bf16 v[116:119], v[204:207], v[232:235], v[116:119]
    ds_read_b128 v[188:191], v32 offset:384
    v_mfma_f32_16x16x32_bf16 v[120:123], v[204:207], v[236:239], v[120:123]
    v_mfma_f32_16x16x32_bf16 v[124:127], v[204:207], v[240:243], v[124:127]
    v_mfma_f32_16x16x32_bf16 v[112:115], v[208:211], v[224:227], v[112:115]
    v_mfma_f32_16x16x32_bf16 v[116:119], v[208:211], v[228:231], v[116:119]
    v_mfma_f32_16x16x32_bf16 v[120:123], v[208:211], v[232:235], v[120:123]
    v_mfma_f32_16x16x32_bf16 v[124:127], v[208:211], v[236:239], v[124:127]
    v_mfma_f32_16x16x32_bf16 v[116:119], v[212:215], v[224:227], v[116:119]
    v_mfma_f32_16x16x32_bf16 v[120:123], v[212:215], v[228:231], v[120:123]
    v_mfma_f32_16x16x32_bf16 v[124:127], v[212:215], v[232:235], v[124:127]
    v_mfma_f32_16x16x32_bf16 v[120:123], v[216:219], v[224:227], v[120:123]
    v_mfma_f32_16x16x32_bf16 v[124:127], v[216:219], v[228:231], v[124:127]
    v_mfma_f32_16x16x32_bf16 v[124:127], v[220:223], v[224:227], v[124:127]
    s_waitcnt lgkmcnt(0)
    v_mfma_f32_16x16x32_bf16 v[96:99], v[128:131], v[160:163], v[96:99]
    ds_read2_b32 v[192:193], v28 offset0:112 offset1:113
    v_mfma_f32_16x16x32_bf16 v[100:103], v[128:131], v[164:167], v[100:103]
    ds_read2_b32 v[194:195], v28 offset0:114 offset1:115
    v_mfma_f32_16x16x32_bf16 v[104:107], v[128:131], v[168:171], v[104:107]
    ds_read_b128 v[224:227], v32 offset:4032
    v_mfma_f32_16x16x32_bf16 v[108:111], v[128:131], v[172:175], v[108:111]
    ds_read2_b32 v[196:197], v28 offset0:240 offset1:241
    v_mfma_f32_16x16x32_bf16 v[112:115], v[128:131], v[176:179], v[112:115]
    ds_read2_b32 v[198:199], v28 offset0:242 offset1:243
    v_mfma_f32_16x16x32_bf16 v[116:119], v[128:131], v[180:183], v[116:119]
    ds_read_b128 v[228:231], v32 offset:3520
    v_mfma_f32_16x16x32_bf16 v[120:123], v[128:131], v[184:187], v[120:123]
    ds_read2_b32 v[200:201], v29 offset0:112 offset1:113
    v_mfma_f32_16x16x32_bf16 v[124:127], v[128:131], v[188:191], v[124:127]
    ds_read2_b32 v[202:203], v29 offset0:114 offset1:115
    v_mfma_f32_16x16x32_bf16 v[100:103], v[132:135], v[160:163], v[100:103]
    ds_read_b128 v[232:235], v32 offset:3008
    v_mfma_f32_16x16x32_bf16 v[104:107], v[132:135], v[164:167], v[104:107]
    ds_read2_b32 v[204:205], v29 offset0:240 offset1:241
    v_mfma_f32_16x16x32_bf16 v[108:111], v[132:135], v[168:171], v[108:111]
    ds_read2_b32 v[206:207], v29 offset0:242 offset1:243
    v_mfma_f32_16x16x32_bf16 v[112:115], v[132:135], v[172:175], v[112:115]
    ds_read_b128 v[236:239], v32 offset:2496
    v_mfma_f32_16x16x32_bf16 v[116:119], v[132:135], v[176:179], v[116:119]
    ds_read2_b32 v[208:209], v30 offset0:112 offset1:113
    v_mfma_f32_16x16x32_bf16 v[120:123], v[132:135], v[180:183], v[120:123]
    ds_read2_b32 v[210:211], v30 offset0:114 offset1:115
    v_mfma_f32_16x16x32_bf16 v[124:127], v[132:135], v[184:187], v[124:127]
    ds_read_b128 v[240:243], v32 offset:1984
    v_mfma_f32_16x16x32_bf16 v[104:107], v[136:139], v[160:163], v[104:107]
    ds_read2_b32 v[212:213], v30 offset0:240 offset1:241
    v_mfma_f32_16x16x32_bf16 v[108:111], v[136:139], v[164:167], v[108:111]
    ds_read2_b32 v[214:215], v30 offset0:242 offset1:243
    v_mfma_f32_16x16x32_bf16 v[112:115], v[136:139], v[168:171], v[112:115]
    ds_read_b128 v[244:247], v32 offset:1472
    v_mfma_f32_16x16x32_bf16 v[116:119], v[136:139], v[172:175], v[116:119]
    ds_read2_b32 v[216:217], v31 offset0:112 offset1:113
    v_mfma_f32_16x16x32_bf16 v[120:123], v[136:139], v[176:179], v[120:123]
    ds_read2_b32 v[218:219], v31 offset0:114 offset1:115
    v_mfma_f32_16x16x32_bf16 v[124:127], v[136:139], v[180:183], v[124:127]
    ds_read_b128 v[248:251], v32 offset:960
    v_mfma_f32_16x16x32_bf16 v[108:111], v[140:143], v[160:163], v[108:111]
    ds_read2_b32 v[220:221], v31 offset0:240 offset1:241
    v_mfma_f32_16x16x32_bf16 v[112:115], v[140:143], v[164:167], v[112:115]
    ds_read2_b32 v[222:223], v31 offset0:242 offset1:243
    v_mfma_f32_16x16x32_bf16 v[116:119], v[140:143], v[168:171], v[116:119]
    ds_read_b128 v[252:255], v32 offset:448
    v_mfma_f32_16x16x32_bf16 v[120:123], v[140:143], v[172:175], v[120:123]
    v_mfma_f32_16x16x32_bf16 v[124:127], v[140:143], v[176:179], v[124:127]
    v_mfma_f32_16x16x32_bf16 v[112:115], v[144:147], v[160:163], v[112:115]
    v_mfma_f32_16x16x32_bf16 v[116:119], v[144:147], v[164:167], v[116:119]
    v_mfma_f32_16x16x32_bf16 v[120:123], v[144:147], v[168:171], v[120:123]
    v_mfma_f32_16x16x32_bf16 v[124:127], v[144:147], v[172:175], v[124:127]
    v_mfma_f32_16x16x32_bf16 v[116:119], v[148:151], v[160:163], v[116:119]
    v_mfma_f32_16x16x32_bf16 v[120:123], v[148:151], v[164:167], v[120:123]
    v_mfma_f32_16x16x32_bf16 v[124:127], v[148:151], v[168:171], v[124:127]
    v_mfma_f32_16x16x32_bf16 v[120:123], v[152:155], v[160:163], v[120:123]
    v_mfma_f32_16x16x32_bf16 v[124:127], v[152:155], v[164:167], v[124:127]
    v_mfma_f32_16x16x32_bf16 v[124:127], v[156:159], v[160:163], v[124:127]
    s_waitcnt lgkmcnt(0)
    v_mfma_f32_16x16x32_bf16 v[96:99], v[192:195], v[224:227], v[96:99]
    v_mfma_f32_16x16x32_bf16 v[100:103], v[192:195], v[228:231], v[100:103]
    v_mfma_f32_16x16x32_bf16 v[104:107], v[192:195], v[232:235], v[104:107]
    v_mfma_f32_16x16x32_bf16 v[108:111], v[192:195], v[236:239], v[108:111]
    v_mfma_f32_16x16x32_bf16 v[112:115], v[192:195], v[240:243], v[112:115]
    v_mfma_f32_16x16x32_bf16 v[116:119], v[192:195], v[244:247], v[116:119]
    v_mfma_f32_16x16x32_bf16 v[120:123], v[192:195], v[248:251], v[120:123]
    v_mfma_f32_16x16x32_bf16 v[124:127], v[192:195], v[252:255], v[124:127]
    v_mfma_f32_16x16x32_bf16 v[100:103], v[196:199], v[224:227], v[100:103]
    v_mfma_f32_16x16x32_bf16 v[104:107], v[196:199], v[228:231], v[104:107]
    v_mfma_f32_16x16x32_bf16 v[108:111], v[196:199], v[232:235], v[108:111]
    v_mfma_f32_16x16x32_bf16 v[112:115], v[196:199], v[236:239], v[112:115]
    v_mfma_f32_16x16x32_bf16 v[116:119], v[196:199], v[240:243], v[116:119]
    v_mfma_f32_16x16x32_bf16 v[120:123], v[196:199], v[244:247], v[120:123]
    v_mfma_f32_16x16x32_bf16 v[124:127], v[196:199], v[248:251], v[124:127]
    v_mfma_f32_16x16x32_bf16 v[104:107], v[200:203], v[224:227], v[104:107]
    v_mfma_f32_16x16x32_bf16 v[108:111], v[200:203], v[228:231], v[108:111]
    v_mfma_f32_16x16x32_bf16 v[112:115], v[200:203], v[232:235], v[112:115]
    v_mfma_f32_16x16x32_bf16 v[116:119], v[200:203], v[236:239], v[116:119]
    v_mfma_f32_16x16x32_bf16 v[120:123], v[200:203], v[240:243], v[120:123]
    v_mfma_f32_16x16x32_bf16 v[124:127], v[200:203], v[244:247], v[124:127]
    v_mfma_f32_16x16x32_bf16 v[108:111], v[204:207], v[224:227], v[108:111]
    v_mfma_f32_16x16x32_bf16 v[112:115], v[204:207], v[228:231], v[112:115]
    v_mfma_f32_16x16x32_bf16 v[116:119], v[204:207], v[232:235], v[116:119]
    v_mfma_f32_16x16x32_bf16 v[120:123], v[204:207], v[236:239], v[120:123]
    v_mfma_f32_16x16x32_bf16 v[124:127], v[204:207], v[240:243], v[124:127]
    v_mfma_f32_16x16x32_bf16 v[112:115], v[208:211], v[224:227], v[112:115]
    v_mfma_f32_16x16x32_bf16 v[116:119], v[208:211], v[228:231], v[116:119]
    v_mfma_f32_16x16x32_bf16 v[120:123], v[208:211], v[232:235], v[120:123]
    v_mfma_f32_16x16x32_bf16 v[124:127], v[208:211], v[236:239], v[124:127]
    v_mfma_f32_16x16x32_bf16 v[116:119], v[212:215], v[224:227], v[116:119]
    v_mfma_f32_16x16x32_bf16 v[120:123], v[212:215], v[228:231], v[120:123]
    v_mfma_f32_16x16x32_bf16 v[124:127], v[212:215], v[232:235], v[124:127]
    v_mfma_f32_16x16x32_bf16 v[120:123], v[216:219], v[224:227], v[120:123]
    v_mfma_f32_16x16x32_bf16 v[124:127], v[216:219], v[228:231], v[124:127]
    v_mfma_f32_16x16x32_bf16 v[124:127], v[220:223], v[224:227], v[124:127]
    s_setprio 0
    v_cvt_pk_bf16_f32 v192, v96, v97
    v_cvt_pk_bf16_f32 v193, v98, v99
    v_cvt_pk_bf16_f32 v194, v100, v101
    v_cvt_pk_bf16_f32 v195, v102, v103
    v_cvt_pk_bf16_f32 v196, v104, v105
    v_cvt_pk_bf16_f32 v197, v106, v107
    v_cvt_pk_bf16_f32 v198, v108, v109
    v_cvt_pk_bf16_f32 v199, v110, v111
    v_cvt_pk_bf16_f32 v200, v112, v113
    v_cvt_pk_bf16_f32 v201, v114, v115
    v_cvt_pk_bf16_f32 v202, v116, v117
    v_cvt_pk_bf16_f32 v203, v118, v119
    v_cvt_pk_bf16_f32 v204, v120, v121
    v_cvt_pk_bf16_f32 v205, v122, v123
    v_cvt_pk_bf16_f32 v206, v124, v125
    v_cvt_pk_bf16_f32 v207, v126, v127
    v_permlane16_swap_b32 v192, v194
    v_permlane16_swap_b32 v193, v195
    v_permlane16_swap_b32 v196, v198
    v_permlane16_swap_b32 v197, v199
    v_permlane16_swap_b32 v200, v202
    v_permlane16_swap_b32 v201, v203
    v_permlane16_swap_b32 v204, v206
    v_permlane16_swap_b32 v205, v207
    ds_bpermute_b32 v192, v17, v192
    ds_bpermute_b32 v193, v17, v193
    ds_bpermute_b32 v194, v17, v194
    ds_bpermute_b32 v195, v17, v195
    ds_bpermute_b32 v196, v17, v196
    ds_bpermute_b32 v197, v17, v197
    ds_bpermute_b32 v198, v17, v198
    ds_bpermute_b32 v199, v17, v199
    ds_bpermute_b32 v200, v17, v200
    ds_bpermute_b32 v201, v17, v201
    ds_bpermute_b32 v202, v17, v202
    ds_bpermute_b32 v203, v17, v203
    ds_bpermute_b32 v204, v17, v204
    ds_bpermute_b32 v205, v17, v205
    ds_bpermute_b32 v206, v17, v206
    ds_bpermute_b32 v207, v17, v207
    ds_read_b32 v60, v21 offset:72
    s_waitcnt lgkmcnt(0)
    v_cmp_eq_u32 vcc, 1, v60
    s_cbranch_vccnz L_zp
    s_mov_b32 s13, 0
    buffer_store_dwordx4 v[192:195], v26, s[56:59], s36 offen offset:0 sc1
    buffer_store_dwordx4 v[196:199], v26, s[56:59], s36 offen offset:1024 sc1
    buffer_store_dwordx4 v[200:203], v26, s[56:59], s36 offen offset:2048 sc1
    buffer_store_dwordx4 v[204:207], v26, s[56:59], s36 offen offset:3072 sc1
    s_branch L_zq
L_zp:
    s_mov_b32 s13, 1
    buffer_store_dwordx4 v[192:195], v26, s[56:59], s36 offen offset:0
    buffer_store_dwordx4 v[196:199], v26, s[56:59], s36 offen offset:1024
    buffer_store_dwordx4 v[200:203], v26, s[56:59], s36 offen offset:2048
    buffer_store_dwordx4 v[204:207], v26, s[56:59], s36 offen offset:3072
L_zq:
    v_add_u32 v33, s101, v26
    s_waitcnt vmcnt(4)
    ds_write_b128 v33, v[64:67] offset:0
    ds_write_b128 v33, v[68:71] offset:1024
    ds_write_b128 v33, v[72:75] offset:2048
    ds_write_b128 v33, v[76:79] offset:3072
    ds_write_b128 v33, v[80:83] offset:4096
    ds_write_b128 v33, v[84:87] offset:5120
    ds_write_b128 v33, v[88:91] offset:6144
    ds_write_b128 v33, v[92:95] offset:7168
    ds_write_b128 v33, v[40:43] offset:8192
    ds_write_b128 v33, v[44:47] offset:9216
    ds_write_b128 v33, v[48:51] offset:10240
    ds_write_b128 v33, v[52:55] offset:11264
    v_mov_b32 v60, 1
    s_mov_b64 exec, 1
    ds_add_u32 v21, v60 offset:68
    s_mov_b64 exec, -1
    s_lshl_b32 s12, s100, 3
    s_add_u32 s12, s12, 8192
    v_lshlrev_b32 v28, 1, v23
    v_lshl_add_u32 v28, v24, 12, v28
    v_lshlrev_b32 v29, 2, v24
    v_lshl_add_u32 v29, v23, 13, v29
    v_lshrrev_b32 v60, 3, v2
    v_and_b32 v61, 7, v2
    v_lshl_add_u32 v28, v60, 2, s35
    v_lshlrev_b32 v28, 12, v28
    v_lshl_add_u32 v28, v61, 4, v28
    s_lshl_b32 s10, s5, 7
    v_add_u32 v28, s10, v28
    v_lshl_add_u32 v30, v61, 3, v60
    v_lshlrev_b32 v30, 2, v30
    s_waitcnt vmcnt(0)
    s_mov_b64 exec, 1
    s_cmp_eq_u32 s13, 1
    s_cbranch_scc0 L_xf2
    buffer_store_dwordx2 v[0:1], v19, s[72:75], s12 offen
    s_branch L_xf3
L_xf2:
    buffer_store_dwordx2 v[0:1], v19, s[72:75], s12 offen sc1
L_xf3:
    s_mov_b64 exec, -1
    s_mov_b32 s15, 0
L_zw_w:
    ds_read_b128 v[60:63], v21 offset:0
    s_waitcnt lgkmcnt(0)
    v_min3_u32 v60, v60, v61, v62
    v_min_u32 v60, v60, v63
    v_cmp_gt_u32 vcc, 22, v60
    s_cbranch_vccz L_zw_ok
    s_sleep 4
    s_add_u32 s15, s15, 1
    s_cmp_lt_u32 s15, 160000
    s_cbranch_scc1 L_zw_w
L_zw_ok:
    s_cmp_eq_u32 s8, 0
    s_cbranch_scc0 L_z1
    s_mov_b32 s15, 0
LZ_poll:
    buffer_load_dwordx4 v[60:63], v3, s[72:75], 0 offen sc1
    s_waitcnt vmcnt(0)
LZ_chk:
    v_cmp_ne_u64 vcc, v[60:61], v[0:1]
    v_cmp_ne_u64 s[10:11], v[62:63], v[0:1]
    s_or_b64 vcc, vcc, s[10:11]
    s_cbranch_scc0 LZ_ok
    s_sleep 4
    s_add_u32 s15, s15, 1
    s_cmp_lt_u32 s15, 20000
    s_cbranch_scc1 LZ_poll
LZ_ok:
    ds_write_b32 v21, v25 offset:48
L_z1:
    s_waitcnt vmcnt(0)
    v_lshlrev_b32 v128, 16, v4
    v_and_b32 v129, 0xffff0000, v4
    v_lshlrev_b32 v130, 16, v5
    v_and_b32 v131, 0xffff0000, v5
    v_lshlrev_b32 v132, 16, v6
    v_and_b32 v133, 0xffff0000, v6
    v_lshlrev_b32 v134, 16, v7
    v_and_b32 v135, 0xffff0000, v7
    v_lshlrev_b32 v136, 16, v8
    v_and_b32 v137, 0xffff0000, v8
    v_lshlrev_b32 v138, 16, v9
    v_and_b32 v139, 0xffff0000, v9
    v_lshlrev_b32 v140, 16, v10
    v_and_b32 v141, 0xffff0000, v10
    v_lshlrev_b32 v142, 16, v11
    v_and_b32 v143, 0xffff0000, v11
    v_lshlrev_b32 v144, 16, v14
    v_and_b32 v145, 0xffff0000, v14
    v_lshlrev_b32 v146, 16, v15
    v_and_b32 v147, 0xffff0000, v15
    v_lshlrev_b32 v148, 16, v56
    v_and_b32 v149, 0xffff0000, v56
    v_lshlrev_b32 v150, 16, v57
    v_and_b32 v151, 0xffff0000, v57
    v_lshlrev_b32 v152, 16, v58
    v_and_b32 v153, 0xffff0000, v58
    v_lshlrev_b32 v154, 16, v59
    v_and_b32 v155, 0xffff0000, v59
    v_lshlrev_b32 v156, 16, v34
    v_and_b32 v157, 0xffff0000, v34
    v_lshlrev_b32 v158, 16, v35
    v_and_b32 v159, 0xffff0000, v35
    s_mov_b32 s15, 0
L_fz_w:
    ds_read_b32 v60, v21 offset:48
    s_waitcnt lgkmcnt(0)
    v_cmp_gt_u32 vcc, 1, v60
    s_cbranch_vccz L_fz_ok
    s_sleep 1
    s_add_u32 s15, s15, 1
    s_cmp_lt_u32 s15, 160000
    s_cbranch_scc1 L_fz_w
L_fz_ok:
    buffer_load_dwordx4 v[64:67], v28, s[56:59], 0 offen sc1
    buffer_load_dwordx4 v[68:71], v28, s[56:59], s32 offen sc1
    buffer_load_dwordx4 v[72:75], v28, s[56:59], s33 offen sc1
    buffer_load_dwordx4 v[76:79], v28, s[56:59], s34 offen sc1
    s_waitcnt vmcnt(3)
    ds_bpermute_b32 v64, v30, v64
    ds_bpermute_b32 v65, v30, v65
    ds_bpermute_b32 v66, v30, v66
    ds_bpermute_b32 v67, v30, v67
    s_waitcnt vmcnt(2)
    ds_bpermute_b32 v68, v30, v68
    ds_bpermute_b32 v69, v30, v69
    ds_bpermute_b32 v70, v30, v70
    ds_bpermute_b32 v71, v30, v71
    s_waitcnt vmcnt(1)
    ds_bpermute_b32 v72, v30, v72
    ds_bpermute_b32 v73, v30, v73
    ds_bpermute_b32 v74, v30, v74
    ds_bpermute_b32 v75, v30, v75
    s_waitcnt vmcnt(0)
    ds_bpermute_b32 v76, v30, v76
    ds_bpermute_b32 v77, v30, v77
    ds_bpermute_b32 v78, v30, v78
    ds_bpermute_b32 v79, v30, v79
    s_waitcnt lgkmcnt(0)
    s_waitcnt vmcnt(0)
    v_lshlrev_b32 v160, 16, v64
    v_lshlrev_b32 v161, 16, v68
    v_lshlrev_b32 v162, 16, v72
    v_lshlrev_b32 v163, 16, v76
    v_mul_f32 v160, v160, v128
    v_mul_f32 v161, v161, v129
    v_mul_f32 v162, v162, v130
    v_mul_f32 v163, v163, v131
    v_and_b32 v164, 0xffff0000, v64
    v_and_b32 v165, 0xffff0000, v68
    v_and_b32 v166, 0xffff0000, v72
    v_and_b32 v167, 0xffff0000, v76
    v_mul_f32 v164, v164, v132
    v_mul_f32 v165, v165, v133
    v_mul_f32 v166, v166, v134
    v_mul_f32 v167, v167, v135
    v_lshlrev_b32 v168, 16, v65
    v_lshlrev_b32 v169, 16, v69
    v_lshlrev_b32 v170, 16, v73
    v_lshlrev_b32 v171, 16, v77
    v_mul_f32 v168, v168, v136
    v_mul_f32 v169, v169, v137
    v_mul_f32 v170, v170, v138
    v_mul_f32 v171, v171, v139
    v_and_b32 v172, 0xffff0000, v65
    v_and_b32 v173, 0xffff0000, v69
    v_and_b32 v174, 0xffff0000, v73
    v_and_b32 v175, 0xffff0000, v77
    v_mul_f32 v172, v172, v140
    v_mul_f32 v173, v173, v141
    v_mul_f32 v174, v174, v142
    v_mul_f32 v175, v175, v143
    v_lshlrev_b32 v176, 16, v66
    v_lshlrev_b32 v177, 16, v70
    v_lshlrev_b32 v178, 16, v74
    v_lshlrev_b32 v179, 16, v78
    v_mul_f32 v176, v176, v144
    v_mul_f32 v177, v177, v145
    v_mul_f32 v178, v178, v146
    v_mul_f32 v179, v179, v147
    v_and_b32 v180, 0xffff0000, v66
    v_and_b32 v181, 0xffff0000, v70
    v_and_b32 v182, 0xffff0000, v74
    v_and_b32 v183, 0xffff0000, v78
    v_mul_f32 v180, v180, v148
    v_mul_f32 v181, v181, v149
    v_mul_f32 v182, v182, v150
    v_mul_f32 v183, v183, v151
    v_lshlrev_b32 v184, 16, v67
    v_lshlrev_b32 v185, 16, v71
    v_lshlrev_b32 v186, 16, v75
    v_lshlrev_b32 v187, 16, v79
    v_mul_f32 v184, v184, v152
    v_mul_f32 v185, v185, v153
    v_mul_f32 v186, v186, v154
    v_mul_f32 v187, v187, v155
    v_and_b32 v188, 0xffff0000, v67
    v_and_b32 v189, 0xffff0000, v71
    v_and_b32 v190, 0xffff0000, v75
    v_and_b32 v191, 0xffff0000, v79
    v_mul_f32 v188, v188, v156
    v_mul_f32 v189, v189, v157
    v_mul_f32 v190, v190, v158
    v_mul_f32 v191, v191, v159
    s_mov_b32 s15, 0
L_ow0_w:
    ds_read_b128 v[60:63], v21 offset:0
    s_waitcnt lgkmcnt(0)
    v_min3_u32 v60, v60, v61, v62
    v_min_u32 v60, v60, v63
    v_cmp_gt_u32 vcc, 27, v60
    s_cbranch_vccz L_ow0_ok
    s_sleep 2
    s_add_u32 s15, s15, 1
    s_cmp_lt_u32 s15, 160000
    s_cbranch_scc1 L_ow0_w
L_ow0_ok:
    s_mov_b32 s10, 0
    buffer_store_dwordx4 v[160:163], v29, s[64:67], s10 offen nt
    s_mov_b32 s15, 0
L_ow1_w:
    ds_read_b128 v[60:63], v21 offset:0
    s_waitcnt lgkmcnt(0)
    v_min3_u32 v60, v60, v61, v62
    v_min_u32 v60, v60, v63
    v_cmp_gt_u32 vcc, 28, v60
    s_cbranch_vccz L_ow1_ok
    s_sleep 2
    s_add_u32 s15, s15, 1
    s_cmp_lt_u32 s15, 160000
    s_cbranch_scc1 L_ow1_w
L_ow1_ok:
    s_mov_b32 s10, 8192
    buffer_store_dwordx4 v[164:167], v29, s[64:67], s10 offen nt
    s_mov_b32 s15, 0
L_ow2_w:
    ds_read_b128 v[60:63], v21 offset:0
    s_waitcnt lgkmcnt(0)
    v_min3_u32 v60, v60, v61, v62
    v_min_u32 v60, v60, v63
    v_cmp_gt_u32 vcc, 29, v60
    s_cbranch_vccz L_ow2_ok
    s_sleep 2
    s_add_u32 s15, s15, 1
    s_cmp_lt_u32 s15, 160000
    s_cbranch_scc1 L_ow2_w
L_ow2_ok:
    s_mov_b32 s10, 16384
    buffer_store_dwordx4 v[168:171], v29, s[64:67], s10 offen nt
    s_mov_b32 s15, 0
L_ow3_w:
    ds_read_b128 v[60:63], v21 offset:0
    s_waitcnt lgkmcnt(0)
    v_min3_u32 v60, v60, v61, v62
    v_min_u32 v60, v60, v63
    v_cmp_gt_u32 vcc, 30, v60
    s_cbranch_vccz L_ow3_ok
    s_sleep 2
    s_add_u32 s15, s15, 1
    s_cmp_lt_u32 s15, 160000
    s_cbranch_scc1 L_ow3_w
L_ow3_ok:
    s_mov_b32 s10, 24576
    buffer_store_dwordx4 v[172:175], v29, s[64:67], s10 offen nt
    s_mov_b32 s15, 0
L_ow4_w:
    ds_read_b128 v[60:63], v21 offset:0
    s_waitcnt lgkmcnt(0)
    v_min3_u32 v60, v60, v61, v62
    v_min_u32 v60, v60, v63
    v_cmp_gt_u32 vcc, 31, v60
    s_cbranch_vccz L_ow4_ok
    s_sleep 2
    s_add_u32 s15, s15, 1
    s_cmp_lt_u32 s15, 160000
    s_cbranch_scc1 L_ow4_w
L_ow4_ok:
    s_mov_b32 s10, 32768
    buffer_store_dwordx4 v[176:179], v29, s[64:67], s10 offen nt
    s_mov_b32 s15, 0
L_ow5_w:
    ds_read_b128 v[60:63], v21 offset:0
    s_waitcnt lgkmcnt(0)
    v_min3_u32 v60, v60, v61, v62
    v_min_u32 v60, v60, v63
    v_cmp_gt_u32 vcc, 32, v60
    s_cbranch_vccz L_ow5_ok
    s_sleep 2
    s_add_u32 s15, s15, 1
    s_cmp_lt_u32 s15, 160000
    s_cbranch_scc1 L_ow5_w
L_ow5_ok:
    s_mov_b32 s10, 40960
    buffer_store_dwordx4 v[180:183], v29, s[64:67], s10 offen nt
    s_mov_b32 s15, 0
L_ow6_w:
    ds_read_b128 v[60:63], v21 offset:0
    s_waitcnt lgkmcnt(0)
    v_min3_u32 v60, v60, v61, v62
    v_min_u32 v60, v60, v63
    v_cmp_gt_u32 vcc, 33, v60
    s_cbranch_vccz L_ow6_ok
    s_sleep 2
    s_add_u32 s15, s15, 1
    s_cmp_lt_u32 s15, 160000
    s_cbranch_scc1 L_ow6_w
L_ow6_ok:
    s_mov_b32 s10, 49152
    buffer_store_dwordx4 v[184:187], v29, s[64:67], s10 offen nt
    s_mov_b32 s15, 0
L_ow7_w:
    ds_read_b128 v[60:63], v21 offset:0
    s_waitcnt lgkmcnt(0)
    v_min3_u32 v60, v60, v61, v62
    v_min_u32 v60, v60, v63
    v_cmp_gt_u32 vcc, 33, v60
    s_cbranch_vccz L_ow7_ok
    s_sleep 2
    s_add_u32 s15, s15, 1
    s_cmp_lt_u32 s15, 160000
    s_cbranch_scc1 L_ow7_w
L_ow7_ok:
    s_mov_b32 s10, 57344
    buffer_store_dwordx4 v[188:191], v29, s[64:67], s10 offen nt
    s_endpgm
Y_G:
    s_and_b32 s68, s4, 6
    s_add_u32 s69, s5, s68
    s_lshl_b32 s69, s69, 1
    s_and_b32 s68, s4, 1
    s_add_u32 s69, s69, s68
    s_and_b32 s69, s69, 15
    s_mov_b32 s100, 0x76543210
    s_mov_b32 s101, 0xfedcba98
    s_lshl_b32 s68, s69, 2
    s_lshr_b64 s[64:65], s[100:101], s68
    s_sub_u32 s68, 64, s68
    s_lshl_b64 s[100:101], s[100:101], s68
    s_or_b64 s[100:101], s[100:101], s[64:65]
    s_sub_u32 s68, s7, s69
    s_and_b32 s68, s68, 15
    s_lshl_b32 s68, s68, 2
    s_bfm_b64 s[64:65], s68, 0
    s_and_b64 s[66:67], s[100:101], s[64:65]
    s_lshl_b64 s[66:67], s[66:67], 4
    s_lshl_b64 s[64:65], s[64:65], 4
    s_or_b32 s64, s64, 15
    s_andn2_b64 s[100:101], s[100:101], s[64:65]
    s_or_b64 s[100:101], s[100:101], s[66:67]
    s_or_b32 s100, s100, s7
    s_setprio 0
    v_and_b32 v3, 31, v2
    v_mov_b32 v23, 0
    v_mov_b32 v11, 163712
    v_lshrrev_b32 v4, 5, v2
    s_lshr_b32 s8, s3, 1
    s_and_b32 s9, s3, 1
    s_lshl_b32 s10, s7, 6
    s_lshl_b32 s11, s9, 5
    s_add_u32 s10, s10, s11
    v_add_u32 v5, s10, v3
    v_lshlrev_b32 v48, 1, v5
    s_lshl_b32 s10, s7, 7
    v_and_b32 v49, 15, v2
    v_lshl_add_u32 v49, v49, 3, s10
    s_lshl_b32 s10, s3, 2
    s_add_u32 s10, s10, 163712
    v_mov_b32 v10, s10
    s_waitcnt lgkmcnt(0)
    s_mov_b32 s76, s48
    s_mov_b32 s77, s49
    s_mov_b32 s78, 256
    s_mov_b32 s79, 0x00020000
    s_or_b32 s10, s2, s3
    s_cmp_eq_u32 s10, 0
    s_cbranch_scc0 G_nononce
    s_memrealtime s[10:11]
    s_waitcnt lgkmcnt(0)
    s_or_b32 s10, s10, 1
    v_mov_b32 v54, s10
    v_mov_b32 v55, s11
    s_mov_b64 exec, 1
    buffer_store_dwordx2 v[54:55], v23, s[76:79], 0 offen sc1
    s_mov_b64 exec, -1
G_nononce:
    s_mov_b32 s52, s42
    s_mov_b32 s53, s43
    s_mov_b32 s54, 2048
    s_mov_b32 s55, 0x00020000
    buffer_load_ushort v12, v48, s[52:55], 0 offen
    s_mov_b32 s52, s30
    s_mov_b32 s53, s31
    buffer_load_ushort v13, v48, s[52:55], 0 offen
    s_mov_b32 s52, s32
    s_mov_b32 s53, s33
    buffer_load_ushort v14, v48, s[52:55], 0 offen
    s_mov_b32 s52, s44
    s_mov_b32 s53, s45
    buffer_load_dwordx2 v[24:25], v49, s[52:55], 0 offen
    s_mov_b32 s52, s28
    s_mov_b32 s53, s29
    s_mov_b32 s54, 4194304
    s_mov_b32 s55, 0x00020000
    s_mov_b32 s60, s46
    s_mov_b32 s61, s47
    s_mov_b32 s62, 16777216
    s_mov_b32 s63, 0x00020000
    s_add_u32 s64, s50, 16777216
    s_addc_u32 s65, s51, 0
    s_mov_b32 s66, 278528
    s_mov_b32 s67, 0x00020000
    s_add_u32 s68, s50, 8388608
    s_addc_u32 s69, s51, 0
    s_mov_b32 s70, 8388608
    s_mov_b32 s71, 0x00020000
    s_add_u32 s72, s50, 17825792
    s_addc_u32 s73, s51, 0
    s_mov_b32 s74, 65536
    s_mov_b32 s75, 0x00020000
    s_cmp_eq_u32 s9, 1
    s_cselect_b32 s80, s40, s38
    s_cselect_b32 s81, s41, s39
    s_mov_b32 s82, 2097152
    s_mov_b32 s83, 0x00020000
    s_lshl_b32 s10, s6, 7
    s_lshl_b32 s11, s3, 5
    s_add_u32 s10, s10, s11
    v_lshrrev_b32 v50, 4, v2
    v_lshl_add_u32 v50, v50, 2, s10
    v_lshl_add_u32 v22, v50, 11, v49
    v_xor_b32 v50, 1, v4
    v_lshlrev_b32 v50, 14, v50
    v_lshl_add_u32 v53, v5, 4, v50
    v_lshlrev_b32 v26, 4, v2
    v_add_u32 v27, 4096, v26
    v_lshrrev_b32 v50, 1, v3
    v_and_b32 v50, 7, v50
    v_xor_b32 v50, v50, v4
    v_lshlrev_b32 v50, 4, v50
    v_lshl_add_u32 v50, v3, 7, v50
    s_lshl_b32 s10, s8, 13
    s_lshl_b32 s11, s9, 13
    s_add_u32 s11, s11, 16384
    v_add_u32 v32, s10, v50
    v_add_u32 v36, s11, v50
    v_xor_b32 v33, 32, v32
    v_xor_b32 v37, 32, v36
    v_xor_b32 v34, 64, v32
    v_xor_b32 v38, 64, v36
    v_xor_b32 v35, 96, v32
    v_xor_b32 v39, 96, v36
    v_add_u32 v40, 65536, v32
    v_add_u32 v41, 65536, v33
    v_add_u32 v42, 65536, v34
    v_add_u32 v43, 65536, v35
    v_add_u32 v44, 65536, v36
    v_add_u32 v45, 65536, v37
    v_add_u32 v46, 65536, v38
    v_add_u32 v47, 65536, v39
    v_mov_b32 v64, 0
    v_mov_b32 v65, 0
    v_mov_b32 v66, 0
    v_mov_b32 v67, 0
    v_mov_b32 v68, 0
    v_mov_b32 v69, 0
    v_mov_b32 v70, 0
    v_mov_b32 v71, 0
    v_mov_b32 v72, 0
    v_mov_b32 v73, 0
    v_mov_b32 v74, 0
    v_mov_b32 v75, 0
    v_mov_b32 v76, 0
    v_mov_b32 v77, 0
    v_mov_b32 v78, 0
    v_mov_b32 v79, 0
    v_mov_b32 v80, 0
    v_mov_b32 v81, 0
    v_mov_b32 v82, 0
    v_mov_b32 v83, 0
    v_mov_b32 v84, 0
    v_mov_b32 v85, 0
    v_mov_b32 v86, 0
    v_mov_b32 v87, 0
    v_mov_b32 v88, 0
    v_mov_b32 v89, 0
    v_mov_b32 v90, 0
    v_mov_b32 v91, 0
    v_mov_b32 v92, 0
    v_mov_b32 v93, 0
    v_mov_b32 v94, 0
    v_mov_b32 v95, 0
    v_mov_b32 v96, 0
    v_mov_b32 v97, 0
    v_mov_b32 v98, 0
    v_mov_b32 v99, 0
    v_mov_b32 v100, 0
    v_mov_b32 v101, 0
    v_mov_b32 v102, 0
    v_mov_b32 v103, 0
    v_mov_b32 v104, 0
    v_mov_b32 v105, 0
    v_mov_b32 v106, 0
    v_mov_b32 v107, 0
    v_mov_b32 v108, 0
    v_mov_b32 v109, 0
    v_mov_b32 v110, 0
    v_mov_b32 v111, 0
    v_mov_b32 v112, 0
    v_mov_b32 v113, 0
    v_mov_b32 v114, 0
    v_mov_b32 v115, 0
    v_mov_b32 v116, 0
    v_mov_b32 v117, 0
    v_mov_b32 v118, 0
    v_mov_b32 v119, 0
    v_mov_b32 v120, 0
    v_mov_b32 v121, 0
    v_mov_b32 v122, 0
    v_mov_b32 v123, 0
    v_mov_b32 v124, 0
    v_mov_b32 v125, 0
    v_mov_b32 v126, 0
    v_mov_b32 v127, 0
    s_lshl_b32 s10, s8, 10
    s_lshl_b32 s11, s9, 9
    s_add_u32 s10, s10, s11
    s_add_u32 s10, s10, 151552
    v_lshl_add_u32 v0, v3, 4, s10
    v_xor_b32 v1, 1024, v0
    s_lshl_b32 s10, s8, 1
    s_sub_i32 s10, s6, s10
    v_sub_u32 v56, s10, v4
    v_add_u32 v57, 0, v56
    v_max_i32 v57, 0, v57
    v_lshlrev_b32 v57, 14, v57
    v_lshl_add_u32 v60, v5, 4, v57
    v_add_u32 v57, -4, v56
    v_max_i32 v57, 0, v57
    v_lshlrev_b32 v57, 14, v57
    v_lshl_add_u32 v61, v5, 4, v57
    v_add_u32 v57, -8, v56
    v_max_i32 v57, 0, v57
    v_lshlrev_b32 v57, 14, v57
    v_lshl_add_u32 v62, v5, 4, v57
    v_add_u32 v57, -12, v56
    v_max_i32 v57, 0, v57
    v_lshlrev_b32 v57, 14, v57
    v_lshl_add_u32 v63, v5, 4, v57
    s_mov_b32 s15, 0
G_s0_w:
    ds_read_b64 v[48:49], v11 offset:16
    s_waitcnt lgkmcnt(0)
    v_min_u32 v48, v48, v49
    v_cmp_gt_u32 vcc, 1, v48
    s_cbranch_vccz G_s0_ok
    s_add_u32 s15, s15, 1
    s_cmp_lt_u32 s15, 160000
    s_cbranch_scc1 G_s0_w
G_s0_ok:
    ds_read_b128 v[128:131], v32 offset:0
    ds_read_b128 v[136:139], v36 offset:0
    ds_read_b128 v[140:143], v36 offset:4096
    ds_read_b128 v[132:135], v32 offset:4096
    ds_read_b128 v[144:147], v33 offset:0
    ds_read_b128 v[152:155], v37 offset:0
    ds_read_b128 v[156:159], v37 offset:4096
    ds_read_b128 v[148:151], v33 offset:4096
    ds_read_b128 v[160:163], v34 offset:0
    ds_read_b128 v[168:171], v38 offset:0
    ds_read_b128 v[172:175], v38 offset:4096
    ds_read_b128 v[164:167], v34 offset:4096
    ds_read_b128 v[176:179], v35 offset:0
    ds_read_b128 v[184:187], v39 offset:0
    ds_read_b128 v[188:191], v39 offset:4096
    ds_read_b128 v[180:183], v35 offset:4096
    ds_read_b64 v[48:49], v11 offset:16
    v_mov_b32 v52, 1
    s_mov_b32 s12, 2
    s_waitcnt lgkmcnt(0)
    ds_write_b32 v10, v52
G1_loop:
    v_mfma_f32_32x32x16_bf16 v[64:79], v[128:131], v[136:139], v[64:79]
    s_waitcnt lgkmcnt(0)
    v_min_u32 v48, v48, v49
    v_cmp_gt_u32 vcc, s12, v48
    s_cbranch_vccnz G1_slow0
G1_back0:
    ds_read_b128 v[192:195], v32 offset:32768
    ds_read_b128 v[200:203], v36 offset:32768
    v_mfma_f32_32x32x16_bf16 v[80:95], v[128:131], v[140:143], v[80:95]
    ds_read_b128 v[204:207], v36 offset:36864
    ds_read_b128 v[196:199], v32 offset:36864
    v_mfma_f32_32x32x16_bf16 v[96:111], v[132:135], v[136:139], v[96:111]
    ds_read_b128 v[208:211], v33 offset:32768
    ds_read_b128 v[216:219], v37 offset:32768
    v_mfma_f32_32x32x16_bf16 v[112:127], v[132:135], v[140:143], v[112:127]
    ds_read_b128 v[220:223], v37 offset:36864
    ds_read_b128 v[212:215], v33 offset:36864
    v_mfma_f32_32x32x16_bf16 v[64:79], v[144:147], v[152:155], v[64:79]
    ds_read_b128 v[224:227], v34 offset:32768
    ds_read_b128 v[232:235], v38 offset:32768
    v_mfma_f32_32x32x16_bf16 v[80:95], v[144:147], v[156:159], v[80:95]
    ds_read_b128 v[236:239], v38 offset:36864
    ds_read_b128 v[228:231], v34 offset:36864
    v_mfma_f32_32x32x16_bf16 v[96:111], v[148:151], v[152:155], v[96:111]
    ds_read_b128 v[240:243], v35 offset:32768
    ds_read_b128 v[248:251], v39 offset:32768
    v_mfma_f32_32x32x16_bf16 v[112:127], v[148:151], v[156:159], v[112:127]
    ds_read_b128 v[252:255], v39 offset:36864
    ds_read_b128 v[244:247], v35 offset:36864
    v_mfma_f32_32x32x16_bf16 v[64:79], v[160:163], v[168:171], v[64:79]
    v_mfma_f32_32x32x16_bf16 v[80:95], v[160:163], v[172:175], v[80:95]
    v_mfma_f32_32x32x16_bf16 v[96:111], v[164:167], v[168:171], v[96:111]
    v_mfma_f32_32x32x16_bf16 v[112:127], v[164:167], v[172:175], v[112:127]
    v_mfma_f32_32x32x16_bf16 v[64:79], v[176:179], v[184:187], v[64:79]
    v_mov_b32 v52, s12
    s_waitcnt lgkmcnt(0)
    ds_write_b32 v10, v52
    s_add_u32 s12, s12, 1
    v_mfma_f32_32x32x16_bf16 v[80:95], v[176:179], v[188:191], v[80:95]
    ds_read_b64 v[48:49], v11 offset:16
    v_mfma_f32_32x32x16_bf16 v[96:111], v[180:183], v[184:187], v[96:111]
    v_mfma_f32_32x32x16_bf16 v[112:127], v[180:183], v[188:191], v[112:127]
    v_mfma_f32_32x32x16_bf16 v[64:79], v[192:195], v[200:203], v[64:79]
    s_waitcnt lgkmcnt(0)
    v_min_u32 v48, v48, v49
    v_cmp_gt_u32 vcc, s12, v48
    s_cbranch_vccnz G1_slow1
G1_back1:
    ds_read_b128 v[128:131], v40 offset:0
    ds_read_b128 v[136:139], v44 offset:0
    v_mfma_f32_32x32x16_bf16 v[80:95], v[192:195], v[204:207], v[80:95]
    ds_read_b128 v[140:143], v44 offset:4096
    ds_read_b128 v[132:135], v40 offset:4096
    v_mfma_f32_32x32x16_bf16 v[96:111], v[196:199], v[200:203], v[96:111]
    ds_read_b128 v[144:147], v41 offset:0
    ds_read_b128 v[152:155], v45 offset:0
    v_mfma_f32_32x32x16_bf16 v[112:127], v[196:199], v[204:207], v[112:127]
    ds_read_b128 v[156:159], v45 offset:4096
    ds_read_b128 v[148:151], v41 offset:4096
    v_mfma_f32_32x32x16_bf16 v[64:79], v[208:211], v[216:219], v[64:79]
    ds_read_b128 v[160:163], v42 offset:0
    ds_read_b128 v[168:171], v46 offset:0
    v_mfma_f32_32x32x16_bf16 v[80:95], v[208:211], v[220:223], v[80:95]
    ds_read_b128 v[172:175], v46 offset:4096
    ds_read_b128 v[164:167], v42 offset:4096
    v_mfma_f32_32x32x16_bf16 v[96:111], v[212:215], v[216:219], v[96:111]
    ds_read_b128 v[176:179], v43 offset:0
    ds_read_b128 v[184:187], v47 offset:0
    v_mfma_f32_32x32x16_bf16 v[112:127], v[212:215], v[220:223], v[112:127]
    ds_read_b128 v[188:191], v47 offset:4096
    ds_read_b128 v[180:183], v43 offset:4096
    v_mfma_f32_32x32x16_bf16 v[64:79], v[224:227], v[232:235], v[64:79]
    v_mfma_f32_32x32x16_bf16 v[80:95], v[224:227], v[236:239], v[80:95]
    v_mfma_f32_32x32x16_bf16 v[96:111], v[228:231], v[232:235], v[96:111]
    v_mfma_f32_32x32x16_bf16 v[112:127], v[228:231], v[236:239], v[112:127]
    v_mfma_f32_32x32x16_bf16 v[64:79], v[240:243], v[248:251], v[64:79]
    v_mov_b32 v52, s12
    s_waitcnt lgkmcnt(0)
    ds_write_b32 v10, v52
    s_add_u32 s12, s12, 1
    v_mfma_f32_32x32x16_bf16 v[80:95], v[240:243], v[252:255], v[80:95]
    ds_read_b64 v[48:49], v11 offset:16
    v_mfma_f32_32x32x16_bf16 v[96:111], v[244:247], v[248:251], v[96:111]
    v_mfma_f32_32x32x16_bf16 v[112:127], v[244:247], v[252:255], v[112:127]
    v_mfma_f32_32x32x16_bf16 v[64:79], v[128:131], v[136:139], v[64:79]
    s_waitcnt lgkmcnt(0)
    v_min_u32 v48, v48, v49
    v_cmp_gt_u32 vcc, s12, v48
    s_cbranch_vccnz G1_slow2
G1_back2:
    ds_read_b128 v[192:195], v40 offset:32768
    ds_read_b128 v[200:203], v44 offset:32768
    v_mfma_f32_32x32x16_bf16 v[80:95], v[128:131], v[140:143], v[80:95]
    ds_read_b128 v[204:207], v44 offset:36864
    ds_read_b128 v[196:199], v40 offset:36864
    v_mfma_f32_32x32x16_bf16 v[96:111], v[132:135], v[136:139], v[96:111]
    ds_read_b128 v[208:211], v41 offset:32768
    ds_read_b128 v[216:219], v45 offset:32768
    v_mfma_f32_32x32x16_bf16 v[112:127], v[132:135], v[140:143], v[112:127]
    ds_read_b128 v[220:223], v45 offset:36864
    ds_read_b128 v[212:215], v41 offset:36864
    v_mfma_f32_32x32x16_bf16 v[64:79], v[144:147], v[152:155], v[64:79]
    ds_read_b128 v[224:227], v42 offset:32768
    ds_read_b128 v[232:235], v46 offset:32768
    v_mfma_f32_32x32x16_bf16 v[80:95], v[144:147], v[156:159], v[80:95]
    ds_read_b128 v[236:239], v46 offset:36864
    ds_read_b128 v[228:231], v42 offset:36864
    v_mfma_f32_32x32x16_bf16 v[96:111], v[148:151], v[152:155], v[96:111]
    ds_read_b128 v[240:243], v43 offset:32768
    ds_read_b128 v[248:251], v47 offset:32768
    v_mfma_f32_32x32x16_bf16 v[112:127], v[148:151], v[156:159], v[112:127]
    ds_read_b128 v[252:255], v47 offset:36864
    ds_read_b128 v[244:247], v43 offset:36864
    v_mfma_f32_32x32x16_bf16 v[64:79], v[160:163], v[168:171], v[64:79]
    v_mfma_f32_32x32x16_bf16 v[80:95], v[160:163], v[172:175], v[80:95]
    v_mfma_f32_32x32x16_bf16 v[96:111], v[164:167], v[168:171], v[96:111]
    v_mfma_f32_32x32x16_bf16 v[112:127], v[164:167], v[172:175], v[112:127]
    v_mfma_f32_32x32x16_bf16 v[64:79], v[176:179], v[184:187], v[64:79]
    v_mov_b32 v52, s12
    s_waitcnt lgkmcnt(0)
    ds_write_b32 v10, v52
    s_add_u32 s12, s12, 1
    v_mfma_f32_32x32x16_bf16 v[80:95], v[176:179], v[188:191], v[80:95]
    ds_read_b64 v[48:49], v11 offset:16
    v_mfma_f32_32x32x16_bf16 v[96:111], v[180:183], v[184:187], v[96:111]
    v_mfma_f32_32x32x16_bf16 v[112:127], v[180:183], v[188:191], v[112:127]
    s_cmp_eq_u32 s12, 17
    s_cbranch_scc1 G1_last
    v_mfma_f32_32x32x16_bf16 v[64:79], v[192:195], v[200:203], v[64:79]
    s_waitcnt lgkmcnt(0)
    v_min_u32 v48, v48, v49
    v_cmp_gt_u32 vcc, s12, v48
    s_cbranch_vccnz G1_slow3
G1_back3:
    ds_read_b128 v[128:131], v32 offset:0
    ds_read_b128 v[136:139], v36 offset:0
    v_mfma_f32_32x32x16_bf16 v[80:95], v[192:195], v[204:207], v[80:95]
    ds_read_b128 v[140:143], v36 offset:4096
    ds_read_b128 v[132:135], v32 offset:4096
    v_mfma_f32_32x32x16_bf16 v[96:111], v[196:199], v[200:203], v[96:111]
    ds_read_b128 v[144:147], v33 offset:0
    ds_read_b128 v[152:155], v37 offset:0
    v_mfma_f32_32x32x16_bf16 v[112:127], v[196:199], v[204:207], v[112:127]
    ds_read_b128 v[156:159], v37 offset:4096
    ds_read_b128 v[148:151], v33 offset:4096
    v_mfma_f32_32x32x16_bf16 v[64:79], v[208:211], v[216:219], v[64:79]
    ds_read_b128 v[160:163], v34 offset:0
    ds_read_b128 v[168:171], v38 offset:0
    v_mfma_f32_32x32x16_bf16 v[80:95], v[208:211], v[220:223], v[80:95]
    ds_read_b128 v[172:175], v38 offset:4096
    ds_read_b128 v[164:167], v34 offset:4096
    v_mfma_f32_32x32x16_bf16 v[96:111], v[212:215], v[216:219], v[96:111]
    ds_read_b128 v[176:179], v35 offset:0
    ds_read_b128 v[184:187], v39 offset:0
    v_mfma_f32_32x32x16_bf16 v[112:127], v[212:215], v[220:223], v[112:127]
    ds_read_b128 v[188:191], v39 offset:4096
    ds_read_b128 v[180:183], v35 offset:4096
    v_mfma_f32_32x32x16_bf16 v[64:79], v[224:227], v[232:235], v[64:79]
    v_mfma_f32_32x32x16_bf16 v[80:95], v[224:227], v[236:239], v[80:95]
    v_mfma_f32_32x32x16_bf16 v[96:111], v[228:231], v[232:235], v[96:111]
    v_mfma_f32_32x32x16_bf16 v[112:127], v[228:231], v[236:239], v[112:127]
    v_mfma_f32_32x32x16_bf16 v[64:79], v[240:243], v[248:251], v[64:79]
    v_mov_b32 v52, s12
    s_waitcnt lgkmcnt(0)
    ds_write_b32 v10, v52
    s_add_u32 s12, s12, 1
    v_mfma_f32_32x32x16_bf16 v[80:95], v[240:243], v[252:255], v[80:95]
    ds_read_b64 v[48:49], v11 offset:16
    v_mfma_f32_32x32x16_bf16 v[96:111], v[244:247], v[248:251], v[96:111]
    v_mfma_f32_32x32x16_bf16 v[112:127], v[244:247], v[252:255], v[112:127]
    s_branch G1_loop
G1_slow0:
    s_mov_b32 s15, 0
G1_sl0_w:
    ds_read_b64 v[48:49], v11 offset:16
    s_waitcnt lgkmcnt(0)
    v_min_u32 v48, v48, v49
    v_cmp_gt_u32 vcc, s12, v48
    s_cbranch_vccz G1_sl0_ok
    s_add_u32 s15, s15, 1
    s_cmp_lt_u32 s15, 160000
    s_cbranch_scc1 G1_sl0_w
G1_sl0_ok:
    s_branch G1_back0
G1_slow1:
    s_mov_b32 s15, 0
G1_sl1_w:
    ds_read_b64 v[48:49], v11 offset:16
    s_waitcnt lgkmcnt(0)
    v_min_u32 v48, v48, v49
    v_cmp_gt_u32 vcc, s12, v48
    s_cbranch_vccz G1_sl1_ok
    s_add_u32 s15, s15, 1
    s_cmp_lt_u32 s15, 160000
    s_cbranch_scc1 G1_sl1_w
G1_sl1_ok:
    s_branch G1_back1
G1_slow2:
    s_mov_b32 s15, 0
G1_sl2_w:
    ds_read_b64 v[48:49], v11 offset:16
    s_waitcnt lgkmcnt(0)
    v_min_u32 v48, v48, v49
    v_cmp_gt_u32 vcc, s12, v48
    s_cbranch_vccz G1_sl2_ok
    s_add_u32 s15, s15, 1
    s_cmp_lt_u32 s15, 160000
    s_cbranch_scc1 G1_sl2_w
G1_sl2_ok:
    s_branch G1_back2
G1_slow3:
    s_mov_b32 s15, 0
G1_sl3_w:
    ds_read_b64 v[48:49], v11 offset:16
    s_waitcnt lgkmcnt(0)
    v_min_u32 v48, v48, v49
    v_cmp_gt_u32 vcc, s12, v48
    s_cbranch_vccz G1_sl3_ok
    s_add_u32 s15, s15, 1
    s_cmp_lt_u32 s15, 160000
    s_cbranch_scc1 G1_sl3_w
G1_sl3_ok:
    s_branch G1_back3
G1_last:
    v_mfma_f32_32x32x16_bf16 v[64:79], v[192:195], v[200:203], v[64:79]
    s_setprio 3
    s_waitcnt vmcnt(0)
    ds_read_b64 v[30:31], v11 offset:32
    v_lshlrev_b32 v133, 16, v12
    v_lshlrev_b32 v134, 16, v13
    v_lshlrev_b32 v135, 16, v14
    v_mul_f32 v133, 0x3fb8aa3b, v133
    v_mfma_f32_32x32x16_bf16 v[80:95], v[192:195], v[204:207], v[80:95]
    v_exp_f32 v133, v133
    v_mul_f32 v140, v134, v134
    v_cvt_pk_bf16_f32 v133, v133, v133
    v_fmac_f32 v140, v135, v135
    v_mfma_f32_32x32x16_bf16 v[96:111], v[196:199], v[200:203], v[96:111]
    v_lshlrev_b32 v133, 16, v133
    v_rcp_f32 v140, v140
    v_mul_f32 v136, v133, v134
    v_mul_f32 v137, v133, v135
    v_mfma_f32_32x32x16_bf16 v[112:127], v[196:199], v[204:207], v[112:127]
    v_mul_f32 v136, 0x3fb8aa3b, v136
    v_exp_f32 v136, v136
    v_mul_f32 v137, 0.15915494, v137
    v_cos_f32 v138, v137
    v_mfma_f32_32x32x16_bf16 v[64:79], v[208:211], v[216:219], v[64:79]
    v_sin_f32 v139, v137
    v_add_f32 v140, v140, v140
    v_mul_f32 v6, v136, v138
    v_mul_f32 v7, v136, v139
    v_mfma_f32_32x32x16_bf16 v[80:95], v[208:211], v[220:223], v[80:95]
    v_mul_f32 v128, v6, v6
    v_mul_f32 v129, v6, v7
    v_fma_f32 v128, -v7, v7, v128
    v_fmac_f32 v129, v7, v6
    v_mfma_f32_32x32x16_bf16 v[96:111], v[212:215], v[216:219], v[96:111]
    v_mul_f32 v130, v128, v128
    v_mul_f32 v131, v128, v129
    v_fma_f32 v130, -v129, v129, v130
    v_fmac_f32 v131, v129, v128
    v_mfma_f32_32x32x16_bf16 v[112:127], v[212:215], v[220:223], v[112:127]
    v_mul_f32 v12, v130, v130
    v_mul_f32 v13, v130, v131
    v_fma_f32 v12, -v131, v131, v12
    v_fmac_f32 v13, v131, v130
    v_mfma_f32_32x32x16_bf16 v[64:79], v[224:227], v[232:235], v[64:79]
    v_mul_f32 v14, v12, v12
    v_mul_f32 v15, v12, v13
    v_fma_f32 v14, -v13, v13, v14
    v_fmac_f32 v15, v13, v12
    v_mfma_f32_32x32x16_bf16 v[80:95], v[224:227], v[236:239], v[80:95]
    v_mul_f32 v16, v14, v14
    v_mul_f32 v17, v14, v15
    v_fma_f32 v16, -v15, v15, v16
    v_fmac_f32 v17, v15, v14
    v_mfma_f32_32x32x16_bf16 v[96:111], v[228:231], v[232:235], v[96:111]
    v_add_f32 v136, -1.0, v6
    v_mul_f32 v138, v136, v134
    v_fmac_f32 v138, v7, v135
    v_mul_f32 v139, v7, v134
    v_mfma_f32_32x32x16_bf16 v[112:127], v[228:231], v[236:239], v[112:127]
    v_fma_f32 v139, -v136, v135, v139
    v_mul_f32 v8, v138, v140
    v_mul_f32 v9, v139, v140
    v_mul_f32 v18, v16, v16
    v_mfma_f32_32x32x16_bf16 v[64:79], v[240:243], v[248:251], v[64:79]
    v_mul_f32 v19, v16, v17
    v_fma_f32 v18, -v17, v17, v18
    v_fmac_f32 v19, v17, v16
    v_mul_f32 v20, v18, v18
    v_mfma_f32_32x32x16_bf16 v[80:95], v[240:243], v[252:255], v[80:95]
    v_mul_f32 v21, v18, v19
    v_fma_f32 v20, -v19, v19, v20
    v_fmac_f32 v21, v19, v18
    v_mfma_f32_32x32x16_bf16 v[96:111], v[244:247], v[248:251], v[96:111]
    v_mfma_f32_32x32x16_bf16 v[112:127], v[244:247], v[252:255], v[112:127]
    s_nop 1
    v_fma_f32 v40, v6, v64, v66
    v_fma_f32 v41, v6, v65, v67
    s_nop 2
    v_fma_f32 v42, v6, v80, v82
    v_fma_f32 v43, v6, v81, v83
    s_nop 1
    v_fma_f32 v44, v6, v96, v98
    v_fma_f32 v45, v6, v97, v99
    v_fma_f32 v46, v6, v112, v114
    v_fma_f32 v47, v6, v113, v115
    v_fma_f32 v40, -v7, v80, v40
    v_fma_f32 v41, -v7, v81, v41
    v_fmac_f32 v42, v7, v64
    v_fmac_f32 v43, v7, v65
    v_fma_f32 v44, -v7, v112, v44
    v_fma_f32 v45, -v7, v113, v45
    v_fmac_f32 v46, v7, v96
    v_fmac_f32 v47, v7, v97
    v_fma_f32 v32, v6, v40, v68
    v_fma_f32 v33, v6, v41, v69
    v_fma_f32 v34, v6, v42, v84
    v_fma_f32 v35, v6, v43, v85
    v_fma_f32 v36, v6, v44, v100
    v_fma_f32 v37, v6, v45, v101
    v_fma_f32 v38, v6, v46, v116
    v_fma_f32 v39, v6, v47, v117
    v_fma_f32 v32, -v7, v42, v32
    v_fma_f32 v33, -v7, v43, v33
    v_fmac_f32 v34, v7, v40
    v_fmac_f32 v35, v7, v41
    v_fma_f32 v36, -v7, v46, v36
    v_fma_f32 v37, -v7, v47, v37
    v_fmac_f32 v38, v7, v44
    v_fmac_f32 v39, v7, v45
    v_fma_f32 v40, v6, v32, v70
    v_fma_f32 v41, v6, v33, v71
    v_fma_f32 v42, v6, v34, v86
    v_fma_f32 v43, v6, v35, v87
    v_fma_f32 v44, v6, v36, v102
    v_fma_f32 v45, v6, v37, v103
    v_fma_f32 v46, v6, v38, v118
    v_fma_f32 v47, v6, v39, v119
    v_fma_f32 v40, -v7, v34, v40
    v_fma_f32 v41, -v7, v35, v41
    v_fmac_f32 v42, v7, v32
    v_fmac_f32 v43, v7, v33
    v_fma_f32 v44, -v7, v38, v44
    v_fma_f32 v45, -v7, v39, v45
    v_fmac_f32 v46, v7, v36
    v_fmac_f32 v47, v7, v37
    v_fma_f32 v32, v6, v40, v72
    v_fma_f32 v33, v6, v41, v73
    v_fma_f32 v34, v6, v42, v88
    v_fma_f32 v35, v6, v43, v89
    v_fma_f32 v36, v6, v44, v104
    v_fma_f32 v37, v6, v45, v105
    v_fma_f32 v38, v6, v46, v120
    v_fma_f32 v39, v6, v47, v121
    v_fma_f32 v32, -v7, v42, v32
    v_fma_f32 v33, -v7, v43, v33
    v_fmac_f32 v34, v7, v40
    v_fmac_f32 v35, v7, v41
    v_fma_f32 v36, -v7, v46, v36
    v_fma_f32 v37, -v7, v47, v37
    v_fmac_f32 v38, v7, v44
    v_fmac_f32 v39, v7, v45
    v_fma_f32 v40, v6, v32, v74
    v_fma_f32 v41, v6, v33, v75
    v_fma_f32 v42, v6, v34, v90
    v_fma_f32 v43, v6, v35, v91
    v_fma_f32 v44, v6, v36, v106
    v_fma_f32 v45, v6, v37, v107
    v_fma_f32 v46, v6, v38, v122
    v_fma_f32 v47, v6, v39, v123
    v_fma_f32 v40, -v7, v34, v40
    v_fma_f32 v41, -v7, v35, v41
    v_fmac_f32 v42, v7, v32
    v_fmac_f32 v43, v7, v33
    v_fma_f32 v44, -v7, v38, v44
    v_fma_f32 v45, -v7, v39, v45
    v_fmac_f32 v46, v7, v36
    v_fmac_f32 v47, v7, v37
    v_fma_f32 v32, v6, v40, v76
    v_fma_f32 v33, v6, v41, v77
    v_fma_f32 v34, v6, v42, v92
    v_fma_f32 v35, v6, v43, v93
    v_fma_f32 v36, v6, v44, v108
    v_fma_f32 v37, v6, v45, v109
    v_fma_f32 v38, v6, v46, v124
    v_fma_f32 v39, v6, v47, v125
    v_fma_f32 v32, -v7, v42, v32
    v_fma_f32 v33, -v7, v43, v33
    v_fmac_f32 v34, v7, v40
    v_fmac_f32 v35, v7, v41
    v_fma_f32 v36, -v7, v46, v36
    v_fma_f32 v37, -v7, v47, v37
    v_fmac_f32 v38, v7, v44
    v_fmac_f32 v39, v7, v45
    v_fma_f32 v40, v6, v32, v78
    v_fma_f32 v41, v6, v33, v79
    v_fma_f32 v42, v6, v34, v94
    v_fma_f32 v43, v6, v35, v95
    v_fma_f32 v44, v6, v36, v110
    v_fma_f32 v45, v6, v37, v111
    v_fma_f32 v46, v6, v38, v126
    v_fma_f32 v47, v6, v39, v127
    v_fma_f32 v40, -v7, v34, v40
    v_fma_f32 v41, -v7, v35, v41
    v_fmac_f32 v42, v7, v32
    v_fmac_f32 v43, v7, v33
    v_fma_f32 v44, -v7, v38, v44
    v_fma_f32 v45, -v7, v39, v45
    v_fmac_f32 v46, v7, v36
    v_fmac_f32 v47, v7, v37
    v_fmac_f32 v44, v12, v40
    v_fmac_f32 v45, v12, v41
    v_fmac_f32 v46, v12, v42
    v_fmac_f32 v47, v12, v43
    v_fma_f32 v44, -v13, v42, v44
    v_fma_f32 v45, -v13, v43, v45
    v_fmac_f32 v46, v13, v40
    v_fmac_f32 v47, v13, v41
    v_fma_f32 v32, v14, v44, v45
    v_fma_f32 v34, v14, v46, v47
    v_fma_f32 v32, -v15, v46, v32
    v_fmac_f32 v34, v15, v44
    v_mov_b32 v33, v32
    v_mov_b32 v35, v34
    s_lshl_b32 s12, s6, 1
    s_add_u32 s12, s12, s8
    v_permlane32_swap_b32 v32, v33
    v_permlane32_swap_b32 v34, v35
    v_fma_f32 v28, v16, v32, v33
    v_fma_f32 v29, v16, v34, v35
    v_fma_f32 v28, -v17, v34, v28
    v_fmac_f32 v29, v17, v32
    s_waitcnt lgkmcnt(0)
    s_mov_b32 s15, 0
G_nw:
    v_cmp_eq_u32 vcc, 0, v30
    s_cbranch_vccz G_nok
    ds_read_b64 v[30:31], v11 offset:32
    s_add_u32 s15, s15, 1
    s_waitcnt lgkmcnt(0)
    s_cmp_lt_u32 s15, 160000
    s_cbranch_scc1 G_nw
G_nok:
    s_cmp_eq_u32 s8, 0
    s_cbranch_scc0 G_pw1
    ds_write_b128 v0, v[28:31] offset:2048
    s_branch G_pub1
G_pw1:
    s_mov_b32 s15, 0
G_x1:
    ds_read_b128 v[56:59], v1 offset:2048
    s_add_u32 s15, s15, 1
    s_waitcnt lgkmcnt(0)
    v_cmp_ne_u64 vcc, v[58:59], v[30:31]
    s_cbranch_vccz G_x1_ok
    s_cmp_lt_u32 s15, 160000
    s_cbranch_scc1 G_x1
G_x1_ok:
    v_fmac_f32 v28, v18, v56
    v_fmac_f32 v29, v18, v57
    s_lshl_b32 s13, s6, 14
    v_fma_f32 v28, -v19, v57, v28
    v_fmac_f32 v29, v19, v56
    s_mov_b32 exec_hi, 0
    buffer_store_dwordx4 v[28:31], v53, s[64:67], s13 offen sc1
    s_cmp_eq_u32 s6, 0
    s_cbranch_scc0 G_pub1
    s_not_b64 exec, exec
    v_mov_b32 v28, 0
    v_mov_b32 v29, 0
    buffer_store_dwordx4 v[28:31], v53, s[64:67], 0 offen sc1
G_pub1:
    s_mov_b64 exec, -1
    v_mul_f32 v128, v8, v64
    v_mul_f32 v129, v8, v65
    v_mul_f32 v144, -v8, v80
    v_mul_f32 v145, -v8, v81
    v_mul_f32 v160, v8, v96
    v_mul_f32 v161, v8, v97
    v_mul_f32 v176, -v8, v112
    v_mul_f32 v177, -v8, v113
    v_fma_f32 v128, -v9, v80, v128
    v_fma_f32 v129, -v9, v81, v129
    v_fma_f32 v144, -v9, v64, v144
    v_fma_f32 v145, -v9, v65, v145
    v_fma_f32 v160, -v9, v112, v160
    v_fma_f32 v161, -v9, v113, v161
    v_fma_f32 v176, -v9, v96, v176
    v_fma_f32 v177, -v9, v97, v177
    v_mul_f32 v130, v8, v66
    v_mul_f32 v131, v8, v67
    v_mul_f32 v146, -v8, v82
    v_mul_f32 v147, -v8, v83
    v_mul_f32 v162, v8, v98
    v_mul_f32 v163, v8, v99
    v_mul_f32 v178, -v8, v114
    v_mul_f32 v179, -v8, v115
    v_fma_f32 v130, -v9, v82, v130
    v_fma_f32 v131, -v9, v83, v131
    v_fma_f32 v146, -v9, v66, v146
    v_fma_f32 v147, -v9, v67, v147
    v_fma_f32 v162, -v9, v114, v162
    v_fma_f32 v163, -v9, v115, v163
    v_fma_f32 v178, -v9, v98, v178
    v_fma_f32 v179, -v9, v99, v179
    v_mul_f32 v132, v8, v68
    v_mul_f32 v133, v8, v69
    v_mul_f32 v148, -v8, v84
    v_mul_f32 v149, -v8, v85
    v_mul_f32 v164, v8, v100
    v_mul_f32 v165, v8, v101
    v_mul_f32 v180, -v8, v116
    v_mul_f32 v181, -v8, v117
    v_fma_f32 v132, -v9, v84, v132
    v_fma_f32 v133, -v9, v85, v133
    v_fma_f32 v148, -v9, v68, v148
    v_fma_f32 v149, -v9, v69, v149
    v_fma_f32 v164, -v9, v116, v164
    v_fma_f32 v165, -v9, v117, v165
    v_fma_f32 v180, -v9, v100, v180
    v_fma_f32 v181, -v9, v101, v181
    v_mul_f32 v134, v8, v70
    v_mul_f32 v135, v8, v71
    v_mul_f32 v150, -v8, v86
    v_mul_f32 v151, -v8, v87
    v_mul_f32 v166, v8, v102
    v_mul_f32 v167, v8, v103
    v_mul_f32 v182, -v8, v118
    v_mul_f32 v183, -v8, v119
    v_fma_f32 v134, -v9, v86, v134
    v_fma_f32 v135, -v9, v87, v135
    v_fma_f32 v150, -v9, v70, v150
    v_fma_f32 v151, -v9, v71, v151
    v_fma_f32 v166, -v9, v118, v166
    v_fma_f32 v167, -v9, v119, v167
    v_fma_f32 v182, -v9, v102, v182
    v_fma_f32 v183, -v9, v103, v183
    v_mul_f32 v136, v8, v72
    v_mul_f32 v137, v8, v73
    v_mul_f32 v152, -v8, v88
    v_mul_f32 v153, -v8, v89
    v_mul_f32 v168, v8, v104
    v_mul_f32 v169, v8, v105
    v_mul_f32 v184, -v8, v120
    v_mul_f32 v185, -v8, v121
    v_fma_f32 v136, -v9, v88, v136
    v_fma_f32 v137, -v9, v89, v137
    v_fma_f32 v152, -v9, v72, v152
    v_fma_f32 v153, -v9, v73, v153
    v_fma_f32 v168, -v9, v120, v168
    v_fma_f32 v169, -v9, v121, v169
    v_fma_f32 v184, -v9, v104, v184
    v_fma_f32 v185, -v9, v105, v185
    v_mul_f32 v138, v8, v74
    v_mul_f32 v139, v8, v75
    v_mul_f32 v154, -v8, v90
    v_mul_f32 v155, -v8, v91
    v_mul_f32 v170, v8, v106
    v_mul_f32 v171, v8, v107
    v_mul_f32 v186, -v8, v122
    v_mul_f32 v187, -v8, v123
    v_fma_f32 v138, -v9, v90, v138
    v_fma_f32 v139, -v9, v91, v139
    v_fma_f32 v154, -v9, v74, v154
    v_fma_f32 v155, -v9, v75, v155
    v_fma_f32 v170, -v9, v122, v170
    v_fma_f32 v171, -v9, v123, v171
    v_fma_f32 v186, -v9, v106, v186
    v_fma_f32 v187, -v9, v107, v187
    v_mul_f32 v140, v8, v76
    v_mul_f32 v141, v8, v77
    v_mul_f32 v156, -v8, v92
    v_mul_f32 v157, -v8, v93
    v_mul_f32 v172, v8, v108
    v_mul_f32 v173, v8, v109
    v_mul_f32 v188, -v8, v124
    v_mul_f32 v189, -v8, v125
    v_fma_f32 v140, -v9, v92, v140
    v_fma_f32 v141, -v9, v93, v141
    v_fma_f32 v156, -v9, v76, v156
    v_fma_f32 v157, -v9, v77, v157
    v_fma_f32 v172, -v9, v124, v172
    v_fma_f32 v173, -v9, v125, v173
    v_fma_f32 v188, -v9, v108, v188
    v_fma_f32 v189, -v9, v109, v189
    v_mul_f32 v142, v8, v78
    v_mul_f32 v143, v8, v79
    v_mul_f32 v158, -v8, v94
    v_mul_f32 v159, -v8, v95
    v_mul_f32 v174, v8, v110
    v_mul_f32 v175, v8, v111
    v_mul_f32 v190, -v8, v126
    v_mul_f32 v191, -v8, v127
    v_fma_f32 v142, -v9, v94, v142
    v_fma_f32 v143, -v9, v95, v143
    v_fma_f32 v158, -v9, v78, v158
    v_fma_f32 v159, -v9, v79, v159
    v_fma_f32 v174, -v9, v126, v174
    v_fma_f32 v175, -v9, v127, v175
    v_fma_f32 v190, -v9, v110, v190
    v_fma_f32 v191, -v9, v111, v191
    s_mov_b32 s13, 0
    buffer_load_dwordx2 v[80:81], v22, s[52:55], s13 offen offset:0
    buffer_load_dwordx2 v[82:83], v22, s[52:55], s13 offen offset:2048
    s_mov_b32 s13, 4096
    buffer_load_dwordx2 v[84:85], v22, s[52:55], s13 offen offset:0
    buffer_load_dwordx2 v[86:87], v22, s[52:55], s13 offen offset:2048
    s_mov_b32 s13, 32768
    buffer_load_dwordx2 v[88:89], v22, s[52:55], s13 offen offset:0
    buffer_load_dwordx2 v[90:91], v22, s[52:55], s13 offen offset:2048
    s_mov_b32 s13, 36864
    buffer_load_dwordx2 v[92:93], v22, s[52:55], s13 offen offset:0
    buffer_load_dwordx2 v[94:95], v22, s[52:55], s13 offen offset:2048
    v_cmp_eq_u32 vcc, 1, v4
    v_mov_b32 v36, 1.0
    s_nop 0
    v_cndmask_b32 v72, v36, v20, vcc
    v_cndmask_b32 v73, 0, v21, vcc
    v_cndmask_b32 v96, 0, v32, vcc
    v_cndmask_b32 v98, 0, v34, vcc
    v_cndmask_b32 v36, v36, v16, vcc
    v_cndmask_b32 v37, 0, v17, vcc
    s_cmp_eq_u32 s8, 1
    s_cselect_b64 s[14:15], -1, 0
    v_mul_f32 v74, v20, v20
    v_fma_f32 v97, v14, v96, v44
    v_mul_f32 v75, v20, v21
    v_fma_f32 v99, v14, v98, v46
    v_fma_f32 v74, -v21, v21, v74
    v_fma_f32 v97, -v15, v98, v97
    v_fmac_f32 v75, v21, v20
    v_fmac_f32 v99, v15, v96
    v_mul_f32 v76, v74, v74
    v_fma_f32 v100, v12, v96, v40
    v_mul_f32 v77, v74, v75
    v_fma_f32 v101, v12, v97, v41
    v_fma_f32 v76, -v75, v75, v76
    v_fma_f32 v102, v12, v98, v42
    v_fmac_f32 v77, v75, v74
    v_fma_f32 v103, v12, v99, v43
    v_cndmask_b32 v74, 1.0, v74, s[14:15]
    v_fma_f32 v100, -v13, v98, v100
    v_cndmask_b32 v75, 0, v75, s[14:15]
    v_fma_f32 v101, -v13, v99, v101
    v_mul_f32 v64, v72, v74
    v_fmac_f32 v102, v13, v96
    v_mul_f32 v65, v72, v75
    v_fmac_f32 v103, v13, v97
    v_fma_f32 v64, -v73, v75, v64
    v_mul_f32 v104, v8, v36
    v_fmac_f32 v65, v73, v74
    v_mul_f32 v106, v8, v37
    v_mul_f32 v66, v64, v76
    v_fma_f32 v104, -v9, v37, v104
    v_mul_f32 v67, v64, v77
    v_fmac_f32 v106, v9, v36
    v_fma_f32 v66, -v65, v77, v66
    v_mul_f32 v105, v14, v104
    v_fmac_f32 v67, v65, v76
    v_mul_f32 v107, v14, v106
    v_mul_f32 v68, v66, v76
    v_fma_f32 v105, -v15, v106, v105
    v_mul_f32 v69, v66, v77
    v_fmac_f32 v107, v15, v104
    v_fma_f32 v68, -v67, v77, v68
    v_mul_f32 v108, v12, v104
    v_fmac_f32 v69, v67, v76
    v_mul_f32 v109, v12, v105
    v_mul_f32 v70, v68, v76
    v_mul_f32 v110, v12, v106
    v_mul_f32 v71, v68, v77
    v_mul_f32 v111, v12, v107
    v_fma_f32 v70, -v69, v77, v70
    v_fma_f32 v108, -v13, v106, v108
    v_fmac_f32 v71, v69, v76
    v_fma_f32 v109, -v13, v107, v109
    v_fmac_f32 v110, v13, v104
    v_fmac_f32 v111, v13, v105
    v_mul_f32 v112, v8, v96
    v_mul_f32 v113, v8, v97
    v_mul_f32 v114, -v8, v98
    v_mul_f32 v115, -v8, v99
    v_fma_f32 v112, -v9, v98, v112
    v_fma_f32 v113, -v9, v99, v113
    v_fma_f32 v114, -v9, v96, v114
    v_fma_f32 v115, -v9, v97, v115
    v_mul_f32 v116, v8, v100
    v_mul_f32 v117, v8, v101
    v_mul_f32 v118, -v8, v102
    v_mul_f32 v119, -v8, v103
    v_fma_f32 v116, -v9, v102, v116
    v_fma_f32 v117, -v9, v103, v117
    v_fma_f32 v118, -v9, v100, v118
    v_fma_f32 v119, -v9, v101, v119
    s_lshl_b32 s13, s3, 13
    s_add_u32 s13, s13, 65536
    v_and_b32 v32, 1, v2
    v_and_b32 v33, 2, v2
    v_lshl_or_b32 v32, v33, 1, v32
    v_lshrrev_b32 v33, 1, v2
    v_xor_b32 v33, v33, v2
    v_bfe_u32 v33, v33, 2, 1
    v_lshl_or_b32 v32, v33, 1, v32
    v_lshlrev_b32 v33, 2, v4
    v_xor_b32 v32, v32, v33
    v_lshlrev_b32 v32, 4, v32
    v_lshl_add_u32 v32, v3, 7, v32
    v_add_u32 v120, s13, v32
    v_xor_b32 v121, 16, v120
    v_xor_b32 v122, 32, v120
    v_xor_b32 v123, 48, v120
    v_bfe_u32 v32, v2, 2, 2
    v_lshrrev_b32 v33, 4, v2
    v_lshl_add_u32 v33, v33, 3, v32
    v_lshlrev_b32 v33, 7, v33
    v_and_b32 v34, 1, v32
    v_and_b32 v32, 2, v32
    v_lshl_or_b32 v32, v32, 1, v34
    v_bfe_u32 v34, v2, 4, 1
    v_bfe_u32 v35, v2, 1, 1
    v_lshl_or_b32 v34, v34, 1, v35
    v_xor_b32 v32, v32, v34
    v_lshl_add_u32 v33, v32, 4, v33
    v_and_b32 v32, 1, v2
    v_lshl_add_u32 v33, v32, 3, v33
    v_add_u32 v124, s13, v33
    v_xor_b32 v125, 64, v124
    v_xor_b32 v126, 32, v124
    v_xor_b32 v127, 64, v126
    s_lshl_b32 s10, s7, 5
    s_add_u32 s10, s10, s8
    s_lshl_b32 s10, s10, 12
    v_lshrrev_b32 v40, 3, v2
    v_lshl_add_u32 v40, v40, 13, s10
    v_lshrrev_b32 v41, 4, v2
    v_xor_b32 v41, v41, v2
    v_and_b32 v41, 7, v41
    v_lshl_add_u32 v16, v41, 4, v40
    v_xor_b32 v17, 64, v16
    v_add_u32 v17, 64512, v17
    s_lshl_b32 s16, s6, 2
    s_add_u32 s16, s16, s3
    s_lshl_b32 s16, s16, 17
    s_lshl_b32 s22, s9, 13
    s_lshl_b32 s10, s8, 12
    s_add_u32 s22, s22, s10
    s_lshl_b32 s10, s9, 6
    s_lshl_b32 s11, s9, 13
    v_xor_b32 v20, s10, v124
    v_xor_b32 v21, s10, v126
    v_subrev_u32 v20, s11, v20
    v_subrev_u32 v21, s11, v21
    s_mov_b32 s15, 0
G_all16_w:
    ds_read_b128 v[48:51], v11 offset:0
    s_waitcnt lgkmcnt(0)
    v_min3_u32 v48, v48, v49, v50
    v_min_u32 v48, v48, v51
    v_cmp_gt_u32 vcc, 16, v48
    s_cbranch_vccz G_all16_ok
    s_add_u32 s15, s15, 1
    s_cmp_lt_u32 s15, 160000
    s_cbranch_scc1 G_all16_w
G_all16_ok:
    v_mov_b32 v36, 0
    v_mov_b32 v37, 0
    s_mov_b32 s15, 0
    s_cmp_eq_u32 s6, 0
    s_cbranch_scc1 G_lb4
    s_lshl_b32 s14, s8, 1
    s_sub_i32 s14, s6, s14
    s_cmp_le_i32 s14, 0
    s_cbranch_scc1 G_lb3
G_lb:
    buffer_load_dwordx4 v[192:195], v60, s[64:67], 0 offen sc1
    s_cmp_le_i32 s14, 4
    s_cbranch_scc1 G_lb1
    buffer_load_dwordx4 v[196:199], v61, s[64:67], 0 offen sc1
    s_cmp_le_i32 s14, 8
    s_cbranch_scc1 G_lb1
    buffer_load_dwordx4 v[200:203], v62, s[64:67], 0 offen sc1
    s_cmp_le_i32 s14, 12
    s_cbranch_scc1 G_lb1
    buffer_load_dwordx4 v[204:207], v63, s[64:67], 0 offen sc1
G_lb1:
    v_mov_b32 v36, 0
    v_mov_b32 v37, 0
    s_mov_b64 s[10:11], 0
    s_waitcnt vmcnt(0)
    v_cmp_ne_u64 vcc, v[194:195], v[30:31]
    v_fmac_f32 v36, v64, v192
    v_fmac_f32 v37, v64, v193
    s_or_b64 s[10:11], s[10:11], vcc
    v_fma_f32 v36, -v65, v193, v36
    v_fmac_f32 v37, v65, v192
    s_cmp_le_i32 s14, 4
    s_cbranch_scc1 G_lb2
    v_cmp_ne_u64 vcc, v[198:199], v[30:31]
    v_fmac_f32 v36, v66, v196
    v_fmac_f32 v37, v66, v197
    s_or_b64 s[10:11], s[10:11], vcc
    v_fma_f32 v36, -v67, v197, v36
    v_fmac_f32 v37, v67, v196
    s_cmp_le_i32 s14, 8
    s_cbranch_scc1 G_lb2
    v_cmp_ne_u64 vcc, v[202:203], v[30:31]
    v_fmac_f32 v36, v68, v200
    v_fmac_f32 v37, v68, v201
    s_or_b64 s[10:11], s[10:11], vcc
    v_fma_f32 v36, -v69, v201, v36
    v_fmac_f32 v37, v69, v200
    s_cmp_le_i32 s14, 12
    s_cbranch_scc1 G_lb2
    v_cmp_ne_u64 vcc, v[206:207], v[30:31]
    v_fmac_f32 v36, v70, v204
    v_fmac_f32 v37, v70, v205
    s_or_b64 s[10:11], s[10:11], vcc
    v_fma_f32 v36, -v71, v205, v36
    v_fmac_f32 v37, v71, v204
G_lb2:
    s_cmp_eq_u64 s[10:11], 0
    s_cbranch_scc1 G_lb2b
    s_add_u32 s15, s15, 1
    s_cmp_lt_u32 s15, 20000
    s_cbranch_scc1 G_lb
G_lb2b:
    v_mov_b32 v38, v36
    v_mov_b32 v39, v37
    s_nop 0
    v_permlane32_swap_b32 v36, v38
    v_permlane32_swap_b32 v37, v39
    v_add_f32 v36, v36, v38
    v_add_f32 v37, v37, v39
G_lb3:
    v_mov_b32 v28, v36
    v_mov_b32 v29, v37
    ds_write_b128 v0, v[28:31]
    s_mov_b32 s15, 0
G_x2:
    ds_read_b128 v[192:195], v1 offset:0
    s_add_u32 s15, s15, 1
    s_waitcnt lgkmcnt(0)
    v_cmp_ne_u64 vcc, v[194:195], v[30:31]
    s_cbranch_vccz G_x2_ok
    s_cmp_lt_u32 s15, 160000
    s_cbranch_scc1 G_x2
G_x2_ok:
    v_add_f32 v36, v36, v192
    v_add_f32 v37, v37, v193
G_lb4:
    s_cmp_eq_u32 s8, 0
    s_cbranch_scc1 G_lbdone
    v_fma_f32 v56, v18, v36, v56
    v_fma_f32 v57, v18, v37, v57
    v_fma_f32 v56, -v19, v37, v56
    v_fma_f32 v37, v19, v36, v57
    v_mov_b32 v36, v56
G_lbdone:
    v_fmac_f32 v112, v36, v104
    v_fmac_f32 v113, v36, v105
    v_fma_f32 v114, -v37, v104, v114
    v_fma_f32 v115, -v37, v105, v115
    v_fmac_f32 v116, v36, v108
    v_fmac_f32 v117, v36, v109
    v_fma_f32 v118, -v37, v108, v118
    v_fma_f32 v119, -v37, v109, v119
    v_fma_f32 v112, -v37, v106, v112
    v_fma_f32 v113, -v37, v107, v113
    v_fma_f32 v114, -v36, v106, v114
    v_fma_f32 v115, -v36, v107, v115
    v_fma_f32 v116, -v37, v110, v116
    v_fma_f32 v117, -v37, v111, v117
    v_fma_f32 v118, -v36, v110, v118
    v_fma_f32 v119, -v36, v111, v119
    s_bfe_u32 s18, s100, 28 + (4 << 16)
    s_lshl_b32 s18, s18, 7
    buffer_load_dwordx4 v[224:227], v16, s[80:83], s18 offen offset:0
    v_fmac_f32 v128, v6, v112
    v_fmac_f32 v129, v6, v113
    v_fmac_f32 v144, v6, v114
    v_fmac_f32 v145, v6, v115
    v_fmac_f32 v160, v6, v116
    v_fmac_f32 v161, v6, v117
    v_fmac_f32 v176, v6, v118
    v_fmac_f32 v177, v6, v119
    v_fmac_f32 v128, v7, v114
    v_fmac_f32 v129, v7, v115
    v_fma_f32 v144, -v7, v112, v144
    v_fma_f32 v145, -v7, v113, v145
    v_fmac_f32 v160, v7, v118
    v_fmac_f32 v161, v7, v119
    v_fma_f32 v176, -v7, v116, v176
    v_fma_f32 v177, -v7, v117, v177
    buffer_load_dwordx4 v[228:231], v17, s[80:83], s18 offen offset:1024
    v_fmac_f32 v130, v6, v128
    v_fmac_f32 v131, v6, v129
    v_fmac_f32 v146, v6, v144
    v_fmac_f32 v147, v6, v145
    v_fmac_f32 v162, v6, v160
    v_fmac_f32 v163, v6, v161
    v_fmac_f32 v178, v6, v176
    v_fmac_f32 v179, v6, v177
    v_fmac_f32 v130, v7, v144
    v_fmac_f32 v131, v7, v145
    v_fma_f32 v146, -v7, v128, v146
    v_fma_f32 v147, -v7, v129, v147
    v_fmac_f32 v162, v7, v176
    v_fmac_f32 v163, v7, v177
    v_fma_f32 v178, -v7, v160, v178
    v_fma_f32 v179, -v7, v161, v179
    buffer_load_dwordx4 v[232:235], v16, s[80:83], s18 offen offset:2048
    v_fmac_f32 v132, v6, v130
    v_fmac_f32 v133, v6, v131
    v_fmac_f32 v148, v6, v146
    v_fmac_f32 v149, v6, v147
    v_fmac_f32 v164, v6, v162
    v_fmac_f32 v165, v6, v163
    v_fmac_f32 v180, v6, v178
    v_fmac_f32 v181, v6, v179
    v_fmac_f32 v132, v7, v146
    v_fmac_f32 v133, v7, v147
    v_fma_f32 v148, -v7, v130, v148
    v_fma_f32 v149, -v7, v131, v149
    v_fmac_f32 v164, v7, v178
    v_fmac_f32 v165, v7, v179
    v_fma_f32 v180, -v7, v162, v180
    v_fma_f32 v181, -v7, v163, v181
    buffer_load_dwordx4 v[236:239], v17, s[80:83], s18 offen offset:3072
    v_fmac_f32 v134, v6, v132
    v_fmac_f32 v135, v6, v133
    v_fmac_f32 v150, v6, v148
    v_fmac_f32 v151, v6, v149
    v_fmac_f32 v166, v6, v164
    v_fmac_f32 v167, v6, v165
    v_fmac_f32 v182, v6, v180
    v_fmac_f32 v183, v6, v181
    v_fmac_f32 v134, v7, v148
    v_fmac_f32 v135, v7, v149
    v_fma_f32 v150, -v7, v132, v150
    v_fma_f32 v151, -v7, v133, v151
    v_fmac_f32 v166, v7, v180
    v_fmac_f32 v167, v7, v181
    v_fma_f32 v182, -v7, v164, v182
    v_fma_f32 v183, -v7, v165, v183
    s_bfe_u32 s18, s101, 0 + (4 << 16)
    s_lshl_b32 s18, s18, 7
    buffer_load_dwordx4 v[240:243], v16, s[80:83], s18 offen offset:0
    v_fmac_f32 v136, v6, v134
    v_fmac_f32 v137, v6, v135
    v_fmac_f32 v152, v6, v150
    v_fmac_f32 v153, v6, v151
    v_fmac_f32 v168, v6, v166
    v_fmac_f32 v169, v6, v167
    v_fmac_f32 v184, v6, v182
    v_fmac_f32 v185, v6, v183
    v_fmac_f32 v136, v7, v150
    v_fmac_f32 v137, v7, v151
    v_fma_f32 v152, -v7, v134, v152
    v_fma_f32 v153, -v7, v135, v153
    v_fmac_f32 v168, v7, v182
    v_fmac_f32 v169, v7, v183
    v_fma_f32 v184, -v7, v166, v184
    v_fma_f32 v185, -v7, v167, v185
    buffer_load_dwordx4 v[244:247], v17, s[80:83], s18 offen offset:1024
    v_fmac_f32 v138, v6, v136
    v_fmac_f32 v139, v6, v137
    v_fmac_f32 v154, v6, v152
    v_fmac_f32 v155, v6, v153
    v_fmac_f32 v170, v6, v168
    v_fmac_f32 v171, v6, v169
    v_fmac_f32 v186, v6, v184
    v_fmac_f32 v187, v6, v185
    v_fmac_f32 v138, v7, v152
    v_fmac_f32 v139, v7, v153
    v_fma_f32 v154, -v7, v136, v154
    v_fma_f32 v155, -v7, v137, v155
    v_fmac_f32 v170, v7, v184
    v_fmac_f32 v171, v7, v185
    v_fma_f32 v186, -v7, v168, v186
    v_fma_f32 v187, -v7, v169, v187
    buffer_load_dwordx4 v[248:251], v16, s[80:83], s18 offen offset:2048
    v_fmac_f32 v140, v6, v138
    v_fmac_f32 v141, v6, v139
    v_fmac_f32 v156, v6, v154
    v_fmac_f32 v157, v6, v155
    v_fmac_f32 v172, v6, v170
    v_fmac_f32 v173, v6, v171
    v_fmac_f32 v188, v6, v186
    v_fmac_f32 v189, v6, v187
    v_fmac_f32 v140, v7, v154
    v_fmac_f32 v141, v7, v155
    v_fma_f32 v156, -v7, v138, v156
    v_fma_f32 v157, -v7, v139, v157
    v_fmac_f32 v172, v7, v186
    v_fmac_f32 v173, v7, v187
    v_fma_f32 v188, -v7, v170, v188
    v_fma_f32 v189, -v7, v171, v189
    buffer_load_dwordx4 v[252:255], v17, s[80:83], s18 offen offset:3072
    v_fmac_f32 v142, v6, v140
    v_fmac_f32 v143, v6, v141
    v_fmac_f32 v158, v6, v156
    v_fmac_f32 v159, v6, v157
    v_fmac_f32 v174, v6, v172
    v_fmac_f32 v175, v6, v173
    v_fmac_f32 v190, v6, v188
    v_fmac_f32 v191, v6, v189
    v_fmac_f32 v142, v7, v156
    v_fmac_f32 v143, v7, v157
    v_fma_f32 v158, -v7, v140, v158
    v_fma_f32 v159, -v7, v141, v159
    v_fmac_f32 v174, v7, v188
    v_fmac_f32 v175, v7, v189
    v_fma_f32 v190, -v7, v172, v190
    v_fma_f32 v191, -v7, v173, v191
    v_cvt_pk_bf16_f32 v192, v128, v130
    v_cvt_pk_bf16_f32 v193, v132, v134
    v_cvt_pk_bf16_f32 v194, v136, v138
    v_cvt_pk_bf16_f32 v195, v140, v142
    ds_write_b128 v120, v[192:195] offset:0
    v_cvt_pk_bf16_f32 v196, v160, v162
    v_cvt_pk_bf16_f32 v197, v164, v166
    v_cvt_pk_bf16_f32 v198, v168, v170
    v_cvt_pk_bf16_f32 v199, v172, v174
    ds_write_b128 v121, v[196:199] offset:0
    v_cvt_pk_bf16_f32 v200, v129, v131
    v_cvt_pk_bf16_f32 v201, v133, v135
    v_cvt_pk_bf16_f32 v202, v137, v139
    v_cvt_pk_bf16_f32 v203, v141, v143
    ds_write_b128 v122, v[200:203] offset:0
    v_cvt_pk_bf16_f32 v204, v161, v163
    v_cvt_pk_bf16_f32 v205, v165, v167
    v_cvt_pk_bf16_f32 v206, v169, v171
    v_cvt_pk_bf16_f32 v207, v173, v175
    ds_write_b128 v123, v[204:207] offset:0
    v_cvt_pk_bf16_f32 v208, v144, v146
    v_cvt_pk_bf16_f32 v209, v148, v150
    v_cvt_pk_bf16_f32 v210, v152, v154
    v_cvt_pk_bf16_f32 v211, v156, v158
    ds_write_b128 v120, v[208:211] offset:4096
    v_cvt_pk_bf16_f32 v212, v176, v178
    v_cvt_pk_bf16_f32 v213, v180, v182
    v_cvt_pk_bf16_f32 v214, v184, v186
    v_cvt_pk_bf16_f32 v215, v188, v190
    ds_write_b128 v121, v[212:215] offset:4096
    v_cvt_pk_bf16_f32 v216, v145, v147
    v_cvt_pk_bf16_f32 v217, v149, v151
    v_cvt_pk_bf16_f32 v218, v153, v155
    v_cvt_pk_bf16_f32 v219, v157, v159
    ds_write_b128 v122, v[216:219] offset:4096
    v_cvt_pk_bf16_f32 v220, v177, v179
    v_cvt_pk_bf16_f32 v221, v181, v183
    v_cvt_pk_bf16_f32 v222, v185, v187
    v_cvt_pk_bf16_f32 v223, v189, v191
    ds_write_b128 v123, v[220:223] offset:4096
    s_lshl_b32 s10, s12, 18
    s_lshl_b32 s11, s7, 13
    s_add_u32 s10, s10, s11
    s_lshl_b32 s11, s9, 11
    s_add_u32 s10, s10, s11
    s_add_u32 s11, s10, 131072
    v_mov_b32 v22, 17
    s_waitcnt lgkmcnt(0)
    ds_read_b64_tr_b16 v[160:161], v124 offset:0
    ds_read_b64_tr_b16 v[162:163], v126 offset:512
    ds_read_b64_tr_b16 v[164:165], v126 offset:0
    ds_read_b64_tr_b16 v[166:167], v124 offset:512
    ds_read_b64_tr_b16 v[168:169], v125 offset:0
    ds_read_b64_tr_b16 v[170:171], v127 offset:512
    ds_read_b64_tr_b16 v[172:173], v127 offset:0
    ds_read_b64_tr_b16 v[174:175], v125 offset:512
    ds_read_b64_tr_b16 v[176:177], v124 offset:4096
    ds_read_b64_tr_b16 v[178:179], v126 offset:4608
    ds_read_b64_tr_b16 v[180:181], v126 offset:4096
    ds_read_b64_tr_b16 v[182:183], v124 offset:4608
    ds_read_b64_tr_b16 v[184:185], v125 offset:4096
    ds_read_b64_tr_b16 v[186:187], v127 offset:4608
    ds_read_b64_tr_b16 v[188:189], v127 offset:4096
    ds_read_b64_tr_b16 v[190:191], v125 offset:4608
    s_waitcnt lgkmcnt(14)
    buffer_store_dwordx4 v[160:163], v26, s[68:71], s10 offen offset:0 sc1
    s_waitcnt lgkmcnt(12)
    buffer_store_dwordx4 v[164:167], v26, s[68:71], s10 offen offset:1024 sc1
    s_waitcnt lgkmcnt(10)
    buffer_store_dwordx4 v[168:171], v26, s[68:71], s11 offen offset:0 sc1
    s_waitcnt lgkmcnt(8)
    buffer_store_dwordx4 v[172:175], v26, s[68:71], s11 offen offset:1024 sc1
    s_waitcnt lgkmcnt(6)
    buffer_store_dwordx4 v[176:179], v27, s[68:71], s10 offen offset:0 sc1
    s_waitcnt lgkmcnt(4)
    buffer_store_dwordx4 v[180:183], v27, s[68:71], s10 offen offset:1024 sc1
    s_waitcnt lgkmcnt(2)
    buffer_store_dwordx4 v[184:187], v27, s[68:71], s11 offen offset:0 sc1
    s_waitcnt lgkmcnt(0)
    buffer_store_dwordx4 v[188:191], v27, s[68:71], s11 offen offset:1024 sc1
    ds_write_b32 v10, v22
    v_and_b32 v112, 15, v2
    v_lshrrev_b32 v113, 1, v112
    v_lshrrev_b32 v114, 4, v2
    v_xor_b32 v113, v113, v114
    v_lshlrev_b32 v113, 4, v113
    v_lshl_add_u32 v6, v112, 7, v113
    v_xor_b32 v7, 64, v6
    v_add_u32 v8, 65536, v6
    v_add_u32 v9, 65536, v7
    v_add_u32 v0, s22, v26
    v_add_u32 v1, 65536, v0
    s_lshl_b32 s10, s6, 11
    s_add_u32 s10, s10, 32768
    s_lshl_b32 s11, s7, 7
    s_add_u32 s11, s11, s10
    v_lshl_add_u32 v5, v112, 7, s10
    v_cmp_ne_u32 s[20:21], s7, v112
    v_lshlrev_b32 v116, 16, v24
    v_and_b32 v117, 0xffff0000, v24
    v_lshlrev_b32 v118, 16, v25
    v_and_b32 v119, 0xffff0000, v25
    v_add_u32 v26, s16, v26
    v_add_u32 v27, s16, v27
    s_waitcnt vmcnt(16)
    v_lshlrev_b32 v192, 16, v80
    v_and_b32 v193, 0xffff0000, v80
    v_lshlrev_b32 v194, 16, v81
    v_and_b32 v195, 0xffff0000, v81
    v_lshlrev_b32 v196, 16, v82
    v_and_b32 v197, 0xffff0000, v82
    v_lshlrev_b32 v198, 16, v83
    v_and_b32 v199, 0xffff0000, v83
    v_lshlrev_b32 v200, 16, v84
    v_and_b32 v201, 0xffff0000, v84
    v_lshlrev_b32 v202, 16, v85
    v_and_b32 v203, 0xffff0000, v85
    v_lshlrev_b32 v204, 16, v86
    v_and_b32 v205, 0xffff0000, v86
    v_lshlrev_b32 v206, 16, v87
    v_and_b32 v207, 0xffff0000, v87
    v_lshlrev_b32 v208, 16, v88
    v_and_b32 v209, 0xffff0000, v88
    v_lshlrev_b32 v210, 16, v89
    v_and_b32 v211, 0xffff0000, v89
    v_lshlrev_b32 v212, 16, v90
    v_and_b32 v213, 0xffff0000, v90
    v_lshlrev_b32 v214, 16, v91
    v_and_b32 v215, 0xffff0000, v91
    v_lshlrev_b32 v216, 16, v92
    v_and_b32 v217, 0xffff0000, v92
    v_lshlrev_b32 v218, 16, v93
    v_and_b32 v219, 0xffff0000, v93
    v_lshlrev_b32 v220, 16, v94
    v_and_b32 v221, 0xffff0000, v94
    v_lshlrev_b32 v222, 16, v95
    v_and_b32 v223, 0xffff0000, v95
    v_mul_f32 v64, v192, v116
    v_mul_f32 v72, v193, v117
    v_mul_f32 v80, v194, v118
    v_mul_f32 v88, v195, v119
    v_mul_f32 v65, v196, v116
    v_mul_f32 v73, v197, v117
    v_mul_f32 v81, v198, v118
    v_mul_f32 v89, v199, v119
    v_mul_f32 v66, v200, v116
    v_mul_f32 v74, v201, v117
    v_mul_f32 v82, v202, v118
    v_mul_f32 v90, v203, v119
    v_mul_f32 v67, v204, v116
    v_mul_f32 v75, v205, v117
    v_mul_f32 v83, v206, v118
    v_mul_f32 v91, v207, v119
    v_mul_f32 v68, v208, v116
    v_mul_f32 v76, v209, v117
    v_mul_f32 v84, v210, v118
    v_mul_f32 v92, v211, v119
    v_mul_f32 v69, v212, v116
    v_mul_f32 v77, v213, v117
    v_mul_f32 v85, v214, v118
    v_mul_f32 v93, v215, v119
    v_mul_f32 v70, v216, v116
    v_mul_f32 v78, v217, v117
    v_mul_f32 v86, v218, v118
    v_mul_f32 v94, v219, v119
    v_mul_f32 v71, v220, v116
    v_mul_f32 v79, v221, v117
    v_mul_f32 v87, v222, v118
    v_mul_f32 v95, v223, v119
    s_mov_b32 s15, 0
G_all17_w:
    ds_read_b128 v[12:15], v11 offset:0
    s_waitcnt lgkmcnt(0)
    v_min3_u32 v12, v12, v13, v14
    v_min_u32 v12, v12, v15
    v_cmp_gt_u32 vcc, 17, v12
    s_cbranch_vccz G_all17_ok
    s_add_u32 s15, s15, 1
    s_cmp_lt_u32 s15, 160000
    s_cbranch_scc1 G_all17_w
G_all17_ok:
    ds_read_b64_tr_b16 v[128:129], v20 offset:0
    ds_read_b64_tr_b16 v[130:131], v21 offset:512
    ds_read_b64_tr_b16 v[132:133], v21 offset:0
    ds_read_b64_tr_b16 v[134:135], v20 offset:512
    ds_read_b64_tr_b16 v[136:137], v20 offset:8192
    ds_read_b64_tr_b16 v[138:139], v21 offset:8704
    ds_read_b64_tr_b16 v[140:141], v21 offset:8192
    ds_read_b64_tr_b16 v[142:143], v20 offset:8704
    ds_read_b64_tr_b16 v[144:145], v20 offset:4096
    ds_read_b64_tr_b16 v[146:147], v21 offset:4608
    ds_read_b64_tr_b16 v[148:149], v21 offset:4096
    ds_read_b64_tr_b16 v[150:151], v20 offset:4608
    ds_read_b64_tr_b16 v[152:153], v20 offset:12288
    ds_read_b64_tr_b16 v[154:155], v21 offset:12800
    ds_read_b64_tr_b16 v[156:157], v21 offset:12288
    ds_read_b64_tr_b16 v[158:159], v20 offset:12800
    v_mov_b32 v18, 1
    s_waitcnt vmcnt(0)
    s_mov_b64 exec, 1
    ds_add_rtn_u32 v18, v11, v18 offset:52
    s_waitcnt lgkmcnt(0)
    v_readfirstlane_b32 s14, v18
    s_cmp_eq_u32 s14, 3
    s_cbranch_scc0 G_nl
    buffer_store_dwordx2 v[30:31], v23, s[72:75], s11 offen sc1
    s_mov_b64 exec, -1
G_nl:
    s_mov_b64 exec, -1
    s_mov_b32 s15, 0
G_f0_w:
    ds_read_b32 v18, v11 offset:60
    s_waitcnt lgkmcnt(0)
    v_cmp_gt_u32 vcc, 4, v18
    s_cbranch_vccz G_f0_ok
    s_sleep 1
    s_add_u32 s15, s15, 1
    s_cmp_lt_u32 s15, 160000
    s_cbranch_scc1 G_f0_w
G_f0_ok:
    ds_read_b128 v[192:195], v6 offset:0
    ds_read_b128 v[196:199], v6 offset:2048
    ds_read_b128 v[200:203], v6 offset:4096
    ds_read_b128 v[204:207], v6 offset:6144
    ds_read_b128 v[208:211], v7 offset:0
    ds_read_b128 v[212:215], v7 offset:2048
    ds_read_b128 v[216:219], v7 offset:4096
    s_waitcnt lgkmcnt(6)
    v_mfma_f32_16x16x32_bf16 v[64:67], v[128:131], v[192:195], v[64:67]
    ds_read_b128 v[220:223], v7 offset:6144
    v_mfma_f32_16x16x32_bf16 v[68:71], v[132:135], v[192:195], v[68:71]
    s_bfe_u32 s18, s101, 4 + (4 << 16)
    s_lshl_b32 s18, s18, 7
    buffer_load_dwordx4 v[48:51], v16, s[80:83], s18 offen offset:0
    s_waitcnt lgkmcnt(6)
    v_mfma_f32_16x16x32_bf16 v[72:75], v[128:131], v[196:199], v[72:75]
    ds_read_b128 v[192:195], v6 offset:8192
    v_mfma_f32_16x16x32_bf16 v[76:79], v[132:135], v[196:199], v[76:79]
    s_waitcnt lgkmcnt(6)
    v_mfma_f32_16x16x32_bf16 v[80:83], v[128:131], v[200:203], v[80:83]
    ds_read_b128 v[196:199], v6 offset:10240
    v_mfma_f32_16x16x32_bf16 v[84:87], v[132:135], v[200:203], v[84:87]
    buffer_load_dwordx4 v[52:55], v17, s[80:83], s18 offen offset:1024
    s_waitcnt lgkmcnt(6)
    v_mfma_f32_16x16x32_bf16 v[88:91], v[128:131], v[204:207], v[88:91]
    ds_read_b128 v[200:203], v6 offset:12288
    v_mfma_f32_16x16x32_bf16 v[92:95], v[132:135], v[204:207], v[92:95]
    s_waitcnt lgkmcnt(6)
    v_mfma_f32_16x16x32_bf16 v[64:67], v[136:139], v[208:211], v[64:67]
    ds_read_b128 v[204:207], v6 offset:14336
    v_mfma_f32_16x16x32_bf16 v[68:71], v[140:143], v[208:211], v[68:71]
    buffer_load_dwordx4 v[56:59], v16, s[80:83], s18 offen offset:2048
    s_waitcnt lgkmcnt(6)
    v_mfma_f32_16x16x32_bf16 v[72:75], v[136:139], v[212:215], v[72:75]
    ds_read_b128 v[208:211], v7 offset:8192
    v_mfma_f32_16x16x32_bf16 v[76:79], v[140:143], v[212:215], v[76:79]
    s_waitcnt lgkmcnt(6)
    v_mfma_f32_16x16x32_bf16 v[80:83], v[136:139], v[216:219], v[80:83]
    ds_read_b128 v[212:215], v7 offset:10240
    v_mfma_f32_16x16x32_bf16 v[84:87], v[140:143], v[216:219], v[84:87]
    buffer_load_dwordx4 v[60:63], v17, s[80:83], s18 offen offset:3072
    s_waitcnt lgkmcnt(6)
    v_mfma_f32_16x16x32_bf16 v[88:91], v[136:139], v[220:223], v[88:91]
    ds_read_b128 v[216:219], v7 offset:12288
    v_mfma_f32_16x16x32_bf16 v[92:95], v[140:143], v[220:223], v[92:95]
    s_waitcnt lgkmcnt(6)
    v_mfma_f32_16x16x32_bf16 v[64:67], v[144:147], v[192:195], v[64:67]
    ds_read_b128 v[220:223], v7 offset:14336
    v_mfma_f32_16x16x32_bf16 v[68:71], v[148:151], v[192:195], v[68:71]
    s_bfe_u32 s18, s101, 8 + (4 << 16)
    s_lshl_b32 s18, s18, 7
    buffer_load_dwordx4 v[32:35], v16, s[80:83], s18 offen offset:0
    s_waitcnt lgkmcnt(6)
    v_mfma_f32_16x16x32_bf16 v[72:75], v[144:147], v[196:199], v[72:75]
    ds_read_b128 v[192:195], v6 offset:16384
    v_mfma_f32_16x16x32_bf16 v[76:79], v[148:151], v[196:199], v[76:79]
    s_waitcnt lgkmcnt(6)
    v_mfma_f32_16x16x32_bf16 v[80:83], v[144:147], v[200:203], v[80:83]
    ds_read_b128 v[196:199], v6 offset:18432
    v_mfma_f32_16x16x32_bf16 v[84:87], v[148:151], v[200:203], v[84:87]
    buffer_load_dwordx4 v[36:39], v17, s[80:83], s18 offen offset:1024
    s_waitcnt lgkmcnt(6)
    v_mfma_f32_16x16x32_bf16 v[88:91], v[144:147], v[204:207], v[88:91]
    ds_read_b128 v[200:203], v6 offset:20480
    v_mfma_f32_16x16x32_bf16 v[92:95], v[148:151], v[204:207], v[92:95]
    s_waitcnt lgkmcnt(6)
    v_mfma_f32_16x16x32_bf16 v[64:67], v[152:155], v[208:211], v[64:67]
    ds_read_b128 v[204:207], v6 offset:22528
    v_mfma_f32_16x16x32_bf16 v[68:71], v[156:159], v[208:211], v[68:71]
    buffer_load_dwordx4 v[40:43], v16, s[80:83], s18 offen offset:2048
    s_waitcnt lgkmcnt(6)
    v_mfma_f32_16x16x32_bf16 v[72:75], v[152:155], v[212:215], v[72:75]
    ds_read_b128 v[208:211], v7 offset:16384
    v_mfma_f32_16x16x32_bf16 v[76:79], v[156:159], v[212:215], v[76:79]
    s_waitcnt lgkmcnt(6)
    v_mfma_f32_16x16x32_bf16 v[80:83], v[152:155], v[216:219], v[80:83]
    ds_read_b128 v[212:215], v7 offset:18432
    v_mfma_f32_16x16x32_bf16 v[84:87], v[156:159], v[216:219], v[84:87]
    buffer_load_dwordx4 v[44:47], v17, s[80:83], s18 offen offset:3072
    s_waitcnt lgkmcnt(6)
    v_mfma_f32_16x16x32_bf16 v[88:91], v[152:155], v[220:223], v[88:91]
    ds_read_b128 v[216:219], v7 offset:20480
    v_mfma_f32_16x16x32_bf16 v[92:95], v[156:159], v[220:223], v[92:95]
    v_mov_b32 v22, 18
    ds_write_b32 v10, v22
    s_bfe_u32 s18, s101, 12 + (4 << 16)
    s_lshl_b32 s18, s18, 7
    buffer_load_dwordx4 v[96:99], v16, s[80:83], s18 offen offset:0
    buffer_load_dwordx4 v[100:103], v17, s[80:83], s18 offen offset:1024
    buffer_load_dwordx4 v[104:107], v16, s[80:83], s18 offen offset:2048
    buffer_load_dwordx4 v[108:111], v17, s[80:83], s18 offen offset:3072
    s_bfe_u32 s18, s101, 16 + (4 << 16)
    s_lshl_b32 s18, s18, 7
    buffer_load_dwordx4 v[112:115], v16, s[80:83], s18 offen offset:0
    buffer_load_dwordx4 v[116:119], v17, s[80:83], s18 offen offset:1024
    buffer_load_dwordx4 v[120:123], v16, s[80:83], s18 offen offset:2048
    buffer_load_dwordx4 v[124:127], v17, s[80:83], s18 offen offset:3072
    s_mov_b32 s15, 0
G_all18_w:
    ds_read_b128 v[12:15], v11 offset:0
    s_waitcnt lgkmcnt(0)
    v_min3_u32 v12, v12, v13, v14
    v_min_u32 v12, v12, v15
    v_cmp_gt_u32 vcc, 18, v12
    s_cbranch_vccz G_all18_ok
    s_add_u32 s15, s15, 1
    s_cmp_lt_u32 s15, 160000
    s_cbranch_scc1 G_all18_w
G_all18_ok:
    s_cmp_eq_u32 s14, 3
    s_cbranch_scc0 G_pl
    buffer_load_dwordx2 v[28:29], v5, s[72:75], 0 offen sc1
G_pl:
    s_bfe_u32 s18, s100, 16 + (4 << 16)
    s_lshl_b32 s18, s18, 7
    s_add_u32 m0, s22, 65536
    s_nop 0
    buffer_load_dwordx4 v16, s[80:83], s18 offen offset:0 lds
    buffer_load_dwordx4 v17, s[80:83], s18 offen offset:1024 lds
    buffer_load_dwordx4 v16, s[80:83], s18 offen offset:2048 lds
    buffer_load_dwordx4 v17, s[80:83], s18 offen offset:3072 lds
    s_bfe_u32 s18, s100, 20 + (4 << 16)
    s_lshl_b32 s18, s18, 7
    s_add_u32 m0, s22, 81920
    s_nop 0
    buffer_load_dwordx4 v16, s[80:83], s18 offen offset:0 lds
    buffer_load_dwordx4 v17, s[80:83], s18 offen offset:1024 lds
    buffer_load_dwordx4 v16, s[80:83], s18 offen offset:2048 lds
    buffer_load_dwordx4 v17, s[80:83], s18 offen offset:3072 lds
    s_bfe_u32 s18, s100, 24 + (4 << 16)
    s_lshl_b32 s18, s18, 7
    s_add_u32 m0, s22, 0
    s_nop 0
    buffer_load_dwordx4 v16, s[80:83], s18 offen offset:0 lds
    buffer_load_dwordx4 v17, s[80:83], s18 offen offset:1024 lds
    buffer_load_dwordx4 v16, s[80:83], s18 offen offset:2048 lds
    buffer_load_dwordx4 v17, s[80:83], s18 offen offset:3072 lds
    s_mov_b32 s15, 0
    s_cmp_eq_u32 s14, 3
    s_cbranch_scc0 G_np
    s_waitcnt vmcnt(12)
GH_chk:
    v_cmp_ne_u64 vcc, v[28:29], v[30:31]
    s_and_b64 vcc, vcc, s[20:21]
    s_cbranch_scc0 GH_ok
    buffer_load_dwordx2 v[28:29], v5, s[72:75], 0 offen sc1
    s_add_u32 s15, s15, 1
    s_cmp_lt_u32 s15, 20000
    s_waitcnt vmcnt(0)
    s_cbranch_scc1 GH_chk
GH_ok:
    ds_write_b32 v11, v22 offset:56
    s_branch G_go
G_np:
    s_mov_b32 s15, 0
G_fho_w:
    ds_read_b32 v18, v11 offset:56
    s_waitcnt lgkmcnt(0)
    v_cmp_gt_u32 vcc, 1, v18
    s_cbranch_vccz G_fho_ok
    s_sleep 1
    s_add_u32 s15, s15, 1
    s_cmp_lt_u32 s15, 160000
    s_cbranch_scc1 G_fho_w
G_fho_ok:
G_go:
    s_bfe_u32 s19, s100, 4 + (4 << 16)
    s_lshl_b32 s19, s19, 13
    buffer_load_dwordx4 v[160:163], v26, s[68:71], s19 offen offset:0 sc1
    buffer_load_dwordx4 v[164:167], v26, s[68:71], s19 offen offset:1024 sc1
    buffer_load_dwordx4 v[168:171], v26, s[68:71], s19 offen offset:2048 sc1
    buffer_load_dwordx4 v[172:175], v26, s[68:71], s19 offen offset:3072 sc1
    buffer_load_dwordx4 v[176:179], v27, s[68:71], s19 offen offset:0 sc1
    buffer_load_dwordx4 v[180:183], v27, s[68:71], s19 offen offset:1024 sc1
    buffer_load_dwordx4 v[184:187], v27, s[68:71], s19 offen offset:2048 sc1
    buffer_load_dwordx4 v[188:191], v27, s[68:71], s19 offen offset:3072 sc1
    s_bfe_u32 s19, s100, 8 + (4 << 16)
    s_lshl_b32 s19, s19, 13
    buffer_load_dwordx4 v[128:131], v26, s[68:71], s19 offen offset:0 sc1
    buffer_load_dwordx4 v[132:135], v26, s[68:71], s19 offen offset:1024 sc1
    buffer_load_dwordx4 v[136:139], v26, s[68:71], s19 offen offset:2048 sc1
    buffer_load_dwordx4 v[140:143], v26, s[68:71], s19 offen offset:3072 sc1
    buffer_load_dwordx4 v[144:147], v27, s[68:71], s19 offen offset:0 sc1
    buffer_load_dwordx4 v[148:151], v27, s[68:71], s19 offen offset:1024 sc1
    buffer_load_dwordx4 v[152:155], v27, s[68:71], s19 offen offset:2048 sc1
    buffer_load_dwordx4 v[156:159], v27, s[68:71], s19 offen offset:3072 sc1
    s_setprio 1
    s_waitcnt vmcnt(14)
    v_mfma_f32_16x16x32_bf16 v[64:67], v[160:163], v[192:195], v[64:67]
    ds_read_b128 v[220:223], v7 offset:22528
    v_mov_b32 v22, 19
    v_mfma_f32_16x16x32_bf16 v[68:71], v[164:167], v[192:195], v[68:71]
    v_mfma_f32_16x16x32_bf16 v[72:75], v[160:163], v[196:199], v[72:75]
    ds_read_b128 v[192:195], v6 offset:24576
    v_mfma_f32_16x16x32_bf16 v[76:79], v[164:167], v[196:199], v[76:79]
    ds_write_b32 v10, v22
    v_mfma_f32_16x16x32_bf16 v[80:83], v[160:163], v[200:203], v[80:83]
    ds_read_b128 v[196:199], v6 offset:26624
    v_mfma_f32_16x16x32_bf16 v[84:87], v[164:167], v[200:203], v[84:87]
    v_mfma_f32_16x16x32_bf16 v[88:91], v[160:163], v[204:207], v[88:91]
    ds_read_b128 v[200:203], v6 offset:28672
    s_bfe_u32 s19, s100, 12 + (4 << 16)
    v_mfma_f32_16x16x32_bf16 v[92:95], v[164:167], v[204:207], v[92:95]
    s_lshl_b32 s19, s19, 13
    s_waitcnt vmcnt(12)
    v_mfma_f32_16x16x32_bf16 v[64:67], v[168:171], v[208:211], v[64:67]
    ds_read_b128 v[204:207], v6 offset:30720
    v_mfma_f32_16x16x32_bf16 v[68:71], v[172:175], v[208:211], v[68:71]
    buffer_load_dwordx4 v[160:163], v26, s[68:71], s19 offen offset:0 sc1
    v_mfma_f32_16x16x32_bf16 v[72:75], v[168:171], v[212:215], v[72:75]
    ds_read_b128 v[208:211], v7 offset:24576
    v_mfma_f32_16x16x32_bf16 v[76:79], v[172:175], v[212:215], v[76:79]
    v_mfma_f32_16x16x32_bf16 v[80:83], v[168:171], v[216:219], v[80:83]
    ds_read_b128 v[212:215], v7 offset:26624
    v_mfma_f32_16x16x32_bf16 v[84:87], v[172:175], v[216:219], v[84:87]
    buffer_load_dwordx4 v[164:167], v26, s[68:71], s19 offen offset:1024 sc1
    s_waitcnt lgkmcnt(7)
    v_mfma_f32_16x16x32_bf16 v[88:91], v[168:171], v[220:223], v[88:91]
    ds_read_b128 v[216:219], v7 offset:28672
    v_mfma_f32_16x16x32_bf16 v[92:95], v[172:175], v[220:223], v[92:95]
    s_waitcnt vmcnt(12) lgkmcnt(7)
    v_mfma_f32_16x16x32_bf16 v[64:67], v[176:179], v[192:195], v[64:67]
    ds_read_b128 v[220:223], v7 offset:30720
    v_mfma_f32_16x16x32_bf16 v[68:71], v[180:183], v[192:195], v[68:71]
    buffer_load_dwordx4 v[168:171], v26, s[68:71], s19 offen offset:2048 sc1
    s_waitcnt lgkmcnt(6)
    v_mfma_f32_16x16x32_bf16 v[72:75], v[176:179], v[196:199], v[72:75]
    ds_read_b128 v[192:195], v6 offset:32768
    v_mfma_f32_16x16x32_bf16 v[76:79], v[180:183], v[196:199], v[76:79]
    s_waitcnt lgkmcnt(6)
    v_mfma_f32_16x16x32_bf16 v[80:83], v[176:179], v[200:203], v[80:83]
    ds_read_b128 v[196:199], v6 offset:34816
    v_mfma_f32_16x16x32_bf16 v[84:87], v[180:183], v[200:203], v[84:87]
    buffer_load_dwordx4 v[172:175], v26, s[68:71], s19 offen offset:3072 sc1
    s_waitcnt lgkmcnt(6)
    v_mfma_f32_16x16x32_bf16 v[88:91], v[176:179], v[204:207], v[88:91]
    ds_read_b128 v[200:203], v6 offset:36864
    v_mfma_f32_16x16x32_bf16 v[92:95], v[180:183], v[204:207], v[92:95]
    s_waitcnt vmcnt(12) lgkmcnt(6)
    v_mfma_f32_16x16x32_bf16 v[64:67], v[184:187], v[208:211], v[64:67]
    ds_read_b128 v[204:207], v6 offset:38912
    v_mfma_f32_16x16x32_bf16 v[68:71], v[188:191], v[208:211], v[68:71]
    buffer_load_dwordx4 v[176:179], v27, s[68:71], s19 offen offset:0 sc1
    s_waitcnt lgkmcnt(6)
    v_mfma_f32_16x16x32_bf16 v[72:75], v[184:187], v[212:215], v[72:75]
    ds_read_b128 v[208:211], v7 offset:32768
    v_mfma_f32_16x16x32_bf16 v[76:79], v[188:191], v[212:215], v[76:79]
    s_waitcnt lgkmcnt(6)
    v_mfma_f32_16x16x32_bf16 v[80:83], v[184:187], v[216:219], v[80:83]
    ds_read_b128 v[212:215], v7 offset:34816
    v_mfma_f32_16x16x32_bf16 v[84:87], v[188:191], v[216:219], v[84:87]
    buffer_load_dwordx4 v[180:183], v27, s[68:71], s19 offen offset:1024 sc1
    s_waitcnt lgkmcnt(6)
    v_mfma_f32_16x16x32_bf16 v[88:91], v[184:187], v[220:223], v[88:91]
    ds_read_b128 v[216:219], v7 offset:36864
    v_mfma_f32_16x16x32_bf16 v[92:95], v[188:191], v[220:223], v[92:95]
    s_waitcnt vmcnt(12) lgkmcnt(6)
    v_mfma_f32_16x16x32_bf16 v[64:67], v[128:131], v[192:195], v[64:67]
    ds_read_b128 v[220:223], v7 offset:38912
    v_mov_b32 v22, 20
    v_mfma_f32_16x16x32_bf16 v[68:71], v[132:135], v[192:195], v[68:71]
    buffer_load_dwordx4 v[184:187], v27, s[68:71], s19 offen offset:2048 sc1
    s_waitcnt lgkmcnt(6)
    v_mfma_f32_16x16x32_bf16 v[72:75], v[128:131], v[196:199], v[72:75]
    ds_read_b128 v[192:195], v6 offset:40960
    v_mfma_f32_16x16x32_bf16 v[76:79], v[132:135], v[196:199], v[76:79]
    ds_write_b32 v10, v22
    s_waitcnt lgkmcnt(7)
    v_mfma_f32_16x16x32_bf16 v[80:83], v[128:131], v[200:203], v[80:83]
    ds_read_b128 v[196:199], v6 offset:43008
    v_mfma_f32_16x16x32_bf16 v[84:87], v[132:135], v[200:203], v[84:87]
    buffer_load_dwordx4 v[188:191], v27, s[68:71], s19 offen offset:3072 sc1
    s_waitcnt lgkmcnt(7)
    v_mfma_f32_16x16x32_bf16 v[88:91], v[128:131], v[204:207], v[88:91]
    ds_read_b128 v[200:203], v6 offset:45056
    s_bfe_u32 s19, s100, 16 + (4 << 16)
    v_mfma_f32_16x16x32_bf16 v[92:95], v[132:135], v[204:207], v[92:95]
    s_lshl_b32 s19, s19, 13
    s_waitcnt vmcnt(12) lgkmcnt(7)
    v_mfma_f32_16x16x32_bf16 v[64:67], v[136:139], v[208:211], v[64:67]
    ds_read_b128 v[204:207], v6 offset:47104
    v_mfma_f32_16x16x32_bf16 v[68:71], v[140:143], v[208:211], v[68:71]
    buffer_load_dwordx4 v[128:131], v26, s[68:71], s19 offen offset:0 sc1
    s_waitcnt lgkmcnt(7)
    v_mfma_f32_16x16x32_bf16 v[72:75], v[136:139], v[212:215], v[72:75]
    ds_read_b128 v[208:211], v7 offset:40960
    v_mfma_f32_16x16x32_bf16 v[76:79], v[140:143], v[212:215], v[76:79]
    s_waitcnt lgkmcnt(7)
    v_mfma_f32_16x16x32_bf16 v[80:83], v[136:139], v[216:219], v[80:83]
    ds_read_b128 v[212:215], v7 offset:43008
    v_mfma_f32_16x16x32_bf16 v[84:87], v[140:143], v[216:219], v[84:87]
    buffer_load_dwordx4 v[132:135], v26, s[68:71], s19 offen offset:1024 sc1
    s_waitcnt lgkmcnt(7)
    v_mfma_f32_16x16x32_bf16 v[88:91], v[136:139], v[220:223], v[88:91]
    ds_read_b128 v[216:219], v7 offset:45056
    v_mfma_f32_16x16x32_bf16 v[92:95], v[140:143], v[220:223], v[92:95]
    s_waitcnt vmcnt(12) lgkmcnt(7)
    v_mfma_f32_16x16x32_bf16 v[64:67], v[144:147], v[192:195], v[64:67]
    ds_read_b128 v[220:223], v7 offset:47104
    v_mfma_f32_16x16x32_bf16 v[68:71], v[148:151], v[192:195], v[68:71]
    buffer_load_dwordx4 v[136:139], v26, s[68:71], s19 offen offset:2048 sc1
    s_waitcnt lgkmcnt(6)
    v_mfma_f32_16x16x32_bf16 v[72:75], v[144:147], v[196:199], v[72:75]
    ds_read_b128 v[192:195], v6 offset:49152
    v_mfma_f32_16x16x32_bf16 v[76:79], v[148:151], v[196:199], v[76:79]
    s_waitcnt lgkmcnt(6)
    v_mfma_f32_16x16x32_bf16 v[80:83], v[144:147], v[200:203], v[80:83]
    ds_read_b128 v[196:199], v6 offset:51200
    ds_read_b128 v[12:15], v11
    v_mfma_f32_16x16x32_bf16 v[84:87], v[148:151], v[200:203], v[84:87]
    buffer_load_dwordx4 v[140:143], v26, s[68:71], s19 offen offset:3072 sc1
    s_waitcnt lgkmcnt(7)
    v_mfma_f32_16x16x32_bf16 v[88:91], v[144:147], v[204:207], v[88:91]
    ds_read_b128 v[200:203], v6 offset:53248
    v_mfma_f32_16x16x32_bf16 v[92:95], v[148:151], v[204:207], v[92:95]
    s_waitcnt vmcnt(12) lgkmcnt(7)
    v_mfma_f32_16x16x32_bf16 v[64:67], v[152:155], v[208:211], v[64:67]
    ds_read_b128 v[204:207], v6 offset:55296
    v_mfma_f32_16x16x32_bf16 v[68:71], v[156:159], v[208:211], v[68:71]
    buffer_load_dwordx4 v[144:147], v27, s[68:71], s19 offen offset:0 sc1
    s_waitcnt lgkmcnt(7)
    v_mfma_f32_16x16x32_bf16 v[72:75], v[152:155], v[212:215], v[72:75]
    ds_read_b128 v[208:211], v7 offset:49152
    v_mfma_f32_16x16x32_bf16 v[76:79], v[156:159], v[212:215], v[76:79]
    s_waitcnt lgkmcnt(7)
    v_mfma_f32_16x16x32_bf16 v[80:83], v[152:155], v[216:219], v[80:83]
    ds_read_b128 v[212:215], v7 offset:51200
    v_mfma_f32_16x16x32_bf16 v[84:87], v[156:159], v[216:219], v[84:87]
    buffer_load_dwordx4 v[148:151], v27, s[68:71], s19 offen offset:1024 sc1
    s_waitcnt lgkmcnt(7)
    v_mfma_f32_16x16x32_bf16 v[88:91], v[152:155], v[220:223], v[88:91]
    ds_read_b128 v[216:219], v7 offset:53248
    v_mfma_f32_16x16x32_bf16 v[92:95], v[156:159], v[220:223], v[92:95]
    s_waitcnt vmcnt(12) lgkmcnt(7)
    v_mfma_f32_16x16x32_bf16 v[64:67], v[160:163], v[192:195], v[64:67]
    ds_read_b128 v[220:223], v7 offset:55296
    v_mov_b32 v22, 21
    v_mfma_f32_16x16x32_bf16 v[68:71], v[164:167], v[192:195], v[68:71]
    buffer_load_dwordx4 v[152:155], v27, s[68:71], s19 offen offset:2048 sc1
    s_waitcnt lgkmcnt(7)
    v_mfma_f32_16x16x32_bf16 v[72:75], v[160:163], v[196:199], v[72:75]
    ds_read_b128 v[192:195], v6 offset:57344
    s_waitcnt lgkmcnt(7)
    v_min3_u32 v12, v12, v13, v14
    v_mfma_f32_16x16x32_bf16 v[76:79], v[164:167], v[196:199], v[76:79]
    ds_write_b32 v10, v22
    s_waitcnt lgkmcnt(7)
    v_mfma_f32_16x16x32_bf16 v[80:83], v[160:163], v[200:203], v[80:83]
    ds_read_b128 v[196:199], v6 offset:59392
    v_min_u32 v12, v12, v15
    v_mfma_f32_16x16x32_bf16 v[84:87], v[164:167], v[200:203], v[84:87]
    buffer_load_dwordx4 v[156:159], v27, s[68:71], s19 offen offset:3072 sc1
    s_waitcnt lgkmcnt(7)
    v_mfma_f32_16x16x32_bf16 v[88:91], v[160:163], v[204:207], v[88:91]
    ds_read_b128 v[200:203], v6 offset:61440
    s_bfe_u32 s19, s100, 20 + (4 << 16)
    v_mfma_f32_16x16x32_bf16 v[92:95], v[164:167], v[204:207], v[92:95]
    s_lshl_b32 s19, s19, 13
    s_waitcnt vmcnt(12) lgkmcnt(7)
    v_mfma_f32_16x16x32_bf16 v[64:67], v[168:171], v[208:211], v[64:67]
    ds_read_b128 v[204:207], v6 offset:63488
    v_cmp_gt_u32 vcc, 20, v12
    v_mfma_f32_16x16x32_bf16 v[68:71], v[172:175], v[208:211], v[68:71]
    buffer_load_dwordx4 v[160:163], v26, s[68:71], s19 offen offset:0 sc1
    s_waitcnt lgkmcnt(7)
    v_mfma_f32_16x16x32_bf16 v[72:75], v[168:171], v[212:215], v[72:75]
    ds_read_b128 v[208:211], v7 offset:57344
    s_cbranch_vccnz G2_slow3
G2_back3:
    v_mfma_f32_16x16x32_bf16 v[76:79], v[172:175], v[212:215], v[76:79]
    ds_write_b64 v0, v[224:225] offset:16384
    s_waitcnt lgkmcnt(8)
    v_mfma_f32_16x16x32_bf16 v[80:83], v[168:171], v[216:219], v[80:83]
    ds_read_b128 v[212:215], v7 offset:59392
    v_mfma_f32_16x16x32_bf16 v[84:87], v[172:175], v[216:219], v[84:87]
    buffer_load_dwordx4 v[164:167], v26, s[68:71], s19 offen offset:1024 sc1
    s_waitcnt lgkmcnt(8)
    v_mfma_f32_16x16x32_bf16 v[88:91], v[168:171], v[220:223], v[88:91]
    ds_read_b128 v[216:219], v7 offset:61440
    v_mfma_f32_16x16x32_bf16 v[92:95], v[172:175], v[220:223], v[92:95]
    ds_write_b64 v0, v[226:227] offset:16392
    s_waitcnt vmcnt(12) lgkmcnt(9)
    v_mfma_f32_16x16x32_bf16 v[64:67], v[176:179], v[192:195], v[64:67]
    ds_read_b128 v[220:223], v7 offset:63488
    ds_write_b64 v0, v[228:229] offset:17408
    v_mfma_f32_16x16x32_bf16 v[68:71], v[180:183], v[192:195], v[68:71]
    buffer_load_dwordx4 v[168:171], v26, s[68:71], s19 offen offset:2048 sc1
    s_waitcnt lgkmcnt(9)
    v_mfma_f32_16x16x32_bf16 v[72:75], v[176:179], v[196:199], v[72:75]
    ds_read_b128 v[192:195], v8 offset:0
    v_mfma_f32_16x16x32_bf16 v[76:79], v[180:183], v[196:199], v[76:79]
    ds_write_b64 v0, v[230:231] offset:17416
    s_waitcnt lgkmcnt(10)
    v_mfma_f32_16x16x32_bf16 v[80:83], v[176:179], v[200:203], v[80:83]
    ds_read_b128 v[196:199], v8 offset:2048
    ds_read_b128 v[12:15], v11
    v_mfma_f32_16x16x32_bf16 v[84:87], v[180:183], v[200:203], v[84:87]
    buffer_load_dwordx4 v[172:175], v26, s[68:71], s19 offen offset:3072 sc1
    s_waitcnt lgkmcnt(11)
    v_mfma_f32_16x16x32_bf16 v[88:91], v[176:179], v[204:207], v[88:91]
    ds_read_b128 v[200:203], v8 offset:4096
    v_mfma_f32_16x16x32_bf16 v[92:95], v[180:183], v[204:207], v[92:95]
    ds_write_b64 v0, v[232:233] offset:18432
    s_waitcnt vmcnt(12) lgkmcnt(12)
    v_mfma_f32_16x16x32_bf16 v[64:67], v[184:187], v[208:211], v[64:67]
    ds_read_b128 v[204:207], v8 offset:6144
    ds_write_b64 v0, v[234:235] offset:18440
    v_mfma_f32_16x16x32_bf16 v[68:71], v[188:191], v[208:211], v[68:71]
    buffer_load_dwordx4 v[176:179], v27, s[68:71], s19 offen offset:0 sc1
    s_waitcnt lgkmcnt(12)
    v_mfma_f32_16x16x32_bf16 v[72:75], v[184:187], v[212:215], v[72:75]
    ds_read_b128 v[208:211], v9 offset:0
    v_mfma_f32_16x16x32_bf16 v[76:79], v[188:191], v[212:215], v[76:79]
    ds_write_b64 v0, v[236:237] offset:19456
    s_waitcnt lgkmcnt(13)
    v_mfma_f32_16x16x32_bf16 v[80:83], v[184:187], v[216:219], v[80:83]
    ds_read_b128 v[212:215], v9 offset:2048
    v_mfma_f32_16x16x32_bf16 v[84:87], v[188:191], v[216:219], v[84:87]
    buffer_load_dwordx4 v[180:183], v27, s[68:71], s19 offen offset:1024 sc1
    s_waitcnt lgkmcnt(12)
    v_mfma_f32_16x16x32_bf16 v[88:91], v[184:187], v[220:223], v[88:91]
    ds_read_b128 v[216:219], v9 offset:4096
    v_mfma_f32_16x16x32_bf16 v[92:95], v[188:191], v[220:223], v[92:95]
    ds_write_b64 v0, v[238:239] offset:19464
    s_waitcnt vmcnt(12) lgkmcnt(12)
    v_mfma_f32_16x16x32_bf16 v[64:67], v[128:131], v[192:195], v[64:67]
    ds_read_b128 v[220:223], v9 offset:6144
    v_mov_b32 v22, 22
    v_mfma_f32_16x16x32_bf16 v[68:71], v[132:135], v[192:195], v[68:71]
    buffer_load_dwordx4 v[184:187], v27, s[68:71], s19 offen offset:2048 sc1
    s_waitcnt lgkmcnt(11)
    v_mfma_f32_16x16x32_bf16 v[72:75], v[128:131], v[196:199], v[72:75]
    ds_read_b128 v[192:195], v8 offset:8192
    s_waitcnt lgkmcnt(11)
    v_min3_u32 v12, v12, v13, v14
    v_mfma_f32_16x16x32_bf16 v[76:79], v[132:135], v[196:199], v[76:79]
    ds_write_b32 v10, v22
    s_waitcnt lgkmcnt(11)
    v_mfma_f32_16x16x32_bf16 v[80:83], v[128:131], v[200:203], v[80:83]
    ds_read_b128 v[196:199], v8 offset:10240
    v_min_u32 v12, v12, v15
    v_mfma_f32_16x16x32_bf16 v[84:87], v[132:135], v[200:203], v[84:87]
    buffer_load_dwordx4 v[188:191], v27, s[68:71], s19 offen offset:3072 sc1
    s_waitcnt lgkmcnt(10)
    v_mfma_f32_16x16x32_bf16 v[88:91], v[128:131], v[204:207], v[88:91]
    ds_read_b128 v[200:203], v8 offset:12288
    s_bfe_u32 s19, s100, 24 + (4 << 16)
    v_mfma_f32_16x16x32_bf16 v[92:95], v[132:135], v[204:207], v[92:95]
    s_lshl_b32 s19, s19, 13
    s_waitcnt vmcnt(12) lgkmcnt(9)
    v_mfma_f32_16x16x32_bf16 v[64:67], v[136:139], v[208:211], v[64:67]
    ds_read_b128 v[204:207], v8 offset:14336
    v_cmp_gt_u32 vcc, 21, v12
    v_mfma_f32_16x16x32_bf16 v[68:71], v[140:143], v[208:211], v[68:71]
    buffer_load_dwordx4 v[128:131], v26, s[68:71], s19 offen offset:0 sc1
    s_waitcnt lgkmcnt(8)
    v_mfma_f32_16x16x32_bf16 v[72:75], v[136:139], v[212:215], v[72:75]
    ds_read_b128 v[208:211], v9 offset:8192
    s_cbranch_vccnz G2_slow4
G2_back4:
    v_mfma_f32_16x16x32_bf16 v[76:79], v[140:143], v[212:215], v[76:79]
    ds_write_b64 v0, v[240:241] offset:32768
    s_waitcnt lgkmcnt(9)
    v_mfma_f32_16x16x32_bf16 v[80:83], v[136:139], v[216:219], v[80:83]
    ds_read_b128 v[212:215], v9 offset:10240
    v_mfma_f32_16x16x32_bf16 v[84:87], v[140:143], v[216:219], v[84:87]
    buffer_load_dwordx4 v[132:135], v26, s[68:71], s19 offen offset:1024 sc1
    s_waitcnt lgkmcnt(8)
    v_mfma_f32_16x16x32_bf16 v[88:91], v[136:139], v[220:223], v[88:91]
    ds_read_b128 v[216:219], v9 offset:12288
    v_mfma_f32_16x16x32_bf16 v[92:95], v[140:143], v[220:223], v[92:95]
    ds_write_b64 v0, v[242:243] offset:32776
    s_waitcnt vmcnt(12) lgkmcnt(9)
    v_mfma_f32_16x16x32_bf16 v[64:67], v[144:147], v[192:195], v[64:67]
    ds_read_b128 v[220:223], v9 offset:14336
    ds_write_b64 v0, v[244:245] offset:33792
    v_mfma_f32_16x16x32_bf16 v[68:71], v[148:151], v[192:195], v[68:71]
    buffer_load_dwordx4 v[136:139], v26, s[68:71], s19 offen offset:2048 sc1
    s_waitcnt lgkmcnt(9)
    v_mfma_f32_16x16x32_bf16 v[72:75], v[144:147], v[196:199], v[72:75]
    ds_read_b128 v[192:195], v8 offset:16384
    v_mfma_f32_16x16x32_bf16 v[76:79], v[148:151], v[196:199], v[76:79]
    ds_write_b64 v0, v[246:247] offset:33800
    s_waitcnt lgkmcnt(10)
    v_mfma_f32_16x16x32_bf16 v[80:83], v[144:147], v[200:203], v[80:83]
    ds_read_b128 v[196:199], v8 offset:18432
    ds_read_b128 v[12:15], v11
    v_mfma_f32_16x16x32_bf16 v[84:87], v[148:151], v[200:203], v[84:87]
    buffer_load_dwordx4 v[140:143], v26, s[68:71], s19 offen offset:3072 sc1
    s_waitcnt lgkmcnt(11)
    v_mfma_f32_16x16x32_bf16 v[88:91], v[144:147], v[204:207], v[88:91]
    ds_read_b128 v[200:203], v8 offset:20480
    v_mfma_f32_16x16x32_bf16 v[92:95], v[148:151], v[204:207], v[92:95]
    ds_write_b64 v0, v[248:249] offset:34816
    s_waitcnt vmcnt(12) lgkmcnt(12)
    v_mfma_f32_16x16x32_bf16 v[64:67], v[152:155], v[208:211], v[64:67]
    ds_read_b128 v[204:207], v8 offset:22528
    ds_write_b64 v0, v[250:251] offset:34824
    v_mfma_f32_16x16x32_bf16 v[68:71], v[156:159], v[208:211], v[68:71]
    buffer_load_dwordx4 v[144:147], v27, s[68:71], s19 offen offset:0 sc1
    s_waitcnt lgkmcnt(12)
    v_mfma_f32_16x16x32_bf16 v[72:75], v[152:155], v[212:215], v[72:75]
    ds_read_b128 v[208:211], v9 offset:16384
    v_mfma_f32_16x16x32_bf16 v[76:79], v[156:159], v[212:215], v[76:79]
    ds_write_b64 v0, v[252:253] offset:35840
    s_waitcnt lgkmcnt(13)
    v_mfma_f32_16x16x32_bf16 v[80:83], v[152:155], v[216:219], v[80:83]
    ds_read_b128 v[212:215], v9 offset:18432
    v_mfma_f32_16x16x32_bf16 v[84:87], v[156:159], v[216:219], v[84:87]
    buffer_load_dwordx4 v[148:151], v27, s[68:71], s19 offen offset:1024 sc1
    s_waitcnt lgkmcnt(12)
    v_mfma_f32_16x16x32_bf16 v[88:91], v[152:155], v[220:223], v[88:91]
    ds_read_b128 v[216:219], v9 offset:20480
    v_mfma_f32_16x16x32_bf16 v[92:95], v[156:159], v[220:223], v[92:95]
    ds_write_b64 v0, v[254:255] offset:35848
    s_waitcnt vmcnt(12) lgkmcnt(12)
    v_mfma_f32_16x16x32_bf16 v[64:67], v[160:163], v[192:195], v[64:67]
    ds_read_b128 v[220:223], v9 offset:22528
    v_mov_b32 v22, 23
    v_mfma_f32_16x16x32_bf16 v[68:71], v[164:167], v[192:195], v[68:71]
    buffer_load_dwordx4 v[152:155], v27, s[68:71], s19 offen offset:2048 sc1
    s_waitcnt lgkmcnt(11)
    v_mfma_f32_16x16x32_bf16 v[72:75], v[160:163], v[196:199], v[72:75]
    ds_read_b128 v[192:195], v8 offset:24576
    s_waitcnt lgkmcnt(11)
    v_min3_u32 v12, v12, v13, v14
    v_mfma_f32_16x16x32_bf16 v[76:79], v[164:167], v[196:199], v[76:79]
    ds_write_b32 v10, v22
    s_waitcnt lgkmcnt(11)
    v_mfma_f32_16x16x32_bf16 v[80:83], v[160:163], v[200:203], v[80:83]
    ds_read_b128 v[196:199], v8 offset:26624
    v_min_u32 v12, v12, v15
    v_mfma_f32_16x16x32_bf16 v[84:87], v[164:167], v[200:203], v[84:87]
    buffer_load_dwordx4 v[156:159], v27, s[68:71], s19 offen offset:3072 sc1
    s_waitcnt lgkmcnt(10)
    v_mfma_f32_16x16x32_bf16 v[88:91], v[160:163], v[204:207], v[88:91]
    ds_read_b128 v[200:203], v8 offset:28672
    s_bfe_u32 s19, s100, 28 + (4 << 16)
    v_mfma_f32_16x16x32_bf16 v[92:95], v[164:167], v[204:207], v[92:95]
    s_lshl_b32 s19, s19, 13
    s_waitcnt vmcnt(12) lgkmcnt(9)
    v_mfma_f32_16x16x32_bf16 v[64:67], v[168:171], v[208:211], v[64:67]
    ds_read_b128 v[204:207], v8 offset:30720
    v_cmp_gt_u32 vcc, 22, v12
    v_mfma_f32_16x16x32_bf16 v[68:71], v[172:175], v[208:211], v[68:71]
    buffer_load_dwordx4 v[160:163], v26, s[68:71], s19 offen offset:0 sc1
    s_waitcnt lgkmcnt(8)
    v_mfma_f32_16x16x32_bf16 v[72:75], v[168:171], v[212:215], v[72:75]
    ds_read_b128 v[208:211], v9 offset:24576
    s_cbranch_vccnz G2_slow5
G2_back5:
    v_mfma_f32_16x16x32_bf16 v[76:79], v[172:175], v[212:215], v[76:79]
    ds_write_b64 v0, v[48:49] offset:49152
    s_waitcnt lgkmcnt(9)
    v_mfma_f32_16x16x32_bf16 v[80:83], v[168:171], v[216:219], v[80:83]
    ds_read_b128 v[212:215], v9 offset:26624
    v_mfma_f32_16x16x32_bf16 v[84:87], v[172:175], v[216:219], v[84:87]
    buffer_load_dwordx4 v[164:167], v26, s[68:71], s19 offen offset:1024 sc1
    s_waitcnt lgkmcnt(8)
    v_mfma_f32_16x16x32_bf16 v[88:91], v[168:171], v[220:223], v[88:91]
    ds_read_b128 v[216:219], v9 offset:28672
    v_mfma_f32_16x16x32_bf16 v[92:95], v[172:175], v[220:223], v[92:95]
    ds_write_b64 v0, v[50:51] offset:49160
    s_waitcnt vmcnt(12) lgkmcnt(9)
    v_mfma_f32_16x16x32_bf16 v[64:67], v[176:179], v[192:195], v[64:67]
    ds_read_b128 v[220:223], v9 offset:30720
    ds_write_b64 v0, v[52:53] offset:50176
    v_mfma_f32_16x16x32_bf16 v[68:71], v[180:183], v[192:195], v[68:71]
    buffer_load_dwordx4 v[168:171], v26, s[68:71], s19 offen offset:2048 sc1
    s_waitcnt lgkmcnt(9)
    v_mfma_f32_16x16x32_bf16 v[72:75], v[176:179], v[196:199], v[72:75]
    ds_read_b128 v[192:195], v6 offset:0
    v_mfma_f32_16x16x32_bf16 v[76:79], v[180:183], v[196:199], v[76:79]
    ds_write_b64 v0, v[54:55] offset:50184
    s_waitcnt lgkmcnt(10)
    v_mfma_f32_16x16x32_bf16 v[80:83], v[176:179], v[200:203], v[80:83]
    ds_read_b128 v[196:199], v6 offset:2048
    ds_read_b128 v[12:15], v11
    v_mfma_f32_16x16x32_bf16 v[84:87], v[180:183], v[200:203], v[84:87]
    buffer_load_dwordx4 v[172:175], v26, s[68:71], s19 offen offset:3072 sc1
    s_waitcnt lgkmcnt(11)
    v_mfma_f32_16x16x32_bf16 v[88:91], v[176:179], v[204:207], v[88:91]
    ds_read_b128 v[200:203], v6 offset:4096
    v_mfma_f32_16x16x32_bf16 v[92:95], v[180:183], v[204:207], v[92:95]
    ds_write_b64 v0, v[56:57] offset:51200
    s_waitcnt vmcnt(12) lgkmcnt(12)
    v_mfma_f32_16x16x32_bf16 v[64:67], v[184:187], v[208:211], v[64:67]
    ds_read_b128 v[204:207], v6 offset:6144
    ds_write_b64 v0, v[58:59] offset:51208
    v_mfma_f32_16x16x32_bf16 v[68:71], v[188:191], v[208:211], v[68:71]
    buffer_load_dwordx4 v[176:179], v27, s[68:71], s19 offen offset:0 sc1
    s_waitcnt lgkmcnt(12)
    v_mfma_f32_16x16x32_bf16 v[72:75], v[184:187], v[212:215], v[72:75]
    ds_read_b128 v[208:211], v7 offset:0
    v_mfma_f32_16x16x32_bf16 v[76:79], v[188:191], v[212:215], v[76:79]
    ds_write_b64 v0, v[60:61] offset:52224
    s_waitcnt lgkmcnt(13)
    v_mfma_f32_16x16x32_bf16 v[80:83], v[184:187], v[216:219], v[80:83]
    ds_read_b128 v[212:215], v7 offset:2048
    v_mfma_f32_16x16x32_bf16 v[84:87], v[188:191], v[216:219], v[84:87]
    buffer_load_dwordx4 v[180:183], v27, s[68:71], s19 offen offset:1024 sc1
    s_waitcnt lgkmcnt(12)
    v_mfma_f32_16x16x32_bf16 v[88:91], v[184:187], v[220:223], v[88:91]
    ds_read_b128 v[216:219], v7 offset:4096
    v_mfma_f32_16x16x32_bf16 v[92:95], v[188:191], v[220:223], v[92:95]
    ds_write_b64 v0, v[62:63] offset:52232
    s_waitcnt vmcnt(12) lgkmcnt(12)
    v_mfma_f32_16x16x32_bf16 v[64:67], v[128:131], v[192:195], v[64:67]
    ds_read_b128 v[220:223], v7 offset:6144
    v_mov_b32 v22, 24
    v_mfma_f32_16x16x32_bf16 v[68:71], v[132:135], v[192:195], v[68:71]
    buffer_load_dwordx4 v[184:187], v27, s[68:71], s19 offen offset:2048 sc1
    s_waitcnt lgkmcnt(11)
    v_mfma_f32_16x16x32_bf16 v[72:75], v[128:131], v[196:199], v[72:75]
    ds_read_b128 v[192:195], v6 offset:8192
    s_waitcnt lgkmcnt(11)
    v_min3_u32 v12, v12, v13, v14
    v_mfma_f32_16x16x32_bf16 v[76:79], v[132:135], v[196:199], v[76:79]
    ds_write_b32 v10, v22
    s_waitcnt lgkmcnt(11)
    v_mfma_f32_16x16x32_bf16 v[80:83], v[128:131], v[200:203], v[80:83]
    ds_read_b128 v[196:199], v6 offset:10240
    v_min_u32 v12, v12, v15
    v_mfma_f32_16x16x32_bf16 v[84:87], v[132:135], v[200:203], v[84:87]
    buffer_load_dwordx4 v[188:191], v27, s[68:71], s19 offen offset:3072 sc1
    s_waitcnt lgkmcnt(10)
    v_mfma_f32_16x16x32_bf16 v[88:91], v[128:131], v[204:207], v[88:91]
    ds_read_b128 v[200:203], v6 offset:12288
    s_bfe_u32 s19, s101, 0 + (4 << 16)
    v_mfma_f32_16x16x32_bf16 v[92:95], v[132:135], v[204:207], v[92:95]
    s_lshl_b32 s19, s19, 13
    s_waitcnt vmcnt(12) lgkmcnt(9)
    v_mfma_f32_16x16x32_bf16 v[64:67], v[136:139], v[208:211], v[64:67]
    ds_read_b128 v[204:207], v6 offset:14336
    v_cmp_gt_u32 vcc, 23, v12
    v_mfma_f32_16x16x32_bf16 v[68:71], v[140:143], v[208:211], v[68:71]
    buffer_load_dwordx4 v[128:131], v26, s[68:71], s19 offen offset:0 sc1
    s_waitcnt lgkmcnt(8)
    v_mfma_f32_16x16x32_bf16 v[72:75], v[136:139], v[212:215], v[72:75]
    ds_read_b128 v[208:211], v7 offset:8192
    s_cbranch_vccnz G2_slow6
G2_back6:
    v_mfma_f32_16x16x32_bf16 v[76:79], v[140:143], v[212:215], v[76:79]
    ds_write_b64 v1, v[32:33] offset:0
    s_waitcnt lgkmcnt(9)
    v_mfma_f32_16x16x32_bf16 v[80:83], v[136:139], v[216:219], v[80:83]
    ds_read_b128 v[212:215], v7 offset:10240
    v_mfma_f32_16x16x32_bf16 v[84:87], v[140:143], v[216:219], v[84:87]
    buffer_load_dwordx4 v[132:135], v26, s[68:71], s19 offen offset:1024 sc1
    s_waitcnt lgkmcnt(8)
    v_mfma_f32_16x16x32_bf16 v[88:91], v[136:139], v[220:223], v[88:91]
    ds_read_b128 v[216:219], v7 offset:12288
    v_mfma_f32_16x16x32_bf16 v[92:95], v[140:143], v[220:223], v[92:95]
    ds_write_b64 v1, v[34:35] offset:8
    s_waitcnt vmcnt(12) lgkmcnt(9)
    v_mfma_f32_16x16x32_bf16 v[64:67], v[144:147], v[192:195], v[64:67]
    ds_read_b128 v[220:223], v7 offset:14336
    ds_write_b64 v1, v[36:37] offset:1024
    v_mfma_f32_16x16x32_bf16 v[68:71], v[148:151], v[192:195], v[68:71]
    buffer_load_dwordx4 v[136:139], v26, s[68:71], s19 offen offset:2048 sc1
    s_waitcnt lgkmcnt(9)
    v_mfma_f32_16x16x32_bf16 v[72:75], v[144:147], v[196:199], v[72:75]
    ds_read_b128 v[192:195], v6 offset:16384
    v_mfma_f32_16x16x32_bf16 v[76:79], v[148:151], v[196:199], v[76:79]
    ds_write_b64 v1, v[38:39] offset:1032
    s_waitcnt lgkmcnt(10)
    v_mfma_f32_16x16x32_bf16 v[80:83], v[144:147], v[200:203], v[80:83]
    ds_read_b128 v[196:199], v6 offset:18432
    ds_read_b128 v[12:15], v11
    v_mfma_f32_16x16x32_bf16 v[84:87], v[148:151], v[200:203], v[84:87]
    buffer_load_dwordx4 v[140:143], v26, s[68:71], s19 offen offset:3072 sc1
    s_waitcnt lgkmcnt(11)
    v_mfma_f32_16x16x32_bf16 v[88:91], v[144:147], v[204:207], v[88:91]
    ds_read_b128 v[200:203], v6 offset:20480
    v_mfma_f32_16x16x32_bf16 v[92:95], v[148:151], v[204:207], v[92:95]
    ds_write_b64 v1, v[40:41] offset:2048
    s_waitcnt vmcnt(12) lgkmcnt(12)
    v_mfma_f32_16x16x32_bf16 v[64:67], v[152:155], v[208:211], v[64:67]
    ds_read_b128 v[204:207], v6 offset:22528
    ds_write_b64 v1, v[42:43] offset:2056
    v_mfma_f32_16x16x32_bf16 v[68:71], v[156:159], v[208:211], v[68:71]
    buffer_load_dwordx4 v[144:147], v27, s[68:71], s19 offen offset:0 sc1
    s_waitcnt lgkmcnt(12)
    v_mfma_f32_16x16x32_bf16 v[72:75], v[152:155], v[212:215], v[72:75]
    ds_read_b128 v[208:211], v7 offset:16384
    v_mfma_f32_16x16x32_bf16 v[76:79], v[156:159], v[212:215], v[76:79]
    ds_write_b64 v1, v[44:45] offset:3072
    s_waitcnt lgkmcnt(13)
    v_mfma_f32_16x16x32_bf16 v[80:83], v[152:155], v[216:219], v[80:83]
    ds_read_b128 v[212:215], v7 offset:18432
    v_mfma_f32_16x16x32_bf16 v[84:87], v[156:159], v[216:219], v[84:87]
    buffer_load_dwordx4 v[148:151], v27, s[68:71], s19 offen offset:1024 sc1
    s_waitcnt lgkmcnt(12)
    v_mfma_f32_16x16x32_bf16 v[88:91], v[152:155], v[220:223], v[88:91]
    ds_read_b128 v[216:219], v7 offset:20480
    v_mfma_f32_16x16x32_bf16 v[92:95], v[156:159], v[220:223], v[92:95]
    ds_write_b64 v1, v[46:47] offset:3080
    s_waitcnt vmcnt(12) lgkmcnt(12)
    v_mfma_f32_16x16x32_bf16 v[64:67], v[160:163], v[192:195], v[64:67]
    ds_read_b128 v[220:223], v7 offset:22528
    v_mov_b32 v22, 25
    v_mfma_f32_16x16x32_bf16 v[68:71], v[164:167], v[192:195], v[68:71]
    buffer_load_dwordx4 v[152:155], v27, s[68:71], s19 offen offset:2048 sc1
    s_waitcnt lgkmcnt(11)
    v_mfma_f32_16x16x32_bf16 v[72:75], v[160:163], v[196:199], v[72:75]
    ds_read_b128 v[192:195], v6 offset:24576
    s_waitcnt lgkmcnt(11)
    v_min3_u32 v12, v12, v13, v14
    v_mfma_f32_16x16x32_bf16 v[76:79], v[164:167], v[196:199], v[76:79]
    ds_write_b32 v10, v22
    s_waitcnt lgkmcnt(11)
    v_mfma_f32_16x16x32_bf16 v[80:83], v[160:163], v[200:203], v[80:83]
    ds_read_b128 v[196:199], v6 offset:26624
    v_min_u32 v12, v12, v15
    v_mfma_f32_16x16x32_bf16 v[84:87], v[164:167], v[200:203], v[84:87]
    buffer_load_dwordx4 v[156:159], v27, s[68:71], s19 offen offset:3072 sc1
    s_waitcnt lgkmcnt(10)
    v_mfma_f32_16x16x32_bf16 v[88:91], v[160:163], v[204:207], v[88:91]
    ds_read_b128 v[200:203], v6 offset:28672
    s_bfe_u32 s19, s101, 4 + (4 << 16)
    v_mfma_f32_16x16x32_bf16 v[92:95], v[164:167], v[204:207], v[92:95]
    s_lshl_b32 s19, s19, 13
    s_waitcnt vmcnt(12) lgkmcnt(9)
    v_mfma_f32_16x16x32_bf16 v[64:67], v[168:171], v[208:211], v[64:67]
    ds_read_b128 v[204:207], v6 offset:30720
    v_cmp_gt_u32 vcc, 24, v12
    v_mfma_f32_16x16x32_bf16 v[68:71], v[172:175], v[208:211], v[68:71]
    buffer_load_dwordx4 v[160:163], v26, s[68:71], s19 offen offset:0 sc1
    s_waitcnt lgkmcnt(8)
    v_mfma_f32_16x16x32_bf16 v[72:75], v[168:171], v[212:215], v[72:75]
    ds_read_b128 v[208:211], v7 offset:24576
    s_cbranch_vccnz G2_slow7
G2_back7:
    v_mfma_f32_16x16x32_bf16 v[76:79], v[172:175], v[212:215], v[76:79]
    ds_write_b64 v1, v[96:97] offset:16384
    s_waitcnt lgkmcnt(9)
    v_mfma_f32_16x16x32_bf16 v[80:83], v[168:171], v[216:219], v[80:83]
    ds_read_b128 v[212:215], v7 offset:26624
    v_mfma_f32_16x16x32_bf16 v[84:87], v[172:175], v[216:219], v[84:87]
    buffer_load_dwordx4 v[164:167], v26, s[68:71], s19 offen offset:1024 sc1
    s_waitcnt lgkmcnt(8)
    v_mfma_f32_16x16x32_bf16 v[88:91], v[168:171], v[220:223], v[88:91]
    ds_read_b128 v[216:219], v7 offset:28672
    v_mfma_f32_16x16x32_bf16 v[92:95], v[172:175], v[220:223], v[92:95]
    ds_write_b64 v1, v[98:99] offset:16392
    s_waitcnt vmcnt(12) lgkmcnt(9)
    v_mfma_f32_16x16x32_bf16 v[64:67], v[176:179], v[192:195], v[64:67]
    ds_read_b128 v[220:223], v7 offset:30720
    ds_write_b64 v1, v[100:101] offset:17408
    v_mfma_f32_16x16x32_bf16 v[68:71], v[180:183], v[192:195], v[68:71]
    buffer_load_dwordx4 v[168:171], v26, s[68:71], s19 offen offset:2048 sc1
    s_waitcnt lgkmcnt(9)
    v_mfma_f32_16x16x32_bf16 v[72:75], v[176:179], v[196:199], v[72:75]
    ds_read_b128 v[192:195], v6 offset:32768
    v_mfma_f32_16x16x32_bf16 v[76:79], v[180:183], v[196:199], v[76:79]
    ds_write_b64 v1, v[102:103] offset:17416
    s_waitcnt lgkmcnt(10)
    v_mfma_f32_16x16x32_bf16 v[80:83], v[176:179], v[200:203], v[80:83]
    ds_read_b128 v[196:199], v6 offset:34816
    ds_read_b128 v[12:15], v11
    v_mfma_f32_16x16x32_bf16 v[84:87], v[180:183], v[200:203], v[84:87]
    buffer_load_dwordx4 v[172:175], v26, s[68:71], s19 offen offset:3072 sc1
    s_waitcnt lgkmcnt(11)
    v_mfma_f32_16x16x32_bf16 v[88:91], v[176:179], v[204:207], v[88:91]
    ds_read_b128 v[200:203], v6 offset:36864
    v_mfma_f32_16x16x32_bf16 v[92:95], v[180:183], v[204:207], v[92:95]
    ds_write_b64 v1, v[104:105] offset:18432
    s_waitcnt vmcnt(12) lgkmcnt(12)
    v_mfma_f32_16x16x32_bf16 v[64:67], v[184:187], v[208:211], v[64:67]
    ds_read_b128 v[204:207], v6 offset:38912
    ds_write_b64 v1, v[106:107] offset:18440
    v_mfma_f32_16x16x32_bf16 v[68:71], v[188:191], v[208:211], v[68:71]
    buffer_load_dwordx4 v[176:179], v27, s[68:71], s19 offen offset:0 sc1
    s_waitcnt lgkmcnt(12)
    v_mfma_f32_16x16x32_bf16 v[72:75], v[184:187], v[212:215], v[72:75]
    ds_read_b128 v[208:211], v7 offset:32768
    v_mfma_f32_16x16x32_bf16 v[76:79], v[188:191], v[212:215], v[76:79]
    ds_write_b64 v1, v[108:109] offset:19456
    s_waitcnt lgkmcnt(13)
    v_mfma_f32_16x16x32_bf16 v[80:83], v[184:187], v[216:219], v[80:83]
    ds_read_b128 v[212:215], v7 offset:34816
    v_mfma_f32_16x16x32_bf16 v[84:87], v[188:191], v[216:219], v[84:87]
    buffer_load_dwordx4 v[180:183], v27, s[68:71], s19 offen offset:1024 sc1
    s_waitcnt lgkmcnt(12)
    v_mfma_f32_16x16x32_bf16 v[88:91], v[184:187], v[220:223], v[88:91]
    ds_read_b128 v[216:219], v7 offset:36864
    v_mfma_f32_16x16x32_bf16 v[92:95], v[188:191], v[220:223], v[92:95]
    ds_write_b64 v1, v[110:111] offset:19464
    s_waitcnt vmcnt(12) lgkmcnt(12)
    v_mfma_f32_16x16x32_bf16 v[64:67], v[128:131], v[192:195], v[64:67]
    ds_read_b128 v[220:223], v7 offset:38912
    v_mov_b32 v22, 26
    v_mfma_f32_16x16x32_bf16 v[68:71], v[132:135], v[192:195], v[68:71]
    buffer_load_dwordx4 v[184:187], v27, s[68:71], s19 offen offset:2048 sc1
    s_waitcnt lgkmcnt(11)
    v_mfma_f32_16x16x32_bf16 v[72:75], v[128:131], v[196:199], v[72:75]
    ds_read_b128 v[192:195], v6 offset:40960
    s_waitcnt lgkmcnt(11)
    v_min3_u32 v12, v12, v13, v14
    v_mfma_f32_16x16x32_bf16 v[76:79], v[132:135], v[196:199], v[76:79]
    ds_write_b32 v10, v22
    s_waitcnt lgkmcnt(11)
    v_mfma_f32_16x16x32_bf16 v[80:83], v[128:131], v[200:203], v[80:83]
    ds_read_b128 v[196:199], v6 offset:43008
    v_min_u32 v12, v12, v15
    v_mfma_f32_16x16x32_bf16 v[84:87], v[132:135], v[200:203], v[84:87]
    buffer_load_dwordx4 v[188:191], v27, s[68:71], s19 offen offset:3072 sc1
    s_waitcnt lgkmcnt(10)
    v_mfma_f32_16x16x32_bf16 v[88:91], v[128:131], v[204:207], v[88:91]
    ds_read_b128 v[200:203], v6 offset:45056
    s_bfe_u32 s19, s101, 8 + (4 << 16)
    v_mfma_f32_16x16x32_bf16 v[92:95], v[132:135], v[204:207], v[92:95]
    s_lshl_b32 s19, s19, 13
    s_waitcnt vmcnt(12) lgkmcnt(9)
    v_mfma_f32_16x16x32_bf16 v[64:67], v[136:139], v[208:211], v[64:67]
    ds_read_b128 v[204:207], v6 offset:47104
    v_cmp_gt_u32 vcc, 25, v12
    v_mfma_f32_16x16x32_bf16 v[68:71], v[140:143], v[208:211], v[68:71]
    buffer_load_dwordx4 v[128:131], v26, s[68:71], s19 offen offset:0 sc1
    s_waitcnt lgkmcnt(8)
    v_mfma_f32_16x16x32_bf16 v[72:75], v[136:139], v[212:215], v[72:75]
    ds_read_b128 v[208:211], v7 offset:40960
    s_cbranch_vccnz G2_slow8
G2_back8:
    v_mfma_f32_16x16x32_bf16 v[76:79], v[140:143], v[212:215], v[76:79]
    ds_write_b64 v0, v[112:113] offset:0
    s_waitcnt lgkmcnt(9)
    v_mfma_f32_16x16x32_bf16 v[80:83], v[136:139], v[216:219], v[80:83]
    ds_read_b128 v[212:215], v7 offset:43008
    v_mfma_f32_16x16x32_bf16 v[84:87], v[140:143], v[216:219], v[84:87]
    buffer_load_dwordx4 v[132:135], v26, s[68:71], s19 offen offset:1024 sc1
    s_waitcnt lgkmcnt(8)
    v_mfma_f32_16x16x32_bf16 v[88:91], v[136:139], v[220:223], v[88:91]
    ds_read_b128 v[216:219], v7 offset:45056
    v_mfma_f32_16x16x32_bf16 v[92:95], v[140:143], v[220:223], v[92:95]
    ds_write_b64 v0, v[114:115] offset:8
    s_waitcnt vmcnt(12) lgkmcnt(9)
    v_mfma_f32_16x16x32_bf16 v[64:67], v[144:147], v[192:195], v[64:67]
    ds_read_b128 v[220:223], v7 offset:47104
    ds_write_b64 v0, v[116:117] offset:1024
    v_mfma_f32_16x16x32_bf16 v[68:71], v[148:151], v[192:195], v[68:71]
    buffer_load_dwordx4 v[136:139], v26, s[68:71], s19 offen offset:2048 sc1
    s_waitcnt lgkmcnt(9)
    v_mfma_f32_16x16x32_bf16 v[72:75], v[144:147], v[196:199], v[72:75]
    ds_read_b128 v[192:195], v6 offset:49152
    v_mfma_f32_16x16x32_bf16 v[76:79], v[148:151], v[196:199], v[76:79]
    ds_write_b64 v0, v[118:119] offset:1032
    s_waitcnt lgkmcnt(10)
    v_mfma_f32_16x16x32_bf16 v[80:83], v[144:147], v[200:203], v[80:83]
    ds_read_b128 v[196:199], v6 offset:51200
    v_mfma_f32_16x16x32_bf16 v[84:87], v[148:151], v[200:203], v[84:87]
    buffer_load_dwordx4 v[140:143], v26, s[68:71], s19 offen offset:3072 sc1
    s_waitcnt lgkmcnt(10)
    v_mfma_f32_16x16x32_bf16 v[88:91], v[144:147], v[204:207], v[88:91]
    ds_read_b128 v[200:203], v6 offset:53248
    v_mfma_f32_16x16x32_bf16 v[92:95], v[148:151], v[204:207], v[92:95]
    ds_write_b64 v0, v[120:121] offset:2048
    s_waitcnt vmcnt(12) lgkmcnt(11)
    v_mfma_f32_16x16x32_bf16 v[64:67], v[152:155], v[208:211], v[64:67]
    ds_read_b128 v[204:207], v6 offset:55296
    ds_write_b64 v0, v[122:123] offset:2056
    v_mfma_f32_16x16x32_bf16 v[68:71], v[156:159], v[208:211], v[68:71]
    buffer_load_dwordx4 v[144:147], v27, s[68:71], s19 offen offset:0 sc1
    s_waitcnt lgkmcnt(11)
    v_mfma_f32_16x16x32_bf16 v[72:75], v[152:155], v[212:215], v[72:75]
    ds_read_b128 v[208:211], v7 offset:49152
    v_mfma_f32_16x16x32_bf16 v[76:79], v[156:159], v[212:215], v[76:79]
    ds_write_b64 v0, v[124:125] offset:3072
    s_waitcnt lgkmcnt(12)
    v_mfma_f32_16x16x32_bf16 v[80:83], v[152:155], v[216:219], v[80:83]
    ds_read_b128 v[212:215], v7 offset:51200
    v_mfma_f32_16x16x32_bf16 v[84:87], v[156:159], v[216:219], v[84:87]
    buffer_load_dwordx4 v[148:151], v27, s[68:71], s19 offen offset:1024 sc1
    s_waitcnt lgkmcnt(11)
    v_mfma_f32_16x16x32_bf16 v[88:91], v[152:155], v[220:223], v[88:91]
    ds_read_b128 v[216:219], v7 offset:53248
    v_mfma_f32_16x16x32_bf16 v[92:95], v[156:159], v[220:223], v[92:95]
    ds_write_b64 v0, v[126:127] offset:3080
    s_waitcnt vmcnt(12) lgkmcnt(11)
    v_mfma_f32_16x16x32_bf16 v[64:67], v[160:163], v[192:195], v[64:67]
    ds_read_b128 v[220:223], v7 offset:55296
    v_mov_b32 v22, 27
    v_mfma_f32_16x16x32_bf16 v[68:71], v[164:167], v[192:195], v[68:71]
    buffer_load_dwordx4 v[152:155], v27, s[68:71], s19 offen offset:2048 sc1
    s_waitcnt lgkmcnt(10)
    v_mfma_f32_16x16x32_bf16 v[72:75], v[160:163], v[196:199], v[72:75]
    ds_read_b128 v[192:195], v6 offset:57344
    v_mfma_f32_16x16x32_bf16 v[76:79], v[164:167], v[196:199], v[76:79]
    ds_write_b32 v10, v22
    s_waitcnt lgkmcnt(11)
    v_mfma_f32_16x16x32_bf16 v[80:83], v[160:163], v[200:203], v[80:83]
    ds_read_b128 v[196:199], v6 offset:59392
    v_mfma_f32_16x16x32_bf16 v[84:87], v[164:167], v[200:203], v[84:87]
    buffer_load_dwordx4 v[156:159], v27, s[68:71], s19 offen offset:3072 sc1
    s_waitcnt lgkmcnt(10)
    v_mfma_f32_16x16x32_bf16 v[88:91], v[160:163], v[204:207], v[88:91]
    ds_read_b128 v[200:203], v6 offset:61440
    s_bfe_u32 s19, s101, 12 + (4 << 16)
    v_mfma_f32_16x16x32_bf16 v[92:95], v[164:167], v[204:207], v[92:95]
    s_lshl_b32 s19, s19, 13
    s_waitcnt vmcnt(12) lgkmcnt(9)
    v_mfma_f32_16x16x32_bf16 v[64:67], v[168:171], v[208:211], v[64:67]
    ds_read_b128 v[204:207], v6 offset:63488
    v_mfma_f32_16x16x32_bf16 v[68:71], v[172:175], v[208:211], v[68:71]
    buffer_load_dwordx4 v[160:163], v26, s[68:71], s19 offen offset:0 sc1
    s_waitcnt lgkmcnt(8)
    v_mfma_f32_16x16x32_bf16 v[72:75], v[168:171], v[212:215], v[72:75]
    ds_read_b128 v[208:211], v7 offset:57344
    v_mfma_f32_16x16x32_bf16 v[76:79], v[172:175], v[212:215], v[76:79]
    s_waitcnt lgkmcnt(8)
    v_mfma_f32_16x16x32_bf16 v[80:83], v[168:171], v[216:219], v[80:83]
    ds_read_b128 v[212:215], v7 offset:59392
    v_mfma_f32_16x16x32_bf16 v[84:87], v[172:175], v[216:219], v[84:87]
    buffer_load_dwordx4 v[164:167], v26, s[68:71], s19 offen offset:1024 sc1
    s_waitcnt lgkmcnt(7)
    v_mfma_f32_16x16x32_bf16 v[88:91], v[168:171], v[220:223], v[88:91]
    ds_read_b128 v[216:219], v7 offset:61440
    v_mfma_f32_16x16x32_bf16 v[92:95], v[172:175], v[220:223], v[92:95]
    s_waitcnt vmcnt(12) lgkmcnt(7)
    v_mfma_f32_16x16x32_bf16 v[64:67], v[176:179], v[192:195], v[64:67]
    ds_read_b128 v[220:223], v7 offset:63488
    v_mfma_f32_16x16x32_bf16 v[68:71], v[180:183], v[192:195], v[68:71]
    buffer_load_dwordx4 v[168:171], v26, s[68:71], s19 offen offset:2048 sc1
    s_waitcnt lgkmcnt(6)
    v_mfma_f32_16x16x32_bf16 v[72:75], v[176:179], v[196:199], v[72:75]
    ds_read_b128 v[192:195], v8 offset:0
    v_mfma_f32_16x16x32_bf16 v[76:79], v[180:183], v[196:199], v[76:79]
    s_waitcnt lgkmcnt(6)
    v_mfma_f32_16x16x32_bf16 v[80:83], v[176:179], v[200:203], v[80:83]
    ds_read_b128 v[196:199], v8 offset:2048
    ds_read_b128 v[12:15], v11
    v_mfma_f32_16x16x32_bf16 v[84:87], v[180:183], v[200:203], v[84:87]
    buffer_load_dwordx4 v[172:175], v26, s[68:71], s19 offen offset:3072 sc1
    s_waitcnt lgkmcnt(7)
    v_mfma_f32_16x16x32_bf16 v[88:91], v[176:179], v[204:207], v[88:91]
    ds_read_b128 v[200:203], v8 offset:4096
    v_mfma_f32_16x16x32_bf16 v[92:95], v[180:183], v[204:207], v[92:95]
    s_waitcnt vmcnt(12) lgkmcnt(7)
    v_mfma_f32_16x16x32_bf16 v[64:67], v[184:187], v[208:211], v[64:67]
    ds_read_b128 v[204:207], v8 offset:6144
    v_mfma_f32_16x16x32_bf16 v[68:71], v[188:191], v[208:211], v[68:71]
    buffer_load_dwordx4 v[176:179], v27, s[68:71], s19 offen offset:0 sc1
    s_waitcnt lgkmcnt(7)
    v_mfma_f32_16x16x32_bf16 v[72:75], v[184:187], v[212:215], v[72:75]
    ds_read_b128 v[208:211], v9 offset:0
    v_mfma_f32_16x16x32_bf16 v[76:79], v[188:191], v[212:215], v[76:79]
    s_waitcnt lgkmcnt(7)
    v_mfma_f32_16x16x32_bf16 v[80:83], v[184:187], v[216:219], v[80:83]
    ds_read_b128 v[212:215], v9 offset:2048
    v_mfma_f32_16x16x32_bf16 v[84:87], v[188:191], v[216:219], v[84:87]
    buffer_load_dwordx4 v[180:183], v27, s[68:71], s19 offen offset:1024 sc1
    s_waitcnt lgkmcnt(7)
    v_mfma_f32_16x16x32_bf16 v[88:91], v[184:187], v[220:223], v[88:91]
    ds_read_b128 v[216:219], v9 offset:4096
    v_mfma_f32_16x16x32_bf16 v[92:95], v[188:191], v[220:223], v[92:95]
    s_waitcnt vmcnt(12) lgkmcnt(7)
    v_mfma_f32_16x16x32_bf16 v[64:67], v[128:131], v[192:195], v[64:67]
    ds_read_b128 v[220:223], v9 offset:6144
    v_mov_b32 v22, 28
    v_mfma_f32_16x16x32_bf16 v[68:71], v[132:135], v[192:195], v[68:71]
    buffer_load_dwordx4 v[184:187], v27, s[68:71], s19 offen offset:2048 sc1
    s_waitcnt lgkmcnt(7)
    v_mfma_f32_16x16x32_bf16 v[72:75], v[128:131], v[196:199], v[72:75]
    ds_read_b128 v[192:195], v8 offset:8192
    s_waitcnt lgkmcnt(7)
    v_min3_u32 v12, v12, v13, v14
    v_mfma_f32_16x16x32_bf16 v[76:79], v[132:135], v[196:199], v[76:79]
    ds_write_b32 v10, v22
    s_waitcnt lgkmcnt(7)
    v_mfma_f32_16x16x32_bf16 v[80:83], v[128:131], v[200:203], v[80:83]
    ds_read_b128 v[196:199], v8 offset:10240
    v_min_u32 v12, v12, v15
    v_mfma_f32_16x16x32_bf16 v[84:87], v[132:135], v[200:203], v[84:87]
    buffer_load_dwordx4 v[188:191], v27, s[68:71], s19 offen offset:3072 sc1
    s_waitcnt lgkmcnt(7)
    v_mfma_f32_16x16x32_bf16 v[88:91], v[128:131], v[204:207], v[88:91]
    ds_read_b128 v[200:203], v8 offset:12288
    s_bfe_u32 s19, s101, 16 + (4 << 16)
    v_mfma_f32_16x16x32_bf16 v[92:95], v[132:135], v[204:207], v[92:95]
    s_lshl_b32 s19, s19, 13
    s_waitcnt vmcnt(12) lgkmcnt(7)
    v_mfma_f32_16x16x32_bf16 v[64:67], v[136:139], v[208:211], v[64:67]
    ds_read_b128 v[204:207], v8 offset:14336
    v_cmp_gt_u32 vcc, 27, v12
    v_mfma_f32_16x16x32_bf16 v[68:71], v[140:143], v[208:211], v[68:71]
    buffer_load_dwordx4 v[128:131], v26, s[68:71], s19 offen offset:0 sc1
    s_waitcnt lgkmcnt(7)
    v_mfma_f32_16x16x32_bf16 v[72:75], v[136:139], v[212:215], v[72:75]
    ds_read_b128 v[208:211], v9 offset:8192
    s_cbranch_vccnz G2_slow10
G2_back10:
    v_mfma_f32_16x16x32_bf16 v[76:79], v[140:143], v[212:215], v[76:79]
    s_waitcnt lgkmcnt(7)
    v_mfma_f32_16x16x32_bf16 v[80:83], v[136:139], v[216:219], v[80:83]
    ds_read_b128 v[212:215], v9 offset:10240
    v_mfma_f32_16x16x32_bf16 v[84:87], v[140:143], v[216:219], v[84:87]
    buffer_load_dwordx4 v[132:135], v26, s[68:71], s19 offen offset:1024 sc1
    s_waitcnt lgkmcnt(7)
    v_mfma_f32_16x16x32_bf16 v[88:91], v[136:139], v[220:223], v[88:91]
    ds_read_b128 v[216:219], v9 offset:12288
    v_mfma_f32_16x16x32_bf16 v[92:95], v[140:143], v[220:223], v[92:95]
    s_waitcnt vmcnt(12) lgkmcnt(7)
    v_mfma_f32_16x16x32_bf16 v[64:67], v[144:147], v[192:195], v[64:67]
    ds_read_b128 v[220:223], v9 offset:14336
    v_mfma_f32_16x16x32_bf16 v[68:71], v[148:151], v[192:195], v[68:71]
    buffer_load_dwordx4 v[136:139], v26, s[68:71], s19 offen offset:2048 sc1
    s_waitcnt lgkmcnt(6)
    v_mfma_f32_16x16x32_bf16 v[72:75], v[144:147], v[196:199], v[72:75]
    ds_read_b128 v[192:195], v8 offset:16384
    v_mfma_f32_16x16x32_bf16 v[76:79], v[148:151], v[196:199], v[76:79]
    s_waitcnt lgkmcnt(6)
    v_mfma_f32_16x16x32_bf16 v[80:83], v[144:147], v[200:203], v[80:83]
    ds_read_b128 v[196:199], v8 offset:18432
    v_mfma_f32_16x16x32_bf16 v[84:87], v[148:151], v[200:203], v[84:87]
    buffer_load_dwordx4 v[140:143], v26, s[68:71], s19 offen offset:3072 sc1
    s_waitcnt lgkmcnt(6)
    v_mfma_f32_16x16x32_bf16 v[88:91], v[144:147], v[204:207], v[88:91]
    ds_read_b128 v[200:203], v8 offset:20480
    v_mfma_f32_16x16x32_bf16 v[92:95], v[148:151], v[204:207], v[92:95]
    s_waitcnt vmcnt(12) lgkmcnt(6)
    v_mfma_f32_16x16x32_bf16 v[64:67], v[152:155], v[208:211], v[64:67]
    ds_read_b128 v[204:207], v8 offset:22528
    v_mfma_f32_16x16x32_bf16 v[68:71], v[156:159], v[208:211], v[68:71]
    buffer_load_dwordx4 v[144:147], v27, s[68:71], s19 offen offset:0 sc1
    s_waitcnt lgkmcnt(6)
    v_mfma_f32_16x16x32_bf16 v[72:75], v[152:155], v[212:215], v[72:75]
    ds_read_b128 v[208:211], v9 offset:16384
    v_mfma_f32_16x16x32_bf16 v[76:79], v[156:159], v[212:215], v[76:79]
    s_waitcnt lgkmcnt(6)
    v_mfma_f32_16x16x32_bf16 v[80:83], v[152:155], v[216:219], v[80:83]
    ds_read_b128 v[212:215], v9 offset:18432
    v_mfma_f32_16x16x32_bf16 v[84:87], v[156:159], v[216:219], v[84:87]
    buffer_load_dwordx4 v[148:151], v27, s[68:71], s19 offen offset:1024 sc1
    s_waitcnt lgkmcnt(6)
    v_mfma_f32_16x16x32_bf16 v[88:91], v[152:155], v[220:223], v[88:91]
    ds_read_b128 v[216:219], v9 offset:20480
    v_mfma_f32_16x16x32_bf16 v[92:95], v[156:159], v[220:223], v[92:95]
    s_waitcnt vmcnt(12) lgkmcnt(6)
    v_mfma_f32_16x16x32_bf16 v[64:67], v[160:163], v[192:195], v[64:67]
    ds_read_b128 v[220:223], v9 offset:22528
    v_mov_b32 v22, 29
    v_mfma_f32_16x16x32_bf16 v[68:71], v[164:167], v[192:195], v[68:71]
    buffer_load_dwordx4 v[152:155], v27, s[68:71], s19 offen offset:2048 sc1
    s_waitcnt lgkmcnt(6)
    v_mfma_f32_16x16x32_bf16 v[72:75], v[160:163], v[196:199], v[72:75]
    ds_read_b128 v[192:195], v8 offset:24576
    v_mfma_f32_16x16x32_bf16 v[76:79], v[164:167], v[196:199], v[76:79]
    ds_write_b32 v10, v22
    s_waitcnt lgkmcnt(7)
    v_mfma_f32_16x16x32_bf16 v[80:83], v[160:163], v[200:203], v[80:83]
    ds_read_b128 v[196:199], v8 offset:26624
    v_mfma_f32_16x16x32_bf16 v[84:87], v[164:167], v[200:203], v[84:87]
    buffer_load_dwordx4 v[156:159], v27, s[68:71], s19 offen offset:3072 sc1
    s_waitcnt lgkmcnt(7)
    v_mfma_f32_16x16x32_bf16 v[88:91], v[160:163], v[204:207], v[88:91]
    ds_read_b128 v[200:203], v8 offset:28672
    s_bfe_u32 s19, s101, 20 + (4 << 16)
    v_mfma_f32_16x16x32_bf16 v[92:95], v[164:167], v[204:207], v[92:95]
    s_lshl_b32 s19, s19, 13
    s_waitcnt vmcnt(12) lgkmcnt(7)
    v_mfma_f32_16x16x32_bf16 v[64:67], v[168:171], v[208:211], v[64:67]
    ds_read_b128 v[204:207], v8 offset:30720
    v_mfma_f32_16x16x32_bf16 v[68:71], v[172:175], v[208:211], v[68:71]
    buffer_load_dwordx4 v[160:163], v26, s[68:71], s19 offen offset:0 sc1
    s_waitcnt lgkmcnt(7)
    v_mfma_f32_16x16x32_bf16 v[72:75], v[168:171], v[212:215], v[72:75]
    ds_read_b128 v[208:211], v9 offset:24576
    v_mfma_f32_16x16x32_bf16 v[76:79], v[172:175], v[212:215], v[76:79]
    s_waitcnt lgkmcnt(7)
    v_mfma_f32_16x16x32_bf16 v[80:83], v[168:171], v[216:219], v[80:83]
    ds_read_b128 v[212:215], v9 offset:26624
    v_mfma_f32_16x16x32_bf16 v[84:87], v[172:175], v[216:219], v[84:87]
    buffer_load_dwordx4 v[164:167], v26, s[68:71], s19 offen offset:1024 sc1
    s_waitcnt lgkmcnt(7)
    v_mfma_f32_16x16x32_bf16 v[88:91], v[168:171], v[220:223], v[88:91]
    ds_read_b128 v[216:219], v9 offset:28672
    v_mfma_f32_16x16x32_bf16 v[92:95], v[172:175], v[220:223], v[92:95]
    s_waitcnt vmcnt(12) lgkmcnt(7)
    v_mfma_f32_16x16x32_bf16 v[64:67], v[176:179], v[192:195], v[64:67]
    ds_read_b128 v[220:223], v9 offset:30720
    v_mfma_f32_16x16x32_bf16 v[68:71], v[180:183], v[192:195], v[68:71]
    buffer_load_dwordx4 v[168:171], v26, s[68:71], s19 offen offset:2048 sc1
    s_waitcnt lgkmcnt(6)
    v_mfma_f32_16x16x32_bf16 v[72:75], v[176:179], v[196:199], v[72:75]
    ds_read_b128 v[192:195], v6 offset:0
    v_mfma_f32_16x16x32_bf16 v[76:79], v[180:183], v[196:199], v[76:79]
    s_waitcnt lgkmcnt(6)
    v_mfma_f32_16x16x32_bf16 v[80:83], v[176:179], v[200:203], v[80:83]
    ds_read_b128 v[196:199], v6 offset:2048
    v_mfma_f32_16x16x32_bf16 v[84:87], v[180:183], v[200:203], v[84:87]
    buffer_load_dwordx4 v[172:175], v26, s[68:71], s19 offen offset:3072 sc1
    s_waitcnt lgkmcnt(6)
    v_mfma_f32_16x16x32_bf16 v[88:91], v[176:179], v[204:207], v[88:91]
    ds_read_b128 v[200:203], v6 offset:4096
    v_mfma_f32_16x16x32_bf16 v[92:95], v[180:183], v[204:207], v[92:95]
    s_waitcnt vmcnt(12) lgkmcnt(6)
    v_mfma_f32_16x16x32_bf16 v[64:67], v[184:187], v[208:211], v[64:67]
    ds_read_b128 v[204:207], v6 offset:6144
    v_mfma_f32_16x16x32_bf16 v[68:71], v[188:191], v[208:211], v[68:71]
    buffer_load_dwordx4 v[176:179], v27, s[68:71], s19 offen offset:0 sc1
    s_waitcnt lgkmcnt(6)
    v_mfma_f32_16x16x32_bf16 v[72:75], v[184:187], v[212:215], v[72:75]
    ds_read_b128 v[208:211], v7 offset:0
    ds_read_b32 v18, v11 offset:68
    v_mfma_f32_16x16x32_bf16 v[76:79], v[188:191], v[212:215], v[76:79]
    s_waitcnt lgkmcnt(7)
    v_mfma_f32_16x16x32_bf16 v[80:83], v[184:187], v[216:219], v[80:83]
    ds_read_b128 v[212:215], v7 offset:2048
    v_mfma_f32_16x16x32_bf16 v[84:87], v[188:191], v[216:219], v[84:87]
    buffer_load_dwordx4 v[180:183], v27, s[68:71], s19 offen offset:1024 sc1
    s_waitcnt lgkmcnt(7)
    v_mfma_f32_16x16x32_bf16 v[88:91], v[184:187], v[220:223], v[88:91]
    ds_read_b128 v[216:219], v7 offset:4096
    v_mfma_f32_16x16x32_bf16 v[92:95], v[188:191], v[220:223], v[92:95]
    s_waitcnt vmcnt(12) lgkmcnt(7)
    v_mfma_f32_16x16x32_bf16 v[64:67], v[128:131], v[192:195], v[64:67]
    ds_read_b128 v[220:223], v7 offset:6144
    v_mov_b32 v22, 30
    v_mfma_f32_16x16x32_bf16 v[68:71], v[132:135], v[192:195], v[68:71]
    buffer_load_dwordx4 v[184:187], v27, s[68:71], s19 offen offset:2048 sc1
    s_waitcnt lgkmcnt(7)
    v_mfma_f32_16x16x32_bf16 v[72:75], v[128:131], v[196:199], v[72:75]
    ds_read_b128 v[192:195], v6 offset:8192
    v_mfma_f32_16x16x32_bf16 v[76:79], v[132:135], v[196:199], v[76:79]
    ds_write_b32 v10, v22
    s_waitcnt lgkmcnt(8)
    v_mfma_f32_16x16x32_bf16 v[80:83], v[128:131], v[200:203], v[80:83]
    ds_read_b128 v[196:199], v6 offset:10240
    v_add_u32 v8, 32768, v8
    v_mfma_f32_16x16x32_bf16 v[84:87], v[132:135], v[200:203], v[84:87]
    buffer_load_dwordx4 v[188:191], v27, s[68:71], s19 offen offset:3072 sc1
    s_waitcnt lgkmcnt(8)
    v_mfma_f32_16x16x32_bf16 v[88:91], v[128:131], v[204:207], v[88:91]
    ds_read_b128 v[200:203], v6 offset:12288
    s_bfe_u32 s19, s101, 24 + (4 << 16)
    v_mfma_f32_16x16x32_bf16 v[92:95], v[132:135], v[204:207], v[92:95]
    s_lshl_b32 s19, s19, 13
    s_waitcnt vmcnt(12) lgkmcnt(8)
    v_mfma_f32_16x16x32_bf16 v[64:67], v[136:139], v[208:211], v[64:67]
    ds_read_b128 v[204:207], v6 offset:14336
    v_add_u32 v9, 32768, v9
    v_mfma_f32_16x16x32_bf16 v[68:71], v[140:143], v[208:211], v[68:71]
    buffer_load_dwordx4 v[128:131], v26, s[68:71], s19 offen offset:0 sc1
    s_waitcnt lgkmcnt(7)
    v_mfma_f32_16x16x32_bf16 v[72:75], v[136:139], v[212:215], v[72:75]
    ds_read_b128 v[208:211], v7 offset:8192
    v_cmp_gt_u32 vcc, 4, v18
    v_mfma_f32_16x16x32_bf16 v[76:79], v[140:143], v[212:215], v[76:79]
    s_waitcnt lgkmcnt(7)
    v_mfma_f32_16x16x32_bf16 v[80:83], v[136:139], v[216:219], v[80:83]
    ds_read_b128 v[212:215], v7 offset:10240
    v_mfma_f32_16x16x32_bf16 v[84:87], v[140:143], v[216:219], v[84:87]
    buffer_load_dwordx4 v[132:135], v26, s[68:71], s19 offen offset:1024 sc1
    s_waitcnt lgkmcnt(7)
    v_mfma_f32_16x16x32_bf16 v[88:91], v[136:139], v[220:223], v[88:91]
    ds_read_b128 v[216:219], v7 offset:12288
    s_cbranch_vccnz G2_slowc
G2_backc:
    v_mfma_f32_16x16x32_bf16 v[92:95], v[140:143], v[220:223], v[92:95]
    s_waitcnt vmcnt(12) lgkmcnt(7)
    v_mfma_f32_16x16x32_bf16 v[64:67], v[144:147], v[192:195], v[64:67]
    ds_read_b128 v[220:223], v7 offset:14336
    v_mfma_f32_16x16x32_bf16 v[68:71], v[148:151], v[192:195], v[68:71]
    buffer_load_dwordx4 v[136:139], v26, s[68:71], s19 offen offset:2048 sc1
    s_waitcnt lgkmcnt(6)
    v_mfma_f32_16x16x32_bf16 v[72:75], v[144:147], v[196:199], v[72:75]
    ds_read_b128 v[192:195], v8 offset:0
    v_mfma_f32_16x16x32_bf16 v[76:79], v[148:151], v[196:199], v[76:79]
    s_waitcnt lgkmcnt(6)
    v_mfma_f32_16x16x32_bf16 v[80:83], v[144:147], v[200:203], v[80:83]
    ds_read_b128 v[196:199], v8 offset:2048
    v_mfma_f32_16x16x32_bf16 v[84:87], v[148:151], v[200:203], v[84:87]
    buffer_load_dwordx4 v[140:143], v26, s[68:71], s19 offen offset:3072 sc1
    s_waitcnt lgkmcnt(6)
    v_mfma_f32_16x16x32_bf16 v[88:91], v[144:147], v[204:207], v[88:91]
    ds_read_b128 v[200:203], v8 offset:25856
    v_mfma_f32_16x16x32_bf16 v[92:95], v[148:151], v[204:207], v[92:95]
    s_waitcnt vmcnt(12) lgkmcnt(6)
    v_mfma_f32_16x16x32_bf16 v[64:67], v[152:155], v[208:211], v[64:67]
    ds_read_b128 v[204:207], v8 offset:27904
    v_mfma_f32_16x16x32_bf16 v[68:71], v[156:159], v[208:211], v[68:71]
    buffer_load_dwordx4 v[144:147], v27, s[68:71], s19 offen offset:0 sc1
    s_waitcnt lgkmcnt(6)
    v_mfma_f32_16x16x32_bf16 v[72:75], v[152:155], v[212:215], v[72:75]
    ds_read_b128 v[208:211], v9 offset:0
    v_mfma_f32_16x16x32_bf16 v[76:79], v[156:159], v[212:215], v[76:79]
    s_waitcnt lgkmcnt(6)
    v_mfma_f32_16x16x32_bf16 v[80:83], v[152:155], v[216:219], v[80:83]
    ds_read_b128 v[212:215], v9 offset:2048
    v_mfma_f32_16x16x32_bf16 v[84:87], v[156:159], v[216:219], v[84:87]
    buffer_load_dwordx4 v[148:151], v27, s[68:71], s19 offen offset:1024 sc1
    s_waitcnt lgkmcnt(6)
    v_mfma_f32_16x16x32_bf16 v[88:91], v[152:155], v[220:223], v[88:91]
    ds_read_b128 v[216:219], v9 offset:25856
    v_mfma_f32_16x16x32_bf16 v[92:95], v[156:159], v[220:223], v[92:95]
    s_waitcnt vmcnt(12) lgkmcnt(6)
    v_mfma_f32_16x16x32_bf16 v[64:67], v[160:163], v[192:195], v[64:67]
    ds_read_b128 v[220:223], v9 offset:27904
    v_mov_b32 v22, 31
    v_mfma_f32_16x16x32_bf16 v[68:71], v[164:167], v[192:195], v[68:71]
    buffer_load_dwordx4 v[152:155], v27, s[68:71], s19 offen offset:2048 sc1
    s_waitcnt lgkmcnt(6)
    v_mfma_f32_16x16x32_bf16 v[72:75], v[160:163], v[196:199], v[72:75]
    ds_read_b128 v[192:195], v8 offset:12928
    v_mfma_f32_16x16x32_bf16 v[76:79], v[164:167], v[196:199], v[76:79]
    ds_write_b32 v10, v22
    s_waitcnt lgkmcnt(7)
    v_mfma_f32_16x16x32_bf16 v[80:83], v[160:163], v[200:203], v[80:83]
    ds_read_b128 v[196:199], v8 offset:14976
    v_mfma_f32_16x16x32_bf16 v[84:87], v[164:167], v[200:203], v[84:87]
    buffer_load_dwordx4 v[156:159], v27, s[68:71], s19 offen offset:3072 sc1
    s_waitcnt lgkmcnt(7)
    v_mfma_f32_16x16x32_bf16 v[88:91], v[160:163], v[204:207], v[88:91]
    ds_read_b128 v[200:203], v8 offset:38784
    s_bfe_u32 s19, s101, 28 + (4 << 16)
    v_mfma_f32_16x16x32_bf16 v[92:95], v[164:167], v[204:207], v[92:95]
    s_lshl_b32 s19, s19, 13
    s_waitcnt vmcnt(12) lgkmcnt(7)
    v_mfma_f32_16x16x32_bf16 v[64:67], v[168:171], v[208:211], v[64:67]
    ds_read_b128 v[204:207], v8 offset:40832
    v_mfma_f32_16x16x32_bf16 v[68:71], v[172:175], v[208:211], v[68:71]
    buffer_load_dwordx4 v[160:163], v26, s[68:71], s19 offen offset:0 sc1
    s_waitcnt lgkmcnt(7)
    v_mfma_f32_16x16x32_bf16 v[72:75], v[168:171], v[212:215], v[72:75]
    ds_read_b128 v[208:211], v9 offset:12928
    v_mfma_f32_16x16x32_bf16 v[76:79], v[172:175], v[212:215], v[76:79]
    s_waitcnt lgkmcnt(7)
    v_mfma_f32_16x16x32_bf16 v[80:83], v[168:171], v[216:219], v[80:83]
    ds_read_b128 v[212:215], v9 offset:14976
    v_mfma_f32_16x16x32_bf16 v[84:87], v[172:175], v[216:219], v[84:87]
    buffer_load_dwordx4 v[164:167], v26, s[68:71], s19 offen offset:1024 sc1
    s_waitcnt lgkmcnt(7)
    v_mfma_f32_16x16x32_bf16 v[88:91], v[168:171], v[220:223], v[88:91]
    ds_read_b128 v[216:219], v9 offset:38784
    v_mfma_f32_16x16x32_bf16 v[92:95], v[172:175], v[220:223], v[92:95]
    s_waitcnt vmcnt(12) lgkmcnt(7)
    v_mfma_f32_16x16x32_bf16 v[64:67], v[176:179], v[192:195], v[64:67]
    ds_read_b128 v[220:223], v9 offset:40832
    v_mfma_f32_16x16x32_bf16 v[68:71], v[180:183], v[192:195], v[68:71]
    buffer_load_dwordx4 v[168:171], v26, s[68:71], s19 offen offset:2048 sc1
    s_waitcnt lgkmcnt(6)
    v_mfma_f32_16x16x32_bf16 v[72:75], v[176:179], v[196:199], v[72:75]
    ds_read_b128 v[192:195], v8 offset:4096
    v_mfma_f32_16x16x32_bf16 v[76:79], v[180:183], v[196:199], v[76:79]
    s_waitcnt lgkmcnt(6)
    v_mfma_f32_16x16x32_bf16 v[80:83], v[176:179], v[200:203], v[80:83]
    ds_read_b128 v[196:199], v8 offset:6144
    v_mfma_f32_16x16x32_bf16 v[84:87], v[180:183], v[200:203], v[84:87]
    buffer_load_dwordx4 v[172:175], v26, s[68:71], s19 offen offset:3072 sc1
    s_waitcnt lgkmcnt(6)
    v_mfma_f32_16x16x32_bf16 v[88:91], v[176:179], v[204:207], v[88:91]
    ds_read_b128 v[200:203], v8 offset:29952
    v_mfma_f32_16x16x32_bf16 v[92:95], v[180:183], v[204:207], v[92:95]
    s_waitcnt vmcnt(12) lgkmcnt(6)
    v_mfma_f32_16x16x32_bf16 v[64:67], v[184:187], v[208:211], v[64:67]
    ds_read_b128 v[204:207], v8 offset:32000
    v_mfma_f32_16x16x32_bf16 v[68:71], v[188:191], v[208:211], v[68:71]
    buffer_load_dwordx4 v[176:179], v27, s[68:71], s19 offen offset:0 sc1
    s_waitcnt lgkmcnt(6)
    v_mfma_f32_16x16x32_bf16 v[72:75], v[184:187], v[212:215], v[72:75]
    ds_read_b128 v[208:211], v9 offset:4096
    v_mfma_f32_16x16x32_bf16 v[76:79], v[188:191], v[212:215], v[76:79]
    s_waitcnt lgkmcnt(6)
    v_mfma_f32_16x16x32_bf16 v[80:83], v[184:187], v[216:219], v[80:83]
    ds_read_b128 v[212:215], v9 offset:6144
    v_mfma_f32_16x16x32_bf16 v[84:87], v[188:191], v[216:219], v[84:87]
    buffer_load_dwordx4 v[180:183], v27, s[68:71], s19 offen offset:1024 sc1
    s_waitcnt lgkmcnt(6)
    v_mfma_f32_16x16x32_bf16 v[88:91], v[184:187], v[220:223], v[88:91]
    ds_read_b128 v[216:219], v9 offset:29952
    v_mfma_f32_16x16x32_bf16 v[92:95], v[188:191], v[220:223], v[92:95]
    s_waitcnt vmcnt(12) lgkmcnt(6)
    v_mfma_f32_16x16x32_bf16 v[64:67], v[128:131], v[192:195], v[64:67]
    ds_read_b128 v[220:223], v9 offset:32000
    v_mov_b32 v22, 32
    v_mfma_f32_16x16x32_bf16 v[68:71], v[132:135], v[192:195], v[68:71]
    buffer_load_dwordx4 v[184:187], v27, s[68:71], s19 offen offset:2048 sc1
    s_waitcnt lgkmcnt(6)
    v_mfma_f32_16x16x32_bf16 v[72:75], v[128:131], v[196:199], v[72:75]
    ds_read_b128 v[192:195], v8 offset:17024
    v_mfma_f32_16x16x32_bf16 v[76:79], v[132:135], v[196:199], v[76:79]
    ds_write_b32 v10, v22
    s_waitcnt lgkmcnt(7)
    v_mfma_f32_16x16x32_bf16 v[80:83], v[128:131], v[200:203], v[80:83]
    ds_read_b128 v[196:199], v8 offset:19072
    v_mfma_f32_16x16x32_bf16 v[84:87], v[132:135], v[200:203], v[84:87]
    buffer_load_dwordx4 v[188:191], v27, s[68:71], s19 offen offset:3072 sc1
    s_waitcnt lgkmcnt(7)
    v_mfma_f32_16x16x32_bf16 v[88:91], v[128:131], v[204:207], v[88:91]
    ds_read_b128 v[200:203], v8 offset:42880
    v_mfma_f32_16x16x32_bf16 v[92:95], v[132:135], v[204:207], v[92:95]
    s_waitcnt vmcnt(12) lgkmcnt(7)
    v_mfma_f32_16x16x32_bf16 v[64:67], v[136:139], v[208:211], v[64:67]
    ds_read_b128 v[204:207], v8 offset:44928
    v_mfma_f32_16x16x32_bf16 v[68:71], v[140:143], v[208:211], v[68:71]
    s_waitcnt lgkmcnt(7)
    v_mfma_f32_16x16x32_bf16 v[72:75], v[136:139], v[212:215], v[72:75]
    ds_read_b128 v[208:211], v9 offset:17024
    v_mfma_f32_16x16x32_bf16 v[76:79], v[140:143], v[212:215], v[76:79]
    s_waitcnt lgkmcnt(7)
    v_mfma_f32_16x16x32_bf16 v[80:83], v[136:139], v[216:219], v[80:83]
    ds_read_b128 v[212:215], v9 offset:19072
    v_mfma_f32_16x16x32_bf16 v[84:87], v[140:143], v[216:219], v[84:87]
    s_waitcnt lgkmcnt(7)
    v_mfma_f32_16x16x32_bf16 v[88:91], v[136:139], v[220:223], v[88:91]
    ds_read_b128 v[216:219], v9 offset:42880
    v_mfma_f32_16x16x32_bf16 v[92:95], v[140:143], v[220:223], v[92:95]
    s_waitcnt vmcnt(10) lgkmcnt(7)
    v_mfma_f32_16x16x32_bf16 v[64:67], v[144:147], v[192:195], v[64:67]
    ds_read_b128 v[220:223], v9 offset:44928
    v_mfma_f32_16x16x32_bf16 v[68:71], v[148:151], v[192:195], v[68:71]
    s_waitcnt lgkmcnt(6)
    v_mfma_f32_16x16x32_bf16 v[72:75], v[144:147], v[196:199], v[72:75]
    ds_read_b128 v[192:195], v8 offset:8192
    v_mfma_f32_16x16x32_bf16 v[76:79], v[148:151], v[196:199], v[76:79]
    s_waitcnt lgkmcnt(6)
    v_mfma_f32_16x16x32_bf16 v[80:83], v[144:147], v[200:203], v[80:83]
    ds_read_b128 v[196:199], v8 offset:10240
    v_mfma_f32_16x16x32_bf16 v[84:87], v[148:151], v[200:203], v[84:87]
    s_waitcnt lgkmcnt(6)
    v_mfma_f32_16x16x32_bf16 v[88:91], v[144:147], v[204:207], v[88:91]
    ds_read_b128 v[200:203], v8 offset:34048
    v_mfma_f32_16x16x32_bf16 v[92:95], v[148:151], v[204:207], v[92:95]
    s_waitcnt vmcnt(8) lgkmcnt(6)
    v_mfma_f32_16x16x32_bf16 v[64:67], v[152:155], v[208:211], v[64:67]
    ds_read_b128 v[204:207], v8 offset:36096
    v_mfma_f32_16x16x32_bf16 v[68:71], v[156:159], v[208:211], v[68:71]
    s_waitcnt lgkmcnt(6)
    v_mfma_f32_16x16x32_bf16 v[72:75], v[152:155], v[212:215], v[72:75]
    ds_read_b128 v[208:211], v9 offset:8192
    v_mfma_f32_16x16x32_bf16 v[76:79], v[156:159], v[212:215], v[76:79]
    s_waitcnt lgkmcnt(6)
    v_mfma_f32_16x16x32_bf16 v[80:83], v[152:155], v[216:219], v[80:83]
    ds_read_b128 v[212:215], v9 offset:10240
    v_mfma_f32_16x16x32_bf16 v[84:87], v[156:159], v[216:219], v[84:87]
    s_waitcnt lgkmcnt(6)
    v_mfma_f32_16x16x32_bf16 v[88:91], v[152:155], v[220:223], v[88:91]
    ds_read_b128 v[216:219], v9 offset:34048
    v_mfma_f32_16x16x32_bf16 v[92:95], v[156:159], v[220:223], v[92:95]
    s_waitcnt vmcnt(6) lgkmcnt(6)
    v_mfma_f32_16x16x32_bf16 v[64:67], v[160:163], v[192:195], v[64:67]
    ds_read_b128 v[220:223], v9 offset:36096
    v_mov_b32 v22, 33
    v_mfma_f32_16x16x32_bf16 v[68:71], v[164:167], v[192:195], v[68:71]
    s_waitcnt lgkmcnt(6)
    v_mfma_f32_16x16x32_bf16 v[72:75], v[160:163], v[196:199], v[72:75]
    ds_read_b128 v[192:195], v8 offset:21120
    v_mfma_f32_16x16x32_bf16 v[76:79], v[164:167], v[196:199], v[76:79]
    ds_write_b32 v10, v22
    s_waitcnt lgkmcnt(7)
    v_mfma_f32_16x16x32_bf16 v[80:83], v[160:163], v[200:203], v[80:83]
    ds_read_b128 v[196:199], v8 offset:23168
    v_mfma_f32_16x16x32_bf16 v[84:87], v[164:167], v[200:203], v[84:87]
    s_waitcnt lgkmcnt(7)
    v_mfma_f32_16x16x32_bf16 v[88:91], v[160:163], v[204:207], v[88:91]
    ds_read_b128 v[200:203], v8 offset:46976
    v_mfma_f32_16x16x32_bf16 v[92:95], v[164:167], v[204:207], v[92:95]
    s_waitcnt vmcnt(4) lgkmcnt(7)
    v_mfma_f32_16x16x32_bf16 v[64:67], v[168:171], v[208:211], v[64:67]
    ds_read_b128 v[204:207], v8 offset:49024
    v_mfma_f32_16x16x32_bf16 v[68:71], v[172:175], v[208:211], v[68:71]
    s_waitcnt lgkmcnt(7)
    v_mfma_f32_16x16x32_bf16 v[72:75], v[168:171], v[212:215], v[72:75]
    ds_read_b128 v[208:211], v9 offset:21120
    v_mfma_f32_16x16x32_bf16 v[76:79], v[172:175], v[212:215], v[76:79]
    s_waitcnt lgkmcnt(7)
    v_mfma_f32_16x16x32_bf16 v[80:83], v[168:171], v[216:219], v[80:83]
    ds_read_b128 v[212:215], v9 offset:23168
    v_mfma_f32_16x16x32_bf16 v[84:87], v[172:175], v[216:219], v[84:87]
    s_waitcnt lgkmcnt(7)
    v_mfma_f32_16x16x32_bf16 v[88:91], v[168:171], v[220:223], v[88:91]
    ds_read_b128 v[216:219], v9 offset:46976
    v_mfma_f32_16x16x32_bf16 v[92:95], v[172:175], v[220:223], v[92:95]
    s_waitcnt vmcnt(2) lgkmcnt(7)
    v_mfma_f32_16x16x32_bf16 v[64:67], v[176:179], v[192:195], v[64:67]
    ds_read_b128 v[220:223], v9 offset:49024
    v_mfma_f32_16x16x32_bf16 v[68:71], v[180:183], v[192:195], v[68:71]
    s_waitcnt lgkmcnt(6)
    v_mfma_f32_16x16x32_bf16 v[72:75], v[176:179], v[196:199], v[72:75]
    v_mfma_f32_16x16x32_bf16 v[76:79], v[180:183], v[196:199], v[76:79]
    s_waitcnt lgkmcnt(5)
    v_mfma_f32_16x16x32_bf16 v[80:83], v[176:179], v[200:203], v[80:83]
    v_mfma_f32_16x16x32_bf16 v[84:87], v[180:183], v[200:203], v[84:87]
    s_waitcnt lgkmcnt(4)
    v_mfma_f32_16x16x32_bf16 v[88:91], v[176:179], v[204:207], v[88:91]
    v_mfma_f32_16x16x32_bf16 v[92:95], v[180:183], v[204:207], v[92:95]
    s_waitcnt vmcnt(0) lgkmcnt(3)
    v_mfma_f32_16x16x32_bf16 v[64:67], v[184:187], v[208:211], v[64:67]
    v_mfma_f32_16x16x32_bf16 v[68:71], v[188:191], v[208:211], v[68:71]
    s_waitcnt lgkmcnt(2)
    v_mfma_f32_16x16x32_bf16 v[72:75], v[184:187], v[212:215], v[72:75]
    v_mfma_f32_16x16x32_bf16 v[76:79], v[188:191], v[212:215], v[76:79]
    s_waitcnt lgkmcnt(1)
    v_mfma_f32_16x16x32_bf16 v[80:83], v[184:187], v[216:219], v[80:83]
    v_mfma_f32_16x16x32_bf16 v[84:87], v[188:191], v[216:219], v[84:87]
    s_waitcnt lgkmcnt(0)
    v_mfma_f32_16x16x32_bf16 v[88:91], v[184:187], v[220:223], v[88:91]
    v_mfma_f32_16x16x32_bf16 v[92:95], v[188:191], v[220:223], v[92:95]
    s_lshl_b32 s10, s6, 7
    s_lshl_b32 s11, s3, 5
    s_add_u32 s10, s10, s11
    v_lshrrev_b32 v32, 4, v2
    v_lshl_add_u32 v32, v32, 2, s10
    s_lshl_b32 s10, s7, 8
    s_add_u32 s10, s10, 4096
    v_and_b32 v33, 15, v2
    v_lshl_add_u32 v33, v33, 4, s10
    v_lshl_add_u32 v32, v32, 13, v33
    v_mov_b32 v224, v64
    v_mov_b32 v225, v72
    v_mov_b32 v226, v80
    v_mov_b32 v227, v88
    s_mov_b32 s10, 0
    buffer_store_dwordx4 v[224:227], v32, s[60:63], s10 offen nt
    v_mov_b32 v228, v65
    v_mov_b32 v229, v73
    v_mov_b32 v230, v81
    v_mov_b32 v231, v89
    s_mov_b32 s10, 8192
    buffer_store_dwordx4 v[228:231], v32, s[60:63], s10 offen nt
    v_mov_b32 v232, v66
    v_mov_b32 v233, v74
    v_mov_b32 v234, v82
    v_mov_b32 v235, v90
    s_mov_b32 s10, 16384
    buffer_store_dwordx4 v[232:235], v32, s[60:63], s10 offen nt
    v_mov_b32 v236, v67
    v_mov_b32 v237, v75
    v_mov_b32 v238, v83
    v_mov_b32 v239, v91
    s_mov_b32 s10, 24576
    buffer_store_dwordx4 v[236:239], v32, s[60:63], s10 offen nt
    v_mov_b32 v240, v68
    v_mov_b32 v241, v76
    v_mov_b32 v242, v84
    v_mov_b32 v243, v92
    s_mov_b32 s10, 131072
    buffer_store_dwordx4 v[240:243], v32, s[60:63], s10 offen nt
    v_mov_b32 v244, v69
    v_mov_b32 v245, v77
    v_mov_b32 v246, v85
    v_mov_b32 v247, v93
    s_mov_b32 s10, 139264
    buffer_store_dwordx4 v[244:247], v32, s[60:63], s10 offen nt
    v_mov_b32 v248, v70
    v_mov_b32 v249, v78
    v_mov_b32 v250, v86
    v_mov_b32 v251, v94
    s_mov_b32 s10, 147456
    buffer_store_dwordx4 v[248:251], v32, s[60:63], s10 offen nt
    v_mov_b32 v252, v71
    v_mov_b32 v253, v79
    v_mov_b32 v254, v87
    v_mov_b32 v255, v95
    s_mov_b32 s10, 155648
    buffer_store_dwordx4 v[252:255], v32, s[60:63], s10 offen nt
    s_endpgm
G2_slow3:
    s_mov_b32 s15, 0
G2_sl3_w:
    ds_read_b128 v[12:15], v11 offset:0
    s_waitcnt lgkmcnt(0)
    v_min3_u32 v12, v12, v13, v14
    v_min_u32 v12, v12, v15
    v_cmp_gt_u32 vcc, 20, v12
    s_cbranch_vccz G2_sl3_ok
    s_add_u32 s15, s15, 1
    s_cmp_lt_u32 s15, 160000
    s_cbranch_scc1 G2_sl3_w
G2_sl3_ok:
    s_branch G2_back3
G2_slow4:
    s_mov_b32 s15, 0
G2_sl4_w:
    ds_read_b128 v[12:15], v11 offset:0
    s_waitcnt lgkmcnt(0)
    v_min3_u32 v12, v12, v13, v14
    v_min_u32 v12, v12, v15
    v_cmp_gt_u32 vcc, 21, v12
    s_cbranch_vccz G2_sl4_ok
    s_add_u32 s15, s15, 1
    s_cmp_lt_u32 s15, 160000
    s_cbranch_scc1 G2_sl4_w
G2_sl4_ok:
    s_branch G2_back4
G2_slow5:
    s_mov_b32 s15, 0
G2_sl5_w:
    ds_read_b128 v[12:15], v11 offset:0
    s_waitcnt lgkmcnt(0)
    v_min3_u32 v12, v12, v13, v14
    v_min_u32 v12, v12, v15
    v_cmp_gt_u32 vcc, 22, v12
    s_cbranch_vccz G2_sl5_ok
    s_add_u32 s15, s15, 1
    s_cmp_lt_u32 s15, 160000
    s_cbranch_scc1 G2_sl5_w
G2_sl5_ok:
    s_branch G2_back5
G2_slow6:
    s_mov_b32 s15, 0
G2_sl6_w:
    ds_read_b128 v[12:15], v11 offset:0
    s_waitcnt lgkmcnt(0)
    v_min3_u32 v12, v12, v13, v14
    v_min_u32 v12, v12, v15
    v_cmp_gt_u32 vcc, 23, v12
    s_cbranch_vccz G2_sl6_ok
    s_add_u32 s15, s15, 1
    s_cmp_lt_u32 s15, 160000
    s_cbranch_scc1 G2_sl6_w
G2_sl6_ok:
    s_branch G2_back6
G2_slow7:
    s_mov_b32 s15, 0
G2_sl7_w:
    ds_read_b128 v[12:15], v11 offset:0
    s_waitcnt lgkmcnt(0)
    v_min3_u32 v12, v12, v13, v14
    v_min_u32 v12, v12, v15
    v_cmp_gt_u32 vcc, 24, v12
    s_cbranch_vccz G2_sl7_ok
    s_add_u32 s15, s15, 1
    s_cmp_lt_u32 s15, 160000
    s_cbranch_scc1 G2_sl7_w
G2_sl7_ok:
    s_branch G2_back7
G2_slow8:
    s_mov_b32 s15, 0
G2_sl8_w:
    ds_read_b128 v[12:15], v11 offset:0
    s_waitcnt lgkmcnt(0)
    v_min3_u32 v12, v12, v13, v14
    v_min_u32 v12, v12, v15
    v_cmp_gt_u32 vcc, 25, v12
    s_cbranch_vccz G2_sl8_ok
    s_add_u32 s15, s15, 1
    s_cmp_lt_u32 s15, 160000
    s_cbranch_scc1 G2_sl8_w
G2_sl8_ok:
    s_branch G2_back8
G2_slow10:
    s_mov_b32 s15, 0
G2_sl10_w:
    ds_read_b128 v[12:15], v11 offset:0
    s_waitcnt lgkmcnt(0)
    v_min3_u32 v12, v12, v13, v14
    v_min_u32 v12, v12, v15
    v_cmp_gt_u32 vcc, 27, v12
    s_cbranch_vccz G2_sl10_ok
    s_add_u32 s15, s15, 1
    s_cmp_lt_u32 s15, 160000
    s_cbranch_scc1 G2_sl10_w
G2_sl10_ok:
    s_branch G2_back10
G2_slowc:
    s_mov_b32 s15, 0
G2_slc_w:
    ds_read_b32 v18, v11 offset:68
    s_waitcnt lgkmcnt(0)
    v_cmp_gt_u32 vcc, 4, v18
    s_cbranch_vccz G2_slc_ok
    s_add_u32 s15, s15, 1
    s_cmp_lt_u32 s15, 160000
    s_cbranch_scc1 G2_slc_w
G2_slc_ok:
    s_branch G2_backc
Y_done:
    s_endpgm
Y_end:
.section .rodata,"a"
.p2align 6
.amdhsa_kernel concat_heads__ssm_conv_h3__ssm_conv_s5__prompt_kernel
  .amdhsa_next_free_vgpr 256
  .amdhsa_next_free_sgpr 102
  .amdhsa_accum_offset 256
  .amdhsa_group_segment_fixed_size 0
  .amdhsa_kernarg_size 144
  .amdhsa_user_sgpr_count 2
  .amdhsa_user_sgpr_kernarg_segment_ptr 1
  .amdhsa_system_sgpr_workgroup_id_x 1
.end_amdhsa_kernel
```

```asm
; @launch grid=(256,1,1) block=(512,1,1) lds=163840
.amdgcn_target "amdgcn-amd-amdhsa--gfx950"
.text
.globl concat_heads__ssm_conv_h3__ssm_conv_s5__prompt_kernel
.p2align 8
.type concat_heads__ssm_conv_h3__ssm_conv_s5__prompt_kernel,@function
concat_heads__ssm_conv_h3__ssm_conv_s5__prompt_kernel:
    s_cmp_ge_u32 s2, 256
    s_cbranch_scc1 Y_done
    s_load_dwordx16 s[16:31], s[0:1], 0
    s_load_dwordx16 s[32:47], s[0:1], 64
    s_load_dwordx4 s[48:51], s[0:1], 128
    s_getpc_b64 s[52:53]
Y_pc:
    v_lshrrev_b32 v1, 6, v0
    v_and_b32 v2, 63, v0
    s_and_b32 s4, s2, 7
    v_readfirstlane_b32 s3, v1
    s_lshr_b32 s5, s2, 3
    s_and_b32 s6, s4, 1
    s_lshl_b32 s6, s6, 3
    s_and_b32 s7, s5, 7
    s_add_u32 s6, s6, s7
    s_and_b32 s7, s4, 6
    s_lshl_b32 s7, s7, 1
    s_lshr_b32 s8, s5, 3
    s_add_u32 s7, s7, s8
    s_cmp_lt_u32 s3, 4
    s_cbranch_scc0 Y_L
    s_lshl_b32 s54, s5, 2
    s_add_u32 s54, s54, s3
    s_lshl_b32 s54, s54, 7
    s_load_dword s56, s[52:53], s54
    s_add_u32 s54, s54, 64
    s_load_dword s57, s[52:53], s54
    s_add_u32 s54, s54, 16320
    s_min_u32 s54, s54, Y_end-Y_pc-4
    s_load_dword s58, s[52:53], s54
    s_add_u32 s54, s54, 64
    s_min_u32 s54, s54, Y_end-Y_pc-4
    s_load_dword s59, s[52:53], s54
    s_barrier
    s_branch Y_G
Y_L:
    s_add_u32 s13, s5, s8
    s_lshl_b32 s13, s13, 3
    s_and_b32 s9, s4, 6
    s_add_u32 s13, s13, s9
    s_and_b32 s9, s4, 1
    s_lshl_b32 s9, s9, 2
    s_add_u32 s13, s13, s9
    s_and_b32 s13, s13, 15
    s_lshl_b32 s13, s13, 7
    s_setprio 2
    s_sub_u32 s8, s3, 4
    s_lshr_b32 s11, s8, 1
    s_and_b32 s9, s8, 1
    s_cmp_eq_u32 s11, 1
    s_cbranch_scc1 L_ns0
    s_lshl_b32 s10, s6, 7
    s_lshl_b32 s12, s9, 6
    s_add_u32 s10, s10, s12
    v_and_b32 v24, 32, v2
    v_bfe_u32 v25, v2, 3, 1
    v_lshl_add_u32 v24, v25, 4, v24
    v_bfe_u32 v25, v2, 4, 1
    v_add_u32 v24, v24, v25
    v_add_u32 v24, s10, v24
    v_lshlrev_b32 v24, 11, v24
    v_lshrrev_b32 v25, 4, v2
    v_xor_b32 v25, v25, v2
    v_and_b32 v25, 7, v25
    v_lshl_add_u32 v4, v25, 4, v24
    v_xor_b32 v5, 64, v4
    v_add_u32 v5, 3072, v5
    v_add_u32 v6, 6144, v4
    v_add_u32 v7, 6144, v5
    s_lshl_b32 s10, s7, 6
    v_lshrrev_b32 v24, 3, v2
    s_lshl_b32 s12, s9, 5
    s_add_u32 s10, s10, s12
    v_add_u32 v24, s10, v24
    v_lshlrev_b32 v24, 11, v24
    v_lshrrev_b32 v25, 4, v2
    v_xor_b32 v25, v25, v2
    v_and_b32 v25, 7, v25
    v_lshl_add_u32 v8, v25, 4, v24
    v_xor_b32 v9, 64, v8
    v_add_u32 v9, 15360, v9
    v_add_u32 v10, 30720, v8
    v_add_u32 v11, 30720, v9
    s_lshl_b32 s14, s8, 13
    s_mov_b32 s54, 4194304
    s_mov_b32 s55, 0x00020000
    s_mov_b32 s58, 2097152
    s_mov_b32 s59, 0x00020000
    s_mov_b32 s62, 2097152
    s_mov_b32 s63, 0x00020000
    s_waitcnt lgkmcnt(0)
    s_mov_b32 s52, s28
    s_mov_b32 s53, s29
    s_mov_b32 s56, s34
    s_mov_b32 s57, s35
    s_mov_b32 s60, s36
    s_mov_b32 s61, s37
    s_mov_b32 s22, 1043403025
    s_mov_b32 s23, 17895742
    s_add_u32 m0, s14, 0
    s_nop 0
    buffer_load_dwordx4 v4, s[52:55], s13 offen offset:0 lds
    buffer_load_dwordx4 v5, s[52:55], s13 offen offset:1024 lds
    buffer_load_dwordx4 v6, s[52:55], s13 offen offset:2048 lds
    buffer_load_dwordx4 v7, s[52:55], s13 offen offset:3072 lds
    s_add_u32 m0, s14, 16384
    s_nop 0
    buffer_load_dwordx4 v8, s[56:59], s13 offen offset:0 lds
    buffer_load_dwordx4 v9, s[56:59], s13 offen offset:1024 lds
    buffer_load_dwordx4 v10, s[56:59], s13 offen offset:2048 lds
    buffer_load_dwordx4 v11, s[56:59], s13 offen offset:3072 lds
    s_add_u32 m0, s14, 4096
    s_add_u32 s12, s13, 16384
    buffer_load_dwordx4 v4, s[52:55], s12 offen offset:0 lds
    buffer_load_dwordx4 v5, s[52:55], s12 offen offset:1024 lds
    buffer_load_dwordx4 v6, s[52:55], s12 offen offset:2048 lds
    buffer_load_dwordx4 v7, s[52:55], s12 offen offset:3072 lds
    s_add_u32 m0, s14, 20480
    s_nop 0
    buffer_load_dwordx4 v8, s[60:63], s13 offen offset:0 lds
    buffer_load_dwordx4 v9, s[60:63], s13 offen offset:1024 lds
    buffer_load_dwordx4 v10, s[60:63], s13 offen offset:2048 lds
    buffer_load_dwordx4 v11, s[60:63], s13 offen offset:3072 lds
    s_and_b32 s12, s22, 15
    s_lshl_b32 s12, s12, 7
    s_add_u32 s13, s13, s12
    s_lshr_b64 s[22:23], s[22:23], 4
    s_and_b32 s13, s13, 2047
    s_add_u32 s14, s14, 32768
    s_and_b32 s14, s14, 131071
L_ns0:
    v_and_b32 v60, 31, v2
    v_mov_b32 v61, 0
    v_mov_b32 v62, 163712
    v_lshl_add_u32 v60, v60, 2, v62
    ds_write_b32 v60, v61
    s_and_b32 s68, s4, 6
    s_add_u32 s69, s5, s68
    s_lshl_b32 s69, s69, 1
    s_and_b32 s68, s4, 1
    s_add_u32 s69, s69, s68
    s_and_b32 s69, s69, 15
    s_mov_b32 s100, 0x76543210
    s_mov_b32 s101, 0xfedcba98
    s_lshl_b32 s68, s69, 2
    s_lshr_b64 s[64:65], s[100:101], s68
    s_sub_u32 s68, 64, s68
    s_lshl_b64 s[100:101], s[100:101], s68
    s_or_b64 s[100:101], s[100:101], s[64:65]
    s_sub_u32 s68, s7, s69
    s_and_b32 s68, s68, 15
    s_lshl_b32 s68, s68, 2
    s_bfm_b64 s[64:65], s68, 0
    s_and_b64 s[66:67], s[100:101], s[64:65]
    s_lshl_b64 s[66:67], s[66:67], 4
    s_lshl_b64 s[64:65], s[64:65], 4
    s_or_b32 s64, s64, 15
    s_andn2_b64 s[100:101], s[100:101], s[64:65]
    s_or_b64 s[100:101], s[100:101], s[66:67]
    s_or_b32 s100, s100, s7
    s_waitcnt lgkmcnt(0)
    s_barrier
    v_mov_b32 v19, 0
    s_lshl_b32 s10, s3, 2
    s_add_u32 s10, s10, 163712
    v_mov_b32 v22, s10
    v_mov_b32 v21, 163712
    s_add_u32 s72, s50, 17825792
    s_addc_u32 s73, s51, 0
    s_mov_b32 s74, 24576
    s_mov_b32 s75, 0x00020000
    s_mov_b32 s76, s48
    s_mov_b32 s77, s49
    s_mov_b32 s78, 256
    s_mov_b32 s79, 0x00020000
    s_mov_b32 s37, s100
    s_mov_b32 s30, s101
    s_lshl_b32 s100, s4, 7
    s_lshl_b32 s10, s5, 2
    s_add_u32 s100, s100, s10
    s_add_u32 s100, s100, s8
    s_lshr_b32 s10, s100, 1
    s_lshl_b32 s10, s10, 2
    s_load_dword s31, s[26:27], s10
    s_mul_i32 s101, s8, 12928
    s_add_u32 s101, s101, 98304
    s_lshl_b32 s10, s7, 5
    s_add_u32 s10, s10, s11
    s_lshl_b32 s10, s10, 12
    v_lshrrev_b32 v24, 3, v2
    v_lshl_add_u32 v24, v24, 13, s10
    v_lshrrev_b32 v25, 4, v2
    v_xor_b32 v25, v25, v2
    v_and_b32 v25, 7, v25
    v_lshl_add_u32 v12, v25, 4, v24
    v_xor_b32 v13, 64, v12
    v_add_u32 v13, 64512, v13
    s_cmp_eq_u32 s9, 1
    s_cselect_b32 s80, s40, s38
    s_cselect_b32 s81, s41, s39
    s_mov_b32 s82, 2097152
    s_mov_b32 s83, 0x00020000
    s_mov_b32 s68, s24
    s_mov_b32 s69, s25
    s_mov_b32 s70, 4194304
    s_mov_b32 s71, 0x00020000
    s_movk_i32 s32, 4096
    s_movk_i32 s33, 8192
    s_movk_i32 s34, 12288
    s_lshl_b32 s10, s5, 6
    v_and_b32 v23, 56, v2
    v_add_u32 v23, s10, v23
    v_lshlrev_b32 v26, 4, v2
    s_lshl_b32 s36, s100, 12
    s_lshl_b32 s10, s4, 1
    s_lshr_b32 s12, s5, 4
    s_add_u32 s10, s10, s12
    s_lshl_b32 s10, s10, 8
    v_and_b32 v60, 31, v2
    v_lshl_add_u32 v20, v60, 3, s10
    s_lshl_b32 s10, s4, 7
    s_lshl_b32 s12, s8, 5
    s_add_u32 s35, s10, s12
    v_and_b32 v25, 7, v2
    v_lshl_add_u32 v24, v25, 2, s35
    v_lshlrev_b32 v25, 1, v24
    v_lshl_add_u32 v16, v23, 11, v25
    v_add_u32 v60, 12416, v26
    v_and_b32 v61, 16, v26
    v_and_b32 v62, 32, v26
    v_mul_u32_u24 v62, 130, v62
    v_add_u32 v61, v61, v62
    v_cmp_gt_u32 vcc, 32, v2
    s_nop 1
    v_cndmask_b32 v60, v61, v60, vcc
    v_add_u32 v18, s101, v60
    s_lshl_b32 s10, s4, 10
    s_add_u32 s10, s10, 8192
    v_add_u32 v3, s10, v26
    v_and_b32 v17, 15, v2
    v_lshrrev_b32 v27, 4, v2
    v_lshlrev_b32 v60, 1, v17
    v_lshlrev_b32 v61, 4, v27
    v_sub_u32 v60, v60, v61
    v_and_b32 v62, 1, v17
    v_mov_b32 v63, 4212
    v_cmp_eq_u32 vcc, 1, v62
    s_nop 1
    v_cndmask_b32 v63, v63, 50, vcc
    v_add3_u32 v28, v60, v63, s101
    v_add_u32 v29, 1024, v28
    v_add_u32 v30, 2048, v28
    v_add_u32 v31, 3072, v28
    v_lshl_add_u32 v60, v17, 5, v61
    s_add_u32 s10, s101, 8848
    v_sub_u32 v32, s10, v60
    s_add_u32 s10, s101, 8320
    v_add_u32 v33, s10, v26
    s_cmp_eq_u32 s11, 1
    s_cbranch_scc1 L_idle
    s_mov_b32 s29, 1
    v_mov_b32 v25, 1
    s_branch L_free
L_loop:
    s_sub_i32 s28, s29, 3
    s_max_i32 s28, s28, 0
    s_waitcnt lgkmcnt(0)
    v_min3_u32 v60, v60, v61, v62
    v_min_u32 v60, v60, v63
    v_mov_b32 v25, s29
    v_cmp_gt_u32 vcc, s28, v60
    s_cbranch_vccz L_free
    s_mov_b32 s15, 0
L_slot_w:
    ds_read_b128 v[60:63], v21 offset:0
    s_waitcnt lgkmcnt(0)
    v_min3_u32 v60, v60, v61, v62
    v_min_u32 v60, v60, v63
    v_cmp_gt_u32 vcc, s28, v60
    s_cbranch_vccz L_slot_ok
    s_sleep 1
    s_add_u32 s15, s15, 1
    s_cmp_lt_u32 s15, 160000
    s_cbranch_scc1 L_slot_w
L_slot_ok:
L_free:
    s_cmp_ge_u32 s29, 10
    s_cbranch_scc1 L_sh
    s_add_u32 m0, s14, 0
    s_waitcnt vmcnt(15)
    buffer_load_dwordx4 v4, s[52:55], s13 offen offset:0 lds
    s_waitcnt vmcnt(15)
    buffer_load_dwordx4 v5, s[52:55], s13 offen offset:1024 lds
    s_waitcnt vmcnt(15)
    buffer_load_dwordx4 v6, s[52:55], s13 offen offset:2048 lds
    s_waitcnt vmcnt(15)
    buffer_load_dwordx4 v7, s[52:55], s13 offen offset:3072 lds
    s_add_u32 m0, s14, 16384
    s_waitcnt vmcnt(15)
    buffer_load_dwordx4 v8, s[56:59], s13 offen offset:0 lds
    s_waitcnt vmcnt(15)
    buffer_load_dwordx4 v9, s[56:59], s13 offen offset:1024 lds
    s_waitcnt vmcnt(15)
    buffer_load_dwordx4 v10, s[56:59], s13 offen offset:2048 lds
    s_waitcnt vmcnt(15)
    buffer_load_dwordx4 v11, s[56:59], s13 offen offset:3072 lds
    s_add_u32 m0, s14, 4096
    s_add_u32 s12, s13, 16384
    s_waitcnt vmcnt(15)
    buffer_load_dwordx4 v4, s[52:55], s12 offen offset:0 lds
    s_waitcnt vmcnt(15)
    buffer_load_dwordx4 v5, s[52:55], s12 offen offset:1024 lds
    s_waitcnt vmcnt(15)
    buffer_load_dwordx4 v6, s[52:55], s12 offen offset:2048 lds
    s_waitcnt vmcnt(15)
    buffer_load_dwordx4 v7, s[52:55], s12 offen offset:3072 lds
    ds_read_b128 v[60:63], v21
    s_add_u32 m0, s14, 20480
    s_waitcnt vmcnt(15)
    buffer_load_dwordx4 v8, s[60:63], s13 offen offset:0 lds
    s_waitcnt vmcnt(15)
    buffer_load_dwordx4 v9, s[60:63], s13 offen offset:1024 lds
    s_waitcnt vmcnt(15)
    buffer_load_dwordx4 v10, s[60:63], s13 offen offset:2048 lds
    s_waitcnt vmcnt(15)
    ds_write_b32 v22, v25
    buffer_load_dwordx4 v11, s[60:63], s13 offen offset:3072 lds
    s_and_b32 s12, s22, 15
    s_lshl_b32 s12, s12, 7
    s_add_u32 s13, s13, s12
    s_lshr_b64 s[22:23], s[22:23], 4
    s_and_b32 s13, s13, 2047
    s_add_u32 s14, s14, 32768
    s_and_b32 s14, s14, 131071
    s_add_u32 s29, s29, 1
    s_branch L_loop
L_sh:
    s_add_u32 m0, s14, 0
    s_waitcnt vmcnt(7)
    buffer_load_dwordx4 v4, s[52:55], s13 offen offset:0 lds
    s_waitcnt vmcnt(7)
    buffer_load_dwordx4 v5, s[52:55], s13 offen offset:1024 lds
    s_waitcnt vmcnt(7)
    buffer_load_dwordx4 v6, s[52:55], s13 offen offset:2048 lds
    s_waitcnt vmcnt(7)
    buffer_load_dwordx4 v7, s[52:55], s13 offen offset:3072 lds
    s_add_u32 m0, s14, 16384
    s_waitcnt vmcnt(7)
    buffer_load_dwordx4 v8, s[56:59], s13 offen offset:0 lds
    s_waitcnt vmcnt(7)
    buffer_load_dwordx4 v9, s[56:59], s13 offen offset:1024 lds
    s_waitcnt vmcnt(7)
    buffer_load_dwordx4 v10, s[56:59], s13 offen offset:2048 lds
    s_waitcnt vmcnt(7)
    ds_write_b32 v22, v25
    buffer_load_dwordx4 v11, s[56:59], s13 offen offset:3072 lds
    s_add_u32 m0, s14, 4096
    s_add_u32 s12, s13, 16384
    s_waitcnt vmcnt(7)
    buffer_load_dwordx4 v4, s[52:55], s12 offen offset:0 lds
    s_waitcnt vmcnt(7)
    buffer_load_dwordx4 v5, s[52:55], s12 offen offset:1024 lds
    s_waitcnt vmcnt(7)
    buffer_load_dwordx4 v6, s[52:55], s12 offen offset:2048 lds
    s_waitcnt vmcnt(7)
    buffer_load_dwordx4 v7, s[52:55], s12 offen offset:3072 lds
    ds_read_b128 v[60:63], v21
    s_add_u32 m0, s14, 20480
    s_waitcnt vmcnt(7)
    buffer_load_dwordx4 v8, s[60:63], s13 offen offset:0 lds
    s_waitcnt vmcnt(7)
    buffer_load_dwordx4 v9, s[60:63], s13 offen offset:1024 lds
    s_waitcnt vmcnt(7)
    buffer_load_dwordx4 v10, s[60:63], s13 offen offset:2048 lds
    s_waitcnt vmcnt(7)
    buffer_load_dwordx4 v11, s[60:63], s13 offen offset:3072 lds
    s_and_b32 s12, s22, 15
    s_lshl_b32 s12, s12, 7
    s_add_u32 s13, s13, s12
    s_lshr_b64 s[22:23], s[22:23], 4
    s_and_b32 s13, s13, 2047
    s_add_u32 s14, s14, 32768
    s_and_b32 s14, s14, 131071
    s_add_u32 s29, s29, 1
    s_cmp_lt_u32 s29, 16
    s_cbranch_scc1 L_loop
    v_mov_b32 v25, 16
    v_mov_b32 v60, 1
    s_mov_b64 exec, 1
    ds_add_u32 v21, v60 offset:40
    s_mov_b64 exec, -1
    s_waitcnt vmcnt(0)
    ds_write_b32 v22, v25
    s_mov_b32 s15, 0
L_is0_w:
    ds_read_b32 v60, v21 offset:40
    s_waitcnt lgkmcnt(0)
    v_cmp_gt_u32 vcc, 2, v60
    s_cbranch_vccz L_is0_ok
    s_add_u32 s15, s15, 1
    s_cmp_lt_u32 s15, 160000
    s_cbranch_scc1 L_is0_w
L_is0_ok:
    buffer_load_dwordx4 v[192:195], v26, s[68:71], s36 offen offset:0 nt
    buffer_load_dwordx4 v[196:199], v26, s[68:71], s36 offen offset:1024 nt
    buffer_load_dwordx4 v[200:203], v26, s[68:71], s36 offen offset:2048 nt
    buffer_load_dwordx4 v[204:207], v26, s[68:71], s36 offen offset:3072 nt
    s_branch L_t2
L_idle:
    s_setprio 0
    s_cmp_eq_u32 s8, 3
    s_cbranch_scc0 L_ntls
    s_lshl_b32 s10, s5, 16
    s_load_dword s29, s[22:23], 0
    s_load_dword s29, s[44:45], 0
    s_load_dword s29, s[18:19], s10
    s_load_dword s29, s[20:21], s10
    s_add_u32 s10, s10, 2097152
    s_load_dword s29, s[18:19], s10
    s_load_dword s29, s[20:21], s10
    s_add_u32 s10, s10, 2097152
    s_add_u32 s10, s10, 2097152
L_ntls:
    s_mov_b32 s52, s18
    s_mov_b32 s53, s19
    s_mov_b32 s54, 4194304
    s_mov_b32 s55, 0x00020000
    s_mov_b32 s56, s20
    s_mov_b32 s57, s21
    s_mov_b32 s58, 4194304
    s_mov_b32 s59, 0x00020000
    s_mov_b32 s60, s22
    s_mov_b32 s61, s23
    s_mov_b32 s62, 8192
    s_mov_b32 s63, 0x00020000
    s_mov_b32 s64, s50
    s_mov_b32 s65, s51
    s_mov_b32 s66, 4194304
    s_mov_b32 s67, 0x00020000
    s_lshl_b32 s10, s4, 7
    s_lshl_b32 s12, s9, 6
    s_add_u32 s10, s10, s12
    v_and_b32 v60, 7, v2
    v_lshl_add_u32 v4, v60, 3, s10
    v_lshlrev_b32 v60, 1, v4
    v_lshl_add_u32 v5, v23, 11, v60
    v_subrev_u32 v6, 6144, v5
    v_bfrev_b32 v60, 1
    v_cmp_eq_u32 vcc, 0, v23
    s_nop 1
    v_cndmask_b32 v6, v6, v60, vcc
    v_lshlrev_b32 v7, 3, v4
    v_sub_u32 v8, 2040, v23
    v_lshlrev_b32 v8, 1, v8
    v_lshl_add_u32 v8, v4, 12, v8
    v_add_u32 v9, 16384, v8
    s_lshl_b32 s13, s4, 1
    s_add_u32 s13, s13, s9
    s_lshl_b32 s13, s13, 5
    s_add_u32 s13, s13, s5
    s_lshl_b32 s13, s13, 3
    v_mov_b32 v25, 16
    s_getreg_b32 s14, hwreg(HW_REG_XCC_ID, 0, 8)
    s_add_u32 s14, s14, 1
    s_lshl_b32 s14, s14, 20
    s_lshl_b32 s10, s4, 8
    s_add_u32 s10, s10, 4096
    v_and_b32 v14, 31, v2
    v_lshl_add_u32 v14, v14, 3, s10
    s_lshl_b32 s28, s5, 3
    s_add_u32 s28, s28, s10
    s_cmp_eq_u32 s9, 0
    s_cbranch_scc0 L_x1
    s_mov_b32 s15, 0
L_x0_w:
    ds_read_b64 v[60:61], v21 offset:16
    s_waitcnt lgkmcnt(0)
    v_min_u32 v60, v60, v61
    v_cmp_gt_u32 vcc, 1, v60
    s_cbranch_vccz L_x0_ok
    s_sleep 2
    s_add_u32 s15, s15, 1
    s_cmp_lt_u32 s15, 160000
    s_cbranch_scc1 L_x0_w
L_x0_ok:
    buffer_load_dwordx2 v[10:11], v19, s[76:79], 0 offen sc1
    s_waitcnt vmcnt(0)
    s_mov_b32 s12, 0
LX_np:
    v_cmp_eq_u32 vcc, 0, v10
    s_cbranch_vccz LX_nok
    buffer_load_dwordx2 v[10:11], v19, s[76:79], 0 offen sc1
    s_add_u32 s12, s12, 1
    s_waitcnt vmcnt(0)
    s_cmp_lt_u32 s12, 20000
    s_cbranch_scc1 LX_np
LX_nok:
    v_xor_b32 v11, s14, v11
    s_mov_b64 exec, 1
    buffer_store_dwordx2 v[10:11], v19, s[72:75], s28 offen sc1
    s_mov_b64 exec, -1
L_x1:
    s_lshr_b32 s10, s5, 1
    s_lshr_b32 s12, s5, 4
    s_lshl_b32 s12, s12, 1
    s_add_u32 s10, s10, s12
    s_and_b32 s10, s10, 3
    s_mul_i32 s10, s10, 1
    s_mul_i32 s12, s9, 0
    s_add_u32 s10, s10, s12
    s_add_u32 s10, s10, 2
    s_mov_b32 s15, 0
L_i1_w:
    ds_read_b64 v[60:61], v21 offset:16
    s_waitcnt lgkmcnt(0)
    v_min_u32 v60, v60, v61
    v_cmp_gt_u32 vcc, s10, v60
    s_cbranch_vccz L_i1_ok
    s_sleep 2
    s_add_u32 s15, s15, 1
    s_cmp_lt_u32 s15, 160000
    s_cbranch_scc1 L_i1_w
L_i1_ok:
    buffer_load_dwordx4 v[64:67], v7, s[60:63], 0 offen offset:0
    buffer_load_dwordx4 v[68:71], v7, s[60:63], 0 offen offset:16
    buffer_load_dwordx4 v[72:75], v7, s[60:63], 0 offen offset:32
    buffer_load_dwordx4 v[76:79], v7, s[60:63], 0 offen offset:48
    buffer_load_dwordx4 v[92:95], v5, s[52:55], 0 offen offset:0 nt
    buffer_load_dwordx4 v[96:99], v5, s[52:55], 0 offen offset:2048 nt
    buffer_load_dwordx4 v[100:103], v5, s[52:55], s32 offen offset:0 nt
    buffer_load_dwordx4 v[104:107], v5, s[52:55], s32 offen offset:2048 nt
    buffer_load_dwordx4 v[108:111], v5, s[52:55], s33 offen offset:0 nt
    buffer_load_dwordx4 v[112:115], v5, s[52:55], s33 offen offset:2048 nt
    buffer_load_dwordx4 v[116:119], v5, s[52:55], s34 offen offset:0 nt
    buffer_load_dwordx4 v[120:123], v5, s[52:55], s34 offen offset:2048 nt
    buffer_load_dwordx4 v[80:83], v6, s[52:55], 0 offen offset:0 nt
    buffer_load_dwordx4 v[84:87], v6, s[52:55], 0 offen offset:2048 nt
    buffer_load_dwordx4 v[88:91], v6, s[52:55], s32 offen offset:0 nt
    buffer_load_dwordx4 v[124:127], v5, s[56:59], 0 offen offset:0 nt
    buffer_load_dwordx4 v[128:131], v5, s[56:59], 0 offen offset:2048 nt
    buffer_load_dwordx4 v[132:135], v5, s[56:59], s32 offen offset:0 nt
    buffer_load_dwordx4 v[136:139], v5, s[56:59], s32 offen offset:2048 nt
    buffer_load_dwordx4 v[140:143], v5, s[56:59], s33 offen offset:0 nt
    buffer_load_dwordx4 v[144:147], v5, s[56:59], s33 offen offset:2048 nt
    buffer_load_dwordx4 v[148:151], v5, s[56:59], s34 offen offset:0 nt
    buffer_load_dwordx4 v[152:155], v5, s[56:59], s34 offen offset:2048 nt
    s_waitcnt vmcnt(19)
    v_lshlrev_b32 v156, 16, v64
    v_and_b32 v160, 0xffff0000, v64
    v_lshlrev_b32 v164, 16, v65
    v_and_b32 v168, 0xffff0000, v65
    v_lshlrev_b32 v157, 16, v66
    v_and_b32 v161, 0xffff0000, v66
    v_lshlrev_b32 v165, 16, v67
    v_and_b32 v169, 0xffff0000, v67
    v_lshlrev_b32 v158, 16, v68
    v_and_b32 v162, 0xffff0000, v68
    v_lshlrev_b32 v166, 16, v69
    v_and_b32 v170, 0xffff0000, v69
    v_lshlrev_b32 v159, 16, v70
    v_and_b32 v163, 0xffff0000, v70
    v_lshlrev_b32 v167, 16, v71
    v_and_b32 v171, 0xffff0000, v71
    s_waitcnt vmcnt(8)
    v_lshlrev_b32 v172, 16, v80
    v_and_b32 v173, 0xffff0000, v80
    v_lshlrev_b32 v174, 16, v81
    v_and_b32 v175, 0xffff0000, v81
    v_lshlrev_b32 v176, 16, v84
    v_and_b32 v177, 0xffff0000, v84
    v_lshlrev_b32 v178, 16, v85
    v_and_b32 v179, 0xffff0000, v85
    v_lshlrev_b32 v180, 16, v88
    v_and_b32 v181, 0xffff0000, v88
    v_lshlrev_b32 v182, 16, v89
    v_and_b32 v183, 0xffff0000, v89
    v_lshlrev_b32 v184, 16, v92
    v_and_b32 v185, 0xffff0000, v92
    v_lshlrev_b32 v186, 16, v93
    v_and_b32 v187, 0xffff0000, v93
    v_lshlrev_b32 v188, 16, v96
    v_and_b32 v189, 0xffff0000, v96
    v_lshlrev_b32 v190, 16, v97
    v_and_b32 v191, 0xffff0000, v97
    v_lshlrev_b32 v192, 16, v100
    v_and_b32 v193, 0xffff0000, v100
    v_lshlrev_b32 v194, 16, v101
    v_and_b32 v195, 0xffff0000, v101
    v_lshlrev_b32 v196, 16, v104
    v_and_b32 v197, 0xffff0000, v104
    v_lshlrev_b32 v198, 16, v105
    v_and_b32 v199, 0xffff0000, v105
    v_lshlrev_b32 v200, 16, v108
    v_and_b32 v201, 0xffff0000, v108
    v_lshlrev_b32 v202, 16, v109
    v_and_b32 v203, 0xffff0000, v109
    v_lshlrev_b32 v204, 16, v112
    v_and_b32 v205, 0xffff0000, v112
    v_lshlrev_b32 v206, 16, v113
    v_and_b32 v207, 0xffff0000, v113
    v_lshlrev_b32 v208, 16, v116
    v_and_b32 v209, 0xffff0000, v116
    v_lshlrev_b32 v210, 16, v117
    v_and_b32 v211, 0xffff0000, v117
    v_lshlrev_b32 v212, 16, v120
    v_and_b32 v213, 0xffff0000, v120
    v_lshlrev_b32 v214, 16, v121
    v_and_b32 v215, 0xffff0000, v121
    v_mul_f32 v216, v184, v156
    v_mul_f32 v217, v185, v157
    v_mul_f32 v218, v186, v158
    v_mul_f32 v219, v187, v159
    v_mul_f32 v220, v188, v156
    v_mul_f32 v221, v189, v157
    v_mul_f32 v222, v190, v158
    v_mul_f32 v223, v191, v159
    v_mul_f32 v224, v192, v156
    v_mul_f32 v225, v193, v157
    v_mul_f32 v226, v194, v158
    v_mul_f32 v227, v195, v159
    v_mul_f32 v228, v196, v156
    v_mul_f32 v229, v197, v157
    v_mul_f32 v230, v198, v158
    v_mul_f32 v231, v199, v159
    v_mul_f32 v232, v200, v156
    v_mul_f32 v233, v201, v157
    v_mul_f32 v234, v202, v158
    v_mul_f32 v235, v203, v159
    v_mul_f32 v236, v204, v156
    v_mul_f32 v237, v205, v157
    v_mul_f32 v238, v206, v158
    v_mul_f32 v239, v207, v159
    v_mul_f32 v240, v208, v156
    v_mul_f32 v241, v209, v157
    v_mul_f32 v242, v210, v158
    v_mul_f32 v243, v211, v159
    v_mul_f32 v244, v212, v156
    v_mul_f32 v245, v213, v157
    v_mul_f32 v246, v214, v158
    v_mul_f32 v247, v215, v159
    v_fmac_f32 v216, v180, v160
    v_fmac_f32 v217, v181, v161
    v_fmac_f32 v218, v182, v162
    v_fmac_f32 v219, v183, v163
    v_fmac_f32 v220, v184, v160
    v_fmac_f32 v221, v185, v161
    v_fmac_f32 v222, v186, v162
    v_fmac_f32 v223, v187, v163
    v_fmac_f32 v224, v188, v160
    v_fmac_f32 v225, v189, v161
    v_fmac_f32 v226, v190, v162
    v_fmac_f32 v227, v191, v163
    v_fmac_f32 v228, v192, v160
    v_fmac_f32 v229, v193, v161
    v_fmac_f32 v230, v194, v162
    v_fmac_f32 v231, v195, v163
    v_fmac_f32 v232, v196, v160
    v_fmac_f32 v233, v197, v161
    v_fmac_f32 v234, v198, v162
    v_fmac_f32 v235, v199, v163
    v_fmac_f32 v236, v200, v160
    v_fmac_f32 v237, v201, v161
    v_fmac_f32 v238, v202, v162
    v_fmac_f32 v239, v203, v163
    v_fmac_f32 v240, v204, v160
    v_fmac_f32 v241, v205, v161
    v_fmac_f32 v242, v206, v162
    v_fmac_f32 v243, v207, v163
    v_fmac_f32 v244, v208, v160
    v_fmac_f32 v245, v209, v161
    v_fmac_f32 v246, v210, v162
    v_fmac_f32 v247, v211, v163
    v_fmac_f32 v216, v176, v164
    v_fmac_f32 v217, v177, v165
    v_fmac_f32 v218, v178, v166
    v_fmac_f32 v219, v179, v167
    v_fmac_f32 v220, v180, v164
    v_fmac_f32 v221, v181, v165
    v_fmac_f32 v222, v182, v166
    v_fmac_f32 v223, v183, v167
    v_fmac_f32 v224, v184, v164
    v_fmac_f32 v225, v185, v165
    v_fmac_f32 v226, v186, v166
    v_fmac_f32 v227, v187, v167
    v_fmac_f32 v228, v188, v164
    v_fmac_f32 v229, v189, v165
    v_fmac_f32 v230, v190, v166
    v_fmac_f32 v231, v191, v167
    v_fmac_f32 v232, v192, v164
    v_fmac_f32 v233, v193, v165
    v_fmac_f32 v234, v194, v166
    v_fmac_f32 v235, v195, v167
    v_fmac_f32 v236, v196, v164
    v_fmac_f32 v237, v197, v165
    v_fmac_f32 v238, v198, v166
    v_fmac_f32 v239, v199, v167
    v_fmac_f32 v240, v200, v164
    v_fmac_f32 v241, v201, v165
    v_fmac_f32 v242, v202, v166
    v_fmac_f32 v243, v203, v167
    v_fmac_f32 v244, v204, v164
    v_fmac_f32 v245, v205, v165
    v_fmac_f32 v246, v206, v166
    v_fmac_f32 v247, v207, v167
    v_fmac_f32 v216, v172, v168
    v_fmac_f32 v217, v173, v169
    v_fmac_f32 v218, v174, v170
    v_fmac_f32 v219, v175, v171
    v_fmac_f32 v220, v176, v168
    v_fmac_f32 v221, v177, v169
    v_fmac_f32 v222, v178, v170
    v_fmac_f32 v223, v179, v171
    v_fmac_f32 v224, v180, v168
    v_fmac_f32 v225, v181, v169
    v_fmac_f32 v226, v182, v170
    v_fmac_f32 v227, v183, v171
    v_fmac_f32 v228, v184, v168
    v_fmac_f32 v229, v185, v169
    v_fmac_f32 v230, v186, v170
    v_fmac_f32 v231, v187, v171
    v_fmac_f32 v232, v188, v168
    v_fmac_f32 v233, v189, v169
    v_fmac_f32 v234, v190, v170
    v_fmac_f32 v235, v191, v171
    v_fmac_f32 v236, v192, v168
    v_fmac_f32 v237, v193, v169
    v_fmac_f32 v238, v194, v170
    v_fmac_f32 v239, v195, v171
    v_fmac_f32 v240, v196, v168
    v_fmac_f32 v241, v197, v169
    v_fmac_f32 v242, v198, v170
    v_fmac_f32 v243, v199, v171
    v_fmac_f32 v244, v200, v168
    v_fmac_f32 v245, v201, v169
    v_fmac_f32 v246, v202, v170
    v_fmac_f32 v247, v203, v171
    s_mov_b32 s15, 0
L_xl_w:
    ds_read_b64 v[60:61], v21 offset:16
    s_waitcnt lgkmcnt(0)
    v_min_u32 v60, v60, v61
    v_cmp_gt_u32 vcc, 5, v60
    s_cbranch_vccz L_xl_ok
    s_sleep 2
    s_add_u32 s15, s15, 1
    s_cmp_lt_u32 s15, 160000
    s_cbranch_scc1 L_xl_w
L_xl_ok:
    buffer_load_dwordx2 v[58:59], v14, s[72:75], 0 offen sc1
    buffer_load_dwordx2 v[0:1], v19, s[76:79], 0 offen sc1
    s_waitcnt vmcnt(0)
    s_mov_b32 s12, 0
L_np:
    v_cmp_eq_u32 vcc, 0, v0
    s_cbranch_vccz L_nok
    buffer_load_dwordx2 v[0:1], v19, s[76:79], 0 offen sc1
    s_add_u32 s12, s12, 1
    s_waitcnt vmcnt(0)
    s_cmp_lt_u32 s12, 20000
    s_cbranch_scc1 L_np
L_nok:
    ds_write_b64 v21, v[0:1] offset:32
    v_xor_b32 v59, s14, v59
    v_cmp_ne_u64 vcc, v[58:59], v[0:1]
    s_cmp_eq_u64 vcc, 0
    s_cselect_b32 s14, 1, 0
    v_mov_b32 v58, s14
    ds_or_b32 v21, v58 offset:72
    v_lshlrev_b32 v172, 16, v124
    v_and_b32 v173, 0xffff0000, v124
    v_lshlrev_b32 v174, 16, v125
    v_and_b32 v175, 0xffff0000, v125
    v_lshlrev_b32 v176, 16, v128
    v_and_b32 v177, 0xffff0000, v128
    v_lshlrev_b32 v178, 16, v129
    v_and_b32 v179, 0xffff0000, v129
    v_lshlrev_b32 v180, 16, v132
    v_and_b32 v181, 0xffff0000, v132
    v_lshlrev_b32 v182, 16, v133
    v_and_b32 v183, 0xffff0000, v133
    v_lshlrev_b32 v184, 16, v136
    v_and_b32 v185, 0xffff0000, v136
    v_lshlrev_b32 v186, 16, v137
    v_and_b32 v187, 0xffff0000, v137
    v_lshlrev_b32 v188, 16, v140
    v_and_b32 v189, 0xffff0000, v140
    v_lshlrev_b32 v190, 16, v141
    v_and_b32 v191, 0xffff0000, v141
    v_lshlrev_b32 v192, 16, v144
    v_and_b32 v193, 0xffff0000, v144
    v_lshlrev_b32 v194, 16, v145
    v_and_b32 v195, 0xffff0000, v145
    v_lshlrev_b32 v196, 16, v148
    v_and_b32 v197, 0xffff0000, v148
    v_lshlrev_b32 v198, 16, v149
    v_and_b32 v199, 0xffff0000, v149
    v_lshlrev_b32 v200, 16, v152
    v_and_b32 v201, 0xffff0000, v152
    v_lshlrev_b32 v202, 16, v153
    v_and_b32 v203, 0xffff0000, v153
    v_mul_f32 v216, v216, v172
    v_mul_f32 v217, v217, v173
    v_mul_f32 v218, v218, v174
    v_mul_f32 v219, v219, v175
    v_mul_f32 v220, v220, v176
    v_mul_f32 v221, v221, v177
    v_mul_f32 v222, v222, v178
    v_mul_f32 v223, v223, v179
    v_mul_f32 v224, v224, v180
    v_mul_f32 v225, v225, v181
    v_mul_f32 v226, v226, v182
    v_mul_f32 v227, v227, v183
    v_mul_f32 v228, v228, v184
    v_mul_f32 v229, v229, v185
    v_mul_f32 v230, v230, v186
    v_mul_f32 v231, v231, v187
    v_mul_f32 v232, v232, v188
    v_mul_f32 v233, v233, v189
    v_mul_f32 v234, v234, v190
    v_mul_f32 v235, v235, v191
    v_mul_f32 v236, v236, v192
    v_mul_f32 v237, v237, v193
    v_mul_f32 v238, v238, v194
    v_mul_f32 v239, v239, v195
    v_mul_f32 v240, v240, v196
    v_mul_f32 v241, v241, v197
    v_mul_f32 v242, v242, v198
    v_mul_f32 v243, v243, v199
    v_mul_f32 v244, v244, v200
    v_mul_f32 v245, v245, v201
    v_mul_f32 v246, v246, v202
    v_mul_f32 v247, v247, v203
    v_cvt_pk_bf16_f32 v40, v244, v240
    v_cvt_pk_bf16_f32 v41, v236, v232
    v_cvt_pk_bf16_f32 v42, v228, v224
    v_cvt_pk_bf16_f32 v43, v220, v216
    v_cvt_pk_bf16_f32 v44, v245, v241
    v_cvt_pk_bf16_f32 v45, v237, v233
    v_cvt_pk_bf16_f32 v46, v229, v225
    v_cvt_pk_bf16_f32 v47, v221, v217
    v_cvt_pk_bf16_f32 v48, v246, v242
    v_cvt_pk_bf16_f32 v49, v238, v234
    v_cvt_pk_bf16_f32 v50, v230, v226
    v_cvt_pk_bf16_f32 v51, v222, v218
    v_cvt_pk_bf16_f32 v52, v247, v243
    v_cvt_pk_bf16_f32 v53, v239, v235
    v_cvt_pk_bf16_f32 v54, v231, v227
    v_cvt_pk_bf16_f32 v55, v223, v219
    s_cmp_eq_u32 s14, 1
    s_cbranch_scc1 L_xp0
    buffer_store_dwordx4 v[40:43], v8, s[64:67], 0 offen sc1
    buffer_store_dwordx4 v[44:47], v8, s[64:67], s32 offen sc1
    buffer_store_dwordx4 v[48:51], v8, s[64:67], s33 offen sc1
    buffer_store_dwordx4 v[52:55], v8, s[64:67], s34 offen sc1
    s_branch L_xq0
L_xp0:
    buffer_store_dwordx4 v[40:43], v8, s[64:67], 0 offen
    buffer_store_dwordx4 v[44:47], v8, s[64:67], s32 offen
    buffer_store_dwordx4 v[48:51], v8, s[64:67], s33 offen
    buffer_store_dwordx4 v[52:55], v8, s[64:67], s34 offen
L_xq0:
    v_lshlrev_b32 v156, 16, v72
    v_and_b32 v160, 0xffff0000, v72
    v_lshlrev_b32 v164, 16, v73
    v_and_b32 v168, 0xffff0000, v73
    v_lshlrev_b32 v157, 16, v74
    v_and_b32 v161, 0xffff0000, v74
    v_lshlrev_b32 v165, 16, v75
    v_and_b32 v169, 0xffff0000, v75
    v_lshlrev_b32 v158, 16, v76
    v_and_b32 v162, 0xffff0000, v76
    v_lshlrev_b32 v166, 16, v77
    v_and_b32 v170, 0xffff0000, v77
    v_lshlrev_b32 v159, 16, v78
    v_and_b32 v163, 0xffff0000, v78
    v_lshlrev_b32 v167, 16, v79
    v_and_b32 v171, 0xffff0000, v79
    v_lshlrev_b32 v172, 16, v82
    v_and_b32 v173, 0xffff0000, v82
    v_lshlrev_b32 v174, 16, v83
    v_and_b32 v175, 0xffff0000, v83
    v_lshlrev_b32 v176, 16, v86
    v_and_b32 v177, 0xffff0000, v86
    v_lshlrev_b32 v178, 16, v87
    v_and_b32 v179, 0xffff0000, v87
    v_lshlrev_b32 v180, 16, v90
    v_and_b32 v181, 0xffff0000, v90
    v_lshlrev_b32 v182, 16, v91
    v_and_b32 v183, 0xffff0000, v91
    v_lshlrev_b32 v184, 16, v94
    v_and_b32 v185, 0xffff0000, v94
    v_lshlrev_b32 v186, 16, v95
    v_and_b32 v187, 0xffff0000, v95
    v_lshlrev_b32 v188, 16, v98
    v_and_b32 v189, 0xffff0000, v98
    v_lshlrev_b32 v190, 16, v99
    v_and_b32 v191, 0xffff0000, v99
    v_lshlrev_b32 v192, 16, v102
    v_and_b32 v193, 0xffff0000, v102
    v_lshlrev_b32 v194, 16, v103
    v_and_b32 v195, 0xffff0000, v103
    v_lshlrev_b32 v196, 16, v106
    v_and_b32 v197, 0xffff0000, v106
    v_lshlrev_b32 v198, 16, v107
    v_and_b32 v199, 0xffff0000, v107
    v_lshlrev_b32 v200, 16, v110
    v_and_b32 v201, 0xffff0000, v110
    v_lshlrev_b32 v202, 16, v111
    v_and_b32 v203, 0xffff0000, v111
    v_lshlrev_b32 v204, 16, v114
    v_and_b32 v205, 0xffff0000, v114
    v_lshlrev_b32 v206, 16, v115
    v_and_b32 v207, 0xffff0000, v115
    v_lshlrev_b32 v208, 16, v118
    v_and_b32 v209, 0xffff0000, v118
    v_lshlrev_b32 v210, 16, v119
    v_and_b32 v211, 0xffff0000, v119
    v_lshlrev_b32 v212, 16, v122
    v_and_b32 v213, 0xffff0000, v122
    v_lshlrev_b32 v214, 16, v123
    v_and_b32 v215, 0xffff0000, v123
    v_mul_f32 v216, v184, v156
    v_mul_f32 v217, v185, v157
    v_mul_f32 v218, v186, v158
    v_mul_f32 v219, v187, v159
    v_mul_f32 v220, v188, v156
    v_mul_f32 v221, v189, v157
    v_mul_f32 v222, v190, v158
    v_mul_f32 v223, v191, v159
    v_mul_f32 v224, v192, v156
    v_mul_f32 v225, v193, v157
    v_mul_f32 v226, v194, v158
    v_mul_f32 v227, v195, v159
    v_mul_f32 v228, v196, v156
    v_mul_f32 v229, v197, v157
    v_mul_f32 v230, v198, v158
    v_mul_f32 v231, v199, v159
    v_mul_f32 v232, v200, v156
    v_mul_f32 v233, v201, v157
    v_mul_f32 v234, v202, v158
    v_mul_f32 v235, v203, v159
    v_mul_f32 v236, v204, v156
    v_mul_f32 v237, v205, v157
    v_mul_f32 v238, v206, v158
    v_mul_f32 v239, v207, v159
    v_mul_f32 v240, v208, v156
    v_mul_f32 v241, v209, v157
    v_mul_f32 v242, v210, v158
    v_mul_f32 v243, v211, v159
    v_mul_f32 v244, v212, v156
    v_mul_f32 v245, v213, v157
    v_mul_f32 v246, v214, v158
    v_mul_f32 v247, v215, v159
    v_fmac_f32 v216, v180, v160
    v_fmac_f32 v217, v181, v161
    v_fmac_f32 v218, v182, v162
    v_fmac_f32 v219, v183, v163
    v_fmac_f32 v220, v184, v160
    v_fmac_f32 v221, v185, v161
    v_fmac_f32 v222, v186, v162
    v_fmac_f32 v223, v187, v163
    v_fmac_f32 v224, v188, v160
    v_fmac_f32 v225, v189, v161
    v_fmac_f32 v226, v190, v162
    v_fmac_f32 v227, v191, v163
    v_fmac_f32 v228, v192, v160
    v_fmac_f32 v229, v193, v161
    v_fmac_f32 v230, v194, v162
    v_fmac_f32 v231, v195, v163
    v_fmac_f32 v232, v196, v160
    v_fmac_f32 v233, v197, v161
    v_fmac_f32 v234, v198, v162
    v_fmac_f32 v235, v199, v163
    v_fmac_f32 v236, v200, v160
    v_fmac_f32 v237, v201, v161
    v_fmac_f32 v238, v202, v162
    v_fmac_f32 v239, v203, v163
    v_fmac_f32 v240, v204, v160
    v_fmac_f32 v241, v205, v161
    v_fmac_f32 v242, v206, v162
    v_fmac_f32 v243, v207, v163
    v_fmac_f32 v244, v208, v160
    v_fmac_f32 v245, v209, v161
    v_fmac_f32 v246, v210, v162
    v_fmac_f32 v247, v211, v163
    v_fmac_f32 v216, v176, v164
    v_fmac_f32 v217, v177, v165
    v_fmac_f32 v218, v178, v166
    v_fmac_f32 v219, v179, v167
    v_fmac_f32 v220, v180, v164
    v_fmac_f32 v221, v181, v165
    v_fmac_f32 v222, v182, v166
    v_fmac_f32 v223, v183, v167
    v_fmac_f32 v224, v184, v164
    v_fmac_f32 v225, v185, v165
    v_fmac_f32 v226, v186, v166
    v_fmac_f32 v227, v187, v167
    v_fmac_f32 v228, v188, v164
    v_fmac_f32 v229, v189, v165
    v_fmac_f32 v230, v190, v166
    v_fmac_f32 v231, v191, v167
    v_fmac_f32 v232, v192, v164
    v_fmac_f32 v233, v193, v165
    v_fmac_f32 v234, v194, v166
    v_fmac_f32 v235, v195, v167
    v_fmac_f32 v236, v196, v164
    v_fmac_f32 v237, v197, v165
    v_fmac_f32 v238, v198, v166
    v_fmac_f32 v239, v199, v167
    v_fmac_f32 v240, v200, v164
    v_fmac_f32 v241, v201, v165
    v_fmac_f32 v242, v202, v166
    v_fmac_f32 v243, v203, v167
    v_fmac_f32 v244, v204, v164
    v_fmac_f32 v245, v205, v165
    v_fmac_f32 v246, v206, v166
    v_fmac_f32 v247, v207, v167
    v_fmac_f32 v216, v172, v168
    v_fmac_f32 v217, v173, v169
    v_fmac_f32 v218, v174, v170
    v_fmac_f32 v219, v175, v171
    v_fmac_f32 v220, v176, v168
    v_fmac_f32 v221, v177, v169
    v_fmac_f32 v222, v178, v170
    v_fmac_f32 v223, v179, v171
    v_fmac_f32 v224, v180, v168
    v_fmac_f32 v225, v181, v169
    v_fmac_f32 v226, v182, v170
    v_fmac_f32 v227, v183, v171
    v_fmac_f32 v228, v184, v168
    v_fmac_f32 v229, v185, v169
    v_fmac_f32 v230, v186, v170
    v_fmac_f32 v231, v187, v171
    v_fmac_f32 v232, v188, v168
    v_fmac_f32 v233, v189, v169
    v_fmac_f32 v234, v190, v170
    v_fmac_f32 v235, v191, v171
    v_fmac_f32 v236, v192, v168
    v_fmac_f32 v237, v193, v169
    v_fmac_f32 v238, v194, v170
    v_fmac_f32 v239, v195, v171
    v_fmac_f32 v240, v196, v168
    v_fmac_f32 v241, v197, v169
    v_fmac_f32 v242, v198, v170
    v_fmac_f32 v243, v199, v171
    v_fmac_f32 v244, v200, v168
    v_fmac_f32 v245, v201, v169
    v_fmac_f32 v246, v202, v170
    v_fmac_f32 v247, v203, v171
    v_lshlrev_b32 v172, 16, v126
    v_and_b32 v173, 0xffff0000, v126
    v_lshlrev_b32 v174, 16, v127
    v_and_b32 v175, 0xffff0000, v127
    v_lshlrev_b32 v176, 16, v130
    v_and_b32 v177, 0xffff0000, v130
    v_lshlrev_b32 v178, 16, v131
    v_and_b32 v179, 0xffff0000, v131
    v_lshlrev_b32 v180, 16, v134
    v_and_b32 v181, 0xffff0000, v134
    v_lshlrev_b32 v182, 16, v135
    v_and_b32 v183, 0xffff0000, v135
    v_lshlrev_b32 v184, 16, v138
    v_and_b32 v185, 0xffff0000, v138
    v_lshlrev_b32 v186, 16, v139
    v_and_b32 v187, 0xffff0000, v139
    v_lshlrev_b32 v188, 16, v142
    v_and_b32 v189, 0xffff0000, v142
    v_lshlrev_b32 v190, 16, v143
    v_and_b32 v191, 0xffff0000, v143
    v_lshlrev_b32 v192, 16, v146
    v_and_b32 v193, 0xffff0000, v146
    v_lshlrev_b32 v194, 16, v147
    v_and_b32 v195, 0xffff0000, v147
    v_lshlrev_b32 v196, 16, v150
    v_and_b32 v197, 0xffff0000, v150
    v_lshlrev_b32 v198, 16, v151
    v_and_b32 v199, 0xffff0000, v151
    v_lshlrev_b32 v200, 16, v154
    v_and_b32 v201, 0xffff0000, v154
    v_lshlrev_b32 v202, 16, v155
    v_and_b32 v203, 0xffff0000, v155
    v_mul_f32 v216, v216, v172
    v_mul_f32 v217, v217, v173
    v_mul_f32 v218, v218, v174
    v_mul_f32 v219, v219, v175
    v_mul_f32 v220, v220, v176
    v_mul_f32 v221, v221, v177
    v_mul_f32 v222, v222, v178
    v_mul_f32 v223, v223, v179
    v_mul_f32 v224, v224, v180
    v_mul_f32 v225, v225, v181
    v_mul_f32 v226, v226, v182
    v_mul_f32 v227, v227, v183
    v_mul_f32 v228, v228, v184
    v_mul_f32 v229, v229, v185
    v_mul_f32 v230, v230, v186
    v_mul_f32 v231, v231, v187
    v_mul_f32 v232, v232, v188
    v_mul_f32 v233, v233, v189
    v_mul_f32 v234, v234, v190
    v_mul_f32 v235, v235, v191
    v_mul_f32 v236, v236, v192
    v_mul_f32 v237, v237, v193
    v_mul_f32 v238, v238, v194
    v_mul_f32 v239, v239, v195
    v_mul_f32 v240, v240, v196
    v_mul_f32 v241, v241, v197
    v_mul_f32 v242, v242, v198
    v_mul_f32 v243, v243, v199
    v_mul_f32 v244, v244, v200
    v_mul_f32 v245, v245, v201
    v_mul_f32 v246, v246, v202
    v_mul_f32 v247, v247, v203
    v_cvt_pk_bf16_f32 v40, v244, v240
    v_cvt_pk_bf16_f32 v41, v236, v232
    v_cvt_pk_bf16_f32 v42, v228, v224
    v_cvt_pk_bf16_f32 v43, v220, v216
    v_cvt_pk_bf16_f32 v44, v245, v241
    v_cvt_pk_bf16_f32 v45, v237, v233
    v_cvt_pk_bf16_f32 v46, v229, v225
    v_cvt_pk_bf16_f32 v47, v221, v217
    v_cvt_pk_bf16_f32 v48, v246, v242
    v_cvt_pk_bf16_f32 v49, v238, v234
    v_cvt_pk_bf16_f32 v50, v230, v226
    v_cvt_pk_bf16_f32 v51, v222, v218
    v_cvt_pk_bf16_f32 v52, v247, v243
    v_cvt_pk_bf16_f32 v53, v239, v235
    v_cvt_pk_bf16_f32 v54, v231, v227
    v_cvt_pk_bf16_f32 v55, v223, v219
    s_cmp_eq_u32 s14, 1
    s_cbranch_scc1 L_xp1
    buffer_store_dwordx4 v[40:43], v9, s[64:67], 0 offen sc1
    buffer_store_dwordx4 v[44:47], v9, s[64:67], s32 offen sc1
    buffer_store_dwordx4 v[48:51], v9, s[64:67], s33 offen sc1
    buffer_store_dwordx4 v[52:55], v9, s[64:67], s34 offen sc1
    s_branch L_xq1
L_xp1:
    buffer_store_dwordx4 v[40:43], v9, s[64:67], 0 offen
    buffer_store_dwordx4 v[44:47], v9, s[64:67], s32 offen
    buffer_store_dwordx4 v[48:51], v9, s[64:67], s33 offen
    buffer_store_dwordx4 v[52:55], v9, s[64:67], s34 offen
L_xq1:
    s_waitcnt vmcnt(0)
    s_mov_b64 exec, 1
    s_cmp_eq_u32 s14, 1
    s_cbranch_scc0 L_xf0
    buffer_store_dwordx2 v[0:1], v19, s[72:75], s13 offen
    s_branch L_xf1
L_xf0:
    buffer_store_dwordx2 v[0:1], v19, s[72:75], s13 offen sc1
L_xf1:
    s_mov_b64 exec, -1
    s_cmp_eq_u32 s8, 3
    s_cbranch_scc0 L_id2
    s_mov_b32 s15, 0
L_i2_w:
    ds_read_b64 v[60:61], v21 offset:16
    s_waitcnt lgkmcnt(0)
    v_min_u32 v60, v60, v61
    v_cmp_gt_u32 vcc, 14, v60
    s_cbranch_vccz L_i2_ok
    s_sleep 2
    s_add_u32 s15, s15, 1
    s_cmp_lt_u32 s15, 160000
    s_cbranch_scc1 L_i2_w
L_i2_ok:
    s_mov_b32 s15, 0
LK_poll:
    buffer_load_dwordx2 v[60:61], v20, s[72:75], 0 offen sc1
    s_waitcnt vmcnt(0)
    v_cmp_ne_u64 vcc, v[60:61], v[0:1]
    s_cbranch_vccz LK_ok
    s_add_u32 s15, s15, 1
    s_cmp_lt_u32 s15, 20000
    s_cbranch_scc1 LK_poll
LK_ok:
    ds_write_b32 v21, v25 offset:44
L_id2:
    s_mov_b32 s15, 0
L_is1_w:
    ds_read_b32 v60, v21 offset:40
    s_waitcnt lgkmcnt(0)
    v_cmp_gt_u32 vcc, 2, v60
    s_cbranch_vccz L_is1_ok
    s_sleep 2
    s_add_u32 s15, s15, 1
    s_cmp_lt_u32 s15, 160000
    s_cbranch_scc1 L_is1_w
L_is1_ok:
    buffer_load_dwordx4 v[192:195], v26, s[68:71], s36 offen offset:0 nt
    buffer_load_dwordx4 v[196:199], v26, s[68:71], s36 offen offset:1024 nt
    buffer_load_dwordx4 v[200:203], v26, s[68:71], s36 offen offset:2048 nt
    buffer_load_dwordx4 v[204:207], v26, s[68:71], s36 offen offset:3072 nt
L_t2:
    s_mov_b32 s52, s50
    s_mov_b32 s53, s51
    s_mov_b32 s54, 4194304
    s_mov_b32 s55, 0x00020000
    s_mov_b32 s56, s50
    s_mov_b32 s57, s51
    s_mov_b32 s58, 4194304
    s_mov_b32 s59, 0x00020000
    s_mov_b32 s60, s16
    s_mov_b32 s61, s17
    s_mov_b32 s62, 4194304
    s_mov_b32 s63, 0x00020000
    s_mov_b32 s64, s46
    s_mov_b32 s65, s47
    s_mov_b32 s66, 16777216
    s_mov_b32 s67, 0x00020000
    s_mov_b32 s15, 0
L_fk_w:
    ds_read_b32 v60, v21 offset:44
    s_waitcnt lgkmcnt(0)
    v_cmp_gt_u32 vcc, 1, v60
    s_cbranch_vccz L_fk_ok
    s_sleep 1
    s_add_u32 s15, s15, 1
    s_cmp_lt_u32 s15, 160000
    s_cbranch_scc1 L_fk_w
L_fk_ok:
    ds_read_b64 v[0:1], v21 offset:32
    buffer_load_dwordx4 v[224:227], v26, s[52:55], s36 offen offset:0 sc1
    buffer_load_dwordx4 v[228:231], v26, s[52:55], s36 offen offset:1024 sc1
    buffer_load_dwordx4 v[232:235], v26, s[52:55], s36 offen offset:2048 sc1
    buffer_load_dwordx4 v[236:239], v26, s[52:55], s36 offen offset:3072 sc1
    buffer_load_dwordx2 v[4:5], v16, s[60:63], 0 offen offset:0 nt
    buffer_load_dwordx2 v[6:7], v16, s[60:63], 0 offen offset:2048 nt
    s_waitcnt vmcnt(9)
    buffer_load_dwordx2 v[8:9], v16, s[60:63], s32 offen offset:0 nt
    s_waitcnt vmcnt(9)
    buffer_load_dwordx2 v[10:11], v16, s[60:63], s32 offen offset:2048 nt
    s_waitcnt vmcnt(9)
    buffer_load_dwordx2 v[14:15], v16, s[60:63], s33 offen offset:0 nt
    s_waitcnt vmcnt(9)
    buffer_load_dwordx2 v[56:57], v16, s[60:63], s33 offen offset:2048 nt
    s_waitcnt vmcnt(9)
    buffer_load_dwordx2 v[58:59], v16, s[60:63], s34 offen offset:0 nt
    s_waitcnt vmcnt(9)
    buffer_load_dwordx2 v[34:35], v16, s[60:63], s34 offen offset:2048 nt
    s_lshl_b32 s14, s9, 13
    s_lshl_b32 s10, s11, 12
    s_add_u32 s14, s14, s10
    s_mov_b32 s15, 0
L_c1_w:
    ds_read_b128 v[60:63], v21 offset:0
    s_waitcnt lgkmcnt(0)
    v_min3_u32 v60, v60, v61, v62
    v_min_u32 v60, v60, v63
    v_cmp_gt_u32 vcc, 14, v60
    s_cbranch_vccz L_c1_ok
    s_sleep 1
    s_add_u32 s15, s15, 1
    s_cmp_lt_u32 s15, 160000
    s_cbranch_scc1 L_c1_w
L_c1_ok:
    s_waitcnt vmcnt(9)
    s_bfe_u32 s13, s37, 0 + (4 << 16)
    s_lshl_b32 s13, s13, 7
    s_add_u32 m0, s14, 0
    s_nop 0
    buffer_load_dwordx4 v12, s[80:83], s13 offen offset:0 lds
    s_waitcnt vmcnt(9)
    buffer_load_dwordx4 v13, s[80:83], s13 offen offset:1024 lds
    s_waitcnt vmcnt(9)
    buffer_load_dwordx4 v12, s[80:83], s13 offen offset:2048 lds
    s_waitcnt vmcnt(9)
    buffer_load_dwordx4 v13, s[80:83], s13 offen offset:3072 lds
    s_waitcnt vmcnt(9)
    s_bfe_u32 s13, s37, 4 + (4 << 16)
    s_lshl_b32 s13, s13, 7
    s_add_u32 m0, s14, 16384
    s_nop 0
    buffer_load_dwordx4 v12, s[80:83], s13 offen offset:0 lds
    s_waitcnt vmcnt(9)
    buffer_load_dwordx4 v13, s[80:83], s13 offen offset:1024 lds
    s_waitcnt vmcnt(9)
    buffer_load_dwordx4 v12, s[80:83], s13 offen offset:2048 lds
    s_waitcnt vmcnt(9)
    buffer_load_dwordx4 v13, s[80:83], s13 offen offset:3072 lds
    s_waitcnt vmcnt(9)
    s_bfe_u32 s13, s37, 8 + (4 << 16)
    s_lshl_b32 s13, s13, 7
    s_add_u32 m0, s14, 32768
    s_nop 0
    buffer_load_dwordx4 v12, s[80:83], s13 offen offset:0 lds
    s_waitcnt vmcnt(9)
    buffer_load_dwordx4 v13, s[80:83], s13 offen offset:1024 lds
    s_waitcnt vmcnt(9)
    buffer_load_dwordx4 v12, s[80:83], s13 offen offset:2048 lds
    s_waitcnt vmcnt(9)
    buffer_load_dwordx4 v13, s[80:83], s13 offen offset:3072 lds
    s_bitcmp1_b32 s100, 0
    s_cselect_b32 s10, 16, 0
    s_lshr_b32 s31, s31, s10
    s_and_b32 s31, s31, 0xffff
    v_lshlrev_b32 v60, 3, v27
    v_sub_u32 v60, v60, v17
    v_add_u32 v60, -9, v60
    v_and_b32 v61, 1, v60
    v_lshlrev_b32 v61, 4, v61
    v_lshlrev_b32 v61, v61, s31
    v_ashrrev_i32 v60, 1, v60
    v_cmp_eq_u32 vcc, 0, v60
    s_nop 1
    v_cndmask_b32 v36, 0, v61, vcc
    v_cmp_eq_u32 vcc, 1, v60
    s_nop 1
    v_cndmask_b32 v37, 0, v61, vcc
    v_cmp_eq_u32 vcc, 2, v60
    s_nop 1
    v_cndmask_b32 v38, 0, v61, vcc
    v_cmp_eq_u32 vcc, 3, v60
    s_nop 1
    v_cndmask_b32 v39, 0, v61, vcc
    v_mov_b32 v128, 0
    v_mov_b32 v129, 0
    v_mov_b32 v130, 0
    v_mov_b32 v131, 0
    v_and_b32 v60, 1, v27
    v_lshlrev_b32 v60, 9, v60
    v_lshl_add_u32 v60, v17, 5, v60
    v_lshrrev_b32 v61, 1, v27
    v_lshl_add_u32 v17, v61, 4, v60
    v_and_b32 v60, 1, v2
    v_lshrrev_b32 v61, 5, v2
    v_lshl_add_u32 v60, v60, 1, v61
    v_bfe_u32 v61, v2, 1, 4
    v_lshl_add_u32 v60, v60, 4, v61
    v_lshlrev_b32 v17, 2, v60
    s_waitcnt vmcnt(24)
    v_mov_b32 v208, 0
    v_alignbit_b32 v209, v193, v192, 16
    v_alignbit_b32 v210, v194, v193, 16
    v_alignbit_b32 v211, v195, v194, 16
    s_nop 0
    v_mov_b32_dpp v208, v195 wave_shr:1 row_mask:0xf bank_mask:0xf
    v_alignbit_b32 v208, v192, v208, 16
    v_readlane_b32 s10, v195, 63
    v_alignbit_b32 v213, v197, v196, 16
    v_alignbit_b32 v214, v198, v197, 16
    v_mov_b32 v212, s10
    v_alignbit_b32 v215, v199, v198, 16
    s_nop 0
    v_mov_b32_dpp v212, v199 wave_shr:1 row_mask:0xf bank_mask:0xf
    v_alignbit_b32 v212, v196, v212, 16
    v_readlane_b32 s10, v199, 63
    v_alignbit_b32 v217, v201, v200, 16
    v_alignbit_b32 v218, v202, v201, 16
    v_mov_b32 v216, s10
    v_alignbit_b32 v219, v203, v202, 16
    s_nop 0
    v_mov_b32_dpp v216, v203 wave_shr:1 row_mask:0xf bank_mask:0xf
    v_alignbit_b32 v216, v200, v216, 16
    v_readlane_b32 s10, v203, 63
    v_alignbit_b32 v221, v205, v204, 16
    v_alignbit_b32 v222, v206, v205, 16
    v_mov_b32 v220, s10
    v_alignbit_b32 v223, v207, v206, 16
    s_nop 0
    v_mov_b32_dpp v220, v207 wave_shr:1 row_mask:0xf bank_mask:0xf
    v_alignbit_b32 v220, v204, v220, 16
    s_mov_b32 s15, 0
L_c2_w:
    ds_read_b128 v[60:63], v21 offset:0
    s_waitcnt lgkmcnt(0)
    v_min3_u32 v60, v60, v61, v62
    v_min_u32 v60, v60, v63
    v_cmp_gt_u32 vcc, 16, v60
    s_cbranch_vccz L_c2_ok
    s_sleep 1
    s_add_u32 s15, s15, 1
    s_cmp_lt_u32 s15, 160000
    s_cbranch_scc1 L_c2_w
L_c2_ok:
    s_setprio 0
    ds_write_b128 v18, v[128:131]
    v_add_u32 v62, -8288, v33
    ds_write_b128 v62, v[192:195] offset:0
    ds_write_b128 v62, v[196:199] offset:1024
    ds_write_b128 v62, v[200:203] offset:2048
    ds_write_b128 v62, v[204:207] offset:3072
    ds_write_b128 v62, v[208:211] offset:4160
    ds_write_b128 v62, v[212:215] offset:5184
    ds_write_b128 v62, v[216:219] offset:6208
    ds_write_b128 v62, v[220:223] offset:7232
    ds_read2_b32 v[128:129], v28 offset0:0 offset1:1
    ds_read2_b32 v[130:131], v28 offset0:2 offset1:3
    ds_read2_b32 v[132:133], v28 offset0:128 offset1:129
    ds_read2_b32 v[134:135], v28 offset0:130 offset1:131
    ds_read2_b32 v[136:137], v29 offset0:0 offset1:1
    ds_read2_b32 v[138:139], v29 offset0:2 offset1:3
    ds_read2_b32 v[140:141], v29 offset0:128 offset1:129
    ds_read2_b32 v[142:143], v29 offset0:130 offset1:131
    ds_read2_b32 v[144:145], v30 offset0:0 offset1:1
    ds_read2_b32 v[146:147], v30 offset0:2 offset1:3
    ds_read2_b32 v[148:149], v30 offset0:128 offset1:129
    ds_read2_b32 v[150:151], v30 offset0:130 offset1:131
    ds_read2_b32 v[152:153], v31 offset0:0 offset1:1
    ds_read2_b32 v[154:155], v31 offset0:2 offset1:3
    ds_read2_b32 v[156:157], v31 offset0:128 offset1:129
    ds_read2_b32 v[158:159], v31 offset0:130 offset1:131
    s_waitcnt vmcnt(23)
    ds_write_b128 v33, v[224:227] offset:0
    s_waitcnt vmcnt(22)
    ds_write_b128 v33, v[228:231] offset:1024
    s_waitcnt vmcnt(21)
    ds_write_b128 v33, v[232:235] offset:2048
    s_waitcnt vmcnt(20)
    ds_write_b128 v33, v[236:239] offset:3072
    ds_read_b128 v[160:163], v32 offset:3584
    ds_read_b128 v[164:167], v32 offset:3072
    ds_read_b128 v[168:171], v32 offset:2560
    ds_read_b128 v[172:175], v32 offset:2048
    ds_read_b128 v[176:179], v32 offset:1536
    ds_read_b128 v[180:183], v32 offset:1024
    ds_read_b128 v[184:187], v32 offset:512
    ds_read_b128 v[188:191], v32 offset:0
    s_setprio 2
    s_waitcnt lgkmcnt(0)
    v_mfma_f32_16x16x32_bf16 v[96:99], v[36:39], v[160:163], 0
    v_mfma_f32_16x16x32_bf16 v[100:103], v[36:39], v[164:167], 0
    v_mfma_f32_16x16x32_bf16 v[104:107], v[36:39], v[168:171], 0
    v_mfma_f32_16x16x32_bf16 v[108:111], v[36:39], v[172:175], 0
    v_mfma_f32_16x16x32_bf16 v[112:115], v[36:39], v[176:179], 0
    v_mfma_f32_16x16x32_bf16 v[116:119], v[36:39], v[180:183], 0
    v_mfma_f32_16x16x32_bf16 v[120:123], v[36:39], v[184:187], 0
    v_mfma_f32_16x16x32_bf16 v[124:127], v[36:39], v[188:191], 0
    v_mfma_f32_16x16x32_bf16 v[96:99], v[128:131], v[160:163], v[96:99]
    ds_read2_b32 v[192:193], v28 offset0:16 offset1:17
    s_bfe_u32 s13, s37, 12 + (4 << 16)
    s_lshl_b32 s13, s13, 7
    s_add_u32 m0, s14, 49152
    s_nop 0
    buffer_load_dwordx4 v12, s[80:83], s13 offen offset:0 lds
    v_mfma_f32_16x16x32_bf16 v[100:103], v[128:131], v[164:167], v[100:103]
    ds_read2_b32 v[194:195], v28 offset0:18 offset1:19
    v_mfma_f32_16x16x32_bf16 v[104:107], v[128:131], v[168:171], v[104:107]
    ds_read_b128 v[224:227], v32 offset:3648
    v_mfma_f32_16x16x32_bf16 v[108:111], v[128:131], v[172:175], v[108:111]
    ds_read2_b32 v[196:197], v28 offset0:144 offset1:145
    v_mfma_f32_16x16x32_bf16 v[112:115], v[128:131], v[176:179], v[112:115]
    ds_read2_b32 v[198:199], v28 offset0:146 offset1:147
    v_mfma_f32_16x16x32_bf16 v[116:119], v[128:131], v[180:183], v[116:119]
    ds_read_b128 v[228:231], v32 offset:3136
    v_mfma_f32_16x16x32_bf16 v[120:123], v[128:131], v[184:187], v[120:123]
    ds_read2_b32 v[200:201], v29 offset0:16 offset1:17
    v_mfma_f32_16x16x32_bf16 v[124:127], v[128:131], v[188:191], v[124:127]
    ds_read2_b32 v[202:203], v29 offset0:18 offset1:19
    v_mfma_f32_16x16x32_bf16 v[100:103], v[132:135], v[160:163], v[100:103]
    ds_read_b128 v[232:235], v32 offset:2624
    buffer_load_dwordx4 v13, s[80:83], s13 offen offset:1024 lds
    v_mfma_f32_16x16x32_bf16 v[104:107], v[132:135], v[164:167], v[104:107]
    ds_read2_b32 v[204:205], v29 offset0:144 offset1:145
    v_mfma_f32_16x16x32_bf16 v[108:111], v[132:135], v[168:171], v[108:111]
    ds_read2_b32 v[206:207], v29 offset0:146 offset1:147
    v_mfma_f32_16x16x32_bf16 v[112:115], v[132:135], v[172:175], v[112:115]
    ds_read_b128 v[236:239], v32 offset:2112
    v_mfma_f32_16x16x32_bf16 v[116:119], v[132:135], v[176:179], v[116:119]
    ds_read2_b32 v[208:209], v30 offset0:16 offset1:17
    v_mfma_f32_16x16x32_bf16 v[120:123], v[132:135], v[180:183], v[120:123]
    ds_read2_b32 v[210:211], v30 offset0:18 offset1:19
    v_mfma_f32_16x16x32_bf16 v[124:127], v[132:135], v[184:187], v[124:127]
    ds_read_b128 v[240:243], v32 offset:1600
    v_mfma_f32_16x16x32_bf16 v[104:107], v[136:139], v[160:163], v[104:107]
    ds_read2_b32 v[212:213], v30 offset0:144 offset1:145
    v_mfma_f32_16x16x32_bf16 v[108:111], v[136:139], v[164:167], v[108:111]
    ds_read2_b32 v[214:215], v30 offset0:146 offset1:147
    buffer_load_dwordx4 v12, s[80:83], s13 offen offset:2048 lds
    v_mfma_f32_16x16x32_bf16 v[112:115], v[136:139], v[168:171], v[112:115]
    ds_read_b128 v[244:247], v32 offset:1088
    v_mfma_f32_16x16x32_bf16 v[116:119], v[136:139], v[172:175], v[116:119]
    ds_read2_b32 v[216:217], v31 offset0:16 offset1:17
    v_mfma_f32_16x16x32_bf16 v[120:123], v[136:139], v[176:179], v[120:123]
    ds_read2_b32 v[218:219], v31 offset0:18 offset1:19
    v_mfma_f32_16x16x32_bf16 v[124:127], v[136:139], v[180:183], v[124:127]
    ds_read_b128 v[248:251], v32 offset:576
    v_mfma_f32_16x16x32_bf16 v[108:111], v[140:143], v[160:163], v[108:111]
    ds_read2_b32 v[220:221], v31 offset0:144 offset1:145
    v_mfma_f32_16x16x32_bf16 v[112:115], v[140:143], v[164:167], v[112:115]
    ds_read2_b32 v[222:223], v31 offset0:146 offset1:147
    v_mfma_f32_16x16x32_bf16 v[116:119], v[140:143], v[168:171], v[116:119]
    ds_read_b128 v[252:255], v32 offset:64
    v_mfma_f32_16x16x32_bf16 v[120:123], v[140:143], v[172:175], v[120:123]
    buffer_load_dwordx4 v13, s[80:83], s13 offen offset:3072 lds
    v_mfma_f32_16x16x32_bf16 v[124:127], v[140:143], v[176:179], v[124:127]
    v_mfma_f32_16x16x32_bf16 v[112:115], v[144:147], v[160:163], v[112:115]
    v_mfma_f32_16x16x32_bf16 v[116:119], v[144:147], v[164:167], v[116:119]
    v_mfma_f32_16x16x32_bf16 v[120:123], v[144:147], v[168:171], v[120:123]
    v_mfma_f32_16x16x32_bf16 v[124:127], v[144:147], v[172:175], v[124:127]
    v_mfma_f32_16x16x32_bf16 v[116:119], v[148:151], v[160:163], v[116:119]
    v_mfma_f32_16x16x32_bf16 v[120:123], v[148:151], v[164:167], v[120:123]
    v_mfma_f32_16x16x32_bf16 v[124:127], v[148:151], v[168:171], v[124:127]
    s_bfe_u32 s13, s30, 28 + (4 << 16)
    s_lshl_b32 s13, s13, 7
    buffer_load_dwordx4 v[40:43], v12, s[80:83], s13 offen offset:0
    v_mfma_f32_16x16x32_bf16 v[120:123], v[152:155], v[160:163], v[120:123]
    v_mfma_f32_16x16x32_bf16 v[124:127], v[152:155], v[164:167], v[124:127]
    v_mfma_f32_16x16x32_bf16 v[124:127], v[156:159], v[160:163], v[124:127]
    s_waitcnt lgkmcnt(0)
    v_mfma_f32_16x16x32_bf16 v[96:99], v[192:195], v[224:227], v[96:99]
    ds_read2_b32 v[128:129], v28 offset0:32 offset1:33
    v_mfma_f32_16x16x32_bf16 v[100:103], v[192:195], v[228:231], v[100:103]
    ds_read2_b32 v[130:131], v28 offset0:34 offset1:35
    v_mfma_f32_16x16x32_bf16 v[104:107], v[192:195], v[232:235], v[104:107]
    ds_read_b128 v[160:163], v32 offset:3712
    v_mfma_f32_16x16x32_bf16 v[108:111], v[192:195], v[236:239], v[108:111]
    ds_read2_b32 v[132:133], v28 offset0:160 offset1:161
    v_mfma_f32_16x16x32_bf16 v[112:115], v[192:195], v[240:243], v[112:115]
    ds_read2_b32 v[134:135], v28 offset0:162 offset1:163
    buffer_load_dwordx4 v[44:47], v13, s[80:83], s13 offen offset:1024
    v_mfma_f32_16x16x32_bf16 v[116:119], v[192:195], v[244:247], v[116:119]
    ds_read_b128 v[164:167], v32 offset:3200
    v_mfma_f32_16x16x32_bf16 v[120:123], v[192:195], v[248:251], v[120:123]
    ds_read2_b32 v[136:137], v29 offset0:32 offset1:33
    v_mfma_f32_16x16x32_bf16 v[124:127], v[192:195], v[252:255], v[124:127]
    ds_read2_b32 v[138:139], v29 offset0:34 offset1:35
    v_mfma_f32_16x16x32_bf16 v[100:103], v[196:199], v[224:227], v[100:103]
    ds_read_b128 v[168:171], v32 offset:2688
    v_mfma_f32_16x16x32_bf16 v[104:107], v[196:199], v[228:231], v[104:107]
    ds_read2_b32 v[140:141], v29 offset0:160 offset1:161
    v_mfma_f32_16x16x32_bf16 v[108:111], v[196:199], v[232:235], v[108:111]
    ds_read2_b32 v[142:143], v29 offset0:162 offset1:163
    v_mfma_f32_16x16x32_bf16 v[112:115], v[196:199], v[236:239], v[112:115]
    ds_read_b128 v[172:175], v32 offset:2176
    v_mfma_f32_16x16x32_bf16 v[116:119], v[196:199], v[240:243], v[116:119]
    ds_read2_b32 v[144:145], v30 offset0:32 offset1:33
    buffer_load_dwordx4 v[48:51], v12, s[80:83], s13 offen offset:2048
    v_mfma_f32_16x16x32_bf16 v[120:123], v[196:199], v[244:247], v[120:123]
    ds_read2_b32 v[146:147], v30 offset0:34 offset1:35
    v_mfma_f32_16x16x32_bf16 v[124:127], v[196:199], v[248:251], v[124:127]
    ds_read_b128 v[176:179], v32 offset:1664
    v_mfma_f32_16x16x32_bf16 v[104:107], v[200:203], v[224:227], v[104:107]
    ds_read2_b32 v[148:149], v30 offset0:160 offset1:161
    v_mfma_f32_16x16x32_bf16 v[108:111], v[200:203], v[228:231], v[108:111]
    ds_read2_b32 v[150:151], v30 offset0:162 offset1:163
    v_mfma_f32_16x16x32_bf16 v[112:115], v[200:203], v[232:235], v[112:115]
    ds_read_b128 v[180:183], v32 offset:1152
    v_mfma_f32_16x16x32_bf16 v[116:119], v[200:203], v[236:239], v[116:119]
    ds_read2_b32 v[152:153], v31 offset0:32 offset1:33
    v_mfma_f32_16x16x32_bf16 v[120:123], v[200:203], v[240:243], v[120:123]
    ds_read2_b32 v[154:155], v31 offset0:34 offset1:35
    v_mfma_f32_16x16x32_bf16 v[124:127], v[200:203], v[244:247], v[124:127]
    ds_read_b128 v[184:187], v32 offset:640
    buffer_load_dwordx4 v[52:55], v13, s[80:83], s13 offen offset:3072
    v_mfma_f32_16x16x32_bf16 v[108:111], v[204:207], v[224:227], v[108:111]
    ds_read2_b32 v[156:157], v31 offset0:160 offset1:161
    v_mfma_f32_16x16x32_bf16 v[112:115], v[204:207], v[228:231], v[112:115]
    ds_read2_b32 v[158:159], v31 offset0:162 offset1:163
    v_mfma_f32_16x16x32_bf16 v[116:119], v[204:207], v[232:235], v[116:119]
    ds_read_b128 v[188:191], v32 offset:128
    v_mfma_f32_16x16x32_bf16 v[120:123], v[204:207], v[236:239], v[120:123]
    v_mfma_f32_16x16x32_bf16 v[124:127], v[204:207], v[240:243], v[124:127]
    v_mfma_f32_16x16x32_bf16 v[112:115], v[208:211], v[224:227], v[112:115]
    v_mfma_f32_16x16x32_bf16 v[116:119], v[208:211], v[228:231], v[116:119]
    v_mfma_f32_16x16x32_bf16 v[120:123], v[208:211], v[232:235], v[120:123]
    s_bfe_u32 s13, s30, 24 + (4 << 16)
    s_lshl_b32 s13, s13, 7
    buffer_load_dwordx4 v[80:83], v12, s[80:83], s13 offen offset:0
    v_mfma_f32_16x16x32_bf16 v[124:127], v[208:211], v[236:239], v[124:127]
    v_mfma_f32_16x16x32_bf16 v[116:119], v[212:215], v[224:227], v[116:119]
    v_mfma_f32_16x16x32_bf16 v[120:123], v[212:215], v[228:231], v[120:123]
    v_mfma_f32_16x16x32_bf16 v[124:127], v[212:215], v[232:235], v[124:127]
    v_mfma_f32_16x16x32_bf16 v[120:123], v[216:219], v[224:227], v[120:123]
    v_mfma_f32_16x16x32_bf16 v[124:127], v[216:219], v[228:231], v[124:127]
    v_mfma_f32_16x16x32_bf16 v[124:127], v[220:223], v[224:227], v[124:127]
    s_waitcnt lgkmcnt(0)
    v_mfma_f32_16x16x32_bf16 v[96:99], v[128:131], v[160:163], v[96:99]
    ds_read2_b32 v[192:193], v28 offset0:48 offset1:49
    buffer_load_dwordx4 v[84:87], v13, s[80:83], s13 offen offset:1024
    v_mfma_f32_16x16x32_bf16 v[100:103], v[128:131], v[164:167], v[100:103]
    ds_read2_b32 v[194:195], v28 offset0:50 offset1:51
    v_mfma_f32_16x16x32_bf16 v[104:107], v[128:131], v[168:171], v[104:107]
    ds_read_b128 v[224:227], v32 offset:3776
    v_mfma_f32_16x16x32_bf16 v[108:111], v[128:131], v[172:175], v[108:111]
    ds_read2_b32 v[196:197], v28 offset0:176 offset1:177
    v_mfma_f32_16x16x32_bf16 v[112:115], v[128:131], v[176:179], v[112:115]
    ds_read2_b32 v[198:199], v28 offset0:178 offset1:179
    v_mfma_f32_16x16x32_bf16 v[116:119], v[128:131], v[180:183], v[116:119]
    ds_read_b128 v[228:231], v32 offset:3264
    v_mfma_f32_16x16x32_bf16 v[120:123], v[128:131], v[184:187], v[120:123]
    ds_read2_b32 v[200:201], v29 offset0:48 offset1:49
    v_mfma_f32_16x16x32_bf16 v[124:127], v[128:131], v[188:191], v[124:127]
    ds_read2_b32 v[202:203], v29 offset0:50 offset1:51
    v_mfma_f32_16x16x32_bf16 v[100:103], v[132:135], v[160:163], v[100:103]
    ds_read_b128 v[232:235], v32 offset:2752
    buffer_load_dwordx4 v[88:91], v12, s[80:83], s13 offen offset:2048
    v_mfma_f32_16x16x32_bf16 v[104:107], v[132:135], v[164:167], v[104:107]
    ds_read2_b32 v[204:205], v29 offset0:176 offset1:177
    v_mfma_f32_16x16x32_bf16 v[108:111], v[132:135], v[168:171], v[108:111]
    ds_read2_b32 v[206:207], v29 offset0:178 offset1:179
    v_mfma_f32_16x16x32_bf16 v[112:115], v[132:135], v[172:175], v[112:115]
    ds_read_b128 v[236:239], v32 offset:2240
    v_mfma_f32_16x16x32_bf16 v[116:119], v[132:135], v[176:179], v[116:119]
    ds_read2_b32 v[208:209], v30 offset0:48 offset1:49
    v_mfma_f32_16x16x32_bf16 v[120:123], v[132:135], v[180:183], v[120:123]
    ds_read2_b32 v[210:211], v30 offset0:50 offset1:51
    v_mfma_f32_16x16x32_bf16 v[124:127], v[132:135], v[184:187], v[124:127]
    ds_read_b128 v[240:243], v32 offset:1728
    v_mfma_f32_16x16x32_bf16 v[104:107], v[136:139], v[160:163], v[104:107]
    ds_read2_b32 v[212:213], v30 offset0:176 offset1:177
    v_mfma_f32_16x16x32_bf16 v[108:111], v[136:139], v[164:167], v[108:111]
    ds_read2_b32 v[214:215], v30 offset0:178 offset1:179
    buffer_load_dwordx4 v[92:95], v13, s[80:83], s13 offen offset:3072
    v_mfma_f32_16x16x32_bf16 v[112:115], v[136:139], v[168:171], v[112:115]
    ds_read_b128 v[244:247], v32 offset:1216
    v_mfma_f32_16x16x32_bf16 v[116:119], v[136:139], v[172:175], v[116:119]
    ds_read2_b32 v[216:217], v31 offset0:48 offset1:49
    v_mfma_f32_16x16x32_bf16 v[120:123], v[136:139], v[176:179], v[120:123]
    ds_read2_b32 v[218:219], v31 offset0:50 offset1:51
    v_mfma_f32_16x16x32_bf16 v[124:127], v[136:139], v[180:183], v[124:127]
    ds_read_b128 v[248:251], v32 offset:704
    v_mfma_f32_16x16x32_bf16 v[108:111], v[140:143], v[160:163], v[108:111]
    ds_read2_b32 v[220:221], v31 offset0:176 offset1:177
    v_mfma_f32_16x16x32_bf16 v[112:115], v[140:143], v[164:167], v[112:115]
    ds_read2_b32 v[222:223], v31 offset0:178 offset1:179
    v_mfma_f32_16x16x32_bf16 v[116:119], v[140:143], v[168:171], v[116:119]
    ds_read_b128 v[252:255], v32 offset:192
    v_mfma_f32_16x16x32_bf16 v[120:123], v[140:143], v[172:175], v[120:123]
    s_bfe_u32 s13, s30, 20 + (4 << 16)
    s_lshl_b32 s13, s13, 7
    buffer_load_dwordx4 v[64:67], v12, s[80:83], s13 offen offset:0
    v_mfma_f32_16x16x32_bf16 v[124:127], v[140:143], v[176:179], v[124:127]
    v_mfma_f32_16x16x32_bf16 v[112:115], v[144:147], v[160:163], v[112:115]
    v_mfma_f32_16x16x32_bf16 v[116:119], v[144:147], v[164:167], v[116:119]
    v_mfma_f32_16x16x32_bf16 v[120:123], v[144:147], v[168:171], v[120:123]
    v_mfma_f32_16x16x32_bf16 v[124:127], v[144:147], v[172:175], v[124:127]
    v_mfma_f32_16x16x32_bf16 v[116:119], v[148:151], v[160:163], v[116:119]
    s_waitcnt vmcnt(9)
    v_mov_b32 v60, 1
    s_mov_b64 exec, 1
    ds_add_u32 v21, v60 offset:60
    s_mov_b64 exec, -1
    v_mfma_f32_16x16x32_bf16 v[120:123], v[148:151], v[164:167], v[120:123]
    v_mfma_f32_16x16x32_bf16 v[124:127], v[148:151], v[168:171], v[124:127]
    buffer_load_dwordx4 v[68:71], v13, s[80:83], s13 offen offset:1024
    v_mfma_f32_16x16x32_bf16 v[120:123], v[152:155], v[160:163], v[120:123]
    v_mfma_f32_16x16x32_bf16 v[124:127], v[152:155], v[164:167], v[124:127]
    v_mfma_f32_16x16x32_bf16 v[124:127], v[156:159], v[160:163], v[124:127]
    s_waitcnt lgkmcnt(0)
    v_mfma_f32_16x16x32_bf16 v[96:99], v[192:195], v[224:227], v[96:99]
    ds_read2_b32 v[128:129], v28 offset0:64 offset1:65
    v_mfma_f32_16x16x32_bf16 v[100:103], v[192:195], v[228:231], v[100:103]
    ds_read2_b32 v[130:131], v28 offset0:66 offset1:67
    v_mfma_f32_16x16x32_bf16 v[104:107], v[192:195], v[232:235], v[104:107]
    ds_read_b128 v[160:163], v32 offset:3840
    v_mfma_f32_16x16x32_bf16 v[108:111], v[192:195], v[236:239], v[108:111]
    ds_read2_b32 v[132:133], v28 offset0:192 offset1:193
    v_mfma_f32_16x16x32_bf16 v[112:115], v[192:195], v[240:243], v[112:115]
    ds_read2_b32 v[134:135], v28 offset0:194 offset1:195
    buffer_load_dwordx4 v[72:75], v12, s[80:83], s13 offen offset:2048
    v_mfma_f32_16x16x32_bf16 v[116:119], v[192:195], v[244:247], v[116:119]
    ds_read_b128 v[164:167], v32 offset:3328
    v_mfma_f32_16x16x32_bf16 v[120:123], v[192:195], v[248:251], v[120:123]
    ds_read2_b32 v[136:137], v29 offset0:64 offset1:65
    v_mfma_f32_16x16x32_bf16 v[124:127], v[192:195], v[252:255], v[124:127]
    ds_read2_b32 v[138:139], v29 offset0:66 offset1:67
    v_mfma_f32_16x16x32_bf16 v[100:103], v[196:199], v[224:227], v[100:103]
    ds_read_b128 v[168:171], v32 offset:2816
    v_mfma_f32_16x16x32_bf16 v[104:107], v[196:199], v[228:231], v[104:107]
    ds_read2_b32 v[140:141], v29 offset0:192 offset1:193
    v_mfma_f32_16x16x32_bf16 v[108:111], v[196:199], v[232:235], v[108:111]
    ds_read2_b32 v[142:143], v29 offset0:194 offset1:195
    v_mfma_f32_16x16x32_bf16 v[112:115], v[196:199], v[236:239], v[112:115]
    ds_read_b128 v[172:175], v32 offset:2304
    v_mfma_f32_16x16x32_bf16 v[116:119], v[196:199], v[240:243], v[116:119]
    ds_read2_b32 v[144:145], v30 offset0:64 offset1:65
    buffer_load_dwordx4 v[76:79], v13, s[80:83], s13 offen offset:3072
    v_mfma_f32_16x16x32_bf16 v[120:123], v[196:199], v[244:247], v[120:123]
    ds_read2_b32 v[146:147], v30 offset0:66 offset1:67
    v_mfma_f32_16x16x32_bf16 v[124:127], v[196:199], v[248:251], v[124:127]
    ds_read_b128 v[176:179], v32 offset:1792
    v_mfma_f32_16x16x32_bf16 v[104:107], v[200:203], v[224:227], v[104:107]
    ds_read2_b32 v[148:149], v30 offset0:192 offset1:193
    v_mfma_f32_16x16x32_bf16 v[108:111], v[200:203], v[228:231], v[108:111]
    ds_read2_b32 v[150:151], v30 offset0:194 offset1:195
    v_mfma_f32_16x16x32_bf16 v[112:115], v[200:203], v[232:235], v[112:115]
    ds_read_b128 v[180:183], v32 offset:1280
    v_mfma_f32_16x16x32_bf16 v[116:119], v[200:203], v[236:239], v[116:119]
    ds_read2_b32 v[152:153], v31 offset0:64 offset1:65
    v_mfma_f32_16x16x32_bf16 v[120:123], v[200:203], v[240:243], v[120:123]
    ds_read2_b32 v[154:155], v31 offset0:66 offset1:67
    v_mfma_f32_16x16x32_bf16 v[124:127], v[200:203], v[244:247], v[124:127]
    ds_read_b128 v[184:187], v32 offset:768
    v_mfma_f32_16x16x32_bf16 v[108:111], v[204:207], v[224:227], v[108:111]
    ds_read2_b32 v[156:157], v31 offset0:192 offset1:193
    v_mfma_f32_16x16x32_bf16 v[112:115], v[204:207], v[228:231], v[112:115]
    ds_read2_b32 v[158:159], v31 offset0:194 offset1:195
    v_mfma_f32_16x16x32_bf16 v[116:119], v[204:207], v[232:235], v[116:119]
    ds_read_b128 v[188:191], v32 offset:256
    v_mfma_f32_16x16x32_bf16 v[120:123], v[204:207], v[236:239], v[120:123]
    v_mfma_f32_16x16x32_bf16 v[124:127], v[204:207], v[240:243], v[124:127]
    v_mfma_f32_16x16x32_bf16 v[112:115], v[208:211], v[224:227], v[112:115]
    v_mfma_f32_16x16x32_bf16 v[116:119], v[208:211], v[228:231], v[116:119]
    v_mfma_f32_16x16x32_bf16 v[120:123], v[208:211], v[232:235], v[120:123]
    v_mfma_f32_16x16x32_bf16 v[124:127], v[208:211], v[236:239], v[124:127]
    v_mfma_f32_16x16x32_bf16 v[116:119], v[212:215], v[224:227], v[116:119]
    v_mfma_f32_16x16x32_bf16 v[120:123], v[212:215], v[228:231], v[120:123]
    v_mfma_f32_16x16x32_bf16 v[124:127], v[212:215], v[232:235], v[124:127]
    v_mfma_f32_16x16x32_bf16 v[120:123], v[216:219], v[224:227], v[120:123]
    v_mfma_f32_16x16x32_bf16 v[124:127], v[216:219], v[228:231], v[124:127]
    v_mfma_f32_16x16x32_bf16 v[124:127], v[220:223], v[224:227], v[124:127]
    s_waitcnt lgkmcnt(0)
    v_mfma_f32_16x16x32_bf16 v[96:99], v[128:131], v[160:163], v[96:99]
    ds_read2_b32 v[192:193], v28 offset0:80 offset1:81
    v_mfma_f32_16x16x32_bf16 v[100:103], v[128:131], v[164:167], v[100:103]
    ds_read2_b32 v[194:195], v28 offset0:82 offset1:83
    v_mfma_f32_16x16x32_bf16 v[104:107], v[128:131], v[168:171], v[104:107]
    ds_read_b128 v[224:227], v32 offset:3904
    v_mfma_f32_16x16x32_bf16 v[108:111], v[128:131], v[172:175], v[108:111]
    ds_read2_b32 v[196:197], v28 offset0:208 offset1:209
    v_mfma_f32_16x16x32_bf16 v[112:115], v[128:131], v[176:179], v[112:115]
    ds_read2_b32 v[198:199], v28 offset0:210 offset1:211
    v_mfma_f32_16x16x32_bf16 v[116:119], v[128:131], v[180:183], v[116:119]
    ds_read_b128 v[228:231], v32 offset:3392
    v_mfma_f32_16x16x32_bf16 v[120:123], v[128:131], v[184:187], v[120:123]
    ds_read2_b32 v[200:201], v29 offset0:80 offset1:81
    v_mfma_f32_16x16x32_bf16 v[124:127], v[128:131], v[188:191], v[124:127]
    ds_read2_b32 v[202:203], v29 offset0:82 offset1:83
    v_mfma_f32_16x16x32_bf16 v[100:103], v[132:135], v[160:163], v[100:103]
    ds_read_b128 v[232:235], v32 offset:2880
    v_mfma_f32_16x16x32_bf16 v[104:107], v[132:135], v[164:167], v[104:107]
    ds_read2_b32 v[204:205], v29 offset0:208 offset1:209
    v_mfma_f32_16x16x32_bf16 v[108:111], v[132:135], v[168:171], v[108:111]
    ds_read2_b32 v[206:207], v29 offset0:210 offset1:211
    v_mfma_f32_16x16x32_bf16 v[112:115], v[132:135], v[172:175], v[112:115]
    ds_read_b128 v[236:239], v32 offset:2368
    v_mfma_f32_16x16x32_bf16 v[116:119], v[132:135], v[176:179], v[116:119]
    ds_read2_b32 v[208:209], v30 offset0:80 offset1:81
    v_mfma_f32_16x16x32_bf16 v[120:123], v[132:135], v[180:183], v[120:123]
    ds_read2_b32 v[210:211], v30 offset0:82 offset1:83
    v_mfma_f32_16x16x32_bf16 v[124:127], v[132:135], v[184:187], v[124:127]
    ds_read_b128 v[240:243], v32 offset:1856
    v_mfma_f32_16x16x32_bf16 v[104:107], v[136:139], v[160:163], v[104:107]
    ds_read2_b32 v[212:213], v30 offset0:208 offset1:209
    v_mfma_f32_16x16x32_bf16 v[108:111], v[136:139], v[164:167], v[108:111]
    ds_read2_b32 v[214:215], v30 offset0:210 offset1:211
    v_mfma_f32_16x16x32_bf16 v[112:115], v[136:139], v[168:171], v[112:115]
    ds_read_b128 v[244:247], v32 offset:1344
    v_mfma_f32_16x16x32_bf16 v[116:119], v[136:139], v[172:175], v[116:119]
    ds_read2_b32 v[216:217], v31 offset0:80 offset1:81
    v_mfma_f32_16x16x32_bf16 v[120:123], v[136:139], v[176:179], v[120:123]
    ds_read2_b32 v[218:219], v31 offset0:82 offset1:83
    v_mfma_f32_16x16x32_bf16 v[124:127], v[136:139], v[180:183], v[124:127]
    ds_read_b128 v[248:251], v32 offset:832
    v_mfma_f32_16x16x32_bf16 v[108:111], v[140:143], v[160:163], v[108:111]
    ds_read2_b32 v[220:221], v31 offset0:208 offset1:209
    v_mfma_f32_16x16x32_bf16 v[112:115], v[140:143], v[164:167], v[112:115]
    ds_read2_b32 v[222:223], v31 offset0:210 offset1:211
    v_mfma_f32_16x16x32_bf16 v[116:119], v[140:143], v[168:171], v[116:119]
    ds_read_b128 v[252:255], v32 offset:320
    v_mfma_f32_16x16x32_bf16 v[120:123], v[140:143], v[172:175], v[120:123]
    v_mfma_f32_16x16x32_bf16 v[124:127], v[140:143], v[176:179], v[124:127]
    v_mfma_f32_16x16x32_bf16 v[112:115], v[144:147], v[160:163], v[112:115]
    v_mfma_f32_16x16x32_bf16 v[116:119], v[144:147], v[164:167], v[116:119]
    v_mfma_f32_16x16x32_bf16 v[120:123], v[144:147], v[168:171], v[120:123]
    v_mfma_f32_16x16x32_bf16 v[124:127], v[144:147], v[172:175], v[124:127]
    v_mfma_f32_16x16x32_bf16 v[116:119], v[148:151], v[160:163], v[116:119]
    v_mfma_f32_16x16x32_bf16 v[120:123], v[148:151], v[164:167], v[120:123]
    v_mfma_f32_16x16x32_bf16 v[124:127], v[148:151], v[168:171], v[124:127]
    v_mfma_f32_16x16x32_bf16 v[120:123], v[152:155], v[160:163], v[120:123]
    v_mfma_f32_16x16x32_bf16 v[124:127], v[152:155], v[164:167], v[124:127]
    v_mfma_f32_16x16x32_bf16 v[124:127], v[156:159], v[160:163], v[124:127]
    s_waitcnt lgkmcnt(0)
    v_mfma_f32_16x16x32_bf16 v[96:99], v[192:195], v[224:227], v[96:99]
    ds_read2_b32 v[128:129], v28 offset0:96 offset1:97
    v_mfma_f32_16x16x32_bf16 v[100:103], v[192:195], v[228:231], v[100:103]
    ds_read2_b32 v[130:131], v28 offset0:98 offset1:99
    v_mfma_f32_16x16x32_bf16 v[104:107], v[192:195], v[232:235], v[104:107]
    ds_read_b128 v[160:163], v32 offset:3968
    v_mfma_f32_16x16x32_bf16 v[108:111], v[192:195], v[236:239], v[108:111]
    ds_read2_b32 v[132:133], v28 offset0:224 offset1:225
    v_mfma_f32_16x16x32_bf16 v[112:115], v[192:195], v[240:243], v[112:115]
    ds_read2_b32 v[134:135], v28 offset0:226 offset1:227
    v_mfma_f32_16x16x32_bf16 v[116:119], v[192:195], v[244:247], v[116:119]
    ds_read_b128 v[164:167], v32 offset:3456
    v_mfma_f32_16x16x32_bf16 v[120:123], v[192:195], v[248:251], v[120:123]
    ds_read2_b32 v[136:137], v29 offset0:96 offset1:97
    v_mfma_f32_16x16x32_bf16 v[124:127], v[192:195], v[252:255], v[124:127]
    ds_read2_b32 v[138:139], v29 offset0:98 offset1:99
    v_mfma_f32_16x16x32_bf16 v[100:103], v[196:199], v[224:227], v[100:103]
    ds_read_b128 v[168:171], v32 offset:2944
    v_mfma_f32_16x16x32_bf16 v[104:107], v[196:199], v[228:231], v[104:107]
    ds_read2_b32 v[140:141], v29 offset0:224 offset1:225
    v_mfma_f32_16x16x32_bf16 v[108:111], v[196:199], v[232:235], v[108:111]
    ds_read2_b32 v[142:143], v29 offset0:226 offset1:227
    v_mfma_f32_16x16x32_bf16 v[112:115], v[196:199], v[236:239], v[112:115]
    ds_read_b128 v[172:175], v32 offset:2432
    v_mfma_f32_16x16x32_bf16 v[116:119], v[196:199], v[240:243], v[116:119]
    ds_read2_b32 v[144:145], v30 offset0:96 offset1:97
    v_mfma_f32_16x16x32_bf16 v[120:123], v[196:199], v[244:247], v[120:123]
    ds_read2_b32 v[146:147], v30 offset0:98 offset1:99
    v_mfma_f32_16x16x32_bf16 v[124:127], v[196:199], v[248:251], v[124:127]
    ds_read_b128 v[176:179], v32 offset:1920
    v_mfma_f32_16x16x32_bf16 v[104:107], v[200:203], v[224:227], v[104:107]
    ds_read2_b32 v[148:149], v30 offset0:224 offset1:225
    v_mfma_f32_16x16x32_bf16 v[108:111], v[200:203], v[228:231], v[108:111]
    ds_read2_b32 v[150:151], v30 offset0:226 offset1:227
    v_mfma_f32_16x16x32_bf16 v[112:115], v[200:203], v[232:235], v[112:115]
    ds_read_b128 v[180:183], v32 offset:1408
    v_mfma_f32_16x16x32_bf16 v[116:119], v[200:203], v[236:239], v[116:119]
    ds_read2_b32 v[152:153], v31 offset0:96 offset1:97
    v_mfma_f32_16x16x32_bf16 v[120:123], v[200:203], v[240:243], v[120:123]
    ds_read2_b32 v[154:155], v31 offset0:98 offset1:99
    v_mfma_f32_16x16x32_bf16 v[124:127], v[200:203], v[244:247], v[124:127]
    ds_read_b128 v[184:187], v32 offset:896
    v_mfma_f32_16x16x32_bf16 v[108:111], v[204:207], v[224:227], v[108:111]
    ds_read2_b32 v[156:157], v31 offset0:224 offset1:225
    v_mfma_f32_16x16x32_bf16 v[112:115], v[204:207], v[228:231], v[112:115]
    ds_read2_b32 v[158:159], v31 offset0:226 offset1:227
    v_mfma_f32_16x16x32_bf16 v[116:119], v[204:207], v[232:235], v[116:119]
    ds_read_b128 v[188:191], v32 offset:384
    v_mfma_f32_16x16x32_bf16 v[120:123], v[204:207], v[236:239], v[120:123]
    v_mfma_f32_16x16x32_bf16 v[124:127], v[204:207], v[240:243], v[124:127]
    v_mfma_f32_16x16x32_bf16 v[112:115], v[208:211], v[224:227], v[112:115]
    v_mfma_f32_16x16x32_bf16 v[116:119], v[208:211], v[228:231], v[116:119]
    v_mfma_f32_16x16x32_bf16 v[120:123], v[208:211], v[232:235], v[120:123]
    v_mfma_f32_16x16x32_bf16 v[124:127], v[208:211], v[236:239], v[124:127]
    v_mfma_f32_16x16x32_bf16 v[116:119], v[212:215], v[224:227], v[116:119]
    v_mfma_f32_16x16x32_bf16 v[120:123], v[212:215], v[228:231], v[120:123]
    v_mfma_f32_16x16x32_bf16 v[124:127], v[212:215], v[232:235], v[124:127]
    v_mfma_f32_16x16x32_bf16 v[120:123], v[216:219], v[224:227], v[120:123]
    v_mfma_f32_16x16x32_bf16 v[124:127], v[216:219], v[228:231], v[124:127]
    v_mfma_f32_16x16x32_bf16 v[124:127], v[220:223], v[224:227], v[124:127]
    s_waitcnt lgkmcnt(0)
    v_mfma_f32_16x16x32_bf16 v[96:99], v[128:131], v[160:163], v[96:99]
    ds_read2_b32 v[192:193], v28 offset0:112 offset1:113
    v_mfma_f32_16x16x32_bf16 v[100:103], v[128:131], v[164:167], v[100:103]
    ds_read2_b32 v[194:195], v28 offset0:114 offset1:115
    v_mfma_f32_16x16x32_bf16 v[104:107], v[128:131], v[168:171], v[104:107]
    ds_read_b128 v[224:227], v32 offset:4032
    v_mfma_f32_16x16x32_bf16 v[108:111], v[128:131], v[172:175], v[108:111]
    ds_read2_b32 v[196:197], v28 offset0:240 offset1:241
    v_mfma_f32_16x16x32_bf16 v[112:115], v[128:131], v[176:179], v[112:115]
    ds_read2_b32 v[198:199], v28 offset0:242 offset1:243
    v_mfma_f32_16x16x32_bf16 v[116:119], v[128:131], v[180:183], v[116:119]
    ds_read_b128 v[228:231], v32 offset:3520
    v_mfma_f32_16x16x32_bf16 v[120:123], v[128:131], v[184:187], v[120:123]
    ds_read2_b32 v[200:201], v29 offset0:112 offset1:113
    v_mfma_f32_16x16x32_bf16 v[124:127], v[128:131], v[188:191], v[124:127]
    ds_read2_b32 v[202:203], v29 offset0:114 offset1:115
    v_mfma_f32_16x16x32_bf16 v[100:103], v[132:135], v[160:163], v[100:103]
    ds_read_b128 v[232:235], v32 offset:3008
    v_mfma_f32_16x16x32_bf16 v[104:107], v[132:135], v[164:167], v[104:107]
    ds_read2_b32 v[204:205], v29 offset0:240 offset1:241
    v_mfma_f32_16x16x32_bf16 v[108:111], v[132:135], v[168:171], v[108:111]
    ds_read2_b32 v[206:207], v29 offset0:242 offset1:243
    v_mfma_f32_16x16x32_bf16 v[112:115], v[132:135], v[172:175], v[112:115]
    ds_read_b128 v[236:239], v32 offset:2496
    v_mfma_f32_16x16x32_bf16 v[116:119], v[132:135], v[176:179], v[116:119]
    ds_read2_b32 v[208:209], v30 offset0:112 offset1:113
    v_mfma_f32_16x16x32_bf16 v[120:123], v[132:135], v[180:183], v[120:123]
    ds_read2_b32 v[210:211], v30 offset0:114 offset1:115
    v_mfma_f32_16x16x32_bf16 v[124:127], v[132:135], v[184:187], v[124:127]
    ds_read_b128 v[240:243], v32 offset:1984
    v_mfma_f32_16x16x32_bf16 v[104:107], v[136:139], v[160:163], v[104:107]
    ds_read2_b32 v[212:213], v30 offset0:240 offset1:241
    v_mfma_f32_16x16x32_bf16 v[108:111], v[136:139], v[164:167], v[108:111]
    ds_read2_b32 v[214:215], v30 offset0:242 offset1:243
    v_mfma_f32_16x16x32_bf16 v[112:115], v[136:139], v[168:171], v[112:115]
    ds_read_b128 v[244:247], v32 offset:1472
    v_mfma_f32_16x16x32_bf16 v[116:119], v[136:139], v[172:175], v[116:119]
    ds_read2_b32 v[216:217], v31 offset0:112 offset1:113
    v_mfma_f32_16x16x32_bf16 v[120:123], v[136:139], v[176:179], v[120:123]
    ds_read2_b32 v[218:219], v31 offset0:114 offset1:115
    v_mfma_f32_16x16x32_bf16 v[124:127], v[136:139], v[180:183], v[124:127]
    ds_read_b128 v[248:251], v32 offset:960
    v_mfma_f32_16x16x32_bf16 v[108:111], v[140:143], v[160:163], v[108:111]
    ds_read2_b32 v[220:221], v31 offset0:240 offset1:241
    v_mfma_f32_16x16x32_bf16 v[112:115], v[140:143], v[164:167], v[112:115]
    ds_read2_b32 v[222:223], v31 offset0:242 offset1:243
    v_mfma_f32_16x16x32_bf16 v[116:119], v[140:143], v[168:171], v[116:119]
    ds_read_b128 v[252:255], v32 offset:448
    v_mfma_f32_16x16x32_bf16 v[120:123], v[140:143], v[172:175], v[120:123]
    v_mfma_f32_16x16x32_bf16 v[124:127], v[140:143], v[176:179], v[124:127]
    v_mfma_f32_16x16x32_bf16 v[112:115], v[144:147], v[160:163], v[112:115]
    v_mfma_f32_16x16x32_bf16 v[116:119], v[144:147], v[164:167], v[116:119]
    v_mfma_f32_16x16x32_bf16 v[120:123], v[144:147], v[168:171], v[120:123]
    v_mfma_f32_16x16x32_bf16 v[124:127], v[144:147], v[172:175], v[124:127]
    v_mfma_f32_16x16x32_bf16 v[116:119], v[148:151], v[160:163], v[116:119]
    v_mfma_f32_16x16x32_bf16 v[120:123], v[148:151], v[164:167], v[120:123]
    v_mfma_f32_16x16x32_bf16 v[124:127], v[148:151], v[168:171], v[124:127]
    v_mfma_f32_16x16x32_bf16 v[120:123], v[152:155], v[160:163], v[120:123]
    v_mfma_f32_16x16x32_bf16 v[124:127], v[152:155], v[164:167], v[124:127]
    v_mfma_f32_16x16x32_bf16 v[124:127], v[156:159], v[160:163], v[124:127]
    s_waitcnt lgkmcnt(0)
    v_mfma_f32_16x16x32_bf16 v[96:99], v[192:195], v[224:227], v[96:99]
    v_mfma_f32_16x16x32_bf16 v[100:103], v[192:195], v[228:231], v[100:103]
    v_mfma_f32_16x16x32_bf16 v[104:107], v[192:195], v[232:235], v[104:107]
    v_mfma_f32_16x16x32_bf16 v[108:111], v[192:195], v[236:239], v[108:111]
    v_mfma_f32_16x16x32_bf16 v[112:115], v[192:195], v[240:243], v[112:115]
    v_mfma_f32_16x16x32_bf16 v[116:119], v[192:195], v[244:247], v[116:119]
    v_mfma_f32_16x16x32_bf16 v[120:123], v[192:195], v[248:251], v[120:123]
    v_mfma_f32_16x16x32_bf16 v[124:127], v[192:195], v[252:255], v[124:127]
    v_mfma_f32_16x16x32_bf16 v[100:103], v[196:199], v[224:227], v[100:103]
    v_mfma_f32_16x16x32_bf16 v[104:107], v[196:199], v[228:231], v[104:107]
    v_mfma_f32_16x16x32_bf16 v[108:111], v[196:199], v[232:235], v[108:111]
    v_mfma_f32_16x16x32_bf16 v[112:115], v[196:199], v[236:239], v[112:115]
    v_mfma_f32_16x16x32_bf16 v[116:119], v[196:199], v[240:243], v[116:119]
    v_mfma_f32_16x16x32_bf16 v[120:123], v[196:199], v[244:247], v[120:123]
    v_mfma_f32_16x16x32_bf16 v[124:127], v[196:199], v[248:251], v[124:127]
    v_mfma_f32_16x16x32_bf16 v[104:107], v[200:203], v[224:227], v[104:107]
    v_mfma_f32_16x16x32_bf16 v[108:111], v[200:203], v[228:231], v[108:111]
    v_mfma_f32_16x16x32_bf16 v[112:115], v[200:203], v[232:235], v[112:115]
    v_mfma_f32_16x16x32_bf16 v[116:119], v[200:203], v[236:239], v[116:119]
    v_mfma_f32_16x16x32_bf16 v[120:123], v[200:203], v[240:243], v[120:123]
    v_mfma_f32_16x16x32_bf16 v[124:127], v[200:203], v[244:247], v[124:127]
    v_mfma_f32_16x16x32_bf16 v[108:111], v[204:207], v[224:227], v[108:111]
    v_mfma_f32_16x16x32_bf16 v[112:115], v[204:207], v[228:231], v[112:115]
    v_mfma_f32_16x16x32_bf16 v[116:119], v[204:207], v[232:235], v[116:119]
    v_mfma_f32_16x16x32_bf16 v[120:123], v[204:207], v[236:239], v[120:123]
    v_mfma_f32_16x16x32_bf16 v[124:127], v[204:207], v[240:243], v[124:127]
    v_mfma_f32_16x16x32_bf16 v[112:115], v[208:211], v[224:227], v[112:115]
    v_mfma_f32_16x16x32_bf16 v[116:119], v[208:211], v[228:231], v[116:119]
    v_mfma_f32_16x16x32_bf16 v[120:123], v[208:211], v[232:235], v[120:123]
    v_mfma_f32_16x16x32_bf16 v[124:127], v[208:211], v[236:239], v[124:127]
    v_mfma_f32_16x16x32_bf16 v[116:119], v[212:215], v[224:227], v[116:119]
    v_mfma_f32_16x16x32_bf16 v[120:123], v[212:215], v[228:231], v[120:123]
    v_mfma_f32_16x16x32_bf16 v[124:127], v[212:215], v[232:235], v[124:127]
    v_mfma_f32_16x16x32_bf16 v[120:123], v[216:219], v[224:227], v[120:123]
    v_mfma_f32_16x16x32_bf16 v[124:127], v[216:219], v[228:231], v[124:127]
    v_mfma_f32_16x16x32_bf16 v[124:127], v[220:223], v[224:227], v[124:127]
    s_setprio 0
    v_cvt_pk_bf16_f32 v192, v96, v97
    v_cvt_pk_bf16_f32 v193, v98, v99
    v_cvt_pk_bf16_f32 v194, v100, v101
    v_cvt_pk_bf16_f32 v195, v102, v103
    v_cvt_pk_bf16_f32 v196, v104, v105
    v_cvt_pk_bf16_f32 v197, v106, v107
    v_cvt_pk_bf16_f32 v198, v108, v109
    v_cvt_pk_bf16_f32 v199, v110, v111
    v_cvt_pk_bf16_f32 v200, v112, v113
    v_cvt_pk_bf16_f32 v201, v114, v115
    v_cvt_pk_bf16_f32 v202, v116, v117
    v_cvt_pk_bf16_f32 v203, v118, v119
    v_cvt_pk_bf16_f32 v204, v120, v121
    v_cvt_pk_bf16_f32 v205, v122, v123
    v_cvt_pk_bf16_f32 v206, v124, v125
    v_cvt_pk_bf16_f32 v207, v126, v127
    v_permlane16_swap_b32 v192, v194
    v_permlane16_swap_b32 v193, v195
    v_permlane16_swap_b32 v196, v198
    v_permlane16_swap_b32 v197, v199
    v_permlane16_swap_b32 v200, v202
    v_permlane16_swap_b32 v201, v203
    v_permlane16_swap_b32 v204, v206
    v_permlane16_swap_b32 v205, v207
    ds_bpermute_b32 v192, v17, v192
    ds_bpermute_b32 v193, v17, v193
    ds_bpermute_b32 v194, v17, v194
    ds_bpermute_b32 v195, v17, v195
    ds_bpermute_b32 v196, v17, v196
    ds_bpermute_b32 v197, v17, v197
    ds_bpermute_b32 v198, v17, v198
    ds_bpermute_b32 v199, v17, v199
    ds_bpermute_b32 v200, v17, v200
    ds_bpermute_b32 v201, v17, v201
    ds_bpermute_b32 v202, v17, v202
    ds_bpermute_b32 v203, v17, v203
    ds_bpermute_b32 v204, v17, v204
    ds_bpermute_b32 v205, v17, v205
    ds_bpermute_b32 v206, v17, v206
    ds_bpermute_b32 v207, v17, v207
    ds_read_b32 v60, v21 offset:72
    s_waitcnt lgkmcnt(0)
    v_cmp_eq_u32 vcc, 1, v60
    s_cbranch_vccnz L_zp
    s_mov_b32 s13, 0
    buffer_store_dwordx4 v[192:195], v26, s[56:59], s36 offen offset:0 sc1
    buffer_store_dwordx4 v[196:199], v26, s[56:59], s36 offen offset:1024 sc1
    buffer_store_dwordx4 v[200:203], v26, s[56:59], s36 offen offset:2048 sc1
    buffer_store_dwordx4 v[204:207], v26, s[56:59], s36 offen offset:3072 sc1
    s_branch L_zq
L_zp:
    s_mov_b32 s13, 1
    buffer_store_dwordx4 v[192:195], v26, s[56:59], s36 offen offset:0
    buffer_store_dwordx4 v[196:199], v26, s[56:59], s36 offen offset:1024
    buffer_store_dwordx4 v[200:203], v26, s[56:59], s36 offen offset:2048
    buffer_store_dwordx4 v[204:207], v26, s[56:59], s36 offen offset:3072
L_zq:
    v_add_u32 v33, s101, v26
    s_waitcnt vmcnt(4)
    ds_write_b128 v33, v[64:67] offset:0
    ds_write_b128 v33, v[68:71] offset:1024
    ds_write_b128 v33, v[72:75] offset:2048
    ds_write_b128 v33, v[76:79] offset:3072
    ds_write_b128 v33, v[80:83] offset:4096
    ds_write_b128 v33, v[84:87] offset:5120
    ds_write_b128 v33, v[88:91] offset:6144
    ds_write_b128 v33, v[92:95] offset:7168
    ds_write_b128 v33, v[40:43] offset:8192
    ds_write_b128 v33, v[44:47] offset:9216
    ds_write_b128 v33, v[48:51] offset:10240
    ds_write_b128 v33, v[52:55] offset:11264
    v_mov_b32 v60, 1
    s_mov_b64 exec, 1
    ds_add_u32 v21, v60 offset:68
    s_mov_b64 exec, -1
    s_lshl_b32 s12, s100, 3
    s_add_u32 s12, s12, 8192
    v_lshlrev_b32 v28, 1, v23
    v_lshl_add_u32 v28, v24, 12, v28
    v_lshlrev_b32 v29, 2, v24
    v_lshl_add_u32 v29, v23, 13, v29
    v_lshrrev_b32 v60, 3, v2
    v_and_b32 v61, 7, v2
    v_lshl_add_u32 v28, v60, 2, s35
    v_lshlrev_b32 v28, 12, v28
    v_lshl_add_u32 v28, v61, 4, v28
    s_lshl_b32 s10, s5, 7
    v_add_u32 v28, s10, v28
    v_lshl_add_u32 v30, v61, 3, v60
    v_lshlrev_b32 v30, 2, v30
    s_waitcnt vmcnt(0)
    s_mov_b64 exec, 1
    s_cmp_eq_u32 s13, 1
    s_cbranch_scc0 L_xf2
    buffer_store_dwordx2 v[0:1], v19, s[72:75], s12 offen
    s_branch L_xf3
L_xf2:
    buffer_store_dwordx2 v[0:1], v19, s[72:75], s12 offen sc1
L_xf3:
    s_mov_b64 exec, -1
    s_mov_b32 s15, 0
L_zw_w:
    ds_read_b128 v[60:63], v21 offset:0
    s_waitcnt lgkmcnt(0)
    v_min3_u32 v60, v60, v61, v62
    v_min_u32 v60, v60, v63
    v_cmp_gt_u32 vcc, 22, v60
    s_cbranch_vccz L_zw_ok
    s_sleep 4
    s_add_u32 s15, s15, 1
    s_cmp_lt_u32 s15, 160000
    s_cbranch_scc1 L_zw_w
L_zw_ok:
    s_cmp_eq_u32 s8, 0
    s_cbranch_scc0 L_z1
    s_mov_b32 s15, 0
LZ_poll:
    buffer_load_dwordx4 v[60:63], v3, s[72:75], 0 offen sc1
    s_waitcnt vmcnt(0)
LZ_chk:
    v_cmp_ne_u64 vcc, v[60:61], v[0:1]
    v_cmp_ne_u64 s[10:11], v[62:63], v[0:1]
    s_or_b64 vcc, vcc, s[10:11]
    s_cbranch_scc0 LZ_ok
    s_sleep 4
    s_add_u32 s15, s15, 1
    s_cmp_lt_u32 s15, 20000
    s_cbranch_scc1 LZ_poll
LZ_ok:
    ds_write_b32 v21, v25 offset:48
L_z1:
    s_waitcnt vmcnt(0)
    v_lshlrev_b32 v128, 16, v4
    v_and_b32 v129, 0xffff0000, v4
    v_lshlrev_b32 v130, 16, v5
    v_and_b32 v131, 0xffff0000, v5
    v_lshlrev_b32 v132, 16, v6
    v_and_b32 v133, 0xffff0000, v6
    v_lshlrev_b32 v134, 16, v7
    v_and_b32 v135, 0xffff0000, v7
    v_lshlrev_b32 v136, 16, v8
    v_and_b32 v137, 0xffff0000, v8
    v_lshlrev_b32 v138, 16, v9
    v_and_b32 v139, 0xffff0000, v9
    v_lshlrev_b32 v140, 16, v10
    v_and_b32 v141, 0xffff0000, v10
    v_lshlrev_b32 v142, 16, v11
    v_and_b32 v143, 0xffff0000, v11
    v_lshlrev_b32 v144, 16, v14
    v_and_b32 v145, 0xffff0000, v14
    v_lshlrev_b32 v146, 16, v15
    v_and_b32 v147, 0xffff0000, v15
    v_lshlrev_b32 v148, 16, v56
    v_and_b32 v149, 0xffff0000, v56
    v_lshlrev_b32 v150, 16, v57
    v_and_b32 v151, 0xffff0000, v57
    v_lshlrev_b32 v152, 16, v58
    v_and_b32 v153, 0xffff0000, v58
    v_lshlrev_b32 v154, 16, v59
    v_and_b32 v155, 0xffff0000, v59
    v_lshlrev_b32 v156, 16, v34
    v_and_b32 v157, 0xffff0000, v34
    v_lshlrev_b32 v158, 16, v35
    v_and_b32 v159, 0xffff0000, v35
    s_mov_b32 s15, 0
L_fz_w:
    ds_read_b32 v60, v21 offset:48
    s_waitcnt lgkmcnt(0)
    v_cmp_gt_u32 vcc, 1, v60
    s_cbranch_vccz L_fz_ok
    s_sleep 1
    s_add_u32 s15, s15, 1
    s_cmp_lt_u32 s15, 160000
    s_cbranch_scc1 L_fz_w
L_fz_ok:
    buffer_load_dwordx4 v[64:67], v28, s[56:59], 0 offen sc1
    buffer_load_dwordx4 v[68:71], v28, s[56:59], s32 offen sc1
    buffer_load_dwordx4 v[72:75], v28, s[56:59], s33 offen sc1
    buffer_load_dwordx4 v[76:79], v28, s[56:59], s34 offen sc1
    s_waitcnt vmcnt(3)
    ds_bpermute_b32 v64, v30, v64
    ds_bpermute_b32 v65, v30, v65
    ds_bpermute_b32 v66, v30, v66
    ds_bpermute_b32 v67, v30, v67
    s_waitcnt vmcnt(2)
    ds_bpermute_b32 v68, v30, v68
    ds_bpermute_b32 v69, v30, v69
    ds_bpermute_b32 v70, v30, v70
    ds_bpermute_b32 v71, v30, v71
    s_waitcnt vmcnt(1)
    ds_bpermute_b32 v72, v30, v72
    ds_bpermute_b32 v73, v30, v73
    ds_bpermute_b32 v74, v30, v74
    ds_bpermute_b32 v75, v30, v75
    s_waitcnt vmcnt(0)
    ds_bpermute_b32 v76, v30, v76
    ds_bpermute_b32 v77, v30, v77
    ds_bpermute_b32 v78, v30, v78
    ds_bpermute_b32 v79, v30, v79
    s_waitcnt lgkmcnt(0)
    s_waitcnt vmcnt(0)
    v_lshlrev_b32 v160, 16, v64
    v_lshlrev_b32 v161, 16, v68
    v_lshlrev_b32 v162, 16, v72
    v_lshlrev_b32 v163, 16, v76
    v_mul_f32 v160, v160, v128
    v_mul_f32 v161, v161, v129
    v_mul_f32 v162, v162, v130
    v_mul_f32 v163, v163, v131
    v_and_b32 v164, 0xffff0000, v64
    v_and_b32 v165, 0xffff0000, v68
    v_and_b32 v166, 0xffff0000, v72
    v_and_b32 v167, 0xffff0000, v76
    v_mul_f32 v164, v164, v132
    v_mul_f32 v165, v165, v133
    v_mul_f32 v166, v166, v134
    v_mul_f32 v167, v167, v135
    v_lshlrev_b32 v168, 16, v65
    v_lshlrev_b32 v169, 16, v69
    v_lshlrev_b32 v170, 16, v73
    v_lshlrev_b32 v171, 16, v77
    v_mul_f32 v168, v168, v136
    v_mul_f32 v169, v169, v137
    v_mul_f32 v170, v170, v138
    v_mul_f32 v171, v171, v139
    v_and_b32 v172, 0xffff0000, v65
    v_and_b32 v173, 0xffff0000, v69
    v_and_b32 v174, 0xffff0000, v73
    v_and_b32 v175, 0xffff0000, v77
    v_mul_f32 v172, v172, v140
    v_mul_f32 v173, v173, v141
    v_mul_f32 v174, v174, v142
    v_mul_f32 v175, v175, v143
    v_lshlrev_b32 v176, 16, v66
    v_lshlrev_b32 v177, 16, v70
    v_lshlrev_b32 v178, 16, v74
    v_lshlrev_b32 v179, 16, v78
    v_mul_f32 v176, v176, v144
    v_mul_f32 v177, v177, v145
    v_mul_f32 v178, v178, v146
    v_mul_f32 v179, v179, v147
    v_and_b32 v180, 0xffff0000, v66
    v_and_b32 v181, 0xffff0000, v70
    v_and_b32 v182, 0xffff0000, v74
    v_and_b32 v183, 0xffff0000, v78
    v_mul_f32 v180, v180, v148
    v_mul_f32 v181, v181, v149
    v_mul_f32 v182, v182, v150
    v_mul_f32 v183, v183, v151
    v_lshlrev_b32 v184, 16, v67
    v_lshlrev_b32 v185, 16, v71
    v_lshlrev_b32 v186, 16, v75
    v_lshlrev_b32 v187, 16, v79
    v_mul_f32 v184, v184, v152
    v_mul_f32 v185, v185, v153
    v_mul_f32 v186, v186, v154
    v_mul_f32 v187, v187, v155
    v_and_b32 v188, 0xffff0000, v67
    v_and_b32 v189, 0xffff0000, v71
    v_and_b32 v190, 0xffff0000, v75
    v_and_b32 v191, 0xffff0000, v79
    v_mul_f32 v188, v188, v156
    v_mul_f32 v189, v189, v157
    v_mul_f32 v190, v190, v158
    v_mul_f32 v191, v191, v159
    s_mov_b32 s15, 0
L_ow0_w:
    ds_read_b128 v[60:63], v21 offset:0
    s_waitcnt lgkmcnt(0)
    v_min3_u32 v60, v60, v61, v62
    v_min_u32 v60, v60, v63
    v_cmp_gt_u32 vcc, 27, v60
    s_cbranch_vccz L_ow0_ok
    s_sleep 2
    s_add_u32 s15, s15, 1
    s_cmp_lt_u32 s15, 160000
    s_cbranch_scc1 L_ow0_w
L_ow0_ok:
    s_mov_b32 s10, 0
    buffer_store_dwordx4 v[160:163], v29, s[64:67], s10 offen nt
    s_mov_b32 s15, 0
L_ow1_w:
    ds_read_b128 v[60:63], v21 offset:0
    s_waitcnt lgkmcnt(0)
    v_min3_u32 v60, v60, v61, v62
    v_min_u32 v60, v60, v63
    v_cmp_gt_u32 vcc, 28, v60
    s_cbranch_vccz L_ow1_ok
    s_sleep 2
    s_add_u32 s15, s15, 1
    s_cmp_lt_u32 s15, 160000
    s_cbranch_scc1 L_ow1_w
L_ow1_ok:
    s_mov_b32 s10, 8192
    buffer_store_dwordx4 v[164:167], v29, s[64:67], s10 offen nt
    s_mov_b32 s15, 0
L_ow2_w:
    ds_read_b128 v[60:63], v21 offset:0
    s_waitcnt lgkmcnt(0)
    v_min3_u32 v60, v60, v61, v62
    v_min_u32 v60, v60, v63
    v_cmp_gt_u32 vcc, 29, v60
    s_cbranch_vccz L_ow2_ok
    s_sleep 2
    s_add_u32 s15, s15, 1
    s_cmp_lt_u32 s15, 160000
    s_cbranch_scc1 L_ow2_w
L_ow2_ok:
    s_mov_b32 s10, 16384
    buffer_store_dwordx4 v[168:171], v29, s[64:67], s10 offen nt
    s_mov_b32 s15, 0
L_ow3_w:
    ds_read_b128 v[60:63], v21 offset:0
    s_waitcnt lgkmcnt(0)
    v_min3_u32 v60, v60, v61, v62
    v_min_u32 v60, v60, v63
    v_cmp_gt_u32 vcc, 30, v60
    s_cbranch_vccz L_ow3_ok
    s_sleep 2
    s_add_u32 s15, s15, 1
    s_cmp_lt_u32 s15, 160000
    s_cbranch_scc1 L_ow3_w
L_ow3_ok:
    s_mov_b32 s10, 24576
    buffer_store_dwordx4 v[172:175], v29, s[64:67], s10 offen nt
    s_mov_b32 s15, 0
L_ow4_w:
    ds_read_b128 v[60:63], v21 offset:0
    s_waitcnt lgkmcnt(0)
    v_min3_u32 v60, v60, v61, v62
    v_min_u32 v60, v60, v63
    v_cmp_gt_u32 vcc, 31, v60
    s_cbranch_vccz L_ow4_ok
    s_sleep 2
    s_add_u32 s15, s15, 1
    s_cmp_lt_u32 s15, 160000
    s_cbranch_scc1 L_ow4_w
L_ow4_ok:
    s_mov_b32 s10, 32768
    buffer_store_dwordx4 v[176:179], v29, s[64:67], s10 offen nt
    s_mov_b32 s15, 0
L_ow5_w:
    ds_read_b128 v[60:63], v21 offset:0
    s_waitcnt lgkmcnt(0)
    v_min3_u32 v60, v60, v61, v62
    v_min_u32 v60, v60, v63
    v_cmp_gt_u32 vcc, 32, v60
    s_cbranch_vccz L_ow5_ok
    s_sleep 2
    s_add_u32 s15, s15, 1
    s_cmp_lt_u32 s15, 160000
    s_cbranch_scc1 L_ow5_w
L_ow5_ok:
    s_mov_b32 s10, 40960
    buffer_store_dwordx4 v[180:183], v29, s[64:67], s10 offen nt
    s_mov_b32 s15, 0
L_ow6_w:
    ds_read_b128 v[60:63], v21 offset:0
    s_waitcnt lgkmcnt(0)
    v_min3_u32 v60, v60, v61, v62
    v_min_u32 v60, v60, v63
    v_cmp_gt_u32 vcc, 33, v60
    s_cbranch_vccz L_ow6_ok
    s_sleep 2
    s_add_u32 s15, s15, 1
    s_cmp_lt_u32 s15, 160000
    s_cbranch_scc1 L_ow6_w
L_ow6_ok:
    s_mov_b32 s10, 49152
    buffer_store_dwordx4 v[184:187], v29, s[64:67], s10 offen nt
    s_mov_b32 s15, 0
L_ow7_w:
    ds_read_b128 v[60:63], v21 offset:0
    s_waitcnt lgkmcnt(0)
    v_min3_u32 v60, v60, v61, v62
    v_min_u32 v60, v60, v63
    v_cmp_gt_u32 vcc, 33, v60
    s_cbranch_vccz L_ow7_ok
    s_sleep 2
    s_add_u32 s15, s15, 1
    s_cmp_lt_u32 s15, 160000
    s_cbranch_scc1 L_ow7_w
L_ow7_ok:
    s_mov_b32 s10, 57344
    buffer_store_dwordx4 v[188:191], v29, s[64:67], s10 offen nt
    s_endpgm
Y_G:
    s_and_b32 s68, s4, 6
    s_add_u32 s69, s5, s68
    s_lshl_b32 s69, s69, 1
    s_and_b32 s68, s4, 1
    s_add_u32 s69, s69, s68
    s_and_b32 s69, s69, 15
    s_mov_b32 s100, 0x76543210
    s_mov_b32 s101, 0xfedcba98
    s_lshl_b32 s68, s69, 2
    s_lshr_b64 s[64:65], s[100:101], s68
    s_sub_u32 s68, 64, s68
    s_lshl_b64 s[100:101], s[100:101], s68
    s_or_b64 s[100:101], s[100:101], s[64:65]
    s_sub_u32 s68, s7, s69
    s_and_b32 s68, s68, 15
    s_lshl_b32 s68, s68, 2
    s_bfm_b64 s[64:65], s68, 0
    s_and_b64 s[66:67], s[100:101], s[64:65]
    s_lshl_b64 s[66:67], s[66:67], 4
    s_lshl_b64 s[64:65], s[64:65], 4
    s_or_b32 s64, s64, 15
    s_andn2_b64 s[100:101], s[100:101], s[64:65]
    s_or_b64 s[100:101], s[100:101], s[66:67]
    s_or_b32 s100, s100, s7
    s_setprio 0
    v_and_b32 v3, 31, v2
    v_mov_b32 v23, 0
    v_mov_b32 v11, 163712
    v_lshrrev_b32 v4, 5, v2
    s_lshr_b32 s8, s3, 1
    s_and_b32 s9, s3, 1
    s_lshl_b32 s10, s7, 6
    s_lshl_b32 s11, s9, 5
    s_add_u32 s10, s10, s11
    v_add_u32 v5, s10, v3
    v_lshlrev_b32 v48, 1, v5
    s_lshl_b32 s10, s7, 7
    v_and_b32 v49, 15, v2
    v_lshl_add_u32 v49, v49, 3, s10
    s_lshl_b32 s10, s3, 2
    s_add_u32 s10, s10, 163712
    v_mov_b32 v10, s10
    s_waitcnt lgkmcnt(0)
    s_mov_b32 s76, s48
    s_mov_b32 s77, s49
    s_mov_b32 s78, 256
    s_mov_b32 s79, 0x00020000
    s_or_b32 s10, s2, s3
    s_cmp_eq_u32 s10, 0
    s_cbranch_scc0 G_nononce
    s_memrealtime s[10:11]
    s_waitcnt lgkmcnt(0)
    s_or_b32 s10, s10, 1
    v_mov_b32 v54, s10
    v_mov_b32 v55, s11
    s_mov_b64 exec, 1
    buffer_store_dwordx2 v[54:55], v23, s[76:79], 0 offen sc1
    s_mov_b64 exec, -1
G_nononce:
    s_mov_b32 s52, s42
    s_mov_b32 s53, s43
    s_mov_b32 s54, 2048
    s_mov_b32 s55, 0x00020000
    buffer_load_ushort v12, v48, s[52:55], 0 offen
    s_mov_b32 s52, s30
    s_mov_b32 s53, s31
    buffer_load_ushort v13, v48, s[52:55], 0 offen
    s_mov_b32 s52, s32
    s_mov_b32 s53, s33
    buffer_load_ushort v14, v48, s[52:55], 0 offen
    s_mov_b32 s52, s44
    s_mov_b32 s53, s45
    buffer_load_dwordx2 v[24:25], v49, s[52:55], 0 offen
    s_mov_b32 s52, s28
    s_mov_b32 s53, s29
    s_mov_b32 s54, 4194304
    s_mov_b32 s55, 0x00020000
    s_mov_b32 s60, s46
    s_mov_b32 s61, s47
    s_mov_b32 s62, 16777216
    s_mov_b32 s63, 0x00020000
    s_add_u32 s64, s50, 16777216
    s_addc_u32 s65, s51, 0
    s_mov_b32 s66, 278528
    s_mov_b32 s67, 0x00020000
    s_add_u32 s68, s50, 8388608
    s_addc_u32 s69, s51, 0
    s_mov_b32 s70, 8388608
    s_mov_b32 s71, 0x00020000
    s_add_u32 s72, s50, 17825792
    s_addc_u32 s73, s51, 0
    s_mov_b32 s74, 65536
    s_mov_b32 s75, 0x00020000
    s_cmp_eq_u32 s9, 1
    s_cselect_b32 s80, s40, s38
    s_cselect_b32 s81, s41, s39
    s_mov_b32 s82, 2097152
    s_mov_b32 s83, 0x00020000
    s_lshl_b32 s10, s6, 7
    s_lshl_b32 s11, s3, 5
    s_add_u32 s10, s10, s11
    v_lshrrev_b32 v50, 4, v2
    v_lshl_add_u32 v50, v50, 2, s10
    v_lshl_add_u32 v22, v50, 11, v49
    v_xor_b32 v50, 1, v4
    v_lshlrev_b32 v50, 14, v50
    v_lshl_add_u32 v53, v5, 4, v50
    v_lshlrev_b32 v26, 4, v2
    v_add_u32 v27, 4096, v26
    v_lshrrev_b32 v50, 1, v3
    v_and_b32 v50, 7, v50
    v_xor_b32 v50, v50, v4
    v_lshlrev_b32 v50, 4, v50
    v_lshl_add_u32 v50, v3, 7, v50
    s_lshl_b32 s10, s8, 13
    s_lshl_b32 s11, s9, 13
    s_add_u32 s11, s11, 16384
    v_add_u32 v32, s10, v50
    v_add_u32 v36, s11, v50
    v_xor_b32 v33, 32, v32
    v_xor_b32 v37, 32, v36
    v_xor_b32 v34, 64, v32
    v_xor_b32 v38, 64, v36
    v_xor_b32 v35, 96, v32
    v_xor_b32 v39, 96, v36
    v_add_u32 v40, 65536, v32
    v_add_u32 v41, 65536, v33
    v_add_u32 v42, 65536, v34
    v_add_u32 v43, 65536, v35
    v_add_u32 v44, 65536, v36
    v_add_u32 v45, 65536, v37
    v_add_u32 v46, 65536, v38
    v_add_u32 v47, 65536, v39
    v_mov_b32 v64, 0
    v_mov_b32 v65, 0
    v_mov_b32 v66, 0
    v_mov_b32 v67, 0
    v_mov_b32 v68, 0
    v_mov_b32 v69, 0
    v_mov_b32 v70, 0
    v_mov_b32 v71, 0
    v_mov_b32 v72, 0
    v_mov_b32 v73, 0
    v_mov_b32 v74, 0
    v_mov_b32 v75, 0
    v_mov_b32 v76, 0
    v_mov_b32 v77, 0
    v_mov_b32 v78, 0
    v_mov_b32 v79, 0
    v_mov_b32 v80, 0
    v_mov_b32 v81, 0
    v_mov_b32 v82, 0
    v_mov_b32 v83, 0
    v_mov_b32 v84, 0
    v_mov_b32 v85, 0
    v_mov_b32 v86, 0
    v_mov_b32 v87, 0
    v_mov_b32 v88, 0
    v_mov_b32 v89, 0
    v_mov_b32 v90, 0
    v_mov_b32 v91, 0
    v_mov_b32 v92, 0
    v_mov_b32 v93, 0
    v_mov_b32 v94, 0
    v_mov_b32 v95, 0
    v_mov_b32 v96, 0
    v_mov_b32 v97, 0
    v_mov_b32 v98, 0
    v_mov_b32 v99, 0
    v_mov_b32 v100, 0
    v_mov_b32 v101, 0
    v_mov_b32 v102, 0
    v_mov_b32 v103, 0
    v_mov_b32 v104, 0
    v_mov_b32 v105, 0
    v_mov_b32 v106, 0
    v_mov_b32 v107, 0
    v_mov_b32 v108, 0
    v_mov_b32 v109, 0
    v_mov_b32 v110, 0
    v_mov_b32 v111, 0
    v_mov_b32 v112, 0
    v_mov_b32 v113, 0
    v_mov_b32 v114, 0
    v_mov_b32 v115, 0
    v_mov_b32 v116, 0
    v_mov_b32 v117, 0
    v_mov_b32 v118, 0
    v_mov_b32 v119, 0
    v_mov_b32 v120, 0
    v_mov_b32 v121, 0
    v_mov_b32 v122, 0
    v_mov_b32 v123, 0
    v_mov_b32 v124, 0
    v_mov_b32 v125, 0
    v_mov_b32 v126, 0
    v_mov_b32 v127, 0
    s_lshl_b32 s10, s8, 10
    s_lshl_b32 s11, s9, 9
    s_add_u32 s10, s10, s11
    s_add_u32 s10, s10, 151552
    v_lshl_add_u32 v0, v3, 4, s10
    v_xor_b32 v1, 1024, v0
    s_lshl_b32 s10, s8, 1
    s_sub_i32 s10, s6, s10
    v_sub_u32 v56, s10, v4
    v_add_u32 v57, 0, v56
    v_max_i32 v57, 0, v57
    v_lshlrev_b32 v57, 14, v57
    v_lshl_add_u32 v60, v5, 4, v57
    v_add_u32 v57, -4, v56
    v_max_i32 v57, 0, v57
    v_lshlrev_b32 v57, 14, v57
    v_lshl_add_u32 v61, v5, 4, v57
    v_add_u32 v57, -8, v56
    v_max_i32 v57, 0, v57
    v_lshlrev_b32 v57, 14, v57
    v_lshl_add_u32 v62, v5, 4, v57
    v_add_u32 v57, -12, v56
    v_max_i32 v57, 0, v57
    v_lshlrev_b32 v57, 14, v57
    v_lshl_add_u32 v63, v5, 4, v57
    s_mov_b32 s15, 0
G_s0_w:
    ds_read_b64 v[48:49], v11 offset:16
    s_waitcnt lgkmcnt(0)
    v_min_u32 v48, v48, v49
    v_cmp_gt_u32 vcc, 1, v48
    s_cbranch_vccz G_s0_ok
    s_add_u32 s15, s15, 1
    s_cmp_lt_u32 s15, 160000
    s_cbranch_scc1 G_s0_w
G_s0_ok:
    ds_read_b128 v[128:131], v32 offset:0
    ds_read_b128 v[136:139], v36 offset:0
    ds_read_b128 v[140:143], v36 offset:4096
    ds_read_b128 v[132:135], v32 offset:4096
    ds_read_b128 v[144:147], v33 offset:0
    ds_read_b128 v[152:155], v37 offset:0
    ds_read_b128 v[156:159], v37 offset:4096
    ds_read_b128 v[148:151], v33 offset:4096
    ds_read_b128 v[160:163], v34 offset:0
    ds_read_b128 v[168:171], v38 offset:0
    ds_read_b128 v[172:175], v38 offset:4096
    ds_read_b128 v[164:167], v34 offset:4096
    ds_read_b128 v[176:179], v35 offset:0
    ds_read_b128 v[184:187], v39 offset:0
    ds_read_b128 v[188:191], v39 offset:4096
    ds_read_b128 v[180:183], v35 offset:4096
    ds_read_b64 v[48:49], v11 offset:16
    v_mov_b32 v52, 1
    s_mov_b32 s12, 2
    s_waitcnt lgkmcnt(0)
    ds_write_b32 v10, v52
G1_loop:
    v_mfma_f32_32x32x16_bf16 v[64:79], v[128:131], v[136:139], v[64:79]
    s_waitcnt lgkmcnt(0)
    v_min_u32 v48, v48, v49
    v_cmp_gt_u32 vcc, s12, v48
    s_cbranch_vccnz G1_slow0
G1_back0:
    ds_read_b128 v[192:195], v32 offset:32768
    ds_read_b128 v[200:203], v36 offset:32768
    v_mfma_f32_32x32x16_bf16 v[80:95], v[128:131], v[140:143], v[80:95]
    ds_read_b128 v[204:207], v36 offset:36864
    ds_read_b128 v[196:199], v32 offset:36864
    v_mfma_f32_32x32x16_bf16 v[96:111], v[132:135], v[136:139], v[96:111]
    ds_read_b128 v[208:211], v33 offset:32768
    ds_read_b128 v[216:219], v37 offset:32768
    v_mfma_f32_32x32x16_bf16 v[112:127], v[132:135], v[140:143], v[112:127]
    ds_read_b128 v[220:223], v37 offset:36864
    ds_read_b128 v[212:215], v33 offset:36864
    v_mfma_f32_32x32x16_bf16 v[64:79], v[144:147], v[152:155], v[64:79]
    ds_read_b128 v[224:227], v34 offset:32768
    ds_read_b128 v[232:235], v38 offset:32768
    v_mfma_f32_32x32x16_bf16 v[80:95], v[144:147], v[156:159], v[80:95]
    ds_read_b128 v[236:239], v38 offset:36864
    ds_read_b128 v[228:231], v34 offset:36864
    v_mfma_f32_32x32x16_bf16 v[96:111], v[148:151], v[152:155], v[96:111]
    ds_read_b128 v[240:243], v35 offset:32768
    ds_read_b128 v[248:251], v39 offset:32768
    v_mfma_f32_32x32x16_bf16 v[112:127], v[148:151], v[156:159], v[112:127]
    ds_read_b128 v[252:255], v39 offset:36864
    ds_read_b128 v[244:247], v35 offset:36864
    v_mfma_f32_32x32x16_bf16 v[64:79], v[160:163], v[168:171], v[64:79]
    v_mfma_f32_32x32x16_bf16 v[80:95], v[160:163], v[172:175], v[80:95]
    v_mfma_f32_32x32x16_bf16 v[96:111], v[164:167], v[168:171], v[96:111]
    v_mfma_f32_32x32x16_bf16 v[112:127], v[164:167], v[172:175], v[112:127]
    v_mfma_f32_32x32x16_bf16 v[64:79], v[176:179], v[184:187], v[64:79]
    v_mov_b32 v52, s12
    s_waitcnt lgkmcnt(0)
    ds_write_b32 v10, v52
    s_add_u32 s12, s12, 1
    v_mfma_f32_32x32x16_bf16 v[80:95], v[176:179], v[188:191], v[80:95]
    ds_read_b64 v[48:49], v11 offset:16
    v_mfma_f32_32x32x16_bf16 v[96:111], v[180:183], v[184:187], v[96:111]
    v_mfma_f32_32x32x16_bf16 v[112:127], v[180:183], v[188:191], v[112:127]
    v_mfma_f32_32x32x16_bf16 v[64:79], v[192:195], v[200:203], v[64:79]
    s_waitcnt lgkmcnt(0)
    v_min_u32 v48, v48, v49
    v_cmp_gt_u32 vcc, s12, v48
    s_cbranch_vccnz G1_slow1
G1_back1:
    ds_read_b128 v[128:131], v40 offset:0
    ds_read_b128 v[136:139], v44 offset:0
    v_mfma_f32_32x32x16_bf16 v[80:95], v[192:195], v[204:207], v[80:95]
    ds_read_b128 v[140:143], v44 offset:4096
    ds_read_b128 v[132:135], v40 offset:4096
    v_mfma_f32_32x32x16_bf16 v[96:111], v[196:199], v[200:203], v[96:111]
    ds_read_b128 v[144:147], v41 offset:0
    ds_read_b128 v[152:155], v45 offset:0
    v_mfma_f32_32x32x16_bf16 v[112:127], v[196:199], v[204:207], v[112:127]
    ds_read_b128 v[156:159], v45 offset:4096
    ds_read_b128 v[148:151], v41 offset:4096
    v_mfma_f32_32x32x16_bf16 v[64:79], v[208:211], v[216:219], v[64:79]
    ds_read_b128 v[160:163], v42 offset:0
    ds_read_b128 v[168:171], v46 offset:0
    v_mfma_f32_32x32x16_bf16 v[80:95], v[208:211], v[220:223], v[80:95]
    ds_read_b128 v[172:175], v46 offset:4096
    ds_read_b128 v[164:167], v42 offset:4096
    v_mfma_f32_32x32x16_bf16 v[96:111], v[212:215], v[216:219], v[96:111]
    ds_read_b128 v[176:179], v43 offset:0
    ds_read_b128 v[184:187], v47 offset:0
    v_mfma_f32_32x32x16_bf16 v[112:127], v[212:215], v[220:223], v[112:127]
    ds_read_b128 v[188:191], v47 offset:4096
    ds_read_b128 v[180:183], v43 offset:4096
    v_mfma_f32_32x32x16_bf16 v[64:79], v[224:227], v[232:235], v[64:79]
    v_mfma_f32_32x32x16_bf16 v[80:95], v[224:227], v[236:239], v[80:95]
    v_mfma_f32_32x32x16_bf16 v[96:111], v[228:231], v[232:235], v[96:111]
    v_mfma_f32_32x32x16_bf16 v[112:127], v[228:231], v[236:239], v[112:127]
    v_mfma_f32_32x32x16_bf16 v[64:79], v[240:243], v[248:251], v[64:79]
    v_mov_b32 v52, s12
    s_waitcnt lgkmcnt(0)
    ds_write_b32 v10, v52
    s_add_u32 s12, s12, 1
    v_mfma_f32_32x32x16_bf16 v[80:95], v[240:243], v[252:255], v[80:95]
    ds_read_b64 v[48:49], v11 offset:16
    v_mfma_f32_32x32x16_bf16 v[96:111], v[244:247], v[248:251], v[96:111]
    v_mfma_f32_32x32x16_bf16 v[112:127], v[244:247], v[252:255], v[112:127]
    v_mfma_f32_32x32x16_bf16 v[64:79], v[128:131], v[136:139], v[64:79]
    s_waitcnt lgkmcnt(0)
    v_min_u32 v48, v48, v49
    v_cmp_gt_u32 vcc, s12, v48
    s_cbranch_vccnz G1_slow2
G1_back2:
    ds_read_b128 v[192:195], v40 offset:32768
    ds_read_b128 v[200:203], v44 offset:32768
    v_mfma_f32_32x32x16_bf16 v[80:95], v[128:131], v[140:143], v[80:95]
    ds_read_b128 v[204:207], v44 offset:36864
    ds_read_b128 v[196:199], v40 offset:36864
    v_mfma_f32_32x32x16_bf16 v[96:111], v[132:135], v[136:139], v[96:111]
    ds_read_b128 v[208:211], v41 offset:32768
    ds_read_b128 v[216:219], v45 offset:32768
    v_mfma_f32_32x32x16_bf16 v[112:127], v[132:135], v[140:143], v[112:127]
    ds_read_b128 v[220:223], v45 offset:36864
    ds_read_b128 v[212:215], v41 offset:36864
    v_mfma_f32_32x32x16_bf16 v[64:79], v[144:147], v[152:155], v[64:79]
    ds_read_b128 v[224:227], v42 offset:32768
    ds_read_b128 v[232:235], v46 offset:32768
    v_mfma_f32_32x32x16_bf16 v[80:95], v[144:147], v[156:159], v[80:95]
    ds_read_b128 v[236:239], v46 offset:36864
    ds_read_b128 v[228:231], v42 offset:36864
    v_mfma_f32_32x32x16_bf16 v[96:111], v[148:151], v[152:155], v[96:111]
    ds_read_b128 v[240:243], v43 offset:32768
    ds_read_b128 v[248:251], v47 offset:32768
    v_mfma_f32_32x32x16_bf16 v[112:127], v[148:151], v[156:159], v[112:127]
    ds_read_b128 v[252:255], v47 offset:36864
    ds_read_b128 v[244:247], v43 offset:36864
    v_mfma_f32_32x32x16_bf16 v[64:79], v[160:163], v[168:171], v[64:79]
    v_mfma_f32_32x32x16_bf16 v[80:95], v[160:163], v[172:175], v[80:95]
    v_mfma_f32_32x32x16_bf16 v[96:111], v[164:167], v[168:171], v[96:111]
    v_mfma_f32_32x32x16_bf16 v[112:127], v[164:167], v[172:175], v[112:127]
    v_mfma_f32_32x32x16_bf16 v[64:79], v[176:179], v[184:187], v[64:79]
    v_mov_b32 v52, s12
    s_waitcnt lgkmcnt(0)
    ds_write_b32 v10, v52
    s_add_u32 s12, s12, 1
    v_mfma_f32_32x32x16_bf16 v[80:95], v[176:179], v[188:191], v[80:95]
    ds_read_b64 v[48:49], v11 offset:16
    v_mfma_f32_32x32x16_bf16 v[96:111], v[180:183], v[184:187], v[96:111]
    v_mfma_f32_32x32x16_bf16 v[112:127], v[180:183], v[188:191], v[112:127]
    s_cmp_eq_u32 s12, 17
    s_cbranch_scc1 G1_last
    v_mfma_f32_32x32x16_bf16 v[64:79], v[192:195], v[200:203], v[64:79]
    s_waitcnt lgkmcnt(0)
    v_min_u32 v48, v48, v49
    v_cmp_gt_u32 vcc, s12, v48
    s_cbranch_vccnz G1_slow3
G1_back3:
    ds_read_b128 v[128:131], v32 offset:0
    ds_read_b128 v[136:139], v36 offset:0
    v_mfma_f32_32x32x16_bf16 v[80:95], v[192:195], v[204:207], v[80:95]
    ds_read_b128 v[140:143], v36 offset:4096
    ds_read_b128 v[132:135], v32 offset:4096
    v_mfma_f32_32x32x16_bf16 v[96:111], v[196:199], v[200:203], v[96:111]
    ds_read_b128 v[144:147], v33 offset:0
    ds_read_b128 v[152:155], v37 offset:0
    v_mfma_f32_32x32x16_bf16 v[112:127], v[196:199], v[204:207], v[112:127]
    ds_read_b128 v[156:159], v37 offset:4096
    ds_read_b128 v[148:151], v33 offset:4096
    v_mfma_f32_32x32x16_bf16 v[64:79], v[208:211], v[216:219], v[64:79]
    ds_read_b128 v[160:163], v34 offset:0
    ds_read_b128 v[168:171], v38 offset:0
    v_mfma_f32_32x32x16_bf16 v[80:95], v[208:211], v[220:223], v[80:95]
    ds_read_b128 v[172:175], v38 offset:4096
    ds_read_b128 v[164:167], v34 offset:4096
    v_mfma_f32_32x32x16_bf16 v[96:111], v[212:215], v[216:219], v[96:111]
    ds_read_b128 v[176:179], v35 offset:0
    ds_read_b128 v[184:187], v39 offset:0
    v_mfma_f32_32x32x16_bf16 v[112:127], v[212:215], v[220:223], v[112:127]
    ds_read_b128 v[188:191], v39 offset:4096
    ds_read_b128 v[180:183], v35 offset:4096
    v_mfma_f32_32x32x16_bf16 v[64:79], v[224:227], v[232:235], v[64:79]
    v_mfma_f32_32x32x16_bf16 v[80:95], v[224:227], v[236:239], v[80:95]
    v_mfma_f32_32x32x16_bf16 v[96:111], v[228:231], v[232:235], v[96:111]
    v_mfma_f32_32x32x16_bf16 v[112:127], v[228:231], v[236:239], v[112:127]
    v_mfma_f32_32x32x16_bf16 v[64:79], v[240:243], v[248:251], v[64:79]
    v_mov_b32 v52, s12
    s_waitcnt lgkmcnt(0)
    ds_write_b32 v10, v52
    s_add_u32 s12, s12, 1
    v_mfma_f32_32x32x16_bf16 v[80:95], v[240:243], v[252:255], v[80:95]
    ds_read_b64 v[48:49], v11 offset:16
    v_mfma_f32_32x32x16_bf16 v[96:111], v[244:247], v[248:251], v[96:111]
    v_mfma_f32_32x32x16_bf16 v[112:127], v[244:247], v[252:255], v[112:127]
    s_branch G1_loop
G1_slow0:
    s_mov_b32 s15, 0
G1_sl0_w:
    ds_read_b64 v[48:49], v11 offset:16
    s_waitcnt lgkmcnt(0)
    v_min_u32 v48, v48, v49
    v_cmp_gt_u32 vcc, s12, v48
    s_cbranch_vccz G1_sl0_ok
    s_add_u32 s15, s15, 1
    s_cmp_lt_u32 s15, 160000
    s_cbranch_scc1 G1_sl0_w
G1_sl0_ok:
    s_branch G1_back0
G1_slow1:
    s_mov_b32 s15, 0
G1_sl1_w:
    ds_read_b64 v[48:49], v11 offset:16
    s_waitcnt lgkmcnt(0)
    v_min_u32 v48, v48, v49
    v_cmp_gt_u32 vcc, s12, v48
    s_cbranch_vccz G1_sl1_ok
    s_add_u32 s15, s15, 1
    s_cmp_lt_u32 s15, 160000
    s_cbranch_scc1 G1_sl1_w
G1_sl1_ok:
    s_branch G1_back1
G1_slow2:
    s_mov_b32 s15, 0
G1_sl2_w:
    ds_read_b64 v[48:49], v11 offset:16
    s_waitcnt lgkmcnt(0)
    v_min_u32 v48, v48, v49
    v_cmp_gt_u32 vcc, s12, v48
    s_cbranch_vccz G1_sl2_ok
    s_add_u32 s15, s15, 1
    s_cmp_lt_u32 s15, 160000
    s_cbranch_scc1 G1_sl2_w
G1_sl2_ok:
    s_branch G1_back2
G1_slow3:
    s_mov_b32 s15, 0
G1_sl3_w:
    ds_read_b64 v[48:49], v11 offset:16
    s_waitcnt lgkmcnt(0)
    v_min_u32 v48, v48, v49
    v_cmp_gt_u32 vcc, s12, v48
    s_cbranch_vccz G1_sl3_ok
    s_add_u32 s15, s15, 1
    s_cmp_lt_u32 s15, 160000
    s_cbranch_scc1 G1_sl3_w
G1_sl3_ok:
    s_branch G1_back3
G1_last:
    v_mfma_f32_32x32x16_bf16 v[64:79], v[192:195], v[200:203], v[64:79]
    s_setprio 3
    s_waitcnt vmcnt(0)
    ds_read_b64 v[30:31], v11 offset:32
    v_lshlrev_b32 v133, 16, v12
    v_lshlrev_b32 v134, 16, v13
    v_lshlrev_b32 v135, 16, v14
    v_mul_f32 v133, 0x3fb8aa3b, v133
    v_mfma_f32_32x32x16_bf16 v[80:95], v[192:195], v[204:207], v[80:95]
    v_exp_f32 v133, v133
    v_mul_f32 v140, v134, v134
    v_cvt_pk_bf16_f32 v133, v133, v133
    v_fmac_f32 v140, v135, v135
    v_mfma_f32_32x32x16_bf16 v[96:111], v[196:199], v[200:203], v[96:111]
    v_lshlrev_b32 v133, 16, v133
    v_rcp_f32 v140, v140
    v_mul_f32 v136, v133, v134
    v_mul_f32 v137, v133, v135
    v_mfma_f32_32x32x16_bf16 v[112:127], v[196:199], v[204:207], v[112:127]
    v_mul_f32 v136, 0x3fb8aa3b, v136
    v_exp_f32 v136, v136
    v_mul_f32 v137, 0.15915494, v137
    v_cos_f32 v138, v137
    v_mfma_f32_32x32x16_bf16 v[64:79], v[208:211], v[216:219], v[64:79]
    v_sin_f32 v139, v137
    v_add_f32 v140, v140, v140
    v_mul_f32 v6, v136, v138
    v_mul_f32 v7, v136, v139
    v_mfma_f32_32x32x16_bf16 v[80:95], v[208:211], v[220:223], v[80:95]
    v_mul_f32 v128, v6, v6
    v_mul_f32 v129, v6, v7
    v_fma_f32 v128, -v7, v7, v128
    v_fmac_f32 v129, v7, v6
    v_mfma_f32_32x32x16_bf16 v[96:111], v[212:215], v[216:219], v[96:111]
    v_mul_f32 v130, v128, v128
    v_mul_f32 v131, v128, v129
    v_fma_f32 v130, -v129, v129, v130
    v_fmac_f32 v131, v129, v128
    v_mfma_f32_32x32x16_bf16 v[112:127], v[212:215], v[220:223], v[112:127]
    v_mul_f32 v12, v130, v130
    v_mul_f32 v13, v130, v131
    v_fma_f32 v12, -v131, v131, v12
    v_fmac_f32 v13, v131, v130
    v_mfma_f32_32x32x16_bf16 v[64:79], v[224:227], v[232:235], v[64:79]
    v_mul_f32 v14, v12, v12
    v_mul_f32 v15, v12, v13
    v_fma_f32 v14, -v13, v13, v14
    v_fmac_f32 v15, v13, v12
    v_mfma_f32_32x32x16_bf16 v[80:95], v[224:227], v[236:239], v[80:95]
    v_mul_f32 v16, v14, v14
    v_mul_f32 v17, v14, v15
    v_fma_f32 v16, -v15, v15, v16
    v_fmac_f32 v17, v15, v14
    v_mfma_f32_32x32x16_bf16 v[96:111], v[228:231], v[232:235], v[96:111]
    v_add_f32 v136, -1.0, v6
    v_mul_f32 v138, v136, v134
    v_fmac_f32 v138, v7, v135
    v_mul_f32 v139, v7, v134
    v_mfma_f32_32x32x16_bf16 v[112:127], v[228:231], v[236:239], v[112:127]
    v_fma_f32 v139, -v136, v135, v139
    v_mul_f32 v8, v138, v140
    v_mul_f32 v9, v139, v140
    v_mul_f32 v18, v16, v16
    v_mfma_f32_32x32x16_bf16 v[64:79], v[240:243], v[248:251], v[64:79]
    v_mul_f32 v19, v16, v17
    v_fma_f32 v18, -v17, v17, v18
    v_fmac_f32 v19, v17, v16
    v_mul_f32 v20, v18, v18
    v_mfma_f32_32x32x16_bf16 v[80:95], v[240:243], v[252:255], v[80:95]
    v_mul_f32 v21, v18, v19
    v_fma_f32 v20, -v19, v19, v20
    v_fmac_f32 v21, v19, v18
    v_mfma_f32_32x32x16_bf16 v[96:111], v[244:247], v[248:251], v[96:111]
    v_mfma_f32_32x32x16_bf16 v[112:127], v[244:247], v[252:255], v[112:127]
    s_nop 1
    v_fma_f32 v40, v6, v64, v66
    v_fma_f32 v41, v6, v65, v67
    s_nop 2
    v_fma_f32 v42, v6, v80, v82
    v_fma_f32 v43, v6, v81, v83
    s_nop 1
    v_fma_f32 v44, v6, v96, v98
    v_fma_f32 v45, v6, v97, v99
    v_fma_f32 v46, v6, v112, v114
    v_fma_f32 v47, v6, v113, v115
    v_fma_f32 v40, -v7, v80, v40
    v_fma_f32 v41, -v7, v81, v41
    v_fmac_f32 v42, v7, v64
    v_fmac_f32 v43, v7, v65
    v_fma_f32 v44, -v7, v112, v44
    v_fma_f32 v45, -v7, v113, v45
    v_fmac_f32 v46, v7, v96
    v_fmac_f32 v47, v7, v97
    v_fma_f32 v32, v6, v40, v68
    v_fma_f32 v33, v6, v41, v69
    v_fma_f32 v34, v6, v42, v84
    v_fma_f32 v35, v6, v43, v85
    v_fma_f32 v36, v6, v44, v100
    v_fma_f32 v37, v6, v45, v101
    v_fma_f32 v38, v6, v46, v116
    v_fma_f32 v39, v6, v47, v117
    v_fma_f32 v32, -v7, v42, v32
    v_fma_f32 v33, -v7, v43, v33
    v_fmac_f32 v34, v7, v40
    v_fmac_f32 v35, v7, v41
    v_fma_f32 v36, -v7, v46, v36
    v_fma_f32 v37, -v7, v47, v37
    v_fmac_f32 v38, v7, v44
    v_fmac_f32 v39, v7, v45
    v_fma_f32 v40, v6, v32, v70
    v_fma_f32 v41, v6, v33, v71
    v_fma_f32 v42, v6, v34, v86
    v_fma_f32 v43, v6, v35, v87
    v_fma_f32 v44, v6, v36, v102
    v_fma_f32 v45, v6, v37, v103
    v_fma_f32 v46, v6, v38, v118
    v_fma_f32 v47, v6, v39, v119
    v_fma_f32 v40, -v7, v34, v40
    v_fma_f32 v41, -v7, v35, v41
    v_fmac_f32 v42, v7, v32
    v_fmac_f32 v43, v7, v33
    v_fma_f32 v44, -v7, v38, v44
    v_fma_f32 v45, -v7, v39, v45
    v_fmac_f32 v46, v7, v36
    v_fmac_f32 v47, v7, v37
    v_fma_f32 v32, v6, v40, v72
    v_fma_f32 v33, v6, v41, v73
    v_fma_f32 v34, v6, v42, v88
    v_fma_f32 v35, v6, v43, v89
    v_fma_f32 v36, v6, v44, v104
    v_fma_f32 v37, v6, v45, v105
    v_fma_f32 v38, v6, v46, v120
    v_fma_f32 v39, v6, v47, v121
    v_fma_f32 v32, -v7, v42, v32
    v_fma_f32 v33, -v7, v43, v33
    v_fmac_f32 v34, v7, v40
    v_fmac_f32 v35, v7, v41
    v_fma_f32 v36, -v7, v46, v36
    v_fma_f32 v37, -v7, v47, v37
    v_fmac_f32 v38, v7, v44
    v_fmac_f32 v39, v7, v45
    v_fma_f32 v40, v6, v32, v74
    v_fma_f32 v41, v6, v33, v75
    v_fma_f32 v42, v6, v34, v90
    v_fma_f32 v43, v6, v35, v91
    v_fma_f32 v44, v6, v36, v106
    v_fma_f32 v45, v6, v37, v107
    v_fma_f32 v46, v6, v38, v122
    v_fma_f32 v47, v6, v39, v123
    v_fma_f32 v40, -v7, v34, v40
    v_fma_f32 v41, -v7, v35, v41
    v_fmac_f32 v42, v7, v32
    v_fmac_f32 v43, v7, v33
    v_fma_f32 v44, -v7, v38, v44
    v_fma_f32 v45, -v7, v39, v45
    v_fmac_f32 v46, v7, v36
    v_fmac_f32 v47, v7, v37
    v_fma_f32 v32, v6, v40, v76
    v_fma_f32 v33, v6, v41, v77
    v_fma_f32 v34, v6, v42, v92
    v_fma_f32 v35, v6, v43, v93
    v_fma_f32 v36, v6, v44, v108
    v_fma_f32 v37, v6, v45, v109
    v_fma_f32 v38, v6, v46, v124
    v_fma_f32 v39, v6, v47, v125
    v_fma_f32 v32, -v7, v42, v32
    v_fma_f32 v33, -v7, v43, v33
    v_fmac_f32 v34, v7, v40
    v_fmac_f32 v35, v7, v41
    v_fma_f32 v36, -v7, v46, v36
    v_fma_f32 v37, -v7, v47, v37
    v_fmac_f32 v38, v7, v44
    v_fmac_f32 v39, v7, v45
    v_fma_f32 v40, v6, v32, v78
    v_fma_f32 v41, v6, v33, v79
    v_fma_f32 v42, v6, v34, v94
    v_fma_f32 v43, v6, v35, v95
    v_fma_f32 v44, v6, v36, v110
    v_fma_f32 v45, v6, v37, v111
    v_fma_f32 v46, v6, v38, v126
    v_fma_f32 v47, v6, v39, v127
    v_fma_f32 v40, -v7, v34, v40
    v_fma_f32 v41, -v7, v35, v41
    v_fmac_f32 v42, v7, v32
    v_fmac_f32 v43, v7, v33
    v_fma_f32 v44, -v7, v38, v44
    v_fma_f32 v45, -v7, v39, v45
    v_fmac_f32 v46, v7, v36
    v_fmac_f32 v47, v7, v37
    v_fmac_f32 v44, v12, v40
    v_fmac_f32 v45, v12, v41
    v_fmac_f32 v46, v12, v42
    v_fmac_f32 v47, v12, v43
    v_fma_f32 v44, -v13, v42, v44
    v_fma_f32 v45, -v13, v43, v45
    v_fmac_f32 v46, v13, v40
    v_fmac_f32 v47, v13, v41
    v_fma_f32 v32, v14, v44, v45
    v_fma_f32 v34, v14, v46, v47
    v_fma_f32 v32, -v15, v46, v32
    v_fmac_f32 v34, v15, v44
    v_mov_b32 v33, v32
    v_mov_b32 v35, v34
    s_lshl_b32 s12, s6, 1
    s_add_u32 s12, s12, s8
    v_permlane32_swap_b32 v32, v33
    v_permlane32_swap_b32 v34, v35
    v_fma_f32 v28, v16, v32, v33
    v_fma_f32 v29, v16, v34, v35
    v_fma_f32 v28, -v17, v34, v28
    v_fmac_f32 v29, v17, v32
    s_waitcnt lgkmcnt(0)
    s_mov_b32 s15, 0
G_nw:
    v_cmp_eq_u32 vcc, 0, v30
    s_cbranch_vccz G_nok
    ds_read_b64 v[30:31], v11 offset:32
    s_add_u32 s15, s15, 1
    s_waitcnt lgkmcnt(0)
    s_cmp_lt_u32 s15, 160000
    s_cbranch_scc1 G_nw
G_nok:
    s_cmp_eq_u32 s8, 0
    s_cbranch_scc0 G_pw1
    ds_write_b128 v0, v[28:31] offset:2048
    s_branch G_pub1
G_pw1:
    s_mov_b32 s15, 0
G_x1:
    ds_read_b128 v[56:59], v1 offset:2048
    s_add_u32 s15, s15, 1
    s_waitcnt lgkmcnt(0)
    v_cmp_ne_u64 vcc, v[58:59], v[30:31]
    s_cbranch_vccz G_x1_ok
    s_cmp_lt_u32 s15, 160000
    s_cbranch_scc1 G_x1
G_x1_ok:
    v_fmac_f32 v28, v18, v56
    v_fmac_f32 v29, v18, v57
    s_lshl_b32 s13, s6, 14
    v_fma_f32 v28, -v19, v57, v28
    v_fmac_f32 v29, v19, v56
    s_mov_b32 exec_hi, 0
    buffer_store_dwordx4 v[28:31], v53, s[64:67], s13 offen sc1
    s_cmp_eq_u32 s6, 0
    s_cbranch_scc0 G_pub1
    s_not_b64 exec, exec
    v_mov_b32 v28, 0
    v_mov_b32 v29, 0
    buffer_store_dwordx4 v[28:31], v53, s[64:67], 0 offen sc1
G_pub1:
    s_mov_b64 exec, -1
    v_mul_f32 v128, v8, v64
    v_mul_f32 v129, v8, v65
    v_mul_f32 v144, -v8, v80
    v_mul_f32 v145, -v8, v81
    v_mul_f32 v160, v8, v96
    v_mul_f32 v161, v8, v97
    v_mul_f32 v176, -v8, v112
    v_mul_f32 v177, -v8, v113
    v_fma_f32 v128, -v9, v80, v128
    v_fma_f32 v129, -v9, v81, v129
    v_fma_f32 v144, -v9, v64, v144
    v_fma_f32 v145, -v9, v65, v145
    v_fma_f32 v160, -v9, v112, v160
    v_fma_f32 v161, -v9, v113, v161
    v_fma_f32 v176, -v9, v96, v176
    v_fma_f32 v177, -v9, v97, v177
    v_mul_f32 v130, v8, v66
    v_mul_f32 v131, v8, v67
    v_mul_f32 v146, -v8, v82
    v_mul_f32 v147, -v8, v83
    v_mul_f32 v162, v8, v98
    v_mul_f32 v163, v8, v99
    v_mul_f32 v178, -v8, v114
    v_mul_f32 v179, -v8, v115
    v_fma_f32 v130, -v9, v82, v130
    v_fma_f32 v131, -v9, v83, v131
    v_fma_f32 v146, -v9, v66, v146
    v_fma_f32 v147, -v9, v67, v147
    v_fma_f32 v162, -v9, v114, v162
    v_fma_f32 v163, -v9, v115, v163
    v_fma_f32 v178, -v9, v98, v178
    v_fma_f32 v179, -v9, v99, v179
    v_mul_f32 v132, v8, v68
    v_mul_f32 v133, v8, v69
    v_mul_f32 v148, -v8, v84
    v_mul_f32 v149, -v8, v85
    v_mul_f32 v164, v8, v100
    v_mul_f32 v165, v8, v101
    v_mul_f32 v180, -v8, v116
    v_mul_f32 v181, -v8, v117
    v_fma_f32 v132, -v9, v84, v132
    v_fma_f32 v133, -v9, v85, v133
    v_fma_f32 v148, -v9, v68, v148
    v_fma_f32 v149, -v9, v69, v149
    v_fma_f32 v164, -v9, v116, v164
    v_fma_f32 v165, -v9, v117, v165
    v_fma_f32 v180, -v9, v100, v180
    v_fma_f32 v181, -v9, v101, v181
    v_mul_f32 v134, v8, v70
    v_mul_f32 v135, v8, v71
    v_mul_f32 v150, -v8, v86
    v_mul_f32 v151, -v8, v87
    v_mul_f32 v166, v8, v102
    v_mul_f32 v167, v8, v103
    v_mul_f32 v182, -v8, v118
    v_mul_f32 v183, -v8, v119
    v_fma_f32 v134, -v9, v86, v134
    v_fma_f32 v135, -v9, v87, v135
    v_fma_f32 v150, -v9, v70, v150
    v_fma_f32 v151, -v9, v71, v151
    v_fma_f32 v166, -v9, v118, v166
    v_fma_f32 v167, -v9, v119, v167
    v_fma_f32 v182, -v9, v102, v182
    v_fma_f32 v183, -v9, v103, v183
    v_mul_f32 v136, v8, v72
    v_mul_f32 v137, v8, v73
    v_mul_f32 v152, -v8, v88
    v_mul_f32 v153, -v8, v89
    v_mul_f32 v168, v8, v104
    v_mul_f32 v169, v8, v105
    v_mul_f32 v184, -v8, v120
    v_mul_f32 v185, -v8, v121
    v_fma_f32 v136, -v9, v88, v136
    v_fma_f32 v137, -v9, v89, v137
    v_fma_f32 v152, -v9, v72, v152
    v_fma_f32 v153, -v9, v73, v153
    v_fma_f32 v168, -v9, v120, v168
    v_fma_f32 v169, -v9, v121, v169
    v_fma_f32 v184, -v9, v104, v184
    v_fma_f32 v185, -v9, v105, v185
    v_mul_f32 v138, v8, v74
    v_mul_f32 v139, v8, v75
    v_mul_f32 v154, -v8, v90
    v_mul_f32 v155, -v8, v91
    v_mul_f32 v170, v8, v106
    v_mul_f32 v171, v8, v107
    v_mul_f32 v186, -v8, v122
    v_mul_f32 v187, -v8, v123
    v_fma_f32 v138, -v9, v90, v138
    v_fma_f32 v139, -v9, v91, v139
    v_fma_f32 v154, -v9, v74, v154
    v_fma_f32 v155, -v9, v75, v155
    v_fma_f32 v170, -v9, v122, v170
    v_fma_f32 v171, -v9, v123, v171
    v_fma_f32 v186, -v9, v106, v186
    v_fma_f32 v187, -v9, v107, v187
    v_mul_f32 v140, v8, v76
    v_mul_f32 v141, v8, v77
    v_mul_f32 v156, -v8, v92
    v_mul_f32 v157, -v8, v93
    v_mul_f32 v172, v8, v108
    v_mul_f32 v173, v8, v109
    v_mul_f32 v188, -v8, v124
    v_mul_f32 v189, -v8, v125
    v_fma_f32 v140, -v9, v92, v140
    v_fma_f32 v141, -v9, v93, v141
    v_fma_f32 v156, -v9, v76, v156
    v_fma_f32 v157, -v9, v77, v157
    v_fma_f32 v172, -v9, v124, v172
    v_fma_f32 v173, -v9, v125, v173
    v_fma_f32 v188, -v9, v108, v188
    v_fma_f32 v189, -v9, v109, v189
    v_mul_f32 v142, v8, v78
    v_mul_f32 v143, v8, v79
    v_mul_f32 v158, -v8, v94
    v_mul_f32 v159, -v8, v95
    v_mul_f32 v174, v8, v110
    v_mul_f32 v175, v8, v111
    v_mul_f32 v190, -v8, v126
    v_mul_f32 v191, -v8, v127
    v_fma_f32 v142, -v9, v94, v142
    v_fma_f32 v143, -v9, v95, v143
    v_fma_f32 v158, -v9, v78, v158
    v_fma_f32 v159, -v9, v79, v159
    v_fma_f32 v174, -v9, v126, v174
    v_fma_f32 v175, -v9, v127, v175
    v_fma_f32 v190, -v9, v110, v190
    v_fma_f32 v191, -v9, v111, v191
    s_mov_b32 s13, 0
    buffer_load_dwordx2 v[80:81], v22, s[52:55], s13 offen offset:0
    buffer_load_dwordx2 v[82:83], v22, s[52:55], s13 offen offset:2048
    s_mov_b32 s13, 4096
    buffer_load_dwordx2 v[84:85], v22, s[52:55], s13 offen offset:0
    buffer_load_dwordx2 v[86:87], v22, s[52:55], s13 offen offset:2048
    s_mov_b32 s13, 32768
    buffer_load_dwordx2 v[88:89], v22, s[52:55], s13 offen offset:0
    buffer_load_dwordx2 v[90:91], v22, s[52:55], s13 offen offset:2048
    s_mov_b32 s13, 36864
    buffer_load_dwordx2 v[92:93], v22, s[52:55], s13 offen offset:0
    buffer_load_dwordx2 v[94:95], v22, s[52:55], s13 offen offset:2048
    v_cmp_eq_u32 vcc, 1, v4
    v_mov_b32 v36, 1.0
    s_nop 0
    v_cndmask_b32 v72, v36, v20, vcc
    v_cndmask_b32 v73, 0, v21, vcc
    v_cndmask_b32 v96, 0, v32, vcc
    v_cndmask_b32 v98, 0, v34, vcc
    v_cndmask_b32 v36, v36, v16, vcc
    v_cndmask_b32 v37, 0, v17, vcc
    s_cmp_eq_u32 s8, 1
    s_cselect_b64 s[14:15], -1, 0
    v_mul_f32 v74, v20, v20
    v_fma_f32 v97, v14, v96, v44
    v_mul_f32 v75, v20, v21
    v_fma_f32 v99, v14, v98, v46
    v_fma_f32 v74, -v21, v21, v74
    v_fma_f32 v97, -v15, v98, v97
    v_fmac_f32 v75, v21, v20
    v_fmac_f32 v99, v15, v96
    v_mul_f32 v76, v74, v74
    v_fma_f32 v100, v12, v96, v40
    v_mul_f32 v77, v74, v75
    v_fma_f32 v101, v12, v97, v41
    v_fma_f32 v76, -v75, v75, v76
    v_fma_f32 v102, v12, v98, v42
    v_fmac_f32 v77, v75, v74
    v_fma_f32 v103, v12, v99, v43
    v_cndmask_b32 v74, 1.0, v74, s[14:15]
    v_fma_f32 v100, -v13, v98, v100
    v_cndmask_b32 v75, 0, v75, s[14:15]
    v_fma_f32 v101, -v13, v99, v101
    v_mul_f32 v64, v72, v74
    v_fmac_f32 v102, v13, v96
    v_mul_f32 v65, v72, v75
    v_fmac_f32 v103, v13, v97
    v_fma_f32 v64, -v73, v75, v64
    v_mul_f32 v104, v8, v36
    v_fmac_f32 v65, v73, v74
    v_mul_f32 v106, v8, v37
    v_mul_f32 v66, v64, v76
    v_fma_f32 v104, -v9, v37, v104
    v_mul_f32 v67, v64, v77
    v_fmac_f32 v106, v9, v36
    v_fma_f32 v66, -v65, v77, v66
    v_mul_f32 v105, v14, v104
    v_fmac_f32 v67, v65, v76
    v_mul_f32 v107, v14, v106
    v_mul_f32 v68, v66, v76
    v_fma_f32 v105, -v15, v106, v105
    v_mul_f32 v69, v66, v77
    v_fmac_f32 v107, v15, v104
    v_fma_f32 v68, -v67, v77, v68
    v_mul_f32 v108, v12, v104
    v_fmac_f32 v69, v67, v76
    v_mul_f32 v109, v12, v105
    v_mul_f32 v70, v68, v76
    v_mul_f32 v110, v12, v106
    v_mul_f32 v71, v68, v77
    v_mul_f32 v111, v12, v107
    v_fma_f32 v70, -v69, v77, v70
    v_fma_f32 v108, -v13, v106, v108
    v_fmac_f32 v71, v69, v76
    v_fma_f32 v109, -v13, v107, v109
    v_fmac_f32 v110, v13, v104
    v_fmac_f32 v111, v13, v105
    v_mul_f32 v112, v8, v96
    v_mul_f32 v113, v8, v97
    v_mul_f32 v114, -v8, v98
    v_mul_f32 v115, -v8, v99
    v_fma_f32 v112, -v9, v98, v112
    v_fma_f32 v113, -v9, v99, v113
    v_fma_f32 v114, -v9, v96, v114
    v_fma_f32 v115, -v9, v97, v115
    v_mul_f32 v116, v8, v100
    v_mul_f32 v117, v8, v101
    v_mul_f32 v118, -v8, v102
    v_mul_f32 v119, -v8, v103
    v_fma_f32 v116, -v9, v102, v116
    v_fma_f32 v117, -v9, v103, v117
    v_fma_f32 v118, -v9, v100, v118
    v_fma_f32 v119, -v9, v101, v119
    s_lshl_b32 s13, s3, 13
    s_add_u32 s13, s13, 65536
    v_and_b32 v32, 1, v2
    v_and_b32 v33, 2, v2
    v_lshl_or_b32 v32, v33, 1, v32
    v_lshrrev_b32 v33, 1, v2
    v_xor_b32 v33, v33, v2
    v_bfe_u32 v33, v33, 2, 1
    v_lshl_or_b32 v32, v33, 1, v32
    v_lshlrev_b32 v33, 2, v4
    v_xor_b32 v32, v32, v33
    v_lshlrev_b32 v32, 4, v32
    v_lshl_add_u32 v32, v3, 7, v32
    v_add_u32 v120, s13, v32
    v_xor_b32 v121, 16, v120
    v_xor_b32 v122, 32, v120
    v_xor_b32 v123, 48, v120
    v_bfe_u32 v32, v2, 2, 2
    v_lshrrev_b32 v33, 4, v2
    v_lshl_add_u32 v33, v33, 3, v32
    v_lshlrev_b32 v33, 7, v33
    v_and_b32 v34, 1, v32
    v_and_b32 v32, 2, v32
    v_lshl_or_b32 v32, v32, 1, v34
    v_bfe_u32 v34, v2, 4, 1
    v_bfe_u32 v35, v2, 1, 1
    v_lshl_or_b32 v34, v34, 1, v35
    v_xor_b32 v32, v32, v34
    v_lshl_add_u32 v33, v32, 4, v33
    v_and_b32 v32, 1, v2
    v_lshl_add_u32 v33, v32, 3, v33
    v_add_u32 v124, s13, v33
    v_xor_b32 v125, 64, v124
    v_xor_b32 v126, 32, v124
    v_xor_b32 v127, 64, v126
    s_lshl_b32 s10, s7, 5
    s_add_u32 s10, s10, s8
    s_lshl_b32 s10, s10, 12
    v_lshrrev_b32 v40, 3, v2
    v_lshl_add_u32 v40, v40, 13, s10
    v_lshrrev_b32 v41, 4, v2
    v_xor_b32 v41, v41, v2
    v_and_b32 v41, 7, v41
    v_lshl_add_u32 v16, v41, 4, v40
    v_xor_b32 v17, 64, v16
    v_add_u32 v17, 64512, v17
    s_lshl_b32 s16, s6, 2
    s_add_u32 s16, s16, s3
    s_lshl_b32 s16, s16, 17
    s_lshl_b32 s22, s9, 13
    s_lshl_b32 s10, s8, 12
    s_add_u32 s22, s22, s10
    s_lshl_b32 s10, s9, 6
    s_lshl_b32 s11, s9, 13
    v_xor_b32 v20, s10, v124
    v_xor_b32 v21, s10, v126
    v_subrev_u32 v20, s11, v20
    v_subrev_u32 v21, s11, v21
    s_mov_b32 s15, 0
G_all16_w:
    ds_read_b128 v[48:51], v11 offset:0
    s_waitcnt lgkmcnt(0)
    v_min3_u32 v48, v48, v49, v50
    v_min_u32 v48, v48, v51
    v_cmp_gt_u32 vcc, 16, v48
    s_cbranch_vccz G_all16_ok
    s_add_u32 s15, s15, 1
    s_cmp_lt_u32 s15, 160000
    s_cbranch_scc1 G_all16_w
G_all16_ok:
    v_mov_b32 v36, 0
    v_mov_b32 v37, 0
    s_mov_b32 s15, 0
    s_cmp_eq_u32 s6, 0
    s_cbranch_scc1 G_lb4
    s_lshl_b32 s14, s8, 1
    s_sub_i32 s14, s6, s14
    s_cmp_le_i32 s14, 0
    s_cbranch_scc1 G_lb3
G_lb:
    buffer_load_dwordx4 v[192:195], v60, s[64:67], 0 offen sc1
    s_cmp_le_i32 s14, 4
    s_cbranch_scc1 G_lb1
    buffer_load_dwordx4 v[196:199], v61, s[64:67], 0 offen sc1
    s_cmp_le_i32 s14, 8
    s_cbranch_scc1 G_lb1
    buffer_load_dwordx4 v[200:203], v62, s[64:67], 0 offen sc1
    s_cmp_le_i32 s14, 12
    s_cbranch_scc1 G_lb1
    buffer_load_dwordx4 v[204:207], v63, s[64:67], 0 offen sc1
G_lb1:
    v_mov_b32 v36, 0
    v_mov_b32 v37, 0
    s_mov_b64 s[10:11], 0
    s_waitcnt vmcnt(0)
    v_cmp_ne_u64 vcc, v[194:195], v[30:31]
    v_fmac_f32 v36, v64, v192
    v_fmac_f32 v37, v64, v193
    s_or_b64 s[10:11], s[10:11], vcc
    v_fma_f32 v36, -v65, v193, v36
    v_fmac_f32 v37, v65, v192
    s_cmp_le_i32 s14, 4
    s_cbranch_scc1 G_lb2
    v_cmp_ne_u64 vcc, v[198:199], v[30:31]
    v_fmac_f32 v36, v66, v196
    v_fmac_f32 v37, v66, v197
    s_or_b64 s[10:11], s[10:11], vcc
    v_fma_f32 v36, -v67, v197, v36
    v_fmac_f32 v37, v67, v196
    s_cmp_le_i32 s14, 8
    s_cbranch_scc1 G_lb2
    v_cmp_ne_u64 vcc, v[202:203], v[30:31]
    v_fmac_f32 v36, v68, v200
    v_fmac_f32 v37, v68, v201
    s_or_b64 s[10:11], s[10:11], vcc
    v_fma_f32 v36, -v69, v201, v36
    v_fmac_f32 v37, v69, v200
    s_cmp_le_i32 s14, 12
    s_cbranch_scc1 G_lb2
    v_cmp_ne_u64 vcc, v[206:207], v[30:31]
    v_fmac_f32 v36, v70, v204
    v_fmac_f32 v37, v70, v205
    s_or_b64 s[10:11], s[10:11], vcc
    v_fma_f32 v36, -v71, v205, v36
    v_fmac_f32 v37, v71, v204
G_lb2:
    s_cmp_eq_u64 s[10:11], 0
    s_cbranch_scc1 G_lb2b
    s_add_u32 s15, s15, 1
    s_cmp_lt_u32 s15, 20000
    s_cbranch_scc1 G_lb
G_lb2b:
    v_mov_b32 v38, v36
    v_mov_b32 v39, v37
    s_nop 0
    v_permlane32_swap_b32 v36, v38
    v_permlane32_swap_b32 v37, v39
    v_add_f32 v36, v36, v38
    v_add_f32 v37, v37, v39
G_lb3:
    v_mov_b32 v28, v36
    v_mov_b32 v29, v37
    ds_write_b128 v0, v[28:31]
    s_mov_b32 s15, 0
G_x2:
    ds_read_b128 v[192:195], v1 offset:0
    s_add_u32 s15, s15, 1
    s_waitcnt lgkmcnt(0)
    v_cmp_ne_u64 vcc, v[194:195], v[30:31]
    s_cbranch_vccz G_x2_ok
    s_cmp_lt_u32 s15, 160000
    s_cbranch_scc1 G_x2
G_x2_ok:
    v_add_f32 v36, v36, v192
    v_add_f32 v37, v37, v193
G_lb4:
    s_cmp_eq_u32 s8, 0
    s_cbranch_scc1 G_lbdone
    v_fma_f32 v56, v18, v36, v56
    v_fma_f32 v57, v18, v37, v57
    v_fma_f32 v56, -v19, v37, v56
    v_fma_f32 v37, v19, v36, v57
    v_mov_b32 v36, v56
G_lbdone:
    v_fmac_f32 v112, v36, v104
    v_fmac_f32 v113, v36, v105
    v_fma_f32 v114, -v37, v104, v114
    v_fma_f32 v115, -v37, v105, v115
    v_fmac_f32 v116, v36, v108
    v_fmac_f32 v117, v36, v109
    v_fma_f32 v118, -v37, v108, v118
    v_fma_f32 v119, -v37, v109, v119
    v_fma_f32 v112, -v37, v106, v112
    v_fma_f32 v113, -v37, v107, v113
    v_fma_f32 v114, -v36, v106, v114
    v_fma_f32 v115, -v36, v107, v115
    v_fma_f32 v116, -v37, v110, v116
    v_fma_f32 v117, -v37, v111, v117
    v_fma_f32 v118, -v36, v110, v118
    v_fma_f32 v119, -v36, v111, v119
    s_bfe_u32 s18, s100, 28 + (4 << 16)
    s_lshl_b32 s18, s18, 7
    buffer_load_dwordx4 v[224:227], v16, s[80:83], s18 offen offset:0
    v_fmac_f32 v128, v6, v112
    v_fmac_f32 v129, v6, v113
    v_fmac_f32 v144, v6, v114
    v_fmac_f32 v145, v6, v115
    v_fmac_f32 v160, v6, v116
    v_fmac_f32 v161, v6, v117
    v_fmac_f32 v176, v6, v118
    v_fmac_f32 v177, v6, v119
    v_fmac_f32 v128, v7, v114
    v_fmac_f32 v129, v7, v115
    v_fma_f32 v144, -v7, v112, v144
    v_fma_f32 v145, -v7, v113, v145
    v_fmac_f32 v160, v7, v118
    v_fmac_f32 v161, v7, v119
    v_fma_f32 v176, -v7, v116, v176
    v_fma_f32 v177, -v7, v117, v177
    buffer_load_dwordx4 v[228:231], v17, s[80:83], s18 offen offset:1024
    v_fmac_f32 v130, v6, v128
    v_fmac_f32 v131, v6, v129
    v_fmac_f32 v146, v6, v144
    v_fmac_f32 v147, v6, v145
    v_fmac_f32 v162, v6, v160
    v_fmac_f32 v163, v6, v161
    v_fmac_f32 v178, v6, v176
    v_fmac_f32 v179, v6, v177
    v_fmac_f32 v130, v7, v144
    v_fmac_f32 v131, v7, v145
    v_fma_f32 v146, -v7, v128, v146
    v_fma_f32 v147, -v7, v129, v147
    v_fmac_f32 v162, v7, v176
    v_fmac_f32 v163, v7, v177
    v_fma_f32 v178, -v7, v160, v178
    v_fma_f32 v179, -v7, v161, v179
    buffer_load_dwordx4 v[232:235], v16, s[80:83], s18 offen offset:2048
    v_fmac_f32 v132, v6, v130
    v_fmac_f32 v133, v6, v131
    v_fmac_f32 v148, v6, v146
    v_fmac_f32 v149, v6, v147
    v_fmac_f32 v164, v6, v162
    v_fmac_f32 v165, v6, v163
    v_fmac_f32 v180, v6, v178
    v_fmac_f32 v181, v6, v179
    v_fmac_f32 v132, v7, v146
    v_fmac_f32 v133, v7, v147
    v_fma_f32 v148, -v7, v130, v148
    v_fma_f32 v149, -v7, v131, v149
    v_fmac_f32 v164, v7, v178
    v_fmac_f32 v165, v7, v179
    v_fma_f32 v180, -v7, v162, v180
    v_fma_f32 v181, -v7, v163, v181
    buffer_load_dwordx4 v[236:239], v17, s[80:83], s18 offen offset:3072
    v_fmac_f32 v134, v6, v132
    v_fmac_f32 v135, v6, v133
    v_fmac_f32 v150, v6, v148
    v_fmac_f32 v151, v6, v149
    v_fmac_f32 v166, v6, v164
    v_fmac_f32 v167, v6, v165
    v_fmac_f32 v182, v6, v180
    v_fmac_f32 v183, v6, v181
    v_fmac_f32 v134, v7, v148
    v_fmac_f32 v135, v7, v149
    v_fma_f32 v150, -v7, v132, v150
    v_fma_f32 v151, -v7, v133, v151
    v_fmac_f32 v166, v7, v180
    v_fmac_f32 v167, v7, v181
    v_fma_f32 v182, -v7, v164, v182
    v_fma_f32 v183, -v7, v165, v183
    s_bfe_u32 s18, s101, 0 + (4 << 16)
    s_lshl_b32 s18, s18, 7
    buffer_load_dwordx4 v[240:243], v16, s[80:83], s18 offen offset:0
    v_fmac_f32 v136, v6, v134
    v_fmac_f32 v137, v6, v135
    v_fmac_f32 v152, v6, v150
    v_fmac_f32 v153, v6, v151
    v_fmac_f32 v168, v6, v166
    v_fmac_f32 v169, v6, v167
    v_fmac_f32 v184, v6, v182
    v_fmac_f32 v185, v6, v183
    v_fmac_f32 v136, v7, v150
    v_fmac_f32 v137, v7, v151
    v_fma_f32 v152, -v7, v134, v152
    v_fma_f32 v153, -v7, v135, v153
    v_fmac_f32 v168, v7, v182
    v_fmac_f32 v169, v7, v183
    v_fma_f32 v184, -v7, v166, v184
    v_fma_f32 v185, -v7, v167, v185
    buffer_load_dwordx4 v[244:247], v17, s[80:83], s18 offen offset:1024
    v_fmac_f32 v138, v6, v136
    v_fmac_f32 v139, v6, v137
    v_fmac_f32 v154, v6, v152
    v_fmac_f32 v155, v6, v153
    v_fmac_f32 v170, v6, v168
    v_fmac_f32 v171, v6, v169
    v_fmac_f32 v186, v6, v184
    v_fmac_f32 v187, v6, v185
    v_fmac_f32 v138, v7, v152
    v_fmac_f32 v139, v7, v153
    v_fma_f32 v154, -v7, v136, v154
    v_fma_f32 v155, -v7, v137, v155
    v_fmac_f32 v170, v7, v184
    v_fmac_f32 v171, v7, v185
    v_fma_f32 v186, -v7, v168, v186
    v_fma_f32 v187, -v7, v169, v187
    buffer_load_dwordx4 v[248:251], v16, s[80:83], s18 offen offset:2048
    v_fmac_f32 v140, v6, v138
    v_fmac_f32 v141, v6, v139
    v_fmac_f32 v156, v6, v154
    v_fmac_f32 v157, v6, v155
    v_fmac_f32 v172, v6, v170
    v_fmac_f32 v173, v6, v171
    v_fmac_f32 v188, v6, v186
    v_fmac_f32 v189, v6, v187
    v_fmac_f32 v140, v7, v154
    v_fmac_f32 v141, v7, v155
    v_fma_f32 v156, -v7, v138, v156
    v_fma_f32 v157, -v7, v139, v157
    v_fmac_f32 v172, v7, v186
    v_fmac_f32 v173, v7, v187
    v_fma_f32 v188, -v7, v170, v188
    v_fma_f32 v189, -v7, v171, v189
    buffer_load_dwordx4 v[252:255], v17, s[80:83], s18 offen offset:3072
    v_fmac_f32 v142, v6, v140
    v_fmac_f32 v143, v6, v141
    v_fmac_f32 v158, v6, v156
    v_fmac_f32 v159, v6, v157
    v_fmac_f32 v174, v6, v172
    v_fmac_f32 v175, v6, v173
    v_fmac_f32 v190, v6, v188
    v_fmac_f32 v191, v6, v189
    v_fmac_f32 v142, v7, v156
    v_fmac_f32 v143, v7, v157
    v_fma_f32 v158, -v7, v140, v158
    v_fma_f32 v159, -v7, v141, v159
    v_fmac_f32 v174, v7, v188
    v_fmac_f32 v175, v7, v189
    v_fma_f32 v190, -v7, v172, v190
    v_fma_f32 v191, -v7, v173, v191
    v_cvt_pk_bf16_f32 v192, v128, v130
    v_cvt_pk_bf16_f32 v193, v132, v134
    v_cvt_pk_bf16_f32 v194, v136, v138
    v_cvt_pk_bf16_f32 v195, v140, v142
    ds_write_b128 v120, v[192:195] offset:0
    v_cvt_pk_bf16_f32 v196, v160, v162
    v_cvt_pk_bf16_f32 v197, v164, v166
    v_cvt_pk_bf16_f32 v198, v168, v170
    v_cvt_pk_bf16_f32 v199, v172, v174
    ds_write_b128 v121, v[196:199] offset:0
    v_cvt_pk_bf16_f32 v200, v129, v131
    v_cvt_pk_bf16_f32 v201, v133, v135
    v_cvt_pk_bf16_f32 v202, v137, v139
    v_cvt_pk_bf16_f32 v203, v141, v143
    ds_write_b128 v122, v[200:203] offset:0
    v_cvt_pk_bf16_f32 v204, v161, v163
    v_cvt_pk_bf16_f32 v205, v165, v167
    v_cvt_pk_bf16_f32 v206, v169, v171
    v_cvt_pk_bf16_f32 v207, v173, v175
    ds_write_b128 v123, v[204:207] offset:0
    v_cvt_pk_bf16_f32 v208, v144, v146
    v_cvt_pk_bf16_f32 v209, v148, v150
    v_cvt_pk_bf16_f32 v210, v152, v154
    v_cvt_pk_bf16_f32 v211, v156, v158
    ds_write_b128 v120, v[208:211] offset:4096
    v_cvt_pk_bf16_f32 v212, v176, v178
    v_cvt_pk_bf16_f32 v213, v180, v182
    v_cvt_pk_bf16_f32 v214, v184, v186
    v_cvt_pk_bf16_f32 v215, v188, v190
    ds_write_b128 v121, v[212:215] offset:4096
    v_cvt_pk_bf16_f32 v216, v145, v147
    v_cvt_pk_bf16_f32 v217, v149, v151
    v_cvt_pk_bf16_f32 v218, v153, v155
    v_cvt_pk_bf16_f32 v219, v157, v159
    ds_write_b128 v122, v[216:219] offset:4096
    v_cvt_pk_bf16_f32 v220, v177, v179
    v_cvt_pk_bf16_f32 v221, v181, v183
    v_cvt_pk_bf16_f32 v222, v185, v187
    v_cvt_pk_bf16_f32 v223, v189, v191
    ds_write_b128 v123, v[220:223] offset:4096
    s_lshl_b32 s10, s12, 18
    s_lshl_b32 s11, s7, 13
    s_add_u32 s10, s10, s11
    s_lshl_b32 s11, s9, 11
    s_add_u32 s10, s10, s11
    s_add_u32 s11, s10, 131072
    v_mov_b32 v22, 17
    s_waitcnt lgkmcnt(0)
    ds_read_b64_tr_b16 v[160:161], v124 offset:0
    ds_read_b64_tr_b16 v[162:163], v126 offset:512
    ds_read_b64_tr_b16 v[164:165], v126 offset:0
    ds_read_b64_tr_b16 v[166:167], v124 offset:512
    ds_read_b64_tr_b16 v[168:169], v125 offset:0
    ds_read_b64_tr_b16 v[170:171], v127 offset:512
    ds_read_b64_tr_b16 v[172:173], v127 offset:0
    ds_read_b64_tr_b16 v[174:175], v125 offset:512
    ds_read_b64_tr_b16 v[176:177], v124 offset:4096
    ds_read_b64_tr_b16 v[178:179], v126 offset:4608
    ds_read_b64_tr_b16 v[180:181], v126 offset:4096
    ds_read_b64_tr_b16 v[182:183], v124 offset:4608
    ds_read_b64_tr_b16 v[184:185], v125 offset:4096
    ds_read_b64_tr_b16 v[186:187], v127 offset:4608
    ds_read_b64_tr_b16 v[188:189], v127 offset:4096
    ds_read_b64_tr_b16 v[190:191], v125 offset:4608
    s_waitcnt lgkmcnt(14)
    buffer_store_dwordx4 v[160:163], v26, s[68:71], s10 offen offset:0 sc1
    s_waitcnt lgkmcnt(12)
    buffer_store_dwordx4 v[164:167], v26, s[68:71], s10 offen offset:1024 sc1
    s_waitcnt lgkmcnt(10)
    buffer_store_dwordx4 v[168:171], v26, s[68:71], s11 offen offset:0 sc1
    s_waitcnt lgkmcnt(8)
    buffer_store_dwordx4 v[172:175], v26, s[68:71], s11 offen offset:1024 sc1
    s_waitcnt lgkmcnt(6)
    buffer_store_dwordx4 v[176:179], v27, s[68:71], s10 offen offset:0 sc1
    s_waitcnt lgkmcnt(4)
    buffer_store_dwordx4 v[180:183], v27, s[68:71], s10 offen offset:1024 sc1
    s_waitcnt lgkmcnt(2)
    buffer_store_dwordx4 v[184:187], v27, s[68:71], s11 offen offset:0 sc1
    s_waitcnt lgkmcnt(0)
    buffer_store_dwordx4 v[188:191], v27, s[68:71], s11 offen offset:1024 sc1
    ds_write_b32 v10, v22
    v_and_b32 v112, 15, v2
    v_lshrrev_b32 v113, 1, v112
    v_lshrrev_b32 v114, 4, v2
    v_xor_b32 v113, v113, v114
    v_lshlrev_b32 v113, 4, v113
    v_lshl_add_u32 v6, v112, 7, v113
    v_xor_b32 v7, 64, v6
    v_add_u32 v8, 65536, v6
    v_add_u32 v9, 65536, v7
    v_add_u32 v0, s22, v26
    v_add_u32 v1, 65536, v0
    s_lshl_b32 s10, s6, 11
    s_add_u32 s10, s10, 32768
    s_lshl_b32 s11, s7, 7
    s_add_u32 s11, s11, s10
    v_lshl_add_u32 v5, v112, 7, s10
    v_cmp_ne_u32 s[20:21], s7, v112
    v_lshlrev_b32 v116, 16, v24
    v_and_b32 v117, 0xffff0000, v24
    v_lshlrev_b32 v118, 16, v25
    v_and_b32 v119, 0xffff0000, v25
    v_add_u32 v26, s16, v26
    v_add_u32 v27, s16, v27
    s_waitcnt vmcnt(16)
    v_lshlrev_b32 v192, 16, v80
    v_and_b32 v193, 0xffff0000, v80
    v_lshlrev_b32 v194, 16, v81
    v_and_b32 v195, 0xffff0000, v81
    v_lshlrev_b32 v196, 16, v82
    v_and_b32 v197, 0xffff0000, v82
    v_lshlrev_b32 v198, 16, v83
    v_and_b32 v199, 0xffff0000, v83
    v_lshlrev_b32 v200, 16, v84
    v_and_b32 v201, 0xffff0000, v84
    v_lshlrev_b32 v202, 16, v85
    v_and_b32 v203, 0xffff0000, v85
    v_lshlrev_b32 v204, 16, v86
    v_and_b32 v205, 0xffff0000, v86
    v_lshlrev_b32 v206, 16, v87
    v_and_b32 v207, 0xffff0000, v87
    v_lshlrev_b32 v208, 16, v88
    v_and_b32 v209, 0xffff0000, v88
    v_lshlrev_b32 v210, 16, v89
    v_and_b32 v211, 0xffff0000, v89
    v_lshlrev_b32 v212, 16, v90
    v_and_b32 v213, 0xffff0000, v90
    v_lshlrev_b32 v214, 16, v91
    v_and_b32 v215, 0xffff0000, v91
    v_lshlrev_b32 v216, 16, v92
    v_and_b32 v217, 0xffff0000, v92
    v_lshlrev_b32 v218, 16, v93
    v_and_b32 v219, 0xffff0000, v93
    v_lshlrev_b32 v220, 16, v94
    v_and_b32 v221, 0xffff0000, v94
    v_lshlrev_b32 v222, 16, v95
    v_and_b32 v223, 0xffff0000, v95
    v_mul_f32 v64, v192, v116
    v_mul_f32 v72, v193, v117
    v_mul_f32 v80, v194, v118
    v_mul_f32 v88, v195, v119
    v_mul_f32 v65, v196, v116
    v_mul_f32 v73, v197, v117
    v_mul_f32 v81, v198, v118
    v_mul_f32 v89, v199, v119
    v_mul_f32 v66, v200, v116
    v_mul_f32 v74, v201, v117
    v_mul_f32 v82, v202, v118
    v_mul_f32 v90, v203, v119
    v_mul_f32 v67, v204, v116
    v_mul_f32 v75, v205, v117
    v_mul_f32 v83, v206, v118
    v_mul_f32 v91, v207, v119
    v_mul_f32 v68, v208, v116
    v_mul_f32 v76, v209, v117
    v_mul_f32 v84, v210, v118
    v_mul_f32 v92, v211, v119
    v_mul_f32 v69, v212, v116
    v_mul_f32 v77, v213, v117
    v_mul_f32 v85, v214, v118
    v_mul_f32 v93, v215, v119
    v_mul_f32 v70, v216, v116
    v_mul_f32 v78, v217, v117
    v_mul_f32 v86, v218, v118
    v_mul_f32 v94, v219, v119
    v_mul_f32 v71, v220, v116
    v_mul_f32 v79, v221, v117
    v_mul_f32 v87, v222, v118
    v_mul_f32 v95, v223, v119
    s_mov_b32 s15, 0
G_all17_w:
    ds_read_b128 v[12:15], v11 offset:0
    s_waitcnt lgkmcnt(0)
    v_min3_u32 v12, v12, v13, v14
    v_min_u32 v12, v12, v15
    v_cmp_gt_u32 vcc, 17, v12
    s_cbranch_vccz G_all17_ok
    s_add_u32 s15, s15, 1
    s_cmp_lt_u32 s15, 160000
    s_cbranch_scc1 G_all17_w
G_all17_ok:
    ds_read_b64_tr_b16 v[128:129], v20 offset:0
    ds_read_b64_tr_b16 v[130:131], v21 offset:512
    ds_read_b64_tr_b16 v[132:133], v21 offset:0
    ds_read_b64_tr_b16 v[134:135], v20 offset:512
    ds_read_b64_tr_b16 v[136:137], v20 offset:8192
    ds_read_b64_tr_b16 v[138:139], v21 offset:8704
    ds_read_b64_tr_b16 v[140:141], v21 offset:8192
    ds_read_b64_tr_b16 v[142:143], v20 offset:8704
    ds_read_b64_tr_b16 v[144:145], v20 offset:4096
    ds_read_b64_tr_b16 v[146:147], v21 offset:4608
    ds_read_b64_tr_b16 v[148:149], v21 offset:4096
    ds_read_b64_tr_b16 v[150:151], v20 offset:4608
    ds_read_b64_tr_b16 v[152:153], v20 offset:12288
    ds_read_b64_tr_b16 v[154:155], v21 offset:12800
    ds_read_b64_tr_b16 v[156:157], v21 offset:12288
    ds_read_b64_tr_b16 v[158:159], v20 offset:12800
    v_mov_b32 v18, 1
    s_waitcnt vmcnt(0)
    s_mov_b64 exec, 1
    ds_add_rtn_u32 v18, v11, v18 offset:52
    s_waitcnt lgkmcnt(0)
    v_readfirstlane_b32 s14, v18
    s_cmp_eq_u32 s14, 3
    s_cbranch_scc0 G_nl
    buffer_store_dwordx2 v[30:31], v23, s[72:75], s11 offen sc1
    s_mov_b64 exec, -1
G_nl:
    s_mov_b64 exec, -1
    s_mov_b32 s15, 0
G_f0_w:
    ds_read_b32 v18, v11 offset:60
    s_waitcnt lgkmcnt(0)
    v_cmp_gt_u32 vcc, 4, v18
    s_cbranch_vccz G_f0_ok
    s_sleep 1
    s_add_u32 s15, s15, 1
    s_cmp_lt_u32 s15, 160000
    s_cbranch_scc1 G_f0_w
G_f0_ok:
    ds_read_b128 v[192:195], v6 offset:0
    ds_read_b128 v[196:199], v6 offset:2048
    ds_read_b128 v[200:203], v6 offset:4096
    ds_read_b128 v[204:207], v6 offset:6144
    ds_read_b128 v[208:211], v7 offset:0
    ds_read_b128 v[212:215], v7 offset:2048
    ds_read_b128 v[216:219], v7 offset:4096
    s_waitcnt lgkmcnt(6)
    v_mfma_f32_16x16x32_bf16 v[64:67], v[128:131], v[192:195], v[64:67]
    ds_read_b128 v[220:223], v7 offset:6144
    v_mfma_f32_16x16x32_bf16 v[68:71], v[132:135], v[192:195], v[68:71]
    s_bfe_u32 s18, s101, 4 + (4 << 16)
    s_lshl_b32 s18, s18, 7
    buffer_load_dwordx4 v[48:51], v16, s[80:83], s18 offen offset:0
    s_waitcnt lgkmcnt(6)
    v_mfma_f32_16x16x32_bf16 v[72:75], v[128:131], v[196:199], v[72:75]
    ds_read_b128 v[192:195], v6 offset:8192
    v_mfma_f32_16x16x32_bf16 v[76:79], v[132:135], v[196:199], v[76:79]
    s_waitcnt lgkmcnt(6)
    v_mfma_f32_16x16x32_bf16 v[80:83], v[128:131], v[200:203], v[80:83]
    ds_read_b128 v[196:199], v6 offset:10240
    v_mfma_f32_16x16x32_bf16 v[84:87], v[132:135], v[200:203], v[84:87]
    buffer_load_dwordx4 v[52:55], v17, s[80:83], s18 offen offset:1024
    s_waitcnt lgkmcnt(6)
    v_mfma_f32_16x16x32_bf16 v[88:91], v[128:131], v[204:207], v[88:91]
    ds_read_b128 v[200:203], v6 offset:12288
    v_mfma_f32_16x16x32_bf16 v[92:95], v[132:135], v[204:207], v[92:95]
    s_waitcnt lgkmcnt(6)
    v_mfma_f32_16x16x32_bf16 v[64:67], v[136:139], v[208:211], v[64:67]
    ds_read_b128 v[204:207], v6 offset:14336
    v_mfma_f32_16x16x32_bf16 v[68:71], v[140:143], v[208:211], v[68:71]
    buffer_load_dwordx4 v[56:59], v16, s[80:83], s18 offen offset:2048
    s_waitcnt lgkmcnt(6)
    v_mfma_f32_16x16x32_bf16 v[72:75], v[136:139], v[212:215], v[72:75]
    ds_read_b128 v[208:211], v7 offset:8192
    v_mfma_f32_16x16x32_bf16 v[76:79], v[140:143], v[212:215], v[76:79]
    s_waitcnt lgkmcnt(6)
    v_mfma_f32_16x16x32_bf16 v[80:83], v[136:139], v[216:219], v[80:83]
    ds_read_b128 v[212:215], v7 offset:10240
    v_mfma_f32_16x16x32_bf16 v[84:87], v[140:143], v[216:219], v[84:87]
    buffer_load_dwordx4 v[60:63], v17, s[80:83], s18 offen offset:3072
    s_waitcnt lgkmcnt(6)
    v_mfma_f32_16x16x32_bf16 v[88:91], v[136:139], v[220:223], v[88:91]
    ds_read_b128 v[216:219], v7 offset:12288
    v_mfma_f32_16x16x32_bf16 v[92:95], v[140:143], v[220:223], v[92:95]
    s_waitcnt lgkmcnt(6)
    v_mfma_f32_16x16x32_bf16 v[64:67], v[144:147], v[192:195], v[64:67]
    ds_read_b128 v[220:223], v7 offset:14336
    v_mfma_f32_16x16x32_bf16 v[68:71], v[148:151], v[192:195], v[68:71]
    s_bfe_u32 s18, s101, 8 + (4 << 16)
    s_lshl_b32 s18, s18, 7
    buffer_load_dwordx4 v[32:35], v16, s[80:83], s18 offen offset:0
    s_waitcnt lgkmcnt(6)
    v_mfma_f32_16x16x32_bf16 v[72:75], v[144:147], v[196:199], v[72:75]
    ds_read_b128 v[192:195], v6 offset:16384
    v_mfma_f32_16x16x32_bf16 v[76:79], v[148:151], v[196:199], v[76:79]
    s_waitcnt lgkmcnt(6)
    v_mfma_f32_16x16x32_bf16 v[80:83], v[144:147], v[200:203], v[80:83]
    ds_read_b128 v[196:199], v6 offset:18432
    v_mfma_f32_16x16x32_bf16 v[84:87], v[148:151], v[200:203], v[84:87]
    buffer_load_dwordx4 v[36:39], v17, s[80:83], s18 offen offset:1024
    s_waitcnt lgkmcnt(6)
    v_mfma_f32_16x16x32_bf16 v[88:91], v[144:147], v[204:207], v[88:91]
    ds_read_b128 v[200:203], v6 offset:20480
    v_mfma_f32_16x16x32_bf16 v[92:95], v[148:151], v[204:207], v[92:95]
    s_waitcnt lgkmcnt(6)
    v_mfma_f32_16x16x32_bf16 v[64:67], v[152:155], v[208:211], v[64:67]
    ds_read_b128 v[204:207], v6 offset:22528
    v_mfma_f32_16x16x32_bf16 v[68:71], v[156:159], v[208:211], v[68:71]
    buffer_load_dwordx4 v[40:43], v16, s[80:83], s18 offen offset:2048
    s_waitcnt lgkmcnt(6)
    v_mfma_f32_16x16x32_bf16 v[72:75], v[152:155], v[212:215], v[72:75]
    ds_read_b128 v[208:211], v7 offset:16384
    v_mfma_f32_16x16x32_bf16 v[76:79], v[156:159], v[212:215], v[76:79]
    s_waitcnt lgkmcnt(6)
    v_mfma_f32_16x16x32_bf16 v[80:83], v[152:155], v[216:219], v[80:83]
    ds_read_b128 v[212:215], v7 offset:18432
    v_mfma_f32_16x16x32_bf16 v[84:87], v[156:159], v[216:219], v[84:87]
    buffer_load_dwordx4 v[44:47], v17, s[80:83], s18 offen offset:3072
    s_waitcnt lgkmcnt(6)
    v_mfma_f32_16x16x32_bf16 v[88:91], v[152:155], v[220:223], v[88:91]
    ds_read_b128 v[216:219], v7 offset:20480
    v_mfma_f32_16x16x32_bf16 v[92:95], v[156:159], v[220:223], v[92:95]
    v_mov_b32 v22, 18
    ds_write_b32 v10, v22
    s_bfe_u32 s18, s101, 12 + (4 << 16)
    s_lshl_b32 s18, s18, 7
    buffer_load_dwordx4 v[96:99], v16, s[80:83], s18 offen offset:0
    buffer_load_dwordx4 v[100:103], v17, s[80:83], s18 offen offset:1024
    buffer_load_dwordx4 v[104:107], v16, s[80:83], s18 offen offset:2048
    buffer_load_dwordx4 v[108:111], v17, s[80:83], s18 offen offset:3072
    s_bfe_u32 s18, s101, 16 + (4 << 16)
    s_lshl_b32 s18, s18, 7
    buffer_load_dwordx4 v[112:115], v16, s[80:83], s18 offen offset:0
    buffer_load_dwordx4 v[116:119], v17, s[80:83], s18 offen offset:1024
    buffer_load_dwordx4 v[120:123], v16, s[80:83], s18 offen offset:2048
    buffer_load_dwordx4 v[124:127], v17, s[80:83], s18 offen offset:3072
    s_mov_b32 s15, 0
G_all18_w:
    ds_read_b128 v[12:15], v11 offset:0
    s_waitcnt lgkmcnt(0)
    v_min3_u32 v12, v12, v13, v14
    v_min_u32 v12, v12, v15
    v_cmp_gt_u32 vcc, 18, v12
    s_cbranch_vccz G_all18_ok
    s_add_u32 s15, s15, 1
    s_cmp_lt_u32 s15, 160000
    s_cbranch_scc1 G_all18_w
G_all18_ok:
    s_cmp_eq_u32 s14, 3
    s_cbranch_scc0 G_pl
    buffer_load_dwordx2 v[28:29], v5, s[72:75], 0 offen sc1
G_pl:
    s_bfe_u32 s18, s100, 16 + (4 << 16)
    s_lshl_b32 s18, s18, 7
    s_add_u32 m0, s22, 65536
    s_nop 0
    buffer_load_dwordx4 v16, s[80:83], s18 offen offset:0 lds
    buffer_load_dwordx4 v17, s[80:83], s18 offen offset:1024 lds
    buffer_load_dwordx4 v16, s[80:83], s18 offen offset:2048 lds
    buffer_load_dwordx4 v17, s[80:83], s18 offen offset:3072 lds
    s_bfe_u32 s18, s100, 20 + (4 << 16)
    s_lshl_b32 s18, s18, 7
    s_add_u32 m0, s22, 81920
    s_nop 0
    buffer_load_dwordx4 v16, s[80:83], s18 offen offset:0 lds
    buffer_load_dwordx4 v17, s[80:83], s18 offen offset:1024 lds
    buffer_load_dwordx4 v16, s[80:83], s18 offen offset:2048 lds
    buffer_load_dwordx4 v17, s[80:83], s18 offen offset:3072 lds
    s_bfe_u32 s18, s100, 24 + (4 << 16)
    s_lshl_b32 s18, s18, 7
    s_add_u32 m0, s22, 0
    s_nop 0
    buffer_load_dwordx4 v16, s[80:83], s18 offen offset:0 lds
    buffer_load_dwordx4 v17, s[80:83], s18 offen offset:1024 lds
    buffer_load_dwordx4 v16, s[80:83], s18 offen offset:2048 lds
    buffer_load_dwordx4 v17, s[80:83], s18 offen offset:3072 lds
    s_mov_b32 s15, 0
    s_cmp_eq_u32 s14, 3
    s_cbranch_scc0 G_np
    s_waitcnt vmcnt(12)
GH_chk:
    v_cmp_ne_u64 vcc, v[28:29], v[30:31]
    s_and_b64 vcc, vcc, s[20:21]
    s_cbranch_scc0 GH_ok
    buffer_load_dwordx2 v[28:29], v5, s[72:75], 0 offen sc1
    s_add_u32 s15, s15, 1
    s_cmp_lt_u32 s15, 20000
    s_waitcnt vmcnt(0)
    s_cbranch_scc1 GH_chk
GH_ok:
    ds_write_b32 v11, v22 offset:56
    s_branch G_go
G_np:
    s_mov_b32 s15, 0
G_fho_w:
    ds_read_b32 v18, v11 offset:56
    s_waitcnt lgkmcnt(0)
    v_cmp_gt_u32 vcc, 1, v18
    s_cbranch_vccz G_fho_ok
    s_sleep 1
    s_add_u32 s15, s15, 1
    s_cmp_lt_u32 s15, 160000
    s_cbranch_scc1 G_fho_w
G_fho_ok:
G_go:
    s_bfe_u32 s19, s100, 4 + (4 << 16)
    s_lshl_b32 s19, s19, 13
    buffer_load_dwordx4 v[160:163], v26, s[68:71], s19 offen offset:0 sc1
    buffer_load_dwordx4 v[164:167], v26, s[68:71], s19 offen offset:1024 sc1
    buffer_load_dwordx4 v[168:171], v26, s[68:71], s19 offen offset:2048 sc1
    buffer_load_dwordx4 v[172:175], v26, s[68:71], s19 offen offset:3072 sc1
    buffer_load_dwordx4 v[176:179], v27, s[68:71], s19 offen offset:0 sc1
    buffer_load_dwordx4 v[180:183], v27, s[68:71], s19 offen offset:1024 sc1
    buffer_load_dwordx4 v[184:187], v27, s[68:71], s19 offen offset:2048 sc1
    buffer_load_dwordx4 v[188:191], v27, s[68:71], s19 offen offset:3072 sc1
    s_bfe_u32 s19, s100, 8 + (4 << 16)
    s_lshl_b32 s19, s19, 13
    buffer_load_dwordx4 v[128:131], v26, s[68:71], s19 offen offset:0 sc1
    buffer_load_dwordx4 v[132:135], v26, s[68:71], s19 offen offset:1024 sc1
    buffer_load_dwordx4 v[136:139], v26, s[68:71], s19 offen offset:2048 sc1
    buffer_load_dwordx4 v[140:143], v26, s[68:71], s19 offen offset:3072 sc1
    buffer_load_dwordx4 v[144:147], v27, s[68:71], s19 offen offset:0 sc1
    buffer_load_dwordx4 v[148:151], v27, s[68:71], s19 offen offset:1024 sc1
    buffer_load_dwordx4 v[152:155], v27, s[68:71], s19 offen offset:2048 sc1
    buffer_load_dwordx4 v[156:159], v27, s[68:71], s19 offen offset:3072 sc1
    s_setprio 1
    s_waitcnt vmcnt(14)
    v_mfma_f32_16x16x32_bf16 v[64:67], v[160:163], v[192:195], v[64:67]
    ds_read_b128 v[220:223], v7 offset:22528
    v_mov_b32 v22, 19
    v_mfma_f32_16x16x32_bf16 v[68:71], v[164:167], v[192:195], v[68:71]
    v_mfma_f32_16x16x32_bf16 v[72:75], v[160:163], v[196:199], v[72:75]
    ds_read_b128 v[192:195], v6 offset:24576
    v_mfma_f32_16x16x32_bf16 v[76:79], v[164:167], v[196:199], v[76:79]
    ds_write_b32 v10, v22
    v_mfma_f32_16x16x32_bf16 v[80:83], v[160:163], v[200:203], v[80:83]
    ds_read_b128 v[196:199], v6 offset:26624
    v_mfma_f32_16x16x32_bf16 v[84:87], v[164:167], v[200:203], v[84:87]
    v_mfma_f32_16x16x32_bf16 v[88:91], v[160:163], v[204:207], v[88:91]
    ds_read_b128 v[200:203], v6 offset:28672
    s_bfe_u32 s19, s100, 12 + (4 << 16)
    v_mfma_f32_16x16x32_bf16 v[92:95], v[164:167], v[204:207], v[92:95]
    s_lshl_b32 s19, s19, 13
    s_waitcnt vmcnt(12)
    v_mfma_f32_16x16x32_bf16 v[64:67], v[168:171], v[208:211], v[64:67]
    ds_read_b128 v[204:207], v6 offset:30720
    v_mfma_f32_16x16x32_bf16 v[68:71], v[172:175], v[208:211], v[68:71]
    buffer_load_dwordx4 v[160:163], v26, s[68:71], s19 offen offset:0 sc1
    v_mfma_f32_16x16x32_bf16 v[72:75], v[168:171], v[212:215], v[72:75]
    ds_read_b128 v[208:211], v7 offset:24576
    v_mfma_f32_16x16x32_bf16 v[76:79], v[172:175], v[212:215], v[76:79]
    v_mfma_f32_16x16x32_bf16 v[80:83], v[168:171], v[216:219], v[80:83]
    ds_read_b128 v[212:215], v7 offset:26624
    v_mfma_f32_16x16x32_bf16 v[84:87], v[172:175], v[216:219], v[84:87]
    buffer_load_dwordx4 v[164:167], v26, s[68:71], s19 offen offset:1024 sc1
    s_waitcnt lgkmcnt(7)
    v_mfma_f32_16x16x32_bf16 v[88:91], v[168:171], v[220:223], v[88:91]
    ds_read_b128 v[216:219], v7 offset:28672
    v_mfma_f32_16x16x32_bf16 v[92:95], v[172:175], v[220:223], v[92:95]
    s_waitcnt vmcnt(12) lgkmcnt(7)
    v_mfma_f32_16x16x32_bf16 v[64:67], v[176:179], v[192:195], v[64:67]
    ds_read_b128 v[220:223], v7 offset:30720
    v_mfma_f32_16x16x32_bf16 v[68:71], v[180:183], v[192:195], v[68:71]
    buffer_load_dwordx4 v[168:171], v26, s[68:71], s19 offen offset:2048 sc1
    s_waitcnt lgkmcnt(6)
    v_mfma_f32_16x16x32_bf16 v[72:75], v[176:179], v[196:199], v[72:75]
    ds_read_b128 v[192:195], v6 offset:32768
    v_mfma_f32_16x16x32_bf16 v[76:79], v[180:183], v[196:199], v[76:79]
    s_waitcnt lgkmcnt(6)
    v_mfma_f32_16x16x32_bf16 v[80:83], v[176:179], v[200:203], v[80:83]
    ds_read_b128 v[196:199], v6 offset:34816
    v_mfma_f32_16x16x32_bf16 v[84:87], v[180:183], v[200:203], v[84:87]
    buffer_load_dwordx4 v[172:175], v26, s[68:71], s19 offen offset:3072 sc1
    s_waitcnt lgkmcnt(6)
    v_mfma_f32_16x16x32_bf16 v[88:91], v[176:179], v[204:207], v[88:91]
    ds_read_b128 v[200:203], v6 offset:36864
    v_mfma_f32_16x16x32_bf16 v[92:95], v[180:183], v[204:207], v[92:95]
    s_waitcnt vmcnt(12) lgkmcnt(6)
    v_mfma_f32_16x16x32_bf16 v[64:67], v[184:187], v[208:211], v[64:67]
    ds_read_b128 v[204:207], v6 offset:38912
    v_mfma_f32_16x16x32_bf16 v[68:71], v[188:191], v[208:211], v[68:71]
    buffer_load_dwordx4 v[176:179], v27, s[68:71], s19 offen offset:0 sc1
    s_waitcnt lgkmcnt(6)
    v_mfma_f32_16x16x32_bf16 v[72:75], v[184:187], v[212:215], v[72:75]
    ds_read_b128 v[208:211], v7 offset:32768
    v_mfma_f32_16x16x32_bf16 v[76:79], v[188:191], v[212:215], v[76:79]
    s_waitcnt lgkmcnt(6)
    v_mfma_f32_16x16x32_bf16 v[80:83], v[184:187], v[216:219], v[80:83]
    ds_read_b128 v[212:215], v7 offset:34816
    v_mfma_f32_16x16x32_bf16 v[84:87], v[188:191], v[216:219], v[84:87]
    buffer_load_dwordx4 v[180:183], v27, s[68:71], s19 offen offset:1024 sc1
    s_waitcnt lgkmcnt(6)
    v_mfma_f32_16x16x32_bf16 v[88:91], v[184:187], v[220:223], v[88:91]
    ds_read_b128 v[216:219], v7 offset:36864
    v_mfma_f32_16x16x32_bf16 v[92:95], v[188:191], v[220:223], v[92:95]
    s_waitcnt vmcnt(12) lgkmcnt(6)
    v_mfma_f32_16x16x32_bf16 v[64:67], v[128:131], v[192:195], v[64:67]
    ds_read_b128 v[220:223], v7 offset:38912
    v_mov_b32 v22, 20
    v_mfma_f32_16x16x32_bf16 v[68:71], v[132:135], v[192:195], v[68:71]
    buffer_load_dwordx4 v[184:187], v27, s[68:71], s19 offen offset:2048 sc1
    s_waitcnt lgkmcnt(6)
    v_mfma_f32_16x16x32_bf16 v[72:75], v[128:131], v[196:199], v[72:75]
    ds_read_b128 v[192:195], v6 offset:40960
    v_mfma_f32_16x16x32_bf16 v[76:79], v[132:135], v[196:199], v[76:79]
    ds_write_b32 v10, v22
    s_waitcnt lgkmcnt(7)
    v_mfma_f32_16x16x32_bf16 v[80:83], v[128:131], v[200:203], v[80:83]
    ds_read_b128 v[196:199], v6 offset:43008
    v_mfma_f32_16x16x32_bf16 v[84:87], v[132:135], v[200:203], v[84:87]
    buffer_load_dwordx4 v[188:191], v27, s[68:71], s19 offen offset:3072 sc1
    s_waitcnt lgkmcnt(7)
    v_mfma_f32_16x16x32_bf16 v[88:91], v[128:131], v[204:207], v[88:91]
    ds_read_b128 v[200:203], v6 offset:45056
    s_bfe_u32 s19, s100, 16 + (4 << 16)
    v_mfma_f32_16x16x32_bf16 v[92:95], v[132:135], v[204:207], v[92:95]
    s_lshl_b32 s19, s19, 13
    s_waitcnt vmcnt(12) lgkmcnt(7)
    v_mfma_f32_16x16x32_bf16 v[64:67], v[136:139], v[208:211], v[64:67]
    ds_read_b128 v[204:207], v6 offset:47104
    v_mfma_f32_16x16x32_bf16 v[68:71], v[140:143], v[208:211], v[68:71]
    buffer_load_dwordx4 v[128:131], v26, s[68:71], s19 offen offset:0 sc1
    s_waitcnt lgkmcnt(7)
    v_mfma_f32_16x16x32_bf16 v[72:75], v[136:139], v[212:215], v[72:75]
    ds_read_b128 v[208:211], v7 offset:40960
    v_mfma_f32_16x16x32_bf16 v[76:79], v[140:143], v[212:215], v[76:79]
    s_waitcnt lgkmcnt(7)
    v_mfma_f32_16x16x32_bf16 v[80:83], v[136:139], v[216:219], v[80:83]
    ds_read_b128 v[212:215], v7 offset:43008
    v_mfma_f32_16x16x32_bf16 v[84:87], v[140:143], v[216:219], v[84:87]
    buffer_load_dwordx4 v[132:135], v26, s[68:71], s19 offen offset:1024 sc1
    s_waitcnt lgkmcnt(7)
    v_mfma_f32_16x16x32_bf16 v[88:91], v[136:139], v[220:223], v[88:91]
    ds_read_b128 v[216:219], v7 offset:45056
    v_mfma_f32_16x16x32_bf16 v[92:95], v[140:143], v[220:223], v[92:95]
    s_waitcnt vmcnt(12) lgkmcnt(7)
    v_mfma_f32_16x16x32_bf16 v[64:67], v[144:147], v[192:195], v[64:67]
    ds_read_b128 v[220:223], v7 offset:47104
    v_mfma_f32_16x16x32_bf16 v[68:71], v[148:151], v[192:195], v[68:71]
    buffer_load_dwordx4 v[136:139], v26, s[68:71], s19 offen offset:2048 sc1
    s_waitcnt lgkmcnt(6)
    v_mfma_f32_16x16x32_bf16 v[72:75], v[144:147], v[196:199], v[72:75]
    ds_read_b128 v[192:195], v6 offset:49152
    v_mfma_f32_16x16x32_bf16 v[76:79], v[148:151], v[196:199], v[76:79]
    s_waitcnt lgkmcnt(6)
    v_mfma_f32_16x16x32_bf16 v[80:83], v[144:147], v[200:203], v[80:83]
    ds_read_b128 v[196:199], v6 offset:51200
    ds_read_b128 v[12:15], v11
    v_mfma_f32_16x16x32_bf16 v[84:87], v[148:151], v[200:203], v[84:87]
    buffer_load_dwordx4 v[140:143], v26, s[68:71], s19 offen offset:3072 sc1
    s_waitcnt lgkmcnt(7)
    v_mfma_f32_16x16x32_bf16 v[88:91], v[144:147], v[204:207], v[88:91]
    ds_read_b128 v[200:203], v6 offset:53248
    v_mfma_f32_16x16x32_bf16 v[92:95], v[148:151], v[204:207], v[92:95]
    s_waitcnt vmcnt(12) lgkmcnt(7)
    v_mfma_f32_16x16x32_bf16 v[64:67], v[152:155], v[208:211], v[64:67]
    ds_read_b128 v[204:207], v6 offset:55296
    v_mfma_f32_16x16x32_bf16 v[68:71], v[156:159], v[208:211], v[68:71]
    buffer_load_dwordx4 v[144:147], v27, s[68:71], s19 offen offset:0 sc1
    s_waitcnt lgkmcnt(7)
    v_mfma_f32_16x16x32_bf16 v[72:75], v[152:155], v[212:215], v[72:75]
    ds_read_b128 v[208:211], v7 offset:49152
    v_mfma_f32_16x16x32_bf16 v[76:79], v[156:159], v[212:215], v[76:79]
    s_waitcnt lgkmcnt(7)
    v_mfma_f32_16x16x32_bf16 v[80:83], v[152:155], v[216:219], v[80:83]
    ds_read_b128 v[212:215], v7 offset:51200
    v_mfma_f32_16x16x32_bf16 v[84:87], v[156:159], v[216:219], v[84:87]
    buffer_load_dwordx4 v[148:151], v27, s[68:71], s19 offen offset:1024 sc1
    s_waitcnt lgkmcnt(7)
    v_mfma_f32_16x16x32_bf16 v[88:91], v[152:155], v[220:223], v[88:91]
    ds_read_b128 v[216:219], v7 offset:53248
    v_mfma_f32_16x16x32_bf16 v[92:95], v[156:159], v[220:223], v[92:95]
    s_waitcnt vmcnt(12) lgkmcnt(7)
    v_mfma_f32_16x16x32_bf16 v[64:67], v[160:163], v[192:195], v[64:67]
    ds_read_b128 v[220:223], v7 offset:55296
    v_mov_b32 v22, 21
    v_mfma_f32_16x16x32_bf16 v[68:71], v[164:167], v[192:195], v[68:71]
    buffer_load_dwordx4 v[152:155], v27, s[68:71], s19 offen offset:2048 sc1
    s_waitcnt lgkmcnt(7)
    v_mfma_f32_16x16x32_bf16 v[72:75], v[160:163], v[196:199], v[72:75]
    ds_read_b128 v[192:195], v6 offset:57344
    s_waitcnt lgkmcnt(7)
    v_min3_u32 v12, v12, v13, v14
    v_mfma_f32_16x16x32_bf16 v[76:79], v[164:167], v[196:199], v[76:79]
    ds_write_b32 v10, v22
    s_waitcnt lgkmcnt(7)
    v_mfma_f32_16x16x32_bf16 v[80:83], v[160:163], v[200:203], v[80:83]
    ds_read_b128 v[196:199], v6 offset:59392
    v_min_u32 v12, v12, v15
    v_mfma_f32_16x16x32_bf16 v[84:87], v[164:167], v[200:203], v[84:87]
    buffer_load_dwordx4 v[156:159], v27, s[68:71], s19 offen offset:3072 sc1
    s_waitcnt lgkmcnt(7)
    v_mfma_f32_16x16x32_bf16 v[88:91], v[160:163], v[204:207], v[88:91]
    ds_read_b128 v[200:203], v6 offset:61440
    s_bfe_u32 s19, s100, 20 + (4 << 16)
    v_mfma_f32_16x16x32_bf16 v[92:95], v[164:167], v[204:207], v[92:95]
    s_lshl_b32 s19, s19, 13
    s_waitcnt vmcnt(12) lgkmcnt(7)
    v_mfma_f32_16x16x32_bf16 v[64:67], v[168:171], v[208:211], v[64:67]
    ds_read_b128 v[204:207], v6 offset:63488
    v_cmp_gt_u32 vcc, 20, v12
    v_mfma_f32_16x16x32_bf16 v[68:71], v[172:175], v[208:211], v[68:71]
    buffer_load_dwordx4 v[160:163], v26, s[68:71], s19 offen offset:0 sc1
    s_waitcnt lgkmcnt(7)
    v_mfma_f32_16x16x32_bf16 v[72:75], v[168:171], v[212:215], v[72:75]
    ds_read_b128 v[208:211], v7 offset:57344
    s_cbranch_vccnz G2_slow3
G2_back3:
    v_mfma_f32_16x16x32_bf16 v[76:79], v[172:175], v[212:215], v[76:79]
    ds_write_b64 v0, v[224:225] offset:16384
    s_waitcnt lgkmcnt(8)
    v_mfma_f32_16x16x32_bf16 v[80:83], v[168:171], v[216:219], v[80:83]
    ds_read_b128 v[212:215], v7 offset:59392
    v_mfma_f32_16x16x32_bf16 v[84:87], v[172:175], v[216:219], v[84:87]
    buffer_load_dwordx4 v[164:167], v26, s[68:71], s19 offen offset:1024 sc1
    s_waitcnt lgkmcnt(8)
    v_mfma_f32_16x16x32_bf16 v[88:91], v[168:171], v[220:223], v[88:91]
    ds_read_b128 v[216:219], v7 offset:61440
    v_mfma_f32_16x16x32_bf16 v[92:95], v[172:175], v[220:223], v[92:95]
    ds_write_b64 v0, v[226:227] offset:16392
    s_waitcnt vmcnt(12) lgkmcnt(9)
    v_mfma_f32_16x16x32_bf16 v[64:67], v[176:179], v[192:195], v[64:67]
    ds_read_b128 v[220:223], v7 offset:63488
    ds_write_b64 v0, v[228:229] offset:17408
    v_mfma_f32_16x16x32_bf16 v[68:71], v[180:183], v[192:195], v[68:71]
    buffer_load_dwordx4 v[168:171], v26, s[68:71], s19 offen offset:2048 sc1
    s_waitcnt lgkmcnt(9)
    v_mfma_f32_16x16x32_bf16 v[72:75], v[176:179], v[196:199], v[72:75]
    ds_read_b128 v[192:195], v8 offset:0
    v_mfma_f32_16x16x32_bf16 v[76:79], v[180:183], v[196:199], v[76:79]
    ds_write_b64 v0, v[230:231] offset:17416
    s_waitcnt lgkmcnt(10)
    v_mfma_f32_16x16x32_bf16 v[80:83], v[176:179], v[200:203], v[80:83]
    ds_read_b128 v[196:199], v8 offset:2048
    ds_read_b128 v[12:15], v11
    v_mfma_f32_16x16x32_bf16 v[84:87], v[180:183], v[200:203], v[84:87]
    buffer_load_dwordx4 v[172:175], v26, s[68:71], s19 offen offset:3072 sc1
    s_waitcnt lgkmcnt(11)
    v_mfma_f32_16x16x32_bf16 v[88:91], v[176:179], v[204:207], v[88:91]
    ds_read_b128 v[200:203], v8 offset:4096
    v_mfma_f32_16x16x32_bf16 v[92:95], v[180:183], v[204:207], v[92:95]
    ds_write_b64 v0, v[232:233] offset:18432
    s_waitcnt vmcnt(12) lgkmcnt(12)
    v_mfma_f32_16x16x32_bf16 v[64:67], v[184:187], v[208:211], v[64:67]
    ds_read_b128 v[204:207], v8 offset:6144
    ds_write_b64 v0, v[234:235] offset:18440
    v_mfma_f32_16x16x32_bf16 v[68:71], v[188:191], v[208:211], v[68:71]
    buffer_load_dwordx4 v[176:179], v27, s[68:71], s19 offen offset:0 sc1
    s_waitcnt lgkmcnt(12)
    v_mfma_f32_16x16x32_bf16 v[72:75], v[184:187], v[212:215], v[72:75]
    ds_read_b128 v[208:211], v9 offset:0
    v_mfma_f32_16x16x32_bf16 v[76:79], v[188:191], v[212:215], v[76:79]
    ds_write_b64 v0, v[236:237] offset:19456
    s_waitcnt lgkmcnt(13)
    v_mfma_f32_16x16x32_bf16 v[80:83], v[184:187], v[216:219], v[80:83]
    ds_read_b128 v[212:215], v9 offset:2048
    v_mfma_f32_16x16x32_bf16 v[84:87], v[188:191], v[216:219], v[84:87]
    buffer_load_dwordx4 v[180:183], v27, s[68:71], s19 offen offset:1024 sc1
    s_waitcnt lgkmcnt(12)
    v_mfma_f32_16x16x32_bf16 v[88:91], v[184:187], v[220:223], v[88:91]
    ds_read_b128 v[216:219], v9 offset:4096
    v_mfma_f32_16x16x32_bf16 v[92:95], v[188:191], v[220:223], v[92:95]
    ds_write_b64 v0, v[238:239] offset:19464
    s_waitcnt vmcnt(12) lgkmcnt(12)
    v_mfma_f32_16x16x32_bf16 v[64:67], v[128:131], v[192:195], v[64:67]
    ds_read_b128 v[220:223], v9 offset:6144
    v_mov_b32 v22, 22
    v_mfma_f32_16x16x32_bf16 v[68:71], v[132:135], v[192:195], v[68:71]
    buffer_load_dwordx4 v[184:187], v27, s[68:71], s19 offen offset:2048 sc1
    s_waitcnt lgkmcnt(11)
    v_mfma_f32_16x16x32_bf16 v[72:75], v[128:131], v[196:199], v[72:75]
    ds_read_b128 v[192:195], v8 offset:8192
    s_waitcnt lgkmcnt(11)
    v_min3_u32 v12, v12, v13, v14
    v_mfma_f32_16x16x32_bf16 v[76:79], v[132:135], v[196:199], v[76:79]
    ds_write_b32 v10, v22
    s_waitcnt lgkmcnt(11)
    v_mfma_f32_16x16x32_bf16 v[80:83], v[128:131], v[200:203], v[80:83]
    ds_read_b128 v[196:199], v8 offset:10240
    v_min_u32 v12, v12, v15
    v_mfma_f32_16x16x32_bf16 v[84:87], v[132:135], v[200:203], v[84:87]
    buffer_load_dwordx4 v[188:191], v27, s[68:71], s19 offen offset:3072 sc1
    s_waitcnt lgkmcnt(10)
    v_mfma_f32_16x16x32_bf16 v[88:91], v[128:131], v[204:207], v[88:91]
    ds_read_b128 v[200:203], v8 offset:12288
    s_bfe_u32 s19, s100, 24 + (4 << 16)
    v_mfma_f32_16x16x32_bf16 v[92:95], v[132:135], v[204:207], v[92:95]
    s_lshl_b32 s19, s19, 13
    s_waitcnt vmcnt(12) lgkmcnt(9)
    v_mfma_f32_16x16x32_bf16 v[64:67], v[136:139], v[208:211], v[64:67]
    ds_read_b128 v[204:207], v8 offset:14336
    v_cmp_gt_u32 vcc, 21, v12
    v_mfma_f32_16x16x32_bf16 v[68:71], v[140:143], v[208:211], v[68:71]
    buffer_load_dwordx4 v[128:131], v26, s[68:71], s19 offen offset:0 sc1
    s_waitcnt lgkmcnt(8)
    v_mfma_f32_16x16x32_bf16 v[72:75], v[136:139], v[212:215], v[72:75]
    ds_read_b128 v[208:211], v9 offset:8192
    s_cbranch_vccnz G2_slow4
G2_back4:
    v_mfma_f32_16x16x32_bf16 v[76:79], v[140:143], v[212:215], v[76:79]
    ds_write_b64 v0, v[240:241] offset:32768
    s_waitcnt lgkmcnt(9)
    v_mfma_f32_16x16x32_bf16 v[80:83], v[136:139], v[216:219], v[80:83]
    ds_read_b128 v[212:215], v9 offset:10240
    v_mfma_f32_16x16x32_bf16 v[84:87], v[140:143], v[216:219], v[84:87]
    buffer_load_dwordx4 v[132:135], v26, s[68:71], s19 offen offset:1024 sc1
    s_waitcnt lgkmcnt(8)
    v_mfma_f32_16x16x32_bf16 v[88:91], v[136:139], v[220:223], v[88:91]
    ds_read_b128 v[216:219], v9 offset:12288
    v_mfma_f32_16x16x32_bf16 v[92:95], v[140:143], v[220:223], v[92:95]
    ds_write_b64 v0, v[242:243] offset:32776
    s_waitcnt vmcnt(12) lgkmcnt(9)
    v_mfma_f32_16x16x32_bf16 v[64:67], v[144:147], v[192:195], v[64:67]
    ds_read_b128 v[220:223], v9 offset:14336
    ds_write_b64 v0, v[244:245] offset:33792
    v_mfma_f32_16x16x32_bf16 v[68:71], v[148:151], v[192:195], v[68:71]
    buffer_load_dwordx4 v[136:139], v26, s[68:71], s19 offen offset:2048 sc1
    s_waitcnt lgkmcnt(9)
    v_mfma_f32_16x16x32_bf16 v[72:75], v[144:147], v[196:199], v[72:75]
    ds_read_b128 v[192:195], v8 offset:16384
    v_mfma_f32_16x16x32_bf16 v[76:79], v[148:151], v[196:199], v[76:79]
    ds_write_b64 v0, v[246:247] offset:33800
    s_waitcnt lgkmcnt(10)
    v_mfma_f32_16x16x32_bf16 v[80:83], v[144:147], v[200:203], v[80:83]
    ds_read_b128 v[196:199], v8 offset:18432
    ds_read_b128 v[12:15], v11
    v_mfma_f32_16x16x32_bf16 v[84:87], v[148:151], v[200:203], v[84:87]
    buffer_load_dwordx4 v[140:143], v26, s[68:71], s19 offen offset:3072 sc1
    s_waitcnt lgkmcnt(11)
    v_mfma_f32_16x16x32_bf16 v[88:91], v[144:147], v[204:207], v[88:91]
    ds_read_b128 v[200:203], v8 offset:20480
    v_mfma_f32_16x16x32_bf16 v[92:95], v[148:151], v[204:207], v[92:95]
    ds_write_b64 v0, v[248:249] offset:34816
    s_waitcnt vmcnt(12) lgkmcnt(12)
    v_mfma_f32_16x16x32_bf16 v[64:67], v[152:155], v[208:211], v[64:67]
    ds_read_b128 v[204:207], v8 offset:22528
    ds_write_b64 v0, v[250:251] offset:34824
    v_mfma_f32_16x16x32_bf16 v[68:71], v[156:159], v[208:211], v[68:71]
    buffer_load_dwordx4 v[144:147], v27, s[68:71], s19 offen offset:0 sc1
    s_waitcnt lgkmcnt(12)
    v_mfma_f32_16x16x32_bf16 v[72:75], v[152:155], v[212:215], v[72:75]
    ds_read_b128 v[208:211], v9 offset:16384
    v_mfma_f32_16x16x32_bf16 v[76:79], v[156:159], v[212:215], v[76:79]
    ds_write_b64 v0, v[252:253] offset:35840
    s_waitcnt lgkmcnt(13)
    v_mfma_f32_16x16x32_bf16 v[80:83], v[152:155], v[216:219], v[80:83]
    ds_read_b128 v[212:215], v9 offset:18432
    v_mfma_f32_16x16x32_bf16 v[84:87], v[156:159], v[216:219], v[84:87]
    buffer_load_dwordx4 v[148:151], v27, s[68:71], s19 offen offset:1024 sc1
    s_waitcnt lgkmcnt(12)
    v_mfma_f32_16x16x32_bf16 v[88:91], v[152:155], v[220:223], v[88:91]
    ds_read_b128 v[216:219], v9 offset:20480
    v_mfma_f32_16x16x32_bf16 v[92:95], v[156:159], v[220:223], v[92:95]
    ds_write_b64 v0, v[254:255] offset:35848
    s_waitcnt vmcnt(12) lgkmcnt(12)
    v_mfma_f32_16x16x32_bf16 v[64:67], v[160:163], v[192:195], v[64:67]
    ds_read_b128 v[220:223], v9 offset:22528
    v_mov_b32 v22, 23
    v_mfma_f32_16x16x32_bf16 v[68:71], v[164:167], v[192:195], v[68:71]
    buffer_load_dwordx4 v[152:155], v27, s[68:71], s19 offen offset:2048 sc1
    s_waitcnt lgkmcnt(11)
    v_mfma_f32_16x16x32_bf16 v[72:75], v[160:163], v[196:199], v[72:75]
    ds_read_b128 v[192:195], v8 offset:24576
    s_waitcnt lgkmcnt(11)
    v_min3_u32 v12, v12, v13, v14
    v_mfma_f32_16x16x32_bf16 v[76:79], v[164:167], v[196:199], v[76:79]
    ds_write_b32 v10, v22
    s_waitcnt lgkmcnt(11)
    v_mfma_f32_16x16x32_bf16 v[80:83], v[160:163], v[200:203], v[80:83]
    ds_read_b128 v[196:199], v8 offset:26624
    v_min_u32 v12, v12, v15
    v_mfma_f32_16x16x32_bf16 v[84:87], v[164:167], v[200:203], v[84:87]
    buffer_load_dwordx4 v[156:159], v27, s[68:71], s19 offen offset:3072 sc1
    s_waitcnt lgkmcnt(10)
    v_mfma_f32_16x16x32_bf16 v[88:91], v[160:163], v[204:207], v[88:91]
    ds_read_b128 v[200:203], v8 offset:28672
    s_bfe_u32 s19, s100, 28 + (4 << 16)
    v_mfma_f32_16x16x32_bf16 v[92:95], v[164:167], v[204:207], v[92:95]
    s_lshl_b32 s19, s19, 13
    s_waitcnt vmcnt(12) lgkmcnt(9)
    v_mfma_f32_16x16x32_bf16 v[64:67], v[168:171], v[208:211], v[64:67]
    ds_read_b128 v[204:207], v8 offset:30720
    v_cmp_gt_u32 vcc, 22, v12
    v_mfma_f32_16x16x32_bf16 v[68:71], v[172:175], v[208:211], v[68:71]
    buffer_load_dwordx4 v[160:163], v26, s[68:71], s19 offen offset:0 sc1
    s_waitcnt lgkmcnt(8)
    v_mfma_f32_16x16x32_bf16 v[72:75], v[168:171], v[212:215], v[72:75]
    ds_read_b128 v[208:211], v9 offset:24576
    s_cbranch_vccnz G2_slow5
G2_back5:
    v_mfma_f32_16x16x32_bf16 v[76:79], v[172:175], v[212:215], v[76:79]
    ds_write_b64 v0, v[48:49] offset:49152
    s_waitcnt lgkmcnt(9)
    v_mfma_f32_16x16x32_bf16 v[80:83], v[168:171], v[216:219], v[80:83]
    ds_read_b128 v[212:215], v9 offset:26624
    v_mfma_f32_16x16x32_bf16 v[84:87], v[172:175], v[216:219], v[84:87]
    buffer_load_dwordx4 v[164:167], v26, s[68:71], s19 offen offset:1024 sc1
    s_waitcnt lgkmcnt(8)
    v_mfma_f32_16x16x32_bf16 v[88:91], v[168:171], v[220:223], v[88:91]
    ds_read_b128 v[216:219], v9 offset:28672
    v_mfma_f32_16x16x32_bf16 v[92:95], v[172:175], v[220:223], v[92:95]
    ds_write_b64 v0, v[50:51] offset:49160
    s_waitcnt vmcnt(12) lgkmcnt(9)
    v_mfma_f32_16x16x32_bf16 v[64:67], v[176:179], v[192:195], v[64:67]
    ds_read_b128 v[220:223], v9 offset:30720
    ds_write_b64 v0, v[52:53] offset:50176
    v_mfma_f32_16x16x32_bf16 v[68:71], v[180:183], v[192:195], v[68:71]
    buffer_load_dwordx4 v[168:171], v26, s[68:71], s19 offen offset:2048 sc1
    s_waitcnt lgkmcnt(9)
    v_mfma_f32_16x16x32_bf16 v[72:75], v[176:179], v[196:199], v[72:75]
    ds_read_b128 v[192:195], v6 offset:0
    v_mfma_f32_16x16x32_bf16 v[76:79], v[180:183], v[196:199], v[76:79]
    ds_write_b64 v0, v[54:55] offset:50184
    s_waitcnt lgkmcnt(10)
    v_mfma_f32_16x16x32_bf16 v[80:83], v[176:179], v[200:203], v[80:83]
    ds_read_b128 v[196:199], v6 offset:2048
    ds_read_b128 v[12:15], v11
    v_mfma_f32_16x16x32_bf16 v[84:87], v[180:183], v[200:203], v[84:87]
    buffer_load_dwordx4 v[172:175], v26, s[68:71], s19 offen offset:3072 sc1
    s_waitcnt lgkmcnt(11)
    v_mfma_f32_16x16x32_bf16 v[88:91], v[176:179], v[204:207], v[88:91]
    ds_read_b128 v[200:203], v6 offset:4096
    v_mfma_f32_16x16x32_bf16 v[92:95], v[180:183], v[204:207], v[92:95]
    ds_write_b64 v0, v[56:57] offset:51200
    s_waitcnt vmcnt(12) lgkmcnt(12)
    v_mfma_f32_16x16x32_bf16 v[64:67], v[184:187], v[208:211], v[64:67]
    ds_read_b128 v[204:207], v6 offset:6144
    ds_write_b64 v0, v[58:59] offset:51208
    v_mfma_f32_16x16x32_bf16 v[68:71], v[188:191], v[208:211], v[68:71]
    buffer_load_dwordx4 v[176:179], v27, s[68:71], s19 offen offset:0 sc1
    s_waitcnt lgkmcnt(12)
    v_mfma_f32_16x16x32_bf16 v[72:75], v[184:187], v[212:215], v[72:75]
    ds_read_b128 v[208:211], v7 offset:0
    v_mfma_f32_16x16x32_bf16 v[76:79], v[188:191], v[212:215], v[76:79]
    ds_write_b64 v0, v[60:61] offset:52224
    s_waitcnt lgkmcnt(13)
    v_mfma_f32_16x16x32_bf16 v[80:83], v[184:187], v[216:219], v[80:83]
    ds_read_b128 v[212:215], v7 offset:2048
    v_mfma_f32_16x16x32_bf16 v[84:87], v[188:191], v[216:219], v[84:87]
    buffer_load_dwordx4 v[180:183], v27, s[68:71], s19 offen offset:1024 sc1
    s_waitcnt lgkmcnt(12)
    v_mfma_f32_16x16x32_bf16 v[88:91], v[184:187], v[220:223], v[88:91]
    ds_read_b128 v[216:219], v7 offset:4096
    v_mfma_f32_16x16x32_bf16 v[92:95], v[188:191], v[220:223], v[92:95]
    ds_write_b64 v0, v[62:63] offset:52232
    s_waitcnt vmcnt(12) lgkmcnt(12)
    v_mfma_f32_16x16x32_bf16 v[64:67], v[128:131], v[192:195], v[64:67]
    ds_read_b128 v[220:223], v7 offset:6144
    v_mov_b32 v22, 24
    v_mfma_f32_16x16x32_bf16 v[68:71], v[132:135], v[192:195], v[68:71]
    buffer_load_dwordx4 v[184:187], v27, s[68:71], s19 offen offset:2048 sc1
    s_waitcnt lgkmcnt(11)
    v_mfma_f32_16x16x32_bf16 v[72:75], v[128:131], v[196:199], v[72:75]
    ds_read_b128 v[192:195], v6 offset:8192
    s_waitcnt lgkmcnt(11)
    v_min3_u32 v12, v12, v13, v14
    v_mfma_f32_16x16x32_bf16 v[76:79], v[132:135], v[196:199], v[76:79]
    ds_write_b32 v10, v22
    s_waitcnt lgkmcnt(11)
    v_mfma_f32_16x16x32_bf16 v[80:83], v[128:131], v[200:203], v[80:83]
    ds_read_b128 v[196:199], v6 offset:10240
    v_min_u32 v12, v12, v15
    v_mfma_f32_16x16x32_bf16 v[84:87], v[132:135], v[200:203], v[84:87]
    buffer_load_dwordx4 v[188:191], v27, s[68:71], s19 offen offset:3072 sc1
    s_waitcnt lgkmcnt(10)
    v_mfma_f32_16x16x32_bf16 v[88:91], v[128:131], v[204:207], v[88:91]
    ds_read_b128 v[200:203], v6 offset:12288
    s_bfe_u32 s19, s101, 0 + (4 << 16)
    v_mfma_f32_16x16x32_bf16 v[92:95], v[132:135], v[204:207], v[92:95]
    s_lshl_b32 s19, s19, 13
    s_waitcnt vmcnt(12) lgkmcnt(9)
    v_mfma_f32_16x16x32_bf16 v[64:67], v[136:139], v[208:211], v[64:67]
    ds_read_b128 v[204:207], v6 offset:14336
    v_cmp_gt_u32 vcc, 23, v12
    v_mfma_f32_16x16x32_bf16 v[68:71], v[140:143], v[208:211], v[68:71]
    buffer_load_dwordx4 v[128:131], v26, s[68:71], s19 offen offset:0 sc1
    s_waitcnt lgkmcnt(8)
    v_mfma_f32_16x16x32_bf16 v[72:75], v[136:139], v[212:215], v[72:75]
    ds_read_b128 v[208:211], v7 offset:8192
    s_cbranch_vccnz G2_slow6
G2_back6:
    v_mfma_f32_16x16x32_bf16 v[76:79], v[140:143], v[212:215], v[76:79]
    ds_write_b64 v1, v[32:33] offset:0
    s_waitcnt lgkmcnt(9)
    v_mfma_f32_16x16x32_bf16 v[80:83], v[136:139], v[216:219], v[80:83]
    ds_read_b128 v[212:215], v7 offset:10240
    v_mfma_f32_16x16x32_bf16 v[84:87], v[140:143], v[216:219], v[84:87]
    buffer_load_dwordx4 v[132:135], v26, s[68:71], s19 offen offset:1024 sc1
    s_waitcnt lgkmcnt(8)
    v_mfma_f32_16x16x32_bf16 v[88:91], v[136:139], v[220:223], v[88:91]
    ds_read_b128 v[216:219], v7 offset:12288
    v_mfma_f32_16x16x32_bf16 v[92:95], v[140:143], v[220:223], v[92:95]
    ds_write_b64 v1, v[34:35] offset:8
    s_waitcnt vmcnt(12) lgkmcnt(9)
    v_mfma_f32_16x16x32_bf16 v[64:67], v[144:147], v[192:195], v[64:67]
    ds_read_b128 v[220:223], v7 offset:14336
    ds_write_b64 v1, v[36:37] offset:1024
    v_mfma_f32_16x16x32_bf16 v[68:71], v[148:151], v[192:195], v[68:71]
    buffer_load_dwordx4 v[136:139], v26, s[68:71], s19 offen offset:2048 sc1
    s_waitcnt lgkmcnt(9)
    v_mfma_f32_16x16x32_bf16 v[72:75], v[144:147], v[196:199], v[72:75]
    ds_read_b128 v[192:195], v6 offset:16384
    v_mfma_f32_16x16x32_bf16 v[76:79], v[148:151], v[196:199], v[76:79]
    ds_write_b64 v1, v[38:39] offset:1032
    s_waitcnt lgkmcnt(10)
    v_mfma_f32_16x16x32_bf16 v[80:83], v[144:147], v[200:203], v[80:83]
    ds_read_b128 v[196:199], v6 offset:18432
    ds_read_b128 v[12:15], v11
    v_mfma_f32_16x16x32_bf16 v[84:87], v[148:151], v[200:203], v[84:87]
    buffer_load_dwordx4 v[140:143], v26, s[68:71], s19 offen offset:3072 sc1
    s_waitcnt lgkmcnt(11)
    v_mfma_f32_16x16x32_bf16 v[88:91], v[144:147], v[204:207], v[88:91]
    ds_read_b128 v[200:203], v6 offset:20480
    v_mfma_f32_16x16x32_bf16 v[92:95], v[148:151], v[204:207], v[92:95]
    ds_write_b64 v1, v[40:41] offset:2048
    s_waitcnt vmcnt(12) lgkmcnt(12)
    v_mfma_f32_16x16x32_bf16 v[64:67], v[152:155], v[208:211], v[64:67]
    ds_read_b128 v[204:207], v6 offset:22528
    ds_write_b64 v1, v[42:43] offset:2056
    v_mfma_f32_16x16x32_bf16 v[68:71], v[156:159], v[208:211], v[68:71]
    buffer_load_dwordx4 v[144:147], v27, s[68:71], s19 offen offset:0 sc1
    s_waitcnt lgkmcnt(12)
    v_mfma_f32_16x16x32_bf16 v[72:75], v[152:155], v[212:215], v[72:75]
    ds_read_b128 v[208:211], v7 offset:16384
    v_mfma_f32_16x16x32_bf16 v[76:79], v[156:159], v[212:215], v[76:79]
    ds_write_b64 v1, v[44:45] offset:3072
    s_waitcnt lgkmcnt(13)
    v_mfma_f32_16x16x32_bf16 v[80:83], v[152:155], v[216:219], v[80:83]
    ds_read_b128 v[212:215], v7 offset:18432
    v_mfma_f32_16x16x32_bf16 v[84:87], v[156:159], v[216:219], v[84:87]
    buffer_load_dwordx4 v[148:151], v27, s[68:71], s19 offen offset:1024 sc1
    s_waitcnt lgkmcnt(12)
    v_mfma_f32_16x16x32_bf16 v[88:91], v[152:155], v[220:223], v[88:91]
    ds_read_b128 v[216:219], v7 offset:20480
    v_mfma_f32_16x16x32_bf16 v[92:95], v[156:159], v[220:223], v[92:95]
    ds_write_b64 v1, v[46:47] offset:3080
    s_waitcnt vmcnt(12) lgkmcnt(12)
    v_mfma_f32_16x16x32_bf16 v[64:67], v[160:163], v[192:195], v[64:67]
    ds_read_b128 v[220:223], v7 offset:22528
    v_mov_b32 v22, 25
    v_mfma_f32_16x16x32_bf16 v[68:71], v[164:167], v[192:195], v[68:71]
    buffer_load_dwordx4 v[152:155], v27, s[68:71], s19 offen offset:2048 sc1
    s_waitcnt lgkmcnt(11)
    v_mfma_f32_16x16x32_bf16 v[72:75], v[160:163], v[196:199], v[72:75]
    ds_read_b128 v[192:195], v6 offset:24576
    s_waitcnt lgkmcnt(11)
    v_min3_u32 v12, v12, v13, v14
    v_mfma_f32_16x16x32_bf16 v[76:79], v[164:167], v[196:199], v[76:79]
    ds_write_b32 v10, v22
    s_waitcnt lgkmcnt(11)
    v_mfma_f32_16x16x32_bf16 v[80:83], v[160:163], v[200:203], v[80:83]
    ds_read_b128 v[196:199], v6 offset:26624
    v_min_u32 v12, v12, v15
    v_mfma_f32_16x16x32_bf16 v[84:87], v[164:167], v[200:203], v[84:87]
    buffer_load_dwordx4 v[156:159], v27, s[68:71], s19 offen offset:3072 sc1
    s_waitcnt lgkmcnt(10)
    v_mfma_f32_16x16x32_bf16 v[88:91], v[160:163], v[204:207], v[88:91]
    ds_read_b128 v[200:203], v6 offset:28672
    s_bfe_u32 s19, s101, 4 + (4 << 16)
    v_mfma_f32_16x16x32_bf16 v[92:95], v[164:167], v[204:207], v[92:95]
    s_lshl_b32 s19, s19, 13
    s_waitcnt vmcnt(12) lgkmcnt(9)
    v_mfma_f32_16x16x32_bf16 v[64:67], v[168:171], v[208:211], v[64:67]
    ds_read_b128 v[204:207], v6 offset:30720
    v_cmp_gt_u32 vcc, 24, v12
    v_mfma_f32_16x16x32_bf16 v[68:71], v[172:175], v[208:211], v[68:71]
    buffer_load_dwordx4 v[160:163], v26, s[68:71], s19 offen offset:0 sc1
    s_waitcnt lgkmcnt(8)
    v_mfma_f32_16x16x32_bf16 v[72:75], v[168:171], v[212:215], v[72:75]
    ds_read_b128 v[208:211], v7 offset:24576
    s_cbranch_vccnz G2_slow7
G2_back7:
    v_mfma_f32_16x16x32_bf16 v[76:79], v[172:175], v[212:215], v[76:79]
    ds_write_b64 v1, v[96:97] offset:16384
    s_waitcnt lgkmcnt(9)
    v_mfma_f32_16x16x32_bf16 v[80:83], v[168:171], v[216:219], v[80:83]
    ds_read_b128 v[212:215], v7 offset:26624
    v_mfma_f32_16x16x32_bf16 v[84:87], v[172:175], v[216:219], v[84:87]
    buffer_load_dwordx4 v[164:167], v26, s[68:71], s19 offen offset:1024 sc1
    s_waitcnt lgkmcnt(8)
    v_mfma_f32_16x16x32_bf16 v[88:91], v[168:171], v[220:223], v[88:91]
    ds_read_b128 v[216:219], v7 offset:28672
    v_mfma_f32_16x16x32_bf16 v[92:95], v[172:175], v[220:223], v[92:95]
    ds_write_b64 v1, v[98:99] offset:16392
    s_waitcnt vmcnt(12) lgkmcnt(9)
    v_mfma_f32_16x16x32_bf16 v[64:67], v[176:179], v[192:195], v[64:67]
    ds_read_b128 v[220:223], v7 offset:30720
    ds_write_b64 v1, v[100:101] offset:17408
    v_mfma_f32_16x16x32_bf16 v[68:71], v[180:183], v[192:195], v[68:71]
    buffer_load_dwordx4 v[168:171], v26, s[68:71], s19 offen offset:2048 sc1
    s_waitcnt lgkmcnt(9)
    v_mfma_f32_16x16x32_bf16 v[72:75], v[176:179], v[196:199], v[72:75]
    ds_read_b128 v[192:195], v6 offset:32768
    v_mfma_f32_16x16x32_bf16 v[76:79], v[180:183], v[196:199], v[76:79]
    ds_write_b64 v1, v[102:103] offset:17416
    s_waitcnt lgkmcnt(10)
    v_mfma_f32_16x16x32_bf16 v[80:83], v[176:179], v[200:203], v[80:83]
    ds_read_b128 v[196:199], v6 offset:34816
    ds_read_b128 v[12:15], v11
    v_mfma_f32_16x16x32_bf16 v[84:87], v[180:183], v[200:203], v[84:87]
    buffer_load_dwordx4 v[172:175], v26, s[68:71], s19 offen offset:3072 sc1
    s_waitcnt lgkmcnt(11)
    v_mfma_f32_16x16x32_bf16 v[88:91], v[176:179], v[204:207], v[88:91]
    ds_read_b128 v[200:203], v6 offset:36864
    v_mfma_f32_16x16x32_bf16 v[92:95], v[180:183], v[204:207], v[92:95]
    ds_write_b64 v1, v[104:105] offset:18432
    s_waitcnt vmcnt(12) lgkmcnt(12)
    v_mfma_f32_16x16x32_bf16 v[64:67], v[184:187], v[208:211], v[64:67]
    ds_read_b128 v[204:207], v6 offset:38912
    ds_write_b64 v1, v[106:107] offset:18440
    v_mfma_f32_16x16x32_bf16 v[68:71], v[188:191], v[208:211], v[68:71]
    buffer_load_dwordx4 v[176:179], v27, s[68:71], s19 offen offset:0 sc1
    s_waitcnt lgkmcnt(12)
    v_mfma_f32_16x16x32_bf16 v[72:75], v[184:187], v[212:215], v[72:75]
    ds_read_b128 v[208:211], v7 offset:32768
    v_mfma_f32_16x16x32_bf16 v[76:79], v[188:191], v[212:215], v[76:79]
    ds_write_b64 v1, v[108:109] offset:19456
    s_waitcnt lgkmcnt(13)
    v_mfma_f32_16x16x32_bf16 v[80:83], v[184:187], v[216:219], v[80:83]
    ds_read_b128 v[212:215], v7 offset:34816
    v_mfma_f32_16x16x32_bf16 v[84:87], v[188:191], v[216:219], v[84:87]
    buffer_load_dwordx4 v[180:183], v27, s[68:71], s19 offen offset:1024 sc1
    s_waitcnt lgkmcnt(12)
    v_mfma_f32_16x16x32_bf16 v[88:91], v[184:187], v[220:223], v[88:91]
    ds_read_b128 v[216:219], v7 offset:36864
    v_mfma_f32_16x16x32_bf16 v[92:95], v[188:191], v[220:223], v[92:95]
    ds_write_b64 v1, v[110:111] offset:19464
    s_waitcnt vmcnt(12) lgkmcnt(12)
    v_mfma_f32_16x16x32_bf16 v[64:67], v[128:131], v[192:195], v[64:67]
    ds_read_b128 v[220:223], v7 offset:38912
    v_mov_b32 v22, 26
    v_mfma_f32_16x16x32_bf16 v[68:71], v[132:135], v[192:195], v[68:71]
    buffer_load_dwordx4 v[184:187], v27, s[68:71], s19 offen offset:2048 sc1
    s_waitcnt lgkmcnt(11)
    v_mfma_f32_16x16x32_bf16 v[72:75], v[128:131], v[196:199], v[72:75]
    ds_read_b128 v[192:195], v6 offset:40960
    s_waitcnt lgkmcnt(11)
    v_min3_u32 v12, v12, v13, v14
    v_mfma_f32_16x16x32_bf16 v[76:79], v[132:135], v[196:199], v[76:79]
    ds_write_b32 v10, v22
    s_waitcnt lgkmcnt(11)
    v_mfma_f32_16x16x32_bf16 v[80:83], v[128:131], v[200:203], v[80:83]
    ds_read_b128 v[196:199], v6 offset:43008
    v_min_u32 v12, v12, v15
    v_mfma_f32_16x16x32_bf16 v[84:87], v[132:135], v[200:203], v[84:87]
    buffer_load_dwordx4 v[188:191], v27, s[68:71], s19 offen offset:3072 sc1
    s_waitcnt lgkmcnt(10)
    v_mfma_f32_16x16x32_bf16 v[88:91], v[128:131], v[204:207], v[88:91]
    ds_read_b128 v[200:203], v6 offset:45056
    s_bfe_u32 s19, s101, 8 + (4 << 16)
    v_mfma_f32_16x16x32_bf16 v[92:95], v[132:135], v[204:207], v[92:95]
    s_lshl_b32 s19, s19, 13
    s_waitcnt vmcnt(12) lgkmcnt(9)
    v_mfma_f32_16x16x32_bf16 v[64:67], v[136:139], v[208:211], v[64:67]
    ds_read_b128 v[204:207], v6 offset:47104
    v_cmp_gt_u32 vcc, 25, v12
    v_mfma_f32_16x16x32_bf16 v[68:71], v[140:143], v[208:211], v[68:71]
    buffer_load_dwordx4 v[128:131], v26, s[68:71], s19 offen offset:0 sc1
    s_waitcnt lgkmcnt(8)
    v_mfma_f32_16x16x32_bf16 v[72:75], v[136:139], v[212:215], v[72:75]
    ds_read_b128 v[208:211], v7 offset:40960
    s_cbranch_vccnz G2_slow8
G2_back8:
    v_mfma_f32_16x16x32_bf16 v[76:79], v[140:143], v[212:215], v[76:79]
    ds_write_b64 v0, v[112:113] offset:0
    s_waitcnt lgkmcnt(9)
    v_mfma_f32_16x16x32_bf16 v[80:83], v[136:139], v[216:219], v[80:83]
    ds_read_b128 v[212:215], v7 offset:43008
    v_mfma_f32_16x16x32_bf16 v[84:87], v[140:143], v[216:219], v[84:87]
    buffer_load_dwordx4 v[132:135], v26, s[68:71], s19 offen offset:1024 sc1
    s_waitcnt lgkmcnt(8)
    v_mfma_f32_16x16x32_bf16 v[88:91], v[136:139], v[220:223], v[88:91]
    ds_read_b128 v[216:219], v7 offset:45056
    v_mfma_f32_16x16x32_bf16 v[92:95], v[140:143], v[220:223], v[92:95]
    ds_write_b64 v0, v[114:115] offset:8
    s_waitcnt vmcnt(12) lgkmcnt(9)
    v_mfma_f32_16x16x32_bf16 v[64:67], v[144:147], v[192:195], v[64:67]
    ds_read_b128 v[220:223], v7 offset:47104
    ds_write_b64 v0, v[116:117] offset:1024
    v_mfma_f32_16x16x32_bf16 v[68:71], v[148:151], v[192:195], v[68:71]
    buffer_load_dwordx4 v[136:139], v26, s[68:71], s19 offen offset:2048 sc1
    s_waitcnt lgkmcnt(9)
    v_mfma_f32_16x16x32_bf16 v[72:75], v[144:147], v[196:199], v[72:75]
    ds_read_b128 v[192:195], v6 offset:49152
    v_mfma_f32_16x16x32_bf16 v[76:79], v[148:151], v[196:199], v[76:79]
    ds_write_b64 v0, v[118:119] offset:1032
    s_waitcnt lgkmcnt(10)
    v_mfma_f32_16x16x32_bf16 v[80:83], v[144:147], v[200:203], v[80:83]
    ds_read_b128 v[196:199], v6 offset:51200
    v_mfma_f32_16x16x32_bf16 v[84:87], v[148:151], v[200:203], v[84:87]
    buffer_load_dwordx4 v[140:143], v26, s[68:71], s19 offen offset:3072 sc1
    s_waitcnt lgkmcnt(10)
    v_mfma_f32_16x16x32_bf16 v[88:91], v[144:147], v[204:207], v[88:91]
    ds_read_b128 v[200:203], v6 offset:53248
    v_mfma_f32_16x16x32_bf16 v[92:95], v[148:151], v[204:207], v[92:95]
    ds_write_b64 v0, v[120:121] offset:2048
    s_waitcnt vmcnt(12) lgkmcnt(11)
    v_mfma_f32_16x16x32_bf16 v[64:67], v[152:155], v[208:211], v[64:67]
    ds_read_b128 v[204:207], v6 offset:55296
    ds_write_b64 v0, v[122:123] offset:2056
    v_mfma_f32_16x16x32_bf16 v[68:71], v[156:159], v[208:211], v[68:71]
    buffer_load_dwordx4 v[144:147], v27, s[68:71], s19 offen offset:0 sc1
    s_waitcnt lgkmcnt(11)
    v_mfma_f32_16x16x32_bf16 v[72:75], v[152:155], v[212:215], v[72:75]
    ds_read_b128 v[208:211], v7 offset:49152
    v_mfma_f32_16x16x32_bf16 v[76:79], v[156:159], v[212:215], v[76:79]
    ds_write_b64 v0, v[124:125] offset:3072
    s_waitcnt lgkmcnt(12)
    v_mfma_f32_16x16x32_bf16 v[80:83], v[152:155], v[216:219], v[80:83]
    ds_read_b128 v[212:215], v7 offset:51200
    v_mfma_f32_16x16x32_bf16 v[84:87], v[156:159], v[216:219], v[84:87]
    buffer_load_dwordx4 v[148:151], v27, s[68:71], s19 offen offset:1024 sc1
    s_waitcnt lgkmcnt(11)
    v_mfma_f32_16x16x32_bf16 v[88:91], v[152:155], v[220:223], v[88:91]
    ds_read_b128 v[216:219], v7 offset:53248
    v_mfma_f32_16x16x32_bf16 v[92:95], v[156:159], v[220:223], v[92:95]
    ds_write_b64 v0, v[126:127] offset:3080
    s_waitcnt vmcnt(12) lgkmcnt(11)
    v_mfma_f32_16x16x32_bf16 v[64:67], v[160:163], v[192:195], v[64:67]
    ds_read_b128 v[220:223], v7 offset:55296
    v_mov_b32 v22, 27
    v_mfma_f32_16x16x32_bf16 v[68:71], v[164:167], v[192:195], v[68:71]
    buffer_load_dwordx4 v[152:155], v27, s[68:71], s19 offen offset:2048 sc1
    s_waitcnt lgkmcnt(10)
    v_mfma_f32_16x16x32_bf16 v[72:75], v[160:163], v[196:199], v[72:75]
    ds_read_b128 v[192:195], v6 offset:57344
    v_mfma_f32_16x16x32_bf16 v[76:79], v[164:167], v[196:199], v[76:79]
    ds_write_b32 v10, v22
    s_waitcnt lgkmcnt(11)
    v_mfma_f32_16x16x32_bf16 v[80:83], v[160:163], v[200:203], v[80:83]
    ds_read_b128 v[196:199], v6 offset:59392
    v_mfma_f32_16x16x32_bf16 v[84:87], v[164:167], v[200:203], v[84:87]
    buffer_load_dwordx4 v[156:159], v27, s[68:71], s19 offen offset:3072 sc1
    s_waitcnt lgkmcnt(10)
    v_mfma_f32_16x16x32_bf16 v[88:91], v[160:163], v[204:207], v[88:91]
    ds_read_b128 v[200:203], v6 offset:61440
    s_bfe_u32 s19, s101, 12 + (4 << 16)
    v_mfma_f32_16x16x32_bf16 v[92:95], v[164:167], v[204:207], v[92:95]
    s_lshl_b32 s19, s19, 13
    s_waitcnt vmcnt(12) lgkmcnt(9)
    v_mfma_f32_16x16x32_bf16 v[64:67], v[168:171], v[208:211], v[64:67]
    ds_read_b128 v[204:207], v6 offset:63488
    v_mfma_f32_16x16x32_bf16 v[68:71], v[172:175], v[208:211], v[68:71]
    buffer_load_dwordx4 v[160:163], v26, s[68:71], s19 offen offset:0 sc1
    s_waitcnt lgkmcnt(8)
    v_mfma_f32_16x16x32_bf16 v[72:75], v[168:171], v[212:215], v[72:75]
    ds_read_b128 v[208:211], v7 offset:57344
    v_mfma_f32_16x16x32_bf16 v[76:79], v[172:175], v[212:215], v[76:79]
    s_waitcnt lgkmcnt(8)
    v_mfma_f32_16x16x32_bf16 v[80:83], v[168:171], v[216:219], v[80:83]
    ds_read_b128 v[212:215], v7 offset:59392
    v_mfma_f32_16x16x32_bf16 v[84:87], v[172:175], v[216:219], v[84:87]
    buffer_load_dwordx4 v[164:167], v26, s[68:71], s19 offen offset:1024 sc1
    s_waitcnt lgkmcnt(7)
    v_mfma_f32_16x16x32_bf16 v[88:91], v[168:171], v[220:223], v[88:91]
    ds_read_b128 v[216:219], v7 offset:61440
    v_mfma_f32_16x16x32_bf16 v[92:95], v[172:175], v[220:223], v[92:95]
    s_waitcnt vmcnt(12) lgkmcnt(7)
    v_mfma_f32_16x16x32_bf16 v[64:67], v[176:179], v[192:195], v[64:67]
    ds_read_b128 v[220:223], v7 offset:63488
    v_mfma_f32_16x16x32_bf16 v[68:71], v[180:183], v[192:195], v[68:71]
    buffer_load_dwordx4 v[168:171], v26, s[68:71], s19 offen offset:2048 sc1
    s_waitcnt lgkmcnt(6)
    v_mfma_f32_16x16x32_bf16 v[72:75], v[176:179], v[196:199], v[72:75]
    ds_read_b128 v[192:195], v8 offset:0
    v_mfma_f32_16x16x32_bf16 v[76:79], v[180:183], v[196:199], v[76:79]
    s_waitcnt lgkmcnt(6)
    v_mfma_f32_16x16x32_bf16 v[80:83], v[176:179], v[200:203], v[80:83]
    ds_read_b128 v[196:199], v8 offset:2048
    ds_read_b128 v[12:15], v11
    v_mfma_f32_16x16x32_bf16 v[84:87], v[180:183], v[200:203], v[84:87]
    buffer_load_dwordx4 v[172:175], v26, s[68:71], s19 offen offset:3072 sc1
    s_waitcnt lgkmcnt(7)
    v_mfma_f32_16x16x32_bf16 v[88:91], v[176:179], v[204:207], v[88:91]
    ds_read_b128 v[200:203], v8 offset:4096
    v_mfma_f32_16x16x32_bf16 v[92:95], v[180:183], v[204:207], v[92:95]
    s_waitcnt vmcnt(12) lgkmcnt(7)
    v_mfma_f32_16x16x32_bf16 v[64:67], v[184:187], v[208:211], v[64:67]
    ds_read_b128 v[204:207], v8 offset:6144
    v_mfma_f32_16x16x32_bf16 v[68:71], v[188:191], v[208:211], v[68:71]
    buffer_load_dwordx4 v[176:179], v27, s[68:71], s19 offen offset:0 sc1
    s_waitcnt lgkmcnt(7)
    v_mfma_f32_16x16x32_bf16 v[72:75], v[184:187], v[212:215], v[72:75]
    ds_read_b128 v[208:211], v9 offset:0
    v_mfma_f32_16x16x32_bf16 v[76:79], v[188:191], v[212:215], v[76:79]
    s_waitcnt lgkmcnt(7)
    v_mfma_f32_16x16x32_bf16 v[80:83], v[184:187], v[216:219], v[80:83]
    ds_read_b128 v[212:215], v9 offset:2048
    v_mfma_f32_16x16x32_bf16 v[84:87], v[188:191], v[216:219], v[84:87]
    buffer_load_dwordx4 v[180:183], v27, s[68:71], s19 offen offset:1024 sc1
    s_waitcnt lgkmcnt(7)
    v_mfma_f32_16x16x32_bf16 v[88:91], v[184:187], v[220:223], v[88:91]
    ds_read_b128 v[216:219], v9 offset:4096
    v_mfma_f32_16x16x32_bf16 v[92:95], v[188:191], v[220:223], v[92:95]
    s_waitcnt vmcnt(12) lgkmcnt(7)
    v_mfma_f32_16x16x32_bf16 v[64:67], v[128:131], v[192:195], v[64:67]
    ds_read_b128 v[220:223], v9 offset:6144
    v_mov_b32 v22, 28
    v_mfma_f32_16x16x32_bf16 v[68:71], v[132:135], v[192:195], v[68:71]
    buffer_load_dwordx4 v[184:187], v27, s[68:71], s19 offen offset:2048 sc1
    s_waitcnt lgkmcnt(7)
    v_mfma_f32_16x16x32_bf16 v[72:75], v[128:131], v[196:199], v[72:75]
    ds_read_b128 v[192:195], v8 offset:8192
    s_waitcnt lgkmcnt(7)
    v_min3_u32 v12, v12, v13, v14
    v_mfma_f32_16x16x32_bf16 v[76:79], v[132:135], v[196:199], v[76:79]
    ds_write_b32 v10, v22
    s_waitcnt lgkmcnt(7)
    v_mfma_f32_16x16x32_bf16 v[80:83], v[128:131], v[200:203], v[80:83]
    ds_read_b128 v[196:199], v8 offset:10240
    v_min_u32 v12, v12, v15
    v_mfma_f32_16x16x32_bf16 v[84:87], v[132:135], v[200:203], v[84:87]
    buffer_load_dwordx4 v[188:191], v27, s[68:71], s19 offen offset:3072 sc1
    s_waitcnt lgkmcnt(7)
    v_mfma_f32_16x16x32_bf16 v[88:91], v[128:131], v[204:207], v[88:91]
    ds_read_b128 v[200:203], v8 offset:12288
    s_bfe_u32 s19, s101, 16 + (4 << 16)
    v_mfma_f32_16x16x32_bf16 v[92:95], v[132:135], v[204:207], v[92:95]
    s_lshl_b32 s19, s19, 13
    s_waitcnt vmcnt(12) lgkmcnt(7)
    v_mfma_f32_16x16x32_bf16 v[64:67], v[136:139], v[208:211], v[64:67]
    ds_read_b128 v[204:207], v8 offset:14336
    v_cmp_gt_u32 vcc, 27, v12
    v_mfma_f32_16x16x32_bf16 v[68:71], v[140:143], v[208:211], v[68:71]
    buffer_load_dwordx4 v[128:131], v26, s[68:71], s19 offen offset:0 sc1
    s_waitcnt lgkmcnt(7)
    v_mfma_f32_16x16x32_bf16 v[72:75], v[136:139], v[212:215], v[72:75]
    ds_read_b128 v[208:211], v9 offset:8192
    s_cbranch_vccnz G2_slow10
G2_back10:
    v_mfma_f32_16x16x32_bf16 v[76:79], v[140:143], v[212:215], v[76:79]
    s_waitcnt lgkmcnt(7)
    v_mfma_f32_16x16x32_bf16 v[80:83], v[136:139], v[216:219], v[80:83]
    ds_read_b128 v[212:215], v9 offset:10240
    v_mfma_f32_16x16x32_bf16 v[84:87], v[140:143], v[216:219], v[84:87]
    buffer_load_dwordx4 v[132:135], v26, s[68:71], s19 offen offset:1024 sc1
    s_waitcnt lgkmcnt(7)
    v_mfma_f32_16x16x32_bf16 v[88:91], v[136:139], v[220:223], v[88:91]
    ds_read_b128 v[216:219], v9 offset:12288
    v_mfma_f32_16x16x32_bf16 v[92:95], v[140:143], v[220:223], v[92:95]
    s_waitcnt vmcnt(12) lgkmcnt(7)
    v_mfma_f32_16x16x32_bf16 v[64:67], v[144:147], v[192:195], v[64:67]
    ds_read_b128 v[220:223], v9 offset:14336
    v_mfma_f32_16x16x32_bf16 v[68:71], v[148:151], v[192:195], v[68:71]
    buffer_load_dwordx4 v[136:139], v26, s[68:71], s19 offen offset:2048 sc1
    s_waitcnt lgkmcnt(6)
    v_mfma_f32_16x16x32_bf16 v[72:75], v[144:147], v[196:199], v[72:75]
    ds_read_b128 v[192:195], v8 offset:16384
    v_mfma_f32_16x16x32_bf16 v[76:79], v[148:151], v[196:199], v[76:79]
    s_waitcnt lgkmcnt(6)
    v_mfma_f32_16x16x32_bf16 v[80:83], v[144:147], v[200:203], v[80:83]
    ds_read_b128 v[196:199], v8 offset:18432
    v_mfma_f32_16x16x32_bf16 v[84:87], v[148:151], v[200:203], v[84:87]
    buffer_load_dwordx4 v[140:143], v26, s[68:71], s19 offen offset:3072 sc1
    s_waitcnt lgkmcnt(6)
    v_mfma_f32_16x16x32_bf16 v[88:91], v[144:147], v[204:207], v[88:91]
    ds_read_b128 v[200:203], v8 offset:20480
    v_mfma_f32_16x16x32_bf16 v[92:95], v[148:151], v[204:207], v[92:95]
    s_waitcnt vmcnt(12) lgkmcnt(6)
    v_mfma_f32_16x16x32_bf16 v[64:67], v[152:155], v[208:211], v[64:67]
    ds_read_b128 v[204:207], v8 offset:22528
    v_mfma_f32_16x16x32_bf16 v[68:71], v[156:159], v[208:211], v[68:71]
    buffer_load_dwordx4 v[144:147], v27, s[68:71], s19 offen offset:0 sc1
    s_waitcnt lgkmcnt(6)
    v_mfma_f32_16x16x32_bf16 v[72:75], v[152:155], v[212:215], v[72:75]
    ds_read_b128 v[208:211], v9 offset:16384
    v_mfma_f32_16x16x32_bf16 v[76:79], v[156:159], v[212:215], v[76:79]
    s_waitcnt lgkmcnt(6)
    v_mfma_f32_16x16x32_bf16 v[80:83], v[152:155], v[216:219], v[80:83]
    ds_read_b128 v[212:215], v9 offset:18432
    v_mfma_f32_16x16x32_bf16 v[84:87], v[156:159], v[216:219], v[84:87]
    buffer_load_dwordx4 v[148:151], v27, s[68:71], s19 offen offset:1024 sc1
    s_waitcnt lgkmcnt(6)
    v_mfma_f32_16x16x32_bf16 v[88:91], v[152:155], v[220:223], v[88:91]
    ds_read_b128 v[216:219], v9 offset:20480
    v_mfma_f32_16x16x32_bf16 v[92:95], v[156:159], v[220:223], v[92:95]
    s_waitcnt vmcnt(12) lgkmcnt(6)
    v_mfma_f32_16x16x32_bf16 v[64:67], v[160:163], v[192:195], v[64:67]
    ds_read_b128 v[220:223], v9 offset:22528
    v_mov_b32 v22, 29
    v_mfma_f32_16x16x32_bf16 v[68:71], v[164:167], v[192:195], v[68:71]
    buffer_load_dwordx4 v[152:155], v27, s[68:71], s19 offen offset:2048 sc1
    s_waitcnt lgkmcnt(6)
    v_mfma_f32_16x16x32_bf16 v[72:75], v[160:163], v[196:199], v[72:75]
    ds_read_b128 v[192:195], v8 offset:24576
    v_mfma_f32_16x16x32_bf16 v[76:79], v[164:167], v[196:199], v[76:79]
    ds_write_b32 v10, v22
    s_waitcnt lgkmcnt(7)
    v_mfma_f32_16x16x32_bf16 v[80:83], v[160:163], v[200:203], v[80:83]
    ds_read_b128 v[196:199], v8 offset:26624
    v_mfma_f32_16x16x32_bf16 v[84:87], v[164:167], v[200:203], v[84:87]
    buffer_load_dwordx4 v[156:159], v27, s[68:71], s19 offen offset:3072 sc1
    s_waitcnt lgkmcnt(7)
    v_mfma_f32_16x16x32_bf16 v[88:91], v[160:163], v[204:207], v[88:91]
    ds_read_b128 v[200:203], v8 offset:28672
    s_bfe_u32 s19, s101, 20 + (4 << 16)
    v_mfma_f32_16x16x32_bf16 v[92:95], v[164:167], v[204:207], v[92:95]
    s_lshl_b32 s19, s19, 13
    s_waitcnt vmcnt(12) lgkmcnt(7)
    v_mfma_f32_16x16x32_bf16 v[64:67], v[168:171], v[208:211], v[64:67]
    ds_read_b128 v[204:207], v8 offset:30720
    v_mfma_f32_16x16x32_bf16 v[68:71], v[172:175], v[208:211], v[68:71]
    buffer_load_dwordx4 v[160:163], v26, s[68:71], s19 offen offset:0 sc1
    s_waitcnt lgkmcnt(7)
    v_mfma_f32_16x16x32_bf16 v[72:75], v[168:171], v[212:215], v[72:75]
    ds_read_b128 v[208:211], v9 offset:24576
    v_mfma_f32_16x16x32_bf16 v[76:79], v[172:175], v[212:215], v[76:79]
    s_waitcnt lgkmcnt(7)
    v_mfma_f32_16x16x32_bf16 v[80:83], v[168:171], v[216:219], v[80:83]
    ds_read_b128 v[212:215], v9 offset:26624
    v_mfma_f32_16x16x32_bf16 v[84:87], v[172:175], v[216:219], v[84:87]
    buffer_load_dwordx4 v[164:167], v26, s[68:71], s19 offen offset:1024 sc1
    s_waitcnt lgkmcnt(7)
    v_mfma_f32_16x16x32_bf16 v[88:91], v[168:171], v[220:223], v[88:91]
    ds_read_b128 v[216:219], v9 offset:28672
    v_mfma_f32_16x16x32_bf16 v[92:95], v[172:175], v[220:223], v[92:95]
    s_waitcnt vmcnt(12) lgkmcnt(7)
    v_mfma_f32_16x16x32_bf16 v[64:67], v[176:179], v[192:195], v[64:67]
    ds_read_b128 v[220:223], v9 offset:30720
    v_mfma_f32_16x16x32_bf16 v[68:71], v[180:183], v[192:195], v[68:71]
    buffer_load_dwordx4 v[168:171], v26, s[68:71], s19 offen offset:2048 sc1
    s_waitcnt lgkmcnt(6)
    v_mfma_f32_16x16x32_bf16 v[72:75], v[176:179], v[196:199], v[72:75]
    ds_read_b128 v[192:195], v6 offset:0
    v_mfma_f32_16x16x32_bf16 v[76:79], v[180:183], v[196:199], v[76:79]
    s_waitcnt lgkmcnt(6)
    v_mfma_f32_16x16x32_bf16 v[80:83], v[176:179], v[200:203], v[80:83]
    ds_read_b128 v[196:199], v6 offset:2048
    v_mfma_f32_16x16x32_bf16 v[84:87], v[180:183], v[200:203], v[84:87]
    buffer_load_dwordx4 v[172:175], v26, s[68:71], s19 offen offset:3072 sc1
    s_waitcnt lgkmcnt(6)
    v_mfma_f32_16x16x32_bf16 v[88:91], v[176:179], v[204:207], v[88:91]
    ds_read_b128 v[200:203], v6 offset:4096
    v_mfma_f32_16x16x32_bf16 v[92:95], v[180:183], v[204:207], v[92:95]
    s_waitcnt vmcnt(12) lgkmcnt(6)
    v_mfma_f32_16x16x32_bf16 v[64:67], v[184:187], v[208:211], v[64:67]
    ds_read_b128 v[204:207], v6 offset:6144
    v_mfma_f32_16x16x32_bf16 v[68:71], v[188:191], v[208:211], v[68:71]
    buffer_load_dwordx4 v[176:179], v27, s[68:71], s19 offen offset:0 sc1
    s_waitcnt lgkmcnt(6)
    v_mfma_f32_16x16x32_bf16 v[72:75], v[184:187], v[212:215], v[72:75]
    ds_read_b128 v[208:211], v7 offset:0
    ds_read_b32 v18, v11 offset:68
    v_mfma_f32_16x16x32_bf16 v[76:79], v[188:191], v[212:215], v[76:79]
    s_waitcnt lgkmcnt(7)
    v_mfma_f32_16x16x32_bf16 v[80:83], v[184:187], v[216:219], v[80:83]
    ds_read_b128 v[212:215], v7 offset:2048
    v_mfma_f32_16x16x32_bf16 v[84:87], v[188:191], v[216:219], v[84:87]
    buffer_load_dwordx4 v[180:183], v27, s[68:71], s19 offen offset:1024 sc1
    s_waitcnt lgkmcnt(7)
    v_mfma_f32_16x16x32_bf16 v[88:91], v[184:187], v[220:223], v[88:91]
    ds_read_b128 v[216:219], v7 offset:4096
    v_mfma_f32_16x16x32_bf16 v[92:95], v[188:191], v[220:223], v[92:95]
    s_waitcnt vmcnt(12) lgkmcnt(7)
    v_mfma_f32_16x16x32_bf16 v[64:67], v[128:131], v[192:195], v[64:67]
    ds_read_b128 v[220:223], v7 offset:6144
    v_mov_b32 v22, 30
    v_mfma_f32_16x16x32_bf16 v[68:71], v[132:135], v[192:195], v[68:71]
    buffer_load_dwordx4 v[184:187], v27, s[68:71], s19 offen offset:2048 sc1
    s_waitcnt lgkmcnt(7)
    v_mfma_f32_16x16x32_bf16 v[72:75], v[128:131], v[196:199], v[72:75]
    ds_read_b128 v[192:195], v6 offset:8192
    v_mfma_f32_16x16x32_bf16 v[76:79], v[132:135], v[196:199], v[76:79]
    ds_write_b32 v10, v22
    s_waitcnt lgkmcnt(8)
    v_mfma_f32_16x16x32_bf16 v[80:83], v[128:131], v[200:203], v[80:83]
    ds_read_b128 v[196:199], v6 offset:10240
    v_add_u32 v8, 32768, v8
    v_mfma_f32_16x16x32_bf16 v[84:87], v[132:135], v[200:203], v[84:87]
    buffer_load_dwordx4 v[188:191], v27, s[68:71], s19 offen offset:3072 sc1
    s_waitcnt lgkmcnt(8)
    v_mfma_f32_16x16x32_bf16 v[88:91], v[128:131], v[204:207], v[88:91]
    ds_read_b128 v[200:203], v6 offset:12288
    s_bfe_u32 s19, s101, 24 + (4 << 16)
    v_mfma_f32_16x16x32_bf16 v[92:95], v[132:135], v[204:207], v[92:95]
    s_lshl_b32 s19, s19, 13
    s_waitcnt vmcnt(12) lgkmcnt(8)
    v_mfma_f32_16x16x32_bf16 v[64:67], v[136:139], v[208:211], v[64:67]
    ds_read_b128 v[204:207], v6 offset:14336
    v_add_u32 v9, 32768, v9
    v_mfma_f32_16x16x32_bf16 v[68:71], v[140:143], v[208:211], v[68:71]
    buffer_load_dwordx4 v[128:131], v26, s[68:71], s19 offen offset:0 sc1
    s_waitcnt lgkmcnt(7)
    v_mfma_f32_16x16x32_bf16 v[72:75], v[136:139], v[212:215], v[72:75]
    ds_read_b128 v[208:211], v7 offset:8192
    v_cmp_gt_u32 vcc, 4, v18
    v_mfma_f32_16x16x32_bf16 v[76:79], v[140:143], v[212:215], v[76:79]
    s_waitcnt lgkmcnt(7)
    v_mfma_f32_16x16x32_bf16 v[80:83], v[136:139], v[216:219], v[80:83]
    ds_read_b128 v[212:215], v7 offset:10240
    v_mfma_f32_16x16x32_bf16 v[84:87], v[140:143], v[216:219], v[84:87]
    buffer_load_dwordx4 v[132:135], v26, s[68:71], s19 offen offset:1024 sc1
    s_waitcnt lgkmcnt(7)
    v_mfma_f32_16x16x32_bf16 v[88:91], v[136:139], v[220:223], v[88:91]
    ds_read_b128 v[216:219], v7 offset:12288
    s_cbranch_vccnz G2_slowc
G2_backc:
    v_mfma_f32_16x16x32_bf16 v[92:95], v[140:143], v[220:223], v[92:95]
    s_waitcnt vmcnt(12) lgkmcnt(7)
    v_mfma_f32_16x16x32_bf16 v[64:67], v[144:147], v[192:195], v[64:67]
    ds_read_b128 v[220:223], v7 offset:14336
    v_mfma_f32_16x16x32_bf16 v[68:71], v[148:151], v[192:195], v[68:71]
    buffer_load_dwordx4 v[136:139], v26, s[68:71], s19 offen offset:2048 sc1
    s_waitcnt lgkmcnt(6)
    v_mfma_f32_16x16x32_bf16 v[72:75], v[144:147], v[196:199], v[72:75]
    ds_read_b128 v[192:195], v8 offset:0
    v_mfma_f32_16x16x32_bf16 v[76:79], v[148:151], v[196:199], v[76:79]
    s_waitcnt lgkmcnt(6)
    v_mfma_f32_16x16x32_bf16 v[80:83], v[144:147], v[200:203], v[80:83]
    ds_read_b128 v[196:199], v8 offset:2048
    v_mfma_f32_16x16x32_bf16 v[84:87], v[148:151], v[200:203], v[84:87]
    buffer_load_dwordx4 v[140:143], v26, s[68:71], s19 offen offset:3072 sc1
    s_waitcnt lgkmcnt(6)
    v_mfma_f32_16x16x32_bf16 v[88:91], v[144:147], v[204:207], v[88:91]
    ds_read_b128 v[200:203], v8 offset:25856
    v_mfma_f32_16x16x32_bf16 v[92:95], v[148:151], v[204:207], v[92:95]
    s_waitcnt vmcnt(12) lgkmcnt(6)
    v_mfma_f32_16x16x32_bf16 v[64:67], v[152:155], v[208:211], v[64:67]
    ds_read_b128 v[204:207], v8 offset:27904
    v_mfma_f32_16x16x32_bf16 v[68:71], v[156:159], v[208:211], v[68:71]
    buffer_load_dwordx4 v[144:147], v27, s[68:71], s19 offen offset:0 sc1
    s_waitcnt lgkmcnt(6)
    v_mfma_f32_16x16x32_bf16 v[72:75], v[152:155], v[212:215], v[72:75]
    ds_read_b128 v[208:211], v9 offset:0
    v_mfma_f32_16x16x32_bf16 v[76:79], v[156:159], v[212:215], v[76:79]
    s_waitcnt lgkmcnt(6)
    v_mfma_f32_16x16x32_bf16 v[80:83], v[152:155], v[216:219], v[80:83]
    ds_read_b128 v[212:215], v9 offset:2048
    v_mfma_f32_16x16x32_bf16 v[84:87], v[156:159], v[216:219], v[84:87]
    buffer_load_dwordx4 v[148:151], v27, s[68:71], s19 offen offset:1024 sc1
    s_waitcnt lgkmcnt(6)
    v_mfma_f32_16x16x32_bf16 v[88:91], v[152:155], v[220:223], v[88:91]
    ds_read_b128 v[216:219], v9 offset:25856
    v_mfma_f32_16x16x32_bf16 v[92:95], v[156:159], v[220:223], v[92:95]
    s_waitcnt vmcnt(12) lgkmcnt(6)
    v_mfma_f32_16x16x32_bf16 v[64:67], v[160:163], v[192:195], v[64:67]
    ds_read_b128 v[220:223], v9 offset:27904
    v_mov_b32 v22, 31
    v_mfma_f32_16x16x32_bf16 v[68:71], v[164:167], v[192:195], v[68:71]
    buffer_load_dwordx4 v[152:155], v27, s[68:71], s19 offen offset:2048 sc1
    s_waitcnt lgkmcnt(6)
    v_mfma_f32_16x16x32_bf16 v[72:75], v[160:163], v[196:199], v[72:75]
    ds_read_b128 v[192:195], v8 offset:12928
    v_mfma_f32_16x16x32_bf16 v[76:79], v[164:167], v[196:199], v[76:79]
    ds_write_b32 v10, v22
    s_waitcnt lgkmcnt(7)
    v_mfma_f32_16x16x32_bf16 v[80:83], v[160:163], v[200:203], v[80:83]
    ds_read_b128 v[196:199], v8 offset:14976
    v_mfma_f32_16x16x32_bf16 v[84:87], v[164:167], v[200:203], v[84:87]
    buffer_load_dwordx4 v[156:159], v27, s[68:71], s19 offen offset:3072 sc1
    s_waitcnt lgkmcnt(7)
    v_mfma_f32_16x16x32_bf16 v[88:91], v[160:163], v[204:207], v[88:91]
    ds_read_b128 v[200:203], v8 offset:38784
    s_bfe_u32 s19, s101, 28 + (4 << 16)
    v_mfma_f32_16x16x32_bf16 v[92:95], v[164:167], v[204:207], v[92:95]
    s_lshl_b32 s19, s19, 13
    s_waitcnt vmcnt(12) lgkmcnt(7)
    v_mfma_f32_16x16x32_bf16 v[64:67], v[168:171], v[208:211], v[64:67]
    ds_read_b128 v[204:207], v8 offset:40832
    v_mfma_f32_16x16x32_bf16 v[68:71], v[172:175], v[208:211], v[68:71]
    buffer_load_dwordx4 v[160:163], v26, s[68:71], s19 offen offset:0 sc1
    s_waitcnt lgkmcnt(7)
    v_mfma_f32_16x16x32_bf16 v[72:75], v[168:171], v[212:215], v[72:75]
    ds_read_b128 v[208:211], v9 offset:12928
    v_mfma_f32_16x16x32_bf16 v[76:79], v[172:175], v[212:215], v[76:79]
    s_waitcnt lgkmcnt(7)
    v_mfma_f32_16x16x32_bf16 v[80:83], v[168:171], v[216:219], v[80:83]
    ds_read_b128 v[212:215], v9 offset:14976
    v_mfma_f32_16x16x32_bf16 v[84:87], v[172:175], v[216:219], v[84:87]
    buffer_load_dwordx4 v[164:167], v26, s[68:71], s19 offen offset:1024 sc1
    s_waitcnt lgkmcnt(7)
    v_mfma_f32_16x16x32_bf16 v[88:91], v[168:171], v[220:223], v[88:91]
    ds_read_b128 v[216:219], v9 offset:38784
    v_mfma_f32_16x16x32_bf16 v[92:95], v[172:175], v[220:223], v[92:95]
    s_waitcnt vmcnt(12) lgkmcnt(7)
    v_mfma_f32_16x16x32_bf16 v[64:67], v[176:179], v[192:195], v[64:67]
    ds_read_b128 v[220:223], v9 offset:40832
    v_mfma_f32_16x16x32_bf16 v[68:71], v[180:183], v[192:195], v[68:71]
    buffer_load_dwordx4 v[168:171], v26, s[68:71], s19 offen offset:2048 sc1
    s_waitcnt lgkmcnt(6)
    v_mfma_f32_16x16x32_bf16 v[72:75], v[176:179], v[196:199], v[72:75]
    ds_read_b128 v[192:195], v8 offset:4096
    v_mfma_f32_16x16x32_bf16 v[76:79], v[180:183], v[196:199], v[76:79]
    s_waitcnt lgkmcnt(6)
    v_mfma_f32_16x16x32_bf16 v[80:83], v[176:179], v[200:203], v[80:83]
    ds_read_b128 v[196:199], v8 offset:6144
    v_mfma_f32_16x16x32_bf16 v[84:87], v[180:183], v[200:203], v[84:87]
    buffer_load_dwordx4 v[172:175], v26, s[68:71], s19 offen offset:3072 sc1
    s_waitcnt lgkmcnt(6)
    v_mfma_f32_16x16x32_bf16 v[88:91], v[176:179], v[204:207], v[88:91]
    ds_read_b128 v[200:203], v8 offset:29952
    v_mfma_f32_16x16x32_bf16 v[92:95], v[180:183], v[204:207], v[92:95]
    s_waitcnt vmcnt(12) lgkmcnt(6)
    v_mfma_f32_16x16x32_bf16 v[64:67], v[184:187], v[208:211], v[64:67]
    ds_read_b128 v[204:207], v8 offset:32000
    v_mfma_f32_16x16x32_bf16 v[68:71], v[188:191], v[208:211], v[68:71]
    buffer_load_dwordx4 v[176:179], v27, s[68:71], s19 offen offset:0 sc1
    s_waitcnt lgkmcnt(6)
    v_mfma_f32_16x16x32_bf16 v[72:75], v[184:187], v[212:215], v[72:75]
    ds_read_b128 v[208:211], v9 offset:4096
    v_mfma_f32_16x16x32_bf16 v[76:79], v[188:191], v[212:215], v[76:79]
    s_waitcnt lgkmcnt(6)
    v_mfma_f32_16x16x32_bf16 v[80:83], v[184:187], v[216:219], v[80:83]
    ds_read_b128 v[212:215], v9 offset:6144
    v_mfma_f32_16x16x32_bf16 v[84:87], v[188:191], v[216:219], v[84:87]
    buffer_load_dwordx4 v[180:183], v27, s[68:71], s19 offen offset:1024 sc1
    s_waitcnt lgkmcnt(6)
    v_mfma_f32_16x16x32_bf16 v[88:91], v[184:187], v[220:223], v[88:91]
    ds_read_b128 v[216:219], v9 offset:29952
    v_mfma_f32_16x16x32_bf16 v[92:95], v[188:191], v[220:223], v[92:95]
    s_waitcnt vmcnt(12) lgkmcnt(6)
    v_mfma_f32_16x16x32_bf16 v[64:67], v[128:131], v[192:195], v[64:67]
    ds_read_b128 v[220:223], v9 offset:32000
    v_mov_b32 v22, 32
    v_mfma_f32_16x16x32_bf16 v[68:71], v[132:135], v[192:195], v[68:71]
    buffer_load_dwordx4 v[184:187], v27, s[68:71], s19 offen offset:2048 sc1
    s_waitcnt lgkmcnt(6)
    v_mfma_f32_16x16x32_bf16 v[72:75], v[128:131], v[196:199], v[72:75]
    ds_read_b128 v[192:195], v8 offset:17024
    v_mfma_f32_16x16x32_bf16 v[76:79], v[132:135], v[196:199], v[76:79]
    ds_write_b32 v10, v22
    s_waitcnt lgkmcnt(7)
    v_mfma_f32_16x16x32_bf16 v[80:83], v[128:131], v[200:203], v[80:83]
    ds_read_b128 v[196:199], v8 offset:19072
    v_mfma_f32_16x16x32_bf16 v[84:87], v[132:135], v[200:203], v[84:87]
    buffer_load_dwordx4 v[188:191], v27, s[68:71], s19 offen offset:3072 sc1
    s_waitcnt lgkmcnt(7)
    v_mfma_f32_16x16x32_bf16 v[88:91], v[128:131], v[204:207], v[88:91]
    ds_read_b128 v[200:203], v8 offset:42880
    v_mfma_f32_16x16x32_bf16 v[92:95], v[132:135], v[204:207], v[92:95]
    s_waitcnt vmcnt(12) lgkmcnt(7)
    v_mfma_f32_16x16x32_bf16 v[64:67], v[136:139], v[208:211], v[64:67]
    ds_read_b128 v[204:207], v8 offset:44928
    v_mfma_f32_16x16x32_bf16 v[68:71], v[140:143], v[208:211], v[68:71]
    s_waitcnt lgkmcnt(7)
    v_mfma_f32_16x16x32_bf16 v[72:75], v[136:139], v[212:215], v[72:75]
    ds_read_b128 v[208:211], v9 offset:17024
    v_mfma_f32_16x16x32_bf16 v[76:79], v[140:143], v[212:215], v[76:79]
    s_waitcnt lgkmcnt(7)
    v_mfma_f32_16x16x32_bf16 v[80:83], v[136:139], v[216:219], v[80:83]
    ds_read_b128 v[212:215], v9 offset:19072
    v_mfma_f32_16x16x32_bf16 v[84:87], v[140:143], v[216:219], v[84:87]
    s_waitcnt lgkmcnt(7)
    v_mfma_f32_16x16x32_bf16 v[88:91], v[136:139], v[220:223], v[88:91]
    ds_read_b128 v[216:219], v9 offset:42880
    v_mfma_f32_16x16x32_bf16 v[92:95], v[140:143], v[220:223], v[92:95]
    s_waitcnt vmcnt(10) lgkmcnt(7)
    v_mfma_f32_16x16x32_bf16 v[64:67], v[144:147], v[192:195], v[64:67]
    ds_read_b128 v[220:223], v9 offset:44928
    v_mfma_f32_16x16x32_bf16 v[68:71], v[148:151], v[192:195], v[68:71]
    s_waitcnt lgkmcnt(6)
    v_mfma_f32_16x16x32_bf16 v[72:75], v[144:147], v[196:199], v[72:75]
    ds_read_b128 v[192:195], v8 offset:8192
    v_mfma_f32_16x16x32_bf16 v[76:79], v[148:151], v[196:199], v[76:79]
    s_waitcnt lgkmcnt(6)
    v_mfma_f32_16x16x32_bf16 v[80:83], v[144:147], v[200:203], v[80:83]
    ds_read_b128 v[196:199], v8 offset:10240
    v_mfma_f32_16x16x32_bf16 v[84:87], v[148:151], v[200:203], v[84:87]
    s_waitcnt lgkmcnt(6)
    v_mfma_f32_16x16x32_bf16 v[88:91], v[144:147], v[204:207], v[88:91]
    ds_read_b128 v[200:203], v8 offset:34048
    v_mfma_f32_16x16x32_bf16 v[92:95], v[148:151], v[204:207], v[92:95]
    s_waitcnt vmcnt(8) lgkmcnt(6)
    v_mfma_f32_16x16x32_bf16 v[64:67], v[152:155], v[208:211], v[64:67]
    ds_read_b128 v[204:207], v8 offset:36096
    v_mfma_f32_16x16x32_bf16 v[68:71], v[156:159], v[208:211], v[68:71]
    s_waitcnt lgkmcnt(6)
    v_mfma_f32_16x16x32_bf16 v[72:75], v[152:155], v[212:215], v[72:75]
    ds_read_b128 v[208:211], v9 offset:8192
    v_mfma_f32_16x16x32_bf16 v[76:79], v[156:159], v[212:215], v[76:79]
    s_waitcnt lgkmcnt(6)
    v_mfma_f32_16x16x32_bf16 v[80:83], v[152:155], v[216:219], v[80:83]
    ds_read_b128 v[212:215], v9 offset:10240
    v_mfma_f32_16x16x32_bf16 v[84:87], v[156:159], v[216:219], v[84:87]
    s_waitcnt lgkmcnt(6)
    v_mfma_f32_16x16x32_bf16 v[88:91], v[152:155], v[220:223], v[88:91]
    ds_read_b128 v[216:219], v9 offset:34048
    v_mfma_f32_16x16x32_bf16 v[92:95], v[156:159], v[220:223], v[92:95]
    s_waitcnt vmcnt(6) lgkmcnt(6)
    v_mfma_f32_16x16x32_bf16 v[64:67], v[160:163], v[192:195], v[64:67]
    ds_read_b128 v[220:223], v9 offset:36096
    v_mov_b32 v22, 33
    v_mfma_f32_16x16x32_bf16 v[68:71], v[164:167], v[192:195], v[68:71]
    s_waitcnt lgkmcnt(6)
    v_mfma_f32_16x16x32_bf16 v[72:75], v[160:163], v[196:199], v[72:75]
    ds_read_b128 v[192:195], v8 offset:21120
    v_mfma_f32_16x16x32_bf16 v[76:79], v[164:167], v[196:199], v[76:79]
    ds_write_b32 v10, v22
    s_waitcnt lgkmcnt(7)
    v_mfma_f32_16x16x32_bf16 v[80:83], v[160:163], v[200:203], v[80:83]
    ds_read_b128 v[196:199], v8 offset:23168
    v_mfma_f32_16x16x32_bf16 v[84:87], v[164:167], v[200:203], v[84:87]
    s_waitcnt lgkmcnt(7)
    v_mfma_f32_16x16x32_bf16 v[88:91], v[160:163], v[204:207], v[88:91]
    ds_read_b128 v[200:203], v8 offset:46976
    v_mfma_f32_16x16x32_bf16 v[92:95], v[164:167], v[204:207], v[92:95]
    s_waitcnt vmcnt(4) lgkmcnt(7)
    v_mfma_f32_16x16x32_bf16 v[64:67], v[168:171], v[208:211], v[64:67]
    ds_read_b128 v[204:207], v8 offset:49024
    v_mfma_f32_16x16x32_bf16 v[68:71], v[172:175], v[208:211], v[68:71]
    s_waitcnt lgkmcnt(7)
    v_mfma_f32_16x16x32_bf16 v[72:75], v[168:171], v[212:215], v[72:75]
    ds_read_b128 v[208:211], v9 offset:21120
    v_mfma_f32_16x16x32_bf16 v[76:79], v[172:175], v[212:215], v[76:79]
    s_waitcnt lgkmcnt(7)
    v_mfma_f32_16x16x32_bf16 v[80:83], v[168:171], v[216:219], v[80:83]
    ds_read_b128 v[212:215], v9 offset:23168
    v_mfma_f32_16x16x32_bf16 v[84:87], v[172:175], v[216:219], v[84:87]
    s_waitcnt lgkmcnt(7)
    v_mfma_f32_16x16x32_bf16 v[88:91], v[168:171], v[220:223], v[88:91]
    ds_read_b128 v[216:219], v9 offset:46976
    v_mfma_f32_16x16x32_bf16 v[92:95], v[172:175], v[220:223], v[92:95]
    s_waitcnt vmcnt(2) lgkmcnt(7)
    v_mfma_f32_16x16x32_bf16 v[64:67], v[176:179], v[192:195], v[64:67]
    ds_read_b128 v[220:223], v9 offset:49024
    v_mfma_f32_16x16x32_bf16 v[68:71], v[180:183], v[192:195], v[68:71]
    s_waitcnt lgkmcnt(6)
    v_mfma_f32_16x16x32_bf16 v[72:75], v[176:179], v[196:199], v[72:75]
    v_mfma_f32_16x16x32_bf16 v[76:79], v[180:183], v[196:199], v[76:79]
    s_waitcnt lgkmcnt(5)
    v_mfma_f32_16x16x32_bf16 v[80:83], v[176:179], v[200:203], v[80:83]
    v_mfma_f32_16x16x32_bf16 v[84:87], v[180:183], v[200:203], v[84:87]
    s_waitcnt lgkmcnt(4)
    v_mfma_f32_16x16x32_bf16 v[88:91], v[176:179], v[204:207], v[88:91]
    v_mfma_f32_16x16x32_bf16 v[92:95], v[180:183], v[204:207], v[92:95]
    s_waitcnt vmcnt(0) lgkmcnt(3)
    v_mfma_f32_16x16x32_bf16 v[64:67], v[184:187], v[208:211], v[64:67]
    v_mfma_f32_16x16x32_bf16 v[68:71], v[188:191], v[208:211], v[68:71]
    s_waitcnt lgkmcnt(2)
    v_mfma_f32_16x16x32_bf16 v[72:75], v[184:187], v[212:215], v[72:75]
    v_mfma_f32_16x16x32_bf16 v[76:79], v[188:191], v[212:215], v[76:79]
    s_waitcnt lgkmcnt(1)
    v_mfma_f32_16x16x32_bf16 v[80:83], v[184:187], v[216:219], v[80:83]
    v_mfma_f32_16x16x32_bf16 v[84:87], v[188:191], v[216:219], v[84:87]
    s_waitcnt lgkmcnt(0)
    v_mfma_f32_16x16x32_bf16 v[88:91], v[184:187], v[220:223], v[88:91]
    v_mfma_f32_16x16x32_bf16 v[92:95], v[188:191], v[220:223], v[92:95]
    s_lshl_b32 s10, s6, 7
    s_lshl_b32 s11, s3, 5
    s_add_u32 s10, s10, s11
    v_lshrrev_b32 v32, 4, v2
    v_lshl_add_u32 v32, v32, 2, s10
    s_lshl_b32 s10, s7, 8
    s_add_u32 s10, s10, 4096
    v_and_b32 v33, 15, v2
    v_lshl_add_u32 v33, v33, 4, s10
    v_lshl_add_u32 v32, v32, 13, v33
    v_mov_b32 v224, v64
    v_mov_b32 v225, v72
    v_mov_b32 v226, v80
    v_mov_b32 v227, v88
    s_mov_b32 s10, 0
    buffer_store_dwordx4 v[224:227], v32, s[60:63], s10 offen nt
    v_mov_b32 v228, v65
    v_mov_b32 v229, v73
    v_mov_b32 v230, v81
    v_mov_b32 v231, v89
    s_mov_b32 s10, 8192
    buffer_store_dwordx4 v[228:231], v32, s[60:63], s10 offen nt
    v_mov_b32 v232, v66
    v_mov_b32 v233, v74
    v_mov_b32 v234, v82
    v_mov_b32 v235, v90
    s_mov_b32 s10, 16384
    buffer_store_dwordx4 v[232:235], v32, s[60:63], s10 offen nt
    v_mov_b32 v236, v67
    v_mov_b32 v237, v75
    v_mov_b32 v238, v83
    v_mov_b32 v239, v91
    s_mov_b32 s10, 24576
    buffer_store_dwordx4 v[236:239], v32, s[60:63], s10 offen nt
    v_mov_b32 v240, v68
    v_mov_b32 v241, v76
    v_mov_b32 v242, v84
    v_mov_b32 v243, v92
    s_mov_b32 s10, 131072
    buffer_store_dwordx4 v[240:243], v32, s[60:63], s10 offen nt
    v_mov_b32 v244, v69
    v_mov_b32 v245, v77
    v_mov_b32 v246, v85
    v_mov_b32 v247, v93
    s_mov_b32 s10, 139264
    buffer_store_dwordx4 v[244:247], v32, s[60:63], s10 offen nt
    v_mov_b32 v248, v70
    v_mov_b32 v249, v78
    v_mov_b32 v250, v86
    v_mov_b32 v251, v94
    s_mov_b32 s10, 147456
    buffer_store_dwordx4 v[248:251], v32, s[60:63], s10 offen nt
    v_mov_b32 v252, v71
    v_mov_b32 v253, v79
    v_mov_b32 v254, v87
    v_mov_b32 v255, v95
    s_mov_b32 s10, 155648
    buffer_store_dwordx4 v[252:255], v32, s[60:63], s10 offen nt
    s_endpgm
G2_slow3:
    s_mov_b32 s15, 0
G2_sl3_w:
    ds_read_b128 v[12:15], v11 offset:0
    s_waitcnt lgkmcnt(0)
    v_min3_u32 v12, v12, v13, v14
    v_min_u32 v12, v12, v15
    v_cmp_gt_u32 vcc, 20, v12
    s_cbranch_vccz G2_sl3_ok
    s_add_u32 s15, s15, 1
    s_cmp_lt_u32 s15, 160000
    s_cbranch_scc1 G2_sl3_w
G2_sl3_ok:
    s_branch G2_back3
G2_slow4:
    s_mov_b32 s15, 0
G2_sl4_w:
    ds_read_b128 v[12:15], v11 offset:0
    s_waitcnt lgkmcnt(0)
    v_min3_u32 v12, v12, v13, v14
    v_min_u32 v12, v12, v15
    v_cmp_gt_u32 vcc, 21, v12
    s_cbranch_vccz G2_sl4_ok
    s_add_u32 s15, s15, 1
    s_cmp_lt_u32 s15, 160000
    s_cbranch_scc1 G2_sl4_w
G2_sl4_ok:
    s_branch G2_back4
G2_slow5:
    s_mov_b32 s15, 0
G2_sl5_w:
    ds_read_b128 v[12:15], v11 offset:0
    s_waitcnt lgkmcnt(0)
    v_min3_u32 v12, v12, v13, v14
    v_min_u32 v12, v12, v15
    v_cmp_gt_u32 vcc, 22, v12
    s_cbranch_vccz G2_sl5_ok
    s_add_u32 s15, s15, 1
    s_cmp_lt_u32 s15, 160000
    s_cbranch_scc1 G2_sl5_w
G2_sl5_ok:
    s_branch G2_back5
G2_slow6:
    s_mov_b32 s15, 0
G2_sl6_w:
    ds_read_b128 v[12:15], v11 offset:0
    s_waitcnt lgkmcnt(0)
    v_min3_u32 v12, v12, v13, v14
    v_min_u32 v12, v12, v15
    v_cmp_gt_u32 vcc, 23, v12
    s_cbranch_vccz G2_sl6_ok
    s_add_u32 s15, s15, 1
    s_cmp_lt_u32 s15, 160000
    s_cbranch_scc1 G2_sl6_w
G2_sl6_ok:
    s_branch G2_back6
G2_slow7:
    s_mov_b32 s15, 0
G2_sl7_w:
    ds_read_b128 v[12:15], v11 offset:0
    s_waitcnt lgkmcnt(0)
    v_min3_u32 v12, v12, v13, v14
    v_min_u32 v12, v12, v15
    v_cmp_gt_u32 vcc, 24, v12
    s_cbranch_vccz G2_sl7_ok
    s_add_u32 s15, s15, 1
    s_cmp_lt_u32 s15, 160000
    s_cbranch_scc1 G2_sl7_w
G2_sl7_ok:
    s_branch G2_back7
G2_slow8:
    s_mov_b32 s15, 0
G2_sl8_w:
    ds_read_b128 v[12:15], v11 offset:0
    s_waitcnt lgkmcnt(0)
    v_min3_u32 v12, v12, v13, v14
    v_min_u32 v12, v12, v15
    v_cmp_gt_u32 vcc, 25, v12
    s_cbranch_vccz G2_sl8_ok
    s_add_u32 s15, s15, 1
    s_cmp_lt_u32 s15, 160000
    s_cbranch_scc1 G2_sl8_w
G2_sl8_ok:
    s_branch G2_back8
G2_slow10:
    s_mov_b32 s15, 0
G2_sl10_w:
    ds_read_b128 v[12:15], v11 offset:0
    s_waitcnt lgkmcnt(0)
    v_min3_u32 v12, v12, v13, v14
    v_min_u32 v12, v12, v15
    v_cmp_gt_u32 vcc, 27, v12
    s_cbranch_vccz G2_sl10_ok
    s_add_u32 s15, s15, 1
    s_cmp_lt_u32 s15, 160000
    s_cbranch_scc1 G2_sl10_w
G2_sl10_ok:
    s_branch G2_back10
G2_slowc:
    s_mov_b32 s15, 0
G2_slc_w:
    ds_read_b32 v18, v11 offset:68
    s_waitcnt lgkmcnt(0)
    v_cmp_gt_u32 vcc, 4, v18
    s_cbranch_vccz G2_slc_ok
    s_add_u32 s15, s15, 1
    s_cmp_lt_u32 s15, 160000
    s_cbranch_scc1 G2_slc_w
G2_slc_ok:
    s_branch G2_backc
Y_done:
    s_endpgm
Y_end:
.section .rodata,"a"
.p2align 6
.amdhsa_kernel concat_heads__ssm_conv_h3__ssm_conv_s5__prompt_kernel
  .amdhsa_next_free_vgpr 256
  .amdhsa_next_free_sgpr 102
  .amdhsa_accum_offset 256
  .amdhsa_group_segment_fixed_size 0
  .amdhsa_kernarg_size 144
  .amdhsa_user_sgpr_count 2
  .amdhsa_user_sgpr_kernarg_segment_ptr 1
  .amdhsa_system_sgpr_workgroup_id_x 1
.end_amdhsa_kernel
```
